```python
import torch

def _softmax(x, axis=-1):
    return torch.softmax(x, dim=axis)
def _gelu(x):
    return torch.nn.functional.gelu(x, approximate="tanh")
def _silu(x):
    return torch.nn.functional.silu(x)
def _sigmoid(x):
    return torch.sigmoid(x)
def _layernorm(x, axis=-1, eps=1e-5):
    m = x.mean(dim=axis, keepdim=True)
    v = x.var(dim=axis, keepdim=True, unbiased=False)
    return (x - m) / torch.sqrt(v + eps)
def _scatter_add(tgt, idx, src, axis=0):
    return tgt.clone().index_add_(axis, idx, src)
def _segment_sum(src, seg, n):
    out = torch.zeros((n,) + src.shape[1:], dtype=src.dtype)
    return out.index_add_(0, seg, src)
def _pad(x, pw):
    flat = tuple(v for pair in reversed(pw) for v in pair)
    return torch.nn.functional.pad(x, flat)

kernel_name = 'concat_heads__ssm_conv_h3__ssm_conv_s5__prompt'

def setup_inputs():

    _w = (lambda a: (lambda t: t.to(torch.bfloat16) if t.is_floating_point() else t)(torch.as_tensor(a)))
    def _A_setup():
        B, S, D = 1, 2048, 1024
        ks = 4
        return {
            "q": _w((lambda *s: torch.randn(*s, dtype=torch.bfloat16) * 0.05)(B, S, D)),
            "k": _w((lambda *s: torch.randn(*s, dtype=torch.bfloat16) * 0.2)(B, S, D)),
            "v": _w((lambda *s: torch.randn(*s, dtype=torch.bfloat16) * 0.2)(B, S, D)),
            "shift_k": _w((lambda *s: torch.randn(*s, dtype=torch.bfloat16) * 0.2)(D, ks) * 0.5),
            "ssm_k": _w((lambda *s: torch.randn(*s, dtype=torch.bfloat16) * 0.8)(D, S) * (1.0 / S ** 0.5)),
            "ssm_D": _w((lambda *s: torch.randn(*s, dtype=torch.bfloat16) * 0.2)(D)),
        }
    _A_in = _A_setup()

    def _B_setup():
        B, S, D = 1, 2048, 1024
        P = D
        Lambda_re = -0.5 * (lambda _x: torch.exp(torch.as_tensor(_x)))((lambda *s: torch.randn(*s, dtype=torch.bfloat16) * 0.2)(P))
        Lambda_im = (lambda *s: torch.randn(*s, dtype=torch.bfloat16) * 0.4)(P) * 1.0
        B_re = (lambda *s: torch.randn(*s, dtype=torch.bfloat16) * 0.2)(P, D) * (D ** -0.5)
        B_im = (lambda *s: torch.randn(*s, dtype=torch.bfloat16) * 0.2)(P, D) * (D ** -0.5)
        C_re = (lambda *s: torch.randn(*s, dtype=torch.bfloat16) * 0.2)(D, P) * (P ** -0.5)
        C_im = (lambda *s: torch.randn(*s, dtype=torch.bfloat16) * 0.2)(D, P) * (P ** -0.5)
        log_dt = (lambda *s: torch.randn(*s, dtype=torch.bfloat16) * 0.2)(P) * 0.3 - 2.0
        Dskip = (lambda *s: torch.randn(*s, dtype=torch.bfloat16) * 0.05)(D)
        return {
            "x": _w((lambda *s: torch.randn(*s, dtype=torch.bfloat16) * 0.05)(B, S, D)),
            "Lambda_re": _w(Lambda_re),
            "Lambda_im": _w(Lambda_im),
            "B_re": _w(B_re),
            "B_im": _w(B_im),
            "C_re": _w(C_re),
            "C_im": _w(C_im),
            "log_dt": _w(log_dt),
            "Dskip": _w(Dskip),
        }
    _B_in = _B_setup()

    return {
        "A_q": _A_in["q"],
        "A_k": _A_in["k"],
        "A_v": _A_in["v"],
        "A_shift_k": _A_in["shift_k"],
        "A_ssm_k": _A_in["ssm_k"],
        "A_ssm_D": _A_in["ssm_D"],
        "B_x": _B_in["x"],
        "B_Lambda_re": _B_in["Lambda_re"],
        "B_Lambda_im": _B_in["Lambda_im"],
        "B_B_re": _B_in["B_re"],
        "B_B_im": _B_in["B_im"],
        "B_C_re": _B_in["C_re"],
        "B_C_im": _B_in["C_im"],
        "B_log_dt": _B_in["log_dt"],
        "B_Dskip": _B_in["Dskip"],
    }

def reference(A_q, A_k, A_v, A_shift_k, A_ssm_k, A_ssm_D, B_x, B_Lambda_re, B_Lambda_im, B_B_re, B_B_im, B_C_re, B_C_im, B_log_dt, B_Dskip):
    def _A_ref(q, k, v, shift_k, ssm_k, ssm_D):
        B, S, D = q.shape
        ks = shift_k.shape[-1]
        k_pad = _pad(k, ((0, 0), (ks - 1, 0), (0, 0)))
        k_shift = torch.zeros_like(k)
        for t in range(ks):
            k_shift = k_shift + k_pad[:, t:t + S, :] * shift_k[:, ks - 1 - t][None, None, :]
        kv = k_shift * v
        L = 2 * S
        kv_pad = _pad(kv, ((0, 0), (0, S), (0, 0)))
        kf_pad = _pad(ssm_k, ((0, 0), (0, S)))
        kv_f = (lambda x, axes=(-2,-1): torch.fft.rfft2(x.float(), dim=axes))(kv_pad[:, None, :, :], axes=(1, 2))
        kf_f = (lambda x, axes=(-2,-1): torch.fft.rfft2(x.float(), dim=axes))(kf_pad[:, None, :], axes=(1, 2))
        kf_f = (lambda x, *d: x.permute(*d))(kf_f, 1, 2, 0)
        y_f = kv_f * kf_f[None, :, :, :]
        y = (lambda x, s, axes=(-2,-1): torch.fft.irfft2(x, s=s, dim=axes).to(torch.bfloat16))(y_f, (1, L), axes=(1, 2))[:, 0, :S, :]
        y = y + kv * ssm_D[None, None, :]
        return q * y

    def _B_ref(x, Lambda_re, Lambda_im, B_re, B_im, C_re, C_im, log_dt, Dskip):
        Bsz, L, H = x.shape
        Lam = Lambda_re + 1j * Lambda_im
        Bmat = B_re + 1j * B_im
        Cmat = C_re + 1j * C_im
        dt = torch.exp(log_dt)
        Lam_bar = torch.exp(dt * Lam)
        B_bar = ((Lam_bar - 1.0) / Lam)[:, None] * Bmat
        Bu = torch.einsum("bld,pd->blp", x + 0j, B_bar)
        h = torch.zeros_like(Bu[:, 0, :])
        hs = []
        for t in range(L):
            h = Lam_bar[None, :] * h + Bu[:, t, :]
            hs.append(h)
        hseq = torch.stack(hs, 1)
        y = 2.0 * torch.einsum("blp,dp->bld", hseq, Cmat).real + x * Dskip[None, None, :]
        return y

    a = _A_ref(A_q, A_k, A_v, A_shift_k, A_ssm_k, A_ssm_D)
    b = _B_ref(B_x, B_Lambda_re, B_Lambda_im, B_B_re, B_B_im, B_C_re, B_C_im, B_log_dt, B_Dskip)
    return torch.concatenate([a, b], axis=-1)
```

```asm
; @launch kernel=k1_kernel grid=(256,1,1) block=(512,1,1) lds=163840
; @launch kernel=k2_kernel grid=(256,1,1) block=(512,1,1) lds=147456
.amdgcn_target "amdgcn-amd-amdhsa--gfx950"
.text
.p2align 8
.globl k1_kernel
.type k1_kernel,@function
k1_kernel:
    s_cmp_ge_u32 s2, 256
    s_cbranch_scc1 K1_done
    s_load_dwordx16 s[32:47], s[0:1], 0
    s_load_dwordx16 s[48:63], s[0:1], 64
    s_load_dwordx4 s[64:67], s[0:1], 128
    v_lshrrev_b32 v1, 6, v0
    v_and_b32 v2, 63, v0
    s_and_b32 s6, s2, 3
    v_readfirstlane_b32 s5, v1
    s_lshl_b32 s6, s6, 2
    s_lshr_b32 s7, s2, 3
    s_and_b32 s3, s7, 3
    s_add_u32 s3, s3, s6
    s_and_b32 s6, s2, 4
    s_lshl_b32 s6, s6, 1
    s_lshr_b32 s4, s7, 2
    s_add_u32 s4, s4, s6
    s_cmp_lt_u32 s5, 4
    s_cbranch_scc1 K1_compute
    s_sub_u32 s6, s5, 4
    v_lshrrev_b32 v12, 3, v2
    v_and_b32 v13, 7, v2
    v_lshrrev_b32 v14, 4, v2
    v_xor_b32 v13, v13, v14
    v_lshlrev_b32 v13, 4, v13
    v_lshrrev_b32 v14, 5, v2
    v_lshlrev_b32 v14, 5, v14
    v_and_b32 v15, 3, v12
    v_add_u32 v14, v14, v15
    v_lshl_add_u32 v14, v14, 11, v13
    v_lshl_add_u32 v15, v12, 11, v13
    s_lshl_b32 s7, s3, 4
    s_add_u32 s7, s7, s6
    s_lshl_b32 s7, s7, 14
    v_add_u32 v4, s7, v14
    v_xor_b32 v5, 64, v4
    v_add_u32 v5, 0x1fc00, v5
    v_add_u32 v6, 0x1800, v4
    v_add_u32 v7, 0x1800, v5
    s_lshl_b32 s7, s4, 2
    s_add_u32 s7, s7, s6
    s_lshl_b32 s7, s7, 15
    v_add_u32 v8, s7, v15
    v_xor_b32 v9, 64, v8
    v_add_u32 v9, 0x3c00, v9
    s_and_b32 s30, s2, 3
    s_lshl_b32 s30, s30, 2
    s_and_b32 s31, s2, 4
    s_lshl_b32 s31, s31, 1
    s_add_u32 s30, s30, s31
    s_add_u32 s31, s3, s4
    s_and_b32 s31, s31, 1
    s_lshl_b32 s31, s31, 1
    s_add_u32 s30, s30, s31
    s_and_b32 s30, s30, 15
    s_lshl_b32 s100, s30, 7
    s_lshl_b32 s101, s6, 12
    s_waitcnt lgkmcnt(0)
    s_mov_b32 s8, s44
    s_mov_b32 s9, s45
    s_mov_b32 s10, 4194304
    s_mov_b32 s11, 0x00020000
    s_mov_b32 s12, s50
    s_mov_b32 s13, s51
    s_mov_b32 s14, 2097152
    s_mov_b32 s15, 0x00020000
    s_mov_b32 s16, s52
    s_mov_b32 s17, s53
    s_mov_b32 s18, 2097152
    s_mov_b32 s19, 0x00020000
    s_add_u32 m0, s101, 98304
    s_nop 0
    buffer_load_dwordx4 v4, s[8:11], s100 offen lds
    buffer_load_dwordx4 v5, s[8:11], s100 offen offset:1024 lds
    buffer_load_dwordx4 v6, s[8:11], s100 offen offset:2048 lds
    buffer_load_dwordx4 v7, s[8:11], s100 offen offset:3072 lds
    s_add_u32 m0, s101, 114688
    s_nop 0
    buffer_load_dwordx4 v8, s[12:15], s100 offen lds
    buffer_load_dwordx4 v9, s[12:15], s100 offen offset:1024 lds
    s_add_u32 m0, s101, 116736
    s_nop 0
    buffer_load_dwordx4 v8, s[16:19], s100 offen lds
    buffer_load_dwordx4 v9, s[16:19], s100 offen offset:1024 lds
    s_add_u32 s100, s100, 128
    s_and_b32 s100, s100, 2047
    s_add_u32 m0, s101, 0
    s_nop 0
    buffer_load_dwordx4 v4, s[8:11], s100 offen lds
    buffer_load_dwordx4 v5, s[8:11], s100 offen offset:1024 lds
    buffer_load_dwordx4 v6, s[8:11], s100 offen offset:2048 lds
    buffer_load_dwordx4 v7, s[8:11], s100 offen offset:3072 lds
    s_add_u32 m0, s101, 16384
    s_nop 0
    buffer_load_dwordx4 v8, s[12:15], s100 offen lds
    buffer_load_dwordx4 v9, s[12:15], s100 offen offset:1024 lds
    s_add_u32 m0, s101, 18432
    s_nop 0
    buffer_load_dwordx4 v8, s[16:19], s100 offen lds
    buffer_load_dwordx4 v9, s[16:19], s100 offen offset:1024 lds
    s_add_u32 s100, s100, 128
    s_and_b32 s100, s100, 2047
    s_mov_b32 s20, s34
    s_mov_b32 s21, s35
    s_mov_b32 s22, 4194304
    s_mov_b32 s23, 0x00020000
    s_mov_b32 s24, s36
    s_mov_b32 s25, s37
    s_mov_b32 s26, 4194304
    s_mov_b32 s27, 0x00020000
    s_mov_b32 s28, s38
    s_mov_b32 s29, s39
    s_mov_b32 s30, 8192
    s_mov_b32 s31, 0x00020000
    s_mov_b32 s68, s40
    s_mov_b32 s69, s41
    s_mov_b32 s70, 4194304
    s_mov_b32 s71, 0x00020000
    s_mov_b32 s72, s66
    s_mov_b32 s73, s67
    s_mov_b32 s74, 4194304
    s_mov_b32 s75, 0x00020000
    s_add_u32 s76, s66, 17825792
    s_addc_u32 s77, s67, 0
    s_mov_b32 s78, 2048
    s_mov_b32 s79, 0x00020000
    s_add_u32 s80, s66, 4194304
    s_addc_u32 s81, s67, 0
    s_mov_b32 s82, 4194304
    s_mov_b32 s83, 0x00020000
    s_lshr_b32 s7, s2, 3
    s_and_b32 s32, s7, 15
    s_lshr_b32 s7, s7, 4
    s_and_b32 s33, s2, 7
    s_lshl_b32 s33, s33, 1
    s_add_u32 s33, s33, s7
    s_lshl_b32 s34, s33, 4
    s_add_u32 s34, s34, s32
    s_lshl_b32 s34, s34, 2
    s_add_u32 s34, s34, s6
    s_lshl_b32 s35, s34, 12
    s_load_dword s36, s[40:41], s35
    s_lshr_b32 s7, s34, 1
    s_lshl_b32 s7, s7, 2
    s_load_dword s37, s[42:43], s7
    v_and_b32 v12, 15, v2
    v_lshrrev_b32 v13, 4, v2
    s_lshl_b32 s7, s32, 2
    s_add_u32 s7, s7, s6
    s_lshl_b32 s7, s7, 16
    s_lshl_b32 s38, s33, 7
    s_add_u32 s7, s7, s38
    v_lshlrev_b32 v10, 14, v13
    v_lshl_add_u32 v10, v12, 3, v10
    v_add_u32 v10, s7, v10
    v_subrev_u32 v11, 0x1800, v10
    v_bfrev_b32 v14, 1
    v_cmp_gt_i32 vcc, 0, v11
    s_lshl_b32 s7, s33, 9
    v_lshlrev_b32 v15, 5, v12
    v_cndmask_b32 v11, v11, v14, vcc
    v_add_u32 v14, s7, v15
    s_lshl_b32 s7, s6, 2
    v_add_u32 v15, s7, v13
    v_sub_u32 v15, 15, v15
    v_xor_b32 v15, v15, v12
    v_lshlrev_b32 v15, 4, v15
    v_lshl_add_u32 v15, v12, 10, v15
    v_add_u32 v15, 147456, v15
    s_mov_b32 s38, 4096
    s_mov_b32 s39, 8192
    s_mov_b32 s44, 12288
    s_waitcnt vmcnt(8)
    s_barrier
    s_add_u32 m0, s101, 32768
    s_nop 0
    buffer_load_dwordx4 v4, s[8:11], s100 offen lds
    buffer_load_dwordx4 v5, s[8:11], s100 offen offset:1024 lds
    buffer_load_dwordx4 v6, s[8:11], s100 offen offset:2048 lds
    buffer_load_dwordx4 v7, s[8:11], s100 offen offset:3072 lds
    s_add_u32 m0, s101, 49152
    s_nop 0
    buffer_load_dwordx4 v8, s[12:15], s100 offen lds
    buffer_load_dwordx4 v9, s[12:15], s100 offen offset:1024 lds
    s_add_u32 m0, s101, 51200
    s_nop 0
    buffer_load_dwordx4 v8, s[16:19], s100 offen lds
    buffer_load_dwordx4 v9, s[16:19], s100 offen offset:1024 lds
    s_add_u32 s100, s100, 128
    s_and_b32 s100, s100, 2047
    s_add_u32 m0, s101, 65536
    s_nop 0
    buffer_load_dwordx4 v4, s[8:11], s100 offen lds
    buffer_load_dwordx4 v5, s[8:11], s100 offen offset:1024 lds
    buffer_load_dwordx4 v6, s[8:11], s100 offen offset:2048 lds
    buffer_load_dwordx4 v7, s[8:11], s100 offen offset:3072 lds
    s_add_u32 m0, s101, 81920
    s_nop 0
    buffer_load_dwordx4 v8, s[12:15], s100 offen lds
    buffer_load_dwordx4 v9, s[12:15], s100 offen offset:1024 lds
    s_add_u32 m0, s101, 83968
    s_nop 0
    buffer_load_dwordx4 v8, s[16:19], s100 offen lds
    buffer_load_dwordx4 v9, s[16:19], s100 offen offset:1024 lds
    s_add_u32 s100, s100, 128
    s_and_b32 s100, s100, 2047
    s_waitcnt vmcnt(16)
    s_barrier
    buffer_load_dwordx4 v[16:19], v14, s[28:31], 0 offen
    buffer_load_dwordx4 v[20:23], v14, s[28:31], 0 offen offset:16
    buffer_load_dwordx2 v[40:41], v11, s[20:23], 0 offen offset:0
    buffer_load_dwordx2 v[42:43], v11, s[20:23], 0 offen offset:2048
    buffer_load_dwordx2 v[44:45], v11, s[20:23], s38 offen offset:0
    buffer_load_dwordx2 v[46:47], v10, s[20:23], 0 offen offset:0
    buffer_load_dwordx2 v[48:49], v10, s[20:23], 0 offen offset:2048
    buffer_load_dwordx2 v[50:51], v10, s[20:23], s38 offen offset:0
    buffer_load_dwordx2 v[52:53], v10, s[20:23], s38 offen offset:2048
    buffer_load_dwordx2 v[54:55], v10, s[20:23], s39 offen offset:0
    buffer_load_dwordx2 v[56:57], v10, s[20:23], s39 offen offset:2048
    s_add_u32 m0, s101, 98304
    s_nop 0
    buffer_load_dwordx4 v4, s[8:11], s100 offen lds
    buffer_load_dwordx4 v5, s[8:11], s100 offen offset:1024 lds
    buffer_load_dwordx4 v6, s[8:11], s100 offen offset:2048 lds
    buffer_load_dwordx4 v7, s[8:11], s100 offen offset:3072 lds
    s_add_u32 m0, s101, 114688
    s_nop 0
    buffer_load_dwordx4 v8, s[12:15], s100 offen lds
    buffer_load_dwordx4 v9, s[12:15], s100 offen offset:1024 lds
    s_add_u32 m0, s101, 116736
    s_nop 0
    buffer_load_dwordx4 v8, s[16:19], s100 offen lds
    buffer_load_dwordx4 v9, s[16:19], s100 offen offset:1024 lds
    s_add_u32 s100, s100, 128
    s_and_b32 s100, s100, 2047
    s_waitcnt vmcnt(27)
    s_barrier
    buffer_load_dwordx2 v[58:59], v10, s[20:23], s44 offen offset:0
    buffer_load_dwordx2 v[60:61], v10, s[20:23], s44 offen offset:2048
    buffer_load_dwordx2 v[62:63], v10, s[24:27], 0 offen offset:0
    buffer_load_dwordx2 v[64:65], v10, s[24:27], 0 offen offset:2048
    buffer_load_dwordx2 v[66:67], v10, s[24:27], s38 offen offset:0
    buffer_load_dwordx2 v[68:69], v10, s[24:27], s38 offen offset:2048
    buffer_load_dwordx2 v[70:71], v10, s[24:27], s39 offen offset:0
    buffer_load_dwordx2 v[72:73], v10, s[24:27], s39 offen offset:2048
    buffer_load_dwordx2 v[74:75], v10, s[24:27], s44 offen offset:0
    buffer_load_dwordx2 v[76:77], v10, s[24:27], s44 offen offset:2048
    s_add_u32 m0, s101, 0
    s_nop 0
    buffer_load_dwordx4 v4, s[8:11], s100 offen lds
    buffer_load_dwordx4 v5, s[8:11], s100 offen offset:1024 lds
    buffer_load_dwordx4 v6, s[8:11], s100 offen offset:2048 lds
    buffer_load_dwordx4 v7, s[8:11], s100 offen offset:3072 lds
    s_add_u32 m0, s101, 16384
    s_nop 0
    buffer_load_dwordx4 v8, s[12:15], s100 offen lds
    buffer_load_dwordx4 v9, s[12:15], s100 offen offset:1024 lds
    s_add_u32 m0, s101, 18432
    s_nop 0
    buffer_load_dwordx4 v8, s[16:19], s100 offen lds
    buffer_load_dwordx4 v9, s[16:19], s100 offen offset:1024 lds
    s_add_u32 s100, s100, 128
    s_and_b32 s100, s100, 2047
    s_waitcnt vmcnt(37)
    s_barrier
    s_add_u32 m0, s101, 32768
    s_nop 0
    buffer_load_dwordx4 v4, s[8:11], s100 offen lds
    buffer_load_dwordx4 v5, s[8:11], s100 offen offset:1024 lds
    buffer_load_dwordx4 v6, s[8:11], s100 offen offset:2048 lds
    buffer_load_dwordx4 v7, s[8:11], s100 offen offset:3072 lds
    s_add_u32 m0, s101, 49152
    s_nop 0
    buffer_load_dwordx4 v8, s[12:15], s100 offen lds
    buffer_load_dwordx4 v9, s[12:15], s100 offen offset:1024 lds
    s_add_u32 m0, s101, 51200
    s_nop 0
    buffer_load_dwordx4 v8, s[16:19], s100 offen lds
    buffer_load_dwordx4 v9, s[16:19], s100 offen offset:1024 lds
    s_add_u32 s100, s100, 128
    s_and_b32 s100, s100, 2047
    s_waitcnt vmcnt(26)
    s_barrier
    s_add_u32 m0, s101, 65536
    s_nop 0
    buffer_load_dwordx4 v4, s[8:11], s100 offen lds
    buffer_load_dwordx4 v5, s[8:11], s100 offen offset:1024 lds
    buffer_load_dwordx4 v6, s[8:11], s100 offen offset:2048 lds
    buffer_load_dwordx4 v7, s[8:11], s100 offen offset:3072 lds
    s_add_u32 m0, s101, 81920
    s_nop 0
    buffer_load_dwordx4 v8, s[12:15], s100 offen lds
    buffer_load_dwordx4 v9, s[12:15], s100 offen offset:1024 lds
    s_add_u32 m0, s101, 83968
    s_nop 0
    buffer_load_dwordx4 v8, s[16:19], s100 offen lds
    buffer_load_dwordx4 v9, s[16:19], s100 offen offset:1024 lds
    s_add_u32 s100, s100, 128
    s_and_b32 s100, s100, 2047
    s_waitcnt vmcnt(16)
    s_barrier
    s_waitcnt vmcnt(24)
    s_add_u32 m0, s101, 98304
    s_nop 0
    buffer_load_dwordx4 v4, s[8:11], s100 offen lds
    v_lshlrev_b32 v24, 16, v16
    v_and_b32 v25, 0xffff0000, v16
    v_lshlrev_b32 v26, 16, v17
    v_and_b32 v27, 0xffff0000, v17
    v_lshlrev_b32 v78, 16, v40
    v_lshlrev_b32 v79, 16, v42
    v_lshlrev_b32 v80, 16, v44
    v_lshlrev_b32 v81, 16, v46
    v_lshlrev_b32 v82, 16, v48
    buffer_load_dwordx4 v5, s[8:11], s100 offen offset:1024 lds
    v_lshlrev_b32 v83, 16, v50
    v_lshlrev_b32 v84, 16, v52
    v_lshlrev_b32 v85, 16, v54
    v_lshlrev_b32 v86, 16, v56
    v_lshlrev_b32 v87, 16, v58
    v_lshlrev_b32 v88, 16, v60
    v_mul_f32 v90, v24, v81
    v_mul_f32 v91, v24, v82
    v_mul_f32 v92, v24, v83
    buffer_load_dwordx4 v6, s[8:11], s100 offen offset:2048 lds
    v_mul_f32 v93, v24, v84
    v_mul_f32 v94, v24, v85
    v_mul_f32 v95, v24, v86
    v_mul_f32 v96, v24, v87
    v_mul_f32 v97, v24, v88
    v_fmac_f32 v90, v25, v80
    v_fmac_f32 v91, v25, v81
    v_fmac_f32 v92, v25, v82
    v_fmac_f32 v93, v25, v83
    buffer_load_dwordx4 v7, s[8:11], s100 offen offset:3072 lds
    v_fmac_f32 v94, v25, v84
    v_fmac_f32 v95, v25, v85
    v_fmac_f32 v96, v25, v86
    v_fmac_f32 v97, v25, v87
    v_fmac_f32 v90, v26, v79
    v_fmac_f32 v91, v26, v80
    v_fmac_f32 v92, v26, v81
    v_fmac_f32 v93, v26, v82
    v_fmac_f32 v94, v26, v83
    s_add_u32 m0, s101, 114688
    s_nop 0
    buffer_load_dwordx4 v8, s[12:15], s100 offen lds
    v_fmac_f32 v95, v26, v84
    v_fmac_f32 v96, v26, v85
    v_fmac_f32 v97, v26, v86
    v_fmac_f32 v90, v27, v78
    v_fmac_f32 v91, v27, v79
    v_fmac_f32 v92, v27, v80
    v_fmac_f32 v93, v27, v81
    v_fmac_f32 v94, v27, v82
    v_fmac_f32 v95, v27, v83
    buffer_load_dwordx4 v9, s[12:15], s100 offen offset:1024 lds
    v_fmac_f32 v96, v27, v84
    v_fmac_f32 v97, v27, v85
    v_lshlrev_b32 v78, 16, v62
    v_lshlrev_b32 v79, 16, v64
    v_lshlrev_b32 v80, 16, v66
    v_lshlrev_b32 v81, 16, v68
    v_lshlrev_b32 v82, 16, v70
    v_lshlrev_b32 v83, 16, v72
    v_lshlrev_b32 v84, 16, v74
    s_add_u32 m0, s101, 116736
    s_nop 0
    buffer_load_dwordx4 v8, s[16:19], s100 offen lds
    v_lshlrev_b32 v85, 16, v76
    v_mul_f32 v90, v90, v78
    v_mul_f32 v91, v91, v79
    v_mul_f32 v92, v92, v80
    v_mul_f32 v93, v93, v81
    v_mul_f32 v94, v94, v82
    v_mul_f32 v95, v95, v83
    v_mul_f32 v96, v96, v84
    v_mul_f32 v97, v97, v85
    buffer_load_dwordx4 v9, s[16:19], s100 offen offset:1024 lds
    s_add_u32 s100, s100, 128
    s_and_b32 s100, s100, 2047
    v_cvt_pk_bf16_f32 v98, v97, v96
    v_cvt_pk_bf16_f32 v99, v95, v94
    v_cvt_pk_bf16_f32 v100, v93, v92
    v_cvt_pk_bf16_f32 v101, v91, v90
    ds_write_b128 v15, v[98:101] offset:0
    s_waitcnt vmcnt(16) lgkmcnt(0)
    s_barrier
    s_add_u32 m0, s101, 0
    s_nop 0
    buffer_load_dwordx4 v4, s[8:11], s100 offen lds
    v_lshlrev_b32 v24, 16, v18
    v_and_b32 v25, 0xffff0000, v18
    v_lshlrev_b32 v26, 16, v19
    v_and_b32 v27, 0xffff0000, v19
    v_and_b32 v78, 0xffff0000, v40
    v_and_b32 v79, 0xffff0000, v42
    v_and_b32 v80, 0xffff0000, v44
    v_and_b32 v81, 0xffff0000, v46
    v_and_b32 v82, 0xffff0000, v48
    buffer_load_dwordx4 v5, s[8:11], s100 offen offset:1024 lds
    v_and_b32 v83, 0xffff0000, v50
    v_and_b32 v84, 0xffff0000, v52
    v_and_b32 v85, 0xffff0000, v54
    v_and_b32 v86, 0xffff0000, v56
    v_and_b32 v87, 0xffff0000, v58
    v_and_b32 v88, 0xffff0000, v60
    v_mul_f32 v90, v24, v81
    v_mul_f32 v91, v24, v82
    v_mul_f32 v92, v24, v83
    buffer_load_dwordx4 v6, s[8:11], s100 offen offset:2048 lds
    v_mul_f32 v93, v24, v84
    v_mul_f32 v94, v24, v85
    v_mul_f32 v95, v24, v86
    v_mul_f32 v96, v24, v87
    v_mul_f32 v97, v24, v88
    v_fmac_f32 v90, v25, v80
    v_fmac_f32 v91, v25, v81
    v_fmac_f32 v92, v25, v82
    v_fmac_f32 v93, v25, v83
    buffer_load_dwordx4 v7, s[8:11], s100 offen offset:3072 lds
    v_fmac_f32 v94, v25, v84
    v_fmac_f32 v95, v25, v85
    v_fmac_f32 v96, v25, v86
    v_fmac_f32 v97, v25, v87
    v_fmac_f32 v90, v26, v79
    v_fmac_f32 v91, v26, v80
    v_fmac_f32 v92, v26, v81
    v_fmac_f32 v93, v26, v82
    v_fmac_f32 v94, v26, v83
    s_add_u32 m0, s101, 16384
    s_nop 0
    buffer_load_dwordx4 v8, s[12:15], s100 offen lds
    v_fmac_f32 v95, v26, v84
    v_fmac_f32 v96, v26, v85
    v_fmac_f32 v97, v26, v86
    v_fmac_f32 v90, v27, v78
    v_fmac_f32 v91, v27, v79
    v_fmac_f32 v92, v27, v80
    v_fmac_f32 v93, v27, v81
    v_fmac_f32 v94, v27, v82
    v_fmac_f32 v95, v27, v83
    buffer_load_dwordx4 v9, s[12:15], s100 offen offset:1024 lds
    v_fmac_f32 v96, v27, v84
    v_fmac_f32 v97, v27, v85
    v_and_b32 v78, 0xffff0000, v62
    v_and_b32 v79, 0xffff0000, v64
    v_and_b32 v80, 0xffff0000, v66
    v_and_b32 v81, 0xffff0000, v68
    v_and_b32 v82, 0xffff0000, v70
    v_and_b32 v83, 0xffff0000, v72
    v_and_b32 v84, 0xffff0000, v74
    s_add_u32 m0, s101, 18432
    s_nop 0
    buffer_load_dwordx4 v8, s[16:19], s100 offen lds
    v_and_b32 v85, 0xffff0000, v76
    v_mul_f32 v90, v90, v78
    v_mul_f32 v91, v91, v79
    v_mul_f32 v92, v92, v80
    v_mul_f32 v93, v93, v81
    v_mul_f32 v94, v94, v82
    v_mul_f32 v95, v95, v83
    v_mul_f32 v96, v96, v84
    v_mul_f32 v97, v97, v85
    buffer_load_dwordx4 v9, s[16:19], s100 offen offset:1024 lds
    s_add_u32 s100, s100, 128
    s_and_b32 s100, s100, 2047
    v_cvt_pk_bf16_f32 v102, v97, v96
    v_cvt_pk_bf16_f32 v103, v95, v94
    v_cvt_pk_bf16_f32 v104, v93, v92
    v_cvt_pk_bf16_f32 v105, v91, v90
    ds_write_b128 v15, v[102:105] offset:256
    s_waitcnt vmcnt(16) lgkmcnt(0)
    s_barrier
    s_add_u32 m0, s101, 32768
    s_nop 0
    buffer_load_dwordx4 v4, s[8:11], s100 offen lds
    v_lshlrev_b32 v24, 16, v20
    v_and_b32 v25, 0xffff0000, v20
    v_lshlrev_b32 v26, 16, v21
    v_and_b32 v27, 0xffff0000, v21
    v_lshlrev_b32 v78, 16, v41
    v_lshlrev_b32 v79, 16, v43
    v_lshlrev_b32 v80, 16, v45
    v_lshlrev_b32 v81, 16, v47
    v_lshlrev_b32 v82, 16, v49
    buffer_load_dwordx4 v5, s[8:11], s100 offen offset:1024 lds
    v_lshlrev_b32 v83, 16, v51
    v_lshlrev_b32 v84, 16, v53
    v_lshlrev_b32 v85, 16, v55
    v_lshlrev_b32 v86, 16, v57
    v_lshlrev_b32 v87, 16, v59
    v_lshlrev_b32 v88, 16, v61
    v_mul_f32 v90, v24, v81
    v_mul_f32 v91, v24, v82
    v_mul_f32 v92, v24, v83
    buffer_load_dwordx4 v6, s[8:11], s100 offen offset:2048 lds
    v_mul_f32 v93, v24, v84
    v_mul_f32 v94, v24, v85
    v_mul_f32 v95, v24, v86
    v_mul_f32 v96, v24, v87
    v_mul_f32 v97, v24, v88
    v_fmac_f32 v90, v25, v80
    v_fmac_f32 v91, v25, v81
    v_fmac_f32 v92, v25, v82
    v_fmac_f32 v93, v25, v83
    buffer_load_dwordx4 v7, s[8:11], s100 offen offset:3072 lds
    v_fmac_f32 v94, v25, v84
    v_fmac_f32 v95, v25, v85
    v_fmac_f32 v96, v25, v86
    v_fmac_f32 v97, v25, v87
    v_fmac_f32 v90, v26, v79
    v_fmac_f32 v91, v26, v80
    v_fmac_f32 v92, v26, v81
    v_fmac_f32 v93, v26, v82
    v_fmac_f32 v94, v26, v83
    s_add_u32 m0, s101, 49152
    s_nop 0
    buffer_load_dwordx4 v8, s[12:15], s100 offen lds
    v_fmac_f32 v95, v26, v84
    v_fmac_f32 v96, v26, v85
    v_fmac_f32 v97, v26, v86
    v_fmac_f32 v90, v27, v78
    v_fmac_f32 v91, v27, v79
    v_fmac_f32 v92, v27, v80
    v_fmac_f32 v93, v27, v81
    v_fmac_f32 v94, v27, v82
    v_fmac_f32 v95, v27, v83
    buffer_load_dwordx4 v9, s[12:15], s100 offen offset:1024 lds
    v_fmac_f32 v96, v27, v84
    v_fmac_f32 v97, v27, v85
    v_lshlrev_b32 v78, 16, v63
    v_lshlrev_b32 v79, 16, v65
    v_lshlrev_b32 v80, 16, v67
    v_lshlrev_b32 v81, 16, v69
    v_lshlrev_b32 v82, 16, v71
    v_lshlrev_b32 v83, 16, v73
    v_lshlrev_b32 v84, 16, v75
    s_add_u32 m0, s101, 51200
    s_nop 0
    buffer_load_dwordx4 v8, s[16:19], s100 offen lds
    v_lshlrev_b32 v85, 16, v77
    v_mul_f32 v90, v90, v78
    v_mul_f32 v91, v91, v79
    v_mul_f32 v92, v92, v80
    v_mul_f32 v93, v93, v81
    v_mul_f32 v94, v94, v82
    v_mul_f32 v95, v95, v83
    v_mul_f32 v96, v96, v84
    v_mul_f32 v97, v97, v85
    buffer_load_dwordx4 v9, s[16:19], s100 offen offset:1024 lds
    s_add_u32 s100, s100, 128
    s_and_b32 s100, s100, 2047
    v_cvt_pk_bf16_f32 v98, v97, v96
    v_cvt_pk_bf16_f32 v99, v95, v94
    v_cvt_pk_bf16_f32 v100, v93, v92
    v_cvt_pk_bf16_f32 v101, v91, v90
    ds_write_b128 v15, v[98:101] offset:512
    s_waitcnt vmcnt(16) lgkmcnt(0)
    s_barrier
    s_add_u32 m0, s101, 65536
    s_nop 0
    buffer_load_dwordx4 v4, s[8:11], s100 offen lds
    v_lshlrev_b32 v24, 16, v22
    v_and_b32 v25, 0xffff0000, v22
    v_lshlrev_b32 v26, 16, v23
    v_and_b32 v27, 0xffff0000, v23
    v_and_b32 v78, 0xffff0000, v41
    v_and_b32 v79, 0xffff0000, v43
    v_and_b32 v80, 0xffff0000, v45
    v_and_b32 v81, 0xffff0000, v47
    v_and_b32 v82, 0xffff0000, v49
    buffer_load_dwordx4 v5, s[8:11], s100 offen offset:1024 lds
    v_and_b32 v83, 0xffff0000, v51
    v_and_b32 v84, 0xffff0000, v53
    v_and_b32 v85, 0xffff0000, v55
    v_and_b32 v86, 0xffff0000, v57
    v_and_b32 v87, 0xffff0000, v59
    v_and_b32 v88, 0xffff0000, v61
    v_mul_f32 v90, v24, v81
    v_mul_f32 v91, v24, v82
    v_mul_f32 v92, v24, v83
    buffer_load_dwordx4 v6, s[8:11], s100 offen offset:2048 lds
    v_mul_f32 v93, v24, v84
    v_mul_f32 v94, v24, v85
    v_mul_f32 v95, v24, v86
    v_mul_f32 v96, v24, v87
    v_mul_f32 v97, v24, v88
    v_fmac_f32 v90, v25, v80
    v_fmac_f32 v91, v25, v81
    v_fmac_f32 v92, v25, v82
    v_fmac_f32 v93, v25, v83
    buffer_load_dwordx4 v7, s[8:11], s100 offen offset:3072 lds
    v_fmac_f32 v94, v25, v84
    v_fmac_f32 v95, v25, v85
    v_fmac_f32 v96, v25, v86
    v_fmac_f32 v97, v25, v87
    v_fmac_f32 v90, v26, v79
    v_fmac_f32 v91, v26, v80
    v_fmac_f32 v92, v26, v81
    v_fmac_f32 v93, v26, v82
    v_fmac_f32 v94, v26, v83
    s_add_u32 m0, s101, 81920
    s_nop 0
    buffer_load_dwordx4 v8, s[12:15], s100 offen lds
    v_fmac_f32 v95, v26, v84
    v_fmac_f32 v96, v26, v85
    v_fmac_f32 v97, v26, v86
    v_fmac_f32 v90, v27, v78
    v_fmac_f32 v91, v27, v79
    v_fmac_f32 v92, v27, v80
    v_fmac_f32 v93, v27, v81
    v_fmac_f32 v94, v27, v82
    v_fmac_f32 v95, v27, v83
    buffer_load_dwordx4 v9, s[12:15], s100 offen offset:1024 lds
    v_fmac_f32 v96, v27, v84
    v_fmac_f32 v97, v27, v85
    v_and_b32 v78, 0xffff0000, v63
    v_and_b32 v79, 0xffff0000, v65
    v_and_b32 v80, 0xffff0000, v67
    v_and_b32 v81, 0xffff0000, v69
    v_and_b32 v82, 0xffff0000, v71
    v_and_b32 v83, 0xffff0000, v73
    v_and_b32 v84, 0xffff0000, v75
    s_add_u32 m0, s101, 83968
    s_nop 0
    buffer_load_dwordx4 v8, s[16:19], s100 offen lds
    v_and_b32 v85, 0xffff0000, v77
    v_mul_f32 v90, v90, v78
    v_mul_f32 v91, v91, v79
    v_mul_f32 v92, v92, v80
    v_mul_f32 v93, v93, v81
    v_mul_f32 v94, v94, v82
    v_mul_f32 v95, v95, v83
    v_mul_f32 v96, v96, v84
    v_mul_f32 v97, v97, v85
    buffer_load_dwordx4 v9, s[16:19], s100 offen offset:1024 lds
    s_add_u32 s100, s100, 128
    s_and_b32 s100, s100, 2047
    v_cvt_pk_bf16_f32 v102, v97, v96
    v_cvt_pk_bf16_f32 v103, v95, v94
    v_cvt_pk_bf16_f32 v104, v93, v92
    v_cvt_pk_bf16_f32 v105, v91, v90
    ds_write_b128 v15, v[102:105] offset:768
    s_waitcnt vmcnt(16) lgkmcnt(0)
    s_barrier
    s_add_u32 m0, s101, 98304
    s_nop 0
    buffer_load_dwordx4 v4, s[8:11], s100 offen lds
    buffer_load_dwordx4 v5, s[8:11], s100 offen offset:1024 lds
    buffer_load_dwordx4 v6, s[8:11], s100 offen offset:2048 lds
    buffer_load_dwordx4 v7, s[8:11], s100 offen offset:3072 lds
    s_add_u32 m0, s101, 114688
    s_nop 0
    buffer_load_dwordx4 v8, s[12:15], s100 offen lds
    buffer_load_dwordx4 v9, s[12:15], s100 offen offset:1024 lds
    s_add_u32 m0, s101, 116736
    s_nop 0
    buffer_load_dwordx4 v8, s[16:19], s100 offen lds
    buffer_load_dwordx4 v9, s[16:19], s100 offen offset:1024 lds
    s_add_u32 s100, s100, 128
    s_and_b32 s100, s100, 2047
    s_waitcnt vmcnt(16)
    s_barrier
    s_add_u32 m0, s101, 0
    s_nop 0
    buffer_load_dwordx4 v4, s[8:11], s100 offen lds
    buffer_load_dwordx4 v5, s[8:11], s100 offen offset:1024 lds
    buffer_load_dwordx4 v6, s[8:11], s100 offen offset:2048 lds
    buffer_load_dwordx4 v7, s[8:11], s100 offen offset:3072 lds
    s_add_u32 m0, s101, 16384
    s_nop 0
    buffer_load_dwordx4 v8, s[12:15], s100 offen lds
    buffer_load_dwordx4 v9, s[12:15], s100 offen offset:1024 lds
    s_add_u32 m0, s101, 18432
    s_nop 0
    buffer_load_dwordx4 v8, s[16:19], s100 offen lds
    buffer_load_dwordx4 v9, s[16:19], s100 offen offset:1024 lds
    s_add_u32 s100, s100, 128
    s_and_b32 s100, s100, 2047
    s_waitcnt vmcnt(16)
    s_barrier
    s_add_u32 m0, s101, 32768
    s_nop 0
    buffer_load_dwordx4 v4, s[8:11], s100 offen lds
    s_waitcnt lgkmcnt(0)
    s_mul_i32 s45, s6, 4160
    s_mul_i32 s46, s6, 4608
    v_lshlrev_b32 v16, 4, v13
    v_lshl_add_u32 v16, v12, 1, v16
    v_and_b32 v1, 1, v12
    v_mov_b32 v3, 98304
    v_mov_b32 v14, 133442
    v_cmp_eq_u32 vcc, 1, v1
    buffer_load_dwordx4 v5, s[8:11], s100 offen offset:1024 lds
    s_and_b32 s7, s34, 1
    s_lshl_b32 s7, s7, 4
    v_cndmask_b32 v3, v3, v14, vcc
    v_add3_u32 v16, v16, v3, s45
    v_add_u32 v17, 1024, v16
    v_add_u32 v18, 2048, v16
    v_add_u32 v19, 3072, v16
    s_add_u32 s47, s46, 115424
    v_lshlrev_b32 v1, 4, v13
    buffer_load_dwordx4 v6, s[8:11], s100 offen offset:2048 lds
    v_lshlrev_b32 v3, 5, v12
    v_sub_u32 v1, v1, v3
    v_add_u32 v20, s47, v1
    s_lshr_b32 s37, s37, s7
    s_and_b32 s37, s37, 0xffff
    v_lshlrev_b32 v1, 3, v13
    v_add_u32 v1, v1, v12
    v_sub_u32 v1, 15, v1
    v_and_b32 v3, 1, v1
    buffer_load_dwordx4 v7, s[8:11], s100 offen offset:3072 lds
    v_lshlrev_b32 v3, 4, v3
    v_lshlrev_b32 v3, v3, s37
    v_lshrrev_b32 v1, 1, v1
    v_cmp_eq_u32 vcc, 0, v1
    s_nop 1
    v_cndmask_b32 v24, 0, v3, vcc
    v_cmp_eq_u32 vcc, 1, v1
    s_nop 1
    v_cndmask_b32 v25, 0, v3, vcc
    s_add_u32 m0, s101, 49152
    s_nop 0
    buffer_load_dwordx4 v8, s[12:15], s100 offen lds
    v_cmp_eq_u32 vcc, 2, v1
    s_nop 1
    v_cndmask_b32 v26, 0, v3, vcc
    v_cmp_eq_u32 vcc, 3, v1
    s_nop 1
    v_cndmask_b32 v27, 0, v3, vcc
    v_and_b32 v1, 1, v13
    v_lshlrev_b32 v1, 9, v1
    v_lshrrev_b32 v3, 1, v13
    buffer_load_dwordx4 v9, s[12:15], s100 offen offset:1024 lds
    v_lshl_add_u32 v1, v3, 8, v1
    v_lshl_add_u32 v1, v12, 4, v1
    v_add_u32 v21, s35, v1
    v_lshlrev_b32 v10, 4, v2
    v_add_u32 v11, 2, v10
    s_lshl_b32 s7, s33, 7
    v_lshlrev_b32 v14, 3, v12
    v_add_u32 v14, s7, v14
    v_mov_b32 v1, 133376
    s_add_u32 m0, s101, 51200
    s_nop 0
    buffer_load_dwordx4 v8, s[16:19], s100 offen lds
    ds_read_b64 v[28:29], v1
    buffer_load_dwordx4 v9, s[16:19], s100 offen offset:1024 lds
    s_add_u32 s100, s100, 128
    s_and_b32 s100, s100, 2047
    s_waitcnt vmcnt(16)
    s_barrier
    s_add_u32 m0, s101, 65536
    s_nop 0
    buffer_load_dwordx4 v4, s[8:11], s100 offen lds
    buffer_load_dwordx4 v5, s[8:11], s100 offen offset:1024 lds
    buffer_load_dwordx4 v6, s[8:11], s100 offen offset:2048 lds
    buffer_load_dwordx4 v7, s[8:11], s100 offen offset:3072 lds
    s_add_u32 m0, s101, 81920
    s_nop 0
    buffer_load_dwordx4 v8, s[12:15], s100 offen lds
    buffer_load_dwordx4 v9, s[12:15], s100 offen offset:1024 lds
    s_add_u32 m0, s101, 83968
    s_nop 0
    buffer_load_dwordx4 v8, s[16:19], s100 offen lds
    buffer_load_dwordx4 v9, s[16:19], s100 offen offset:1024 lds
    s_add_u32 s100, s100, 128
    s_and_b32 s100, s100, 2047
    buffer_load_dwordx2 v[22:23], v14, s[76:79], 0 offen sc1
    s_add_u32 m0, s45, 133472
    s_nop 0
    buffer_load_dwordx4 v10, s[68:71], s35 offen offset:0 lds
    buffer_load_dwordx4 v10, s[68:71], s35 offen offset:1024 lds
    buffer_load_dwordx4 v10, s[68:71], s35 offen offset:2048 lds
    buffer_load_dwordx4 v10, s[68:71], s35 offen offset:3072 lds
    s_waitcnt vmcnt(21)
    s_barrier
    s_add_u32 m0, s45, 98336
    s_nop 0
    buffer_load_dwordx4 v11, s[68:71], s35 offen offset:0 lds
    buffer_load_dwordx4 v11, s[68:71], s35 offen offset:1024 lds
    buffer_load_dwordx4 v11, s[68:71], s35 offen offset:2048 lds
    buffer_load_dwordx4 v11, s[68:71], s35 offen offset:3072 lds
    v_mov_b32 v32, 0
    v_mov_b32 v33, 0
    v_mov_b32 v34, 0
    v_mov_b32 v35, 0
    s_add_u32 s47, s46, 119040
    v_add_u32 v1, s47, v10
    v_and_b32 v3, 16, v10
    v_and_b32 v15, 32, v10
    v_mul_u32_u24 v15, 1098, v15
    v_add3_u32 v3, v3, v15, s45
    v_add_u32 v3, 98304, v3
    v_cmp_gt_u32 vcc, 32, v2
    s_add_u32 s47, s45, 98334
    v_mov_b32 v15, s36
    v_cndmask_b32 v1, v3, v1, vcc
    v_mov_b32 v3, s47
    ds_write_b128 v1, v[32:35]
    ds_write_b16 v3, v15
    s_waitcnt vmcnt(17)
    s_barrier
    s_waitcnt vmcnt(8) lgkmcnt(0)
    v_cmp_eq_u32 vcc, v22, v28
    v_cmp_eq_u32 s[48:49], v23, v29
    v_bfrev_b32 v1, 1
    s_and_b64 s[48:49], s[48:49], vcc
    s_cmp_eq_u64 s[48:49], -1
    s_cselect_b32 s50, 1, 0
    s_cselect_b64 vcc, -1, 0
    s_nop 1
    v_cndmask_b32 v1, v1, v10, vcc
    buffer_load_dwordx4 v[192:195], v1, s[72:75], s35 offen offset:0 sc1
    buffer_load_dwordx4 v[196:199], v1, s[72:75], s35 offen offset:1024 sc1
    buffer_load_dwordx4 v[200:203], v1, s[72:75], s35 offen offset:2048 sc1
    buffer_load_dwordx4 v[204:207], v1, s[72:75], s35 offen offset:3072 sc1
    s_waitcnt vmcnt(13)
    s_barrier
    s_barrier
    s_cmp_eq_u32 s50, 1
    s_cbranch_scc1 K1L_have
    s_mov_b32 s51, 0
K1L_spin:
    buffer_load_dwordx2 v[22:23], v14, s[76:79], 0 offen sc1
    s_add_u32 s51, s51, 1
    s_waitcnt vmcnt(0)
    v_cmp_eq_u32 vcc, v22, v28
    v_cmp_eq_u32 s[48:49], v23, v29
    s_cmp_gt_u32 s51, 4096
    s_cbranch_scc1 K1L_go
    s_and_b64 s[48:49], s[48:49], vcc
    s_cmp_eq_u64 s[48:49], -1
    s_cbranch_scc0 K1L_spin
K1L_go:
    buffer_load_dwordx4 v[192:195], v10, s[72:75], s35 offen offset:0 sc1
    buffer_load_dwordx4 v[196:199], v10, s[72:75], s35 offen offset:1024 sc1
    buffer_load_dwordx4 v[200:203], v10, s[72:75], s35 offen offset:2048 sc1
    buffer_load_dwordx4 v[204:207], v10, s[72:75], s35 offen offset:3072 sc1
K1L_have:
    s_add_u32 s47, s46, 114944
    v_add_u32 v1, s47, v10
    s_waitcnt vmcnt(0)
    ds_write_b128 v1, v[192:195] offset:0
    ds_write_b128 v1, v[196:199] offset:1024
    ds_write_b128 v1, v[200:203] offset:2048
    ds_write_b128 v1, v[204:207] offset:3072
    s_waitcnt lgkmcnt(0)
    ds_read_b128 v[96:99], v20 offset:3584
    ds_read2_b32 v[64:65], v16 offset0:0 offset1:1
    ds_read2_b32 v[66:67], v16 offset0:2 offset1:3
    ds_read_b128 v[100:103], v20 offset:3072
    ds_read2_b32 v[68:69], v16 offset0:128 offset1:129
    ds_read2_b32 v[70:71], v16 offset0:130 offset1:131
    ds_read_b128 v[104:107], v20 offset:2560
    ds_read2_b32 v[72:73], v17 offset0:0 offset1:1
    ds_read2_b32 v[74:75], v17 offset0:2 offset1:3
    ds_read_b128 v[108:111], v20 offset:2048
    ds_read2_b32 v[76:77], v17 offset0:128 offset1:129
    ds_read2_b32 v[78:79], v17 offset0:130 offset1:131
    ds_read_b128 v[112:115], v20 offset:1536
    ds_read2_b32 v[80:81], v18 offset0:0 offset1:1
    ds_read2_b32 v[82:83], v18 offset0:2 offset1:3
    ds_read_b128 v[116:119], v20 offset:1024
    ds_read2_b32 v[84:85], v18 offset0:128 offset1:129
    ds_read2_b32 v[86:87], v18 offset0:130 offset1:131
    ds_read_b128 v[120:123], v20 offset:512
    ds_read2_b32 v[88:89], v19 offset0:0 offset1:1
    ds_read2_b32 v[90:91], v19 offset0:2 offset1:3
    ds_read_b128 v[124:127], v20 offset:0
    ds_read2_b32 v[92:93], v19 offset0:128 offset1:129
    ds_read2_b32 v[94:95], v19 offset0:130 offset1:131
    s_waitcnt lgkmcnt(0)
    v_mfma_f32_16x16x32_bf16 v[32:35], v[24:27], v[96:99], 0
    v_mfma_f32_16x16x32_bf16 v[36:39], v[24:27], v[100:103], 0
    v_mfma_f32_16x16x32_bf16 v[40:43], v[24:27], v[104:107], 0
    v_mfma_f32_16x16x32_bf16 v[44:47], v[24:27], v[108:111], 0
    v_mfma_f32_16x16x32_bf16 v[48:51], v[24:27], v[112:115], 0
    v_mfma_f32_16x16x32_bf16 v[52:55], v[24:27], v[116:119], 0
    v_mfma_f32_16x16x32_bf16 v[56:59], v[24:27], v[120:123], 0
    v_mfma_f32_16x16x32_bf16 v[60:63], v[24:27], v[124:127], 0
    s_mov_b32 s51, 0
K1L_conv:
    v_mfma_f32_16x16x32_bf16 v[32:35], v[64:67], v[96:99], v[32:35]
    ds_read_b128 v[160:163], v20 offset:3648
    v_mfma_f32_16x16x32_bf16 v[36:39], v[64:67], v[100:103], v[36:39]
    ds_read2_b32 v[128:129], v16 offset0:16 offset1:17
    v_mfma_f32_16x16x32_bf16 v[40:43], v[64:67], v[104:107], v[40:43]
    ds_read2_b32 v[130:131], v16 offset0:18 offset1:19
    v_mfma_f32_16x16x32_bf16 v[44:47], v[64:67], v[108:111], v[44:47]
    ds_read_b128 v[164:167], v20 offset:3136
    v_mfma_f32_16x16x32_bf16 v[48:51], v[64:67], v[112:115], v[48:51]
    ds_read2_b32 v[132:133], v16 offset0:144 offset1:145
    v_mfma_f32_16x16x32_bf16 v[52:55], v[64:67], v[116:119], v[52:55]
    ds_read2_b32 v[134:135], v16 offset0:146 offset1:147
    v_mfma_f32_16x16x32_bf16 v[56:59], v[64:67], v[120:123], v[56:59]
    ds_read_b128 v[168:171], v20 offset:2624
    v_mfma_f32_16x16x32_bf16 v[60:63], v[64:67], v[124:127], v[60:63]
    ds_read2_b32 v[136:137], v17 offset0:16 offset1:17
    v_mfma_f32_16x16x32_bf16 v[36:39], v[68:71], v[96:99], v[36:39]
    ds_read2_b32 v[138:139], v17 offset0:18 offset1:19
    v_mfma_f32_16x16x32_bf16 v[40:43], v[68:71], v[100:103], v[40:43]
    ds_read_b128 v[172:175], v20 offset:2112
    v_mfma_f32_16x16x32_bf16 v[44:47], v[68:71], v[104:107], v[44:47]
    ds_read2_b32 v[140:141], v17 offset0:144 offset1:145
    v_mfma_f32_16x16x32_bf16 v[48:51], v[68:71], v[108:111], v[48:51]
    ds_read2_b32 v[142:143], v17 offset0:146 offset1:147
    v_mfma_f32_16x16x32_bf16 v[52:55], v[68:71], v[112:115], v[52:55]
    ds_read_b128 v[176:179], v20 offset:1600
    v_mfma_f32_16x16x32_bf16 v[56:59], v[68:71], v[116:119], v[56:59]
    ds_read2_b32 v[144:145], v18 offset0:16 offset1:17
    v_mfma_f32_16x16x32_bf16 v[60:63], v[68:71], v[120:123], v[60:63]
    ds_read2_b32 v[146:147], v18 offset0:18 offset1:19
    v_mfma_f32_16x16x32_bf16 v[40:43], v[72:75], v[96:99], v[40:43]
    ds_read_b128 v[180:183], v20 offset:1088
    v_mfma_f32_16x16x32_bf16 v[44:47], v[72:75], v[100:103], v[44:47]
    ds_read2_b32 v[148:149], v18 offset0:144 offset1:145
    v_mfma_f32_16x16x32_bf16 v[48:51], v[72:75], v[104:107], v[48:51]
    ds_read2_b32 v[150:151], v18 offset0:146 offset1:147
    v_mfma_f32_16x16x32_bf16 v[52:55], v[72:75], v[108:111], v[52:55]
    ds_read_b128 v[184:187], v20 offset:576
    v_mfma_f32_16x16x32_bf16 v[56:59], v[72:75], v[112:115], v[56:59]
    ds_read2_b32 v[152:153], v19 offset0:16 offset1:17
    v_mfma_f32_16x16x32_bf16 v[60:63], v[72:75], v[116:119], v[60:63]
    ds_read2_b32 v[154:155], v19 offset0:18 offset1:19
    v_mfma_f32_16x16x32_bf16 v[44:47], v[76:79], v[96:99], v[44:47]
    ds_read_b128 v[188:191], v20 offset:64
    v_mfma_f32_16x16x32_bf16 v[48:51], v[76:79], v[100:103], v[48:51]
    ds_read2_b32 v[156:157], v19 offset0:144 offset1:145
    v_mfma_f32_16x16x32_bf16 v[52:55], v[76:79], v[104:107], v[52:55]
    ds_read2_b32 v[158:159], v19 offset0:146 offset1:147
    v_mfma_f32_16x16x32_bf16 v[56:59], v[76:79], v[108:111], v[56:59]
    v_mfma_f32_16x16x32_bf16 v[60:63], v[76:79], v[112:115], v[60:63]
    v_mfma_f32_16x16x32_bf16 v[48:51], v[80:83], v[96:99], v[48:51]
    v_mfma_f32_16x16x32_bf16 v[52:55], v[80:83], v[100:103], v[52:55]
    v_mfma_f32_16x16x32_bf16 v[56:59], v[80:83], v[104:107], v[56:59]
    v_mfma_f32_16x16x32_bf16 v[60:63], v[80:83], v[108:111], v[60:63]
    v_mfma_f32_16x16x32_bf16 v[52:55], v[84:87], v[96:99], v[52:55]
    v_mfma_f32_16x16x32_bf16 v[56:59], v[84:87], v[100:103], v[56:59]
    v_mfma_f32_16x16x32_bf16 v[60:63], v[84:87], v[104:107], v[60:63]
    v_mfma_f32_16x16x32_bf16 v[56:59], v[88:91], v[96:99], v[56:59]
    v_mfma_f32_16x16x32_bf16 v[60:63], v[88:91], v[100:103], v[60:63]
    v_mfma_f32_16x16x32_bf16 v[60:63], v[92:95], v[96:99], v[60:63]
    s_waitcnt lgkmcnt(0)
    v_mfma_f32_16x16x32_bf16 v[32:35], v[128:131], v[160:163], v[32:35]
    ds_read_b128 v[96:99], v20 offset:3712
    v_mfma_f32_16x16x32_bf16 v[36:39], v[128:131], v[164:167], v[36:39]
    ds_read2_b32 v[64:65], v16 offset0:32 offset1:33
    v_mfma_f32_16x16x32_bf16 v[40:43], v[128:131], v[168:171], v[40:43]
    ds_read2_b32 v[66:67], v16 offset0:34 offset1:35
    v_mfma_f32_16x16x32_bf16 v[44:47], v[128:131], v[172:175], v[44:47]
    ds_read_b128 v[100:103], v20 offset:3200
    v_mfma_f32_16x16x32_bf16 v[48:51], v[128:131], v[176:179], v[48:51]
    ds_read2_b32 v[68:69], v16 offset0:160 offset1:161
    v_mfma_f32_16x16x32_bf16 v[52:55], v[128:131], v[180:183], v[52:55]
    ds_read2_b32 v[70:71], v16 offset0:162 offset1:163
    v_mfma_f32_16x16x32_bf16 v[56:59], v[128:131], v[184:187], v[56:59]
    ds_read_b128 v[104:107], v20 offset:2688
    v_mfma_f32_16x16x32_bf16 v[60:63], v[128:131], v[188:191], v[60:63]
    ds_read2_b32 v[72:73], v17 offset0:32 offset1:33
    v_mfma_f32_16x16x32_bf16 v[36:39], v[132:135], v[160:163], v[36:39]
    ds_read2_b32 v[74:75], v17 offset0:34 offset1:35
    v_mfma_f32_16x16x32_bf16 v[40:43], v[132:135], v[164:167], v[40:43]
    ds_read_b128 v[108:111], v20 offset:2176
    v_mfma_f32_16x16x32_bf16 v[44:47], v[132:135], v[168:171], v[44:47]
    ds_read2_b32 v[76:77], v17 offset0:160 offset1:161
    v_mfma_f32_16x16x32_bf16 v[48:51], v[132:135], v[172:175], v[48:51]
    ds_read2_b32 v[78:79], v17 offset0:162 offset1:163
    v_mfma_f32_16x16x32_bf16 v[52:55], v[132:135], v[176:179], v[52:55]
    ds_read_b128 v[112:115], v20 offset:1664
    v_mfma_f32_16x16x32_bf16 v[56:59], v[132:135], v[180:183], v[56:59]
    ds_read2_b32 v[80:81], v18 offset0:32 offset1:33
    v_mfma_f32_16x16x32_bf16 v[60:63], v[132:135], v[184:187], v[60:63]
    ds_read2_b32 v[82:83], v18 offset0:34 offset1:35
    v_mfma_f32_16x16x32_bf16 v[40:43], v[136:139], v[160:163], v[40:43]
    ds_read_b128 v[116:119], v20 offset:1152
    v_mfma_f32_16x16x32_bf16 v[44:47], v[136:139], v[164:167], v[44:47]
    ds_read2_b32 v[84:85], v18 offset0:160 offset1:161
    v_mfma_f32_16x16x32_bf16 v[48:51], v[136:139], v[168:171], v[48:51]
    ds_read2_b32 v[86:87], v18 offset0:162 offset1:163
    v_mfma_f32_16x16x32_bf16 v[52:55], v[136:139], v[172:175], v[52:55]
    ds_read_b128 v[120:123], v20 offset:640
    v_mfma_f32_16x16x32_bf16 v[56:59], v[136:139], v[176:179], v[56:59]
    ds_read2_b32 v[88:89], v19 offset0:32 offset1:33
    v_mfma_f32_16x16x32_bf16 v[60:63], v[136:139], v[180:183], v[60:63]
    ds_read2_b32 v[90:91], v19 offset0:34 offset1:35
    v_mfma_f32_16x16x32_bf16 v[44:47], v[140:143], v[160:163], v[44:47]
    ds_read_b128 v[124:127], v20 offset:128
    v_mfma_f32_16x16x32_bf16 v[48:51], v[140:143], v[164:167], v[48:51]
    ds_read2_b32 v[92:93], v19 offset0:160 offset1:161
    v_mfma_f32_16x16x32_bf16 v[52:55], v[140:143], v[168:171], v[52:55]
    ds_read2_b32 v[94:95], v19 offset0:162 offset1:163
    v_mfma_f32_16x16x32_bf16 v[56:59], v[140:143], v[172:175], v[56:59]
    v_add_u32 v16, 128, v16
    v_mfma_f32_16x16x32_bf16 v[60:63], v[140:143], v[176:179], v[60:63]
    v_add_u32 v17, 128, v17
    v_mfma_f32_16x16x32_bf16 v[48:51], v[144:147], v[160:163], v[48:51]
    v_add_u32 v18, 128, v18
    v_mfma_f32_16x16x32_bf16 v[52:55], v[144:147], v[164:167], v[52:55]
    v_add_u32 v19, 128, v19
    v_mfma_f32_16x16x32_bf16 v[56:59], v[144:147], v[168:171], v[56:59]
    v_add_u32 v20, 128, v20
    v_mfma_f32_16x16x32_bf16 v[60:63], v[144:147], v[172:175], v[60:63]
    v_mfma_f32_16x16x32_bf16 v[52:55], v[148:151], v[160:163], v[52:55]
    v_mfma_f32_16x16x32_bf16 v[56:59], v[148:151], v[164:167], v[56:59]
    v_mfma_f32_16x16x32_bf16 v[60:63], v[148:151], v[168:171], v[60:63]
    v_mfma_f32_16x16x32_bf16 v[56:59], v[152:155], v[160:163], v[56:59]
    v_mfma_f32_16x16x32_bf16 v[60:63], v[152:155], v[164:167], v[60:63]
    v_mfma_f32_16x16x32_bf16 v[60:63], v[156:159], v[160:163], v[60:63]
    s_add_u32 s51, s51, 1
    s_waitcnt lgkmcnt(0)
    s_cmp_lt_u32 s51, 4
    s_cbranch_scc1 K1L_conv
    s_nop 4
    v_cvt_pk_bf16_f32 v64, v32, v33
    v_cvt_pk_bf16_f32 v65, v34, v35
    v_cvt_pk_bf16_f32 v66, v36, v37
    v_cvt_pk_bf16_f32 v67, v38, v39
    v_cvt_pk_bf16_f32 v68, v40, v41
    v_cvt_pk_bf16_f32 v69, v42, v43
    v_cvt_pk_bf16_f32 v70, v44, v45
    v_cvt_pk_bf16_f32 v71, v46, v47
    v_cvt_pk_bf16_f32 v72, v48, v49
    v_cvt_pk_bf16_f32 v73, v50, v51
    v_cvt_pk_bf16_f32 v74, v52, v53
    v_cvt_pk_bf16_f32 v75, v54, v55
    v_cvt_pk_bf16_f32 v76, v56, v57
    v_cvt_pk_bf16_f32 v77, v58, v59
    v_cvt_pk_bf16_f32 v78, v60, v61
    v_cvt_pk_bf16_f32 v79, v62, v63
    s_nop 1
    v_permlane16_swap_b32 v64, v66
    v_permlane16_swap_b32 v65, v67
    v_permlane16_swap_b32 v68, v70
    v_permlane16_swap_b32 v69, v71
    v_permlane16_swap_b32 v72, v74
    v_permlane16_swap_b32 v73, v75
    v_permlane16_swap_b32 v76, v78
    v_permlane16_swap_b32 v77, v79
    buffer_store_dwordx4 v[64:67], v21, s[80:83], 0 offen offset:0
    buffer_store_dwordx4 v[68:71], v21, s[80:83], 0 offen offset:1024
    buffer_store_dwordx4 v[72:75], v21, s[80:83], 0 offen offset:2048
    buffer_store_dwordx4 v[76:79], v21, s[80:83], 0 offen offset:3072
    s_endpgm
K1_compute:
    v_and_b32 v12, 15, v2
    v_lshrrev_b32 v13, 4, v2
    v_lshrrev_b32 v3, 1, v12
    v_xor_b32 v3, v3, v13
    v_lshlrev_b32 v3, 4, v3
    v_lshl_add_u32 v4, v12, 7, v3
    v_xor_b32 v6, 64, v4
    v_add_u32 v5, 0x10000, v4
    v_add_u32 v7, 0x10000, v6
    s_lshl_b32 s6, s5, 12
    s_add_u32 s6, s6, 16384
    v_add_u32 v8, s6, v4
    v_add_u32 v9, s6, v5
    v_add_u32 v10, s6, v6
    v_add_u32 v11, s6, v7
    s_lshl_b32 s6, s4, 2
    s_add_u32 s6, s6, s5
    s_lshl_b32 s6, s6, 4
    v_add_u32 v14, s6, v12
    v_lshlrev_b32 v44, 1, v14
    s_waitcnt lgkmcnt(0)
    s_mov_b32 s20, s58
    s_mov_b32 s21, s59
    s_mov_b32 s22, 2048
    s_mov_b32 s23, 0x00020000
    s_mov_b32 s24, s46
    s_mov_b32 s25, s47
    s_mov_b32 s26, 2048
    s_mov_b32 s27, 0x00020000
    s_mov_b32 s28, s48
    s_mov_b32 s29, s49
    s_mov_b32 s30, 2048
    s_mov_b32 s31, 0x00020000
    buffer_load_ushort v45, v44, s[20:23], 0 offen
    buffer_load_ushort v46, v44, s[24:27], 0 offen
    buffer_load_ushort v47, v44, s[28:31], 0 offen
    s_mov_b32 s16, s64
    s_mov_b32 s17, s65
    s_mov_b32 s18, 256
    s_mov_b32 s19, 0x00020000
    s_or_b32 s6, s2, s5
    s_cmp_eq_u32 s6, 0
    s_cbranch_scc0 K1C_nonce_w
    s_memrealtime s[6:7]
    v_mov_b32 v1, 0
    s_waitcnt lgkmcnt(0)
    s_or_b32 s6, s6, 1
    v_mov_b32 v48, s6
    v_mov_b32 v49, s7
    s_mov_b64 exec, 1
    buffer_store_dwordx2 v[48:49], v1, s[16:19], 0 offen sc1
    s_mov_b64 exec, -1
K1C_nonce_w:
    s_add_u32 s8, s66, 8388608
    s_addc_u32 s9, s67, 0
    s_mov_b32 s10, 8388608
    s_mov_b32 s11, 0x00020000
    s_add_u32 s12, s66, 16777216
    s_addc_u32 s13, s67, 0
    s_mov_b32 s14, 262144
    s_mov_b32 s15, 0x00020000
    s_mov_b32 s68, s66
    s_mov_b32 s69, s67
    s_mov_b32 s70, 4194304
    s_mov_b32 s71, 0x00020000
    s_add_u32 s72, s66, 17825792
    s_addc_u32 s73, s67, 0
    s_mov_b32 s74, 2048
    s_mov_b32 s75, 0x00020000
    s_lshr_b32 s7, s2, 3
    s_and_b32 s32, s7, 15
    s_lshr_b32 s7, s7, 4
    s_and_b32 s33, s2, 7
    s_lshl_b32 s33, s33, 1
    s_add_u32 s33, s33, s7
    s_lshl_b32 s34, s33, 4
    s_add_u32 s34, s34, s32
    s_lshl_b32 s34, s34, 3
    s_mov_b32 s36, 16384
    s_mov_b32 s37, 32768
    s_mov_b32 s38, 49152
    s_lshl_b32 s6, s5, 2
    v_xor_b32 v1, s6, v12
    v_lshlrev_b32 v1, 4, v1
    v_lshl_add_u32 v1, v13, 8, v1
    s_lshl_b32 s6, s5, 12
    s_add_u32 s6, s6, 147456
    v_add_u32 v37, s6, v1
    v_xor_b32 v38, 16, v37
    v_xor_b32 v39, 32, v37
    v_xor_b32 v40, 48, v37
    s_lshl_b32 s6, s33, 2
    s_add_u32 s6, s6, s5
    s_lshl_b32 s6, s6, 16
    s_lshl_b32 s7, s32, 8
    s_sub_u32 s7, 3840, s7
    s_add_u32 s6, s6, s7
    v_lshlrev_b32 v1, 12, v13
    v_lshl_add_u32 v1, v12, 4, v1
    v_add_u32 v41, s6, v1
    s_lshl_b32 s6, s3, 14
    v_lshlrev_b32 v1, 4, v14
    v_add_u32 v34, s6, v1
    v_lshlrev_b32 v1, 14, v13
    v_sub_u32 v1, v34, v1
    v_subrev_u32 v30, 0x4000, v1
    v_subrev_u32 v31, 0x14000, v1
    v_subrev_u32 v32, 0x24000, v1
    v_subrev_u32 v33, 0x34000, v1
    v_cmp_gt_i32 s[40:41], 0, v30
    v_cmp_gt_i32 s[42:43], 0, v31
    v_cmp_gt_i32 s[44:45], 0, v32
    v_cmp_gt_i32 s[46:47], 0, v33
    s_lshl_b32 s6, s3, 4
    s_add_u32 s6, s6, s4
    s_lshl_b32 s6, s6, 15
    s_lshl_b32 s7, s5, 8
    s_add_u32 s6, s6, s7
    v_lshlrev_b32 v1, 12, v13
    v_lshl_add_u32 v1, v12, 4, v1
    v_add_u32 v35, s6, v1
    v_xor_b32 v36, 64, v35
    v_cmp_eq_u32 s[48:49], 1, v13
    v_cmp_eq_u32 s[50:51], 2, v13
    v_cmp_eq_u32 s[52:53], 3, v13
    v_mov_b32 v64, 0
    v_mov_b32 v65, 0
    v_mov_b32 v66, 0
    v_mov_b32 v67, 0
    v_mov_b32 v68, 0
    v_mov_b32 v69, 0
    v_mov_b32 v70, 0
    v_mov_b32 v71, 0
    v_mov_b32 v72, 0
    v_mov_b32 v73, 0
    v_mov_b32 v74, 0
    v_mov_b32 v75, 0
    v_mov_b32 v76, 0
    v_mov_b32 v77, 0
    v_mov_b32 v78, 0
    v_mov_b32 v79, 0
    v_mov_b32 v80, 0
    v_mov_b32 v81, 0
    v_mov_b32 v82, 0
    v_mov_b32 v83, 0
    v_mov_b32 v84, 0
    v_mov_b32 v85, 0
    v_mov_b32 v86, 0
    v_mov_b32 v87, 0
    v_mov_b32 v88, 0
    v_mov_b32 v89, 0
    v_mov_b32 v90, 0
    v_mov_b32 v91, 0
    v_mov_b32 v92, 0
    v_mov_b32 v93, 0
    v_mov_b32 v94, 0
    v_mov_b32 v95, 0
    v_mov_b32 v96, 0
    v_mov_b32 v97, 0
    v_mov_b32 v98, 0
    v_mov_b32 v99, 0
    v_mov_b32 v100, 0
    v_mov_b32 v101, 0
    v_mov_b32 v102, 0
    v_mov_b32 v103, 0
    v_mov_b32 v104, 0
    v_mov_b32 v105, 0
    v_mov_b32 v106, 0
    v_mov_b32 v107, 0
    v_mov_b32 v108, 0
    v_mov_b32 v109, 0
    v_mov_b32 v110, 0
    v_mov_b32 v111, 0
    v_mov_b32 v112, 0
    v_mov_b32 v113, 0
    v_mov_b32 v114, 0
    v_mov_b32 v115, 0
    v_mov_b32 v116, 0
    v_mov_b32 v117, 0
    v_mov_b32 v118, 0
    v_mov_b32 v119, 0
    v_mov_b32 v120, 0
    v_mov_b32 v121, 0
    v_mov_b32 v122, 0
    v_mov_b32 v123, 0
    v_mov_b32 v124, 0
    v_mov_b32 v125, 0
    v_mov_b32 v126, 0
    v_mov_b32 v127, 0
    s_waitcnt vmcnt(0)
    v_lshlrev_b32 v45, 16, v45
    v_lshlrev_b32 v46, 16, v46
    v_lshlrev_b32 v47, 16, v47
    v_mul_f32 v45, 0x3fb8aa3b, v45
    v_exp_f32 v45, v45
    s_nop 0
    v_cvt_pk_bf16_f32 v45, v45, v45
    v_lshlrev_b32 v45, 16, v45
    v_mul_f32 v48, v45, v46
    v_mul_f32 v49, v45, v47
    v_mul_f32 v48, 0x3fb8aa3b, v48
    v_exp_f32 v48, v48
    v_mul_f32 v49, 0.15915494, v49
    v_cos_f32 v50, v49
    v_sin_f32 v51, v49
    s_nop 0
    v_mul_f32 v16, v48, v50
    v_mul_f32 v17, v48, v51
    v_add_f32 v48, -1.0, v16
    v_mul_f32 v49, v46, v46
    v_fmac_f32 v49, v47, v47
    v_rcp_f32 v49, v49
    v_mul_f32 v50, v48, v46
    v_fmac_f32 v50, v17, v47
    v_mul_f32 v51, v17, v46
    v_fma_f32 v51, -v48, v47, v51
    v_add_f32 v49, v49, v49
    v_mul_f32 v20, v50, v49
    v_mul_f32 v21, v51, v49
    v_xor_b32 v18, 0x80000000, v17
    v_xor_b32 v42, 0x80000000, v20
    v_xor_b32 v43, 0x80000000, v21
    v_mul_f32 v44, v16, v16
    v_mul_f32 v45, v16, v17
    v_fma_f32 v44, -v17, v17, v44
    v_fmac_f32 v45, v17, v16
    v_mul_f32 v46, v44, v44
    v_mul_f32 v47, v44, v45
    v_fma_f32 v46, -v45, v45, v46
    v_fmac_f32 v47, v45, v44
    v_mul_f32 v44, v46, v46
    v_mul_f32 v45, v46, v47
    v_fma_f32 v44, -v47, v47, v44
    v_fmac_f32 v45, v47, v46
    v_mul_f32 v46, v44, v44
    v_mul_f32 v47, v44, v45
    v_fma_f32 v46, -v45, v45, v46
    v_fmac_f32 v47, v45, v44
    v_mul_f32 v22, v46, v46
    v_mul_f32 v23, v46, v47
    v_fma_f32 v22, -v47, v47, v22
    v_fmac_f32 v23, v47, v46
    v_mul_f32 v44, v22, v22
    v_mul_f32 v45, v22, v23
    v_fma_f32 v44, -v23, v23, v44
    v_fmac_f32 v45, v23, v22
    v_mul_f32 v46, v44, v22
    v_mul_f32 v47, v44, v23
    v_fma_f32 v46, -v45, v23, v46
    v_fmac_f32 v47, v45, v22
    v_mov_b32 v48, 1.0
    v_mov_b32 v49, 0
    v_cndmask_b32 v48, v48, v22, s[48:49]
    v_cndmask_b32 v49, v49, v23, s[48:49]
    v_cndmask_b32 v48, v48, v44, s[50:51]
    v_cndmask_b32 v49, v49, v45, s[50:51]
    v_cndmask_b32 v48, v48, v46, s[52:53]
    v_cndmask_b32 v49, v49, v47, s[52:53]
    v_mul_f32 v24, v20, v48
    v_mul_f32 v25, v20, v49
    v_fma_f32 v24, -v21, v49, v24
    v_fmac_f32 v25, v21, v48
    v_mul_f32 v46, v44, v44
    v_mul_f32 v47, v44, v45
    v_fma_f32 v46, -v45, v45, v46
    v_fmac_f32 v47, v45, v44
    v_mul_f32 v44, v46, v46
    v_mul_f32 v45, v46, v47
    v_fma_f32 v44, -v47, v47, v44
    v_fmac_f32 v45, v47, v46
    v_mul_f32 v48, v44, v46
    v_mul_f32 v49, v44, v47
    v_fma_f32 v48, -v45, v47, v48
    v_fmac_f32 v49, v45, v46
    v_mul_f32 v28, v44, v44
    v_mul_f32 v29, v44, v45
    v_fma_f32 v28, -v45, v45, v28
    v_fmac_f32 v29, v45, v44
    v_mov_b32 v26, 1.0
    v_mov_b32 v27, 0
    v_cndmask_b32 v26, v26, v46, s[48:49]
    v_cndmask_b32 v27, v27, v47, s[48:49]
    v_cndmask_b32 v26, v26, v44, s[50:51]
    v_cndmask_b32 v27, v27, v45, s[50:51]
    v_cndmask_b32 v26, v26, v48, s[52:53]
    v_cndmask_b32 v27, v27, v49, s[52:53]
    s_barrier
    ds_read_b128 v[160:163], v9 offset:32768
    ds_read_b128 v[164:167], v9 offset:34816
    ds_read_b128 v[128:131], v5 offset:32768
    ds_read_b128 v[132:135], v5 offset:34816
    ds_read_b128 v[136:139], v5 offset:36864
    ds_read_b128 v[140:143], v5 offset:38912
    ds_read_b128 v[144:147], v5 offset:40960
    ds_read_b128 v[148:151], v5 offset:43008
    ds_read_b128 v[152:155], v5 offset:45056
    ds_read_b128 v[156:159], v5 offset:47104
    s_cmp_eq_u32 s5, 0
    s_cbranch_scc0 K1C_nonce_l
    v_mov_b32 v1, 0
    s_mov_b64 exec, 1
    buffer_load_dwordx2 v[224:225], v1, s[16:19], 0 offen sc1
    s_mov_b64 exec, -1
K1C_nonce_l:
    s_mov_b32 s30, 0
    s_mov_b32 s31, s5
K1C_loop:
    s_waitcnt lgkmcnt(0)
    s_cmp_eq_u32 s31, 8
    s_cbranch_scc0 K1C_s0
    s_mov_b32 s39, 0
    s_mov_b64 exec, 1
    v_mov_b32 v1, 0
K1C_nspin:
    s_waitcnt vmcnt(0)
    v_readfirstlane_b32 s6, v224
    s_add_u32 s39, s39, 1
    s_cmp_lg_u32 s6, 0
    s_cbranch_scc1 K1C_nok
    s_cmp_gt_u32 s39, 4096
    s_cbranch_scc1 K1C_nok
    buffer_load_dwordx2 v[224:225], v1, s[16:19], 0 offen sc1
    s_branch K1C_nspin
K1C_nok:
    v_mov_b32 v1, 133376
    ds_write_b64 v1, v[224:225]
    s_mov_b64 exec, -1
    s_nop 3
K1C_s0:
    v_mfma_f32_16x16x32_bf16 v[64:67], v[128:131], v[160:163], v[64:67]
    ds_read_b128 v[200:203], v11 offset:32768
    v_mfma_f32_16x16x32_bf16 v[68:71], v[128:131], v[164:167], v[68:71]
    ds_read_b128 v[204:207], v11 offset:34816
    v_mfma_f32_16x16x32_bf16 v[76:79], v[132:135], v[164:167], v[76:79]
    ds_read_b128 v[168:171], v7 offset:32768
    v_mfma_f32_16x16x32_bf16 v[72:75], v[132:135], v[160:163], v[72:75]
    ds_read_b128 v[172:175], v7 offset:34816
    v_mfma_f32_16x16x32_bf16 v[80:83], v[136:139], v[160:163], v[80:83]
    ds_read_b128 v[176:179], v7 offset:36864
    v_mfma_f32_16x16x32_bf16 v[84:87], v[136:139], v[164:167], v[84:87]
    ds_read_b128 v[180:183], v7 offset:38912
    v_mfma_f32_16x16x32_bf16 v[92:95], v[140:143], v[164:167], v[92:95]
    ds_read_b128 v[184:187], v7 offset:40960
    v_mfma_f32_16x16x32_bf16 v[88:91], v[140:143], v[160:163], v[88:91]
    ds_read_b128 v[188:191], v7 offset:43008
    v_mfma_f32_16x16x32_bf16 v[96:99], v[144:147], v[160:163], v[96:99]
    ds_read_b128 v[192:195], v7 offset:45056
    v_mfma_f32_16x16x32_bf16 v[100:103], v[144:147], v[164:167], v[100:103]
    ds_read_b128 v[196:199], v7 offset:47104
    v_mfma_f32_16x16x32_bf16 v[108:111], v[148:151], v[164:167], v[108:111]
    v_mfma_f32_16x16x32_bf16 v[104:107], v[148:151], v[160:163], v[104:107]
    v_mfma_f32_16x16x32_bf16 v[112:115], v[152:155], v[160:163], v[112:115]
    v_mfma_f32_16x16x32_bf16 v[116:119], v[152:155], v[164:167], v[116:119]
    v_mfma_f32_16x16x32_bf16 v[124:127], v[156:159], v[164:167], v[124:127]
    v_mfma_f32_16x16x32_bf16 v[120:123], v[156:159], v[160:163], v[120:123]
    s_waitcnt lgkmcnt(0)
    s_barrier
    s_cmp_eq_u32 s30, 2
    s_cbranch_scc0 K1C_s1
    ds_read_b128 v[208:211], v37 offset:0
    ds_read_b128 v[212:215], v38 offset:1024
    ds_read_b128 v[216:219], v39 offset:2048
    ds_read_b128 v[220:223], v40 offset:3072
K1C_s1:
    v_mfma_f32_16x16x32_bf16 v[64:67], v[168:171], v[200:203], v[64:67]
    ds_read_b128 v[160:163], v8 offset:0
    v_mfma_f32_16x16x32_bf16 v[68:71], v[168:171], v[204:207], v[68:71]
    ds_read_b128 v[164:167], v8 offset:2048
    v_mfma_f32_16x16x32_bf16 v[76:79], v[172:175], v[204:207], v[76:79]
    ds_read_b128 v[128:131], v4 offset:0
    v_mfma_f32_16x16x32_bf16 v[72:75], v[172:175], v[200:203], v[72:75]
    ds_read_b128 v[132:135], v4 offset:2048
    v_mfma_f32_16x16x32_bf16 v[80:83], v[176:179], v[200:203], v[80:83]
    ds_read_b128 v[136:139], v4 offset:4096
    v_mfma_f32_16x16x32_bf16 v[84:87], v[176:179], v[204:207], v[84:87]
    ds_read_b128 v[140:143], v4 offset:6144
    v_mfma_f32_16x16x32_bf16 v[92:95], v[180:183], v[204:207], v[92:95]
    ds_read_b128 v[144:147], v4 offset:8192
    v_mfma_f32_16x16x32_bf16 v[88:91], v[180:183], v[200:203], v[88:91]
    ds_read_b128 v[148:151], v4 offset:10240
    v_mfma_f32_16x16x32_bf16 v[96:99], v[184:187], v[200:203], v[96:99]
    ds_read_b128 v[152:155], v4 offset:12288
    v_mfma_f32_16x16x32_bf16 v[100:103], v[184:187], v[204:207], v[100:103]
    ds_read_b128 v[156:159], v4 offset:14336
    v_mfma_f32_16x16x32_bf16 v[108:111], v[188:191], v[204:207], v[108:111]
    v_mfma_f32_16x16x32_bf16 v[104:107], v[188:191], v[200:203], v[104:107]
    v_mfma_f32_16x16x32_bf16 v[112:115], v[192:195], v[200:203], v[112:115]
    v_mfma_f32_16x16x32_bf16 v[116:119], v[192:195], v[204:207], v[116:119]
    v_mfma_f32_16x16x32_bf16 v[124:127], v[196:199], v[204:207], v[124:127]
    v_mfma_f32_16x16x32_bf16 v[120:123], v[196:199], v[200:203], v[120:123]
    s_waitcnt lgkmcnt(0)
    s_cmp_eq_u32 s30, 2
    s_cbranch_scc0 K1C_s2
    buffer_store_dwordx4 v[208:211], v41, s[68:71], 0 offen sc1
    buffer_store_dwordx4 v[212:215], v41, s[68:71], s36 offen sc1
    buffer_store_dwordx4 v[216:219], v41, s[68:71], s37 offen sc1
    buffer_store_dwordx4 v[220:223], v41, s[68:71], s38 offen sc1
K1C_s2:
    v_mfma_f32_16x16x32_bf16 v[64:67], v[128:131], v[160:163], v[64:67]
    ds_read_b128 v[200:203], v10 offset:0
    v_mfma_f32_16x16x32_bf16 v[68:71], v[128:131], v[164:167], v[68:71]
    ds_read_b128 v[204:207], v10 offset:2048
    v_mfma_f32_16x16x32_bf16 v[76:79], v[132:135], v[164:167], v[76:79]
    ds_read_b128 v[168:171], v6 offset:0
    v_mfma_f32_16x16x32_bf16 v[72:75], v[132:135], v[160:163], v[72:75]
    ds_read_b128 v[172:175], v6 offset:2048
    v_mfma_f32_16x16x32_bf16 v[80:83], v[136:139], v[160:163], v[80:83]
    ds_read_b128 v[176:179], v6 offset:4096
    v_mfma_f32_16x16x32_bf16 v[84:87], v[136:139], v[164:167], v[84:87]
    ds_read_b128 v[180:183], v6 offset:6144
    v_mfma_f32_16x16x32_bf16 v[92:95], v[140:143], v[164:167], v[92:95]
    ds_read_b128 v[184:187], v6 offset:8192
    v_mfma_f32_16x16x32_bf16 v[88:91], v[140:143], v[160:163], v[88:91]
    ds_read_b128 v[188:191], v6 offset:10240
    v_mfma_f32_16x16x32_bf16 v[96:99], v[144:147], v[160:163], v[96:99]
    ds_read_b128 v[192:195], v6 offset:12288
    v_mfma_f32_16x16x32_bf16 v[100:103], v[144:147], v[164:167], v[100:103]
    ds_read_b128 v[196:199], v6 offset:14336
    v_mfma_f32_16x16x32_bf16 v[108:111], v[148:151], v[164:167], v[108:111]
    v_mfma_f32_16x16x32_bf16 v[104:107], v[148:151], v[160:163], v[104:107]
    v_mfma_f32_16x16x32_bf16 v[112:115], v[152:155], v[160:163], v[112:115]
    v_mfma_f32_16x16x32_bf16 v[116:119], v[152:155], v[164:167], v[116:119]
    v_mfma_f32_16x16x32_bf16 v[124:127], v[156:159], v[164:167], v[124:127]
    v_mfma_f32_16x16x32_bf16 v[120:123], v[156:159], v[160:163], v[120:123]
    s_waitcnt lgkmcnt(0)
    s_barrier
    v_mfma_f32_16x16x32_bf16 v[64:67], v[168:171], v[200:203], v[64:67]
    ds_read_b128 v[160:163], v8 offset:32768
    v_mfma_f32_16x16x32_bf16 v[68:71], v[168:171], v[204:207], v[68:71]
    ds_read_b128 v[164:167], v8 offset:34816
    v_mfma_f32_16x16x32_bf16 v[76:79], v[172:175], v[204:207], v[76:79]
    ds_read_b128 v[128:131], v4 offset:32768
    v_mfma_f32_16x16x32_bf16 v[72:75], v[172:175], v[200:203], v[72:75]
    ds_read_b128 v[132:135], v4 offset:34816
    v_mfma_f32_16x16x32_bf16 v[80:83], v[176:179], v[200:203], v[80:83]
    ds_read_b128 v[136:139], v4 offset:36864
    v_mfma_f32_16x16x32_bf16 v[84:87], v[176:179], v[204:207], v[84:87]
    ds_read_b128 v[140:143], v4 offset:38912
    v_mfma_f32_16x16x32_bf16 v[92:95], v[180:183], v[204:207], v[92:95]
    ds_read_b128 v[144:147], v4 offset:40960
    v_mfma_f32_16x16x32_bf16 v[88:91], v[180:183], v[200:203], v[88:91]
    ds_read_b128 v[148:151], v4 offset:43008
    v_mfma_f32_16x16x32_bf16 v[96:99], v[184:187], v[200:203], v[96:99]
    ds_read_b128 v[152:155], v4 offset:45056
    v_mfma_f32_16x16x32_bf16 v[100:103], v[184:187], v[204:207], v[100:103]
    ds_read_b128 v[156:159], v4 offset:47104
    v_mfma_f32_16x16x32_bf16 v[108:111], v[188:191], v[204:207], v[108:111]
    v_mfma_f32_16x16x32_bf16 v[104:107], v[188:191], v[200:203], v[104:107]
    v_mfma_f32_16x16x32_bf16 v[112:115], v[192:195], v[200:203], v[112:115]
    v_mfma_f32_16x16x32_bf16 v[116:119], v[192:195], v[204:207], v[116:119]
    v_mfma_f32_16x16x32_bf16 v[124:127], v[196:199], v[204:207], v[124:127]
    v_mfma_f32_16x16x32_bf16 v[120:123], v[196:199], v[200:203], v[120:123]
    s_waitcnt lgkmcnt(0)
    v_mfma_f32_16x16x32_bf16 v[64:67], v[128:131], v[160:163], v[64:67]
    ds_read_b128 v[200:203], v10 offset:32768
    v_mfma_f32_16x16x32_bf16 v[68:71], v[128:131], v[164:167], v[68:71]
    ds_read_b128 v[204:207], v10 offset:34816
    v_mfma_f32_16x16x32_bf16 v[76:79], v[132:135], v[164:167], v[76:79]
    ds_read_b128 v[168:171], v6 offset:32768
    v_mfma_f32_16x16x32_bf16 v[72:75], v[132:135], v[160:163], v[72:75]
    ds_read_b128 v[172:175], v6 offset:34816
    v_mfma_f32_16x16x32_bf16 v[80:83], v[136:139], v[160:163], v[80:83]
    ds_read_b128 v[176:179], v6 offset:36864
    v_mfma_f32_16x16x32_bf16 v[84:87], v[136:139], v[164:167], v[84:87]
    ds_read_b128 v[180:183], v6 offset:38912
    v_mfma_f32_16x16x32_bf16 v[92:95], v[140:143], v[164:167], v[92:95]
    ds_read_b128 v[184:187], v6 offset:40960
    v_mfma_f32_16x16x32_bf16 v[88:91], v[140:143], v[160:163], v[88:91]
    ds_read_b128 v[188:191], v6 offset:43008
    v_mfma_f32_16x16x32_bf16 v[96:99], v[144:147], v[160:163], v[96:99]
    ds_read_b128 v[192:195], v6 offset:45056
    v_mfma_f32_16x16x32_bf16 v[100:103], v[144:147], v[164:167], v[100:103]
    ds_read_b128 v[196:199], v6 offset:47104
    v_mfma_f32_16x16x32_bf16 v[108:111], v[148:151], v[164:167], v[108:111]
    v_mfma_f32_16x16x32_bf16 v[104:107], v[148:151], v[160:163], v[104:107]
    v_mfma_f32_16x16x32_bf16 v[112:115], v[152:155], v[160:163], v[112:115]
    v_mfma_f32_16x16x32_bf16 v[116:119], v[152:155], v[164:167], v[116:119]
    v_mfma_f32_16x16x32_bf16 v[124:127], v[156:159], v[164:167], v[124:127]
    v_mfma_f32_16x16x32_bf16 v[120:123], v[156:159], v[160:163], v[120:123]
    s_cmp_eq_u32 s30, 2
    s_cbranch_scc0 K1C_s3
    s_waitcnt vmcnt(0)
K1C_s3:
    s_waitcnt lgkmcnt(0)
    s_barrier
    s_cmp_eq_u32 s31, 16
    s_cbranch_scc0 K1C_s4
    v_mov_b32 v1, s34
    s_mov_b64 exec, 1
    buffer_store_dwordx2 v[224:225], v1, s[72:75], 0 offen sc1
    s_mov_b64 exec, -1
    s_nop 3
K1C_s4:
    v_mfma_f32_16x16x32_bf16 v[64:67], v[168:171], v[200:203], v[64:67]
    ds_read_b128 v[160:163], v9 offset:0
    v_mfma_f32_16x16x32_bf16 v[68:71], v[168:171], v[204:207], v[68:71]
    ds_read_b128 v[164:167], v9 offset:2048
    v_mfma_f32_16x16x32_bf16 v[76:79], v[172:175], v[204:207], v[76:79]
    ds_read_b128 v[128:131], v5 offset:0
    v_mfma_f32_16x16x32_bf16 v[72:75], v[172:175], v[200:203], v[72:75]
    ds_read_b128 v[132:135], v5 offset:2048
    v_mfma_f32_16x16x32_bf16 v[80:83], v[176:179], v[200:203], v[80:83]
    ds_read_b128 v[136:139], v5 offset:4096
    v_mfma_f32_16x16x32_bf16 v[84:87], v[176:179], v[204:207], v[84:87]
    ds_read_b128 v[140:143], v5 offset:6144
    v_mfma_f32_16x16x32_bf16 v[92:95], v[180:183], v[204:207], v[92:95]
    ds_read_b128 v[144:147], v5 offset:8192
    v_mfma_f32_16x16x32_bf16 v[88:91], v[180:183], v[200:203], v[88:91]
    ds_read_b128 v[148:151], v5 offset:10240
    v_mfma_f32_16x16x32_bf16 v[96:99], v[184:187], v[200:203], v[96:99]
    ds_read_b128 v[152:155], v5 offset:12288
    v_mfma_f32_16x16x32_bf16 v[100:103], v[184:187], v[204:207], v[100:103]
    ds_read_b128 v[156:159], v5 offset:14336
    v_mfma_f32_16x16x32_bf16 v[108:111], v[188:191], v[204:207], v[108:111]
    v_mfma_f32_16x16x32_bf16 v[104:107], v[188:191], v[200:203], v[104:107]
    v_mfma_f32_16x16x32_bf16 v[112:115], v[192:195], v[200:203], v[112:115]
    v_mfma_f32_16x16x32_bf16 v[116:119], v[192:195], v[204:207], v[116:119]
    v_mfma_f32_16x16x32_bf16 v[124:127], v[196:199], v[204:207], v[124:127]
    v_mfma_f32_16x16x32_bf16 v[120:123], v[196:199], v[200:203], v[120:123]
    s_waitcnt lgkmcnt(0)
    v_mfma_f32_16x16x32_bf16 v[64:67], v[128:131], v[160:163], v[64:67]
    ds_read_b128 v[200:203], v11 offset:0
    v_mfma_f32_16x16x32_bf16 v[68:71], v[128:131], v[164:167], v[68:71]
    ds_read_b128 v[204:207], v11 offset:2048
    v_mfma_f32_16x16x32_bf16 v[76:79], v[132:135], v[164:167], v[76:79]
    ds_read_b128 v[168:171], v7 offset:0
    v_mfma_f32_16x16x32_bf16 v[72:75], v[132:135], v[160:163], v[72:75]
    ds_read_b128 v[172:175], v7 offset:2048
    v_mfma_f32_16x16x32_bf16 v[80:83], v[136:139], v[160:163], v[80:83]
    ds_read_b128 v[176:179], v7 offset:4096
    v_mfma_f32_16x16x32_bf16 v[84:87], v[136:139], v[164:167], v[84:87]
    ds_read_b128 v[180:183], v7 offset:6144
    v_mfma_f32_16x16x32_bf16 v[92:95], v[140:143], v[164:167], v[92:95]
    ds_read_b128 v[184:187], v7 offset:8192
    v_mfma_f32_16x16x32_bf16 v[88:91], v[140:143], v[160:163], v[88:91]
    ds_read_b128 v[188:191], v7 offset:10240
    v_mfma_f32_16x16x32_bf16 v[96:99], v[144:147], v[160:163], v[96:99]
    ds_read_b128 v[192:195], v7 offset:12288
    v_mfma_f32_16x16x32_bf16 v[100:103], v[144:147], v[164:167], v[100:103]
    ds_read_b128 v[196:199], v7 offset:14336
    v_mfma_f32_16x16x32_bf16 v[108:111], v[148:151], v[164:167], v[108:111]
    v_mfma_f32_16x16x32_bf16 v[104:107], v[148:151], v[160:163], v[104:107]
    v_mfma_f32_16x16x32_bf16 v[112:115], v[152:155], v[160:163], v[112:115]
    v_mfma_f32_16x16x32_bf16 v[116:119], v[152:155], v[164:167], v[116:119]
    v_mfma_f32_16x16x32_bf16 v[124:127], v[156:159], v[164:167], v[124:127]
    v_mfma_f32_16x16x32_bf16 v[120:123], v[156:159], v[160:163], v[120:123]
    s_waitcnt lgkmcnt(0)
    s_barrier
    v_mfma_f32_16x16x32_bf16 v[64:67], v[168:171], v[200:203], v[64:67]
    ds_read_b128 v[160:163], v9 offset:32768
    v_mfma_f32_16x16x32_bf16 v[68:71], v[168:171], v[204:207], v[68:71]
    ds_read_b128 v[164:167], v9 offset:34816
    v_mfma_f32_16x16x32_bf16 v[76:79], v[172:175], v[204:207], v[76:79]
    ds_read_b128 v[128:131], v5 offset:32768
    v_mfma_f32_16x16x32_bf16 v[72:75], v[172:175], v[200:203], v[72:75]
    ds_read_b128 v[132:135], v5 offset:34816
    v_mfma_f32_16x16x32_bf16 v[80:83], v[176:179], v[200:203], v[80:83]
    ds_read_b128 v[136:139], v5 offset:36864
    v_mfma_f32_16x16x32_bf16 v[84:87], v[176:179], v[204:207], v[84:87]
    ds_read_b128 v[140:143], v5 offset:38912
    v_mfma_f32_16x16x32_bf16 v[92:95], v[180:183], v[204:207], v[92:95]
    ds_read_b128 v[144:147], v5 offset:40960
    v_mfma_f32_16x16x32_bf16 v[88:91], v[180:183], v[200:203], v[88:91]
    ds_read_b128 v[148:151], v5 offset:43008
    v_mfma_f32_16x16x32_bf16 v[96:99], v[184:187], v[200:203], v[96:99]
    ds_read_b128 v[152:155], v5 offset:45056
    v_mfma_f32_16x16x32_bf16 v[100:103], v[184:187], v[204:207], v[100:103]
    ds_read_b128 v[156:159], v5 offset:47104
    v_mfma_f32_16x16x32_bf16 v[108:111], v[188:191], v[204:207], v[108:111]
    v_mfma_f32_16x16x32_bf16 v[104:107], v[188:191], v[200:203], v[104:107]
    v_mfma_f32_16x16x32_bf16 v[112:115], v[192:195], v[200:203], v[112:115]
    v_mfma_f32_16x16x32_bf16 v[116:119], v[192:195], v[204:207], v[116:119]
    v_mfma_f32_16x16x32_bf16 v[124:127], v[196:199], v[204:207], v[124:127]
    v_mfma_f32_16x16x32_bf16 v[120:123], v[196:199], v[200:203], v[120:123]
    s_add_u32 s30, s30, 1
    s_add_u32 s31, s31, 8
    s_cmp_lt_u32 s30, 4
    s_cbranch_scc1 K1C_loop
    v_mov_b32 v1, 133376
    ds_read_b64 v[54:55], v1
    v_fma_f32 v46, v16, v64, v65
    v_fma_f32 v47, v16, v68, v69
    v_fmac_f32 v46, v18, v68
    v_fmac_f32 v47, v17, v64
    v_fma_f32 v44, v16, v46, v66
    v_fma_f32 v45, v16, v47, v70
    v_fmac_f32 v44, v18, v47
    v_fmac_f32 v45, v17, v46
    v_fma_f32 v46, v16, v44, v67
    v_fma_f32 v47, v16, v45, v71
    v_fmac_f32 v46, v18, v45
    v_fmac_f32 v47, v17, v44
    v_fma_f32 v44, v16, v46, v72
    v_fma_f32 v45, v16, v47, v76
    v_fmac_f32 v44, v18, v47
    v_fmac_f32 v45, v17, v46
    v_fma_f32 v46, v16, v44, v73
    v_fma_f32 v47, v16, v45, v77
    v_fmac_f32 v46, v18, v45
    v_fmac_f32 v47, v17, v44
    v_fma_f32 v44, v16, v46, v74
    v_fma_f32 v45, v16, v47, v78
    v_fmac_f32 v44, v18, v47
    v_fmac_f32 v45, v17, v46
    v_fma_f32 v46, v16, v44, v75
    v_fma_f32 v47, v16, v45, v79
    v_fmac_f32 v46, v18, v45
    v_fmac_f32 v47, v17, v44
    v_fma_f32 v44, v16, v46, v80
    v_fma_f32 v45, v16, v47, v84
    v_fmac_f32 v44, v18, v47
    v_fmac_f32 v45, v17, v46
    v_fma_f32 v46, v16, v44, v81
    v_fma_f32 v47, v16, v45, v85
    v_fmac_f32 v46, v18, v45
    v_fmac_f32 v47, v17, v44
    v_fma_f32 v44, v16, v46, v82
    v_fma_f32 v45, v16, v47, v86
    v_fmac_f32 v44, v18, v47
    v_fmac_f32 v45, v17, v46
    v_fma_f32 v46, v16, v44, v83
    v_fma_f32 v47, v16, v45, v87
    v_fmac_f32 v46, v18, v45
    v_fmac_f32 v47, v17, v44
    v_fma_f32 v44, v16, v46, v88
    v_fma_f32 v45, v16, v47, v92
    v_fmac_f32 v44, v18, v47
    v_fmac_f32 v45, v17, v46
    v_fma_f32 v46, v16, v44, v89
    v_fma_f32 v47, v16, v45, v93
    v_fmac_f32 v46, v18, v45
    v_fmac_f32 v47, v17, v44
    v_fma_f32 v44, v16, v46, v90
    v_fma_f32 v45, v16, v47, v94
    v_fmac_f32 v44, v18, v47
    v_fmac_f32 v45, v17, v46
    v_fma_f32 v46, v16, v44, v91
    v_fma_f32 v47, v16, v45, v95
    v_fmac_f32 v46, v18, v45
    v_fmac_f32 v47, v17, v44
    v_fma_f32 v44, v16, v46, v96
    v_fma_f32 v45, v16, v47, v100
    v_fmac_f32 v44, v18, v47
    v_fmac_f32 v45, v17, v46
    v_fma_f32 v46, v16, v44, v97
    v_fma_f32 v47, v16, v45, v101
    v_fmac_f32 v46, v18, v45
    v_fmac_f32 v47, v17, v44
    v_fma_f32 v44, v16, v46, v98
    v_fma_f32 v45, v16, v47, v102
    v_fmac_f32 v44, v18, v47
    v_fmac_f32 v45, v17, v46
    v_fma_f32 v46, v16, v44, v99
    v_fma_f32 v47, v16, v45, v103
    v_fmac_f32 v46, v18, v45
    v_fmac_f32 v47, v17, v44
    v_fma_f32 v44, v16, v46, v104
    v_fma_f32 v45, v16, v47, v108
    v_fmac_f32 v44, v18, v47
    v_fmac_f32 v45, v17, v46
    v_fma_f32 v46, v16, v44, v105
    v_fma_f32 v47, v16, v45, v109
    v_fmac_f32 v46, v18, v45
    v_fmac_f32 v47, v17, v44
    v_fma_f32 v44, v16, v46, v106
    v_fma_f32 v45, v16, v47, v110
    v_fmac_f32 v44, v18, v47
    v_fmac_f32 v45, v17, v46
    v_fma_f32 v46, v16, v44, v107
    v_fma_f32 v47, v16, v45, v111
    v_fmac_f32 v46, v18, v45
    v_fmac_f32 v47, v17, v44
    v_fma_f32 v44, v16, v46, v112
    v_fma_f32 v45, v16, v47, v116
    v_fmac_f32 v44, v18, v47
    v_fmac_f32 v45, v17, v46
    v_fma_f32 v46, v16, v44, v113
    v_fma_f32 v47, v16, v45, v117
    v_fmac_f32 v46, v18, v45
    v_fmac_f32 v47, v17, v44
    v_fma_f32 v44, v16, v46, v114
    v_fma_f32 v45, v16, v47, v118
    v_fmac_f32 v44, v18, v47
    v_fmac_f32 v45, v17, v46
    v_fma_f32 v46, v16, v44, v115
    v_fma_f32 v47, v16, v45, v119
    v_fmac_f32 v46, v18, v45
    v_fmac_f32 v47, v17, v44
    v_fma_f32 v44, v16, v46, v120
    v_fma_f32 v45, v16, v47, v124
    v_fmac_f32 v44, v18, v47
    v_fmac_f32 v45, v17, v46
    v_fma_f32 v46, v16, v44, v121
    v_fma_f32 v47, v16, v45, v125
    v_fmac_f32 v46, v18, v45
    v_fmac_f32 v47, v17, v44
    v_fma_f32 v44, v16, v46, v122
    v_fma_f32 v45, v16, v47, v126
    v_fmac_f32 v44, v18, v47
    v_fmac_f32 v45, v17, v46
    v_fma_f32 v46, v16, v44, v123
    v_fma_f32 v47, v16, v45, v127
    v_fmac_f32 v46, v18, v45
    v_fmac_f32 v47, v17, v44
    v_mov_b32 v44, v46
    v_mov_b32 v45, v47
    s_nop 1
    v_permlane32_swap_b32 v46, v44
    v_permlane32_swap_b32 v47, v45
    v_mov_b32 v48, v46
    v_mov_b32 v49, v47
    v_mov_b32 v50, v44
    v_mov_b32 v51, v45
    s_nop 0
    v_permlane16_swap_b32 v46, v48
    v_permlane16_swap_b32 v47, v49
    v_permlane16_swap_b32 v44, v50
    v_permlane16_swap_b32 v45, v51
    v_fma_f32 v48, v46, v22, v48
    v_fma_f32 v49, v46, v23, v49
    v_fma_f32 v48, -v47, v23, v48
    v_fmac_f32 v49, v47, v22
    v_fma_f32 v44, v48, v22, v44
    v_fma_f32 v45, v48, v23, v45
    v_fma_f32 v44, -v49, v23, v44
    v_fmac_f32 v45, v49, v22
    v_fma_f32 v52, v44, v22, v50
    v_fma_f32 v53, v44, v23, v51
    v_fma_f32 v52, -v45, v23, v52
    v_fmac_f32 v53, v45, v22
    s_waitcnt lgkmcnt(0)
    s_mov_b64 exec, 0xffff
    buffer_store_dwordx4 v[52:55], v34, s[12:15], 0 offen sc1
    s_mov_b64 exec, -1
    buffer_load_dwordx4 v[192:195], v30, s[12:15], 0 offen sc1
    buffer_load_dwordx4 v[196:199], v31, s[12:15], 0 offen sc1
    buffer_load_dwordx4 v[200:203], v32, s[12:15], 0 offen sc1
    buffer_load_dwordx4 v[204:207], v33, s[12:15], 0 offen sc1
    v_cndmask_b32 v50, 0, v46, s[48:49]
    v_cndmask_b32 v51, 0, v47, s[48:49]
    v_cndmask_b32 v50, v50, v48, s[50:51]
    v_cndmask_b32 v51, v51, v49, s[50:51]
    v_cndmask_b32 v50, v50, v44, s[52:53]
    v_cndmask_b32 v51, v51, v45, s[52:53]
    v_mul_f32 v56, v20, v50
    v_mul_f32 v57, v20, v51
    v_fma_f32 v56, -v21, v51, v56
    v_fmac_f32 v57, v21, v50
    v_mul_f32 v128, v20, v64
    v_fmac_f32 v128, v43, v68
    v_mul_f32 v68, v42, v68
    v_fmac_f32 v68, v43, v64
    v_mul_f32 v129, v20, v65
    v_fmac_f32 v129, v43, v69
    v_mul_f32 v69, v42, v69
    v_fmac_f32 v69, v43, v65
    v_mul_f32 v130, v20, v66
    v_fmac_f32 v130, v43, v70
    v_mul_f32 v70, v42, v70
    v_fmac_f32 v70, v43, v66
    v_mul_f32 v131, v20, v67
    v_fmac_f32 v131, v43, v71
    v_mul_f32 v71, v42, v71
    v_fmac_f32 v71, v43, v67
    v_mul_f32 v132, v20, v72
    v_fmac_f32 v132, v43, v76
    v_mul_f32 v76, v42, v76
    v_fmac_f32 v76, v43, v72
    v_mul_f32 v133, v20, v73
    v_fmac_f32 v133, v43, v77
    v_mul_f32 v77, v42, v77
    v_fmac_f32 v77, v43, v73
    v_mul_f32 v134, v20, v74
    v_fmac_f32 v134, v43, v78
    v_mul_f32 v78, v42, v78
    v_fmac_f32 v78, v43, v74
    v_mul_f32 v135, v20, v75
    v_fmac_f32 v135, v43, v79
    v_mul_f32 v79, v42, v79
    v_fmac_f32 v79, v43, v75
    v_mul_f32 v136, v20, v80
    v_fmac_f32 v136, v43, v84
    v_mul_f32 v84, v42, v84
    v_fmac_f32 v84, v43, v80
    v_mul_f32 v137, v20, v81
    v_fmac_f32 v137, v43, v85
    v_mul_f32 v85, v42, v85
    v_fmac_f32 v85, v43, v81
    v_mul_f32 v138, v20, v82
    v_fmac_f32 v138, v43, v86
    v_mul_f32 v86, v42, v86
    v_fmac_f32 v86, v43, v82
    v_mul_f32 v139, v20, v83
    v_fmac_f32 v139, v43, v87
    v_mul_f32 v87, v42, v87
    v_fmac_f32 v87, v43, v83
    v_mul_f32 v140, v20, v88
    v_fmac_f32 v140, v43, v92
    v_mul_f32 v92, v42, v92
    v_fmac_f32 v92, v43, v88
    v_mul_f32 v141, v20, v89
    v_fmac_f32 v141, v43, v93
    v_mul_f32 v93, v42, v93
    v_fmac_f32 v93, v43, v89
    v_mul_f32 v142, v20, v90
    v_fmac_f32 v142, v43, v94
    v_mul_f32 v94, v42, v94
    v_fmac_f32 v94, v43, v90
    v_mul_f32 v143, v20, v91
    v_fmac_f32 v143, v43, v95
    v_mul_f32 v95, v42, v95
    v_fmac_f32 v95, v43, v91
    v_mul_f32 v144, v20, v96
    v_fmac_f32 v144, v43, v100
    v_mul_f32 v100, v42, v100
    v_fmac_f32 v100, v43, v96
    v_mul_f32 v145, v20, v97
    v_fmac_f32 v145, v43, v101
    v_mul_f32 v101, v42, v101
    v_fmac_f32 v101, v43, v97
    v_mul_f32 v146, v20, v98
    v_fmac_f32 v146, v43, v102
    v_mul_f32 v102, v42, v102
    v_fmac_f32 v102, v43, v98
    v_mul_f32 v147, v20, v99
    v_fmac_f32 v147, v43, v103
    v_mul_f32 v103, v42, v103
    v_fmac_f32 v103, v43, v99
    v_mul_f32 v148, v20, v104
    v_fmac_f32 v148, v43, v108
    v_mul_f32 v108, v42, v108
    v_fmac_f32 v108, v43, v104
    v_mul_f32 v149, v20, v105
    v_fmac_f32 v149, v43, v109
    v_mul_f32 v109, v42, v109
    v_fmac_f32 v109, v43, v105
    v_mul_f32 v150, v20, v106
    v_fmac_f32 v150, v43, v110
    v_mul_f32 v110, v42, v110
    v_fmac_f32 v110, v43, v106
    v_mul_f32 v151, v20, v107
    v_fmac_f32 v151, v43, v111
    v_mul_f32 v111, v42, v111
    v_fmac_f32 v111, v43, v107
    v_mul_f32 v152, v20, v112
    v_fmac_f32 v152, v43, v116
    v_mul_f32 v116, v42, v116
    v_fmac_f32 v116, v43, v112
    v_mul_f32 v153, v20, v113
    v_fmac_f32 v153, v43, v117
    v_mul_f32 v117, v42, v117
    v_fmac_f32 v117, v43, v113
    v_mul_f32 v154, v20, v114
    v_fmac_f32 v154, v43, v118
    v_mul_f32 v118, v42, v118
    v_fmac_f32 v118, v43, v114
    v_mul_f32 v155, v20, v115
    v_fmac_f32 v155, v43, v119
    v_mul_f32 v119, v42, v119
    v_fmac_f32 v119, v43, v115
    v_mul_f32 v156, v20, v120
    v_fmac_f32 v156, v43, v124
    v_mul_f32 v124, v42, v124
    v_fmac_f32 v124, v43, v120
    v_mul_f32 v157, v20, v121
    v_fmac_f32 v157, v43, v125
    v_mul_f32 v125, v42, v125
    v_fmac_f32 v125, v43, v121
    v_mul_f32 v158, v20, v122
    v_fmac_f32 v158, v43, v126
    v_mul_f32 v126, v42, v126
    v_fmac_f32 v126, v43, v122
    v_mul_f32 v159, v20, v123
    v_fmac_f32 v159, v43, v127
    v_mul_f32 v127, v42, v127
    v_fmac_f32 v127, v43, v123
    s_mov_b32 s39, 0
K1C_chk:
    s_waitcnt vmcnt(0)
    v_cmp_eq_u32 vcc, v194, v54
    v_cmp_eq_u32 s[54:55], v195, v55
    s_and_b64 s[54:55], s[54:55], vcc
    s_or_b64 s[56:57], s[54:55], s[40:41]
    v_cmp_eq_u32 vcc, v198, v54
    v_cmp_eq_u32 s[54:55], v199, v55
    s_and_b64 s[54:55], s[54:55], vcc
    s_or_b64 s[58:59], s[54:55], s[42:43]
    v_cmp_eq_u32 vcc, v202, v54
    v_cmp_eq_u32 s[54:55], v203, v55
    s_and_b64 s[54:55], s[54:55], vcc
    s_or_b64 s[60:61], s[54:55], s[44:45]
    v_cmp_eq_u32 vcc, v206, v54
    v_cmp_eq_u32 s[54:55], v207, v55
    s_and_b64 s[54:55], s[54:55], vcc
    s_or_b64 s[62:63], s[54:55], s[46:47]
    s_and_b64 s[56:57], s[56:57], s[58:59]
    s_and_b64 s[60:61], s[60:61], s[62:63]
    s_and_b64 s[56:57], s[56:57], s[60:61]
    s_cmp_eq_u64 s[56:57], -1
    s_cbranch_scc1 K1C_ok
    s_add_u32 s39, s39, 1
    s_cmp_gt_u32 s39, 4096
    s_cbranch_scc1 K1C_ok
    buffer_load_dwordx4 v[192:195], v30, s[12:15], 0 offen sc1
    buffer_load_dwordx4 v[196:199], v31, s[12:15], 0 offen sc1
    buffer_load_dwordx4 v[200:203], v32, s[12:15], 0 offen sc1
    buffer_load_dwordx4 v[204:207], v33, s[12:15], 0 offen sc1
    s_branch K1C_chk
K1C_ok:
    v_fma_f32 v200, v204, v28, v200
    v_fma_f32 v201, v204, v29, v201
    v_fma_f32 v200, -v205, v29, v200
    v_fmac_f32 v201, v205, v28
    v_fma_f32 v196, v200, v28, v196
    v_fma_f32 v197, v200, v29, v197
    v_fma_f32 v196, -v201, v29, v196
    v_fmac_f32 v197, v201, v28
    v_fma_f32 v192, v196, v28, v192
    v_fma_f32 v193, v196, v29, v193
    v_fma_f32 v192, -v197, v29, v192
    v_fmac_f32 v193, v197, v28
    v_mul_f32 v44, v192, v26
    v_mul_f32 v45, v192, v27
    v_fma_f32 v44, -v193, v27, v44
    v_fmac_f32 v45, v193, v26
    v_mov_b32 v46, v44
    v_mov_b32 v47, v45
    s_nop 1
    v_permlane32_swap_b32 v44, v46
    v_permlane32_swap_b32 v45, v47
    v_add_f32 v44, v44, v46
    v_add_f32 v45, v45, v47
    v_mov_b32 v46, v44
    v_mov_b32 v47, v45
    s_nop 1
    v_permlane16_swap_b32 v44, v46
    v_permlane16_swap_b32 v45, v47
    v_add_f32 v44, v44, v46
    v_add_f32 v45, v45, v47
    v_fma_f32 v56, v24, v44, v56
    v_fma_f32 v57, v24, v45, v57
    v_fma_f32 v56, -v25, v45, v56
    v_fmac_f32 v57, v25, v44
    v_xor_b32 v57, 0x80000000, v57
    v_fmac_f32 v128, v16, v56
    v_fmac_f32 v68, v16, v57
    v_fmac_f32 v128, v17, v57
    v_fmac_f32 v68, v18, v56
    v_fmac_f32 v129, v16, v128
    v_fmac_f32 v69, v16, v68
    v_fmac_f32 v129, v17, v68
    v_fmac_f32 v69, v18, v128
    v_cvt_pk_bf16_f32 v160, v128, v129
    v_cvt_pk_bf16_f32 v164, v68, v69
    v_fmac_f32 v130, v16, v129
    v_fmac_f32 v70, v16, v69
    v_fmac_f32 v130, v17, v69
    v_fmac_f32 v70, v18, v129
    v_fmac_f32 v131, v16, v130
    v_fmac_f32 v71, v16, v70
    v_fmac_f32 v131, v17, v70
    v_fmac_f32 v71, v18, v130
    v_cvt_pk_bf16_f32 v161, v130, v131
    v_cvt_pk_bf16_f32 v165, v70, v71
    v_fmac_f32 v132, v16, v131
    v_fmac_f32 v76, v16, v71
    v_fmac_f32 v132, v17, v71
    v_fmac_f32 v76, v18, v131
    v_fmac_f32 v133, v16, v132
    v_fmac_f32 v77, v16, v76
    v_fmac_f32 v133, v17, v76
    v_fmac_f32 v77, v18, v132
    v_cvt_pk_bf16_f32 v162, v132, v133
    v_cvt_pk_bf16_f32 v166, v76, v77
    v_fmac_f32 v134, v16, v133
    v_fmac_f32 v78, v16, v77
    v_fmac_f32 v134, v17, v77
    v_fmac_f32 v78, v18, v133
    v_fmac_f32 v135, v16, v134
    v_fmac_f32 v79, v16, v78
    v_fmac_f32 v135, v17, v78
    v_fmac_f32 v79, v18, v134
    v_cvt_pk_bf16_f32 v163, v134, v135
    v_cvt_pk_bf16_f32 v167, v78, v79
    buffer_store_dwordx4 v[160:163], v35, s[8:11], 0 offen offset:0
    buffer_store_dwordx4 v[164:167], v35, s[8:11], s36 offen offset:0
    v_fmac_f32 v136, v16, v135
    v_fmac_f32 v84, v16, v79
    v_fmac_f32 v136, v17, v79
    v_fmac_f32 v84, v18, v135
    v_fmac_f32 v137, v16, v136
    v_fmac_f32 v85, v16, v84
    v_fmac_f32 v137, v17, v84
    v_fmac_f32 v85, v18, v136
    v_cvt_pk_bf16_f32 v168, v136, v137
    v_cvt_pk_bf16_f32 v172, v84, v85
    v_fmac_f32 v138, v16, v137
    v_fmac_f32 v86, v16, v85
    v_fmac_f32 v138, v17, v85
    v_fmac_f32 v86, v18, v137
    v_fmac_f32 v139, v16, v138
    v_fmac_f32 v87, v16, v86
    v_fmac_f32 v139, v17, v86
    v_fmac_f32 v87, v18, v138
    v_cvt_pk_bf16_f32 v169, v138, v139
    v_cvt_pk_bf16_f32 v173, v86, v87
    v_fmac_f32 v140, v16, v139
    v_fmac_f32 v92, v16, v87
    v_fmac_f32 v140, v17, v87
    v_fmac_f32 v92, v18, v139
    v_fmac_f32 v141, v16, v140
    v_fmac_f32 v93, v16, v92
    v_fmac_f32 v141, v17, v92
    v_fmac_f32 v93, v18, v140
    v_cvt_pk_bf16_f32 v170, v140, v141
    v_cvt_pk_bf16_f32 v174, v92, v93
    v_fmac_f32 v142, v16, v141
    v_fmac_f32 v94, v16, v93
    v_fmac_f32 v142, v17, v93
    v_fmac_f32 v94, v18, v141
    v_fmac_f32 v143, v16, v142
    v_fmac_f32 v95, v16, v94
    v_fmac_f32 v143, v17, v94
    v_fmac_f32 v95, v18, v142
    v_cvt_pk_bf16_f32 v171, v142, v143
    v_cvt_pk_bf16_f32 v175, v94, v95
    buffer_store_dwordx4 v[168:171], v36, s[8:11], 0 offen offset:1024
    buffer_store_dwordx4 v[172:175], v36, s[8:11], s36 offen offset:1024
    v_fmac_f32 v144, v16, v143
    v_fmac_f32 v100, v16, v95
    v_fmac_f32 v144, v17, v95
    v_fmac_f32 v100, v18, v143
    v_fmac_f32 v145, v16, v144
    v_fmac_f32 v101, v16, v100
    v_fmac_f32 v145, v17, v100
    v_fmac_f32 v101, v18, v144
    v_cvt_pk_bf16_f32 v176, v144, v145
    v_cvt_pk_bf16_f32 v180, v100, v101
    v_fmac_f32 v146, v16, v145
    v_fmac_f32 v102, v16, v101
    v_fmac_f32 v146, v17, v101
    v_fmac_f32 v102, v18, v145
    v_fmac_f32 v147, v16, v146
    v_fmac_f32 v103, v16, v102
    v_fmac_f32 v147, v17, v102
    v_fmac_f32 v103, v18, v146
    v_cvt_pk_bf16_f32 v177, v146, v147
    v_cvt_pk_bf16_f32 v181, v102, v103
    v_fmac_f32 v148, v16, v147
    v_fmac_f32 v108, v16, v103
    v_fmac_f32 v148, v17, v103
    v_fmac_f32 v108, v18, v147
    v_fmac_f32 v149, v16, v148
    v_fmac_f32 v109, v16, v108
    v_fmac_f32 v149, v17, v108
    v_fmac_f32 v109, v18, v148
    v_cvt_pk_bf16_f32 v178, v148, v149
    v_cvt_pk_bf16_f32 v182, v108, v109
    v_fmac_f32 v150, v16, v149
    v_fmac_f32 v110, v16, v109
    v_fmac_f32 v150, v17, v109
    v_fmac_f32 v110, v18, v149
    v_fmac_f32 v151, v16, v150
    v_fmac_f32 v111, v16, v110
    v_fmac_f32 v151, v17, v110
    v_fmac_f32 v111, v18, v150
    v_cvt_pk_bf16_f32 v179, v150, v151
    v_cvt_pk_bf16_f32 v183, v110, v111
    buffer_store_dwordx4 v[176:179], v35, s[8:11], 0 offen offset:2048
    buffer_store_dwordx4 v[180:183], v35, s[8:11], s36 offen offset:2048
    v_fmac_f32 v152, v16, v151
    v_fmac_f32 v116, v16, v111
    v_fmac_f32 v152, v17, v111
    v_fmac_f32 v116, v18, v151
    v_fmac_f32 v153, v16, v152
    v_fmac_f32 v117, v16, v116
    v_fmac_f32 v153, v17, v116
    v_fmac_f32 v117, v18, v152
    v_cvt_pk_bf16_f32 v184, v152, v153
    v_cvt_pk_bf16_f32 v188, v116, v117
    v_fmac_f32 v154, v16, v153
    v_fmac_f32 v118, v16, v117
    v_fmac_f32 v154, v17, v117
    v_fmac_f32 v118, v18, v153
    v_fmac_f32 v155, v16, v154
    v_fmac_f32 v119, v16, v118
    v_fmac_f32 v155, v17, v118
    v_fmac_f32 v119, v18, v154
    v_cvt_pk_bf16_f32 v185, v154, v155
    v_cvt_pk_bf16_f32 v189, v118, v119
    v_fmac_f32 v156, v16, v155
    v_fmac_f32 v124, v16, v119
    v_fmac_f32 v156, v17, v119
    v_fmac_f32 v124, v18, v155
    v_fmac_f32 v157, v16, v156
    v_fmac_f32 v125, v16, v124
    v_fmac_f32 v157, v17, v124
    v_fmac_f32 v125, v18, v156
    v_cvt_pk_bf16_f32 v186, v156, v157
    v_cvt_pk_bf16_f32 v190, v124, v125
    v_fmac_f32 v158, v16, v157
    v_fmac_f32 v126, v16, v125
    v_fmac_f32 v158, v17, v125
    v_fmac_f32 v126, v18, v157
    v_fmac_f32 v159, v16, v158
    v_fmac_f32 v127, v16, v126
    v_fmac_f32 v159, v17, v126
    v_fmac_f32 v127, v18, v158
    v_cvt_pk_bf16_f32 v187, v158, v159
    v_cvt_pk_bf16_f32 v191, v126, v127
    buffer_store_dwordx4 v[184:187], v36, s[8:11], 0 offen offset:3072
    buffer_store_dwordx4 v[188:191], v36, s[8:11], s36 offen offset:3072
K1_fin:
K1_done:
    s_endpgm
.p2align 8
.globl k2_kernel
.type k2_kernel,@function
k2_kernel:
    s_cmp_ge_u32 s2, 256
    s_cbranch_scc1 K2_done
    s_load_dwordx16 s[32:47], s[0:1], 0
    s_load_dwordx16 s[48:63], s[0:1], 64
    s_load_dwordx4 s[64:67], s[0:1], 128
    v_lshrrev_b32 v1, 6, v0
    v_and_b32 v2, 63, v0
    s_and_b32 s6, s2, 3
    v_readfirstlane_b32 s5, v1
    s_lshl_b32 s6, s6, 2
    s_lshr_b32 s7, s2, 3
    s_and_b32 s3, s7, 3
    s_add_u32 s3, s3, s6
    s_and_b32 s6, s2, 4
    s_lshl_b32 s6, s6, 1
    s_lshr_b32 s4, s7, 2
    s_add_u32 s4, s4, s6
    s_cmp_lt_u32 s5, 4
    s_cbranch_scc1 K2_compute
    s_sub_u32 s6, s5, 4
    s_lshl_b32 s101, s6, 12
    s_lshl_b32 s100, s6, 11
    s_lshl_b32 s7, s3, 19
    s_add_u32 s7, s7, s101
    v_lshlrev_b32 v4, 4, v2
    v_add_u32 v4, s7, v4
    v_lshrrev_b32 v12, 3, v2
    v_and_b32 v13, 7, v2
    v_lshrrev_b32 v14, 4, v2
    v_xor_b32 v13, v13, v14
    v_lshlrev_b32 v13, 4, v13
    v_lshl_add_u32 v15, v12, 11, v13
    s_lshl_b32 s7, s4, 2
    s_add_u32 s7, s7, s6
    s_lshl_b32 s7, s7, 15
    v_add_u32 v5, s7, v15
    v_xor_b32 v6, 64, v5
    v_add_u32 v6, 0x3c00, v6
    s_and_b32 s30, s2, 3
    s_lshl_b32 s30, s30, 2
    s_and_b32 s31, s2, 4
    s_lshl_b32 s31, s31, 1
    s_add_u32 s30, s30, s31
    s_add_u32 s31, s3, s4
    s_and_b32 s31, s31, 3
    s_add_u32 s30, s30, s31
    s_and_b32 s30, s30, 15
    s_lshl_b32 s72, s30, 7
    s_lshl_b32 s73, s30, 15
    s_waitcnt lgkmcnt(0)
    s_add_u32 s8, s66, 8388608
    s_addc_u32 s9, s67, 0
    s_mov_b32 s10, 8388608
    s_mov_b32 s11, 0x00020000
    s_mov_b32 s12, s54
    s_mov_b32 s13, s55
    s_mov_b32 s14, 2097152
    s_mov_b32 s15, 0x00020000
    s_mov_b32 s16, s56
    s_mov_b32 s17, s57
    s_mov_b32 s18, 2097152
    s_mov_b32 s19, 0x00020000
    s_add_u32 m0, s101, 0
    s_nop 0
    buffer_load_dwordx4 v4, s[8:11], s73 offen lds
    buffer_load_dwordx4 v4, s[8:11], s73 offen offset:1024 lds
    buffer_load_dwordx4 v4, s[8:11], s73 offen offset:2048 lds
    buffer_load_dwordx4 v4, s[8:11], s73 offen offset:3072 lds
    s_add_u32 m0, s100, 16384
    s_add_u32 s73, s73, 16384
    buffer_load_dwordx4 v5, s[12:15], s72 offen lds
    buffer_load_dwordx4 v6, s[12:15], s72 offen offset:1024 lds
    s_add_u32 m0, s101, 24576
    s_nop 0
    buffer_load_dwordx4 v4, s[8:11], s73 offen lds
    buffer_load_dwordx4 v4, s[8:11], s73 offen offset:1024 lds
    buffer_load_dwordx4 v4, s[8:11], s73 offen offset:2048 lds
    buffer_load_dwordx4 v4, s[8:11], s73 offen offset:3072 lds
    s_add_u32 m0, s100, 40960
    s_add_u32 s73, s73, 16384
    buffer_load_dwordx4 v5, s[16:19], s72 offen lds
    buffer_load_dwordx4 v6, s[16:19], s72 offen offset:1024 lds
    s_add_u32 s72, s72, 128
    s_and_b32 s72, s72, 2047
    s_lshl_b32 s73, s72, 8
    s_mov_b32 s20, s44
    s_mov_b32 s21, s45
    s_mov_b32 s22, 4194304
    s_mov_b32 s23, 0x00020000
    s_mov_b32 s24, s32
    s_mov_b32 s25, s33
    s_mov_b32 s26, 4194304
    s_mov_b32 s27, 0x00020000
    s_add_u32 s28, s66, 4194304
    s_addc_u32 s29, s67, 0
    s_mov_b32 s30, 4194304
    s_mov_b32 s31, 0x00020000
    s_mov_b32 s68, s62
    s_mov_b32 s69, s63
    s_mov_b32 s70, 16777216
    s_mov_b32 s71, 0x00020000
    s_lshl_b32 s7, s3, 2
    s_add_u32 s7, s7, s6
    s_lshl_b32 s74, s7, 18
    s_lshl_b32 s7, s7, 16
    s_lshl_b32 s75, s4, 7
    s_add_u32 s7, s7, s75
    v_add_u32 v8, s7, v15
    v_xor_b32 v9, 64, v8
    v_add_u32 v9, 0x3c00, v9
    v_add_u32 v10, 0x7800, v8
    v_add_u32 v11, 0x7800, v9
    v_and_b32 v12, 15, v2
    v_xor_b32 v13, v12, v14
    v_and_b32 v1, 7, v13
    v_lshlrev_b32 v1, 4, v1
    v_lshrrev_b32 v3, 3, v13
    v_lshl_add_u32 v1, v3, 8, v1
    v_lshl_add_u32 v1, v14, 12, v1
    s_lshl_b32 s7, s4, 2
    s_add_u32 s7, s7, s6
    s_lshl_b32 s7, s7, 16
    s_lshr_b32 s76, s3, 1
    s_lshl_b32 s76, s76, 9
    s_add_u32 s7, s7, s76
    s_and_b32 s76, s3, 1
    s_lshl_b32 s76, s76, 7
    s_add_u32 s7, s7, s76
    v_add_u32 v16, s7, v1
    v_xor_b32 v17, 64, v16
    v_add_u32 v17, 15360, v17
    v_xor_b32 v18, 0x100, v16
    v_add_u32 v18, 30720, v18
    v_xor_b32 v19, 0x140, v16
    v_add_u32 v19, 46080, v19
    s_lshl_b32 s7, s6, 1
    v_xor_b32 v1, s7, v12
    v_lshlrev_b32 v1, 4, v1
    v_lshl_add_u32 v1, v2, 8, v1
    v_add_u32 v20, 114688, v1
    v_xor_b32 v21, 0x80, v20
    v_xor_b32 v22, 16, v20
    v_xor_b32 v23, 0x90, v20
    v_bfe_u32 v1, v2, 2, 2
    v_bfe_u32 v3, v2, 1, 1
    v_lshl_add_u32 v3, v14, 1, v3
    v_bfe_u32 v7, v2, 3, 1
    v_xor_b32 v3, v3, v7
    v_lshlrev_b32 v3, 4, v3
    v_lshl_add_u32 v3, v1, 7, v3
    v_and_b32 v1, 1, v2
    v_lshl_add_u32 v3, v1, 3, v3
    s_add_u32 s7, s101, 131072
    v_add_u32 v24, s7, v3
    v_xor_b32 v25, 32, v24
    v_xor_b32 v26, 64, v24
    v_xor_b32 v27, 0x60, v24
    s_lshl_b32 s7, s4, 8
    s_add_u32 s7, s7, s74
    v_lshlrev_b32 v28, 2, v2
    v_add_u32 v28, s7, v28
    s_waitcnt vmcnt(6)
    s_barrier
    s_add_u32 m0, s101, 49152
    s_nop 0
    buffer_load_dwordx4 v4, s[8:11], s73 offen lds
    buffer_load_dwordx4 v4, s[8:11], s73 offen offset:1024 lds
    buffer_load_dwordx4 v4, s[8:11], s73 offen offset:2048 lds
    buffer_load_dwordx4 v4, s[8:11], s73 offen offset:3072 lds
    s_add_u32 m0, s100, 65536
    s_add_u32 s73, s73, 16384
    buffer_load_dwordx4 v5, s[12:15], s72 offen lds
    buffer_load_dwordx4 v6, s[12:15], s72 offen offset:1024 lds
    s_add_u32 m0, s101, 73728
    s_nop 0
    buffer_load_dwordx4 v4, s[8:11], s73 offen lds
    buffer_load_dwordx4 v4, s[8:11], s73 offen offset:1024 lds
    buffer_load_dwordx4 v4, s[8:11], s73 offen offset:2048 lds
    buffer_load_dwordx4 v4, s[8:11], s73 offen offset:3072 lds
    s_add_u32 m0, s100, 90112
    s_add_u32 s73, s73, 16384
    buffer_load_dwordx4 v5, s[16:19], s72 offen lds
    buffer_load_dwordx4 v6, s[16:19], s72 offen offset:1024 lds
    s_add_u32 s72, s72, 128
    s_and_b32 s72, s72, 2047
    s_lshl_b32 s73, s72, 8
    s_waitcnt vmcnt(12)
    s_barrier
    s_add_u32 m0, s101, 0
    s_nop 0
    buffer_load_dwordx4 v4, s[8:11], s73 offen lds
    buffer_load_dwordx4 v4, s[8:11], s73 offen offset:1024 lds
    buffer_load_dwordx4 v4, s[8:11], s73 offen offset:2048 lds
    buffer_load_dwordx4 v4, s[8:11], s73 offen offset:3072 lds
    s_add_u32 m0, s100, 16384
    s_add_u32 s73, s73, 16384
    buffer_load_dwordx4 v5, s[12:15], s72 offen lds
    buffer_load_dwordx4 v6, s[12:15], s72 offen offset:1024 lds
    s_waitcnt vmcnt(12)
    s_barrier
    s_add_u32 m0, s101, 24576
    s_nop 0
    buffer_load_dwordx4 v4, s[8:11], s73 offen lds
    buffer_load_dwordx4 v4, s[8:11], s73 offen offset:1024 lds
    buffer_load_dwordx4 v4, s[8:11], s73 offen offset:2048 lds
    buffer_load_dwordx4 v4, s[8:11], s73 offen offset:3072 lds
    s_add_u32 m0, s100, 40960
    s_add_u32 s73, s73, 16384
    buffer_load_dwordx4 v5, s[16:19], s72 offen lds
    buffer_load_dwordx4 v6, s[16:19], s72 offen offset:1024 lds
    s_add_u32 s72, s72, 128
    s_and_b32 s72, s72, 2047
    s_lshl_b32 s73, s72, 8
    s_waitcnt vmcnt(12)
    s_barrier
    s_add_u32 m0, s101, 49152
    s_nop 0
    buffer_load_dwordx4 v4, s[8:11], s73 offen lds
    buffer_load_dwordx4 v4, s[8:11], s73 offen offset:1024 lds
    buffer_load_dwordx4 v4, s[8:11], s73 offen offset:2048 lds
    buffer_load_dwordx4 v4, s[8:11], s73 offen offset:3072 lds
    s_add_u32 m0, s100, 65536
    s_add_u32 s73, s73, 16384
    buffer_load_dwordx4 v5, s[12:15], s72 offen lds
    buffer_load_dwordx4 v6, s[12:15], s72 offen offset:1024 lds
    s_waitcnt vmcnt(12)
    s_barrier
    s_add_u32 m0, s101, 73728
    s_nop 0
    buffer_load_dwordx4 v4, s[8:11], s73 offen lds
    buffer_load_dwordx4 v4, s[8:11], s73 offen offset:1024 lds
    buffer_load_dwordx4 v4, s[8:11], s73 offen offset:2048 lds
    buffer_load_dwordx4 v4, s[8:11], s73 offen offset:3072 lds
    s_add_u32 m0, s100, 90112
    s_add_u32 s73, s73, 16384
    buffer_load_dwordx4 v5, s[16:19], s72 offen lds
    buffer_load_dwordx4 v6, s[16:19], s72 offen offset:1024 lds
    s_add_u32 s72, s72, 128
    s_and_b32 s72, s72, 2047
    s_lshl_b32 s73, s72, 8
    s_add_u32 m0, s101, 114688
    s_nop 0
    buffer_load_dwordx4 v16, s[28:31], 0 offen offset:0 lds
    buffer_load_dwordx4 v17, s[28:31], 0 offen offset:1024 lds
    buffer_load_dwordx4 v18, s[28:31], 0 offen offset:2048 lds
    buffer_load_dwordx4 v19, s[28:31], 0 offen offset:3072 lds
    s_add_u32 m0, s101, 98304
    s_nop 0
    buffer_load_dwordx4 v8, s[20:23], 0 offen offset:0 lds
    buffer_load_dwordx4 v9, s[20:23], 0 offen offset:1024 lds
    buffer_load_dwordx4 v10, s[20:23], 0 offen offset:2048 lds
    buffer_load_dwordx4 v11, s[20:23], 0 offen offset:3072 lds
    s_add_u32 m0, s101, 131072
    s_nop 0
    buffer_load_dwordx4 v8, s[24:27], 0 offen offset:0 lds
    buffer_load_dwordx4 v9, s[24:27], 0 offen offset:1024 lds
    buffer_load_dwordx4 v10, s[24:27], 0 offen offset:2048 lds
    buffer_load_dwordx4 v11, s[24:27], 0 offen offset:3072 lds
    s_waitcnt vmcnt(24)
    s_barrier
    s_add_u32 m0, s101, 0
    s_nop 0
    buffer_load_dwordx4 v4, s[8:11], s73 offen lds
    buffer_load_dwordx4 v4, s[8:11], s73 offen offset:1024 lds
    buffer_load_dwordx4 v4, s[8:11], s73 offen offset:2048 lds
    buffer_load_dwordx4 v4, s[8:11], s73 offen offset:3072 lds
    s_add_u32 m0, s100, 16384
    s_add_u32 s73, s73, 16384
    buffer_load_dwordx4 v5, s[12:15], s72 offen lds
    buffer_load_dwordx4 v6, s[12:15], s72 offen offset:1024 lds
    s_waitcnt vmcnt(24)
    s_barrier
    s_add_u32 m0, s101, 24576
    s_nop 0
    buffer_load_dwordx4 v4, s[8:11], s73 offen lds
    buffer_load_dwordx4 v4, s[8:11], s73 offen offset:1024 lds
    buffer_load_dwordx4 v4, s[8:11], s73 offen offset:2048 lds
    buffer_load_dwordx4 v4, s[8:11], s73 offen offset:3072 lds
    s_add_u32 m0, s100, 40960
    s_add_u32 s73, s73, 16384
    buffer_load_dwordx4 v5, s[16:19], s72 offen lds
    buffer_load_dwordx4 v6, s[16:19], s72 offen offset:1024 lds
    s_add_u32 s72, s72, 128
    s_and_b32 s72, s72, 2047
    s_lshl_b32 s73, s72, 8
    s_waitcnt vmcnt(24)
    s_barrier
    s_add_u32 m0, s101, 49152
    s_nop 0
    buffer_load_dwordx4 v4, s[8:11], s73 offen lds
    buffer_load_dwordx4 v4, s[8:11], s73 offen offset:1024 lds
    buffer_load_dwordx4 v4, s[8:11], s73 offen offset:2048 lds
    buffer_load_dwordx4 v4, s[8:11], s73 offen offset:3072 lds
    s_add_u32 m0, s100, 65536
    s_add_u32 s73, s73, 16384
    buffer_load_dwordx4 v5, s[12:15], s72 offen lds
    buffer_load_dwordx4 v6, s[12:15], s72 offen offset:1024 lds
    s_waitcnt vmcnt(12)
    s_barrier
    ds_read_b128 v[32:35], v20
    ds_read_b64_tr_b16 v[36:37], v24 offset:0
    ds_read_b64_tr_b16 v[38:39], v25 offset:512
    s_add_u32 m0, s101, 73728
    s_nop 0
    buffer_load_dwordx4 v4, s[8:11], s73 offen lds
    s_waitcnt lgkmcnt(0)
    v_lshlrev_b32 v40, 16, v32
    v_lshlrev_b32 v48, 16, v36
    v_mul_f32 v48, v48, v40
    v_and_b32 v40, 0xffff0000, v32
    buffer_load_dwordx4 v4, s[8:11], s73 offen offset:1024 lds
    v_and_b32 v49, 0xffff0000, v36
    v_mul_f32 v49, v49, v40
    v_lshlrev_b32 v40, 16, v33
    v_lshlrev_b32 v50, 16, v37
    v_mul_f32 v50, v50, v40
    buffer_load_dwordx4 v4, s[8:11], s73 offen offset:2048 lds
    v_and_b32 v40, 0xffff0000, v33
    v_and_b32 v51, 0xffff0000, v37
    v_mul_f32 v51, v51, v40
    v_lshlrev_b32 v40, 16, v34
    v_lshlrev_b32 v52, 16, v38
    buffer_load_dwordx4 v4, s[8:11], s73 offen offset:3072 lds
    v_mul_f32 v52, v52, v40
    v_and_b32 v40, 0xffff0000, v34
    v_and_b32 v53, 0xffff0000, v38
    v_mul_f32 v53, v53, v40
    v_lshlrev_b32 v40, 16, v35
    s_add_u32 m0, s100, 90112
    s_add_u32 s73, s73, 16384
    buffer_load_dwordx4 v5, s[16:19], s72 offen lds
    v_lshlrev_b32 v54, 16, v39
    v_mul_f32 v54, v54, v40
    v_and_b32 v40, 0xffff0000, v35
    v_and_b32 v55, 0xffff0000, v39
    v_mul_f32 v55, v55, v40
    buffer_load_dwordx4 v6, s[16:19], s72 offen offset:1024 lds
    s_add_u32 s72, s72, 128
    s_and_b32 s72, s72, 2047
    s_lshl_b32 s73, s72, 8
    s_mov_b32 s7, 0
    buffer_store_dword v48, v28, s[68:71], s7 offen
    s_mov_b32 s7, 8192
    buffer_store_dword v49, v28, s[68:71], s7 offen
    s_mov_b32 s7, 16384
    buffer_store_dword v50, v28, s[68:71], s7 offen
    s_mov_b32 s7, 24576
    buffer_store_dword v51, v28, s[68:71], s7 offen
    s_mov_b32 s7, 32768
    buffer_store_dword v52, v28, s[68:71], s7 offen
    s_mov_b32 s7, 40960
    buffer_store_dword v53, v28, s[68:71], s7 offen
    s_mov_b32 s7, 49152
    buffer_store_dword v54, v28, s[68:71], s7 offen
    s_mov_b32 s7, 57344
    buffer_store_dword v55, v28, s[68:71], s7 offen
    s_waitcnt vmcnt(20)
    s_barrier
    ds_read_b128 v[32:35], v21
    ds_read_b64_tr_b16 v[36:37], v26 offset:1024
    ds_read_b64_tr_b16 v[38:39], v27 offset:1536
    s_add_u32 m0, s101, 0
    s_nop 0
    buffer_load_dwordx4 v4, s[8:11], s73 offen lds
    s_waitcnt lgkmcnt(0)
    v_lshlrev_b32 v40, 16, v32
    v_lshlrev_b32 v56, 16, v36
    v_mul_f32 v56, v56, v40
    v_and_b32 v40, 0xffff0000, v32
    buffer_load_dwordx4 v4, s[8:11], s73 offen offset:1024 lds
    v_and_b32 v57, 0xffff0000, v36
    v_mul_f32 v57, v57, v40
    v_lshlrev_b32 v40, 16, v33
    v_lshlrev_b32 v58, 16, v37
    v_mul_f32 v58, v58, v40
    buffer_load_dwordx4 v4, s[8:11], s73 offen offset:2048 lds
    v_and_b32 v40, 0xffff0000, v33
    v_and_b32 v59, 0xffff0000, v37
    v_mul_f32 v59, v59, v40
    v_lshlrev_b32 v40, 16, v34
    v_lshlrev_b32 v60, 16, v38
    buffer_load_dwordx4 v4, s[8:11], s73 offen offset:3072 lds
    v_mul_f32 v60, v60, v40
    v_and_b32 v40, 0xffff0000, v34
    v_and_b32 v61, 0xffff0000, v38
    v_mul_f32 v61, v61, v40
    v_lshlrev_b32 v40, 16, v35
    s_add_u32 m0, s100, 16384
    s_add_u32 s73, s73, 16384
    buffer_load_dwordx4 v5, s[12:15], s72 offen lds
    v_lshlrev_b32 v62, 16, v39
    v_mul_f32 v62, v62, v40
    v_and_b32 v40, 0xffff0000, v35
    v_and_b32 v63, 0xffff0000, v39
    v_mul_f32 v63, v63, v40
    buffer_load_dwordx4 v6, s[12:15], s72 offen offset:1024 lds
    s_mov_b32 s7, 65536
    buffer_store_dword v56, v28, s[68:71], s7 offen
    s_mov_b32 s7, 73728
    buffer_store_dword v57, v28, s[68:71], s7 offen
    s_mov_b32 s7, 81920
    buffer_store_dword v58, v28, s[68:71], s7 offen
    s_mov_b32 s7, 90112
    buffer_store_dword v59, v28, s[68:71], s7 offen
    s_mov_b32 s7, 98304
    buffer_store_dword v60, v28, s[68:71], s7 offen
    s_mov_b32 s7, 106496
    buffer_store_dword v61, v28, s[68:71], s7 offen
    s_mov_b32 s7, 114688
    buffer_store_dword v62, v28, s[68:71], s7 offen
    s_mov_b32 s7, 122880
    buffer_store_dword v63, v28, s[68:71], s7 offen
    s_waitcnt vmcnt(28)
    s_barrier
    ds_read_b128 v[32:35], v22
    ds_read_b64_tr_b16 v[36:37], v24 offset:2048
    ds_read_b64_tr_b16 v[38:39], v25 offset:2560
    s_add_u32 m0, s101, 24576
    s_nop 0
    buffer_load_dwordx4 v4, s[8:11], s73 offen lds
    s_waitcnt lgkmcnt(0)
    v_lshlrev_b32 v40, 16, v32
    v_lshlrev_b32 v48, 16, v36
    v_mul_f32 v48, v48, v40
    v_and_b32 v40, 0xffff0000, v32
    buffer_load_dwordx4 v4, s[8:11], s73 offen offset:1024 lds
    v_and_b32 v49, 0xffff0000, v36
    v_mul_f32 v49, v49, v40
    v_lshlrev_b32 v40, 16, v33
    v_lshlrev_b32 v50, 16, v37
    v_mul_f32 v50, v50, v40
    buffer_load_dwordx4 v4, s[8:11], s73 offen offset:2048 lds
    v_and_b32 v40, 0xffff0000, v33
    v_and_b32 v51, 0xffff0000, v37
    v_mul_f32 v51, v51, v40
    v_lshlrev_b32 v40, 16, v34
    v_lshlrev_b32 v52, 16, v38
    buffer_load_dwordx4 v4, s[8:11], s73 offen offset:3072 lds
    v_mul_f32 v52, v52, v40
    v_and_b32 v40, 0xffff0000, v34
    v_and_b32 v53, 0xffff0000, v38
    v_mul_f32 v53, v53, v40
    v_lshlrev_b32 v40, 16, v35
    s_add_u32 m0, s100, 40960
    s_add_u32 s73, s73, 16384
    buffer_load_dwordx4 v5, s[16:19], s72 offen lds
    v_lshlrev_b32 v54, 16, v39
    v_mul_f32 v54, v54, v40
    v_and_b32 v40, 0xffff0000, v35
    v_and_b32 v55, 0xffff0000, v39
    v_mul_f32 v55, v55, v40
    buffer_load_dwordx4 v6, s[16:19], s72 offen offset:1024 lds
    s_add_u32 s72, s72, 128
    s_and_b32 s72, s72, 2047
    s_lshl_b32 s73, s72, 8
    s_mov_b32 s7, 131072
    buffer_store_dword v48, v28, s[68:71], s7 offen
    s_mov_b32 s7, 139264
    buffer_store_dword v49, v28, s[68:71], s7 offen
    s_mov_b32 s7, 147456
    buffer_store_dword v50, v28, s[68:71], s7 offen
    s_mov_b32 s7, 155648
    buffer_store_dword v51, v28, s[68:71], s7 offen
    s_mov_b32 s7, 163840
    buffer_store_dword v52, v28, s[68:71], s7 offen
    s_mov_b32 s7, 172032
    buffer_store_dword v53, v28, s[68:71], s7 offen
    s_mov_b32 s7, 180224
    buffer_store_dword v54, v28, s[68:71], s7 offen
    s_mov_b32 s7, 188416
    buffer_store_dword v55, v28, s[68:71], s7 offen
    s_waitcnt vmcnt(36)
    s_barrier
    ds_read_b128 v[32:35], v23
    ds_read_b64_tr_b16 v[36:37], v26 offset:3072
    ds_read_b64_tr_b16 v[38:39], v27 offset:3584
    s_add_u32 m0, s101, 49152
    s_nop 0
    buffer_load_dwordx4 v4, s[8:11], s73 offen lds
    s_waitcnt lgkmcnt(0)
    v_lshlrev_b32 v40, 16, v32
    v_lshlrev_b32 v56, 16, v36
    v_mul_f32 v56, v56, v40
    v_and_b32 v40, 0xffff0000, v32
    buffer_load_dwordx4 v4, s[8:11], s73 offen offset:1024 lds
    v_and_b32 v57, 0xffff0000, v36
    v_mul_f32 v57, v57, v40
    v_lshlrev_b32 v40, 16, v33
    v_lshlrev_b32 v58, 16, v37
    v_mul_f32 v58, v58, v40
    buffer_load_dwordx4 v4, s[8:11], s73 offen offset:2048 lds
    v_and_b32 v40, 0xffff0000, v33
    v_and_b32 v59, 0xffff0000, v37
    v_mul_f32 v59, v59, v40
    v_lshlrev_b32 v40, 16, v34
    v_lshlrev_b32 v60, 16, v38
    buffer_load_dwordx4 v4, s[8:11], s73 offen offset:3072 lds
    v_mul_f32 v60, v60, v40
    v_and_b32 v40, 0xffff0000, v34
    v_and_b32 v61, 0xffff0000, v38
    v_mul_f32 v61, v61, v40
    v_lshlrev_b32 v40, 16, v35
    s_add_u32 m0, s100, 65536
    s_add_u32 s73, s73, 16384
    buffer_load_dwordx4 v5, s[12:15], s72 offen lds
    v_lshlrev_b32 v62, 16, v39
    v_mul_f32 v62, v62, v40
    v_and_b32 v40, 0xffff0000, v35
    v_and_b32 v63, 0xffff0000, v39
    v_mul_f32 v63, v63, v40
    buffer_load_dwordx4 v6, s[12:15], s72 offen offset:1024 lds
    s_mov_b32 s7, 196608
    buffer_store_dword v56, v28, s[68:71], s7 offen
    s_mov_b32 s7, 204800
    buffer_store_dword v57, v28, s[68:71], s7 offen
    s_mov_b32 s7, 212992
    buffer_store_dword v58, v28, s[68:71], s7 offen
    s_mov_b32 s7, 221184
    buffer_store_dword v59, v28, s[68:71], s7 offen
    s_mov_b32 s7, 229376
    buffer_store_dword v60, v28, s[68:71], s7 offen
    s_mov_b32 s7, 237568
    buffer_store_dword v61, v28, s[68:71], s7 offen
    s_mov_b32 s7, 245760
    buffer_store_dword v62, v28, s[68:71], s7 offen
    s_mov_b32 s7, 253952
    buffer_store_dword v63, v28, s[68:71], s7 offen
    s_waitcnt vmcnt(36)
    s_barrier
    s_add_u32 m0, s101, 73728
    s_nop 0
    buffer_load_dwordx4 v4, s[8:11], s73 offen lds
    buffer_load_dwordx4 v4, s[8:11], s73 offen offset:1024 lds
    buffer_load_dwordx4 v4, s[8:11], s73 offen offset:2048 lds
    buffer_load_dwordx4 v4, s[8:11], s73 offen offset:3072 lds
    s_add_u32 m0, s100, 90112
    s_add_u32 s73, s73, 16384
    buffer_load_dwordx4 v5, s[16:19], s72 offen lds
    buffer_load_dwordx4 v6, s[16:19], s72 offen offset:1024 lds
    s_add_u32 s72, s72, 128
    s_and_b32 s72, s72, 2047
    s_lshl_b32 s73, s72, 8
    s_waitcnt vmcnt(28)
    s_barrier
    s_mov_b32 s77, 0
K2L_loop:
    s_add_u32 m0, s101, 0
    s_nop 0
    buffer_load_dwordx4 v4, s[8:11], s73 offen lds
    buffer_load_dwordx4 v4, s[8:11], s73 offen offset:1024 lds
    buffer_load_dwordx4 v4, s[8:11], s73 offen offset:2048 lds
    buffer_load_dwordx4 v4, s[8:11], s73 offen offset:3072 lds
    s_add_u32 m0, s100, 16384
    s_add_u32 s73, s73, 16384
    buffer_load_dwordx4 v5, s[12:15], s72 offen lds
    buffer_load_dwordx4 v6, s[12:15], s72 offen offset:1024 lds
    s_waitcnt vmcnt(12)
    s_barrier
    s_add_u32 m0, s101, 24576
    s_nop 0
    buffer_load_dwordx4 v4, s[8:11], s73 offen lds
    buffer_load_dwordx4 v4, s[8:11], s73 offen offset:1024 lds
    buffer_load_dwordx4 v4, s[8:11], s73 offen offset:2048 lds
    buffer_load_dwordx4 v4, s[8:11], s73 offen offset:3072 lds
    s_add_u32 m0, s100, 40960
    s_add_u32 s73, s73, 16384
    buffer_load_dwordx4 v5, s[16:19], s72 offen lds
    buffer_load_dwordx4 v6, s[16:19], s72 offen offset:1024 lds
    s_add_u32 s72, s72, 128
    s_and_b32 s72, s72, 2047
    s_lshl_b32 s73, s72, 8
    s_waitcnt vmcnt(12)
    s_barrier
    s_add_u32 m0, s101, 49152
    s_nop 0
    buffer_load_dwordx4 v4, s[8:11], s73 offen lds
    buffer_load_dwordx4 v4, s[8:11], s73 offen offset:1024 lds
    buffer_load_dwordx4 v4, s[8:11], s73 offen offset:2048 lds
    buffer_load_dwordx4 v4, s[8:11], s73 offen offset:3072 lds
    s_add_u32 m0, s100, 65536
    s_add_u32 s73, s73, 16384
    buffer_load_dwordx4 v5, s[12:15], s72 offen lds
    buffer_load_dwordx4 v6, s[12:15], s72 offen offset:1024 lds
    s_waitcnt vmcnt(12)
    s_barrier
    s_add_u32 m0, s101, 73728
    s_nop 0
    buffer_load_dwordx4 v4, s[8:11], s73 offen lds
    buffer_load_dwordx4 v4, s[8:11], s73 offen offset:1024 lds
    buffer_load_dwordx4 v4, s[8:11], s73 offen offset:2048 lds
    buffer_load_dwordx4 v4, s[8:11], s73 offen offset:3072 lds
    s_add_u32 m0, s100, 90112
    s_add_u32 s73, s73, 16384
    buffer_load_dwordx4 v5, s[16:19], s72 offen lds
    buffer_load_dwordx4 v6, s[16:19], s72 offen offset:1024 lds
    s_add_u32 s72, s72, 128
    s_and_b32 s72, s72, 2047
    s_lshl_b32 s73, s72, 8
    s_waitcnt vmcnt(12)
    s_barrier
    s_add_u32 s77, s77, 1
    s_cmp_lt_u32 s77, 4
    s_cbranch_scc1 K2L_loop
    s_waitcnt vmcnt(6)
    s_barrier
    s_waitcnt vmcnt(0)
    s_barrier
    s_endpgm
K2_compute:
    v_and_b32 v12, 15, v2
    v_lshrrev_b32 v13, 4, v2
    s_lshl_b32 s6, s4, 7
    v_lshlrev_b32 v1, 1, v12
    v_add_u32 v1, s6, v1
    s_waitcnt lgkmcnt(0)
    s_mov_b32 s12, s60
    s_mov_b32 s13, s61
    s_mov_b32 s14, 2048
    s_mov_b32 s15, 0x00020000
    buffer_load_ushort v20, v1, s[12:15], 0 offen offset:0
    buffer_load_ushort v21, v1, s[12:15], 0 offen offset:32
    buffer_load_ushort v22, v1, s[12:15], 0 offen offset:64
    buffer_load_ushort v23, v1, s[12:15], 0 offen offset:96
    s_mov_b32 s8, s62
    s_mov_b32 s9, s63
    s_mov_b32 s10, 16777216
    s_mov_b32 s11, 0x00020000
    v_bfe_u32 v1, v2, 1, 1
    v_bfe_u32 v3, v2, 2, 2
    v_lshl_add_u32 v3, v13, 3, v3
    v_lshl_add_u32 v3, v1, 2, v3
    v_lshlrev_b32 v3, 4, v3
    v_lshl_add_u32 v3, v1, 10, v3
    v_and_b32 v1, 1, v2
    v_lshl_add_u32 v3, v1, 3, v3
    s_lshl_b32 s6, s5, 12
    v_add_u32 v4, s6, v3
    v_xor_b32 v6, 64, v4
    v_add_u32 v5, 49152, v4
    v_add_u32 v7, 49152, v6
    v_lshrrev_b32 v3, 1, v12
    v_xor_b32 v3, v3, v13
    v_lshlrev_b32 v3, 4, v3
    v_lshl_add_u32 v3, v12, 7, v3
    v_add_u32 v8, 16384, v3
    v_xor_b32 v10, 64, v8
    v_add_u32 v9, 49152, v8
    v_add_u32 v11, 49152, v10
    s_add_u32 s6, s6, 98304
    v_add_u32 v14, s6, v3
    v_xor_b32 v15, 64, v14
    s_lshl_b32 s6, s3, 2
    s_add_u32 s6, s6, s5
    s_lshl_b32 s6, s6, 18
    s_lshl_b32 s7, s4, 8
    s_add_u32 s6, s6, s7
    s_add_u32 s6, s6, 4096
    v_lshlrev_b32 v16, 15, v13
    v_lshl_add_u32 v16, v12, 2, v16
    v_add_u32 v16, s6, v16
    v_lshlrev_b32 v17, 3, v13
    v_sub_u32 v17, v12, v17
    v_and_b32 v18, 1, v12
    v_lshlrev_b32 v18, 4, v18
    v_mov_b32 v32, 0
    v_mov_b32 v33, 0
    v_mov_b32 v34, 0
    v_mov_b32 v35, 0
    v_mov_b32 v36, 0
    v_mov_b32 v37, 0
    v_mov_b32 v38, 0
    v_mov_b32 v39, 0
    v_mov_b32 v40, 0
    v_mov_b32 v41, 0
    v_mov_b32 v42, 0
    v_mov_b32 v43, 0
    v_mov_b32 v44, 0
    v_mov_b32 v45, 0
    v_mov_b32 v46, 0
    v_mov_b32 v47, 0
    v_mov_b32 v48, 0
    v_mov_b32 v49, 0
    v_mov_b32 v50, 0
    v_mov_b32 v51, 0
    v_mov_b32 v52, 0
    v_mov_b32 v53, 0
    v_mov_b32 v54, 0
    v_mov_b32 v55, 0
    v_mov_b32 v56, 0
    v_mov_b32 v57, 0
    v_mov_b32 v58, 0
    v_mov_b32 v59, 0
    v_mov_b32 v60, 0
    v_mov_b32 v61, 0
    v_mov_b32 v62, 0
    v_mov_b32 v63, 0
    s_waitcnt vmcnt(0)
    v_lshlrev_b32 v20, v18, v20
    v_add_u32 v1, 0, v17
    v_lshrrev_b32 v1, 1, v1
    v_cmp_eq_u32 vcc, 0, v1
    s_nop 1
    v_cndmask_b32 v112, 0, v20, vcc
    v_cmp_eq_u32 vcc, 1, v1
    s_nop 1
    v_cndmask_b32 v113, 0, v20, vcc
    v_cmp_eq_u32 vcc, 2, v1
    s_nop 1
    v_cndmask_b32 v114, 0, v20, vcc
    v_cmp_eq_u32 vcc, 3, v1
    s_nop 1
    v_cndmask_b32 v115, 0, v20, vcc
    v_lshlrev_b32 v21, v18, v21
    v_add_u32 v1, 16, v17
    v_lshrrev_b32 v1, 1, v1
    v_cmp_eq_u32 vcc, 0, v1
    s_nop 1
    v_cndmask_b32 v116, 0, v21, vcc
    v_cmp_eq_u32 vcc, 1, v1
    s_nop 1
    v_cndmask_b32 v117, 0, v21, vcc
    v_cmp_eq_u32 vcc, 2, v1
    s_nop 1
    v_cndmask_b32 v118, 0, v21, vcc
    v_cmp_eq_u32 vcc, 3, v1
    s_nop 1
    v_cndmask_b32 v119, 0, v21, vcc
    v_lshlrev_b32 v22, v18, v22
    v_add_u32 v1, 0, v17
    v_lshrrev_b32 v1, 1, v1
    v_cmp_eq_u32 vcc, 0, v1
    s_nop 1
    v_cndmask_b32 v120, 0, v22, vcc
    v_cmp_eq_u32 vcc, 1, v1
    s_nop 1
    v_cndmask_b32 v121, 0, v22, vcc
    v_cmp_eq_u32 vcc, 2, v1
    s_nop 1
    v_cndmask_b32 v122, 0, v22, vcc
    v_cmp_eq_u32 vcc, 3, v1
    s_nop 1
    v_cndmask_b32 v123, 0, v22, vcc
    v_lshlrev_b32 v23, v18, v23
    v_add_u32 v1, 16, v17
    v_lshrrev_b32 v1, 1, v1
    v_cmp_eq_u32 vcc, 0, v1
    s_nop 1
    v_cndmask_b32 v124, 0, v23, vcc
    v_cmp_eq_u32 vcc, 1, v1
    s_nop 1
    v_cndmask_b32 v125, 0, v23, vcc
    v_cmp_eq_u32 vcc, 2, v1
    s_nop 1
    v_cndmask_b32 v126, 0, v23, vcc
    v_cmp_eq_u32 vcc, 3, v1
    s_nop 1
    v_cndmask_b32 v127, 0, v23, vcc
    s_barrier
    ds_read_b64_tr_b16 v[64:65], v4 offset:0
    ds_read_b64_tr_b16 v[66:67], v6 offset:0
    ds_read_b64_tr_b16 v[68:69], v4 offset:2048
    ds_read_b64_tr_b16 v[70:71], v6 offset:2048
    ds_read_b128 v[72:75], v8 offset:0
    ds_read_b128 v[76:79], v8 offset:2048
    ds_read_b128 v[80:83], v8 offset:4096
    ds_read_b128 v[84:87], v8 offset:6144
    s_mov_b32 s30, 0
K2C_loop:
    s_waitcnt lgkmcnt(0)
    v_mfma_f32_16x16x32_bf16 v[32:35], v[64:67], v[72:75], v[32:35]
    ds_read_b64_tr_b16 v[88:89], v4 offset:512
    v_mfma_f32_16x16x32_bf16 v[36:39], v[64:67], v[76:79], v[36:39]
    ds_read_b64_tr_b16 v[90:91], v6 offset:512
    v_mfma_f32_16x16x32_bf16 v[40:43], v[64:67], v[80:83], v[40:43]
    ds_read_b64_tr_b16 v[92:93], v4 offset:2560
    v_mfma_f32_16x16x32_bf16 v[44:47], v[64:67], v[84:87], v[44:47]
    ds_read_b64_tr_b16 v[94:95], v6 offset:2560
    v_mfma_f32_16x16x32_bf16 v[60:63], v[68:71], v[84:87], v[60:63]
    ds_read_b128 v[96:99], v10 offset:0
    v_mfma_f32_16x16x32_bf16 v[56:59], v[68:71], v[80:83], v[56:59]
    ds_read_b128 v[100:103], v10 offset:2048
    v_mfma_f32_16x16x32_bf16 v[52:55], v[68:71], v[76:79], v[52:55]
    ds_read_b128 v[104:107], v10 offset:4096
    v_mfma_f32_16x16x32_bf16 v[48:51], v[68:71], v[72:75], v[48:51]
    ds_read_b128 v[108:111], v10 offset:6144
    s_waitcnt lgkmcnt(0)
    s_barrier
    v_mfma_f32_16x16x32_bf16 v[32:35], v[88:91], v[96:99], v[32:35]
    ds_read_b64_tr_b16 v[64:65], v4 offset:24576
    v_mfma_f32_16x16x32_bf16 v[36:39], v[88:91], v[100:103], v[36:39]
    ds_read_b64_tr_b16 v[66:67], v6 offset:24576
    v_mfma_f32_16x16x32_bf16 v[40:43], v[88:91], v[104:107], v[40:43]
    ds_read_b64_tr_b16 v[68:69], v4 offset:26624
    v_mfma_f32_16x16x32_bf16 v[44:47], v[88:91], v[108:111], v[44:47]
    ds_read_b64_tr_b16 v[70:71], v6 offset:26624
    v_mfma_f32_16x16x32_bf16 v[60:63], v[92:95], v[108:111], v[60:63]
    ds_read_b128 v[72:75], v8 offset:24576
    v_mfma_f32_16x16x32_bf16 v[56:59], v[92:95], v[104:107], v[56:59]
    ds_read_b128 v[76:79], v8 offset:26624
    v_mfma_f32_16x16x32_bf16 v[52:55], v[92:95], v[100:103], v[52:55]
    ds_read_b128 v[80:83], v8 offset:28672
    v_mfma_f32_16x16x32_bf16 v[48:51], v[92:95], v[96:99], v[48:51]
    ds_read_b128 v[84:87], v8 offset:30720
    s_waitcnt lgkmcnt(0)
    v_mfma_f32_16x16x32_bf16 v[32:35], v[64:67], v[72:75], v[32:35]
    ds_read_b64_tr_b16 v[88:89], v4 offset:25088
    v_mfma_f32_16x16x32_bf16 v[36:39], v[64:67], v[76:79], v[36:39]
    ds_read_b64_tr_b16 v[90:91], v6 offset:25088
    v_mfma_f32_16x16x32_bf16 v[40:43], v[64:67], v[80:83], v[40:43]
    ds_read_b64_tr_b16 v[92:93], v4 offset:27136
    v_mfma_f32_16x16x32_bf16 v[44:47], v[64:67], v[84:87], v[44:47]
    ds_read_b64_tr_b16 v[94:95], v6 offset:27136
    v_mfma_f32_16x16x32_bf16 v[60:63], v[68:71], v[84:87], v[60:63]
    ds_read_b128 v[96:99], v10 offset:24576
    v_mfma_f32_16x16x32_bf16 v[56:59], v[68:71], v[80:83], v[56:59]
    ds_read_b128 v[100:103], v10 offset:26624
    v_mfma_f32_16x16x32_bf16 v[52:55], v[68:71], v[76:79], v[52:55]
    ds_read_b128 v[104:107], v10 offset:28672
    v_mfma_f32_16x16x32_bf16 v[48:51], v[68:71], v[72:75], v[48:51]
    ds_read_b128 v[108:111], v10 offset:30720
    s_waitcnt lgkmcnt(0)
    s_barrier
    v_mfma_f32_16x16x32_bf16 v[32:35], v[88:91], v[96:99], v[32:35]
    ds_read_b64_tr_b16 v[64:65], v5 offset:0
    v_mfma_f32_16x16x32_bf16 v[36:39], v[88:91], v[100:103], v[36:39]
    ds_read_b64_tr_b16 v[66:67], v7 offset:0
    v_mfma_f32_16x16x32_bf16 v[40:43], v[88:91], v[104:107], v[40:43]
    ds_read_b64_tr_b16 v[68:69], v5 offset:2048
    v_mfma_f32_16x16x32_bf16 v[44:47], v[88:91], v[108:111], v[44:47]
    ds_read_b64_tr_b16 v[70:71], v7 offset:2048
    v_mfma_f32_16x16x32_bf16 v[60:63], v[92:95], v[108:111], v[60:63]
    ds_read_b128 v[72:75], v9 offset:0
    v_mfma_f32_16x16x32_bf16 v[56:59], v[92:95], v[104:107], v[56:59]
    ds_read_b128 v[76:79], v9 offset:2048
    v_mfma_f32_16x16x32_bf16 v[52:55], v[92:95], v[100:103], v[52:55]
    ds_read_b128 v[80:83], v9 offset:4096
    v_mfma_f32_16x16x32_bf16 v[48:51], v[92:95], v[96:99], v[48:51]
    ds_read_b128 v[84:87], v9 offset:6144
    s_waitcnt lgkmcnt(0)
    v_mfma_f32_16x16x32_bf16 v[32:35], v[64:67], v[72:75], v[32:35]
    ds_read_b64_tr_b16 v[88:89], v5 offset:512
    v_mfma_f32_16x16x32_bf16 v[36:39], v[64:67], v[76:79], v[36:39]
    ds_read_b64_tr_b16 v[90:91], v7 offset:512
    v_mfma_f32_16x16x32_bf16 v[40:43], v[64:67], v[80:83], v[40:43]
    ds_read_b64_tr_b16 v[92:93], v5 offset:2560
    v_mfma_f32_16x16x32_bf16 v[44:47], v[64:67], v[84:87], v[44:47]
    ds_read_b64_tr_b16 v[94:95], v7 offset:2560
    v_mfma_f32_16x16x32_bf16 v[60:63], v[68:71], v[84:87], v[60:63]
    ds_read_b128 v[96:99], v11 offset:0
    v_mfma_f32_16x16x32_bf16 v[56:59], v[68:71], v[80:83], v[56:59]
    ds_read_b128 v[100:103], v11 offset:2048
    v_mfma_f32_16x16x32_bf16 v[52:55], v[68:71], v[76:79], v[52:55]
    ds_read_b128 v[104:107], v11 offset:4096
    v_mfma_f32_16x16x32_bf16 v[48:51], v[68:71], v[72:75], v[48:51]
    ds_read_b128 v[108:111], v11 offset:6144
    s_waitcnt lgkmcnt(0)
    s_barrier
    v_mfma_f32_16x16x32_bf16 v[32:35], v[88:91], v[96:99], v[32:35]
    ds_read_b64_tr_b16 v[64:65], v5 offset:24576
    v_mfma_f32_16x16x32_bf16 v[36:39], v[88:91], v[100:103], v[36:39]
    ds_read_b64_tr_b16 v[66:67], v7 offset:24576
    v_mfma_f32_16x16x32_bf16 v[40:43], v[88:91], v[104:107], v[40:43]
    ds_read_b64_tr_b16 v[68:69], v5 offset:26624
    v_mfma_f32_16x16x32_bf16 v[44:47], v[88:91], v[108:111], v[44:47]
    ds_read_b64_tr_b16 v[70:71], v7 offset:26624
    v_mfma_f32_16x16x32_bf16 v[60:63], v[92:95], v[108:111], v[60:63]
    ds_read_b128 v[72:75], v9 offset:24576
    v_mfma_f32_16x16x32_bf16 v[56:59], v[92:95], v[104:107], v[56:59]
    ds_read_b128 v[76:79], v9 offset:26624
    v_mfma_f32_16x16x32_bf16 v[52:55], v[92:95], v[100:103], v[52:55]
    ds_read_b128 v[80:83], v9 offset:28672
    v_mfma_f32_16x16x32_bf16 v[48:51], v[92:95], v[96:99], v[48:51]
    ds_read_b128 v[84:87], v9 offset:30720
    s_waitcnt lgkmcnt(0)
    v_mfma_f32_16x16x32_bf16 v[32:35], v[64:67], v[72:75], v[32:35]
    ds_read_b64_tr_b16 v[88:89], v5 offset:25088
    v_mfma_f32_16x16x32_bf16 v[36:39], v[64:67], v[76:79], v[36:39]
    ds_read_b64_tr_b16 v[90:91], v7 offset:25088
    v_mfma_f32_16x16x32_bf16 v[40:43], v[64:67], v[80:83], v[40:43]
    ds_read_b64_tr_b16 v[92:93], v5 offset:27136
    v_mfma_f32_16x16x32_bf16 v[44:47], v[64:67], v[84:87], v[44:47]
    ds_read_b64_tr_b16 v[94:95], v7 offset:27136
    v_mfma_f32_16x16x32_bf16 v[60:63], v[68:71], v[84:87], v[60:63]
    ds_read_b128 v[96:99], v11 offset:24576
    v_mfma_f32_16x16x32_bf16 v[56:59], v[68:71], v[80:83], v[56:59]
    ds_read_b128 v[100:103], v11 offset:26624
    v_mfma_f32_16x16x32_bf16 v[52:55], v[68:71], v[76:79], v[52:55]
    ds_read_b128 v[104:107], v11 offset:28672
    v_mfma_f32_16x16x32_bf16 v[48:51], v[68:71], v[72:75], v[48:51]
    ds_read_b128 v[108:111], v11 offset:30720
    s_waitcnt lgkmcnt(0)
    s_barrier
    v_mfma_f32_16x16x32_bf16 v[32:35], v[88:91], v[96:99], v[32:35]
    ds_read_b64_tr_b16 v[64:65], v4 offset:0
    v_mfma_f32_16x16x32_bf16 v[36:39], v[88:91], v[100:103], v[36:39]
    ds_read_b64_tr_b16 v[66:67], v6 offset:0
    v_mfma_f32_16x16x32_bf16 v[40:43], v[88:91], v[104:107], v[40:43]
    ds_read_b64_tr_b16 v[68:69], v4 offset:2048
    v_mfma_f32_16x16x32_bf16 v[44:47], v[88:91], v[108:111], v[44:47]
    ds_read_b64_tr_b16 v[70:71], v6 offset:2048
    v_mfma_f32_16x16x32_bf16 v[60:63], v[92:95], v[108:111], v[60:63]
    ds_read_b128 v[72:75], v8 offset:0
    v_mfma_f32_16x16x32_bf16 v[56:59], v[92:95], v[104:107], v[56:59]
    ds_read_b128 v[76:79], v8 offset:2048
    v_mfma_f32_16x16x32_bf16 v[52:55], v[92:95], v[100:103], v[52:55]
    ds_read_b128 v[80:83], v8 offset:4096
    v_mfma_f32_16x16x32_bf16 v[48:51], v[92:95], v[96:99], v[48:51]
    ds_read_b128 v[84:87], v8 offset:6144
    s_cmp_eq_u32 s30, 2
    s_cbranch_scc0 K2C_nox
    ds_read_b128 v[128:131], v14 offset:0
    ds_read_b128 v[132:135], v15 offset:0
    ds_read_b128 v[136:139], v14 offset:2048
    ds_read_b128 v[140:143], v15 offset:2048
    s_waitcnt lgkmcnt(0)
    v_mfma_f32_16x16x32_bf16 v[32:35], v[128:131], v[112:115], v[32:35]
    v_mfma_f32_16x16x32_bf16 v[36:39], v[128:131], v[116:119], v[36:39]
    v_mfma_f32_16x16x32_bf16 v[40:43], v[132:135], v[120:123], v[40:43]
    v_mfma_f32_16x16x32_bf16 v[44:47], v[132:135], v[124:127], v[44:47]
    v_mfma_f32_16x16x32_bf16 v[48:51], v[136:139], v[112:115], v[48:51]
    v_mfma_f32_16x16x32_bf16 v[52:55], v[136:139], v[116:119], v[52:55]
    v_mfma_f32_16x16x32_bf16 v[56:59], v[140:143], v[120:123], v[56:59]
    v_mfma_f32_16x16x32_bf16 v[60:63], v[140:143], v[124:127], v[60:63]
K2C_nox:
    s_add_u32 s30, s30, 1
    s_cmp_lt_u32 s30, 8
    s_cbranch_scc1 K2C_loop
    s_nop 4
    s_mov_b32 s6, 0
    buffer_store_dword v32, v16, s[8:11], s6 offen offset:0
    buffer_store_dword v36, v16, s[8:11], s6 offen offset:64
    buffer_store_dword v40, v16, s[8:11], s6 offen offset:128
    buffer_store_dword v44, v16, s[8:11], s6 offen offset:192
    s_mov_b32 s6, 8192
    buffer_store_dword v33, v16, s[8:11], s6 offen offset:0
    buffer_store_dword v37, v16, s[8:11], s6 offen offset:64
    buffer_store_dword v41, v16, s[8:11], s6 offen offset:128
    buffer_store_dword v45, v16, s[8:11], s6 offen offset:192
    s_mov_b32 s6, 16384
    buffer_store_dword v34, v16, s[8:11], s6 offen offset:0
    buffer_store_dword v38, v16, s[8:11], s6 offen offset:64
    buffer_store_dword v42, v16, s[8:11], s6 offen offset:128
    buffer_store_dword v46, v16, s[8:11], s6 offen offset:192
    s_mov_b32 s6, 24576
    buffer_store_dword v35, v16, s[8:11], s6 offen offset:0
    buffer_store_dword v39, v16, s[8:11], s6 offen offset:64
    buffer_store_dword v43, v16, s[8:11], s6 offen offset:128
    buffer_store_dword v47, v16, s[8:11], s6 offen offset:192
    s_mov_b32 s6, 131072
    buffer_store_dword v48, v16, s[8:11], s6 offen offset:0
    buffer_store_dword v52, v16, s[8:11], s6 offen offset:64
    buffer_store_dword v56, v16, s[8:11], s6 offen offset:128
    buffer_store_dword v60, v16, s[8:11], s6 offen offset:192
    s_mov_b32 s6, 139264
    buffer_store_dword v49, v16, s[8:11], s6 offen offset:0
    buffer_store_dword v53, v16, s[8:11], s6 offen offset:64
    buffer_store_dword v57, v16, s[8:11], s6 offen offset:128
    buffer_store_dword v61, v16, s[8:11], s6 offen offset:192
    s_mov_b32 s6, 147456
    buffer_store_dword v50, v16, s[8:11], s6 offen offset:0
    buffer_store_dword v54, v16, s[8:11], s6 offen offset:64
    buffer_store_dword v58, v16, s[8:11], s6 offen offset:128
    buffer_store_dword v62, v16, s[8:11], s6 offen offset:192
    s_mov_b32 s6, 155648
    buffer_store_dword v51, v16, s[8:11], s6 offen offset:0
    buffer_store_dword v55, v16, s[8:11], s6 offen offset:64
    buffer_store_dword v59, v16, s[8:11], s6 offen offset:128
    buffer_store_dword v63, v16, s[8:11], s6 offen offset:192
K2_fin:
K2_done:
    s_endpgm
.section .rodata,"a"
.p2align 6
.amdhsa_kernel k1_kernel
  .amdhsa_next_free_vgpr 228
  .amdhsa_next_free_sgpr 102
  .amdhsa_accum_offset 228
  .amdhsa_group_segment_fixed_size 0
  .amdhsa_kernarg_size 144
  .amdhsa_user_sgpr_count 2
  .amdhsa_user_sgpr_kernarg_segment_ptr 1
  .amdhsa_system_sgpr_workgroup_id_x 1
.end_amdhsa_kernel
.p2align 6
.amdhsa_kernel k2_kernel
  .amdhsa_next_free_vgpr 144
  .amdhsa_next_free_sgpr 102
  .amdhsa_accum_offset 144
  .amdhsa_group_segment_fixed_size 0
  .amdhsa_kernarg_size 144
  .amdhsa_user_sgpr_count 2
  .amdhsa_user_sgpr_kernarg_segment_ptr 1
  .amdhsa_system_sgpr_workgroup_id_x 1
.end_amdhsa_kernel
```

```asm
; @launch kernel=k1_kernel grid=(256,1,1) block=(512,1,1) lds=163840
; @launch kernel=k2_kernel grid=(256,1,1) block=(512,1,1) lds=147456
.amdgcn_target "amdgcn-amd-amdhsa--gfx950"
.text
.p2align 8
.globl k1_kernel
.type k1_kernel,@function
k1_kernel:
    s_cmp_ge_u32 s2, 256
    s_cbranch_scc1 K1_done
    s_load_dwordx16 s[32:47], s[0:1], 0
    s_load_dwordx16 s[48:63], s[0:1], 64
    s_load_dwordx4 s[64:67], s[0:1], 128
    v_lshrrev_b32 v1, 6, v0
    v_and_b32 v2, 63, v0
    s_and_b32 s6, s2, 3
    v_readfirstlane_b32 s5, v1
    s_lshl_b32 s6, s6, 2
    s_lshr_b32 s7, s2, 3
    s_and_b32 s3, s7, 3
    s_add_u32 s3, s3, s6
    s_and_b32 s6, s2, 4
    s_lshl_b32 s6, s6, 1
    s_lshr_b32 s4, s7, 2
    s_add_u32 s4, s4, s6
    s_cmp_lt_u32 s5, 4
    s_cbranch_scc1 K1_compute
    s_sub_u32 s6, s5, 4
    v_lshrrev_b32 v12, 3, v2
    v_and_b32 v13, 7, v2
    v_lshrrev_b32 v14, 4, v2
    v_xor_b32 v13, v13, v14
    v_lshlrev_b32 v13, 4, v13
    v_lshrrev_b32 v14, 5, v2
    v_lshlrev_b32 v14, 5, v14
    v_and_b32 v15, 3, v12
    v_add_u32 v14, v14, v15
    v_lshl_add_u32 v14, v14, 11, v13
    v_lshl_add_u32 v15, v12, 11, v13
    s_lshl_b32 s7, s3, 4
    s_add_u32 s7, s7, s6
    s_lshl_b32 s7, s7, 14
    v_add_u32 v4, s7, v14
    v_xor_b32 v5, 64, v4
    v_add_u32 v5, 0x1fc00, v5
    v_add_u32 v6, 0x1800, v4
    v_add_u32 v7, 0x1800, v5
    s_lshl_b32 s7, s4, 2
    s_add_u32 s7, s7, s6
    s_lshl_b32 s7, s7, 15
    v_add_u32 v8, s7, v15
    v_xor_b32 v9, 64, v8
    v_add_u32 v9, 0x3c00, v9
    s_and_b32 s30, s2, 3
    s_lshl_b32 s30, s30, 2
    s_and_b32 s31, s2, 4
    s_lshl_b32 s31, s31, 1
    s_add_u32 s30, s30, s31
    s_add_u32 s31, s3, s4
    s_and_b32 s31, s31, 1
    s_lshl_b32 s31, s31, 1
    s_add_u32 s30, s30, s31
    s_and_b32 s30, s30, 15
    s_lshl_b32 s100, s30, 7
    s_lshl_b32 s101, s6, 12
    s_waitcnt lgkmcnt(0)
    s_mov_b32 s8, s44
    s_mov_b32 s9, s45
    s_mov_b32 s10, 4194304
    s_mov_b32 s11, 0x00020000
    s_mov_b32 s12, s50
    s_mov_b32 s13, s51
    s_mov_b32 s14, 2097152
    s_mov_b32 s15, 0x00020000
    s_mov_b32 s16, s52
    s_mov_b32 s17, s53
    s_mov_b32 s18, 2097152
    s_mov_b32 s19, 0x00020000
    s_add_u32 m0, s101, 98304
    s_nop 0
    buffer_load_dwordx4 v4, s[8:11], s100 offen lds
    buffer_load_dwordx4 v5, s[8:11], s100 offen offset:1024 lds
    buffer_load_dwordx4 v6, s[8:11], s100 offen offset:2048 lds
    buffer_load_dwordx4 v7, s[8:11], s100 offen offset:3072 lds
    s_add_u32 m0, s101, 114688
    s_nop 0
    buffer_load_dwordx4 v8, s[12:15], s100 offen lds
    buffer_load_dwordx4 v9, s[12:15], s100 offen offset:1024 lds
    s_add_u32 m0, s101, 116736
    s_nop 0
    buffer_load_dwordx4 v8, s[16:19], s100 offen lds
    buffer_load_dwordx4 v9, s[16:19], s100 offen offset:1024 lds
    s_add_u32 s100, s100, 128
    s_and_b32 s100, s100, 2047
    s_mov_b32 s20, s34
    s_mov_b32 s21, s35
    s_mov_b32 s22, 4194304
    s_mov_b32 s23, 0x00020000
    s_mov_b32 s24, s36
    s_mov_b32 s25, s37
    s_mov_b32 s26, 4194304
    s_mov_b32 s27, 0x00020000
    s_mov_b32 s28, s38
    s_mov_b32 s29, s39
    s_mov_b32 s30, 8192
    s_mov_b32 s31, 0x00020000
    s_cmp_eq_u32 s6, 0
    s_cselect_b32 s52, s54, s56
    s_cselect_b32 s53, s55, s57
    s_cmp_lt_u32 s6, 2
    s_cselect_b32 s52, s52, s32
    s_cselect_b32 s53, s53, s33
    s_cselect_b32 s54, 1, 2
    s_lshl_b32 s54, s54, 21
    s_mov_b32 s55, 0x00020000
    s_lshr_b32 s7, s2, 3
    s_and_b32 s32, s7, 15
    s_lshr_b32 s7, s7, 4
    s_and_b32 s33, s2, 7
    s_lshl_b32 s33, s33, 1
    s_add_u32 s33, s33, s7
    s_lshl_b32 s34, s33, 4
    s_add_u32 s34, s34, s32
    s_lshl_b32 s34, s34, 2
    s_add_u32 s34, s34, s6
    s_lshl_b32 s35, s34, 12
    s_lshr_b32 s7, s34, 1
    s_lshl_b32 s7, s7, 2
    s_load_dword s37, s[42:43], s7
    v_and_b32 v12, 15, v2
    v_lshrrev_b32 v13, 4, v2
    s_lshl_b32 s7, s32, 2
    s_add_u32 s7, s7, s6
    s_lshl_b32 s7, s7, 16
    s_lshl_b32 s38, s33, 7
    s_add_u32 s7, s7, s38
    v_lshlrev_b32 v10, 14, v13
    v_lshl_add_u32 v10, v12, 3, v10
    v_add_u32 v10, s7, v10
    v_subrev_u32 v11, 0x1800, v10
    v_bfrev_b32 v14, 1
    v_cmp_gt_i32 vcc, 0, v11
    s_lshl_b32 s7, s33, 9
    v_lshlrev_b32 v15, 5, v12
    v_cndmask_b32 v11, v11, v14, vcc
    v_add_u32 v14, s7, v15
    s_lshl_b32 s7, s6, 2
    v_add_u32 v15, s7, v13
    v_sub_u32 v15, 15, v15
    v_xor_b32 v15, v15, v12
    v_lshlrev_b32 v15, 4, v15
    v_lshl_add_u32 v15, v12, 10, v15
    v_add_u32 v15, 147456, v15
    s_mov_b32 s38, 4096
    s_mov_b32 s39, 8192
    s_mov_b32 s44, 12288
    buffer_load_dwordx4 v[16:19], v14, s[28:31], 0 offen
    buffer_load_dwordx4 v[20:23], v14, s[28:31], 0 offen offset:16
    buffer_load_dwordx2 v[40:41], v11, s[20:23], 0 offen offset:0 nt
    buffer_load_dwordx2 v[42:43], v11, s[20:23], 0 offen offset:2048 nt
    buffer_load_dwordx2 v[44:45], v11, s[20:23], s38 offen offset:0 nt
    buffer_load_dwordx2 v[46:47], v10, s[20:23], 0 offen offset:0 nt
    buffer_load_dwordx2 v[48:49], v10, s[20:23], 0 offen offset:2048 nt
    buffer_load_dwordx2 v[50:51], v10, s[20:23], s38 offen offset:0 nt
    buffer_load_dwordx2 v[52:53], v10, s[20:23], s38 offen offset:2048 nt
    buffer_load_dwordx2 v[54:55], v10, s[20:23], s39 offen offset:0 nt
    buffer_load_dwordx2 v[56:57], v10, s[20:23], s39 offen offset:2048 nt
    buffer_load_dwordx2 v[58:59], v10, s[20:23], s44 offen offset:0 nt
    buffer_load_dwordx2 v[60:61], v10, s[20:23], s44 offen offset:2048 nt
    buffer_load_dwordx2 v[62:63], v10, s[24:27], 0 offen offset:0 nt
    buffer_load_dwordx2 v[64:65], v10, s[24:27], 0 offen offset:2048 nt
    buffer_load_dwordx2 v[66:67], v10, s[24:27], s38 offen offset:0 nt
    buffer_load_dwordx2 v[68:69], v10, s[24:27], s38 offen offset:2048 nt
    buffer_load_dwordx2 v[70:71], v10, s[24:27], s39 offen offset:0 nt
    buffer_load_dwordx2 v[72:73], v10, s[24:27], s39 offen offset:2048 nt
    buffer_load_dwordx2 v[74:75], v10, s[24:27], s44 offen offset:0 nt
    buffer_load_dwordx2 v[76:77], v10, s[24:27], s44 offen offset:2048 nt
    s_add_u32 m0, s101, 0
    s_nop 0
    buffer_load_dwordx4 v4, s[8:11], s100 offen lds
    buffer_load_dwordx4 v5, s[8:11], s100 offen offset:1024 lds
    buffer_load_dwordx4 v6, s[8:11], s100 offen offset:2048 lds
    buffer_load_dwordx4 v7, s[8:11], s100 offen offset:3072 lds
    s_add_u32 m0, s101, 16384
    s_nop 0
    buffer_load_dwordx4 v8, s[12:15], s100 offen lds
    buffer_load_dwordx4 v9, s[12:15], s100 offen offset:1024 lds
    s_add_u32 m0, s101, 18432
    s_nop 0
    buffer_load_dwordx4 v8, s[16:19], s100 offen lds
    buffer_load_dwordx4 v9, s[16:19], s100 offen offset:1024 lds
    s_add_u32 s100, s100, 128
    s_and_b32 s100, s100, 2047
    s_mov_b32 s68, s40
    s_mov_b32 s69, s41
    s_mov_b32 s70, 4194304
    s_mov_b32 s71, 0x00020000
    s_mov_b32 s72, s66
    s_mov_b32 s73, s67
    s_mov_b32 s74, 4194304
    s_mov_b32 s75, 0x00020000
    s_add_u32 s76, s66, 17825792
    s_addc_u32 s77, s67, 0
    s_mov_b32 s78, 2048
    s_mov_b32 s79, 0x00020000
    s_add_u32 s80, s66, 4194304
    s_addc_u32 s81, s67, 0
    s_mov_b32 s82, 4194304
    s_mov_b32 s83, 0x00020000
    s_mov_b32 s20, s64
    s_mov_b32 s21, s65
    s_mov_b32 s22, 256
    s_mov_b32 s23, 0x00020000
    s_lshl_b32 s7, s6, 29
    v_mov_b32 v212, s7
    s_lshl_b32 s36, s34, 1
    s_or_b32 s7, s7, s36
    v_mov_b32 v213, s7
    s_waitcnt vmcnt(29)
    s_barrier
    s_waitcnt vmcnt(8)
    s_add_u32 m0, s101, 32768
    s_nop 0
    buffer_load_dwordx4 v4, s[8:11], s100 offen lds
    v_lshlrev_b32 v24, 16, v16
    v_and_b32 v25, 0xffff0000, v16
    v_lshlrev_b32 v26, 16, v17
    v_and_b32 v27, 0xffff0000, v17
    v_lshlrev_b32 v78, 16, v40
    v_lshlrev_b32 v79, 16, v42
    v_lshlrev_b32 v80, 16, v44
    v_lshlrev_b32 v81, 16, v46
    v_lshlrev_b32 v82, 16, v48
    v_lshlrev_b32 v83, 16, v50
    v_lshlrev_b32 v84, 16, v52
    v_lshlrev_b32 v85, 16, v54
    v_lshlrev_b32 v86, 16, v56
    v_lshlrev_b32 v87, 16, v58
    v_lshlrev_b32 v88, 16, v60
    v_mul_f32 v90, v24, v81
    v_mul_f32 v91, v24, v82
    v_mul_f32 v92, v24, v83
    v_mul_f32 v93, v24, v84
    v_mul_f32 v94, v24, v85
    v_mul_f32 v95, v24, v86
    v_mul_f32 v96, v24, v87
    v_mul_f32 v97, v24, v88
    buffer_load_dwordx4 v5, s[8:11], s100 offen offset:1024 lds
    v_fmac_f32 v90, v25, v80
    v_fmac_f32 v91, v25, v81
    v_fmac_f32 v92, v25, v82
    v_fmac_f32 v93, v25, v83
    v_fmac_f32 v94, v25, v84
    v_fmac_f32 v95, v25, v85
    v_fmac_f32 v96, v25, v86
    v_fmac_f32 v97, v25, v87
    v_fmac_f32 v90, v26, v79
    v_fmac_f32 v91, v26, v80
    v_fmac_f32 v92, v26, v81
    v_fmac_f32 v93, v26, v82
    v_fmac_f32 v94, v26, v83
    v_fmac_f32 v95, v26, v84
    v_fmac_f32 v96, v26, v85
    v_fmac_f32 v97, v26, v86
    v_fmac_f32 v90, v27, v78
    v_fmac_f32 v91, v27, v79
    v_fmac_f32 v92, v27, v80
    v_fmac_f32 v93, v27, v81
    v_fmac_f32 v94, v27, v82
    v_fmac_f32 v95, v27, v83
    v_fmac_f32 v96, v27, v84
    buffer_load_dwordx4 v6, s[8:11], s100 offen offset:2048 lds
    v_fmac_f32 v97, v27, v85
    v_lshlrev_b32 v78, 16, v62
    v_lshlrev_b32 v79, 16, v64
    v_lshlrev_b32 v80, 16, v66
    v_lshlrev_b32 v81, 16, v68
    v_lshlrev_b32 v82, 16, v70
    v_lshlrev_b32 v83, 16, v72
    v_lshlrev_b32 v84, 16, v74
    v_lshlrev_b32 v85, 16, v76
    v_mul_f32 v90, v90, v78
    v_mul_f32 v91, v91, v79
    v_mul_f32 v92, v92, v80
    v_mul_f32 v93, v93, v81
    v_mul_f32 v94, v94, v82
    v_mul_f32 v95, v95, v83
    v_mul_f32 v96, v96, v84
    v_mul_f32 v97, v97, v85
    v_cvt_pk_bf16_f32 v98, v97, v96
    v_cvt_pk_bf16_f32 v99, v95, v94
    v_cvt_pk_bf16_f32 v100, v93, v92
    v_cvt_pk_bf16_f32 v101, v91, v90
    ds_write_b128 v15, v[98:101] offset:0
    v_lshlrev_b32 v24, 16, v18
    buffer_load_dwordx4 v7, s[8:11], s100 offen offset:3072 lds
    v_and_b32 v25, 0xffff0000, v18
    v_lshlrev_b32 v26, 16, v19
    v_and_b32 v27, 0xffff0000, v19
    v_and_b32 v78, 0xffff0000, v40
    v_and_b32 v79, 0xffff0000, v42
    v_and_b32 v80, 0xffff0000, v44
    v_and_b32 v81, 0xffff0000, v46
    v_and_b32 v82, 0xffff0000, v48
    v_and_b32 v83, 0xffff0000, v50
    v_and_b32 v84, 0xffff0000, v52
    v_and_b32 v85, 0xffff0000, v54
    v_and_b32 v86, 0xffff0000, v56
    v_and_b32 v87, 0xffff0000, v58
    v_and_b32 v88, 0xffff0000, v60
    v_mul_f32 v90, v24, v81
    v_mul_f32 v91, v24, v82
    v_mul_f32 v92, v24, v83
    v_mul_f32 v93, v24, v84
    v_mul_f32 v94, v24, v85
    v_mul_f32 v95, v24, v86
    v_mul_f32 v96, v24, v87
    v_mul_f32 v97, v24, v88
    v_fmac_f32 v90, v25, v80
    s_add_u32 m0, s101, 49152
    s_nop 0
    buffer_load_dwordx4 v8, s[12:15], s100 offen lds
    v_fmac_f32 v91, v25, v81
    v_fmac_f32 v92, v25, v82
    v_fmac_f32 v93, v25, v83
    v_fmac_f32 v94, v25, v84
    v_fmac_f32 v95, v25, v85
    v_fmac_f32 v96, v25, v86
    v_fmac_f32 v97, v25, v87
    v_fmac_f32 v90, v26, v79
    v_fmac_f32 v91, v26, v80
    v_fmac_f32 v92, v26, v81
    v_fmac_f32 v93, v26, v82
    v_fmac_f32 v94, v26, v83
    v_fmac_f32 v95, v26, v84
    v_fmac_f32 v96, v26, v85
    v_fmac_f32 v97, v26, v86
    v_fmac_f32 v90, v27, v78
    v_fmac_f32 v91, v27, v79
    v_fmac_f32 v92, v27, v80
    v_fmac_f32 v93, v27, v81
    v_fmac_f32 v94, v27, v82
    v_fmac_f32 v95, v27, v83
    v_fmac_f32 v96, v27, v84
    v_fmac_f32 v97, v27, v85
    buffer_load_dwordx4 v9, s[12:15], s100 offen offset:1024 lds
    v_and_b32 v78, 0xffff0000, v62
    v_and_b32 v79, 0xffff0000, v64
    v_and_b32 v80, 0xffff0000, v66
    v_and_b32 v81, 0xffff0000, v68
    v_and_b32 v82, 0xffff0000, v70
    v_and_b32 v83, 0xffff0000, v72
    v_and_b32 v84, 0xffff0000, v74
    v_and_b32 v85, 0xffff0000, v76
    v_mul_f32 v90, v90, v78
    v_mul_f32 v91, v91, v79
    v_mul_f32 v92, v92, v80
    v_mul_f32 v93, v93, v81
    v_mul_f32 v94, v94, v82
    v_mul_f32 v95, v95, v83
    v_mul_f32 v96, v96, v84
    v_mul_f32 v97, v97, v85
    v_cvt_pk_bf16_f32 v102, v97, v96
    v_cvt_pk_bf16_f32 v103, v95, v94
    v_cvt_pk_bf16_f32 v104, v93, v92
    v_cvt_pk_bf16_f32 v105, v91, v90
    ds_write_b128 v15, v[102:105] offset:256
    v_lshlrev_b32 v24, 16, v20
    v_and_b32 v25, 0xffff0000, v20
    s_add_u32 m0, s101, 51200
    s_nop 0
    buffer_load_dwordx4 v8, s[16:19], s100 offen lds
    v_lshlrev_b32 v26, 16, v21
    v_and_b32 v27, 0xffff0000, v21
    v_lshlrev_b32 v78, 16, v41
    v_lshlrev_b32 v79, 16, v43
    v_lshlrev_b32 v80, 16, v45
    v_lshlrev_b32 v81, 16, v47
    v_lshlrev_b32 v82, 16, v49
    v_lshlrev_b32 v83, 16, v51
    v_lshlrev_b32 v84, 16, v53
    v_lshlrev_b32 v85, 16, v55
    v_lshlrev_b32 v86, 16, v57
    v_lshlrev_b32 v87, 16, v59
    v_lshlrev_b32 v88, 16, v61
    v_mul_f32 v90, v24, v81
    v_mul_f32 v91, v24, v82
    v_mul_f32 v92, v24, v83
    v_mul_f32 v93, v24, v84
    v_mul_f32 v94, v24, v85
    v_mul_f32 v95, v24, v86
    v_mul_f32 v96, v24, v87
    v_mul_f32 v97, v24, v88
    v_fmac_f32 v90, v25, v80
    v_fmac_f32 v91, v25, v81
    buffer_load_dwordx4 v9, s[16:19], s100 offen offset:1024 lds
    s_add_u32 s100, s100, 128
    s_and_b32 s100, s100, 2047
    v_fmac_f32 v92, v25, v82
    v_fmac_f32 v93, v25, v83
    v_fmac_f32 v94, v25, v84
    v_fmac_f32 v95, v25, v85
    v_fmac_f32 v96, v25, v86
    v_fmac_f32 v97, v25, v87
    v_fmac_f32 v90, v26, v79
    v_fmac_f32 v91, v26, v80
    v_fmac_f32 v92, v26, v81
    v_fmac_f32 v93, v26, v82
    v_fmac_f32 v94, v26, v83
    v_fmac_f32 v95, v26, v84
    v_fmac_f32 v96, v26, v85
    v_fmac_f32 v97, v26, v86
    v_fmac_f32 v90, v27, v78
    v_fmac_f32 v91, v27, v79
    v_fmac_f32 v92, v27, v80
    v_fmac_f32 v93, v27, v81
    v_fmac_f32 v94, v27, v82
    v_fmac_f32 v95, v27, v83
    v_fmac_f32 v96, v27, v84
    v_fmac_f32 v97, v27, v85
    v_lshlrev_b32 v78, 16, v63
    s_add_u32 m0, s101, 65536
    s_nop 0
    buffer_load_dwordx4 v4, s[8:11], s100 offen lds
    v_lshlrev_b32 v79, 16, v65
    v_lshlrev_b32 v80, 16, v67
    v_lshlrev_b32 v81, 16, v69
    v_lshlrev_b32 v82, 16, v71
    v_lshlrev_b32 v83, 16, v73
    v_lshlrev_b32 v84, 16, v75
    v_lshlrev_b32 v85, 16, v77
    v_mul_f32 v90, v90, v78
    v_mul_f32 v91, v91, v79
    v_mul_f32 v92, v92, v80
    v_mul_f32 v93, v93, v81
    v_mul_f32 v94, v94, v82
    v_mul_f32 v95, v95, v83
    v_mul_f32 v96, v96, v84
    v_mul_f32 v97, v97, v85
    v_cvt_pk_bf16_f32 v98, v97, v96
    v_cvt_pk_bf16_f32 v99, v95, v94
    v_cvt_pk_bf16_f32 v100, v93, v92
    v_cvt_pk_bf16_f32 v101, v91, v90
    ds_write_b128 v15, v[98:101] offset:512
    v_lshlrev_b32 v24, 16, v22
    v_and_b32 v25, 0xffff0000, v22
    v_lshlrev_b32 v26, 16, v23
    buffer_load_dwordx4 v5, s[8:11], s100 offen offset:1024 lds
    v_and_b32 v27, 0xffff0000, v23
    v_and_b32 v78, 0xffff0000, v41
    v_and_b32 v79, 0xffff0000, v43
    v_and_b32 v80, 0xffff0000, v45
    v_and_b32 v81, 0xffff0000, v47
    v_and_b32 v82, 0xffff0000, v49
    v_and_b32 v83, 0xffff0000, v51
    v_and_b32 v84, 0xffff0000, v53
    v_and_b32 v85, 0xffff0000, v55
    v_and_b32 v86, 0xffff0000, v57
    v_and_b32 v87, 0xffff0000, v59
    v_and_b32 v88, 0xffff0000, v61
    v_mul_f32 v90, v24, v81
    v_mul_f32 v91, v24, v82
    v_mul_f32 v92, v24, v83
    v_mul_f32 v93, v24, v84
    v_mul_f32 v94, v24, v85
    v_mul_f32 v95, v24, v86
    v_mul_f32 v96, v24, v87
    v_mul_f32 v97, v24, v88
    v_fmac_f32 v90, v25, v80
    v_fmac_f32 v91, v25, v81
    v_fmac_f32 v92, v25, v82
    buffer_load_dwordx4 v6, s[8:11], s100 offen offset:2048 lds
    v_fmac_f32 v93, v25, v83
    v_fmac_f32 v94, v25, v84
    v_fmac_f32 v95, v25, v85
    v_fmac_f32 v96, v25, v86
    v_fmac_f32 v97, v25, v87
    v_fmac_f32 v90, v26, v79
    v_fmac_f32 v91, v26, v80
    v_fmac_f32 v92, v26, v81
    v_fmac_f32 v93, v26, v82
    v_fmac_f32 v94, v26, v83
    v_fmac_f32 v95, v26, v84
    v_fmac_f32 v96, v26, v85
    v_fmac_f32 v97, v26, v86
    v_fmac_f32 v90, v27, v78
    v_fmac_f32 v91, v27, v79
    v_fmac_f32 v92, v27, v80
    v_fmac_f32 v93, v27, v81
    v_fmac_f32 v94, v27, v82
    v_fmac_f32 v95, v27, v83
    v_fmac_f32 v96, v27, v84
    v_fmac_f32 v97, v27, v85
    v_and_b32 v78, 0xffff0000, v63
    v_and_b32 v79, 0xffff0000, v65
    buffer_load_dwordx4 v7, s[8:11], s100 offen offset:3072 lds
    v_and_b32 v80, 0xffff0000, v67
    v_and_b32 v81, 0xffff0000, v69
    v_and_b32 v82, 0xffff0000, v71
    v_and_b32 v83, 0xffff0000, v73
    v_and_b32 v84, 0xffff0000, v75
    v_and_b32 v85, 0xffff0000, v77
    v_mul_f32 v90, v90, v78
    v_mul_f32 v91, v91, v79
    v_mul_f32 v92, v92, v80
    v_mul_f32 v93, v93, v81
    v_mul_f32 v94, v94, v82
    v_mul_f32 v95, v95, v83
    v_mul_f32 v96, v96, v84
    v_mul_f32 v97, v97, v85
    v_cvt_pk_bf16_f32 v102, v97, v96
    v_cvt_pk_bf16_f32 v103, v95, v94
    v_cvt_pk_bf16_f32 v104, v93, v92
    v_cvt_pk_bf16_f32 v105, v91, v90
    ds_write_b128 v15, v[102:105] offset:768
    s_add_u32 m0, s101, 81920
    s_nop 0
    buffer_load_dwordx4 v8, s[12:15], s100 offen lds
    buffer_load_dwordx4 v9, s[12:15], s100 offen offset:1024 lds
    s_add_u32 m0, s101, 83968
    s_nop 0
    buffer_load_dwordx4 v8, s[16:19], s100 offen lds
    buffer_load_dwordx4 v9, s[16:19], s100 offen offset:1024 lds
    s_add_u32 s100, s100, 128
    s_and_b32 s100, s100, 2047
    s_waitcnt vmcnt(16) lgkmcnt(0)
    s_barrier
    s_mov_b64 exec, 1
    buffer_load_dwordx2 v[210:211], v212, s[20:23], 0 offen sc1
    s_mov_b64 exec, -1
    s_waitcnt lgkmcnt(0)
    s_mul_i32 s45, s6, 4160
    s_mul_i32 s46, s6, 4608
    v_lshlrev_b32 v16, 4, v13
    v_lshl_add_u32 v16, v12, 1, v16
    v_and_b32 v1, 1, v12
    v_mov_b32 v3, 98308
    v_mov_b32 v14, 133442
    v_cmp_eq_u32 vcc, 1, v1
    s_add_u32 m0, s101, 98304
    s_nop 0
    buffer_load_dwordx4 v4, s[8:11], s100 offen lds
    s_and_b32 s7, s34, 1
    s_lshl_b32 s7, s7, 4
    v_cndmask_b32 v3, v3, v14, vcc
    v_add3_u32 v16, v16, v3, s45
    v_add_u32 v17, 1024, v16
    v_add_u32 v18, 2048, v16
    v_add_u32 v19, 3072, v16
    s_add_u32 s47, s46, 115424
    v_lshlrev_b32 v1, 4, v13
    buffer_load_dwordx4 v5, s[8:11], s100 offen offset:1024 lds
    v_lshlrev_b32 v3, 5, v12
    v_sub_u32 v1, v1, v3
    v_add_u32 v20, s47, v1
    s_lshr_b32 s37, s37, s7
    s_and_b32 s37, s37, 0xffff
    v_lshlrev_b32 v1, 3, v13
    v_add_u32 v1, v1, v12
    v_sub_u32 v1, 15, v1
    v_and_b32 v3, 1, v1
    buffer_load_dwordx4 v6, s[8:11], s100 offen offset:2048 lds
    v_lshlrev_b32 v3, 4, v3
    v_lshlrev_b32 v3, v3, s37
    v_lshrrev_b32 v1, 1, v1
    v_cmp_eq_u32 vcc, 0, v1
    s_nop 1
    v_cndmask_b32 v24, 0, v3, vcc
    v_cmp_eq_u32 vcc, 1, v1
    s_nop 1
    v_cndmask_b32 v25, 0, v3, vcc
    buffer_load_dwordx4 v7, s[8:11], s100 offen offset:3072 lds
    v_cmp_eq_u32 vcc, 2, v1
    s_nop 1
    v_cndmask_b32 v26, 0, v3, vcc
    v_cmp_eq_u32 vcc, 3, v1
    s_nop 1
    v_cndmask_b32 v27, 0, v3, vcc
    v_and_b32 v1, 1, v13
    v_lshlrev_b32 v1, 9, v1
    v_lshrrev_b32 v3, 1, v13
    s_add_u32 m0, s101, 114688
    s_nop 0
    buffer_load_dwordx4 v8, s[12:15], s100 offen lds
    v_lshl_add_u32 v1, v3, 8, v1
    v_lshl_add_u32 v1, v12, 4, v1
    v_add_u32 v21, s35, v1
    v_lshlrev_b32 v10, 4, v2
    s_lshl_b32 s7, s33, 7
    v_lshlrev_b32 v14, 3, v12
    v_add_u32 v14, s7, v14
    s_and_b32 s7, s2, 7
    s_lshl_b32 s7, s7, 5
    buffer_load_dwordx4 v9, s[12:15], s100 offen offset:1024 lds
    s_lshr_b32 s56, s2, 3
    s_add_u32 s7, s7, s56
    s_lshl_b32 s7, s7, 13
    v_lshlrev_b32 v30, 7, v2
    v_add_u32 v30, s7, v30
    s_lshl_b32 s7, s3, 1
    s_and_b32 s56, s6, 1
    s_add_u32 s7, s7, s56
    s_lshl_b32 s7, s7, 17
    s_add_u32 m0, s101, 116736
    s_nop 0
    buffer_load_dwordx4 v8, s[16:19], s100 offen lds
    s_lshl_b32 s56, s4, 7
    s_add_u32 s7, s7, s56
    v_lshlrev_b32 v31, 11, v2
    v_add_u32 v31, s7, v31
    s_waitcnt vmcnt(16)
    s_barrier
    buffer_load_dwordx4 v9, s[16:19], s100 offen offset:1024 lds
    s_add_u32 s100, s100, 128
    s_and_b32 s100, s100, 2047
    s_add_u32 m0, s101, 0
    s_nop 0
    buffer_load_dwordx4 v4, s[8:11], s100 offen lds
    buffer_load_dwordx4 v5, s[8:11], s100 offen offset:1024 lds
    buffer_load_dwordx4 v6, s[8:11], s100 offen offset:2048 lds
    buffer_load_dwordx4 v7, s[8:11], s100 offen offset:3072 lds
    s_add_u32 m0, s101, 16384
    s_nop 0
    buffer_load_dwordx4 v8, s[12:15], s100 offen lds
    buffer_load_dwordx4 v9, s[12:15], s100 offen offset:1024 lds
    s_add_u32 m0, s101, 18432
    s_nop 0
    buffer_load_dwordx4 v8, s[16:19], s100 offen lds
    s_waitcnt vmcnt(16)
    s_barrier
    buffer_load_dwordx4 v9, s[16:19], s100 offen offset:1024 lds
    s_add_u32 s100, s100, 128
    s_and_b32 s100, s100, 2047
    s_add_u32 m0, s101, 32768
    s_nop 0
    buffer_load_dwordx4 v4, s[8:11], s100 offen lds
    buffer_load_dwordx4 v5, s[8:11], s100 offen offset:1024 lds
    buffer_load_dwordx4 v6, s[8:11], s100 offen offset:2048 lds
    buffer_load_dwordx4 v7, s[8:11], s100 offen offset:3072 lds
    s_add_u32 m0, s101, 49152
    s_nop 0
    buffer_load_dwordx4 v8, s[12:15], s100 offen lds
    buffer_load_dwordx4 v9, s[12:15], s100 offen offset:1024 lds
    s_add_u32 m0, s101, 51200
    s_nop 0
    buffer_load_dwordx4 v8, s[16:19], s100 offen lds
    buffer_load_dwordx4 v9, s[16:19], s100 offen offset:1024 lds
    s_add_u32 s100, s100, 128
    s_and_b32 s100, s100, 2047
    s_waitcnt vmcnt(16)
    s_barrier
    s_cmp_eq_u32 s6, 0
    s_cbranch_scc0 K1L_nskip
    s_mov_b32 s51, 0
    s_mov_b64 exec, 1
    s_waitcnt vmcnt(24)
K1L_nspin:
    v_readfirstlane_b32 s7, v210
    s_add_u32 s51, s51, 1
    s_cmp_lg_u32 s7, 0
    s_cbranch_scc1 K1L_nok
    s_cmp_gt_u32 s51, 4096
    s_cbranch_scc1 K1L_nok
    buffer_load_dwordx2 v[210:211], v212, s[20:23], 0 offen sc1
    s_waitcnt vmcnt(0)
    s_branch K1L_nspin
K1L_nok:
    v_mov_b32 v1, 133376
    ds_write_b64 v1, v[210:211]
    s_mov_b64 exec, -1
    s_waitcnt lgkmcnt(0)
K1L_nskip:
    s_add_u32 m0, s101, 65536
    s_nop 0
    buffer_load_dwordx4 v4, s[8:11], s100 offen lds
    buffer_load_dwordx4 v5, s[8:11], s100 offen offset:1024 lds
    buffer_load_dwordx4 v6, s[8:11], s100 offen offset:2048 lds
    buffer_load_dwordx4 v7, s[8:11], s100 offen offset:3072 lds
    s_add_u32 m0, s101, 81920
    s_nop 0
    buffer_load_dwordx4 v8, s[12:15], s100 offen lds
    buffer_load_dwordx4 v9, s[12:15], s100 offen offset:1024 lds
    s_add_u32 m0, s101, 83968
    s_nop 0
    buffer_load_dwordx4 v8, s[16:19], s100 offen lds
    buffer_load_dwordx4 v9, s[16:19], s100 offen offset:1024 lds
    s_add_u32 s100, s100, 128
    s_and_b32 s100, s100, 2047
    s_waitcnt vmcnt(16)
    s_barrier
    v_mov_b32 v1, 133376
    ds_read_b64 v[28:29], v1
    s_add_u32 m0, s101, 98304
    s_nop 0
    buffer_load_dwordx4 v4, s[8:11], s100 offen lds
    buffer_load_dwordx4 v5, s[8:11], s100 offen offset:1024 lds
    buffer_load_dwordx4 v6, s[8:11], s100 offen offset:2048 lds
    buffer_load_dwordx4 v7, s[8:11], s100 offen offset:3072 lds
    s_add_u32 m0, s101, 114688
    s_nop 0
    buffer_load_dwordx4 v8, s[12:15], s100 offen lds
    buffer_load_dwordx4 v9, s[12:15], s100 offen offset:1024 lds
    s_add_u32 m0, s101, 116736
    s_nop 0
    buffer_load_dwordx4 v8, s[16:19], s100 offen lds
    buffer_load_dwordx4 v9, s[16:19], s100 offen offset:1024 lds
    s_add_u32 s100, s100, 128
    s_and_b32 s100, s100, 2047
    s_waitcnt vmcnt(16) lgkmcnt(0)
    s_barrier
    s_mov_b64 exec, 1
    buffer_store_dwordx2 v[210:211], v213, s[76:79], 0 offen sc1
    s_mov_b64 exec, -1
    s_add_u32 m0, s101, 0
    s_nop 0
    buffer_load_dwordx4 v4, s[8:11], s100 offen lds
    buffer_load_dwordx4 v5, s[8:11], s100 offen offset:1024 lds
    buffer_load_dwordx4 v6, s[8:11], s100 offen offset:2048 lds
    buffer_load_dwordx4 v7, s[8:11], s100 offen offset:3072 lds
    s_add_u32 m0, s101, 16384
    s_nop 0
    buffer_load_dwordx4 v8, s[12:15], s100 offen lds
    buffer_load_dwordx4 v9, s[12:15], s100 offen offset:1024 lds
    s_add_u32 m0, s101, 18432
    s_nop 0
    buffer_load_dwordx4 v8, s[16:19], s100 offen lds
    buffer_load_dwordx4 v9, s[16:19], s100 offen offset:1024 lds
    s_add_u32 s100, s100, 128
    s_and_b32 s100, s100, 2047
    s_waitcnt vmcnt(17)
    s_barrier
    s_add_u32 m0, s101, 32768
    s_nop 0
    buffer_load_dwordx4 v4, s[8:11], s100 offen lds
    buffer_load_dwordx4 v5, s[8:11], s100 offen offset:1024 lds
    buffer_load_dwordx4 v6, s[8:11], s100 offen offset:2048 lds
    buffer_load_dwordx4 v7, s[8:11], s100 offen offset:3072 lds
    s_add_u32 m0, s101, 49152
    s_nop 0
    buffer_load_dwordx4 v8, s[12:15], s100 offen lds
    buffer_load_dwordx4 v9, s[12:15], s100 offen offset:1024 lds
    s_add_u32 m0, s101, 51200
    s_nop 0
    buffer_load_dwordx4 v8, s[16:19], s100 offen lds
    buffer_load_dwordx4 v9, s[16:19], s100 offen offset:1024 lds
    s_add_u32 s100, s100, 128
    s_and_b32 s100, s100, 2047
    s_waitcnt vmcnt(17)
    s_barrier
    s_add_u32 m0, s101, 65536
    s_nop 0
    buffer_load_dwordx4 v4, s[8:11], s100 offen lds
    buffer_load_dwordx4 v5, s[8:11], s100 offen offset:1024 lds
    buffer_load_dwordx4 v6, s[8:11], s100 offen offset:2048 lds
    buffer_load_dwordx4 v7, s[8:11], s100 offen offset:3072 lds
    s_add_u32 m0, s101, 81920
    s_nop 0
    buffer_load_dwordx4 v8, s[12:15], s100 offen lds
    buffer_load_dwordx4 v9, s[12:15], s100 offen offset:1024 lds
    s_add_u32 m0, s101, 83968
    s_nop 0
    buffer_load_dwordx4 v8, s[16:19], s100 offen lds
    buffer_load_dwordx4 v9, s[16:19], s100 offen offset:1024 lds
    s_add_u32 s100, s100, 128
    s_and_b32 s100, s100, 2047
    s_waitcnt vmcnt(16)
    s_barrier
    s_add_u32 m0, s101, 98304
    s_nop 0
    buffer_load_dwordx4 v4, s[8:11], s100 offen lds
    buffer_load_dwordx4 v5, s[8:11], s100 offen offset:1024 lds
    buffer_load_dwordx4 v6, s[8:11], s100 offen offset:2048 lds
    buffer_load_dwordx4 v7, s[8:11], s100 offen offset:3072 lds
    s_add_u32 m0, s101, 114688
    s_nop 0
    buffer_load_dwordx4 v8, s[12:15], s100 offen lds
    buffer_load_dwordx4 v9, s[12:15], s100 offen offset:1024 lds
    s_add_u32 m0, s101, 116736
    s_nop 0
    buffer_load_dwordx4 v8, s[16:19], s100 offen lds
    buffer_load_dwordx4 v9, s[16:19], s100 offen offset:1024 lds
    s_add_u32 s100, s100, 128
    s_and_b32 s100, s100, 2047
    s_waitcnt vmcnt(16)
    s_barrier
    buffer_load_dwordx2 v[22:23], v14, s[76:79], 0 offen sc1
    s_add_u32 m0, s101, 0
    s_nop 0
    buffer_load_dwordx4 v4, s[8:11], s100 offen lds
    buffer_load_dwordx4 v5, s[8:11], s100 offen offset:1024 lds
    buffer_load_dwordx4 v6, s[8:11], s100 offen offset:2048 lds
    buffer_load_dwordx4 v7, s[8:11], s100 offen offset:3072 lds
    s_add_u32 m0, s101, 16384
    s_nop 0
    buffer_load_dwordx4 v8, s[12:15], s100 offen lds
    buffer_load_dwordx4 v9, s[12:15], s100 offen offset:1024 lds
    s_add_u32 m0, s101, 18432
    s_nop 0
    buffer_load_dwordx4 v8, s[16:19], s100 offen lds
    s_waitcnt vmcnt(16)
    s_barrier
    buffer_load_dwordx4 v9, s[16:19], s100 offen offset:1024 lds
    s_add_u32 s100, s100, 128
    s_and_b32 s100, s100, 2047
    s_add_u32 m0, s101, 32768
    s_nop 0
    buffer_load_dwordx4 v4, s[8:11], s100 offen lds
    buffer_load_dwordx4 v5, s[8:11], s100 offen offset:1024 lds
    buffer_load_dwordx4 v6, s[8:11], s100 offen offset:2048 lds
    buffer_load_dwordx4 v7, s[8:11], s100 offen offset:3072 lds
    s_add_u32 m0, s101, 49152
    s_nop 0
    buffer_load_dwordx4 v8, s[12:15], s100 offen lds
    buffer_load_dwordx4 v9, s[12:15], s100 offen offset:1024 lds
    s_add_u32 m0, s101, 51200
    s_nop 0
    buffer_load_dwordx4 v8, s[16:19], s100 offen lds
    s_waitcnt vmcnt(16)
    s_barrier
    buffer_load_dwordx4 v9, s[16:19], s100 offen offset:1024 lds
    s_add_u32 s100, s100, 128
    s_and_b32 s100, s100, 2047
    s_add_u32 m0, s101, 65536
    s_nop 0
    buffer_load_dwordx4 v4, s[8:11], s100 offen lds
    buffer_load_dwordx4 v5, s[8:11], s100 offen offset:1024 lds
    buffer_load_dwordx4 v6, s[8:11], s100 offen offset:2048 lds
    buffer_load_dwordx4 v7, s[8:11], s100 offen offset:3072 lds
    s_add_u32 m0, s101, 81920
    s_nop 0
    buffer_load_dwordx4 v8, s[12:15], s100 offen lds
    buffer_load_dwordx4 v9, s[12:15], s100 offen offset:1024 lds
    s_add_u32 m0, s101, 83968
    s_nop 0
    buffer_load_dwordx4 v8, s[16:19], s100 offen lds
    buffer_load_dwordx4 v9, s[16:19], s100 offen offset:1024 lds
    s_add_u32 s100, s100, 128
    s_and_b32 s100, s100, 2047
    s_waitcnt vmcnt(16)
    s_barrier
    s_add_u32 m0, s45, 133472
    s_nop 0
    buffer_load_dwordx4 v10, s[68:71], s35 offen offset:0 nt lds
    s_add_u32 m0, s45, 133472
    s_nop 0
    buffer_load_dwordx4 v10, s[68:71], s35 offen offset:1024 nt lds
    s_add_u32 m0, s45, 133472
    s_nop 0
    buffer_load_dwordx4 v10, s[68:71], s35 offen offset:2048 nt lds
    s_add_u32 m0, s45, 133472
    s_nop 0
    buffer_load_dwordx4 v10, s[68:71], s35 offen offset:3072 nt lds
    v_bfrev_b32 v11, 1
    s_waitcnt vmcnt(28)
    v_cmp_eq_u32 vcc, v22, v28
    v_cmp_eq_u32 s[48:49], v23, v29
    s_nop 0
    s_and_b64 s[48:49], s[48:49], vcc
    s_cmp_eq_u64 s[48:49], -1
    s_cselect_b32 s50, 1, 0
    s_cselect_b64 vcc, -1, 0
    s_nop 1
    v_cndmask_b32 v11, v11, v10, vcc
    buffer_load_dwordx4 v[192:195], v11, s[72:75], s35 offen offset:0 sc1
    buffer_load_dwordx4 v[196:199], v11, s[72:75], s35 offen offset:1024 sc1
    buffer_load_dwordx4 v[200:203], v11, s[72:75], s35 offen offset:2048 sc1
    buffer_load_dwordx4 v[204:207], v11, s[72:75], s35 offen offset:3072 sc1
    s_waitcnt vmcnt(16)
    s_barrier
    v_mov_b32 v32, 0
    v_mov_b32 v33, 0
    v_mov_b32 v34, 0
    v_mov_b32 v35, 0
    s_add_u32 s47, s46, 119040
    v_add_u32 v1, s47, v10
    v_and_b32 v3, 16, v10
    v_and_b32 v15, 32, v10
    v_mul_u32_u24 v15, 1098, v15
    v_add3_u32 v3, v3, v15, s45
    v_add_u32 v3, 98304, v3
    v_cmp_gt_u32 vcc, 32, v2
    s_add_u32 s47, s45, 133468
    v_add_u32 v15, s47, v10
    v_cndmask_b32 v1, v3, v1, vcc
    ds_write_b128 v1, v[32:35]
    s_waitcnt vmcnt(8)
    s_barrier
    s_waitcnt vmcnt(4)
    ds_read_b32 v64, v15 offset:0
    ds_read_b128 v[68:71], v15 offset:4
    ds_read_b32 v72, v15 offset:1024
    ds_read_b128 v[76:79], v15 offset:1028
    ds_read_b32 v80, v15 offset:2048
    ds_read_b128 v[84:87], v15 offset:2052
    ds_read_b32 v88, v15 offset:3072
    ds_read_b128 v[92:95], v15 offset:3076
    v_subrev_u32 v15, 35132, v15
    s_waitcnt lgkmcnt(0)
    v_alignbit_b32 v64, v68, v64, 16
    v_alignbit_b32 v65, v69, v68, 16
    v_alignbit_b32 v66, v70, v69, 16
    v_alignbit_b32 v67, v71, v70, 16
    ds_write_b128 v15, v[64:67] offset:0
    v_alignbit_b32 v72, v76, v72, 16
    v_alignbit_b32 v73, v77, v76, 16
    v_alignbit_b32 v74, v78, v77, 16
    v_alignbit_b32 v75, v79, v78, 16
    ds_write_b128 v15, v[72:75] offset:1024
    v_alignbit_b32 v80, v84, v80, 16
    v_alignbit_b32 v81, v85, v84, 16
    v_alignbit_b32 v82, v86, v85, 16
    v_alignbit_b32 v83, v87, v86, 16
    ds_write_b128 v15, v[80:83] offset:2048
    v_alignbit_b32 v88, v92, v88, 16
    v_alignbit_b32 v89, v93, v92, 16
    v_alignbit_b32 v90, v94, v93, 16
    v_alignbit_b32 v91, v95, v94, 16
    ds_write_b128 v15, v[88:91] offset:3072
    s_cmp_eq_u32 s50, 1
    s_cbranch_scc1 K1L_have
    s_mov_b32 s51, 0
K1L_spin:
    buffer_load_dwordx2 v[22:23], v14, s[76:79], 0 offen sc1
    s_add_u32 s51, s51, 1
    s_waitcnt vmcnt(0)
    v_cmp_eq_u32 vcc, v22, v28
    v_cmp_eq_u32 s[48:49], v23, v29
    s_cmp_gt_u32 s51, 4096
    s_cbranch_scc1 K1L_go
    s_and_b64 s[48:49], s[48:49], vcc
    s_cmp_eq_u64 s[48:49], -1
    s_cbranch_scc0 K1L_spin
K1L_go:
    buffer_load_dwordx4 v[192:195], v10, s[72:75], s35 offen offset:0 sc1
    buffer_load_dwordx4 v[196:199], v10, s[72:75], s35 offen offset:1024 sc1
    buffer_load_dwordx4 v[200:203], v10, s[72:75], s35 offen offset:2048 sc1
    buffer_load_dwordx4 v[204:207], v10, s[72:75], s35 offen offset:3072 sc1
    s_waitcnt vmcnt(0)
K1L_have:
    s_add_u32 s47, s46, 114944
    v_add_u32 v1, s47, v10
    s_waitcnt vmcnt(0)
    s_cmp_lt_u32 s6, 2
    s_cbranch_scc1 K1L_tc
    buffer_load_dword v208, v31, s[52:55], 0 offen
    s_branch K1L_td
K1L_tc:
    buffer_load_dword v208, v30, s[52:55], 0 offen
K1L_td:
    ds_write_b128 v1, v[192:195] offset:0
    ds_write_b128 v1, v[196:199] offset:1024
    ds_write_b128 v1, v[200:203] offset:2048
    ds_write_b128 v1, v[204:207] offset:3072
    s_waitcnt lgkmcnt(0)
    ds_read_b128 v[96:99], v20 offset:3584
    ds_read2_b32 v[64:65], v16 offset0:0 offset1:1
    ds_read2_b32 v[66:67], v16 offset0:2 offset1:3
    ds_read_b128 v[100:103], v20 offset:3072
    ds_read2_b32 v[68:69], v16 offset0:128 offset1:129
    ds_read2_b32 v[70:71], v16 offset0:130 offset1:131
    ds_read_b128 v[104:107], v20 offset:2560
    ds_read2_b32 v[72:73], v17 offset0:0 offset1:1
    ds_read2_b32 v[74:75], v17 offset0:2 offset1:3
    ds_read_b128 v[108:111], v20 offset:2048
    ds_read2_b32 v[76:77], v17 offset0:128 offset1:129
    ds_read2_b32 v[78:79], v17 offset0:130 offset1:131
    ds_read_b128 v[112:115], v20 offset:1536
    ds_read2_b32 v[80:81], v18 offset0:0 offset1:1
    ds_read2_b32 v[82:83], v18 offset0:2 offset1:3
    ds_read_b128 v[116:119], v20 offset:1024
    ds_read2_b32 v[84:85], v18 offset0:128 offset1:129
    ds_read2_b32 v[86:87], v18 offset0:130 offset1:131
    ds_read_b128 v[120:123], v20 offset:512
    ds_read2_b32 v[88:89], v19 offset0:0 offset1:1
    ds_read2_b32 v[90:91], v19 offset0:2 offset1:3
    ds_read_b128 v[124:127], v20 offset:0
    ds_read2_b32 v[92:93], v19 offset0:128 offset1:129
    ds_read2_b32 v[94:95], v19 offset0:130 offset1:131
    s_waitcnt lgkmcnt(0)
    v_mfma_f32_16x16x32_bf16 v[32:35], v[24:27], v[96:99], 0
    v_mfma_f32_16x16x32_bf16 v[36:39], v[24:27], v[100:103], 0
    v_mfma_f32_16x16x32_bf16 v[40:43], v[24:27], v[104:107], 0
    v_mfma_f32_16x16x32_bf16 v[44:47], v[24:27], v[108:111], 0
    v_mfma_f32_16x16x32_bf16 v[48:51], v[24:27], v[112:115], 0
    v_mfma_f32_16x16x32_bf16 v[52:55], v[24:27], v[116:119], 0
    v_mfma_f32_16x16x32_bf16 v[56:59], v[24:27], v[120:123], 0
    v_mfma_f32_16x16x32_bf16 v[60:63], v[24:27], v[124:127], 0
    s_mov_b32 s51, 0
K1L_conv:
    v_mfma_f32_16x16x32_bf16 v[32:35], v[64:67], v[96:99], v[32:35]
    ds_read_b128 v[160:163], v20 offset:3648
    v_mfma_f32_16x16x32_bf16 v[36:39], v[64:67], v[100:103], v[36:39]
    ds_read2_b32 v[128:129], v16 offset0:16 offset1:17
    v_mfma_f32_16x16x32_bf16 v[40:43], v[64:67], v[104:107], v[40:43]
    ds_read2_b32 v[130:131], v16 offset0:18 offset1:19
    v_mfma_f32_16x16x32_bf16 v[44:47], v[64:67], v[108:111], v[44:47]
    ds_read_b128 v[164:167], v20 offset:3136
    v_mfma_f32_16x16x32_bf16 v[48:51], v[64:67], v[112:115], v[48:51]
    ds_read2_b32 v[132:133], v16 offset0:144 offset1:145
    v_mfma_f32_16x16x32_bf16 v[52:55], v[64:67], v[116:119], v[52:55]
    ds_read2_b32 v[134:135], v16 offset0:146 offset1:147
    v_mfma_f32_16x16x32_bf16 v[56:59], v[64:67], v[120:123], v[56:59]
    ds_read_b128 v[168:171], v20 offset:2624
    v_mfma_f32_16x16x32_bf16 v[60:63], v[64:67], v[124:127], v[60:63]
    ds_read2_b32 v[136:137], v17 offset0:16 offset1:17
    v_mfma_f32_16x16x32_bf16 v[36:39], v[68:71], v[96:99], v[36:39]
    ds_read2_b32 v[138:139], v17 offset0:18 offset1:19
    v_mfma_f32_16x16x32_bf16 v[40:43], v[68:71], v[100:103], v[40:43]
    ds_read_b128 v[172:175], v20 offset:2112
    v_mfma_f32_16x16x32_bf16 v[44:47], v[68:71], v[104:107], v[44:47]
    ds_read2_b32 v[140:141], v17 offset0:144 offset1:145
    v_mfma_f32_16x16x32_bf16 v[48:51], v[68:71], v[108:111], v[48:51]
    ds_read2_b32 v[142:143], v17 offset0:146 offset1:147
    v_mfma_f32_16x16x32_bf16 v[52:55], v[68:71], v[112:115], v[52:55]
    ds_read_b128 v[176:179], v20 offset:1600
    v_mfma_f32_16x16x32_bf16 v[56:59], v[68:71], v[116:119], v[56:59]
    ds_read2_b32 v[144:145], v18 offset0:16 offset1:17
    v_mfma_f32_16x16x32_bf16 v[60:63], v[68:71], v[120:123], v[60:63]
    ds_read2_b32 v[146:147], v18 offset0:18 offset1:19
    v_mfma_f32_16x16x32_bf16 v[40:43], v[72:75], v[96:99], v[40:43]
    ds_read_b128 v[180:183], v20 offset:1088
    v_mfma_f32_16x16x32_bf16 v[44:47], v[72:75], v[100:103], v[44:47]
    ds_read2_b32 v[148:149], v18 offset0:144 offset1:145
    v_mfma_f32_16x16x32_bf16 v[48:51], v[72:75], v[104:107], v[48:51]
    ds_read2_b32 v[150:151], v18 offset0:146 offset1:147
    v_mfma_f32_16x16x32_bf16 v[52:55], v[72:75], v[108:111], v[52:55]
    ds_read_b128 v[184:187], v20 offset:576
    v_mfma_f32_16x16x32_bf16 v[56:59], v[72:75], v[112:115], v[56:59]
    ds_read2_b32 v[152:153], v19 offset0:16 offset1:17
    v_mfma_f32_16x16x32_bf16 v[60:63], v[72:75], v[116:119], v[60:63]
    ds_read2_b32 v[154:155], v19 offset0:18 offset1:19
    v_mfma_f32_16x16x32_bf16 v[44:47], v[76:79], v[96:99], v[44:47]
    ds_read_b128 v[188:191], v20 offset:64
    v_mfma_f32_16x16x32_bf16 v[48:51], v[76:79], v[100:103], v[48:51]
    ds_read2_b32 v[156:157], v19 offset0:144 offset1:145
    v_mfma_f32_16x16x32_bf16 v[52:55], v[76:79], v[104:107], v[52:55]
    ds_read2_b32 v[158:159], v19 offset0:146 offset1:147
    v_mfma_f32_16x16x32_bf16 v[56:59], v[76:79], v[108:111], v[56:59]
    v_mfma_f32_16x16x32_bf16 v[60:63], v[76:79], v[112:115], v[60:63]
    v_mfma_f32_16x16x32_bf16 v[48:51], v[80:83], v[96:99], v[48:51]
    v_mfma_f32_16x16x32_bf16 v[52:55], v[80:83], v[100:103], v[52:55]
    v_mfma_f32_16x16x32_bf16 v[56:59], v[80:83], v[104:107], v[56:59]
    v_mfma_f32_16x16x32_bf16 v[60:63], v[80:83], v[108:111], v[60:63]
    v_mfma_f32_16x16x32_bf16 v[52:55], v[84:87], v[96:99], v[52:55]
    v_mfma_f32_16x16x32_bf16 v[56:59], v[84:87], v[100:103], v[56:59]
    v_mfma_f32_16x16x32_bf16 v[60:63], v[84:87], v[104:107], v[60:63]
    v_mfma_f32_16x16x32_bf16 v[56:59], v[88:91], v[96:99], v[56:59]
    v_mfma_f32_16x16x32_bf16 v[60:63], v[88:91], v[100:103], v[60:63]
    v_mfma_f32_16x16x32_bf16 v[60:63], v[92:95], v[96:99], v[60:63]
    s_waitcnt lgkmcnt(0)
    v_mfma_f32_16x16x32_bf16 v[32:35], v[128:131], v[160:163], v[32:35]
    ds_read_b128 v[96:99], v20 offset:3712
    v_mfma_f32_16x16x32_bf16 v[36:39], v[128:131], v[164:167], v[36:39]
    ds_read2_b32 v[64:65], v16 offset0:32 offset1:33
    v_mfma_f32_16x16x32_bf16 v[40:43], v[128:131], v[168:171], v[40:43]
    ds_read2_b32 v[66:67], v16 offset0:34 offset1:35
    v_mfma_f32_16x16x32_bf16 v[44:47], v[128:131], v[172:175], v[44:47]
    ds_read_b128 v[100:103], v20 offset:3200
    v_mfma_f32_16x16x32_bf16 v[48:51], v[128:131], v[176:179], v[48:51]
    ds_read2_b32 v[68:69], v16 offset0:160 offset1:161
    v_mfma_f32_16x16x32_bf16 v[52:55], v[128:131], v[180:183], v[52:55]
    ds_read2_b32 v[70:71], v16 offset0:162 offset1:163
    v_mfma_f32_16x16x32_bf16 v[56:59], v[128:131], v[184:187], v[56:59]
    ds_read_b128 v[104:107], v20 offset:2688
    v_mfma_f32_16x16x32_bf16 v[60:63], v[128:131], v[188:191], v[60:63]
    ds_read2_b32 v[72:73], v17 offset0:32 offset1:33
    v_mfma_f32_16x16x32_bf16 v[36:39], v[132:135], v[160:163], v[36:39]
    ds_read2_b32 v[74:75], v17 offset0:34 offset1:35
    v_mfma_f32_16x16x32_bf16 v[40:43], v[132:135], v[164:167], v[40:43]
    ds_read_b128 v[108:111], v20 offset:2176
    v_mfma_f32_16x16x32_bf16 v[44:47], v[132:135], v[168:171], v[44:47]
    ds_read2_b32 v[76:77], v17 offset0:160 offset1:161
    v_mfma_f32_16x16x32_bf16 v[48:51], v[132:135], v[172:175], v[48:51]
    ds_read2_b32 v[78:79], v17 offset0:162 offset1:163
    v_mfma_f32_16x16x32_bf16 v[52:55], v[132:135], v[176:179], v[52:55]
    ds_read_b128 v[112:115], v20 offset:1664
    v_mfma_f32_16x16x32_bf16 v[56:59], v[132:135], v[180:183], v[56:59]
    ds_read2_b32 v[80:81], v18 offset0:32 offset1:33
    v_mfma_f32_16x16x32_bf16 v[60:63], v[132:135], v[184:187], v[60:63]
    ds_read2_b32 v[82:83], v18 offset0:34 offset1:35
    v_mfma_f32_16x16x32_bf16 v[40:43], v[136:139], v[160:163], v[40:43]
    ds_read_b128 v[116:119], v20 offset:1152
    v_mfma_f32_16x16x32_bf16 v[44:47], v[136:139], v[164:167], v[44:47]
    ds_read2_b32 v[84:85], v18 offset0:160 offset1:161
    v_mfma_f32_16x16x32_bf16 v[48:51], v[136:139], v[168:171], v[48:51]
    ds_read2_b32 v[86:87], v18 offset0:162 offset1:163
    v_mfma_f32_16x16x32_bf16 v[52:55], v[136:139], v[172:175], v[52:55]
    ds_read_b128 v[120:123], v20 offset:640
    v_mfma_f32_16x16x32_bf16 v[56:59], v[136:139], v[176:179], v[56:59]
    ds_read2_b32 v[88:89], v19 offset0:32 offset1:33
    v_mfma_f32_16x16x32_bf16 v[60:63], v[136:139], v[180:183], v[60:63]
    ds_read2_b32 v[90:91], v19 offset0:34 offset1:35
    v_mfma_f32_16x16x32_bf16 v[44:47], v[140:143], v[160:163], v[44:47]
    ds_read_b128 v[124:127], v20 offset:128
    v_mfma_f32_16x16x32_bf16 v[48:51], v[140:143], v[164:167], v[48:51]
    ds_read2_b32 v[92:93], v19 offset0:160 offset1:161
    v_mfma_f32_16x16x32_bf16 v[52:55], v[140:143], v[168:171], v[52:55]
    ds_read2_b32 v[94:95], v19 offset0:162 offset1:163
    v_mfma_f32_16x16x32_bf16 v[56:59], v[140:143], v[172:175], v[56:59]
    v_add_u32 v16, 128, v16
    v_mfma_f32_16x16x32_bf16 v[60:63], v[140:143], v[176:179], v[60:63]
    v_add_u32 v17, 128, v17
    v_mfma_f32_16x16x32_bf16 v[48:51], v[144:147], v[160:163], v[48:51]
    v_add_u32 v18, 128, v18
    v_mfma_f32_16x16x32_bf16 v[52:55], v[144:147], v[164:167], v[52:55]
    v_add_u32 v19, 128, v19
    v_mfma_f32_16x16x32_bf16 v[56:59], v[144:147], v[168:171], v[56:59]
    v_add_u32 v20, 128, v20
    v_mfma_f32_16x16x32_bf16 v[60:63], v[144:147], v[172:175], v[60:63]
    v_mfma_f32_16x16x32_bf16 v[52:55], v[148:151], v[160:163], v[52:55]
    v_mfma_f32_16x16x32_bf16 v[56:59], v[148:151], v[164:167], v[56:59]
    v_mfma_f32_16x16x32_bf16 v[60:63], v[148:151], v[168:171], v[60:63]
    v_mfma_f32_16x16x32_bf16 v[56:59], v[152:155], v[160:163], v[56:59]
    v_mfma_f32_16x16x32_bf16 v[60:63], v[152:155], v[164:167], v[60:63]
    v_mfma_f32_16x16x32_bf16 v[60:63], v[156:159], v[160:163], v[60:63]
    s_add_u32 s51, s51, 1
    s_waitcnt lgkmcnt(0)
    s_cmp_lt_u32 s51, 4
    s_cbranch_scc1 K1L_conv
    s_nop 4
    v_cvt_pk_bf16_f32 v64, v32, v33
    v_cvt_pk_bf16_f32 v65, v34, v35
    v_cvt_pk_bf16_f32 v66, v36, v37
    v_cvt_pk_bf16_f32 v67, v38, v39
    v_cvt_pk_bf16_f32 v68, v40, v41
    v_cvt_pk_bf16_f32 v69, v42, v43
    v_cvt_pk_bf16_f32 v70, v44, v45
    v_cvt_pk_bf16_f32 v71, v46, v47
    v_cvt_pk_bf16_f32 v72, v48, v49
    v_cvt_pk_bf16_f32 v73, v50, v51
    v_cvt_pk_bf16_f32 v74, v52, v53
    v_cvt_pk_bf16_f32 v75, v54, v55
    v_cvt_pk_bf16_f32 v76, v56, v57
    v_cvt_pk_bf16_f32 v77, v58, v59
    v_cvt_pk_bf16_f32 v78, v60, v61
    v_cvt_pk_bf16_f32 v79, v62, v63
    s_nop 1
    v_permlane16_swap_b32 v64, v66
    v_permlane16_swap_b32 v65, v67
    v_permlane16_swap_b32 v68, v70
    v_permlane16_swap_b32 v69, v71
    v_permlane16_swap_b32 v72, v74
    v_permlane16_swap_b32 v73, v75
    v_permlane16_swap_b32 v76, v78
    v_permlane16_swap_b32 v77, v79
    buffer_store_dwordx4 v[64:67], v21, s[80:83], 0 offen offset:0 sc1
    buffer_store_dwordx4 v[68:71], v21, s[80:83], 0 offen offset:1024 sc1
    buffer_store_dwordx4 v[72:75], v21, s[80:83], 0 offen offset:2048 sc1
    buffer_store_dwordx4 v[76:79], v21, s[80:83], 0 offen offset:3072 sc1
    s_endpgm
K1_compute:
    v_and_b32 v12, 15, v2
    v_lshrrev_b32 v13, 4, v2
    v_lshrrev_b32 v3, 1, v12
    v_xor_b32 v3, v3, v13
    v_lshlrev_b32 v3, 4, v3
    v_lshl_add_u32 v4, v12, 7, v3
    v_xor_b32 v6, 64, v4
    v_add_u32 v5, 0x10000, v4
    v_add_u32 v7, 0x10000, v6
    s_lshl_b32 s6, s5, 12
    s_add_u32 s6, s6, 16384
    v_add_u32 v8, s6, v4
    v_add_u32 v9, s6, v5
    v_add_u32 v10, s6, v6
    v_add_u32 v11, s6, v7
    s_lshl_b32 s6, s4, 2
    s_add_u32 s6, s6, s5
    s_lshl_b32 s6, s6, 4
    v_add_u32 v14, s6, v12
    v_lshlrev_b32 v44, 1, v14
    s_waitcnt lgkmcnt(0)
    s_mov_b32 s20, s58
    s_mov_b32 s21, s59
    s_mov_b32 s22, 2048
    s_mov_b32 s23, 0x00020000
    s_mov_b32 s24, s46
    s_mov_b32 s25, s47
    s_mov_b32 s26, 2048
    s_mov_b32 s27, 0x00020000
    s_mov_b32 s28, s48
    s_mov_b32 s29, s49
    s_mov_b32 s30, 2048
    s_mov_b32 s31, 0x00020000
    buffer_load_ushort v45, v44, s[20:23], 0 offen
    buffer_load_ushort v46, v44, s[24:27], 0 offen
    buffer_load_ushort v47, v44, s[28:31], 0 offen
    s_mov_b32 s16, s64
    s_mov_b32 s17, s65
    s_mov_b32 s18, 256
    s_mov_b32 s19, 0x00020000
    s_or_b32 s6, s2, s5
    s_cmp_eq_u32 s6, 0
    s_cbranch_scc0 K1C_nonce_w
    s_memrealtime s[6:7]
    v_mov_b32 v1, 0
    s_waitcnt lgkmcnt(0)
    s_or_b32 s6, s6, 1
    v_mov_b32 v48, s6
    v_mov_b32 v49, s7
    s_mov_b64 exec, 1
    buffer_store_dwordx2 v[48:49], v1, s[16:19], 0 offen sc1
    s_mov_b64 exec, -1
K1C_nonce_w:
    s_add_u32 s8, s66, 8388608
    s_addc_u32 s9, s67, 0
    s_mov_b32 s10, 8388608
    s_mov_b32 s11, 0x00020000
    s_add_u32 s12, s66, 16777216
    s_addc_u32 s13, s67, 0
    s_mov_b32 s14, 262144
    s_mov_b32 s15, 0x00020000
    s_mov_b32 s68, s66
    s_mov_b32 s69, s67
    s_mov_b32 s70, 4194304
    s_mov_b32 s71, 0x00020000
    s_lshr_b32 s7, s2, 3
    s_and_b32 s32, s7, 15
    s_lshr_b32 s7, s7, 4
    s_and_b32 s33, s2, 7
    s_lshl_b32 s33, s33, 1
    s_add_u32 s33, s33, s7
    s_mov_b32 s36, 16384
    s_mov_b32 s37, 32768
    s_mov_b32 s38, 49152
    s_lshl_b32 s6, s5, 2
    v_xor_b32 v1, s6, v12
    v_lshlrev_b32 v1, 4, v1
    v_lshl_add_u32 v1, v13, 8, v1
    s_lshl_b32 s6, s5, 12
    s_add_u32 s6, s6, 147456
    v_add_u32 v37, s6, v1
    v_xor_b32 v38, 16, v37
    v_xor_b32 v39, 32, v37
    v_xor_b32 v40, 48, v37
    s_lshl_b32 s6, s33, 2
    s_add_u32 s6, s6, s5
    s_lshl_b32 s6, s6, 16
    s_lshl_b32 s7, s32, 8
    s_sub_u32 s7, 3840, s7
    s_add_u32 s6, s6, s7
    v_lshlrev_b32 v1, 12, v13
    v_lshl_add_u32 v1, v12, 4, v1
    v_add_u32 v41, s6, v1
    s_lshl_b32 s6, s3, 14
    v_lshlrev_b32 v1, 4, v14
    v_add_u32 v34, s6, v1
    v_lshlrev_b32 v1, 14, v13
    v_sub_u32 v1, v34, v1
    v_subrev_u32 v30, 0x4000, v1
    v_subrev_u32 v31, 0x14000, v1
    v_subrev_u32 v32, 0x24000, v1
    v_subrev_u32 v33, 0x34000, v1
    v_cmp_gt_i32 s[40:41], 0, v30
    v_cmp_gt_i32 s[42:43], 0, v31
    v_cmp_gt_i32 s[44:45], 0, v32
    v_cmp_gt_i32 s[46:47], 0, v33
    s_lshl_b32 s6, s3, 4
    s_add_u32 s6, s6, s4
    s_lshl_b32 s6, s6, 15
    s_lshl_b32 s7, s5, 8
    s_add_u32 s6, s6, s7
    v_lshlrev_b32 v1, 12, v13
    v_lshl_add_u32 v1, v12, 4, v1
    v_add_u32 v35, s6, v1
    v_xor_b32 v36, 64, v35
    v_cmp_eq_u32 s[48:49], 1, v13
    v_cmp_eq_u32 s[50:51], 2, v13
    v_cmp_eq_u32 s[52:53], 3, v13
    v_mov_b32 v64, 0
    v_mov_b32 v65, 0
    v_mov_b32 v66, 0
    v_mov_b32 v67, 0
    v_mov_b32 v68, 0
    v_mov_b32 v69, 0
    v_mov_b32 v70, 0
    v_mov_b32 v71, 0
    v_mov_b32 v72, 0
    v_mov_b32 v73, 0
    v_mov_b32 v74, 0
    v_mov_b32 v75, 0
    v_mov_b32 v76, 0
    v_mov_b32 v77, 0
    v_mov_b32 v78, 0
    v_mov_b32 v79, 0
    v_mov_b32 v80, 0
    v_mov_b32 v81, 0
    v_mov_b32 v82, 0
    v_mov_b32 v83, 0
    v_mov_b32 v84, 0
    v_mov_b32 v85, 0
    v_mov_b32 v86, 0
    v_mov_b32 v87, 0
    v_mov_b32 v88, 0
    v_mov_b32 v89, 0
    v_mov_b32 v90, 0
    v_mov_b32 v91, 0
    v_mov_b32 v92, 0
    v_mov_b32 v93, 0
    v_mov_b32 v94, 0
    v_mov_b32 v95, 0
    v_mov_b32 v96, 0
    v_mov_b32 v97, 0
    v_mov_b32 v98, 0
    v_mov_b32 v99, 0
    v_mov_b32 v100, 0
    v_mov_b32 v101, 0
    v_mov_b32 v102, 0
    v_mov_b32 v103, 0
    v_mov_b32 v104, 0
    v_mov_b32 v105, 0
    v_mov_b32 v106, 0
    v_mov_b32 v107, 0
    v_mov_b32 v108, 0
    v_mov_b32 v109, 0
    v_mov_b32 v110, 0
    v_mov_b32 v111, 0
    v_mov_b32 v112, 0
    v_mov_b32 v113, 0
    v_mov_b32 v114, 0
    v_mov_b32 v115, 0
    v_mov_b32 v116, 0
    v_mov_b32 v117, 0
    v_mov_b32 v118, 0
    v_mov_b32 v119, 0
    v_mov_b32 v120, 0
    v_mov_b32 v121, 0
    v_mov_b32 v122, 0
    v_mov_b32 v123, 0
    v_mov_b32 v124, 0
    v_mov_b32 v125, 0
    v_mov_b32 v126, 0
    v_mov_b32 v127, 0
    s_waitcnt vmcnt(0)
    v_lshlrev_b32 v45, 16, v45
    v_lshlrev_b32 v46, 16, v46
    v_lshlrev_b32 v47, 16, v47
    v_mul_f32 v45, 0x3fb8aa3b, v45
    v_exp_f32 v45, v45
    s_nop 0
    v_cvt_pk_bf16_f32 v45, v45, v45
    v_lshlrev_b32 v45, 16, v45
    v_mul_f32 v48, v45, v46
    v_mul_f32 v49, v45, v47
    v_mul_f32 v48, 0x3fb8aa3b, v48
    v_exp_f32 v48, v48
    v_mul_f32 v49, 0.15915494, v49
    v_cos_f32 v50, v49
    v_sin_f32 v51, v49
    s_nop 0
    v_mul_f32 v16, v48, v50
    v_mul_f32 v17, v48, v51
    v_add_f32 v48, -1.0, v16
    v_mul_f32 v49, v46, v46
    v_fmac_f32 v49, v47, v47
    v_rcp_f32 v49, v49
    v_mul_f32 v50, v48, v46
    v_fmac_f32 v50, v17, v47
    v_mul_f32 v51, v17, v46
    v_fma_f32 v51, -v48, v47, v51
    v_add_f32 v49, v49, v49
    v_mul_f32 v20, v50, v49
    v_mul_f32 v21, v51, v49
    v_xor_b32 v18, 0x80000000, v17
    v_xor_b32 v42, 0x80000000, v20
    v_xor_b32 v43, 0x80000000, v21
    v_mul_f32 v44, v16, v16
    v_mul_f32 v45, v16, v17
    v_fma_f32 v44, -v17, v17, v44
    v_fmac_f32 v45, v17, v16
    v_mul_f32 v46, v44, v44
    v_mul_f32 v47, v44, v45
    v_fma_f32 v46, -v45, v45, v46
    v_fmac_f32 v47, v45, v44
    v_mul_f32 v44, v46, v46
    v_mul_f32 v45, v46, v47
    v_fma_f32 v44, -v47, v47, v44
    v_fmac_f32 v45, v47, v46
    v_mul_f32 v46, v44, v44
    v_mul_f32 v47, v44, v45
    v_fma_f32 v46, -v45, v45, v46
    v_fmac_f32 v47, v45, v44
    v_mul_f32 v22, v46, v46
    v_mul_f32 v23, v46, v47
    v_fma_f32 v22, -v47, v47, v22
    v_fmac_f32 v23, v47, v46
    v_mul_f32 v44, v22, v22
    v_mul_f32 v45, v22, v23
    v_fma_f32 v44, -v23, v23, v44
    v_fmac_f32 v45, v23, v22
    v_mul_f32 v46, v44, v22
    v_mul_f32 v47, v44, v23
    v_fma_f32 v46, -v45, v23, v46
    v_fmac_f32 v47, v45, v22
    v_mov_b32 v48, 1.0
    v_mov_b32 v49, 0
    v_cndmask_b32 v48, v48, v22, s[48:49]
    v_cndmask_b32 v49, v49, v23, s[48:49]
    v_cndmask_b32 v48, v48, v44, s[50:51]
    v_cndmask_b32 v49, v49, v45, s[50:51]
    v_cndmask_b32 v48, v48, v46, s[52:53]
    v_cndmask_b32 v49, v49, v47, s[52:53]
    v_mul_f32 v24, v20, v48
    v_mul_f32 v25, v20, v49
    v_fma_f32 v24, -v21, v49, v24
    v_fmac_f32 v25, v21, v48
    v_mul_f32 v46, v44, v44
    v_mul_f32 v47, v44, v45
    v_fma_f32 v46, -v45, v45, v46
    v_fmac_f32 v47, v45, v44
    v_mul_f32 v44, v46, v46
    v_mul_f32 v45, v46, v47
    v_fma_f32 v44, -v47, v47, v44
    v_fmac_f32 v45, v47, v46
    v_mul_f32 v48, v44, v46
    v_mul_f32 v49, v44, v47
    v_fma_f32 v48, -v45, v47, v48
    v_fmac_f32 v49, v45, v46
    v_mul_f32 v28, v44, v44
    v_mul_f32 v29, v44, v45
    v_fma_f32 v28, -v45, v45, v28
    v_fmac_f32 v29, v45, v44
    v_mov_b32 v26, 1.0
    v_mov_b32 v27, 0
    v_cndmask_b32 v26, v26, v46, s[48:49]
    v_cndmask_b32 v27, v27, v47, s[48:49]
    v_cndmask_b32 v26, v26, v44, s[50:51]
    v_cndmask_b32 v27, v27, v45, s[50:51]
    v_cndmask_b32 v26, v26, v48, s[52:53]
    v_cndmask_b32 v27, v27, v49, s[52:53]
    s_barrier
    ds_read_b128 v[160:163], v9 offset:32768
    ds_read_b128 v[164:167], v9 offset:34816
    ds_read_b128 v[128:131], v5 offset:32768
    ds_read_b128 v[132:135], v5 offset:34816
    ds_read_b128 v[136:139], v5 offset:36864
    ds_read_b128 v[140:143], v5 offset:38912
    ds_read_b128 v[144:147], v5 offset:40960
    ds_read_b128 v[148:151], v5 offset:43008
    ds_read_b128 v[152:155], v5 offset:45056
    ds_read_b128 v[156:159], v5 offset:47104
    s_setprio 3
    s_mov_b32 s30, 0
    s_mov_b32 s31, s5
K1C_loop:
    s_waitcnt lgkmcnt(0)
    v_mfma_f32_16x16x32_bf16 v[64:67], v[128:131], v[160:163], v[64:67]
    ds_read_b128 v[200:203], v11 offset:32768
    v_mfma_f32_16x16x32_bf16 v[68:71], v[128:131], v[164:167], v[68:71]
    ds_read_b128 v[204:207], v11 offset:34816
    v_mfma_f32_16x16x32_bf16 v[76:79], v[132:135], v[164:167], v[76:79]
    ds_read_b128 v[168:171], v7 offset:32768
    v_mfma_f32_16x16x32_bf16 v[72:75], v[132:135], v[160:163], v[72:75]
    ds_read_b128 v[172:175], v7 offset:34816
    v_mfma_f32_16x16x32_bf16 v[80:83], v[136:139], v[160:163], v[80:83]
    ds_read_b128 v[176:179], v7 offset:36864
    v_mfma_f32_16x16x32_bf16 v[84:87], v[136:139], v[164:167], v[84:87]
    ds_read_b128 v[180:183], v7 offset:38912
    v_mfma_f32_16x16x32_bf16 v[92:95], v[140:143], v[164:167], v[92:95]
    ds_read_b128 v[184:187], v7 offset:40960
    v_mfma_f32_16x16x32_bf16 v[88:91], v[140:143], v[160:163], v[88:91]
    ds_read_b128 v[188:191], v7 offset:43008
    v_mfma_f32_16x16x32_bf16 v[96:99], v[144:147], v[160:163], v[96:99]
    ds_read_b128 v[192:195], v7 offset:45056
    v_mfma_f32_16x16x32_bf16 v[100:103], v[144:147], v[164:167], v[100:103]
    ds_read_b128 v[196:199], v7 offset:47104
    v_mfma_f32_16x16x32_bf16 v[108:111], v[148:151], v[164:167], v[108:111]
    v_mfma_f32_16x16x32_bf16 v[104:107], v[148:151], v[160:163], v[104:107]
    v_mfma_f32_16x16x32_bf16 v[112:115], v[152:155], v[160:163], v[112:115]
    v_mfma_f32_16x16x32_bf16 v[116:119], v[152:155], v[164:167], v[116:119]
    v_mfma_f32_16x16x32_bf16 v[124:127], v[156:159], v[164:167], v[124:127]
    v_mfma_f32_16x16x32_bf16 v[120:123], v[156:159], v[160:163], v[120:123]
    s_waitcnt lgkmcnt(0)
    s_barrier
    s_cmp_eq_u32 s30, 0
    s_cbranch_scc0 K1C_s0
    ds_read_b128 v[208:211], v37 offset:0
    ds_read_b128 v[212:215], v38 offset:1024
    ds_read_b128 v[216:219], v39 offset:2048
    ds_read_b128 v[220:223], v40 offset:3072
K1C_s0:
    v_mfma_f32_16x16x32_bf16 v[64:67], v[168:171], v[200:203], v[64:67]
    ds_read_b128 v[160:163], v8 offset:0
    v_mfma_f32_16x16x32_bf16 v[68:71], v[168:171], v[204:207], v[68:71]
    ds_read_b128 v[164:167], v8 offset:2048
    v_mfma_f32_16x16x32_bf16 v[76:79], v[172:175], v[204:207], v[76:79]
    ds_read_b128 v[128:131], v4 offset:0
    v_mfma_f32_16x16x32_bf16 v[72:75], v[172:175], v[200:203], v[72:75]
    ds_read_b128 v[132:135], v4 offset:2048
    v_mfma_f32_16x16x32_bf16 v[80:83], v[176:179], v[200:203], v[80:83]
    ds_read_b128 v[136:139], v4 offset:4096
    v_mfma_f32_16x16x32_bf16 v[84:87], v[176:179], v[204:207], v[84:87]
    ds_read_b128 v[140:143], v4 offset:6144
    v_mfma_f32_16x16x32_bf16 v[92:95], v[180:183], v[204:207], v[92:95]
    ds_read_b128 v[144:147], v4 offset:8192
    v_mfma_f32_16x16x32_bf16 v[88:91], v[180:183], v[200:203], v[88:91]
    ds_read_b128 v[148:151], v4 offset:10240
    v_mfma_f32_16x16x32_bf16 v[96:99], v[184:187], v[200:203], v[96:99]
    ds_read_b128 v[152:155], v4 offset:12288
    v_mfma_f32_16x16x32_bf16 v[100:103], v[184:187], v[204:207], v[100:103]
    ds_read_b128 v[156:159], v4 offset:14336
    v_mfma_f32_16x16x32_bf16 v[108:111], v[188:191], v[204:207], v[108:111]
    v_mfma_f32_16x16x32_bf16 v[104:107], v[188:191], v[200:203], v[104:107]
    v_mfma_f32_16x16x32_bf16 v[112:115], v[192:195], v[200:203], v[112:115]
    v_mfma_f32_16x16x32_bf16 v[116:119], v[192:195], v[204:207], v[116:119]
    v_mfma_f32_16x16x32_bf16 v[124:127], v[196:199], v[204:207], v[124:127]
    v_mfma_f32_16x16x32_bf16 v[120:123], v[196:199], v[200:203], v[120:123]
    s_waitcnt lgkmcnt(0)
    s_cmp_eq_u32 s30, 0
    s_cbranch_scc0 K1C_s1
    buffer_store_dwordx4 v[208:211], v41, s[68:71], 0 offen sc1
    buffer_store_dwordx4 v[212:215], v41, s[68:71], s36 offen sc1
    buffer_store_dwordx4 v[216:219], v41, s[68:71], s37 offen sc1
    buffer_store_dwordx4 v[220:223], v41, s[68:71], s38 offen sc1
K1C_s1:
    v_mfma_f32_16x16x32_bf16 v[64:67], v[128:131], v[160:163], v[64:67]
    ds_read_b128 v[200:203], v10 offset:0
    v_mfma_f32_16x16x32_bf16 v[68:71], v[128:131], v[164:167], v[68:71]
    ds_read_b128 v[204:207], v10 offset:2048
    v_mfma_f32_16x16x32_bf16 v[76:79], v[132:135], v[164:167], v[76:79]
    ds_read_b128 v[168:171], v6 offset:0
    v_mfma_f32_16x16x32_bf16 v[72:75], v[132:135], v[160:163], v[72:75]
    ds_read_b128 v[172:175], v6 offset:2048
    v_mfma_f32_16x16x32_bf16 v[80:83], v[136:139], v[160:163], v[80:83]
    ds_read_b128 v[176:179], v6 offset:4096
    v_mfma_f32_16x16x32_bf16 v[84:87], v[136:139], v[164:167], v[84:87]
    ds_read_b128 v[180:183], v6 offset:6144
    v_mfma_f32_16x16x32_bf16 v[92:95], v[140:143], v[164:167], v[92:95]
    ds_read_b128 v[184:187], v6 offset:8192
    v_mfma_f32_16x16x32_bf16 v[88:91], v[140:143], v[160:163], v[88:91]
    ds_read_b128 v[188:191], v6 offset:10240
    v_mfma_f32_16x16x32_bf16 v[96:99], v[144:147], v[160:163], v[96:99]
    ds_read_b128 v[192:195], v6 offset:12288
    v_mfma_f32_16x16x32_bf16 v[100:103], v[144:147], v[164:167], v[100:103]
    ds_read_b128 v[196:199], v6 offset:14336
    v_mfma_f32_16x16x32_bf16 v[108:111], v[148:151], v[164:167], v[108:111]
    v_mfma_f32_16x16x32_bf16 v[104:107], v[148:151], v[160:163], v[104:107]
    v_mfma_f32_16x16x32_bf16 v[112:115], v[152:155], v[160:163], v[112:115]
    v_mfma_f32_16x16x32_bf16 v[116:119], v[152:155], v[164:167], v[116:119]
    v_mfma_f32_16x16x32_bf16 v[124:127], v[156:159], v[164:167], v[124:127]
    v_mfma_f32_16x16x32_bf16 v[120:123], v[156:159], v[160:163], v[120:123]
    s_cmp_eq_u32 s30, 1
    s_cbranch_scc0 K1C_s2
    s_waitcnt vmcnt(0)
K1C_s2:
    s_waitcnt lgkmcnt(0)
    s_barrier
    v_mfma_f32_16x16x32_bf16 v[64:67], v[168:171], v[200:203], v[64:67]
    ds_read_b128 v[160:163], v8 offset:32768
    v_mfma_f32_16x16x32_bf16 v[68:71], v[168:171], v[204:207], v[68:71]
    ds_read_b128 v[164:167], v8 offset:34816
    v_mfma_f32_16x16x32_bf16 v[76:79], v[172:175], v[204:207], v[76:79]
    ds_read_b128 v[128:131], v4 offset:32768
    v_mfma_f32_16x16x32_bf16 v[72:75], v[172:175], v[200:203], v[72:75]
    ds_read_b128 v[132:135], v4 offset:34816
    v_mfma_f32_16x16x32_bf16 v[80:83], v[176:179], v[200:203], v[80:83]
    ds_read_b128 v[136:139], v4 offset:36864
    v_mfma_f32_16x16x32_bf16 v[84:87], v[176:179], v[204:207], v[84:87]
    ds_read_b128 v[140:143], v4 offset:38912
    v_mfma_f32_16x16x32_bf16 v[92:95], v[180:183], v[204:207], v[92:95]
    ds_read_b128 v[144:147], v4 offset:40960
    v_mfma_f32_16x16x32_bf16 v[88:91], v[180:183], v[200:203], v[88:91]
    ds_read_b128 v[148:151], v4 offset:43008
    v_mfma_f32_16x16x32_bf16 v[96:99], v[184:187], v[200:203], v[96:99]
    ds_read_b128 v[152:155], v4 offset:45056
    v_mfma_f32_16x16x32_bf16 v[100:103], v[184:187], v[204:207], v[100:103]
    ds_read_b128 v[156:159], v4 offset:47104
    v_mfma_f32_16x16x32_bf16 v[108:111], v[188:191], v[204:207], v[108:111]
    v_mfma_f32_16x16x32_bf16 v[104:107], v[188:191], v[200:203], v[104:107]
    v_mfma_f32_16x16x32_bf16 v[112:115], v[192:195], v[200:203], v[112:115]
    v_mfma_f32_16x16x32_bf16 v[116:119], v[192:195], v[204:207], v[116:119]
    v_mfma_f32_16x16x32_bf16 v[124:127], v[196:199], v[204:207], v[124:127]
    v_mfma_f32_16x16x32_bf16 v[120:123], v[196:199], v[200:203], v[120:123]
    s_waitcnt lgkmcnt(0)
    v_mfma_f32_16x16x32_bf16 v[64:67], v[128:131], v[160:163], v[64:67]
    ds_read_b128 v[200:203], v10 offset:32768
    v_mfma_f32_16x16x32_bf16 v[68:71], v[128:131], v[164:167], v[68:71]
    ds_read_b128 v[204:207], v10 offset:34816
    v_mfma_f32_16x16x32_bf16 v[76:79], v[132:135], v[164:167], v[76:79]
    ds_read_b128 v[168:171], v6 offset:32768
    v_mfma_f32_16x16x32_bf16 v[72:75], v[132:135], v[160:163], v[72:75]
    ds_read_b128 v[172:175], v6 offset:34816
    v_mfma_f32_16x16x32_bf16 v[80:83], v[136:139], v[160:163], v[80:83]
    ds_read_b128 v[176:179], v6 offset:36864
    v_mfma_f32_16x16x32_bf16 v[84:87], v[136:139], v[164:167], v[84:87]
    ds_read_b128 v[180:183], v6 offset:38912
    v_mfma_f32_16x16x32_bf16 v[92:95], v[140:143], v[164:167], v[92:95]
    ds_read_b128 v[184:187], v6 offset:40960
    v_mfma_f32_16x16x32_bf16 v[88:91], v[140:143], v[160:163], v[88:91]
    ds_read_b128 v[188:191], v6 offset:43008
    v_mfma_f32_16x16x32_bf16 v[96:99], v[144:147], v[160:163], v[96:99]
    ds_read_b128 v[192:195], v6 offset:45056
    v_mfma_f32_16x16x32_bf16 v[100:103], v[144:147], v[164:167], v[100:103]
    ds_read_b128 v[196:199], v6 offset:47104
    v_mfma_f32_16x16x32_bf16 v[108:111], v[148:151], v[164:167], v[108:111]
    v_mfma_f32_16x16x32_bf16 v[104:107], v[148:151], v[160:163], v[104:107]
    v_mfma_f32_16x16x32_bf16 v[112:115], v[152:155], v[160:163], v[112:115]
    v_mfma_f32_16x16x32_bf16 v[116:119], v[152:155], v[164:167], v[116:119]
    v_mfma_f32_16x16x32_bf16 v[124:127], v[156:159], v[164:167], v[124:127]
    v_mfma_f32_16x16x32_bf16 v[120:123], v[156:159], v[160:163], v[120:123]
    s_waitcnt lgkmcnt(0)
    s_barrier
    v_mfma_f32_16x16x32_bf16 v[64:67], v[168:171], v[200:203], v[64:67]
    ds_read_b128 v[160:163], v9 offset:0
    v_mfma_f32_16x16x32_bf16 v[68:71], v[168:171], v[204:207], v[68:71]
    ds_read_b128 v[164:167], v9 offset:2048
    v_mfma_f32_16x16x32_bf16 v[76:79], v[172:175], v[204:207], v[76:79]
    ds_read_b128 v[128:131], v5 offset:0
    v_mfma_f32_16x16x32_bf16 v[72:75], v[172:175], v[200:203], v[72:75]
    ds_read_b128 v[132:135], v5 offset:2048
    v_mfma_f32_16x16x32_bf16 v[80:83], v[176:179], v[200:203], v[80:83]
    ds_read_b128 v[136:139], v5 offset:4096
    v_mfma_f32_16x16x32_bf16 v[84:87], v[176:179], v[204:207], v[84:87]
    ds_read_b128 v[140:143], v5 offset:6144
    v_mfma_f32_16x16x32_bf16 v[92:95], v[180:183], v[204:207], v[92:95]
    ds_read_b128 v[144:147], v5 offset:8192
    v_mfma_f32_16x16x32_bf16 v[88:91], v[180:183], v[200:203], v[88:91]
    ds_read_b128 v[148:151], v5 offset:10240
    v_mfma_f32_16x16x32_bf16 v[96:99], v[184:187], v[200:203], v[96:99]
    ds_read_b128 v[152:155], v5 offset:12288
    v_mfma_f32_16x16x32_bf16 v[100:103], v[184:187], v[204:207], v[100:103]
    ds_read_b128 v[156:159], v5 offset:14336
    v_mfma_f32_16x16x32_bf16 v[108:111], v[188:191], v[204:207], v[108:111]
    v_mfma_f32_16x16x32_bf16 v[104:107], v[188:191], v[200:203], v[104:107]
    v_mfma_f32_16x16x32_bf16 v[112:115], v[192:195], v[200:203], v[112:115]
    v_mfma_f32_16x16x32_bf16 v[116:119], v[192:195], v[204:207], v[116:119]
    v_mfma_f32_16x16x32_bf16 v[124:127], v[196:199], v[204:207], v[124:127]
    v_mfma_f32_16x16x32_bf16 v[120:123], v[196:199], v[200:203], v[120:123]
    s_waitcnt lgkmcnt(0)
    v_mfma_f32_16x16x32_bf16 v[64:67], v[128:131], v[160:163], v[64:67]
    ds_read_b128 v[200:203], v11 offset:0
    v_mfma_f32_16x16x32_bf16 v[68:71], v[128:131], v[164:167], v[68:71]
    ds_read_b128 v[204:207], v11 offset:2048
    v_mfma_f32_16x16x32_bf16 v[76:79], v[132:135], v[164:167], v[76:79]
    ds_read_b128 v[168:171], v7 offset:0
    v_mfma_f32_16x16x32_bf16 v[72:75], v[132:135], v[160:163], v[72:75]
    ds_read_b128 v[172:175], v7 offset:2048
    v_mfma_f32_16x16x32_bf16 v[80:83], v[136:139], v[160:163], v[80:83]
    ds_read_b128 v[176:179], v7 offset:4096
    v_mfma_f32_16x16x32_bf16 v[84:87], v[136:139], v[164:167], v[84:87]
    ds_read_b128 v[180:183], v7 offset:6144
    v_mfma_f32_16x16x32_bf16 v[92:95], v[140:143], v[164:167], v[92:95]
    ds_read_b128 v[184:187], v7 offset:8192
    v_mfma_f32_16x16x32_bf16 v[88:91], v[140:143], v[160:163], v[88:91]
    ds_read_b128 v[188:191], v7 offset:10240
    v_mfma_f32_16x16x32_bf16 v[96:99], v[144:147], v[160:163], v[96:99]
    ds_read_b128 v[192:195], v7 offset:12288
    v_mfma_f32_16x16x32_bf16 v[100:103], v[144:147], v[164:167], v[100:103]
    ds_read_b128 v[196:199], v7 offset:14336
    v_mfma_f32_16x16x32_bf16 v[108:111], v[148:151], v[164:167], v[108:111]
    v_mfma_f32_16x16x32_bf16 v[104:107], v[148:151], v[160:163], v[104:107]
    v_mfma_f32_16x16x32_bf16 v[112:115], v[152:155], v[160:163], v[112:115]
    v_mfma_f32_16x16x32_bf16 v[116:119], v[152:155], v[164:167], v[116:119]
    v_mfma_f32_16x16x32_bf16 v[124:127], v[156:159], v[164:167], v[124:127]
    v_mfma_f32_16x16x32_bf16 v[120:123], v[156:159], v[160:163], v[120:123]
    s_cmp_eq_u32 s30, 3
    s_waitcnt lgkmcnt(0)
    s_cbranch_scc1 K1C_nobar
    s_barrier
K1C_nobar:
    v_mfma_f32_16x16x32_bf16 v[64:67], v[168:171], v[200:203], v[64:67]
    ds_read_b128 v[160:163], v9 offset:32768
    v_mfma_f32_16x16x32_bf16 v[68:71], v[168:171], v[204:207], v[68:71]
    ds_read_b128 v[164:167], v9 offset:34816
    v_mfma_f32_16x16x32_bf16 v[76:79], v[172:175], v[204:207], v[76:79]
    ds_read_b128 v[128:131], v5 offset:32768
    v_mfma_f32_16x16x32_bf16 v[72:75], v[172:175], v[200:203], v[72:75]
    ds_read_b128 v[132:135], v5 offset:34816
    v_mfma_f32_16x16x32_bf16 v[80:83], v[176:179], v[200:203], v[80:83]
    ds_read_b128 v[136:139], v5 offset:36864
    v_mfma_f32_16x16x32_bf16 v[84:87], v[176:179], v[204:207], v[84:87]
    ds_read_b128 v[140:143], v5 offset:38912
    v_mfma_f32_16x16x32_bf16 v[92:95], v[180:183], v[204:207], v[92:95]
    ds_read_b128 v[144:147], v5 offset:40960
    v_mfma_f32_16x16x32_bf16 v[88:91], v[180:183], v[200:203], v[88:91]
    ds_read_b128 v[148:151], v5 offset:43008
    v_mfma_f32_16x16x32_bf16 v[96:99], v[184:187], v[200:203], v[96:99]
    ds_read_b128 v[152:155], v5 offset:45056
    v_mfma_f32_16x16x32_bf16 v[100:103], v[184:187], v[204:207], v[100:103]
    ds_read_b128 v[156:159], v5 offset:47104
    v_mfma_f32_16x16x32_bf16 v[108:111], v[188:191], v[204:207], v[108:111]
    v_mfma_f32_16x16x32_bf16 v[104:107], v[188:191], v[200:203], v[104:107]
    v_mfma_f32_16x16x32_bf16 v[112:115], v[192:195], v[200:203], v[112:115]
    v_mfma_f32_16x16x32_bf16 v[116:119], v[192:195], v[204:207], v[116:119]
    v_mfma_f32_16x16x32_bf16 v[124:127], v[196:199], v[204:207], v[124:127]
    v_mfma_f32_16x16x32_bf16 v[120:123], v[196:199], v[200:203], v[120:123]
    s_add_u32 s30, s30, 1
    s_add_u32 s31, s31, 8
    s_cmp_lt_u32 s30, 4
    s_cbranch_scc1 K1C_loop
    v_mov_b32 v1, 133376
    ds_read_b64 v[54:55], v1
    v_fma_f32 v46, v16, v64, v65
    v_fma_f32 v47, v16, v68, v69
    v_fmac_f32 v46, v18, v68
    v_fmac_f32 v47, v17, v64
    v_fma_f32 v44, v16, v46, v66
    v_fma_f32 v45, v16, v47, v70
    v_fmac_f32 v44, v18, v47
    v_fmac_f32 v45, v17, v46
    v_fma_f32 v46, v16, v44, v67
    v_fma_f32 v47, v16, v45, v71
    v_fmac_f32 v46, v18, v45
    v_fmac_f32 v47, v17, v44
    v_fma_f32 v44, v16, v46, v72
    v_fma_f32 v45, v16, v47, v76
    v_fmac_f32 v44, v18, v47
    v_fmac_f32 v45, v17, v46
    v_fma_f32 v46, v16, v44, v73
    v_fma_f32 v47, v16, v45, v77
    v_fmac_f32 v46, v18, v45
    v_fmac_f32 v47, v17, v44
    v_fma_f32 v44, v16, v46, v74
    v_fma_f32 v45, v16, v47, v78
    v_fmac_f32 v44, v18, v47
    v_fmac_f32 v45, v17, v46
    s_waitcnt lgkmcnt(0)
    v_fma_f32 v46, v16, v44, v75
    v_fma_f32 v47, v16, v45, v79
    v_fmac_f32 v46, v18, v45
    v_fmac_f32 v47, v17, v44
    v_fma_f32 v44, v16, v46, v80
    v_fma_f32 v45, v16, v47, v84
    v_fmac_f32 v44, v18, v47
    v_fmac_f32 v45, v17, v46
    v_fma_f32 v46, v16, v44, v81
    v_fma_f32 v47, v16, v45, v85
    v_fmac_f32 v46, v18, v45
    v_fmac_f32 v47, v17, v44
    v_fma_f32 v44, v16, v46, v82
    v_fma_f32 v45, v16, v47, v86
    v_fmac_f32 v44, v18, v47
    v_fmac_f32 v45, v17, v46
    v_fma_f32 v46, v16, v44, v83
    v_fma_f32 v47, v16, v45, v87
    v_fmac_f32 v46, v18, v45
    v_fmac_f32 v47, v17, v44
    v_fma_f32 v44, v16, v46, v88
    v_fma_f32 v45, v16, v47, v92
    v_fmac_f32 v44, v18, v47
    v_fmac_f32 v45, v17, v46
    v_fma_f32 v46, v16, v44, v89
    v_fma_f32 v47, v16, v45, v93
    v_fmac_f32 v46, v18, v45
    v_fmac_f32 v47, v17, v44
    v_fma_f32 v44, v16, v46, v90
    v_fma_f32 v45, v16, v47, v94
    v_fmac_f32 v44, v18, v47
    v_fmac_f32 v45, v17, v46
    v_fma_f32 v46, v16, v44, v91
    v_fma_f32 v47, v16, v45, v95
    v_fmac_f32 v46, v18, v45
    v_fmac_f32 v47, v17, v44
    v_fma_f32 v44, v16, v46, v96
    v_fma_f32 v45, v16, v47, v100
    v_fmac_f32 v44, v18, v47
    v_fmac_f32 v45, v17, v46
    v_fma_f32 v46, v16, v44, v97
    v_fma_f32 v47, v16, v45, v101
    v_fmac_f32 v46, v18, v45
    v_fmac_f32 v47, v17, v44
    v_fma_f32 v44, v16, v46, v98
    v_fma_f32 v45, v16, v47, v102
    v_fmac_f32 v44, v18, v47
    v_fmac_f32 v45, v17, v46
    v_fma_f32 v46, v16, v44, v99
    v_fma_f32 v47, v16, v45, v103
    v_fmac_f32 v46, v18, v45
    v_fmac_f32 v47, v17, v44
    v_fma_f32 v44, v16, v46, v104
    v_fma_f32 v45, v16, v47, v108
    v_fmac_f32 v44, v18, v47
    v_fmac_f32 v45, v17, v46
    v_fma_f32 v46, v16, v44, v105
    v_fma_f32 v47, v16, v45, v109
    v_fmac_f32 v46, v18, v45
    v_fmac_f32 v47, v17, v44
    v_fma_f32 v44, v16, v46, v106
    v_fma_f32 v45, v16, v47, v110
    v_fmac_f32 v44, v18, v47
    v_fmac_f32 v45, v17, v46
    v_fma_f32 v46, v16, v44, v107
    v_fma_f32 v47, v16, v45, v111
    v_fmac_f32 v46, v18, v45
    v_fmac_f32 v47, v17, v44
    v_fma_f32 v44, v16, v46, v112
    v_fma_f32 v45, v16, v47, v116
    v_fmac_f32 v44, v18, v47
    v_fmac_f32 v45, v17, v46
    v_fma_f32 v46, v16, v44, v113
    v_fma_f32 v47, v16, v45, v117
    v_fmac_f32 v46, v18, v45
    v_fmac_f32 v47, v17, v44
    v_fma_f32 v44, v16, v46, v114
    v_fma_f32 v45, v16, v47, v118
    v_fmac_f32 v44, v18, v47
    v_fmac_f32 v45, v17, v46
    v_fma_f32 v46, v16, v44, v115
    v_fma_f32 v47, v16, v45, v119
    v_fmac_f32 v46, v18, v45
    v_fmac_f32 v47, v17, v44
    v_fma_f32 v44, v16, v46, v120
    v_fma_f32 v45, v16, v47, v124
    v_fmac_f32 v44, v18, v47
    v_fmac_f32 v45, v17, v46
    v_fma_f32 v46, v16, v44, v121
    v_fma_f32 v47, v16, v45, v125
    v_fmac_f32 v46, v18, v45
    v_fmac_f32 v47, v17, v44
    v_fma_f32 v44, v16, v46, v122
    v_fma_f32 v45, v16, v47, v126
    v_fmac_f32 v44, v18, v47
    v_fmac_f32 v45, v17, v46
    v_fma_f32 v46, v16, v44, v123
    v_fma_f32 v47, v16, v45, v127
    v_fmac_f32 v46, v18, v45
    v_fmac_f32 v47, v17, v44
    v_mov_b32 v44, v46
    v_mov_b32 v45, v47
    s_nop 1
    v_permlane32_swap_b32 v46, v44
    v_permlane32_swap_b32 v47, v45
    v_mov_b32 v48, v46
    v_mov_b32 v49, v47
    v_mov_b32 v50, v44
    v_mov_b32 v51, v45
    s_nop 0
    v_permlane16_swap_b32 v46, v48
    v_permlane16_swap_b32 v47, v49
    v_permlane16_swap_b32 v44, v50
    v_permlane16_swap_b32 v45, v51
    v_fma_f32 v48, v46, v22, v48
    v_fma_f32 v49, v46, v23, v49
    v_fma_f32 v48, -v47, v23, v48
    v_fmac_f32 v49, v47, v22
    v_fma_f32 v44, v48, v22, v44
    v_fma_f32 v45, v48, v23, v45
    v_fma_f32 v44, -v49, v23, v44
    v_fmac_f32 v45, v49, v22
    v_fma_f32 v52, v44, v22, v50
    v_fma_f32 v53, v44, v23, v51
    v_fma_f32 v52, -v45, v23, v52
    v_fmac_f32 v53, v45, v22
    s_mov_b64 exec, 0xffff
    buffer_store_dwordx4 v[52:55], v34, s[12:15], 0 offen sc1
    s_mov_b64 exec, -1
    buffer_load_dwordx4 v[192:195], v30, s[12:15], 0 offen sc1
    buffer_load_dwordx4 v[196:199], v31, s[12:15], 0 offen sc1
    buffer_load_dwordx4 v[200:203], v32, s[12:15], 0 offen sc1
    buffer_load_dwordx4 v[204:207], v33, s[12:15], 0 offen sc1
    v_cndmask_b32 v50, 0, v46, s[48:49]
    v_cndmask_b32 v51, 0, v47, s[48:49]
    v_cndmask_b32 v50, v50, v48, s[50:51]
    v_cndmask_b32 v51, v51, v49, s[50:51]
    v_cndmask_b32 v50, v50, v44, s[52:53]
    v_cndmask_b32 v51, v51, v45, s[52:53]
    v_mul_f32 v56, v20, v50
    v_mul_f32 v57, v20, v51
    v_fma_f32 v56, -v21, v51, v56
    v_fmac_f32 v57, v21, v50
    v_mul_f32 v128, v20, v64
    v_fmac_f32 v128, v43, v68
    v_mul_f32 v68, v42, v68
    v_fmac_f32 v68, v43, v64
    v_mul_f32 v129, v20, v65
    v_fmac_f32 v129, v43, v69
    v_mul_f32 v69, v42, v69
    v_fmac_f32 v69, v43, v65
    v_mul_f32 v130, v20, v66
    v_fmac_f32 v130, v43, v70
    v_mul_f32 v70, v42, v70
    v_fmac_f32 v70, v43, v66
    v_mul_f32 v131, v20, v67
    v_fmac_f32 v131, v43, v71
    v_mul_f32 v71, v42, v71
    v_fmac_f32 v71, v43, v67
    v_mul_f32 v132, v20, v72
    v_fmac_f32 v132, v43, v76
    v_mul_f32 v76, v42, v76
    v_fmac_f32 v76, v43, v72
    v_mul_f32 v133, v20, v73
    v_fmac_f32 v133, v43, v77
    v_mul_f32 v77, v42, v77
    v_fmac_f32 v77, v43, v73
    v_mul_f32 v134, v20, v74
    v_fmac_f32 v134, v43, v78
    v_mul_f32 v78, v42, v78
    v_fmac_f32 v78, v43, v74
    v_mul_f32 v135, v20, v75
    v_fmac_f32 v135, v43, v79
    v_mul_f32 v79, v42, v79
    v_fmac_f32 v79, v43, v75
    v_mul_f32 v136, v20, v80
    v_fmac_f32 v136, v43, v84
    v_mul_f32 v84, v42, v84
    v_fmac_f32 v84, v43, v80
    v_mul_f32 v137, v20, v81
    v_fmac_f32 v137, v43, v85
    v_mul_f32 v85, v42, v85
    v_fmac_f32 v85, v43, v81
    v_mul_f32 v138, v20, v82
    v_fmac_f32 v138, v43, v86
    v_mul_f32 v86, v42, v86
    v_fmac_f32 v86, v43, v82
    v_mul_f32 v139, v20, v83
    v_fmac_f32 v139, v43, v87
    v_mul_f32 v87, v42, v87
    v_fmac_f32 v87, v43, v83
    v_mul_f32 v140, v20, v88
    v_fmac_f32 v140, v43, v92
    v_mul_f32 v92, v42, v92
    v_fmac_f32 v92, v43, v88
    v_mul_f32 v141, v20, v89
    v_fmac_f32 v141, v43, v93
    v_mul_f32 v93, v42, v93
    v_fmac_f32 v93, v43, v89
    v_mul_f32 v142, v20, v90
    v_fmac_f32 v142, v43, v94
    v_mul_f32 v94, v42, v94
    v_fmac_f32 v94, v43, v90
    v_mul_f32 v143, v20, v91
    v_fmac_f32 v143, v43, v95
    v_mul_f32 v95, v42, v95
    v_fmac_f32 v95, v43, v91
    v_mul_f32 v144, v20, v96
    v_fmac_f32 v144, v43, v100
    v_mul_f32 v100, v42, v100
    v_fmac_f32 v100, v43, v96
    v_mul_f32 v145, v20, v97
    v_fmac_f32 v145, v43, v101
    v_mul_f32 v101, v42, v101
    v_fmac_f32 v101, v43, v97
    v_mul_f32 v146, v20, v98
    v_fmac_f32 v146, v43, v102
    v_mul_f32 v102, v42, v102
    v_fmac_f32 v102, v43, v98
    v_mul_f32 v147, v20, v99
    v_fmac_f32 v147, v43, v103
    v_mul_f32 v103, v42, v103
    v_fmac_f32 v103, v43, v99
    v_mul_f32 v148, v20, v104
    v_fmac_f32 v148, v43, v108
    v_mul_f32 v108, v42, v108
    v_fmac_f32 v108, v43, v104
    v_mul_f32 v149, v20, v105
    v_fmac_f32 v149, v43, v109
    v_mul_f32 v109, v42, v109
    v_fmac_f32 v109, v43, v105
    v_mul_f32 v150, v20, v106
    v_fmac_f32 v150, v43, v110
    v_mul_f32 v110, v42, v110
    v_fmac_f32 v110, v43, v106
    v_mul_f32 v151, v20, v107
    v_fmac_f32 v151, v43, v111
    v_mul_f32 v111, v42, v111
    v_fmac_f32 v111, v43, v107
    v_mul_f32 v152, v20, v112
    v_fmac_f32 v152, v43, v116
    v_mul_f32 v116, v42, v116
    v_fmac_f32 v116, v43, v112
    v_mul_f32 v153, v20, v113
    v_fmac_f32 v153, v43, v117
    v_mul_f32 v117, v42, v117
    v_fmac_f32 v117, v43, v113
    v_mul_f32 v154, v20, v114
    v_fmac_f32 v154, v43, v118
    v_mul_f32 v118, v42, v118
    v_fmac_f32 v118, v43, v114
    v_mul_f32 v155, v20, v115
    v_fmac_f32 v155, v43, v119
    v_mul_f32 v119, v42, v119
    v_fmac_f32 v119, v43, v115
    v_mul_f32 v156, v20, v120
    v_fmac_f32 v156, v43, v124
    v_mul_f32 v124, v42, v124
    v_fmac_f32 v124, v43, v120
    v_mul_f32 v157, v20, v121
    v_fmac_f32 v157, v43, v125
    v_mul_f32 v125, v42, v125
    v_fmac_f32 v125, v43, v121
    v_mul_f32 v158, v20, v122
    v_fmac_f32 v158, v43, v126
    v_mul_f32 v126, v42, v126
    v_fmac_f32 v126, v43, v122
    v_mul_f32 v159, v20, v123
    v_fmac_f32 v159, v43, v127
    v_mul_f32 v127, v42, v127
    v_fmac_f32 v127, v43, v123
    s_mov_b32 s39, 0
K1C_chk:
    s_waitcnt vmcnt(0)
    v_cmp_eq_u32 vcc, v194, v54
    v_cmp_eq_u32 s[54:55], v195, v55
    s_and_b64 s[54:55], s[54:55], vcc
    s_or_b64 s[56:57], s[54:55], s[40:41]
    v_cmp_eq_u32 vcc, v198, v54
    v_cmp_eq_u32 s[54:55], v199, v55
    s_and_b64 s[54:55], s[54:55], vcc
    s_or_b64 s[58:59], s[54:55], s[42:43]
    v_cmp_eq_u32 vcc, v202, v54
    v_cmp_eq_u32 s[54:55], v203, v55
    s_and_b64 s[54:55], s[54:55], vcc
    s_or_b64 s[60:61], s[54:55], s[44:45]
    v_cmp_eq_u32 vcc, v206, v54
    v_cmp_eq_u32 s[54:55], v207, v55
    s_and_b64 s[54:55], s[54:55], vcc
    s_or_b64 s[62:63], s[54:55], s[46:47]
    s_and_b64 s[56:57], s[56:57], s[58:59]
    s_and_b64 s[60:61], s[60:61], s[62:63]
    s_and_b64 s[56:57], s[56:57], s[60:61]
    s_cmp_eq_u64 s[56:57], -1
    s_cbranch_scc1 K1C_ok
    s_add_u32 s39, s39, 1
    s_cmp_gt_u32 s39, 4096
    s_cbranch_scc1 K1C_ok
    buffer_load_dwordx4 v[192:195], v30, s[12:15], 0 offen sc1
    buffer_load_dwordx4 v[196:199], v31, s[12:15], 0 offen sc1
    buffer_load_dwordx4 v[200:203], v32, s[12:15], 0 offen sc1
    buffer_load_dwordx4 v[204:207], v33, s[12:15], 0 offen sc1
    s_branch K1C_chk
K1C_ok:
    v_fma_f32 v200, v204, v28, v200
    v_fma_f32 v201, v204, v29, v201
    v_fma_f32 v200, -v205, v29, v200
    v_fmac_f32 v201, v205, v28
    v_fma_f32 v196, v200, v28, v196
    v_fma_f32 v197, v200, v29, v197
    v_fma_f32 v196, -v201, v29, v196
    v_fmac_f32 v197, v201, v28
    v_fma_f32 v192, v196, v28, v192
    v_fma_f32 v193, v196, v29, v193
    v_fma_f32 v192, -v197, v29, v192
    v_fmac_f32 v193, v197, v28
    v_mul_f32 v44, v192, v26
    v_mul_f32 v45, v192, v27
    v_fma_f32 v44, -v193, v27, v44
    v_fmac_f32 v45, v193, v26
    v_mov_b32 v46, v44
    v_mov_b32 v47, v45
    s_nop 1
    v_permlane32_swap_b32 v44, v46
    v_permlane32_swap_b32 v45, v47
    v_add_f32 v44, v44, v46
    v_add_f32 v45, v45, v47
    v_mov_b32 v46, v44
    v_mov_b32 v47, v45
    s_nop 1
    v_permlane16_swap_b32 v44, v46
    v_permlane16_swap_b32 v45, v47
    v_add_f32 v44, v44, v46
    v_add_f32 v45, v45, v47
    v_fma_f32 v56, v24, v44, v56
    v_fma_f32 v57, v24, v45, v57
    v_fma_f32 v56, -v25, v45, v56
    v_fmac_f32 v57, v25, v44
    v_xor_b32 v57, 0x80000000, v57
    v_fmac_f32 v128, v16, v56
    v_fmac_f32 v68, v16, v57
    v_fmac_f32 v128, v17, v57
    v_fmac_f32 v68, v18, v56
    v_fmac_f32 v129, v16, v128
    v_fmac_f32 v69, v16, v68
    v_fmac_f32 v129, v17, v68
    v_fmac_f32 v69, v18, v128
    v_cvt_pk_bf16_f32 v160, v128, v129
    v_cvt_pk_bf16_f32 v164, v68, v69
    v_fmac_f32 v130, v16, v129
    v_fmac_f32 v70, v16, v69
    v_fmac_f32 v130, v17, v69
    v_fmac_f32 v70, v18, v129
    v_fmac_f32 v131, v16, v130
    v_fmac_f32 v71, v16, v70
    v_fmac_f32 v131, v17, v70
    v_fmac_f32 v71, v18, v130
    v_cvt_pk_bf16_f32 v161, v130, v131
    v_cvt_pk_bf16_f32 v165, v70, v71
    v_fmac_f32 v132, v16, v131
    v_fmac_f32 v76, v16, v71
    v_fmac_f32 v132, v17, v71
    v_fmac_f32 v76, v18, v131
    v_fmac_f32 v133, v16, v132
    v_fmac_f32 v77, v16, v76
    v_fmac_f32 v133, v17, v76
    v_fmac_f32 v77, v18, v132
    v_cvt_pk_bf16_f32 v162, v132, v133
    v_cvt_pk_bf16_f32 v166, v76, v77
    v_fmac_f32 v134, v16, v133
    v_fmac_f32 v78, v16, v77
    v_fmac_f32 v134, v17, v77
    v_fmac_f32 v78, v18, v133
    v_fmac_f32 v135, v16, v134
    v_fmac_f32 v79, v16, v78
    v_fmac_f32 v135, v17, v78
    v_fmac_f32 v79, v18, v134
    v_cvt_pk_bf16_f32 v163, v134, v135
    v_cvt_pk_bf16_f32 v167, v78, v79
    buffer_store_dwordx4 v[160:163], v35, s[8:11], 0 offen offset:0 sc1
    buffer_store_dwordx4 v[164:167], v35, s[8:11], s36 offen offset:0 sc1
    v_fmac_f32 v136, v16, v135
    v_fmac_f32 v84, v16, v79
    v_fmac_f32 v136, v17, v79
    v_fmac_f32 v84, v18, v135
    v_fmac_f32 v137, v16, v136
    v_fmac_f32 v85, v16, v84
    v_fmac_f32 v137, v17, v84
    v_fmac_f32 v85, v18, v136
    v_cvt_pk_bf16_f32 v168, v136, v137
    v_cvt_pk_bf16_f32 v172, v84, v85
    v_fmac_f32 v138, v16, v137
    v_fmac_f32 v86, v16, v85
    v_fmac_f32 v138, v17, v85
    v_fmac_f32 v86, v18, v137
    v_fmac_f32 v139, v16, v138
    v_fmac_f32 v87, v16, v86
    v_fmac_f32 v139, v17, v86
    v_fmac_f32 v87, v18, v138
    v_cvt_pk_bf16_f32 v169, v138, v139
    v_cvt_pk_bf16_f32 v173, v86, v87
    v_fmac_f32 v140, v16, v139
    v_fmac_f32 v92, v16, v87
    v_fmac_f32 v140, v17, v87
    v_fmac_f32 v92, v18, v139
    v_fmac_f32 v141, v16, v140
    v_fmac_f32 v93, v16, v92
    v_fmac_f32 v141, v17, v92
    v_fmac_f32 v93, v18, v140
    v_cvt_pk_bf16_f32 v170, v140, v141
    v_cvt_pk_bf16_f32 v174, v92, v93
    v_fmac_f32 v142, v16, v141
    v_fmac_f32 v94, v16, v93
    v_fmac_f32 v142, v17, v93
    v_fmac_f32 v94, v18, v141
    v_fmac_f32 v143, v16, v142
    v_fmac_f32 v95, v16, v94
    v_fmac_f32 v143, v17, v94
    v_fmac_f32 v95, v18, v142
    v_cvt_pk_bf16_f32 v171, v142, v143
    v_cvt_pk_bf16_f32 v175, v94, v95
    buffer_store_dwordx4 v[168:171], v36, s[8:11], 0 offen offset:1024 sc1
    buffer_store_dwordx4 v[172:175], v36, s[8:11], s36 offen offset:1024 sc1
    v_fmac_f32 v144, v16, v143
    v_fmac_f32 v100, v16, v95
    v_fmac_f32 v144, v17, v95
    v_fmac_f32 v100, v18, v143
    v_fmac_f32 v145, v16, v144
    v_fmac_f32 v101, v16, v100
    v_fmac_f32 v145, v17, v100
    v_fmac_f32 v101, v18, v144
    v_cvt_pk_bf16_f32 v176, v144, v145
    v_cvt_pk_bf16_f32 v180, v100, v101
    v_fmac_f32 v146, v16, v145
    v_fmac_f32 v102, v16, v101
    v_fmac_f32 v146, v17, v101
    v_fmac_f32 v102, v18, v145
    v_fmac_f32 v147, v16, v146
    v_fmac_f32 v103, v16, v102
    v_fmac_f32 v147, v17, v102
    v_fmac_f32 v103, v18, v146
    v_cvt_pk_bf16_f32 v177, v146, v147
    v_cvt_pk_bf16_f32 v181, v102, v103
    v_fmac_f32 v148, v16, v147
    v_fmac_f32 v108, v16, v103
    v_fmac_f32 v148, v17, v103
    v_fmac_f32 v108, v18, v147
    v_fmac_f32 v149, v16, v148
    v_fmac_f32 v109, v16, v108
    v_fmac_f32 v149, v17, v108
    v_fmac_f32 v109, v18, v148
    v_cvt_pk_bf16_f32 v178, v148, v149
    v_cvt_pk_bf16_f32 v182, v108, v109
    v_fmac_f32 v150, v16, v149
    v_fmac_f32 v110, v16, v109
    v_fmac_f32 v150, v17, v109
    v_fmac_f32 v110, v18, v149
    v_fmac_f32 v151, v16, v150
    v_fmac_f32 v111, v16, v110
    v_fmac_f32 v151, v17, v110
    v_fmac_f32 v111, v18, v150
    v_cvt_pk_bf16_f32 v179, v150, v151
    v_cvt_pk_bf16_f32 v183, v110, v111
    buffer_store_dwordx4 v[176:179], v35, s[8:11], 0 offen offset:2048 sc1
    buffer_store_dwordx4 v[180:183], v35, s[8:11], s36 offen offset:2048 sc1
    v_fmac_f32 v152, v16, v151
    v_fmac_f32 v116, v16, v111
    v_fmac_f32 v152, v17, v111
    v_fmac_f32 v116, v18, v151
    v_fmac_f32 v153, v16, v152
    v_fmac_f32 v117, v16, v116
    v_fmac_f32 v153, v17, v116
    v_fmac_f32 v117, v18, v152
    v_cvt_pk_bf16_f32 v184, v152, v153
    v_cvt_pk_bf16_f32 v188, v116, v117
    v_fmac_f32 v154, v16, v153
    v_fmac_f32 v118, v16, v117
    v_fmac_f32 v154, v17, v117
    v_fmac_f32 v118, v18, v153
    v_fmac_f32 v155, v16, v154
    v_fmac_f32 v119, v16, v118
    v_fmac_f32 v155, v17, v118
    v_fmac_f32 v119, v18, v154
    v_cvt_pk_bf16_f32 v185, v154, v155
    v_cvt_pk_bf16_f32 v189, v118, v119
    v_fmac_f32 v156, v16, v155
    v_fmac_f32 v124, v16, v119
    v_fmac_f32 v156, v17, v119
    v_fmac_f32 v124, v18, v155
    v_fmac_f32 v157, v16, v156
    v_fmac_f32 v125, v16, v124
    v_fmac_f32 v157, v17, v124
    v_fmac_f32 v125, v18, v156
    v_cvt_pk_bf16_f32 v186, v156, v157
    v_cvt_pk_bf16_f32 v190, v124, v125
    v_fmac_f32 v158, v16, v157
    v_fmac_f32 v126, v16, v125
    v_fmac_f32 v158, v17, v125
    v_fmac_f32 v126, v18, v157
    v_fmac_f32 v159, v16, v158
    v_fmac_f32 v127, v16, v126
    v_fmac_f32 v159, v17, v126
    v_fmac_f32 v127, v18, v158
    v_cvt_pk_bf16_f32 v187, v158, v159
    v_cvt_pk_bf16_f32 v191, v126, v127
    buffer_store_dwordx4 v[184:187], v36, s[8:11], 0 offen offset:3072 sc1
    buffer_store_dwordx4 v[188:191], v36, s[8:11], s36 offen offset:3072 sc1
K1_fin:
K1_done:
    s_endpgm
.p2align 8
.globl k2_kernel
.type k2_kernel,@function
k2_kernel:
    s_cmp_ge_u32 s2, 256
    s_cbranch_scc1 K2_done
    s_load_dwordx16 s[32:47], s[0:1], 0
    s_load_dwordx16 s[48:63], s[0:1], 64
    s_load_dwordx4 s[64:67], s[0:1], 128
    v_lshrrev_b32 v1, 6, v0
    v_and_b32 v2, 63, v0
    s_and_b32 s6, s2, 3
    v_readfirstlane_b32 s5, v1
    s_lshl_b32 s6, s6, 2
    s_lshr_b32 s7, s2, 3
    s_and_b32 s3, s7, 3
    s_add_u32 s3, s3, s6
    s_and_b32 s6, s2, 4
    s_lshl_b32 s6, s6, 1
    s_lshr_b32 s4, s7, 2
    s_add_u32 s4, s4, s6
    s_cmp_lt_u32 s5, 4
    s_cbranch_scc1 K2_compute
    s_sub_u32 s6, s5, 4
    s_lshl_b32 s101, s6, 12
    s_lshl_b32 s100, s6, 11
    s_lshl_b32 s7, s3, 19
    s_add_u32 s7, s7, s101
    v_lshlrev_b32 v4, 4, v2
    v_add_u32 v4, s7, v4
    v_lshrrev_b32 v12, 3, v2
    v_and_b32 v13, 7, v2
    v_lshrrev_b32 v14, 4, v2
    v_xor_b32 v13, v13, v14
    v_lshlrev_b32 v13, 4, v13
    v_lshl_add_u32 v15, v12, 11, v13
    s_lshl_b32 s7, s4, 2
    s_add_u32 s7, s7, s6
    s_lshl_b32 s7, s7, 15
    v_add_u32 v5, s7, v15
    v_xor_b32 v6, 64, v5
    v_add_u32 v6, 0x3c00, v6
    s_and_b32 s30, s2, 3
    s_lshl_b32 s30, s30, 2
    s_and_b32 s31, s2, 4
    s_lshl_b32 s31, s31, 1
    s_add_u32 s30, s30, s31
    s_add_u32 s31, s3, s4
    s_and_b32 s31, s31, 3
    s_add_u32 s30, s30, s31
    s_and_b32 s30, s30, 15
    s_lshl_b32 s72, s30, 7
    s_lshl_b32 s73, s30, 15
    s_waitcnt lgkmcnt(0)
    s_add_u32 s8, s66, 8388608
    s_addc_u32 s9, s67, 0
    s_mov_b32 s10, 8388608
    s_mov_b32 s11, 0x00020000
    s_mov_b32 s12, s54
    s_mov_b32 s13, s55
    s_mov_b32 s14, 2097152
    s_mov_b32 s15, 0x00020000
    s_mov_b32 s16, s56
    s_mov_b32 s17, s57
    s_mov_b32 s18, 2097152
    s_mov_b32 s19, 0x00020000
    s_add_u32 m0, s101, 0
    s_nop 0
    buffer_load_dwordx4 v4, s[8:11], s73 offen lds
    buffer_load_dwordx4 v4, s[8:11], s73 offen offset:1024 lds
    buffer_load_dwordx4 v4, s[8:11], s73 offen offset:2048 lds
    buffer_load_dwordx4 v4, s[8:11], s73 offen offset:3072 lds
    s_add_u32 m0, s100, 16384
    s_add_u32 s73, s73, 16384
    buffer_load_dwordx4 v5, s[12:15], s72 offen lds
    buffer_load_dwordx4 v6, s[12:15], s72 offen offset:1024 lds
    s_mov_b32 s20, s44
    s_mov_b32 s21, s45
    s_mov_b32 s22, 4194304
    s_mov_b32 s23, 0x00020000
    s_mov_b32 s24, s32
    s_mov_b32 s25, s33
    s_mov_b32 s26, 4194304
    s_mov_b32 s27, 0x00020000
    s_add_u32 s28, s66, 4194304
    s_addc_u32 s29, s67, 0
    s_mov_b32 s30, 4194304
    s_mov_b32 s31, 0x00020000
    s_mov_b32 s68, s62
    s_mov_b32 s69, s63
    s_mov_b32 s70, 16777216
    s_mov_b32 s71, 0x00020000
    s_lshl_b32 s7, s3, 2
    s_add_u32 s7, s7, s6
    s_lshl_b32 s74, s7, 18
    s_lshl_b32 s7, s7, 16
    s_lshl_b32 s75, s4, 7
    s_add_u32 s7, s7, s75
    v_add_u32 v8, s7, v15
    v_xor_b32 v9, 64, v8
    v_add_u32 v9, 0x3c00, v9
    v_add_u32 v10, 0x7800, v8
    v_add_u32 v11, 0x7800, v9
    v_and_b32 v12, 15, v2
    v_xor_b32 v13, v12, v14
    v_and_b32 v1, 7, v13
    v_lshlrev_b32 v1, 4, v1
    v_lshrrev_b32 v3, 3, v13
    v_lshl_add_u32 v1, v3, 8, v1
    v_lshl_add_u32 v1, v14, 12, v1
    s_lshl_b32 s7, s4, 2
    s_add_u32 s7, s7, s6
    s_lshl_b32 s7, s7, 16
    s_lshr_b32 s76, s3, 1
    s_lshl_b32 s76, s76, 9
    s_add_u32 s7, s7, s76
    s_and_b32 s76, s3, 1
    s_lshl_b32 s76, s76, 7
    s_add_u32 s7, s7, s76
    v_add_u32 v16, s7, v1
    v_xor_b32 v17, 64, v16
    v_add_u32 v17, 15360, v17
    v_xor_b32 v18, 0x100, v16
    v_add_u32 v18, 30720, v18
    v_xor_b32 v19, 0x140, v16
    v_add_u32 v19, 46080, v19
    s_add_u32 m0, s101, 114688
    s_nop 0
    buffer_load_dwordx4 v16, s[28:31], 0 offen offset:0 lds
    buffer_load_dwordx4 v17, s[28:31], 0 offen offset:1024 lds
    buffer_load_dwordx4 v18, s[28:31], 0 offen offset:2048 lds
    buffer_load_dwordx4 v19, s[28:31], 0 offen offset:3072 lds
    s_add_u32 m0, s101, 131072
    s_nop 0
    buffer_load_dwordx4 v8, s[24:27], 0 offen offset:0 nt lds
    buffer_load_dwordx4 v9, s[24:27], 0 offen offset:1024 nt lds
    buffer_load_dwordx4 v10, s[24:27], 0 offen offset:2048 nt lds
    buffer_load_dwordx4 v11, s[24:27], 0 offen offset:3072 nt lds
    s_add_u32 m0, s101, 24576
    s_nop 0
    buffer_load_dwordx4 v4, s[8:11], s73 offen lds
    buffer_load_dwordx4 v4, s[8:11], s73 offen offset:1024 lds
    buffer_load_dwordx4 v4, s[8:11], s73 offen offset:2048 lds
    buffer_load_dwordx4 v4, s[8:11], s73 offen offset:3072 lds
    s_add_u32 m0, s100, 40960
    s_add_u32 s73, s73, 16384
    buffer_load_dwordx4 v5, s[16:19], s72 offen lds
    buffer_load_dwordx4 v6, s[16:19], s72 offen offset:1024 lds
    s_add_u32 s72, s72, 128
    s_and_b32 s72, s72, 2047
    s_lshl_b32 s73, s72, 8
    s_lshl_b32 s7, s6, 1
    v_xor_b32 v1, s7, v12
    v_lshlrev_b32 v1, 4, v1
    v_lshl_add_u32 v1, v2, 8, v1
    v_add_u32 v20, 114688, v1
    v_xor_b32 v21, 0x80, v20
    v_xor_b32 v22, 16, v20
    v_xor_b32 v23, 0x90, v20
    v_bfe_u32 v1, v2, 2, 2
    v_bfe_u32 v3, v2, 1, 1
    v_lshl_add_u32 v3, v14, 1, v3
    v_bfe_u32 v7, v2, 3, 1
    v_xor_b32 v3, v3, v7
    v_lshlrev_b32 v3, 4, v3
    v_lshl_add_u32 v3, v1, 7, v3
    v_and_b32 v1, 1, v2
    v_lshl_add_u32 v3, v1, 3, v3
    s_add_u32 s7, s101, 131072
    v_add_u32 v24, s7, v3
    v_xor_b32 v25, 32, v24
    v_xor_b32 v26, 64, v24
    v_xor_b32 v27, 0x60, v24
    s_lshl_b32 s7, s4, 8
    s_add_u32 s7, s7, s74
    v_lshlrev_b32 v28, 2, v2
    v_add_u32 v28, s7, v28
    s_waitcnt vmcnt(6)
    s_barrier
    s_add_u32 m0, s101, 49152
    s_nop 0
    buffer_load_dwordx4 v4, s[8:11], s73 offen lds
    buffer_load_dwordx4 v4, s[8:11], s73 offen offset:1024 lds
    buffer_load_dwordx4 v4, s[8:11], s73 offen offset:2048 lds
    buffer_load_dwordx4 v4, s[8:11], s73 offen offset:3072 lds
    s_add_u32 m0, s100, 65536
    s_add_u32 s73, s73, 16384
    buffer_load_dwordx4 v5, s[12:15], s72 offen lds
    buffer_load_dwordx4 v6, s[12:15], s72 offen offset:1024 lds
    s_add_u32 m0, s101, 73728
    s_nop 0
    buffer_load_dwordx4 v4, s[8:11], s73 offen lds
    buffer_load_dwordx4 v4, s[8:11], s73 offen offset:1024 lds
    buffer_load_dwordx4 v4, s[8:11], s73 offen offset:2048 lds
    buffer_load_dwordx4 v4, s[8:11], s73 offen offset:3072 lds
    s_add_u32 m0, s100, 90112
    s_add_u32 s73, s73, 16384
    buffer_load_dwordx4 v5, s[16:19], s72 offen lds
    buffer_load_dwordx4 v6, s[16:19], s72 offen offset:1024 lds
    s_add_u32 s72, s72, 128
    s_and_b32 s72, s72, 2047
    s_lshl_b32 s73, s72, 8
    ds_read_b128 v[32:35], v20
    ds_read_b64_tr_b16 v[36:37], v24 offset:0
    ds_read_b64_tr_b16 v[38:39], v25 offset:512
    s_waitcnt lgkmcnt(0)
    v_lshlrev_b32 v40, 16, v32
    v_lshlrev_b32 v48, 16, v36
    v_mul_f32 v48, v48, v40
    v_and_b32 v40, 0xffff0000, v32
    v_and_b32 v49, 0xffff0000, v36
    v_mul_f32 v49, v49, v40
    v_lshlrev_b32 v40, 16, v33
    v_lshlrev_b32 v50, 16, v37
    v_mul_f32 v50, v50, v40
    v_and_b32 v40, 0xffff0000, v33
    v_and_b32 v51, 0xffff0000, v37
    v_mul_f32 v51, v51, v40
    v_lshlrev_b32 v40, 16, v34
    v_lshlrev_b32 v52, 16, v38
    v_mul_f32 v52, v52, v40
    v_and_b32 v40, 0xffff0000, v34
    v_and_b32 v53, 0xffff0000, v38
    v_mul_f32 v53, v53, v40
    v_lshlrev_b32 v40, 16, v35
    v_lshlrev_b32 v54, 16, v39
    v_mul_f32 v54, v54, v40
    v_and_b32 v40, 0xffff0000, v35
    v_and_b32 v55, 0xffff0000, v39
    v_mul_f32 v55, v55, v40
    s_mov_b32 s7, 0
    buffer_store_dword v48, v28, s[68:71], s7 offen
    s_mov_b32 s7, 8192
    buffer_store_dword v49, v28, s[68:71], s7 offen
    s_mov_b32 s7, 16384
    buffer_store_dword v50, v28, s[68:71], s7 offen
    s_mov_b32 s7, 24576
    buffer_store_dword v51, v28, s[68:71], s7 offen
    s_mov_b32 s7, 32768
    buffer_store_dword v52, v28, s[68:71], s7 offen
    s_mov_b32 s7, 40960
    buffer_store_dword v53, v28, s[68:71], s7 offen
    s_mov_b32 s7, 49152
    buffer_store_dword v54, v28, s[68:71], s7 offen
    s_mov_b32 s7, 57344
    buffer_store_dword v55, v28, s[68:71], s7 offen
    ds_read_b128 v[32:35], v21
    ds_read_b64_tr_b16 v[36:37], v26 offset:1024
    ds_read_b64_tr_b16 v[38:39], v27 offset:1536
    s_waitcnt lgkmcnt(0)
    v_lshlrev_b32 v40, 16, v32
    v_lshlrev_b32 v56, 16, v36
    v_mul_f32 v56, v56, v40
    v_and_b32 v40, 0xffff0000, v32
    v_and_b32 v57, 0xffff0000, v36
    v_mul_f32 v57, v57, v40
    v_lshlrev_b32 v40, 16, v33
    v_lshlrev_b32 v58, 16, v37
    v_mul_f32 v58, v58, v40
    v_and_b32 v40, 0xffff0000, v33
    v_and_b32 v59, 0xffff0000, v37
    v_mul_f32 v59, v59, v40
    v_lshlrev_b32 v40, 16, v34
    v_lshlrev_b32 v60, 16, v38
    v_mul_f32 v60, v60, v40
    v_and_b32 v40, 0xffff0000, v34
    v_and_b32 v61, 0xffff0000, v38
    v_mul_f32 v61, v61, v40
    v_lshlrev_b32 v40, 16, v35
    v_lshlrev_b32 v62, 16, v39
    v_mul_f32 v62, v62, v40
    v_and_b32 v40, 0xffff0000, v35
    v_and_b32 v63, 0xffff0000, v39
    v_mul_f32 v63, v63, v40
    s_mov_b32 s7, 65536
    buffer_store_dword v56, v28, s[68:71], s7 offen
    s_mov_b32 s7, 73728
    buffer_store_dword v57, v28, s[68:71], s7 offen
    s_mov_b32 s7, 81920
    buffer_store_dword v58, v28, s[68:71], s7 offen
    s_mov_b32 s7, 90112
    buffer_store_dword v59, v28, s[68:71], s7 offen
    s_mov_b32 s7, 98304
    buffer_store_dword v60, v28, s[68:71], s7 offen
    s_mov_b32 s7, 106496
    buffer_store_dword v61, v28, s[68:71], s7 offen
    s_mov_b32 s7, 114688
    buffer_store_dword v62, v28, s[68:71], s7 offen
    s_mov_b32 s7, 122880
    buffer_store_dword v63, v28, s[68:71], s7 offen
    ds_read_b128 v[32:35], v22
    ds_read_b64_tr_b16 v[36:37], v24 offset:2048
    ds_read_b64_tr_b16 v[38:39], v25 offset:2560
    s_waitcnt lgkmcnt(0)
    v_lshlrev_b32 v40, 16, v32
    v_lshlrev_b32 v48, 16, v36
    v_mul_f32 v48, v48, v40
    v_and_b32 v40, 0xffff0000, v32
    v_and_b32 v49, 0xffff0000, v36
    v_mul_f32 v49, v49, v40
    v_lshlrev_b32 v40, 16, v33
    v_lshlrev_b32 v50, 16, v37
    v_mul_f32 v50, v50, v40
    v_and_b32 v40, 0xffff0000, v33
    v_and_b32 v51, 0xffff0000, v37
    v_mul_f32 v51, v51, v40
    v_lshlrev_b32 v40, 16, v34
    v_lshlrev_b32 v52, 16, v38
    v_mul_f32 v52, v52, v40
    v_and_b32 v40, 0xffff0000, v34
    v_and_b32 v53, 0xffff0000, v38
    v_mul_f32 v53, v53, v40
    v_lshlrev_b32 v40, 16, v35
    v_lshlrev_b32 v54, 16, v39
    v_mul_f32 v54, v54, v40
    v_and_b32 v40, 0xffff0000, v35
    v_and_b32 v55, 0xffff0000, v39
    v_mul_f32 v55, v55, v40
    s_mov_b32 s7, 131072
    buffer_store_dword v48, v28, s[68:71], s7 offen
    s_mov_b32 s7, 139264
    buffer_store_dword v49, v28, s[68:71], s7 offen
    s_mov_b32 s7, 147456
    buffer_store_dword v50, v28, s[68:71], s7 offen
    s_mov_b32 s7, 155648
    buffer_store_dword v51, v28, s[68:71], s7 offen
    s_mov_b32 s7, 163840
    buffer_store_dword v52, v28, s[68:71], s7 offen
    s_mov_b32 s7, 172032
    buffer_store_dword v53, v28, s[68:71], s7 offen
    s_mov_b32 s7, 180224
    buffer_store_dword v54, v28, s[68:71], s7 offen
    s_mov_b32 s7, 188416
    buffer_store_dword v55, v28, s[68:71], s7 offen
    ds_read_b128 v[32:35], v23
    ds_read_b64_tr_b16 v[36:37], v26 offset:3072
    ds_read_b64_tr_b16 v[38:39], v27 offset:3584
    s_waitcnt lgkmcnt(0)
    v_lshlrev_b32 v40, 16, v32
    v_lshlrev_b32 v56, 16, v36
    v_mul_f32 v56, v56, v40
    v_and_b32 v40, 0xffff0000, v32
    v_and_b32 v57, 0xffff0000, v36
    v_mul_f32 v57, v57, v40
    v_lshlrev_b32 v40, 16, v33
    v_lshlrev_b32 v58, 16, v37
    v_mul_f32 v58, v58, v40
    v_and_b32 v40, 0xffff0000, v33
    v_and_b32 v59, 0xffff0000, v37
    v_mul_f32 v59, v59, v40
    v_lshlrev_b32 v40, 16, v34
    v_lshlrev_b32 v60, 16, v38
    v_mul_f32 v60, v60, v40
    v_and_b32 v40, 0xffff0000, v34
    v_and_b32 v61, 0xffff0000, v38
    v_mul_f32 v61, v61, v40
    v_lshlrev_b32 v40, 16, v35
    v_lshlrev_b32 v62, 16, v39
    v_mul_f32 v62, v62, v40
    v_and_b32 v40, 0xffff0000, v35
    v_and_b32 v63, 0xffff0000, v39
    v_mul_f32 v63, v63, v40
    s_mov_b32 s7, 196608
    buffer_store_dword v56, v28, s[68:71], s7 offen
    s_mov_b32 s7, 204800
    buffer_store_dword v57, v28, s[68:71], s7 offen
    s_mov_b32 s7, 212992
    buffer_store_dword v58, v28, s[68:71], s7 offen
    s_mov_b32 s7, 221184
    buffer_store_dword v59, v28, s[68:71], s7 offen
    s_mov_b32 s7, 229376
    buffer_store_dword v60, v28, s[68:71], s7 offen
    s_mov_b32 s7, 237568
    buffer_store_dword v61, v28, s[68:71], s7 offen
    s_mov_b32 s7, 245760
    buffer_store_dword v62, v28, s[68:71], s7 offen
    s_mov_b32 s7, 253952
    buffer_store_dword v63, v28, s[68:71], s7 offen
    s_waitcnt vmcnt(44)
    s_barrier
    s_add_u32 m0, s101, 0
    s_nop 0
    buffer_load_dwordx4 v4, s[8:11], s73 offen lds
    buffer_load_dwordx4 v4, s[8:11], s73 offen offset:1024 lds
    buffer_load_dwordx4 v4, s[8:11], s73 offen offset:2048 lds
    buffer_load_dwordx4 v4, s[8:11], s73 offen offset:3072 lds
    s_add_u32 m0, s100, 16384
    s_add_u32 s73, s73, 16384
    buffer_load_dwordx4 v5, s[12:15], s72 offen lds
    buffer_load_dwordx4 v6, s[12:15], s72 offen offset:1024 lds
    s_waitcnt vmcnt(44)
    s_barrier
    s_add_u32 m0, s101, 24576
    s_nop 0
    buffer_load_dwordx4 v4, s[8:11], s73 offen lds
    buffer_load_dwordx4 v4, s[8:11], s73 offen offset:1024 lds
    buffer_load_dwordx4 v4, s[8:11], s73 offen offset:2048 lds
    buffer_load_dwordx4 v4, s[8:11], s73 offen offset:3072 lds
    s_add_u32 m0, s100, 40960
    s_add_u32 s73, s73, 16384
    buffer_load_dwordx4 v5, s[16:19], s72 offen lds
    buffer_load_dwordx4 v6, s[16:19], s72 offen offset:1024 lds
    s_add_u32 s72, s72, 128
    s_and_b32 s72, s72, 2047
    s_lshl_b32 s73, s72, 8
    s_waitcnt vmcnt(44)
    s_barrier
    s_add_u32 m0, s101, 49152
    s_nop 0
    buffer_load_dwordx4 v4, s[8:11], s73 offen lds
    buffer_load_dwordx4 v4, s[8:11], s73 offen offset:1024 lds
    buffer_load_dwordx4 v4, s[8:11], s73 offen offset:2048 lds
    buffer_load_dwordx4 v4, s[8:11], s73 offen offset:3072 lds
    s_add_u32 m0, s100, 65536
    s_add_u32 s73, s73, 16384
    buffer_load_dwordx4 v5, s[12:15], s72 offen lds
    buffer_load_dwordx4 v6, s[12:15], s72 offen offset:1024 lds
    s_waitcnt vmcnt(12)
    s_barrier
    s_add_u32 m0, s101, 73728
    s_nop 0
    buffer_load_dwordx4 v4, s[8:11], s73 offen lds
    buffer_load_dwordx4 v4, s[8:11], s73 offen offset:1024 lds
    buffer_load_dwordx4 v4, s[8:11], s73 offen offset:2048 lds
    buffer_load_dwordx4 v4, s[8:11], s73 offen offset:3072 lds
    s_add_u32 m0, s100, 90112
    s_add_u32 s73, s73, 16384
    buffer_load_dwordx4 v5, s[16:19], s72 offen lds
    buffer_load_dwordx4 v6, s[16:19], s72 offen offset:1024 lds
    s_add_u32 s72, s72, 128
    s_and_b32 s72, s72, 2047
    s_lshl_b32 s73, s72, 8
    s_waitcnt vmcnt(12)
    s_barrier
    s_add_u32 m0, s101, 0
    s_nop 0
    buffer_load_dwordx4 v4, s[8:11], s73 offen lds
    buffer_load_dwordx4 v4, s[8:11], s73 offen offset:1024 lds
    buffer_load_dwordx4 v4, s[8:11], s73 offen offset:2048 lds
    buffer_load_dwordx4 v4, s[8:11], s73 offen offset:3072 lds
    s_add_u32 m0, s100, 16384
    s_add_u32 s73, s73, 16384
    buffer_load_dwordx4 v5, s[12:15], s72 offen lds
    buffer_load_dwordx4 v6, s[12:15], s72 offen offset:1024 lds
    s_waitcnt vmcnt(12)
    s_barrier
    s_add_u32 m0, s101, 24576
    s_nop 0
    buffer_load_dwordx4 v4, s[8:11], s73 offen lds
    buffer_load_dwordx4 v4, s[8:11], s73 offen offset:1024 lds
    buffer_load_dwordx4 v4, s[8:11], s73 offen offset:2048 lds
    buffer_load_dwordx4 v4, s[8:11], s73 offen offset:3072 lds
    s_add_u32 m0, s100, 40960
    s_add_u32 s73, s73, 16384
    buffer_load_dwordx4 v5, s[16:19], s72 offen lds
    buffer_load_dwordx4 v6, s[16:19], s72 offen offset:1024 lds
    s_add_u32 s72, s72, 128
    s_and_b32 s72, s72, 2047
    s_lshl_b32 s73, s72, 8
    s_waitcnt vmcnt(12)
    s_barrier
    s_add_u32 m0, s101, 49152
    s_nop 0
    buffer_load_dwordx4 v4, s[8:11], s73 offen lds
    buffer_load_dwordx4 v4, s[8:11], s73 offen offset:1024 lds
    buffer_load_dwordx4 v4, s[8:11], s73 offen offset:2048 lds
    buffer_load_dwordx4 v4, s[8:11], s73 offen offset:3072 lds
    s_add_u32 m0, s100, 65536
    s_add_u32 s73, s73, 16384
    buffer_load_dwordx4 v5, s[12:15], s72 offen lds
    buffer_load_dwordx4 v6, s[12:15], s72 offen offset:1024 lds
    s_waitcnt vmcnt(12)
    s_barrier
    s_add_u32 m0, s101, 73728
    s_nop 0
    buffer_load_dwordx4 v4, s[8:11], s73 offen lds
    buffer_load_dwordx4 v4, s[8:11], s73 offen offset:1024 lds
    buffer_load_dwordx4 v4, s[8:11], s73 offen offset:2048 lds
    buffer_load_dwordx4 v4, s[8:11], s73 offen offset:3072 lds
    s_add_u32 m0, s100, 90112
    s_add_u32 s73, s73, 16384
    buffer_load_dwordx4 v5, s[16:19], s72 offen lds
    buffer_load_dwordx4 v6, s[16:19], s72 offen offset:1024 lds
    s_add_u32 s72, s72, 128
    s_and_b32 s72, s72, 2047
    s_lshl_b32 s73, s72, 8
    s_waitcnt vmcnt(12)
    s_barrier
    s_add_u32 m0, s101, 0
    s_nop 0
    buffer_load_dwordx4 v4, s[8:11], s73 offen lds
    buffer_load_dwordx4 v4, s[8:11], s73 offen offset:1024 lds
    buffer_load_dwordx4 v4, s[8:11], s73 offen offset:2048 lds
    buffer_load_dwordx4 v4, s[8:11], s73 offen offset:3072 lds
    s_add_u32 m0, s100, 16384
    s_add_u32 s73, s73, 16384
    buffer_load_dwordx4 v5, s[12:15], s72 offen lds
    buffer_load_dwordx4 v6, s[12:15], s72 offen offset:1024 lds
    s_add_u32 m0, s101, 98304
    s_nop 0
    buffer_load_dwordx4 v8, s[20:23], 0 offen offset:0 lds
    buffer_load_dwordx4 v9, s[20:23], 0 offen offset:1024 lds
    buffer_load_dwordx4 v10, s[20:23], 0 offen offset:2048 lds
    buffer_load_dwordx4 v11, s[20:23], 0 offen offset:3072 lds
    s_waitcnt vmcnt(16)
    s_barrier
    s_add_u32 m0, s101, 24576
    s_nop 0
    buffer_load_dwordx4 v4, s[8:11], s73 offen lds
    buffer_load_dwordx4 v4, s[8:11], s73 offen offset:1024 lds
    buffer_load_dwordx4 v4, s[8:11], s73 offen offset:2048 lds
    buffer_load_dwordx4 v4, s[8:11], s73 offen offset:3072 lds
    s_add_u32 m0, s100, 40960
    s_add_u32 s73, s73, 16384
    buffer_load_dwordx4 v5, s[16:19], s72 offen lds
    buffer_load_dwordx4 v6, s[16:19], s72 offen offset:1024 lds
    s_add_u32 s72, s72, 128
    s_and_b32 s72, s72, 2047
    s_lshl_b32 s73, s72, 8
    s_waitcnt vmcnt(16)
    s_barrier
    s_add_u32 m0, s101, 49152
    s_nop 0
    buffer_load_dwordx4 v4, s[8:11], s73 offen lds
    buffer_load_dwordx4 v4, s[8:11], s73 offen offset:1024 lds
    buffer_load_dwordx4 v4, s[8:11], s73 offen offset:2048 lds
    buffer_load_dwordx4 v4, s[8:11], s73 offen offset:3072 lds
    s_add_u32 m0, s100, 65536
    s_add_u32 s73, s73, 16384
    buffer_load_dwordx4 v5, s[12:15], s72 offen lds
    buffer_load_dwordx4 v6, s[12:15], s72 offen offset:1024 lds
    s_waitcnt vmcnt(16)
    s_barrier
    s_add_u32 m0, s101, 73728
    s_nop 0
    buffer_load_dwordx4 v4, s[8:11], s73 offen lds
    buffer_load_dwordx4 v4, s[8:11], s73 offen offset:1024 lds
    buffer_load_dwordx4 v4, s[8:11], s73 offen offset:2048 lds
    buffer_load_dwordx4 v4, s[8:11], s73 offen offset:3072 lds
    s_add_u32 m0, s100, 90112
    s_add_u32 s73, s73, 16384
    buffer_load_dwordx4 v5, s[16:19], s72 offen lds
    buffer_load_dwordx4 v6, s[16:19], s72 offen offset:1024 lds
    s_add_u32 s72, s72, 128
    s_and_b32 s72, s72, 2047
    s_lshl_b32 s73, s72, 8
    s_waitcnt vmcnt(12)
    s_barrier
    s_mov_b32 s77, 0
K2L_loop:
    s_add_u32 m0, s101, 0
    s_nop 0
    buffer_load_dwordx4 v4, s[8:11], s73 offen lds
    buffer_load_dwordx4 v4, s[8:11], s73 offen offset:1024 lds
    buffer_load_dwordx4 v4, s[8:11], s73 offen offset:2048 lds
    buffer_load_dwordx4 v4, s[8:11], s73 offen offset:3072 lds
    s_add_u32 m0, s100, 16384
    s_add_u32 s73, s73, 16384
    buffer_load_dwordx4 v5, s[12:15], s72 offen lds
    buffer_load_dwordx4 v6, s[12:15], s72 offen offset:1024 lds
    s_waitcnt vmcnt(12)
    s_barrier
    s_add_u32 m0, s101, 24576
    s_nop 0
    buffer_load_dwordx4 v4, s[8:11], s73 offen lds
    buffer_load_dwordx4 v4, s[8:11], s73 offen offset:1024 lds
    buffer_load_dwordx4 v4, s[8:11], s73 offen offset:2048 lds
    buffer_load_dwordx4 v4, s[8:11], s73 offen offset:3072 lds
    s_add_u32 m0, s100, 40960
    s_add_u32 s73, s73, 16384
    buffer_load_dwordx4 v5, s[16:19], s72 offen lds
    buffer_load_dwordx4 v6, s[16:19], s72 offen offset:1024 lds
    s_add_u32 s72, s72, 128
    s_and_b32 s72, s72, 2047
    s_lshl_b32 s73, s72, 8
    s_waitcnt vmcnt(12)
    s_barrier
    s_add_u32 m0, s101, 49152
    s_nop 0
    buffer_load_dwordx4 v4, s[8:11], s73 offen lds
    buffer_load_dwordx4 v4, s[8:11], s73 offen offset:1024 lds
    buffer_load_dwordx4 v4, s[8:11], s73 offen offset:2048 lds
    buffer_load_dwordx4 v4, s[8:11], s73 offen offset:3072 lds
    s_add_u32 m0, s100, 65536
    s_add_u32 s73, s73, 16384
    buffer_load_dwordx4 v5, s[12:15], s72 offen lds
    buffer_load_dwordx4 v6, s[12:15], s72 offen offset:1024 lds
    s_waitcnt vmcnt(12)
    s_barrier
    s_add_u32 m0, s101, 73728
    s_nop 0
    buffer_load_dwordx4 v4, s[8:11], s73 offen lds
    buffer_load_dwordx4 v4, s[8:11], s73 offen offset:1024 lds
    buffer_load_dwordx4 v4, s[8:11], s73 offen offset:2048 lds
    buffer_load_dwordx4 v4, s[8:11], s73 offen offset:3072 lds
    s_add_u32 m0, s100, 90112
    s_add_u32 s73, s73, 16384
    buffer_load_dwordx4 v5, s[16:19], s72 offen lds
    buffer_load_dwordx4 v6, s[16:19], s72 offen offset:1024 lds
    s_add_u32 s72, s72, 128
    s_and_b32 s72, s72, 2047
    s_lshl_b32 s73, s72, 8
    s_waitcnt vmcnt(12)
    s_barrier
    s_add_u32 s77, s77, 1
    s_cmp_lt_u32 s77, 4
    s_cbranch_scc1 K2L_loop
    s_waitcnt vmcnt(6)
    s_barrier
    s_waitcnt vmcnt(0)
    s_barrier
    s_endpgm
K2_compute:
    v_and_b32 v12, 15, v2
    v_lshrrev_b32 v13, 4, v2
    s_lshl_b32 s6, s4, 7
    v_lshlrev_b32 v1, 1, v12
    v_add_u32 v1, s6, v1
    s_waitcnt lgkmcnt(0)
    s_mov_b32 s12, s60
    s_mov_b32 s13, s61
    s_mov_b32 s14, 2048
    s_mov_b32 s15, 0x00020000
    buffer_load_ushort v20, v1, s[12:15], 0 offen offset:0
    buffer_load_ushort v21, v1, s[12:15], 0 offen offset:32
    buffer_load_ushort v22, v1, s[12:15], 0 offen offset:64
    buffer_load_ushort v23, v1, s[12:15], 0 offen offset:96
    s_mov_b32 s8, s62
    s_mov_b32 s9, s63
    s_mov_b32 s10, 16777216
    s_mov_b32 s11, 0x00020000
    v_bfe_u32 v1, v2, 1, 1
    v_bfe_u32 v3, v2, 2, 2
    v_lshl_add_u32 v3, v13, 3, v3
    v_lshl_add_u32 v3, v1, 2, v3
    v_lshlrev_b32 v3, 4, v3
    v_lshl_add_u32 v3, v1, 10, v3
    v_and_b32 v1, 1, v2
    v_lshl_add_u32 v3, v1, 3, v3
    s_lshl_b32 s6, s5, 12
    v_add_u32 v4, s6, v3
    v_xor_b32 v6, 64, v4
    v_add_u32 v5, 49152, v4
    v_add_u32 v7, 49152, v6
    v_lshrrev_b32 v3, 1, v12
    v_xor_b32 v3, v3, v13
    v_lshlrev_b32 v3, 4, v3
    v_lshl_add_u32 v3, v12, 7, v3
    v_add_u32 v8, 16384, v3
    v_xor_b32 v10, 64, v8
    v_add_u32 v9, 49152, v8
    v_add_u32 v11, 49152, v10
    s_add_u32 s6, s6, 98304
    v_add_u32 v14, s6, v3
    v_xor_b32 v15, 64, v14
    s_lshl_b32 s6, s3, 2
    s_add_u32 s6, s6, s5
    s_lshl_b32 s6, s6, 18
    s_lshl_b32 s7, s4, 8
    s_add_u32 s6, s6, s7
    s_add_u32 s6, s6, 4096
    v_lshlrev_b32 v16, 15, v13
    v_lshl_add_u32 v16, v12, 2, v16
    v_add_u32 v16, s6, v16
    v_lshlrev_b32 v17, 3, v13
    v_sub_u32 v17, v12, v17
    v_and_b32 v18, 1, v12
    v_lshlrev_b32 v18, 4, v18
    v_mov_b32 v32, 0
    v_mov_b32 v33, 0
    v_mov_b32 v34, 0
    v_mov_b32 v35, 0
    v_mov_b32 v36, 0
    v_mov_b32 v37, 0
    v_mov_b32 v38, 0
    v_mov_b32 v39, 0
    v_mov_b32 v40, 0
    v_mov_b32 v41, 0
    v_mov_b32 v42, 0
    v_mov_b32 v43, 0
    v_mov_b32 v44, 0
    v_mov_b32 v45, 0
    v_mov_b32 v46, 0
    v_mov_b32 v47, 0
    v_mov_b32 v48, 0
    v_mov_b32 v49, 0
    v_mov_b32 v50, 0
    v_mov_b32 v51, 0
    v_mov_b32 v52, 0
    v_mov_b32 v53, 0
    v_mov_b32 v54, 0
    v_mov_b32 v55, 0
    v_mov_b32 v56, 0
    v_mov_b32 v57, 0
    v_mov_b32 v58, 0
    v_mov_b32 v59, 0
    v_mov_b32 v60, 0
    v_mov_b32 v61, 0
    v_mov_b32 v62, 0
    v_mov_b32 v63, 0
    s_waitcnt vmcnt(0)
    v_lshlrev_b32 v20, v18, v20
    v_add_u32 v1, 0, v17
    v_lshrrev_b32 v1, 1, v1
    v_cmp_eq_u32 vcc, 0, v1
    s_nop 1
    v_cndmask_b32 v112, 0, v20, vcc
    v_cmp_eq_u32 vcc, 1, v1
    s_nop 1
    v_cndmask_b32 v113, 0, v20, vcc
    v_cmp_eq_u32 vcc, 2, v1
    s_nop 1
    v_cndmask_b32 v114, 0, v20, vcc
    v_cmp_eq_u32 vcc, 3, v1
    s_nop 1
    v_cndmask_b32 v115, 0, v20, vcc
    v_lshlrev_b32 v21, v18, v21
    v_add_u32 v1, 16, v17
    v_lshrrev_b32 v1, 1, v1
    v_cmp_eq_u32 vcc, 0, v1
    s_nop 1
    v_cndmask_b32 v116, 0, v21, vcc
    v_cmp_eq_u32 vcc, 1, v1
    s_nop 1
    v_cndmask_b32 v117, 0, v21, vcc
    v_cmp_eq_u32 vcc, 2, v1
    s_nop 1
    v_cndmask_b32 v118, 0, v21, vcc
    v_cmp_eq_u32 vcc, 3, v1
    s_nop 1
    v_cndmask_b32 v119, 0, v21, vcc
    v_lshlrev_b32 v22, v18, v22
    v_add_u32 v1, 0, v17
    v_lshrrev_b32 v1, 1, v1
    v_cmp_eq_u32 vcc, 0, v1
    s_nop 1
    v_cndmask_b32 v120, 0, v22, vcc
    v_cmp_eq_u32 vcc, 1, v1
    s_nop 1
    v_cndmask_b32 v121, 0, v22, vcc
    v_cmp_eq_u32 vcc, 2, v1
    s_nop 1
    v_cndmask_b32 v122, 0, v22, vcc
    v_cmp_eq_u32 vcc, 3, v1
    s_nop 1
    v_cndmask_b32 v123, 0, v22, vcc
    v_lshlrev_b32 v23, v18, v23
    v_add_u32 v1, 16, v17
    v_lshrrev_b32 v1, 1, v1
    v_cmp_eq_u32 vcc, 0, v1
    s_nop 1
    v_cndmask_b32 v124, 0, v23, vcc
    v_cmp_eq_u32 vcc, 1, v1
    s_nop 1
    v_cndmask_b32 v125, 0, v23, vcc
    v_cmp_eq_u32 vcc, 2, v1
    s_nop 1
    v_cndmask_b32 v126, 0, v23, vcc
    v_cmp_eq_u32 vcc, 3, v1
    s_nop 1
    v_cndmask_b32 v127, 0, v23, vcc
    s_barrier
    ds_read_b64_tr_b16 v[64:65], v4 offset:0
    ds_read_b64_tr_b16 v[66:67], v6 offset:0
    ds_read_b64_tr_b16 v[68:69], v4 offset:2048
    ds_read_b64_tr_b16 v[70:71], v6 offset:2048
    ds_read_b128 v[72:75], v8 offset:0
    ds_read_b128 v[76:79], v8 offset:2048
    ds_read_b128 v[80:83], v8 offset:4096
    ds_read_b128 v[84:87], v8 offset:6144
    s_mov_b32 s30, 0
K2C_loop:
    s_waitcnt lgkmcnt(0)
    v_mfma_f32_16x16x32_bf16 v[32:35], v[64:67], v[72:75], v[32:35]
    ds_read_b64_tr_b16 v[88:89], v4 offset:512
    v_mfma_f32_16x16x32_bf16 v[36:39], v[64:67], v[76:79], v[36:39]
    ds_read_b64_tr_b16 v[90:91], v6 offset:512
    v_mfma_f32_16x16x32_bf16 v[40:43], v[64:67], v[80:83], v[40:43]
    ds_read_b64_tr_b16 v[92:93], v4 offset:2560
    v_mfma_f32_16x16x32_bf16 v[44:47], v[64:67], v[84:87], v[44:47]
    ds_read_b64_tr_b16 v[94:95], v6 offset:2560
    v_mfma_f32_16x16x32_bf16 v[60:63], v[68:71], v[84:87], v[60:63]
    ds_read_b128 v[96:99], v10 offset:0
    v_mfma_f32_16x16x32_bf16 v[56:59], v[68:71], v[80:83], v[56:59]
    ds_read_b128 v[100:103], v10 offset:2048
    v_mfma_f32_16x16x32_bf16 v[52:55], v[68:71], v[76:79], v[52:55]
    ds_read_b128 v[104:107], v10 offset:4096
    v_mfma_f32_16x16x32_bf16 v[48:51], v[68:71], v[72:75], v[48:51]
    ds_read_b128 v[108:111], v10 offset:6144
    s_waitcnt lgkmcnt(0)
    s_barrier
    v_mfma_f32_16x16x32_bf16 v[32:35], v[88:91], v[96:99], v[32:35]
    ds_read_b64_tr_b16 v[64:65], v4 offset:24576
    v_mfma_f32_16x16x32_bf16 v[36:39], v[88:91], v[100:103], v[36:39]
    ds_read_b64_tr_b16 v[66:67], v6 offset:24576
    v_mfma_f32_16x16x32_bf16 v[40:43], v[88:91], v[104:107], v[40:43]
    ds_read_b64_tr_b16 v[68:69], v4 offset:26624
    v_mfma_f32_16x16x32_bf16 v[44:47], v[88:91], v[108:111], v[44:47]
    ds_read_b64_tr_b16 v[70:71], v6 offset:26624
    v_mfma_f32_16x16x32_bf16 v[60:63], v[92:95], v[108:111], v[60:63]
    ds_read_b128 v[72:75], v8 offset:24576
    v_mfma_f32_16x16x32_bf16 v[56:59], v[92:95], v[104:107], v[56:59]
    ds_read_b128 v[76:79], v8 offset:26624
    v_mfma_f32_16x16x32_bf16 v[52:55], v[92:95], v[100:103], v[52:55]
    ds_read_b128 v[80:83], v8 offset:28672
    v_mfma_f32_16x16x32_bf16 v[48:51], v[92:95], v[96:99], v[48:51]
    ds_read_b128 v[84:87], v8 offset:30720
    s_waitcnt lgkmcnt(0)
    v_mfma_f32_16x16x32_bf16 v[32:35], v[64:67], v[72:75], v[32:35]
    ds_read_b64_tr_b16 v[88:89], v4 offset:25088
    v_mfma_f32_16x16x32_bf16 v[36:39], v[64:67], v[76:79], v[36:39]
    ds_read_b64_tr_b16 v[90:91], v6 offset:25088
    v_mfma_f32_16x16x32_bf16 v[40:43], v[64:67], v[80:83], v[40:43]
    ds_read_b64_tr_b16 v[92:93], v4 offset:27136
    v_mfma_f32_16x16x32_bf16 v[44:47], v[64:67], v[84:87], v[44:47]
    ds_read_b64_tr_b16 v[94:95], v6 offset:27136
    v_mfma_f32_16x16x32_bf16 v[60:63], v[68:71], v[84:87], v[60:63]
    ds_read_b128 v[96:99], v10 offset:24576
    v_mfma_f32_16x16x32_bf16 v[56:59], v[68:71], v[80:83], v[56:59]
    ds_read_b128 v[100:103], v10 offset:26624
    v_mfma_f32_16x16x32_bf16 v[52:55], v[68:71], v[76:79], v[52:55]
    ds_read_b128 v[104:107], v10 offset:28672
    v_mfma_f32_16x16x32_bf16 v[48:51], v[68:71], v[72:75], v[48:51]
    ds_read_b128 v[108:111], v10 offset:30720
    s_waitcnt lgkmcnt(0)
    s_barrier
    v_mfma_f32_16x16x32_bf16 v[32:35], v[88:91], v[96:99], v[32:35]
    ds_read_b64_tr_b16 v[64:65], v5 offset:0
    v_mfma_f32_16x16x32_bf16 v[36:39], v[88:91], v[100:103], v[36:39]
    ds_read_b64_tr_b16 v[66:67], v7 offset:0
    v_mfma_f32_16x16x32_bf16 v[40:43], v[88:91], v[104:107], v[40:43]
    ds_read_b64_tr_b16 v[68:69], v5 offset:2048
    v_mfma_f32_16x16x32_bf16 v[44:47], v[88:91], v[108:111], v[44:47]
    ds_read_b64_tr_b16 v[70:71], v7 offset:2048
    v_mfma_f32_16x16x32_bf16 v[60:63], v[92:95], v[108:111], v[60:63]
    ds_read_b128 v[72:75], v9 offset:0
    v_mfma_f32_16x16x32_bf16 v[56:59], v[92:95], v[104:107], v[56:59]
    ds_read_b128 v[76:79], v9 offset:2048
    v_mfma_f32_16x16x32_bf16 v[52:55], v[92:95], v[100:103], v[52:55]
    ds_read_b128 v[80:83], v9 offset:4096
    v_mfma_f32_16x16x32_bf16 v[48:51], v[92:95], v[96:99], v[48:51]
    ds_read_b128 v[84:87], v9 offset:6144
    s_waitcnt lgkmcnt(0)
    v_mfma_f32_16x16x32_bf16 v[32:35], v[64:67], v[72:75], v[32:35]
    ds_read_b64_tr_b16 v[88:89], v5 offset:512
    v_mfma_f32_16x16x32_bf16 v[36:39], v[64:67], v[76:79], v[36:39]
    ds_read_b64_tr_b16 v[90:91], v7 offset:512
    v_mfma_f32_16x16x32_bf16 v[40:43], v[64:67], v[80:83], v[40:43]
    ds_read_b64_tr_b16 v[92:93], v5 offset:2560
    v_mfma_f32_16x16x32_bf16 v[44:47], v[64:67], v[84:87], v[44:47]
    ds_read_b64_tr_b16 v[94:95], v7 offset:2560
    v_mfma_f32_16x16x32_bf16 v[60:63], v[68:71], v[84:87], v[60:63]
    ds_read_b128 v[96:99], v11 offset:0
    v_mfma_f32_16x16x32_bf16 v[56:59], v[68:71], v[80:83], v[56:59]
    ds_read_b128 v[100:103], v11 offset:2048
    v_mfma_f32_16x16x32_bf16 v[52:55], v[68:71], v[76:79], v[52:55]
    ds_read_b128 v[104:107], v11 offset:4096
    v_mfma_f32_16x16x32_bf16 v[48:51], v[68:71], v[72:75], v[48:51]
    ds_read_b128 v[108:111], v11 offset:6144
    s_waitcnt lgkmcnt(0)
    s_barrier
    v_mfma_f32_16x16x32_bf16 v[32:35], v[88:91], v[96:99], v[32:35]
    ds_read_b64_tr_b16 v[64:65], v5 offset:24576
    v_mfma_f32_16x16x32_bf16 v[36:39], v[88:91], v[100:103], v[36:39]
    ds_read_b64_tr_b16 v[66:67], v7 offset:24576
    v_mfma_f32_16x16x32_bf16 v[40:43], v[88:91], v[104:107], v[40:43]
    ds_read_b64_tr_b16 v[68:69], v5 offset:26624
    v_mfma_f32_16x16x32_bf16 v[44:47], v[88:91], v[108:111], v[44:47]
    ds_read_b64_tr_b16 v[70:71], v7 offset:26624
    v_mfma_f32_16x16x32_bf16 v[60:63], v[92:95], v[108:111], v[60:63]
    ds_read_b128 v[72:75], v9 offset:24576
    v_mfma_f32_16x16x32_bf16 v[56:59], v[92:95], v[104:107], v[56:59]
    ds_read_b128 v[76:79], v9 offset:26624
    v_mfma_f32_16x16x32_bf16 v[52:55], v[92:95], v[100:103], v[52:55]
    ds_read_b128 v[80:83], v9 offset:28672
    v_mfma_f32_16x16x32_bf16 v[48:51], v[92:95], v[96:99], v[48:51]
    ds_read_b128 v[84:87], v9 offset:30720
    s_waitcnt lgkmcnt(0)
    v_mfma_f32_16x16x32_bf16 v[32:35], v[64:67], v[72:75], v[32:35]
    ds_read_b64_tr_b16 v[88:89], v5 offset:25088
    v_mfma_f32_16x16x32_bf16 v[36:39], v[64:67], v[76:79], v[36:39]
    ds_read_b64_tr_b16 v[90:91], v7 offset:25088
    v_mfma_f32_16x16x32_bf16 v[40:43], v[64:67], v[80:83], v[40:43]
    ds_read_b64_tr_b16 v[92:93], v5 offset:27136
    v_mfma_f32_16x16x32_bf16 v[44:47], v[64:67], v[84:87], v[44:47]
    ds_read_b64_tr_b16 v[94:95], v7 offset:27136
    v_mfma_f32_16x16x32_bf16 v[60:63], v[68:71], v[84:87], v[60:63]
    ds_read_b128 v[96:99], v11 offset:24576
    v_mfma_f32_16x16x32_bf16 v[56:59], v[68:71], v[80:83], v[56:59]
    ds_read_b128 v[100:103], v11 offset:26624
    v_mfma_f32_16x16x32_bf16 v[52:55], v[68:71], v[76:79], v[52:55]
    ds_read_b128 v[104:107], v11 offset:28672
    v_mfma_f32_16x16x32_bf16 v[48:51], v[68:71], v[72:75], v[48:51]
    ds_read_b128 v[108:111], v11 offset:30720
    s_waitcnt lgkmcnt(0)
    s_barrier
    v_mfma_f32_16x16x32_bf16 v[32:35], v[88:91], v[96:99], v[32:35]
    ds_read_b64_tr_b16 v[64:65], v4 offset:0
    v_mfma_f32_16x16x32_bf16 v[36:39], v[88:91], v[100:103], v[36:39]
    ds_read_b64_tr_b16 v[66:67], v6 offset:0
    v_mfma_f32_16x16x32_bf16 v[40:43], v[88:91], v[104:107], v[40:43]
    ds_read_b64_tr_b16 v[68:69], v4 offset:2048
    v_mfma_f32_16x16x32_bf16 v[44:47], v[88:91], v[108:111], v[44:47]
    ds_read_b64_tr_b16 v[70:71], v6 offset:2048
    v_mfma_f32_16x16x32_bf16 v[60:63], v[92:95], v[108:111], v[60:63]
    ds_read_b128 v[72:75], v8 offset:0
    v_mfma_f32_16x16x32_bf16 v[56:59], v[92:95], v[104:107], v[56:59]
    ds_read_b128 v[76:79], v8 offset:2048
    v_mfma_f32_16x16x32_bf16 v[52:55], v[92:95], v[100:103], v[52:55]
    ds_read_b128 v[80:83], v8 offset:4096
    v_mfma_f32_16x16x32_bf16 v[48:51], v[92:95], v[96:99], v[48:51]
    ds_read_b128 v[84:87], v8 offset:6144
    s_cmp_eq_u32 s30, 3
    s_cbranch_scc0 K2C_nox
    ds_read_b128 v[128:131], v14 offset:0
    ds_read_b128 v[132:135], v15 offset:0
    ds_read_b128 v[136:139], v14 offset:2048
    ds_read_b128 v[140:143], v15 offset:2048
    s_waitcnt lgkmcnt(0)
    v_mfma_f32_16x16x32_bf16 v[32:35], v[128:131], v[112:115], v[32:35]
    v_mfma_f32_16x16x32_bf16 v[36:39], v[128:131], v[116:119], v[36:39]
    v_mfma_f32_16x16x32_bf16 v[40:43], v[132:135], v[120:123], v[40:43]
    v_mfma_f32_16x16x32_bf16 v[44:47], v[132:135], v[124:127], v[44:47]
    v_mfma_f32_16x16x32_bf16 v[48:51], v[136:139], v[112:115], v[48:51]
    v_mfma_f32_16x16x32_bf16 v[52:55], v[136:139], v[116:119], v[52:55]
    v_mfma_f32_16x16x32_bf16 v[56:59], v[140:143], v[120:123], v[56:59]
    v_mfma_f32_16x16x32_bf16 v[60:63], v[140:143], v[124:127], v[60:63]
K2C_nox:
    s_add_u32 s30, s30, 1
    s_cmp_lt_u32 s30, 8
    s_cbranch_scc1 K2C_loop
    s_nop 4
    s_mov_b32 s6, 0
    buffer_store_dword v32, v16, s[8:11], s6 offen offset:0
    buffer_store_dword v36, v16, s[8:11], s6 offen offset:64
    buffer_store_dword v40, v16, s[8:11], s6 offen offset:128
    buffer_store_dword v44, v16, s[8:11], s6 offen offset:192
    s_mov_b32 s6, 8192
    buffer_store_dword v33, v16, s[8:11], s6 offen offset:0
    buffer_store_dword v37, v16, s[8:11], s6 offen offset:64
    buffer_store_dword v41, v16, s[8:11], s6 offen offset:128
    buffer_store_dword v45, v16, s[8:11], s6 offen offset:192
    s_mov_b32 s6, 16384
    buffer_store_dword v34, v16, s[8:11], s6 offen offset:0
    buffer_store_dword v38, v16, s[8:11], s6 offen offset:64
    buffer_store_dword v42, v16, s[8:11], s6 offen offset:128
    buffer_store_dword v46, v16, s[8:11], s6 offen offset:192
    s_mov_b32 s6, 24576
    buffer_store_dword v35, v16, s[8:11], s6 offen offset:0
    buffer_store_dword v39, v16, s[8:11], s6 offen offset:64
    buffer_store_dword v43, v16, s[8:11], s6 offen offset:128
    buffer_store_dword v47, v16, s[8:11], s6 offen offset:192
    s_mov_b32 s6, 131072
    buffer_store_dword v48, v16, s[8:11], s6 offen offset:0
    buffer_store_dword v52, v16, s[8:11], s6 offen offset:64
    buffer_store_dword v56, v16, s[8:11], s6 offen offset:128
    buffer_store_dword v60, v16, s[8:11], s6 offen offset:192
    s_mov_b32 s6, 139264
    buffer_store_dword v49, v16, s[8:11], s6 offen offset:0
    buffer_store_dword v53, v16, s[8:11], s6 offen offset:64
    buffer_store_dword v57, v16, s[8:11], s6 offen offset:128
    buffer_store_dword v61, v16, s[8:11], s6 offen offset:192
    s_mov_b32 s6, 147456
    buffer_store_dword v50, v16, s[8:11], s6 offen offset:0
    buffer_store_dword v54, v16, s[8:11], s6 offen offset:64
    buffer_store_dword v58, v16, s[8:11], s6 offen offset:128
    buffer_store_dword v62, v16, s[8:11], s6 offen offset:192
    s_mov_b32 s6, 155648
    buffer_store_dword v51, v16, s[8:11], s6 offen offset:0
    buffer_store_dword v55, v16, s[8:11], s6 offen offset:64
    buffer_store_dword v59, v16, s[8:11], s6 offen offset:128
    buffer_store_dword v63, v16, s[8:11], s6 offen offset:192
K2_fin:
K2_done:
    s_endpgm
.section .rodata,"a"
.p2align 6
.amdhsa_kernel k1_kernel
  .amdhsa_next_free_vgpr 228
  .amdhsa_next_free_sgpr 102
  .amdhsa_accum_offset 228
  .amdhsa_group_segment_fixed_size 0
  .amdhsa_kernarg_size 144
  .amdhsa_user_sgpr_count 2
  .amdhsa_user_sgpr_kernarg_segment_ptr 1
  .amdhsa_system_sgpr_workgroup_id_x 1
.end_amdhsa_kernel
.p2align 6
.amdhsa_kernel k2_kernel
  .amdhsa_next_free_vgpr 144
  .amdhsa_next_free_sgpr 102
  .amdhsa_accum_offset 144
  .amdhsa_group_segment_fixed_size 0
  .amdhsa_kernarg_size 144
  .amdhsa_user_sgpr_count 2
  .amdhsa_user_sgpr_kernarg_segment_ptr 1
  .amdhsa_system_sgpr_workgroup_id_x 1
.end_amdhsa_kernel
```

```asm
; @launch grid=(256,1,1) block=(512,1,1) lds=163840
.amdgcn_target "amdgcn-amd-amdhsa--gfx950"
.text
.p2align 8
.globl concat_heads__ssm_conv_h3__ssm_conv_s5__prompt_kernel
.type concat_heads__ssm_conv_h3__ssm_conv_s5__prompt_kernel,@function
concat_heads__ssm_conv_h3__ssm_conv_s5__prompt_kernel:
    s_cmp_ge_u32 s2, 256
    s_cbranch_scc1 K_done
    s_load_dwordx16 s[32:47], s[0:1], 0
    s_load_dwordx16 s[48:63], s[0:1], 64
    s_load_dwordx4 s[64:67], s[0:1], 128
    v_lshrrev_b32 v1, 6, v0
    v_and_b32 v2, 63, v0
    s_and_b32 s6, s2, 3
    v_readfirstlane_b32 s5, v1
    s_lshl_b32 s6, s6, 2
    s_lshr_b32 s7, s2, 3
    s_and_b32 s3, s7, 3
    s_add_u32 s3, s3, s6
    s_and_b32 s6, s2, 4
    s_lshl_b32 s6, s6, 1
    s_lshr_b32 s4, s7, 2
    s_add_u32 s4, s4, s6
    s_cmp_lt_u32 s5, 4
    s_cbranch_scc1 K_compute
    s_sub_u32 s6, s5, 4
    v_lshrrev_b32 v12, 3, v2
    v_and_b32 v13, 7, v2
    v_lshrrev_b32 v14, 4, v2
    v_xor_b32 v13, v13, v14
    v_lshlrev_b32 v13, 4, v13
    v_lshrrev_b32 v14, 5, v2
    v_lshlrev_b32 v14, 5, v14
    v_and_b32 v15, 3, v12
    v_add_u32 v14, v14, v15
    v_lshl_add_u32 v14, v14, 11, v13
    v_lshl_add_u32 v15, v12, 11, v13
    s_lshl_b32 s7, s3, 4
    s_add_u32 s7, s7, s6
    s_lshl_b32 s7, s7, 14
    v_add_u32 v4, s7, v14
    v_xor_b32 v5, 64, v4
    v_add_u32 v5, 0x1fc00, v5
    v_add_u32 v6, 0x1800, v4
    v_add_u32 v7, 0x1800, v5
    s_lshl_b32 s7, s4, 2
    s_add_u32 s7, s7, s6
    s_lshl_b32 s7, s7, 15
    v_add_u32 v8, s7, v15
    v_xor_b32 v9, 64, v8
    v_add_u32 v9, 0x3c00, v9
    s_and_b32 s30, s2, 3
    s_lshl_b32 s30, s30, 2
    s_and_b32 s31, s2, 4
    s_lshl_b32 s31, s31, 1
    s_add_u32 s30, s30, s31
    s_add_u32 s31, s3, s4
    s_and_b32 s31, s31, 1
    s_lshl_b32 s31, s31, 1
    s_add_u32 s30, s30, s31
    s_and_b32 s30, s30, 15
    s_lshl_b32 s100, s30, 7
    s_lshl_b32 s101, s6, 12
    s_waitcnt lgkmcnt(0)
    s_mov_b32 s8, s44
    s_mov_b32 s9, s45
    s_mov_b32 s10, 4194304
    s_mov_b32 s11, 0x00020000
    s_mov_b32 s12, s50
    s_mov_b32 s13, s51
    s_mov_b32 s14, 2097152
    s_mov_b32 s15, 0x00020000
    s_mov_b32 s16, s52
    s_mov_b32 s17, s53
    s_mov_b32 s18, 2097152
    s_mov_b32 s19, 0x00020000
    s_add_u32 m0, s101, 98304
    s_nop 0
    buffer_load_dwordx4 v4, s[8:11], s100 offen lds
    buffer_load_dwordx4 v5, s[8:11], s100 offen offset:1024 lds
    buffer_load_dwordx4 v6, s[8:11], s100 offen offset:2048 lds
    buffer_load_dwordx4 v7, s[8:11], s100 offen offset:3072 lds
    s_add_u32 m0, s101, 114688
    s_nop 0
    buffer_load_dwordx4 v8, s[12:15], s100 offen lds
    buffer_load_dwordx4 v9, s[12:15], s100 offen offset:1024 lds
    s_add_u32 m0, s101, 116736
    s_nop 0
    buffer_load_dwordx4 v8, s[16:19], s100 offen lds
    buffer_load_dwordx4 v9, s[16:19], s100 offen offset:1024 lds
    s_add_u32 s100, s100, 128
    s_and_b32 s100, s100, 2047
    s_mov_b32 s20, s34
    s_mov_b32 s21, s35
    s_mov_b32 s22, 4194304
    s_mov_b32 s23, 0x00020000
    s_mov_b32 s24, s36
    s_mov_b32 s25, s37
    s_mov_b32 s26, 4194304
    s_mov_b32 s27, 0x00020000
    s_mov_b32 s28, s38
    s_mov_b32 s29, s39
    s_mov_b32 s30, 8192
    s_mov_b32 s31, 0x00020000
    s_mov_b32 s58, s32
    s_mov_b32 s59, s33
    s_lshr_b32 s7, s2, 3
    s_and_b32 s32, s7, 15
    s_lshr_b32 s7, s7, 4
    s_and_b32 s33, s2, 7
    s_lshl_b32 s33, s33, 1
    s_add_u32 s33, s33, s7
    s_lshl_b32 s34, s33, 4
    s_add_u32 s34, s34, s32
    s_lshl_b32 s34, s34, 2
    s_add_u32 s34, s34, s6
    s_lshl_b32 s35, s34, 12
    s_lshr_b32 s7, s34, 1
    s_lshl_b32 s7, s7, 2
    s_load_dword s37, s[42:43], s7
    v_and_b32 v12, 15, v2
    v_lshrrev_b32 v13, 4, v2
    s_lshl_b32 s7, s32, 2
    s_add_u32 s7, s7, s6
    s_lshl_b32 s7, s7, 16
    s_lshl_b32 s38, s33, 7
    s_add_u32 s7, s7, s38
    v_lshlrev_b32 v10, 14, v13
    v_lshl_add_u32 v10, v12, 3, v10
    v_add_u32 v10, s7, v10
    v_subrev_u32 v11, 0x1800, v10
    v_bfrev_b32 v14, 1
    v_cmp_gt_i32 vcc, 0, v11
    s_lshl_b32 s7, s33, 9
    v_lshlrev_b32 v15, 5, v12
    v_cndmask_b32 v11, v11, v14, vcc
    v_add_u32 v14, s7, v15
    s_lshl_b32 s7, s6, 2
    v_add_u32 v15, s7, v13
    v_sub_u32 v15, 15, v15
    v_xor_b32 v15, v15, v12
    v_lshlrev_b32 v15, 4, v15
    v_lshl_add_u32 v15, v12, 10, v15
    v_add_u32 v15, 147456, v15
    s_mov_b32 s38, 4096
    s_mov_b32 s39, 8192
    s_mov_b32 s44, 12288
    buffer_load_dwordx4 v[16:19], v14, s[28:31], 0 offen
    buffer_load_dwordx4 v[20:23], v14, s[28:31], 0 offen offset:16
    buffer_load_dwordx2 v[40:41], v11, s[20:23], 0 offen offset:0 nt
    buffer_load_dwordx2 v[42:43], v11, s[20:23], 0 offen offset:2048 nt
    buffer_load_dwordx2 v[44:45], v11, s[20:23], s38 offen offset:0 nt
    buffer_load_dwordx2 v[46:47], v10, s[20:23], 0 offen offset:0 nt
    buffer_load_dwordx2 v[48:49], v10, s[20:23], 0 offen offset:2048 nt
    buffer_load_dwordx2 v[50:51], v10, s[20:23], s38 offen offset:0 nt
    buffer_load_dwordx2 v[52:53], v10, s[20:23], s38 offen offset:2048 nt
    buffer_load_dwordx2 v[54:55], v10, s[20:23], s39 offen offset:0 nt
    buffer_load_dwordx2 v[56:57], v10, s[20:23], s39 offen offset:2048 nt
    buffer_load_dwordx2 v[58:59], v10, s[20:23], s44 offen offset:0 nt
    buffer_load_dwordx2 v[60:61], v10, s[20:23], s44 offen offset:2048 nt
    buffer_load_dwordx2 v[62:63], v10, s[24:27], 0 offen offset:0 nt
    buffer_load_dwordx2 v[64:65], v10, s[24:27], 0 offen offset:2048 nt
    buffer_load_dwordx2 v[66:67], v10, s[24:27], s38 offen offset:0 nt
    buffer_load_dwordx2 v[68:69], v10, s[24:27], s38 offen offset:2048 nt
    buffer_load_dwordx2 v[70:71], v10, s[24:27], s39 offen offset:0 nt
    buffer_load_dwordx2 v[72:73], v10, s[24:27], s39 offen offset:2048 nt
    buffer_load_dwordx2 v[74:75], v10, s[24:27], s44 offen offset:0 nt
    buffer_load_dwordx2 v[76:77], v10, s[24:27], s44 offen offset:2048 nt
    s_add_u32 m0, s101, 0
    s_nop 0
    buffer_load_dwordx4 v4, s[8:11], s100 offen lds
    buffer_load_dwordx4 v5, s[8:11], s100 offen offset:1024 lds
    buffer_load_dwordx4 v6, s[8:11], s100 offen offset:2048 lds
    buffer_load_dwordx4 v7, s[8:11], s100 offen offset:3072 lds
    s_add_u32 m0, s101, 16384
    s_nop 0
    buffer_load_dwordx4 v8, s[12:15], s100 offen lds
    buffer_load_dwordx4 v9, s[12:15], s100 offen offset:1024 lds
    s_add_u32 m0, s101, 18432
    s_nop 0
    buffer_load_dwordx4 v8, s[16:19], s100 offen lds
    buffer_load_dwordx4 v9, s[16:19], s100 offen offset:1024 lds
    s_add_u32 s100, s100, 128
    s_and_b32 s100, s100, 2047
    s_mov_b32 s68, s40
    s_mov_b32 s69, s41
    s_mov_b32 s70, 4194304
    s_mov_b32 s71, 0x00020000
    s_mov_b32 s72, s66
    s_mov_b32 s73, s67
    s_mov_b32 s74, 4194304
    s_mov_b32 s75, 0x00020000
    s_add_u32 s76, s66, 17825792
    s_addc_u32 s77, s67, 0
    s_mov_b32 s78, 393216
    s_mov_b32 s79, 0x00020000
    s_add_u32 s80, s66, 8388608
    s_addc_u32 s81, s67, 0
    s_mov_b32 s82, 8388608
    s_mov_b32 s83, 0x00020000
    s_mov_b32 s20, s64
    s_mov_b32 s21, s65
    s_mov_b32 s22, 256
    s_mov_b32 s23, 0x00020000
    s_mov_b32 s24, s54
    s_mov_b32 s25, s55
    s_mov_b32 s26, 2097152
    s_mov_b32 s27, 0x00020000
    s_mov_b32 s28, s56
    s_mov_b32 s29, s57
    s_mov_b32 s30, 2097152
    s_mov_b32 s31, 0x00020000
    s_mov_b32 s40, s58
    s_mov_b32 s41, s59
    s_mov_b32 s42, 4194304
    s_mov_b32 s43, 0x00020000
    s_cmp_lt_u32 s6, 2
    s_cselect_b32 s52, s54, s56
    s_cselect_b32 s53, s55, s57
    s_mov_b32 s54, 2097152
    s_mov_b32 s55, 0x00020000
    s_lshl_b32 s7, s6, 29
    v_mov_b32 v212, s7
    s_lshl_b32 s36, s34, 1
    s_or_b32 s7, s7, s36
    v_mov_b32 v213, s7
    s_waitcnt vmcnt(29)
    s_barrier
    s_waitcnt vmcnt(8)
    s_add_u32 m0, s101, 32768
    s_nop 0
    buffer_load_dwordx4 v4, s[8:11], s100 offen lds
    v_lshlrev_b32 v24, 16, v16
    v_and_b32 v25, 0xffff0000, v16
    v_lshlrev_b32 v26, 16, v17
    v_and_b32 v27, 0xffff0000, v17
    v_lshlrev_b32 v78, 16, v40
    v_lshlrev_b32 v79, 16, v42
    v_lshlrev_b32 v80, 16, v44
    v_lshlrev_b32 v81, 16, v46
    v_lshlrev_b32 v82, 16, v48
    v_lshlrev_b32 v83, 16, v50
    v_lshlrev_b32 v84, 16, v52
    v_lshlrev_b32 v85, 16, v54
    v_lshlrev_b32 v86, 16, v56
    v_lshlrev_b32 v87, 16, v58
    v_lshlrev_b32 v88, 16, v60
    v_mul_f32 v90, v24, v81
    v_mul_f32 v91, v24, v82
    v_mul_f32 v92, v24, v83
    v_mul_f32 v93, v24, v84
    v_mul_f32 v94, v24, v85
    v_mul_f32 v95, v24, v86
    v_mul_f32 v96, v24, v87
    v_mul_f32 v97, v24, v88
    buffer_load_dwordx4 v5, s[8:11], s100 offen offset:1024 lds
    v_fmac_f32 v90, v25, v80
    v_fmac_f32 v91, v25, v81
    v_fmac_f32 v92, v25, v82
    v_fmac_f32 v93, v25, v83
    v_fmac_f32 v94, v25, v84
    v_fmac_f32 v95, v25, v85
    v_fmac_f32 v96, v25, v86
    v_fmac_f32 v97, v25, v87
    v_fmac_f32 v90, v26, v79
    v_fmac_f32 v91, v26, v80
    v_fmac_f32 v92, v26, v81
    v_fmac_f32 v93, v26, v82
    v_fmac_f32 v94, v26, v83
    v_fmac_f32 v95, v26, v84
    v_fmac_f32 v96, v26, v85
    v_fmac_f32 v97, v26, v86
    v_fmac_f32 v90, v27, v78
    v_fmac_f32 v91, v27, v79
    v_fmac_f32 v92, v27, v80
    v_fmac_f32 v93, v27, v81
    v_fmac_f32 v94, v27, v82
    v_fmac_f32 v95, v27, v83
    v_fmac_f32 v96, v27, v84
    buffer_load_dwordx4 v6, s[8:11], s100 offen offset:2048 lds
    v_fmac_f32 v97, v27, v85
    v_lshlrev_b32 v78, 16, v62
    v_lshlrev_b32 v79, 16, v64
    v_lshlrev_b32 v80, 16, v66
    v_lshlrev_b32 v81, 16, v68
    v_lshlrev_b32 v82, 16, v70
    v_lshlrev_b32 v83, 16, v72
    v_lshlrev_b32 v84, 16, v74
    v_lshlrev_b32 v85, 16, v76
    v_mul_f32 v90, v90, v78
    v_mul_f32 v91, v91, v79
    v_mul_f32 v92, v92, v80
    v_mul_f32 v93, v93, v81
    v_mul_f32 v94, v94, v82
    v_mul_f32 v95, v95, v83
    v_mul_f32 v96, v96, v84
    v_mul_f32 v97, v97, v85
    v_cvt_pk_bf16_f32 v98, v97, v96
    v_cvt_pk_bf16_f32 v99, v95, v94
    v_cvt_pk_bf16_f32 v100, v93, v92
    v_cvt_pk_bf16_f32 v101, v91, v90
    ds_write_b128 v15, v[98:101] offset:0
    v_lshlrev_b32 v24, 16, v18
    buffer_load_dwordx4 v7, s[8:11], s100 offen offset:3072 lds
    v_and_b32 v25, 0xffff0000, v18
    v_lshlrev_b32 v26, 16, v19
    v_and_b32 v27, 0xffff0000, v19
    v_and_b32 v78, 0xffff0000, v40
    v_and_b32 v79, 0xffff0000, v42
    v_and_b32 v80, 0xffff0000, v44
    v_and_b32 v81, 0xffff0000, v46
    v_and_b32 v82, 0xffff0000, v48
    v_and_b32 v83, 0xffff0000, v50
    v_and_b32 v84, 0xffff0000, v52
    v_and_b32 v85, 0xffff0000, v54
    v_and_b32 v86, 0xffff0000, v56
    v_and_b32 v87, 0xffff0000, v58
    v_and_b32 v88, 0xffff0000, v60
    v_mul_f32 v90, v24, v81
    v_mul_f32 v91, v24, v82
    v_mul_f32 v92, v24, v83
    v_mul_f32 v93, v24, v84
    v_mul_f32 v94, v24, v85
    v_mul_f32 v95, v24, v86
    v_mul_f32 v96, v24, v87
    v_mul_f32 v97, v24, v88
    v_fmac_f32 v90, v25, v80
    s_add_u32 m0, s101, 49152
    s_nop 0
    buffer_load_dwordx4 v8, s[12:15], s100 offen lds
    v_fmac_f32 v91, v25, v81
    v_fmac_f32 v92, v25, v82
    v_fmac_f32 v93, v25, v83
    v_fmac_f32 v94, v25, v84
    v_fmac_f32 v95, v25, v85
    v_fmac_f32 v96, v25, v86
    v_fmac_f32 v97, v25, v87
    v_fmac_f32 v90, v26, v79
    v_fmac_f32 v91, v26, v80
    v_fmac_f32 v92, v26, v81
    v_fmac_f32 v93, v26, v82
    v_fmac_f32 v94, v26, v83
    v_fmac_f32 v95, v26, v84
    v_fmac_f32 v96, v26, v85
    v_fmac_f32 v97, v26, v86
    v_fmac_f32 v90, v27, v78
    v_fmac_f32 v91, v27, v79
    v_fmac_f32 v92, v27, v80
    v_fmac_f32 v93, v27, v81
    v_fmac_f32 v94, v27, v82
    v_fmac_f32 v95, v27, v83
    v_fmac_f32 v96, v27, v84
    v_fmac_f32 v97, v27, v85
    buffer_load_dwordx4 v9, s[12:15], s100 offen offset:1024 lds
    v_and_b32 v78, 0xffff0000, v62
    v_and_b32 v79, 0xffff0000, v64
    v_and_b32 v80, 0xffff0000, v66
    v_and_b32 v81, 0xffff0000, v68
    v_and_b32 v82, 0xffff0000, v70
    v_and_b32 v83, 0xffff0000, v72
    v_and_b32 v84, 0xffff0000, v74
    v_and_b32 v85, 0xffff0000, v76
    v_mul_f32 v90, v90, v78
    v_mul_f32 v91, v91, v79
    v_mul_f32 v92, v92, v80
    v_mul_f32 v93, v93, v81
    v_mul_f32 v94, v94, v82
    v_mul_f32 v95, v95, v83
    v_mul_f32 v96, v96, v84
    v_mul_f32 v97, v97, v85
    v_cvt_pk_bf16_f32 v102, v97, v96
    v_cvt_pk_bf16_f32 v103, v95, v94
    v_cvt_pk_bf16_f32 v104, v93, v92
    v_cvt_pk_bf16_f32 v105, v91, v90
    ds_write_b128 v15, v[102:105] offset:256
    v_lshlrev_b32 v24, 16, v20
    v_and_b32 v25, 0xffff0000, v20
    s_add_u32 m0, s101, 51200
    s_nop 0
    buffer_load_dwordx4 v8, s[16:19], s100 offen lds
    v_lshlrev_b32 v26, 16, v21
    v_and_b32 v27, 0xffff0000, v21
    v_lshlrev_b32 v78, 16, v41
    v_lshlrev_b32 v79, 16, v43
    v_lshlrev_b32 v80, 16, v45
    v_lshlrev_b32 v81, 16, v47
    v_lshlrev_b32 v82, 16, v49
    v_lshlrev_b32 v83, 16, v51
    v_lshlrev_b32 v84, 16, v53
    v_lshlrev_b32 v85, 16, v55
    v_lshlrev_b32 v86, 16, v57
    v_lshlrev_b32 v87, 16, v59
    v_lshlrev_b32 v88, 16, v61
    v_mul_f32 v90, v24, v81
    v_mul_f32 v91, v24, v82
    v_mul_f32 v92, v24, v83
    v_mul_f32 v93, v24, v84
    v_mul_f32 v94, v24, v85
    v_mul_f32 v95, v24, v86
    v_mul_f32 v96, v24, v87
    v_mul_f32 v97, v24, v88
    v_fmac_f32 v90, v25, v80
    v_fmac_f32 v91, v25, v81
    buffer_load_dwordx4 v9, s[16:19], s100 offen offset:1024 lds
    s_add_u32 s100, s100, 128
    s_and_b32 s100, s100, 2047
    v_fmac_f32 v92, v25, v82
    v_fmac_f32 v93, v25, v83
    v_fmac_f32 v94, v25, v84
    v_fmac_f32 v95, v25, v85
    v_fmac_f32 v96, v25, v86
    v_fmac_f32 v97, v25, v87
    v_fmac_f32 v90, v26, v79
    v_fmac_f32 v91, v26, v80
    v_fmac_f32 v92, v26, v81
    v_fmac_f32 v93, v26, v82
    v_fmac_f32 v94, v26, v83
    v_fmac_f32 v95, v26, v84
    v_fmac_f32 v96, v26, v85
    v_fmac_f32 v97, v26, v86
    v_fmac_f32 v90, v27, v78
    v_fmac_f32 v91, v27, v79
    v_fmac_f32 v92, v27, v80
    v_fmac_f32 v93, v27, v81
    v_fmac_f32 v94, v27, v82
    v_fmac_f32 v95, v27, v83
    v_fmac_f32 v96, v27, v84
    v_fmac_f32 v97, v27, v85
    v_lshlrev_b32 v78, 16, v63
    s_add_u32 m0, s101, 65536
    s_nop 0
    buffer_load_dwordx4 v4, s[8:11], s100 offen lds
    v_lshlrev_b32 v79, 16, v65
    v_lshlrev_b32 v80, 16, v67
    v_lshlrev_b32 v81, 16, v69
    v_lshlrev_b32 v82, 16, v71
    v_lshlrev_b32 v83, 16, v73
    v_lshlrev_b32 v84, 16, v75
    v_lshlrev_b32 v85, 16, v77
    v_mul_f32 v90, v90, v78
    v_mul_f32 v91, v91, v79
    v_mul_f32 v92, v92, v80
    v_mul_f32 v93, v93, v81
    v_mul_f32 v94, v94, v82
    v_mul_f32 v95, v95, v83
    v_mul_f32 v96, v96, v84
    v_mul_f32 v97, v97, v85
    v_cvt_pk_bf16_f32 v98, v97, v96
    v_cvt_pk_bf16_f32 v99, v95, v94
    v_cvt_pk_bf16_f32 v100, v93, v92
    v_cvt_pk_bf16_f32 v101, v91, v90
    ds_write_b128 v15, v[98:101] offset:512
    v_lshlrev_b32 v24, 16, v22
    v_and_b32 v25, 0xffff0000, v22
    v_lshlrev_b32 v26, 16, v23
    buffer_load_dwordx4 v5, s[8:11], s100 offen offset:1024 lds
    v_and_b32 v27, 0xffff0000, v23
    v_and_b32 v78, 0xffff0000, v41
    v_and_b32 v79, 0xffff0000, v43
    v_and_b32 v80, 0xffff0000, v45
    v_and_b32 v81, 0xffff0000, v47
    v_and_b32 v82, 0xffff0000, v49
    v_and_b32 v83, 0xffff0000, v51
    v_and_b32 v84, 0xffff0000, v53
    v_and_b32 v85, 0xffff0000, v55
    v_and_b32 v86, 0xffff0000, v57
    v_and_b32 v87, 0xffff0000, v59
    v_and_b32 v88, 0xffff0000, v61
    v_mul_f32 v90, v24, v81
    v_mul_f32 v91, v24, v82
    v_mul_f32 v92, v24, v83
    v_mul_f32 v93, v24, v84
    v_mul_f32 v94, v24, v85
    v_mul_f32 v95, v24, v86
    v_mul_f32 v96, v24, v87
    v_mul_f32 v97, v24, v88
    v_fmac_f32 v90, v25, v80
    v_fmac_f32 v91, v25, v81
    v_fmac_f32 v92, v25, v82
    buffer_load_dwordx4 v6, s[8:11], s100 offen offset:2048 lds
    v_fmac_f32 v93, v25, v83
    v_fmac_f32 v94, v25, v84
    v_fmac_f32 v95, v25, v85
    v_fmac_f32 v96, v25, v86
    v_fmac_f32 v97, v25, v87
    v_fmac_f32 v90, v26, v79
    v_fmac_f32 v91, v26, v80
    v_fmac_f32 v92, v26, v81
    v_fmac_f32 v93, v26, v82
    v_fmac_f32 v94, v26, v83
    v_fmac_f32 v95, v26, v84
    v_fmac_f32 v96, v26, v85
    v_fmac_f32 v97, v26, v86
    v_fmac_f32 v90, v27, v78
    v_fmac_f32 v91, v27, v79
    v_fmac_f32 v92, v27, v80
    v_fmac_f32 v93, v27, v81
    v_fmac_f32 v94, v27, v82
    v_fmac_f32 v95, v27, v83
    v_fmac_f32 v96, v27, v84
    v_fmac_f32 v97, v27, v85
    v_and_b32 v78, 0xffff0000, v63
    v_and_b32 v79, 0xffff0000, v65
    buffer_load_dwordx4 v7, s[8:11], s100 offen offset:3072 lds
    v_and_b32 v80, 0xffff0000, v67
    v_and_b32 v81, 0xffff0000, v69
    v_and_b32 v82, 0xffff0000, v71
    v_and_b32 v83, 0xffff0000, v73
    v_and_b32 v84, 0xffff0000, v75
    v_and_b32 v85, 0xffff0000, v77
    v_mul_f32 v90, v90, v78
    v_mul_f32 v91, v91, v79
    v_mul_f32 v92, v92, v80
    v_mul_f32 v93, v93, v81
    v_mul_f32 v94, v94, v82
    v_mul_f32 v95, v95, v83
    v_mul_f32 v96, v96, v84
    v_mul_f32 v97, v97, v85
    v_cvt_pk_bf16_f32 v102, v97, v96
    v_cvt_pk_bf16_f32 v103, v95, v94
    v_cvt_pk_bf16_f32 v104, v93, v92
    v_cvt_pk_bf16_f32 v105, v91, v90
    ds_write_b128 v15, v[102:105] offset:768
    s_add_u32 m0, s101, 81920
    s_nop 0
    buffer_load_dwordx4 v8, s[12:15], s100 offen lds
    buffer_load_dwordx4 v9, s[12:15], s100 offen offset:1024 lds
    s_add_u32 m0, s101, 83968
    s_nop 0
    buffer_load_dwordx4 v8, s[16:19], s100 offen lds
    buffer_load_dwordx4 v9, s[16:19], s100 offen offset:1024 lds
    s_add_u32 s100, s100, 128
    s_and_b32 s100, s100, 2047
    s_waitcnt vmcnt(16) lgkmcnt(0)
    s_barrier
    s_mov_b64 exec, 1
    buffer_load_dwordx2 v[210:211], v212, s[20:23], 0 offen sc1
    s_mov_b64 exec, -1
    s_waitcnt lgkmcnt(0)
    s_lshl_b32 s45, s6, 14
    v_lshlrev_b32 v16, 4, v13
    v_lshl_add_u32 v16, v12, 1, v16
    v_and_b32 v1, 1, v12
    v_mov_b32 v3, 98308
    v_mov_b32 v14, 102466
    v_cmp_eq_u32 vcc, 1, v1
    s_and_b32 s7, s34, 1
    s_lshl_b32 s7, s7, 4
    v_cndmask_b32 v3, v3, v14, vcc
    v_add3_u32 v16, v16, v3, s45
    s_add_u32 m0, s101, 98304
    s_nop 0
    buffer_load_dwordx4 v4, s[8:11], s100 offen lds
    v_add_u32 v17, 1024, v16
    v_add_u32 v18, 2048, v16
    v_add_u32 v19, 3072, v16
    s_add_u32 s47, s45, 107104
    v_lshlrev_b32 v1, 4, v13
    v_lshlrev_b32 v3, 5, v12
    v_sub_u32 v1, v1, v3
    v_add_u32 v20, s47, v1
    s_lshr_b32 s37, s37, s7
    s_and_b32 s37, s37, 0xffff
    v_lshlrev_b32 v1, 3, v13
    v_add_u32 v1, v1, v12
    buffer_load_dwordx4 v5, s[8:11], s100 offen offset:1024 lds
    v_sub_u32 v1, 15, v1
    v_and_b32 v3, 1, v1
    v_lshlrev_b32 v3, 4, v3
    v_lshlrev_b32 v3, v3, s37
    v_lshrrev_b32 v1, 1, v1
    v_cmp_eq_u32 vcc, 0, v1
    s_nop 1
    v_cndmask_b32 v24, 0, v3, vcc
    v_cmp_eq_u32 vcc, 1, v1
    s_nop 1
    v_cndmask_b32 v25, 0, v3, vcc
    v_cmp_eq_u32 vcc, 2, v1
    buffer_load_dwordx4 v6, s[8:11], s100 offen offset:2048 lds
    s_nop 1
    v_cndmask_b32 v26, 0, v3, vcc
    v_cmp_eq_u32 vcc, 3, v1
    s_nop 1
    v_cndmask_b32 v27, 0, v3, vcc
    s_add_u32 s7, s45, 106496
    v_lshlrev_b32 v1, 3, v2
    v_add_u32 v21, s7, v1
    s_lshl_b32 s7, s3, 13
    s_add_u32 s7, s7, 131072
    v_and_b32 v1, 60, v2
    v_lshlrev_b32 v1, 7, v1
    buffer_load_dwordx4 v7, s[8:11], s100 offen offset:3072 lds
    v_add_u32 v217, s7, v1
    v_lshlrev_b32 v10, 4, v2
    s_lshl_b32 s7, s3, 19
    s_add_u32 s7, s7, s101
    v_add_u32 v214, s7, v10
    v_lshrrev_b32 v1, 3, v2
    v_and_b32 v3, 7, v2
    v_xor_b32 v3, v3, v13
    v_lshlrev_b32 v3, 4, v3
    v_lshl_add_u32 v3, v1, 13, v3
    s_lshl_b32 s7, s4, 6
    s_add_u32 s7, s7, s6
    s_add_u32 m0, s101, 114688
    s_nop 0
    buffer_load_dwordx4 v8, s[12:15], s100 offen lds
    s_lshl_b32 s7, s7, 11
    v_add_u32 v215, s7, v3
    v_xor_b32 v216, 64, v215
    v_add_u32 v216, 64512, v216
    s_lshl_b32 s44, s4, 7
    v_lshlrev_b32 v3, 11, v13
    v_lshl_add_u32 v3, v12, 3, v3
    s_lshl_b32 s7, s4, 2
    s_lshl_b64 s[56:57], 15, s7
    s_lshl_b32 s7, s3, 2
    s_add_u32 s7, s7, s6
    s_lshl_b32 s7, s7, 16
    buffer_load_dwordx4 v9, s[12:15], s100 offen offset:1024 lds
    s_add_u32 s7, s7, s44
    v_add_u32 v218, s7, v3
    s_lshr_b32 s46, s2, 3
    s_and_b32 s46, s46, 7
    s_add_u32 s38, s4, 1
    s_and_b32 s38, s38, 15
    s_lshl_b32 s38, s38, 15
    s_lshl_b32 s39, s6, 13
    s_lshl_b32 s7, s33, 7
    v_lshlrev_b32 v14, 3, v12
    v_add_u32 v14, s7, v14
    s_and_b32 s7, s2, 7
    s_add_u32 m0, s101, 116736
    s_nop 0
    buffer_load_dwordx4 v8, s[16:19], s100 offen lds
    s_lshl_b32 s7, s7, 5
    s_lshr_b32 s47, s2, 3
    s_add_u32 s7, s7, s47
    s_lshl_b32 s7, s7, 1
    s_and_b32 s47, s6, 1
    s_add_u32 s7, s7, s47
    s_lshl_b32 s7, s7, 12
    v_lshlrev_b32 v30, 6, v2
    v_add_u32 v30, s7, v30
    s_waitcnt vmcnt(16)
    s_barrier
    buffer_load_dwordx4 v9, s[16:19], s100 offen offset:1024 lds
    s_add_u32 s100, s100, 128
    s_and_b32 s100, s100, 2047
    s_add_u32 m0, s101, 0
    s_nop 0
    buffer_load_dwordx4 v4, s[8:11], s100 offen lds
    buffer_load_dwordx4 v5, s[8:11], s100 offen offset:1024 lds
    buffer_load_dwordx4 v6, s[8:11], s100 offen offset:2048 lds
    buffer_load_dwordx4 v7, s[8:11], s100 offen offset:3072 lds
    s_add_u32 m0, s101, 16384
    s_nop 0
    buffer_load_dwordx4 v8, s[12:15], s100 offen lds
    buffer_load_dwordx4 v9, s[12:15], s100 offen offset:1024 lds
    s_add_u32 m0, s101, 18432
    s_nop 0
    buffer_load_dwordx4 v8, s[16:19], s100 offen lds
    s_waitcnt vmcnt(16)
    s_barrier
    buffer_load_dwordx4 v9, s[16:19], s100 offen offset:1024 lds
    s_add_u32 s100, s100, 128
    s_and_b32 s100, s100, 2047
    s_add_u32 m0, s101, 32768
    s_nop 0
    buffer_load_dwordx4 v4, s[8:11], s100 offen lds
    buffer_load_dwordx4 v5, s[8:11], s100 offen offset:1024 lds
    buffer_load_dwordx4 v6, s[8:11], s100 offen offset:2048 lds
    buffer_load_dwordx4 v7, s[8:11], s100 offen offset:3072 lds
    s_add_u32 m0, s101, 49152
    s_nop 0
    buffer_load_dwordx4 v8, s[12:15], s100 offen lds
    buffer_load_dwordx4 v9, s[12:15], s100 offen offset:1024 lds
    s_add_u32 m0, s101, 51200
    s_nop 0
    buffer_load_dwordx4 v8, s[16:19], s100 offen lds
    buffer_load_dwordx4 v9, s[16:19], s100 offen offset:1024 lds
    s_add_u32 s100, s100, 128
    s_and_b32 s100, s100, 2047
    s_waitcnt vmcnt(16)
    s_barrier
    s_cmp_eq_u32 s6, 0
    s_cbranch_scc0 L_nskip
    s_mov_b32 s51, 0
    s_mov_b64 exec, 1
    s_waitcnt vmcnt(24)
L_nspin:
    v_readfirstlane_b32 s7, v210
    s_add_u32 s51, s51, 1
    s_cmp_lg_u32 s7, 0
    s_cbranch_scc1 L_nok
    s_cmp_gt_u32 s51, 4096
    s_cbranch_scc1 L_nok
    buffer_load_dwordx2 v[210:211], v212, s[20:23], 0 offen sc1
    s_waitcnt vmcnt(0)
    s_branch L_nspin
L_nok:
    v_mov_b32 v1, 147392
    ds_write_b64 v1, v[210:211]
    s_mov_b64 exec, -1
    s_waitcnt lgkmcnt(0)
L_nskip:
    s_add_u32 m0, s101, 65536
    s_nop 0
    buffer_load_dwordx4 v4, s[8:11], s100 offen lds
    buffer_load_dwordx4 v5, s[8:11], s100 offen offset:1024 lds
    buffer_load_dwordx4 v6, s[8:11], s100 offen offset:2048 lds
    buffer_load_dwordx4 v7, s[8:11], s100 offen offset:3072 lds
    s_add_u32 m0, s101, 81920
    s_nop 0
    buffer_load_dwordx4 v8, s[12:15], s100 offen lds
    buffer_load_dwordx4 v9, s[12:15], s100 offen offset:1024 lds
    s_add_u32 m0, s101, 83968
    s_nop 0
    buffer_load_dwordx4 v8, s[16:19], s100 offen lds
    buffer_load_dwordx4 v9, s[16:19], s100 offen offset:1024 lds
    s_add_u32 s100, s100, 128
    s_and_b32 s100, s100, 2047
    s_waitcnt vmcnt(16)
    s_barrier
    v_mov_b32 v1, 147392
    ds_read_b64 v[28:29], v1
    s_add_u32 m0, s101, 98304
    s_nop 0
    buffer_load_dwordx4 v4, s[8:11], s100 offen lds
    buffer_load_dwordx4 v5, s[8:11], s100 offen offset:1024 lds
    buffer_load_dwordx4 v6, s[8:11], s100 offen offset:2048 lds
    buffer_load_dwordx4 v7, s[8:11], s100 offen offset:3072 lds
    s_add_u32 m0, s101, 114688
    s_nop 0
    buffer_load_dwordx4 v8, s[12:15], s100 offen lds
    buffer_load_dwordx4 v9, s[12:15], s100 offen offset:1024 lds
    s_add_u32 m0, s101, 116736
    s_nop 0
    buffer_load_dwordx4 v8, s[16:19], s100 offen lds
    buffer_load_dwordx4 v9, s[16:19], s100 offen offset:1024 lds
    s_add_u32 s100, s100, 128
    s_and_b32 s100, s100, 2047
    s_cmp_eq_u32 s46, 0
    s_cbranch_scc0 L_t0
    buffer_load_dword v208, v30, s[52:55], 0 offen
    L_t0:
    s_waitcnt vmcnt(16) lgkmcnt(0)
    s_barrier
    s_mov_b64 exec, 1
    buffer_store_dwordx2 v[210:211], v213, s[76:79], 0 offen sc1
    s_mov_b64 exec, -1
    s_add_u32 m0, s101, 0
    s_nop 0
    buffer_load_dwordx4 v4, s[8:11], s100 offen lds
    buffer_load_dwordx4 v5, s[8:11], s100 offen offset:1024 lds
    buffer_load_dwordx4 v6, s[8:11], s100 offen offset:2048 lds
    buffer_load_dwordx4 v7, s[8:11], s100 offen offset:3072 lds
    s_add_u32 m0, s101, 16384
    s_nop 0
    buffer_load_dwordx4 v8, s[12:15], s100 offen lds
    buffer_load_dwordx4 v9, s[12:15], s100 offen offset:1024 lds
    s_add_u32 m0, s101, 18432
    s_nop 0
    buffer_load_dwordx4 v8, s[16:19], s100 offen lds
    buffer_load_dwordx4 v9, s[16:19], s100 offen offset:1024 lds
    s_add_u32 s100, s100, 128
    s_and_b32 s100, s100, 2047
    s_cmp_eq_u32 s46, 1
    s_cbranch_scc0 L_t1
    buffer_load_dword v208, v30, s[52:55], 0 offen
    L_t1:
    s_waitcnt vmcnt(17)
    s_barrier
    s_add_u32 m0, s101, 32768
    s_nop 0
    buffer_load_dwordx4 v4, s[8:11], s100 offen lds
    buffer_load_dwordx4 v5, s[8:11], s100 offen offset:1024 lds
    buffer_load_dwordx4 v6, s[8:11], s100 offen offset:2048 lds
    buffer_load_dwordx4 v7, s[8:11], s100 offen offset:3072 lds
    s_add_u32 m0, s101, 49152
    s_nop 0
    buffer_load_dwordx4 v8, s[12:15], s100 offen lds
    buffer_load_dwordx4 v9, s[12:15], s100 offen offset:1024 lds
    s_add_u32 m0, s101, 51200
    s_nop 0
    buffer_load_dwordx4 v8, s[16:19], s100 offen lds
    buffer_load_dwordx4 v9, s[16:19], s100 offen offset:1024 lds
    s_add_u32 s100, s100, 128
    s_and_b32 s100, s100, 2047
    s_cmp_eq_u32 s46, 2
    s_cbranch_scc0 L_t2
    buffer_load_dword v208, v30, s[52:55], 0 offen
    L_t2:
    s_waitcnt vmcnt(17)
    s_barrier
    s_add_u32 m0, s101, 65536
    s_nop 0
    buffer_load_dwordx4 v4, s[8:11], s100 offen lds
    buffer_load_dwordx4 v5, s[8:11], s100 offen offset:1024 lds
    buffer_load_dwordx4 v6, s[8:11], s100 offen offset:2048 lds
    buffer_load_dwordx4 v7, s[8:11], s100 offen offset:3072 lds
    s_add_u32 m0, s101, 81920
    s_nop 0
    buffer_load_dwordx4 v8, s[12:15], s100 offen lds
    buffer_load_dwordx4 v9, s[12:15], s100 offen offset:1024 lds
    s_add_u32 m0, s101, 83968
    s_nop 0
    buffer_load_dwordx4 v8, s[16:19], s100 offen lds
    buffer_load_dwordx4 v9, s[16:19], s100 offen offset:1024 lds
    s_add_u32 s100, s100, 128
    s_and_b32 s100, s100, 2047
    s_cmp_eq_u32 s46, 3
    s_cbranch_scc0 L_t3
    buffer_load_dword v208, v30, s[52:55], 0 offen
    L_t3:
    s_waitcnt vmcnt(16)
    s_barrier
    s_add_u32 m0, s101, 98304
    s_nop 0
    buffer_load_dwordx4 v4, s[8:11], s100 offen lds
    buffer_load_dwordx4 v5, s[8:11], s100 offen offset:1024 lds
    buffer_load_dwordx4 v6, s[8:11], s100 offen offset:2048 lds
    buffer_load_dwordx4 v7, s[8:11], s100 offen offset:3072 lds
    s_add_u32 m0, s101, 114688
    s_nop 0
    buffer_load_dwordx4 v8, s[12:15], s100 offen lds
    buffer_load_dwordx4 v9, s[12:15], s100 offen offset:1024 lds
    s_add_u32 m0, s101, 116736
    s_nop 0
    buffer_load_dwordx4 v8, s[16:19], s100 offen lds
    buffer_load_dwordx4 v9, s[16:19], s100 offen offset:1024 lds
    s_add_u32 s100, s100, 128
    s_and_b32 s100, s100, 2047
    s_cmp_eq_u32 s46, 4
    s_cbranch_scc0 L_t4
    buffer_load_dword v208, v30, s[52:55], 0 offen
    L_t4:
    s_waitcnt vmcnt(16)
    s_barrier
    buffer_load_dwordx2 v[22:23], v14, s[76:79], 0 offen sc1
    s_add_u32 m0, s101, 0
    s_nop 0
    buffer_load_dwordx4 v4, s[8:11], s100 offen lds
    buffer_load_dwordx4 v5, s[8:11], s100 offen offset:1024 lds
    buffer_load_dwordx4 v6, s[8:11], s100 offen offset:2048 lds
    buffer_load_dwordx4 v7, s[8:11], s100 offen offset:3072 lds
    s_add_u32 m0, s101, 16384
    s_nop 0
    buffer_load_dwordx4 v8, s[12:15], s100 offen lds
    buffer_load_dwordx4 v9, s[12:15], s100 offen offset:1024 lds
    s_add_u32 m0, s101, 18432
    s_nop 0
    buffer_load_dwordx4 v8, s[16:19], s100 offen lds
    s_waitcnt vmcnt(16)
    s_barrier
    buffer_load_dwordx4 v9, s[16:19], s100 offen offset:1024 lds
    s_add_u32 s100, s100, 128
    s_and_b32 s100, s100, 2047
    s_cmp_eq_u32 s46, 5
    s_cbranch_scc0 L_t5
    buffer_load_dword v208, v30, s[52:55], 0 offen
    L_t5:
    s_add_u32 m0, s101, 32768
    s_nop 0
    buffer_load_dwordx4 v4, s[8:11], s100 offen lds
    buffer_load_dwordx4 v5, s[8:11], s100 offen offset:1024 lds
    buffer_load_dwordx4 v6, s[8:11], s100 offen offset:2048 lds
    buffer_load_dwordx4 v7, s[8:11], s100 offen offset:3072 lds
    s_add_u32 m0, s101, 49152
    s_nop 0
    buffer_load_dwordx4 v8, s[12:15], s100 offen lds
    buffer_load_dwordx4 v9, s[12:15], s100 offen offset:1024 lds
    s_add_u32 m0, s101, 51200
    s_nop 0
    buffer_load_dwordx4 v8, s[16:19], s100 offen lds
    s_waitcnt vmcnt(16)
    s_barrier
    buffer_load_dwordx4 v9, s[16:19], s100 offen offset:1024 lds
    s_add_u32 s100, s100, 128
    s_and_b32 s100, s100, 2047
    s_cmp_eq_u32 s46, 6
    s_cbranch_scc0 L_t6
    buffer_load_dword v208, v30, s[52:55], 0 offen
    L_t6:
    s_add_u32 m0, s101, 65536
    s_nop 0
    buffer_load_dwordx4 v4, s[8:11], s100 offen lds
    buffer_load_dwordx4 v5, s[8:11], s100 offen offset:1024 lds
    buffer_load_dwordx4 v6, s[8:11], s100 offen offset:2048 lds
    buffer_load_dwordx4 v7, s[8:11], s100 offen offset:3072 lds
    s_add_u32 m0, s101, 81920
    s_nop 0
    buffer_load_dwordx4 v8, s[12:15], s100 offen lds
    buffer_load_dwordx4 v9, s[12:15], s100 offen offset:1024 lds
    s_add_u32 m0, s101, 83968
    s_nop 0
    buffer_load_dwordx4 v8, s[16:19], s100 offen lds
    buffer_load_dwordx4 v9, s[16:19], s100 offen offset:1024 lds
    s_add_u32 s100, s100, 128
    s_and_b32 s100, s100, 2047
    s_cmp_eq_u32 s46, 7
    s_cbranch_scc0 L_t7
    buffer_load_dword v208, v30, s[52:55], 0 offen
    L_t7:
    s_waitcnt vmcnt(16)
    s_barrier
    s_add_u32 m0, s45, 102496
    s_nop 0
    buffer_load_dwordx4 v10, s[68:71], s35 offen offset:0 nt lds
    s_add_u32 m0, s45, 102496
    s_nop 0
    buffer_load_dwordx4 v10, s[68:71], s35 offen offset:1024 nt lds
    s_add_u32 m0, s45, 102496
    s_nop 0
    buffer_load_dwordx4 v10, s[68:71], s35 offen offset:2048 nt lds
    s_add_u32 m0, s45, 102496
    s_nop 0
    buffer_load_dwordx4 v10, s[68:71], s35 offen offset:3072 nt lds
    v_bfrev_b32 v11, 1
    s_waitcnt vmcnt(28)
    v_cmp_eq_u32 vcc, v22, v28
    v_cmp_eq_u32 s[48:49], v23, v29
    s_nop 0
    s_and_b64 s[48:49], s[48:49], vcc
    s_cmp_eq_u64 s[48:49], -1
    s_cselect_b32 s50, 1, 0
    s_cselect_b64 vcc, -1, 0
    s_nop 1
    v_cndmask_b32 v11, v11, v10, vcc
    buffer_load_dwordx4 v[192:195], v11, s[72:75], s35 offen offset:0 sc1
    buffer_load_dwordx4 v[196:199], v11, s[72:75], s35 offen offset:1024 sc1
    buffer_load_dwordx4 v[200:203], v11, s[72:75], s35 offen offset:2048 sc1
    buffer_load_dwordx4 v[204:207], v11, s[72:75], s35 offen offset:3072 sc1
    s_waitcnt vmcnt(16)
    s_barrier
    v_mov_b32 v32, 0
    v_mov_b32 v33, 0
    v_mov_b32 v34, 0
    v_mov_b32 v35, 0
    s_add_u32 s47, s45, 110720
    v_add_u32 v1, s47, v10
    v_and_b32 v3, 16, v10
    v_and_b32 v15, 32, v10
    v_mul_u32_u24 v15, 130, v15
    v_add3_u32 v3, v3, v15, s45
    v_add_u32 v3, 98304, v3
    v_cmp_gt_u32 vcc, 32, v2
    s_add_u32 s47, s45, 102492
    v_add_u32 v15, s47, v10
    v_cndmask_b32 v1, v3, v1, vcc
    ds_write_b128 v1, v[32:35]
    s_waitcnt vmcnt(8)
    s_barrier
    s_mov_b32 s36, 0
    buffer_load_dwordx2 v[220:221], v218, s[40:43], s36 offen nt
    s_mov_b32 s36, 8192
    buffer_load_dwordx2 v[222:223], v218, s[40:43], s36 offen nt
    s_mov_b32 s36, 16384
    buffer_load_dwordx2 v[224:225], v218, s[40:43], s36 offen nt
    s_mov_b32 s36, 24576
    buffer_load_dwordx2 v[226:227], v218, s[40:43], s36 offen nt
    s_mov_b32 s36, 32768
    buffer_load_dwordx2 v[228:229], v218, s[40:43], s36 offen nt
    s_mov_b32 s36, 40960
    buffer_load_dwordx2 v[230:231], v218, s[40:43], s36 offen nt
    s_mov_b32 s36, 49152
    buffer_load_dwordx2 v[232:233], v218, s[40:43], s36 offen nt
    s_mov_b32 s36, 57344
    buffer_load_dwordx2 v[234:235], v218, s[40:43], s36 offen nt
    s_waitcnt vmcnt(12)
    ds_read_b32 v64, v15 offset:0
    ds_read_b128 v[68:71], v15 offset:4
    ds_read_b32 v72, v15 offset:1024
    ds_read_b128 v[76:79], v15 offset:1028
    ds_read_b32 v80, v15 offset:2048
    ds_read_b128 v[84:87], v15 offset:2052
    ds_read_b32 v88, v15 offset:3072
    ds_read_b128 v[92:95], v15 offset:3076
    v_subrev_u32 v15, 4156, v15
    s_waitcnt lgkmcnt(0)
    v_alignbit_b32 v64, v68, v64, 16
    v_alignbit_b32 v65, v69, v68, 16
    v_alignbit_b32 v66, v70, v69, 16
    v_alignbit_b32 v67, v71, v70, 16
    ds_write_b128 v15, v[64:67] offset:0
    v_alignbit_b32 v72, v76, v72, 16
    v_alignbit_b32 v73, v77, v76, 16
    v_alignbit_b32 v74, v78, v77, 16
    v_alignbit_b32 v75, v79, v78, 16
    ds_write_b128 v15, v[72:75] offset:1024
    v_alignbit_b32 v80, v84, v80, 16
    v_alignbit_b32 v81, v85, v84, 16
    v_alignbit_b32 v82, v86, v85, 16
    v_alignbit_b32 v83, v87, v86, 16
    ds_write_b128 v15, v[80:83] offset:2048
    v_alignbit_b32 v88, v92, v88, 16
    v_alignbit_b32 v89, v93, v92, 16
    v_alignbit_b32 v90, v94, v93, 16
    v_alignbit_b32 v91, v95, v94, 16
    ds_write_b128 v15, v[88:91] offset:3072
    s_cmp_eq_u32 s50, 1
    s_cbranch_scc1 L_have
    s_mov_b32 s51, 0
L_spin:
    buffer_load_dwordx2 v[22:23], v14, s[76:79], 0 offen sc1
    s_add_u32 s51, s51, 1
    s_waitcnt vmcnt(0)
    v_cmp_eq_u32 vcc, v22, v28
    v_cmp_eq_u32 s[48:49], v23, v29
    s_cmp_gt_u32 s51, 4096
    s_cbranch_scc1 L_spin_go
    s_and_b64 s[48:49], s[48:49], vcc
    s_cmp_eq_u64 s[48:49], -1
    s_cbranch_scc0 L_spin
L_spin_go:
    buffer_load_dwordx4 v[192:195], v10, s[72:75], s35 offen offset:0 sc1
    buffer_load_dwordx4 v[196:199], v10, s[72:75], s35 offen offset:1024 sc1
    buffer_load_dwordx4 v[200:203], v10, s[72:75], s35 offen offset:2048 sc1
    buffer_load_dwordx4 v[204:207], v10, s[72:75], s35 offen offset:3072 sc1
    s_waitcnt vmcnt(0)
L_have:
    s_add_u32 s47, s45, 106624
    v_add_u32 v1, s47, v10
    s_waitcnt vmcnt(8)
    ds_write_b128 v1, v[192:195] offset:0
    ds_write_b128 v1, v[196:199] offset:1024
    ds_write_b128 v1, v[200:203] offset:2048
    ds_write_b128 v1, v[204:207] offset:3072
    s_waitcnt lgkmcnt(0)
    ds_read_b128 v[96:99], v20 offset:3584
    ds_read2_b32 v[64:65], v16 offset0:0 offset1:1
    ds_read2_b32 v[66:67], v16 offset0:2 offset1:3
    ds_read_b128 v[100:103], v20 offset:3072
    ds_read2_b32 v[68:69], v16 offset0:128 offset1:129
    ds_read2_b32 v[70:71], v16 offset0:130 offset1:131
    ds_read_b128 v[104:107], v20 offset:2560
    ds_read2_b32 v[72:73], v17 offset0:0 offset1:1
    ds_read2_b32 v[74:75], v17 offset0:2 offset1:3
    ds_read_b128 v[108:111], v20 offset:2048
    ds_read2_b32 v[76:77], v17 offset0:128 offset1:129
    ds_read2_b32 v[78:79], v17 offset0:130 offset1:131
    ds_read_b128 v[112:115], v20 offset:1536
    ds_read2_b32 v[80:81], v18 offset0:0 offset1:1
    ds_read2_b32 v[82:83], v18 offset0:2 offset1:3
    ds_read_b128 v[116:119], v20 offset:1024
    ds_read2_b32 v[84:85], v18 offset0:128 offset1:129
    ds_read2_b32 v[86:87], v18 offset0:130 offset1:131
    ds_read_b128 v[120:123], v20 offset:512
    ds_read2_b32 v[88:89], v19 offset0:0 offset1:1
    ds_read2_b32 v[90:91], v19 offset0:2 offset1:3
    ds_read_b128 v[124:127], v20 offset:0
    ds_read2_b32 v[92:93], v19 offset0:128 offset1:129
    ds_read2_b32 v[94:95], v19 offset0:130 offset1:131
    s_waitcnt lgkmcnt(0)
    v_mfma_f32_16x16x32_bf16 v[32:35], v[24:27], v[96:99], 0
    v_mfma_f32_16x16x32_bf16 v[36:39], v[24:27], v[100:103], 0
    v_mfma_f32_16x16x32_bf16 v[40:43], v[24:27], v[104:107], 0
    v_mfma_f32_16x16x32_bf16 v[44:47], v[24:27], v[108:111], 0
    v_mfma_f32_16x16x32_bf16 v[48:51], v[24:27], v[112:115], 0
    v_mfma_f32_16x16x32_bf16 v[52:55], v[24:27], v[116:119], 0
    v_mfma_f32_16x16x32_bf16 v[56:59], v[24:27], v[120:123], 0
    v_mfma_f32_16x16x32_bf16 v[60:63], v[24:27], v[124:127], 0
    s_mov_b32 s51, 0
    s_mov_b32 m0, s45
L_conv:
    v_mfma_f32_16x16x32_bf16 v[32:35], v[64:67], v[96:99], v[32:35]
    ds_read_b128 v[160:163], v20 offset:3648
    v_mfma_f32_16x16x32_bf16 v[36:39], v[64:67], v[100:103], v[36:39]
    ds_read2_b32 v[128:129], v16 offset0:16 offset1:17
    v_mfma_f32_16x16x32_bf16 v[40:43], v[64:67], v[104:107], v[40:43]
    ds_read2_b32 v[130:131], v16 offset0:18 offset1:19
    v_mfma_f32_16x16x32_bf16 v[44:47], v[64:67], v[108:111], v[44:47]
    ds_read_b128 v[164:167], v20 offset:3136
    v_mfma_f32_16x16x32_bf16 v[48:51], v[64:67], v[112:115], v[48:51]
    ds_read2_b32 v[132:133], v16 offset0:144 offset1:145
    v_mfma_f32_16x16x32_bf16 v[52:55], v[64:67], v[116:119], v[52:55]
    ds_read2_b32 v[134:135], v16 offset0:146 offset1:147
    v_mfma_f32_16x16x32_bf16 v[56:59], v[64:67], v[120:123], v[56:59]
    ds_read_b128 v[168:171], v20 offset:2624
    v_mfma_f32_16x16x32_bf16 v[60:63], v[64:67], v[124:127], v[60:63]
    ds_read2_b32 v[136:137], v17 offset0:16 offset1:17
    v_mfma_f32_16x16x32_bf16 v[36:39], v[68:71], v[96:99], v[36:39]
    ds_read2_b32 v[138:139], v17 offset0:18 offset1:19
    v_mfma_f32_16x16x32_bf16 v[40:43], v[68:71], v[100:103], v[40:43]
    ds_read_b128 v[172:175], v20 offset:2112
    v_mfma_f32_16x16x32_bf16 v[44:47], v[68:71], v[104:107], v[44:47]
    ds_read2_b32 v[140:141], v17 offset0:144 offset1:145
    v_mfma_f32_16x16x32_bf16 v[48:51], v[68:71], v[108:111], v[48:51]
    ds_read2_b32 v[142:143], v17 offset0:146 offset1:147
    v_mfma_f32_16x16x32_bf16 v[52:55], v[68:71], v[112:115], v[52:55]
    ds_read_b128 v[176:179], v20 offset:1600
    v_mfma_f32_16x16x32_bf16 v[56:59], v[68:71], v[116:119], v[56:59]
    ds_read2_b32 v[144:145], v18 offset0:16 offset1:17
    v_mfma_f32_16x16x32_bf16 v[60:63], v[68:71], v[120:123], v[60:63]
    ds_read2_b32 v[146:147], v18 offset0:18 offset1:19
    v_mfma_f32_16x16x32_bf16 v[40:43], v[72:75], v[96:99], v[40:43]
    ds_read_b128 v[180:183], v20 offset:1088
    v_mfma_f32_16x16x32_bf16 v[44:47], v[72:75], v[100:103], v[44:47]
    ds_read2_b32 v[148:149], v18 offset0:144 offset1:145
    v_mfma_f32_16x16x32_bf16 v[48:51], v[72:75], v[104:107], v[48:51]
    ds_read2_b32 v[150:151], v18 offset0:146 offset1:147
    v_mfma_f32_16x16x32_bf16 v[52:55], v[72:75], v[108:111], v[52:55]
    ds_read_b128 v[184:187], v20 offset:576
    v_mfma_f32_16x16x32_bf16 v[56:59], v[72:75], v[112:115], v[56:59]
    ds_read2_b32 v[152:153], v19 offset0:16 offset1:17
    v_mfma_f32_16x16x32_bf16 v[60:63], v[72:75], v[116:119], v[60:63]
    ds_read2_b32 v[154:155], v19 offset0:18 offset1:19
    v_mfma_f32_16x16x32_bf16 v[44:47], v[76:79], v[96:99], v[44:47]
    ds_read_b128 v[188:191], v20 offset:64
    v_mfma_f32_16x16x32_bf16 v[48:51], v[76:79], v[100:103], v[48:51]
    ds_read2_b32 v[156:157], v19 offset0:144 offset1:145
    v_mfma_f32_16x16x32_bf16 v[52:55], v[76:79], v[104:107], v[52:55]
    ds_read2_b32 v[158:159], v19 offset0:146 offset1:147
    v_mfma_f32_16x16x32_bf16 v[56:59], v[76:79], v[108:111], v[56:59]
    buffer_load_dwordx4 v215, s[24:27], s44 offen lds
    v_mfma_f32_16x16x32_bf16 v[60:63], v[76:79], v[112:115], v[60:63]
    buffer_load_dwordx4 v216, s[24:27], s44 offen offset:1024 lds
    s_add_u32 m0, m0, 2048
    v_mfma_f32_16x16x32_bf16 v[48:51], v[80:83], v[96:99], v[48:51]
    v_mfma_f32_16x16x32_bf16 v[52:55], v[80:83], v[100:103], v[52:55]
    v_mfma_f32_16x16x32_bf16 v[56:59], v[80:83], v[104:107], v[56:59]
    v_mfma_f32_16x16x32_bf16 v[60:63], v[80:83], v[108:111], v[60:63]
    v_mfma_f32_16x16x32_bf16 v[52:55], v[84:87], v[96:99], v[52:55]
    v_mfma_f32_16x16x32_bf16 v[56:59], v[84:87], v[100:103], v[56:59]
    v_mfma_f32_16x16x32_bf16 v[60:63], v[84:87], v[104:107], v[60:63]
    v_mfma_f32_16x16x32_bf16 v[56:59], v[88:91], v[96:99], v[56:59]
    v_mfma_f32_16x16x32_bf16 v[60:63], v[88:91], v[100:103], v[60:63]
    v_mfma_f32_16x16x32_bf16 v[60:63], v[92:95], v[96:99], v[60:63]
    s_waitcnt lgkmcnt(0)
    v_mfma_f32_16x16x32_bf16 v[32:35], v[128:131], v[160:163], v[32:35]
    buffer_load_dwordx4 v215, s[28:31], s44 offen lds
    v_mfma_f32_16x16x32_bf16 v[36:39], v[128:131], v[164:167], v[36:39]
    buffer_load_dwordx4 v216, s[28:31], s44 offen offset:1024 lds
    s_add_u32 s44, s44, 128
    s_and_b32 s44, s44, 2047
    s_add_u32 m0, m0, 2048
    v_mfma_f32_16x16x32_bf16 v[40:43], v[128:131], v[168:171], v[40:43]
    ds_read_b128 v[96:99], v20 offset:3712
    v_mfma_f32_16x16x32_bf16 v[44:47], v[128:131], v[172:175], v[44:47]
    ds_read2_b32 v[64:65], v16 offset0:32 offset1:33
    v_mfma_f32_16x16x32_bf16 v[48:51], v[128:131], v[176:179], v[48:51]
    ds_read2_b32 v[66:67], v16 offset0:34 offset1:35
    v_mfma_f32_16x16x32_bf16 v[52:55], v[128:131], v[180:183], v[52:55]
    ds_read_b128 v[100:103], v20 offset:3200
    v_mfma_f32_16x16x32_bf16 v[56:59], v[128:131], v[184:187], v[56:59]
    ds_read2_b32 v[68:69], v16 offset0:160 offset1:161
    v_mfma_f32_16x16x32_bf16 v[60:63], v[128:131], v[188:191], v[60:63]
    ds_read2_b32 v[70:71], v16 offset0:162 offset1:163
    v_mfma_f32_16x16x32_bf16 v[36:39], v[132:135], v[160:163], v[36:39]
    ds_read_b128 v[104:107], v20 offset:2688
    v_mfma_f32_16x16x32_bf16 v[40:43], v[132:135], v[164:167], v[40:43]
    ds_read2_b32 v[72:73], v17 offset0:32 offset1:33
    v_mfma_f32_16x16x32_bf16 v[44:47], v[132:135], v[168:171], v[44:47]
    ds_read2_b32 v[74:75], v17 offset0:34 offset1:35
    v_mfma_f32_16x16x32_bf16 v[48:51], v[132:135], v[172:175], v[48:51]
    ds_read_b128 v[108:111], v20 offset:2176
    v_mfma_f32_16x16x32_bf16 v[52:55], v[132:135], v[176:179], v[52:55]
    ds_read2_b32 v[76:77], v17 offset0:160 offset1:161
    v_mfma_f32_16x16x32_bf16 v[56:59], v[132:135], v[180:183], v[56:59]
    ds_read2_b32 v[78:79], v17 offset0:162 offset1:163
    v_mfma_f32_16x16x32_bf16 v[60:63], v[132:135], v[184:187], v[60:63]
    ds_read_b128 v[112:115], v20 offset:1664
    v_mfma_f32_16x16x32_bf16 v[40:43], v[136:139], v[160:163], v[40:43]
    ds_read2_b32 v[80:81], v18 offset0:32 offset1:33
    v_mfma_f32_16x16x32_bf16 v[44:47], v[136:139], v[164:167], v[44:47]
    ds_read2_b32 v[82:83], v18 offset0:34 offset1:35
    v_mfma_f32_16x16x32_bf16 v[48:51], v[136:139], v[168:171], v[48:51]
    ds_read_b128 v[116:119], v20 offset:1152
    v_mfma_f32_16x16x32_bf16 v[52:55], v[136:139], v[172:175], v[52:55]
    ds_read2_b32 v[84:85], v18 offset0:160 offset1:161
    v_mfma_f32_16x16x32_bf16 v[56:59], v[136:139], v[176:179], v[56:59]
    ds_read2_b32 v[86:87], v18 offset0:162 offset1:163
    v_mfma_f32_16x16x32_bf16 v[60:63], v[136:139], v[180:183], v[60:63]
    ds_read_b128 v[120:123], v20 offset:640
    v_mfma_f32_16x16x32_bf16 v[44:47], v[140:143], v[160:163], v[44:47]
    ds_read2_b32 v[88:89], v19 offset0:32 offset1:33
    v_mfma_f32_16x16x32_bf16 v[48:51], v[140:143], v[164:167], v[48:51]
    ds_read2_b32 v[90:91], v19 offset0:34 offset1:35
    v_mfma_f32_16x16x32_bf16 v[52:55], v[140:143], v[168:171], v[52:55]
    ds_read_b128 v[124:127], v20 offset:128
    v_mfma_f32_16x16x32_bf16 v[56:59], v[140:143], v[172:175], v[56:59]
    ds_read2_b32 v[92:93], v19 offset0:160 offset1:161
    v_mfma_f32_16x16x32_bf16 v[60:63], v[140:143], v[176:179], v[60:63]
    ds_read2_b32 v[94:95], v19 offset0:162 offset1:163
    v_mfma_f32_16x16x32_bf16 v[48:51], v[144:147], v[160:163], v[48:51]
    v_add_u32 v16, 128, v16
    v_mfma_f32_16x16x32_bf16 v[52:55], v[144:147], v[164:167], v[52:55]
    v_add_u32 v17, 128, v17
    v_mfma_f32_16x16x32_bf16 v[56:59], v[144:147], v[168:171], v[56:59]
    v_add_u32 v18, 128, v18
    v_mfma_f32_16x16x32_bf16 v[60:63], v[144:147], v[172:175], v[60:63]
    v_add_u32 v19, 128, v19
    v_mfma_f32_16x16x32_bf16 v[52:55], v[148:151], v[160:163], v[52:55]
    v_add_u32 v20, 128, v20
    v_mfma_f32_16x16x32_bf16 v[56:59], v[148:151], v[164:167], v[56:59]
    v_mfma_f32_16x16x32_bf16 v[60:63], v[148:151], v[168:171], v[60:63]
    v_mfma_f32_16x16x32_bf16 v[56:59], v[152:155], v[160:163], v[56:59]
    v_mfma_f32_16x16x32_bf16 v[60:63], v[152:155], v[164:167], v[60:63]
    v_mfma_f32_16x16x32_bf16 v[60:63], v[156:159], v[160:163], v[60:63]
    s_add_u32 s51, s51, 1
    s_waitcnt lgkmcnt(0)
    s_cmp_lt_u32 s51, 4
    s_cbranch_scc1 L_conv
    s_nop 4
    v_cvt_pk_bf16_f32 v64, v32, v33
    v_cvt_pk_bf16_f32 v65, v34, v35
    ds_write_b64 v21, v[64:65] offset:0
    v_cvt_pk_bf16_f32 v66, v36, v37
    v_cvt_pk_bf16_f32 v67, v38, v39
    ds_write_b64 v21, v[66:67] offset:512
    v_cvt_pk_bf16_f32 v68, v40, v41
    v_cvt_pk_bf16_f32 v69, v42, v43
    ds_write_b64 v21, v[68:69] offset:1024
    v_cvt_pk_bf16_f32 v70, v44, v45
    v_cvt_pk_bf16_f32 v71, v46, v47
    ds_write_b64 v21, v[70:71] offset:1536
    v_cvt_pk_bf16_f32 v72, v48, v49
    v_cvt_pk_bf16_f32 v73, v50, v51
    ds_write_b64 v21, v[72:73] offset:2048
    v_cvt_pk_bf16_f32 v74, v52, v53
    v_cvt_pk_bf16_f32 v75, v54, v55
    ds_write_b64 v21, v[74:75] offset:2560
    v_cvt_pk_bf16_f32 v76, v56, v57
    v_cvt_pk_bf16_f32 v77, v58, v59
    ds_write_b64 v21, v[76:77] offset:3072
    v_cvt_pk_bf16_f32 v78, v60, v61
    v_cvt_pk_bf16_f32 v79, v62, v63
    ds_write_b64 v21, v[78:79] offset:3584
    s_waitcnt vmcnt(0)
    s_waitcnt lgkmcnt(0)
    s_barrier
    s_barrier
    s_mov_b32 s51, 0
L_hspin:
    buffer_load_dwordx2 v[22:23], v217, s[76:79], 0 offen sc1
    s_add_u32 s51, s51, 1
    s_waitcnt vmcnt(0)
    v_cmp_eq_u32 vcc, v22, v28
    v_cmp_eq_u32 s[48:49], v23, v29
    s_cmp_gt_u32 s51, 4096
    s_cbranch_scc1 L_hspin_go
    s_and_b64 s[48:49], s[48:49], vcc
    s_or_b64 s[48:49], s[48:49], s[56:57]
    s_cmp_eq_u64 s[48:49], -1
    s_cbranch_scc0 L_hspin
L_hspin_go:
    s_add_u32 m0, s45, 98304
    s_nop 0
    buffer_load_dwordx4 v214, s[80:83], s38 offen sc1 lds
    buffer_load_dwordx4 v214, s[80:83], s38 offen offset:1024 sc1 lds
    buffer_load_dwordx4 v214, s[80:83], s38 offen offset:2048 sc1 lds
    buffer_load_dwordx4 v214, s[80:83], s38 offen offset:3072 sc1 lds
    s_add_u32 s38, s38, 16384
    s_add_u32 m0, s45, 102400
    s_nop 0
    buffer_load_dwordx4 v214, s[80:83], s38 offen sc1 lds
    buffer_load_dwordx4 v214, s[80:83], s38 offen offset:1024 sc1 lds
    buffer_load_dwordx4 v214, s[80:83], s38 offen offset:2048 sc1 lds
    buffer_load_dwordx4 v214, s[80:83], s38 offen offset:3072 sc1 lds
    s_add_u32 s38, s38, 16384
    s_and_b32 s38, s38, 0x7ffff
L_join:
    s_add_u32 m0, s39, 65536
    s_nop 0
    buffer_load_dwordx4 v214, s[80:83], s38 offen sc1 lds
    buffer_load_dwordx4 v214, s[80:83], s38 offen offset:1024 sc1 lds
    buffer_load_dwordx4 v214, s[80:83], s38 offen offset:2048 sc1 lds
    buffer_load_dwordx4 v214, s[80:83], s38 offen offset:3072 sc1 lds
    s_add_u32 s38, s38, 16384
    s_add_u32 m0, s45, 0
    s_nop 0
    buffer_load_dwordx4 v215, s[24:27], s44 offen lds
    buffer_load_dwordx4 v216, s[24:27], s44 offen offset:1024 lds
    s_add_u32 s8, s66, 4194304
    s_addc_u32 s9, s67, 0
    s_mov_b32 s10, 4194304
    s_mov_b32 s11, 0x00020000
    s_mov_b32 s12, s62
    s_mov_b32 s13, s63
    s_mov_b32 s14, 16777216
    s_mov_b32 s15, 0x00020000
    s_lshr_b32 s7, s3, 2
    s_lshl_b32 s7, s7, 4
    s_add_u32 s7, s7, s4
    s_lshl_b32 s7, s7, 11
    s_add_u32 s7, s7, 262144
    v_lshlrev_b32 v1, 7, v12
    v_add_u32 v32, s7, v1
    v_xor_b32 v1, v12, v13
    v_lshlrev_b32 v1, 4, v1
    v_lshl_add_u32 v3, v13, 14, v1
    s_lshl_b32 s47, s3, 2
    s_add_u32 s47, s47, s6
    s_lshl_b32 s7, s4, 10
    s_add_u32 s7, s7, s47
    s_lshl_b32 s7, s7, 8
    v_add_u32 v33, s7, v3
    v_xor_b32 v34, 64, v33
    v_add_u32 v34, 64512, v34
    v_xor_b32 v35, 128, v33
    v_add_u32 v35, 129024, v35
    v_xor_b32 v36, 192, v33
    v_add_u32 v36, 193536, v36
    s_add_u32 s35, s45, 106496
    v_lshl_add_u32 v1, v12, 8, v1
    v_add_u32 v37, s35, v1
    v_xor_b32 v38, 64, v37
    v_xor_b32 v39, 128, v37
    v_xor_b32 v40, 192, v37
    s_lshl_b32 s47, s47, 10
    s_add_u32 s47, s47, s4
    s_lshl_b32 s47, s47, 8
    v_lshlrev_b32 v1, 13, v13
    v_lshl_add_u32 v1, v12, 4, v1
    v_add_u32 v41, s47, v1
    s_waitcnt vmcnt(10)
    s_barrier
    s_add_u32 m0, s39, 69632
    s_nop 0
    buffer_load_dwordx4 v214, s[80:83], s38 offen sc1 lds
    buffer_load_dwordx4 v214, s[80:83], s38 offen offset:1024 sc1 lds
    buffer_load_dwordx4 v214, s[80:83], s38 offen offset:2048 sc1 lds
    buffer_load_dwordx4 v214, s[80:83], s38 offen offset:3072 sc1 lds
    s_add_u32 s38, s38, 16384
    s_and_b32 s38, s38, 0x7ffff
    s_add_u32 m0, s45, 2048
    s_nop 0
    buffer_load_dwordx4 v215, s[28:31], s44 offen lds
    buffer_load_dwordx4 v216, s[28:31], s44 offen offset:1024 lds
    s_add_u32 s44, s44, 128
    s_and_b32 s44, s44, 2047
    s_waitcnt vmcnt(12)
    s_barrier
    s_add_u32 m0, s45, 98304
    s_nop 0
    buffer_load_dwordx4 v214, s[80:83], s38 offen sc1 lds
    buffer_load_dwordx4 v214, s[80:83], s38 offen offset:1024 sc1 lds
    buffer_load_dwordx4 v214, s[80:83], s38 offen offset:2048 sc1 lds
    buffer_load_dwordx4 v214, s[80:83], s38 offen offset:3072 sc1 lds
    s_add_u32 s38, s38, 16384
    s_add_u32 m0, s45, 4096
    s_nop 0
    buffer_load_dwordx4 v215, s[24:27], s44 offen lds
    buffer_load_dwordx4 v216, s[24:27], s44 offen offset:1024 lds
    s_waitcnt vmcnt(14)
    s_barrier
    s_add_u32 m0, s45, 102400
    s_nop 0
    buffer_load_dwordx4 v214, s[80:83], s38 offen sc1 lds
    buffer_load_dwordx4 v214, s[80:83], s38 offen offset:1024 sc1 lds
    buffer_load_dwordx4 v214, s[80:83], s38 offen offset:2048 sc1 lds
    buffer_load_dwordx4 v214, s[80:83], s38 offen offset:3072 sc1 lds
    s_add_u32 s38, s38, 16384
    s_and_b32 s38, s38, 0x7ffff
    s_add_u32 m0, s45, 6144
    s_nop 0
    buffer_load_dwordx4 v215, s[28:31], s44 offen lds
    buffer_load_dwordx4 v216, s[28:31], s44 offen offset:1024 lds
    s_add_u32 s44, s44, 128
    s_and_b32 s44, s44, 2047
    s_waitcnt vmcnt(14)
    s_barrier
    s_add_u32 m0, s39, 65536
    s_nop 0
    buffer_load_dwordx4 v214, s[80:83], s38 offen sc1 lds
    buffer_load_dwordx4 v214, s[80:83], s38 offen offset:1024 sc1 lds
    buffer_load_dwordx4 v214, s[80:83], s38 offen offset:2048 sc1 lds
    buffer_load_dwordx4 v214, s[80:83], s38 offen offset:3072 sc1 lds
    s_add_u32 s38, s38, 16384
    s_add_u32 m0, s45, 8192
    s_nop 0
    buffer_load_dwordx4 v215, s[24:27], s44 offen lds
    buffer_load_dwordx4 v216, s[24:27], s44 offen offset:1024 lds
    s_waitcnt vmcnt(14)
    s_barrier
    s_add_u32 m0, s39, 69632
    s_nop 0
    buffer_load_dwordx4 v214, s[80:83], s38 offen sc1 lds
    buffer_load_dwordx4 v214, s[80:83], s38 offen offset:1024 sc1 lds
    buffer_load_dwordx4 v214, s[80:83], s38 offen offset:2048 sc1 lds
    buffer_load_dwordx4 v214, s[80:83], s38 offen offset:3072 sc1 lds
    s_add_u32 s38, s38, 16384
    s_and_b32 s38, s38, 0x7ffff
    s_add_u32 m0, s45, 10240
    s_nop 0
    buffer_load_dwordx4 v215, s[28:31], s44 offen lds
    buffer_load_dwordx4 v216, s[28:31], s44 offen offset:1024 lds
    s_add_u32 s44, s44, 128
    s_and_b32 s44, s44, 2047
    s_waitcnt vmcnt(14)
    s_barrier
    s_add_u32 m0, s45, 98304
    s_nop 0
    buffer_load_dwordx4 v214, s[80:83], s38 offen sc1 lds
    buffer_load_dwordx4 v214, s[80:83], s38 offen offset:1024 sc1 lds
    buffer_load_dwordx4 v214, s[80:83], s38 offen offset:2048 sc1 lds
    buffer_load_dwordx4 v214, s[80:83], s38 offen offset:3072 sc1 lds
    s_add_u32 s38, s38, 16384
    s_add_u32 m0, s45, 12288
    s_nop 0
    buffer_load_dwordx4 v215, s[24:27], s44 offen lds
    buffer_load_dwordx4 v216, s[24:27], s44 offen offset:1024 lds
    s_waitcnt vmcnt(14)
    s_barrier
    s_add_u32 m0, s45, 102400
    s_nop 0
    buffer_load_dwordx4 v214, s[80:83], s38 offen sc1 lds
    buffer_load_dwordx4 v214, s[80:83], s38 offen offset:1024 sc1 lds
    buffer_load_dwordx4 v214, s[80:83], s38 offen offset:2048 sc1 lds
    buffer_load_dwordx4 v214, s[80:83], s38 offen offset:3072 sc1 lds
    s_add_u32 s38, s38, 16384
    s_and_b32 s38, s38, 0x7ffff
    s_add_u32 m0, s45, 14336
    s_nop 0
    buffer_load_dwordx4 v215, s[28:31], s44 offen lds
    buffer_load_dwordx4 v216, s[28:31], s44 offen offset:1024 lds
    s_add_u32 s44, s44, 128
    s_and_b32 s44, s44, 2047
    s_waitcnt vmcnt(14)
    s_barrier
    s_add_u32 m0, s39, 65536
    s_nop 0
    buffer_load_dwordx4 v214, s[80:83], s38 offen sc1 lds
    buffer_load_dwordx4 v214, s[80:83], s38 offen offset:1024 sc1 lds
    buffer_load_dwordx4 v214, s[80:83], s38 offen offset:2048 sc1 lds
    buffer_load_dwordx4 v214, s[80:83], s38 offen offset:3072 sc1 lds
    s_add_u32 s38, s38, 16384
    s_add_u32 m0, s45, 0
    s_nop 0
    buffer_load_dwordx4 v215, s[24:27], s44 offen lds
    buffer_load_dwordx4 v216, s[24:27], s44 offen offset:1024 lds
    s_waitcnt vmcnt(14)
    s_barrier
    s_add_u32 m0, s39, 69632
    s_nop 0
    buffer_load_dwordx4 v214, s[80:83], s38 offen sc1 lds
    buffer_load_dwordx4 v214, s[80:83], s38 offen offset:1024 sc1 lds
    buffer_load_dwordx4 v214, s[80:83], s38 offen offset:2048 sc1 lds
    buffer_load_dwordx4 v214, s[80:83], s38 offen offset:3072 sc1 lds
    s_add_u32 s38, s38, 16384
    s_and_b32 s38, s38, 0x7ffff
    s_add_u32 m0, s45, 2048
    s_nop 0
    buffer_load_dwordx4 v215, s[28:31], s44 offen lds
    buffer_load_dwordx4 v216, s[28:31], s44 offen offset:1024 lds
    s_add_u32 s44, s44, 128
    s_and_b32 s44, s44, 2047
    s_waitcnt vmcnt(14)
    s_barrier
    s_add_u32 m0, s45, 98304
    s_nop 0
    buffer_load_dwordx4 v214, s[80:83], s38 offen sc1 lds
    buffer_load_dwordx4 v214, s[80:83], s38 offen offset:1024 sc1 lds
    buffer_load_dwordx4 v214, s[80:83], s38 offen offset:2048 sc1 lds
    buffer_load_dwordx4 v214, s[80:83], s38 offen offset:3072 sc1 lds
    s_add_u32 s38, s38, 16384
    s_add_u32 m0, s45, 4096
    s_nop 0
    buffer_load_dwordx4 v215, s[24:27], s44 offen lds
    buffer_load_dwordx4 v216, s[24:27], s44 offen offset:1024 lds
    s_waitcnt vmcnt(14)
    s_barrier
    s_add_u32 m0, s45, 102400
    s_nop 0
    buffer_load_dwordx4 v214, s[80:83], s38 offen sc1 lds
    buffer_load_dwordx4 v214, s[80:83], s38 offen offset:1024 sc1 lds
    buffer_load_dwordx4 v214, s[80:83], s38 offen offset:2048 sc1 lds
    buffer_load_dwordx4 v214, s[80:83], s38 offen offset:3072 sc1 lds
    s_add_u32 s38, s38, 16384
    s_and_b32 s38, s38, 0x7ffff
    s_add_u32 m0, s45, 6144
    s_nop 0
    buffer_load_dwordx4 v215, s[28:31], s44 offen lds
    buffer_load_dwordx4 v216, s[28:31], s44 offen offset:1024 lds
    s_add_u32 s44, s44, 128
    s_and_b32 s44, s44, 2047
    s_waitcnt vmcnt(14)
    s_barrier
    s_add_u32 m0, s39, 65536
    s_nop 0
    buffer_load_dwordx4 v214, s[80:83], s38 offen sc1 lds
    buffer_load_dwordx4 v214, s[80:83], s38 offen offset:1024 sc1 lds
    buffer_load_dwordx4 v214, s[80:83], s38 offen offset:2048 sc1 lds
    buffer_load_dwordx4 v214, s[80:83], s38 offen offset:3072 sc1 lds
    s_add_u32 s38, s38, 16384
    s_add_u32 m0, s45, 8192
    s_nop 0
    buffer_load_dwordx4 v215, s[24:27], s44 offen lds
    buffer_load_dwordx4 v216, s[24:27], s44 offen offset:1024 lds
    s_waitcnt vmcnt(14)
    s_barrier
    s_add_u32 m0, s39, 69632
    s_nop 0
    buffer_load_dwordx4 v214, s[80:83], s38 offen sc1 lds
    buffer_load_dwordx4 v214, s[80:83], s38 offen offset:1024 sc1 lds
    buffer_load_dwordx4 v214, s[80:83], s38 offen offset:2048 sc1 lds
    buffer_load_dwordx4 v214, s[80:83], s38 offen offset:3072 sc1 lds
    s_add_u32 s38, s38, 16384
    s_and_b32 s38, s38, 0x7ffff
    s_add_u32 m0, s45, 10240
    s_nop 0
    buffer_load_dwordx4 v215, s[28:31], s44 offen lds
    buffer_load_dwordx4 v216, s[28:31], s44 offen offset:1024 lds
    s_add_u32 s44, s44, 128
    s_and_b32 s44, s44, 2047
    s_waitcnt vmcnt(14)
    s_barrier
    s_add_u32 m0, s45, 98304
    s_nop 0
    buffer_load_dwordx4 v214, s[80:83], s38 offen sc1 lds
    buffer_load_dwordx4 v214, s[80:83], s38 offen offset:1024 sc1 lds
    buffer_load_dwordx4 v214, s[80:83], s38 offen offset:2048 sc1 lds
    buffer_load_dwordx4 v214, s[80:83], s38 offen offset:3072 sc1 lds
    s_add_u32 s38, s38, 16384
    s_add_u32 m0, s45, 12288
    s_nop 0
    buffer_load_dwordx4 v215, s[24:27], s44 offen lds
    buffer_load_dwordx4 v216, s[24:27], s44 offen offset:1024 lds
    s_waitcnt vmcnt(14)
    s_barrier
    s_add_u32 m0, s45, 102400
    s_nop 0
    buffer_load_dwordx4 v214, s[80:83], s38 offen sc1 lds
    buffer_load_dwordx4 v214, s[80:83], s38 offen offset:1024 sc1 lds
    buffer_load_dwordx4 v214, s[80:83], s38 offen offset:2048 sc1 lds
    buffer_load_dwordx4 v214, s[80:83], s38 offen offset:3072 sc1 lds
    s_add_u32 s38, s38, 16384
    s_and_b32 s38, s38, 0x7ffff
    s_add_u32 m0, s45, 14336
    s_nop 0
    buffer_load_dwordx4 v215, s[28:31], s44 offen lds
    buffer_load_dwordx4 v216, s[28:31], s44 offen offset:1024 lds
    s_add_u32 s44, s44, 128
    s_and_b32 s44, s44, 2047
    s_waitcnt vmcnt(14)
    s_barrier
    s_add_u32 m0, s39, 65536
    s_nop 0
    buffer_load_dwordx4 v214, s[80:83], s38 offen sc1 lds
    buffer_load_dwordx4 v214, s[80:83], s38 offen offset:1024 sc1 lds
    buffer_load_dwordx4 v214, s[80:83], s38 offen offset:2048 sc1 lds
    buffer_load_dwordx4 v214, s[80:83], s38 offen offset:3072 sc1 lds
    s_add_u32 s38, s38, 16384
    s_add_u32 m0, s45, 0
    s_nop 0
    buffer_load_dwordx4 v215, s[24:27], s44 offen lds
    buffer_load_dwordx4 v216, s[24:27], s44 offen offset:1024 lds
    s_waitcnt vmcnt(14)
    s_barrier
    s_add_u32 m0, s39, 69632
    s_nop 0
    buffer_load_dwordx4 v214, s[80:83], s38 offen sc1 lds
    buffer_load_dwordx4 v214, s[80:83], s38 offen offset:1024 sc1 lds
    buffer_load_dwordx4 v214, s[80:83], s38 offen offset:2048 sc1 lds
    buffer_load_dwordx4 v214, s[80:83], s38 offen offset:3072 sc1 lds
    s_add_u32 s38, s38, 16384
    s_and_b32 s38, s38, 0x7ffff
    s_add_u32 m0, s45, 2048
    s_nop 0
    buffer_load_dwordx4 v215, s[28:31], s44 offen lds
    buffer_load_dwordx4 v216, s[28:31], s44 offen offset:1024 lds
    s_add_u32 s44, s44, 128
    s_and_b32 s44, s44, 2047
    s_waitcnt vmcnt(14)
    s_barrier
    s_add_u32 m0, s45, 98304
    s_nop 0
    buffer_load_dwordx4 v214, s[80:83], s38 offen sc1 lds
    buffer_load_dwordx4 v214, s[80:83], s38 offen offset:1024 sc1 lds
    buffer_load_dwordx4 v214, s[80:83], s38 offen offset:2048 sc1 lds
    buffer_load_dwordx4 v214, s[80:83], s38 offen offset:3072 sc1 lds
    s_add_u32 s38, s38, 16384
    s_add_u32 m0, s45, 4096
    s_nop 0
    buffer_load_dwordx4 v215, s[24:27], s44 offen lds
    buffer_load_dwordx4 v216, s[24:27], s44 offen offset:1024 lds
    s_waitcnt vmcnt(14)
    s_barrier
    s_add_u32 m0, s45, 102400
    s_nop 0
    buffer_load_dwordx4 v214, s[80:83], s38 offen sc1 lds
    buffer_load_dwordx4 v214, s[80:83], s38 offen offset:1024 sc1 lds
    buffer_load_dwordx4 v214, s[80:83], s38 offen offset:2048 sc1 lds
    buffer_load_dwordx4 v214, s[80:83], s38 offen offset:3072 sc1 lds
    s_add_u32 s38, s38, 16384
    s_and_b32 s38, s38, 0x7ffff
    s_add_u32 m0, s45, 6144
    s_nop 0
    buffer_load_dwordx4 v215, s[28:31], s44 offen lds
    buffer_load_dwordx4 v216, s[28:31], s44 offen offset:1024 lds
    s_add_u32 s44, s44, 128
    s_and_b32 s44, s44, 2047
    s_waitcnt vmcnt(14)
    s_barrier
    s_add_u32 m0, s39, 65536
    s_nop 0
    buffer_load_dwordx4 v214, s[80:83], s38 offen sc1 lds
    buffer_load_dwordx4 v214, s[80:83], s38 offen offset:1024 sc1 lds
    buffer_load_dwordx4 v214, s[80:83], s38 offen offset:2048 sc1 lds
    buffer_load_dwordx4 v214, s[80:83], s38 offen offset:3072 sc1 lds
    s_add_u32 s38, s38, 16384
    s_add_u32 m0, s45, 8192
    s_nop 0
    buffer_load_dwordx4 v215, s[24:27], s44 offen lds
    buffer_load_dwordx4 v216, s[24:27], s44 offen offset:1024 lds
    s_waitcnt vmcnt(14)
    s_barrier
    s_add_u32 m0, s39, 69632
    s_nop 0
    buffer_load_dwordx4 v214, s[80:83], s38 offen sc1 lds
    buffer_load_dwordx4 v214, s[80:83], s38 offen offset:1024 sc1 lds
    buffer_load_dwordx4 v214, s[80:83], s38 offen offset:2048 sc1 lds
    buffer_load_dwordx4 v214, s[80:83], s38 offen offset:3072 sc1 lds
    s_add_u32 s38, s38, 16384
    s_and_b32 s38, s38, 0x7ffff
    s_add_u32 m0, s45, 10240
    s_nop 0
    buffer_load_dwordx4 v215, s[28:31], s44 offen lds
    buffer_load_dwordx4 v216, s[28:31], s44 offen offset:1024 lds
    s_add_u32 s44, s44, 128
    s_and_b32 s44, s44, 2047
    buffer_load_dwordx2 v[22:23], v32, s[76:79], 0 offen sc1
    s_waitcnt vmcnt(15)
    s_barrier
    s_add_u32 m0, s45, 98304
    s_nop 0
    buffer_load_dwordx4 v214, s[80:83], s38 offen sc1 lds
    buffer_load_dwordx4 v214, s[80:83], s38 offen offset:1024 sc1 lds
    buffer_load_dwordx4 v214, s[80:83], s38 offen offset:2048 sc1 lds
    buffer_load_dwordx4 v214, s[80:83], s38 offen offset:3072 sc1 lds
    s_add_u32 s38, s38, 16384
    s_add_u32 m0, s45, 12288
    s_nop 0
    buffer_load_dwordx4 v215, s[24:27], s44 offen lds
    buffer_load_dwordx4 v216, s[24:27], s44 offen offset:1024 lds
    s_waitcnt vmcnt(15)
    s_barrier
    s_add_u32 m0, s45, 102400
    s_nop 0
    buffer_load_dwordx4 v214, s[80:83], s38 offen sc1 lds
    buffer_load_dwordx4 v214, s[80:83], s38 offen offset:1024 sc1 lds
    buffer_load_dwordx4 v214, s[80:83], s38 offen offset:2048 sc1 lds
    buffer_load_dwordx4 v214, s[80:83], s38 offen offset:3072 sc1 lds
    s_add_u32 s38, s38, 16384
    s_and_b32 s38, s38, 0x7ffff
    s_add_u32 m0, s45, 14336
    s_nop 0
    buffer_load_dwordx4 v215, s[28:31], s44 offen lds
    buffer_load_dwordx4 v216, s[28:31], s44 offen offset:1024 lds
    s_add_u32 s44, s44, 128
    s_and_b32 s44, s44, 2047
    s_waitcnt vmcnt(15)
    s_barrier
    s_waitcnt vmcnt(12)
    v_cmp_eq_u32 vcc, v22, v28
    v_cmp_eq_u32 s[48:49], v23, v29
    s_mov_b32 m0, s35
    s_and_b64 s[48:49], s[48:49], vcc
    s_cmp_eq_u64 s[48:49], -1
    s_cbranch_scc1 L_zspin_go
    s_mov_b32 s51, 0
L_zspin:
    buffer_load_dwordx2 v[22:23], v32, s[76:79], 0 offen sc1
    s_add_u32 s51, s51, 1
    s_waitcnt vmcnt(0)
    v_cmp_eq_u32 vcc, v22, v28
    v_cmp_eq_u32 s[48:49], v23, v29
    s_cmp_gt_u32 s51, 4096
    s_cbranch_scc1 L_zspin_go
    s_and_b64 s[48:49], s[48:49], vcc
    s_cmp_eq_u64 s[48:49], -1
    s_cbranch_scc0 L_zspin
L_zspin_go:
    buffer_load_dwordx4 v33, s[8:11], 0 offen offset:0 sc1 lds
    buffer_load_dwordx4 v34, s[8:11], 0 offen offset:1024 sc1 lds
    buffer_load_dwordx4 v35, s[8:11], 0 offen offset:2048 sc1 lds
    buffer_load_dwordx4 v36, s[8:11], 0 offen offset:3072 sc1 lds
    s_add_u32 m0, s39, 65536
    s_nop 0
    buffer_load_dwordx4 v214, s[80:83], s38 offen sc1 lds
    buffer_load_dwordx4 v214, s[80:83], s38 offen offset:1024 sc1 lds
    buffer_load_dwordx4 v214, s[80:83], s38 offen offset:2048 sc1 lds
    buffer_load_dwordx4 v214, s[80:83], s38 offen offset:3072 sc1 lds
    s_add_u32 s38, s38, 16384
    s_waitcnt vmcnt(16)
    s_barrier
    s_add_u32 m0, s39, 69632
    s_nop 0
    buffer_load_dwordx4 v214, s[80:83], s38 offen sc1 lds
    buffer_load_dwordx4 v214, s[80:83], s38 offen offset:1024 sc1 lds
    buffer_load_dwordx4 v214, s[80:83], s38 offen offset:2048 sc1 lds
    buffer_load_dwordx4 v214, s[80:83], s38 offen offset:3072 sc1 lds
    s_add_u32 s38, s38, 16384
    s_and_b32 s38, s38, 0x7ffff
    s_waitcnt vmcnt(14)
    s_barrier
    s_add_u32 m0, s45, 98304
    s_nop 0
    buffer_load_dwordx4 v214, s[80:83], s38 offen sc1 lds
    buffer_load_dwordx4 v214, s[80:83], s38 offen offset:1024 sc1 lds
    buffer_load_dwordx4 v214, s[80:83], s38 offen offset:2048 sc1 lds
    buffer_load_dwordx4 v214, s[80:83], s38 offen offset:3072 sc1 lds
    s_add_u32 s38, s38, 16384
    s_waitcnt vmcnt(8)
    s_barrier
    s_add_u32 m0, s45, 102400
    s_nop 0
    buffer_load_dwordx4 v214, s[80:83], s38 offen sc1 lds
    buffer_load_dwordx4 v214, s[80:83], s38 offen offset:1024 sc1 lds
    buffer_load_dwordx4 v214, s[80:83], s38 offen offset:2048 sc1 lds
    buffer_load_dwordx4 v214, s[80:83], s38 offen offset:3072 sc1 lds
    s_add_u32 s38, s38, 16384
    s_and_b32 s38, s38, 0x7ffff
    s_waitcnt vmcnt(16)
    ds_read_b128 v[44:47], v37
    ds_read_b128 v[48:51], v38
    ds_read_b128 v[52:55], v39
    ds_read_b128 v[56:59], v40
    s_waitcnt lgkmcnt(3)
    v_lshlrev_b32 v1, 16, v44
    v_lshlrev_b32 v64, 16, v220
    v_mul_f32 v64, v64, v1
    v_and_b32 v1, 0xffff0000, v44
    v_and_b32 v65, 0xffff0000, v220
    v_mul_f32 v65, v65, v1
    v_lshlrev_b32 v1, 16, v45
    v_lshlrev_b32 v66, 16, v221
    v_mul_f32 v66, v66, v1
    v_and_b32 v1, 0xffff0000, v45
    v_and_b32 v67, 0xffff0000, v221
    v_mul_f32 v67, v67, v1
    s_mov_b32 s7, 0
    buffer_store_dwordx4 v[64:67], v41, s[12:15], s7 offen nt
    v_lshlrev_b32 v1, 16, v46
    v_lshlrev_b32 v80, 16, v228
    v_mul_f32 v80, v80, v1
    v_and_b32 v1, 0xffff0000, v46
    v_and_b32 v81, 0xffff0000, v228
    v_mul_f32 v81, v81, v1
    v_lshlrev_b32 v1, 16, v47
    v_lshlrev_b32 v82, 16, v229
    v_mul_f32 v82, v82, v1
    v_and_b32 v1, 0xffff0000, v47
    v_and_b32 v83, 0xffff0000, v229
    v_mul_f32 v83, v83, v1
    s_mov_b32 s7, 131072
    buffer_store_dwordx4 v[80:83], v41, s[12:15], s7 offen nt
    s_waitcnt vmcnt(10)
    s_barrier
    s_waitcnt lgkmcnt(2)
    v_lshlrev_b32 v1, 16, v48
    v_lshlrev_b32 v68, 16, v222
    v_mul_f32 v68, v68, v1
    v_and_b32 v1, 0xffff0000, v48
    v_and_b32 v69, 0xffff0000, v222
    v_mul_f32 v69, v69, v1
    v_lshlrev_b32 v1, 16, v49
    v_lshlrev_b32 v70, 16, v223
    v_mul_f32 v70, v70, v1
    v_and_b32 v1, 0xffff0000, v49
    v_and_b32 v71, 0xffff0000, v223
    v_mul_f32 v71, v71, v1
    s_mov_b32 s7, 32768
    buffer_store_dwordx4 v[68:71], v41, s[12:15], s7 offen nt
    v_lshlrev_b32 v1, 16, v50
    v_lshlrev_b32 v84, 16, v230
    v_mul_f32 v84, v84, v1
    v_and_b32 v1, 0xffff0000, v50
    v_and_b32 v85, 0xffff0000, v230
    v_mul_f32 v85, v85, v1
    v_lshlrev_b32 v1, 16, v51
    v_lshlrev_b32 v86, 16, v231
    v_mul_f32 v86, v86, v1
    v_and_b32 v1, 0xffff0000, v51
    v_and_b32 v87, 0xffff0000, v231
    v_mul_f32 v87, v87, v1
    s_mov_b32 s7, 163840
    buffer_store_dwordx4 v[84:87], v41, s[12:15], s7 offen nt
    s_waitcnt vmcnt(8)
    s_barrier
    s_waitcnt lgkmcnt(1)
    v_lshlrev_b32 v1, 16, v52
    v_lshlrev_b32 v72, 16, v224
    v_mul_f32 v72, v72, v1
    v_and_b32 v1, 0xffff0000, v52
    v_and_b32 v73, 0xffff0000, v224
    v_mul_f32 v73, v73, v1
    v_lshlrev_b32 v1, 16, v53
    v_lshlrev_b32 v74, 16, v225
    v_mul_f32 v74, v74, v1
    v_and_b32 v1, 0xffff0000, v53
    v_and_b32 v75, 0xffff0000, v225
    v_mul_f32 v75, v75, v1
    s_mov_b32 s7, 65536
    buffer_store_dwordx4 v[72:75], v41, s[12:15], s7 offen nt
    v_lshlrev_b32 v1, 16, v54
    v_lshlrev_b32 v88, 16, v232
    v_mul_f32 v88, v88, v1
    v_and_b32 v1, 0xffff0000, v54
    v_and_b32 v89, 0xffff0000, v232
    v_mul_f32 v89, v89, v1
    v_lshlrev_b32 v1, 16, v55
    v_lshlrev_b32 v90, 16, v233
    v_mul_f32 v90, v90, v1
    v_and_b32 v1, 0xffff0000, v55
    v_and_b32 v91, 0xffff0000, v233
    v_mul_f32 v91, v91, v1
    s_mov_b32 s7, 196608
    buffer_store_dwordx4 v[88:91], v41, s[12:15], s7 offen nt
    s_waitcnt vmcnt(6)
    s_barrier
    s_waitcnt lgkmcnt(0)
    v_lshlrev_b32 v1, 16, v56
    v_lshlrev_b32 v76, 16, v226
    v_mul_f32 v76, v76, v1
    v_and_b32 v1, 0xffff0000, v56
    v_and_b32 v77, 0xffff0000, v226
    v_mul_f32 v77, v77, v1
    v_lshlrev_b32 v1, 16, v57
    v_lshlrev_b32 v78, 16, v227
    v_mul_f32 v78, v78, v1
    v_and_b32 v1, 0xffff0000, v57
    v_and_b32 v79, 0xffff0000, v227
    v_mul_f32 v79, v79, v1
    s_mov_b32 s7, 98304
    buffer_store_dwordx4 v[76:79], v41, s[12:15], s7 offen nt
    v_lshlrev_b32 v1, 16, v58
    v_lshlrev_b32 v92, 16, v234
    v_mul_f32 v92, v92, v1
    v_and_b32 v1, 0xffff0000, v58
    v_and_b32 v93, 0xffff0000, v234
    v_mul_f32 v93, v93, v1
    v_lshlrev_b32 v1, 16, v59
    v_lshlrev_b32 v94, 16, v235
    v_mul_f32 v94, v94, v1
    v_and_b32 v1, 0xffff0000, v59
    v_and_b32 v95, 0xffff0000, v235
    v_mul_f32 v95, v95, v1
    s_mov_b32 s7, 229376
    buffer_store_dwordx4 v[92:95], v41, s[12:15], s7 offen nt
    s_endpgm
K_compute:
    v_and_b32 v12, 15, v2
    v_lshrrev_b32 v13, 4, v2
    v_lshrrev_b32 v3, 1, v12
    v_xor_b32 v3, v3, v13
    v_lshlrev_b32 v3, 4, v3
    v_lshl_add_u32 v4, v12, 7, v3
    v_xor_b32 v6, 64, v4
    v_add_u32 v5, 0x10000, v4
    v_add_u32 v7, 0x10000, v6
    s_lshl_b32 s6, s5, 12
    s_add_u32 s6, s6, 16384
    v_add_u32 v8, s6, v4
    v_add_u32 v9, s6, v5
    v_add_u32 v10, s6, v6
    v_add_u32 v11, s6, v7
    s_lshl_b32 s6, s4, 2
    s_add_u32 s6, s6, s5
    s_lshl_b32 s6, s6, 4
    v_add_u32 v14, s6, v12
    v_lshlrev_b32 v44, 1, v14
    s_lshl_b32 s6, s4, 7
    v_lshlrev_b32 v1, 3, v12
    v_add_u32 v1, s6, v1
    s_waitcnt lgkmcnt(0)
    s_mov_b32 s20, s58
    s_mov_b32 s21, s59
    s_mov_b32 s22, 2048
    s_mov_b32 s23, 0x00020000
    s_mov_b32 s24, s46
    s_mov_b32 s25, s47
    s_mov_b32 s26, 2048
    s_mov_b32 s27, 0x00020000
    s_mov_b32 s28, s48
    s_mov_b32 s29, s49
    s_mov_b32 s30, 2048
    s_mov_b32 s31, 0x00020000
    s_mov_b32 s80, s60
    s_mov_b32 s81, s61
    s_mov_b32 s82, 2048
    s_mov_b32 s83, 0x00020000
    buffer_load_ushort v45, v44, s[20:23], 0 offen
    buffer_load_ushort v46, v44, s[24:27], 0 offen
    buffer_load_ushort v47, v44, s[28:31], 0 offen
    buffer_load_dwordx2 v[244:245], v1, s[80:83], 0 offen
    s_mov_b32 s16, s64
    s_mov_b32 s17, s65
    s_mov_b32 s18, 256
    s_mov_b32 s19, 0x00020000
    s_or_b32 s6, s2, s5
    s_cmp_eq_u32 s6, 0
    s_cbranch_scc0 C_nonce_w
    s_memrealtime s[6:7]
    v_mov_b32 v1, 0
    s_waitcnt lgkmcnt(0)
    s_or_b32 s6, s6, 1
    v_mov_b32 v48, s6
    v_mov_b32 v49, s7
    s_mov_b64 exec, 1
    buffer_store_dwordx2 v[48:49], v1, s[16:19], 0 offen sc1
    s_mov_b64 exec, -1
C_nonce_w:
    s_add_u32 s8, s66, 8388608
    s_addc_u32 s9, s67, 0
    s_mov_b32 s10, 8388608
    s_mov_b32 s11, 0x00020000
    s_add_u32 s12, s66, 16777216
    s_addc_u32 s13, s67, 0
    s_mov_b32 s14, 262144
    s_mov_b32 s15, 0x00020000
    s_mov_b32 s68, s66
    s_mov_b32 s69, s67
    s_mov_b32 s70, 4194304
    s_mov_b32 s71, 0x00020000
    s_add_u32 s72, s66, 17825792
    s_addc_u32 s73, s67, 0
    s_mov_b32 s74, 393216
    s_mov_b32 s75, 0x00020000
    s_mov_b32 s76, s62
    s_mov_b32 s77, s63
    s_mov_b32 s78, 16777216
    s_mov_b32 s79, 0x00020000
    s_add_u32 s80, s66, 4194304
    s_addc_u32 s81, s67, 0
    s_mov_b32 s82, 4194304
    s_mov_b32 s83, 0x00020000
    s_and_b32 s34, s2, 3
    s_lshl_b32 s34, s34, 2
    s_and_b32 s35, s2, 4
    s_lshl_b32 s35, s35, 1
    s_add_u32 s34, s34, s35
    s_add_u32 s35, s3, s4
    s_and_b32 s35, s35, 1
    s_lshl_b32 s35, s35, 1
    s_add_u32 s34, s34, s35
    s_and_b32 s34, s34, 15
    s_sub_u32 s34, s4, s34
    s_and_b32 s34, s34, 15
    s_add_u32 s35, s34, 3
    s_and_b32 s35, s35, 3
    s_lshl_b32 s35, s35, 15
    s_lshl_b32 s6, s5, 9
    s_add_u32 s35, s35, s6
    v_lshrrev_b32 v1, 2, v12
    v_lshlrev_b32 v1, 11, v1
    v_and_b32 v3, 3, v12
    v_lshl_add_u32 v1, v3, 7, v1
    v_lshrrev_b32 v3, 1, v3
    s_lshl_b32 s6, s5, 1
    v_add_u32 v3, s6, v3
    v_xor_b32 v3, v3, v13
    v_lshl_add_u32 v1, v3, 4, v1
    v_add_u32 v58, s35, v1
    v_xor_b32 v59, 64, v58
    v_mov_b32 v60, 147392
    s_lshr_b32 s7, s2, 3
    s_and_b32 s32, s7, 15
    s_lshr_b32 s7, s7, 4
    s_and_b32 s33, s2, 7
    s_lshl_b32 s33, s33, 1
    s_add_u32 s33, s33, s7
    s_mov_b32 s36, 16384
    s_mov_b32 s37, 32768
    s_mov_b32 s38, 49152
    s_lshl_b32 s6, s5, 2
    v_xor_b32 v1, s6, v12
    v_lshlrev_b32 v1, 4, v1
    v_lshl_add_u32 v1, v13, 8, v1
    s_lshl_b32 s6, s5, 12
    s_add_u32 s6, s6, 147456
    v_add_u32 v37, s6, v1
    v_xor_b32 v38, 16, v37
    v_xor_b32 v39, 32, v37
    v_xor_b32 v40, 48, v37
    s_lshl_b32 s6, s33, 2
    s_add_u32 s6, s6, s5
    s_lshl_b32 s6, s6, 16
    s_lshl_b32 s7, s32, 8
    s_sub_u32 s7, 3840, s7
    s_add_u32 s6, s6, s7
    v_lshlrev_b32 v1, 12, v13
    v_lshl_add_u32 v1, v12, 4, v1
    v_add_u32 v41, s6, v1
    s_lshl_b32 s6, s3, 14
    v_lshlrev_b32 v1, 4, v14
    v_add_u32 v34, s6, v1
    v_lshlrev_b32 v1, 14, v13
    v_sub_u32 v1, v34, v1
    v_subrev_u32 v30, 0x4000, v1
    v_subrev_u32 v31, 0x14000, v1
    v_subrev_u32 v32, 0x24000, v1
    v_subrev_u32 v33, 0x34000, v1
    v_cmp_gt_i32 s[40:41], 0, v30
    v_cmp_gt_i32 s[42:43], 0, v31
    v_cmp_gt_i32 s[44:45], 0, v32
    v_cmp_gt_i32 s[46:47], 0, v33
    s_lshl_b32 s6, s3, 4
    s_add_u32 s6, s6, s4
    s_lshl_b32 s6, s6, 15
    s_lshl_b32 s7, s5, 8
    s_add_u32 s6, s6, s7
    v_lshlrev_b32 v1, 12, v13
    v_lshl_add_u32 v1, v12, 4, v1
    v_add_u32 v35, s6, v1
    v_xor_b32 v36, 64, v35
    s_add_u32 s7, s7, 65536
    v_lshlrev_b32 v1, 13, v13
    v_lshl_add_u32 v1, v12, 4, v1
    v_add_u32 v61, s7, v1
    s_lshl_b32 s7, s5, 2
    v_add_u32 v63, s7, v60
    v_xor_b32 v62, 64, v61
    v_cmp_eq_u32 s[48:49], 1, v13
    v_cmp_eq_u32 s[50:51], 2, v13
    v_cmp_eq_u32 s[52:53], 3, v13
    v_mov_b32 v64, 0
    v_mov_b32 v65, 0
    v_mov_b32 v66, 0
    v_mov_b32 v67, 0
    v_mov_b32 v68, 0
    v_mov_b32 v69, 0
    v_mov_b32 v70, 0
    v_mov_b32 v71, 0
    v_mov_b32 v72, 0
    v_mov_b32 v73, 0
    v_mov_b32 v74, 0
    v_mov_b32 v75, 0
    v_mov_b32 v76, 0
    v_mov_b32 v77, 0
    v_mov_b32 v78, 0
    v_mov_b32 v79, 0
    v_mov_b32 v80, 0
    v_mov_b32 v81, 0
    v_mov_b32 v82, 0
    v_mov_b32 v83, 0
    v_mov_b32 v84, 0
    v_mov_b32 v85, 0
    v_mov_b32 v86, 0
    v_mov_b32 v87, 0
    v_mov_b32 v88, 0
    v_mov_b32 v89, 0
    v_mov_b32 v90, 0
    v_mov_b32 v91, 0
    v_mov_b32 v92, 0
    v_mov_b32 v93, 0
    v_mov_b32 v94, 0
    v_mov_b32 v95, 0
    v_mov_b32 v96, 0
    v_mov_b32 v97, 0
    v_mov_b32 v98, 0
    v_mov_b32 v99, 0
    v_mov_b32 v100, 0
    v_mov_b32 v101, 0
    v_mov_b32 v102, 0
    v_mov_b32 v103, 0
    v_mov_b32 v104, 0
    v_mov_b32 v105, 0
    v_mov_b32 v106, 0
    v_mov_b32 v107, 0
    v_mov_b32 v108, 0
    v_mov_b32 v109, 0
    v_mov_b32 v110, 0
    v_mov_b32 v111, 0
    v_mov_b32 v112, 0
    v_mov_b32 v113, 0
    v_mov_b32 v114, 0
    v_mov_b32 v115, 0
    v_mov_b32 v116, 0
    v_mov_b32 v117, 0
    v_mov_b32 v118, 0
    v_mov_b32 v119, 0
    v_mov_b32 v120, 0
    v_mov_b32 v121, 0
    v_mov_b32 v122, 0
    v_mov_b32 v123, 0
    v_mov_b32 v124, 0
    v_mov_b32 v125, 0
    v_mov_b32 v126, 0
    v_mov_b32 v127, 0
    s_waitcnt vmcnt(0)
    v_lshlrev_b32 v45, 16, v45
    v_lshlrev_b32 v46, 16, v46
    v_lshlrev_b32 v47, 16, v47
    v_mul_f32 v45, 0x3fb8aa3b, v45
    v_exp_f32 v45, v45
    s_nop 0
    v_cvt_pk_bf16_f32 v45, v45, v45
    v_lshlrev_b32 v45, 16, v45
    v_mul_f32 v48, v45, v46
    v_mul_f32 v49, v45, v47
    v_mul_f32 v48, 0x3fb8aa3b, v48
    v_exp_f32 v48, v48
    v_mul_f32 v49, 0.15915494, v49
    v_cos_f32 v50, v49
    v_sin_f32 v51, v49
    s_nop 0
    v_mul_f32 v16, v48, v50
    v_mul_f32 v17, v48, v51
    v_add_f32 v48, -1.0, v16
    v_mul_f32 v49, v46, v46
    v_fmac_f32 v49, v47, v47
    v_rcp_f32 v49, v49
    v_mul_f32 v50, v48, v46
    v_fmac_f32 v50, v17, v47
    v_mul_f32 v51, v17, v46
    v_fma_f32 v51, -v48, v47, v51
    v_add_f32 v49, v49, v49
    v_mul_f32 v20, v50, v49
    v_mul_f32 v21, v51, v49
    v_xor_b32 v18, 0x80000000, v17
    v_xor_b32 v42, 0x80000000, v20
    v_xor_b32 v43, 0x80000000, v21
    v_mul_f32 v44, v16, v16
    v_mul_f32 v45, v16, v17
    v_fma_f32 v44, -v17, v17, v44
    v_fmac_f32 v45, v17, v16
    v_mul_f32 v46, v44, v44
    v_mul_f32 v47, v44, v45
    v_fma_f32 v46, -v45, v45, v46
    v_fmac_f32 v47, v45, v44
    v_mul_f32 v44, v46, v46
    v_mul_f32 v45, v46, v47
    v_fma_f32 v44, -v47, v47, v44
    v_fmac_f32 v45, v47, v46
    v_mul_f32 v46, v44, v44
    v_mul_f32 v47, v44, v45
    v_fma_f32 v46, -v45, v45, v46
    v_fmac_f32 v47, v45, v44
    v_mul_f32 v22, v46, v46
    v_mul_f32 v23, v46, v47
    v_fma_f32 v22, -v47, v47, v22
    v_fmac_f32 v23, v47, v46
    v_mul_f32 v44, v22, v22
    v_mul_f32 v45, v22, v23
    v_fma_f32 v44, -v23, v23, v44
    v_fmac_f32 v45, v23, v22
    v_mul_f32 v46, v44, v22
    v_mul_f32 v47, v44, v23
    v_fma_f32 v46, -v45, v23, v46
    v_fmac_f32 v47, v45, v22
    v_mov_b32 v48, 1.0
    v_mov_b32 v49, 0
    v_cndmask_b32 v48, v48, v22, s[48:49]
    v_cndmask_b32 v49, v49, v23, s[48:49]
    v_cndmask_b32 v48, v48, v44, s[50:51]
    v_cndmask_b32 v49, v49, v45, s[50:51]
    v_cndmask_b32 v48, v48, v46, s[52:53]
    v_cndmask_b32 v49, v49, v47, s[52:53]
    v_mul_f32 v24, v20, v48
    v_mul_f32 v25, v20, v49
    v_fma_f32 v24, -v21, v49, v24
    v_fmac_f32 v25, v21, v48
    v_mul_f32 v46, v44, v44
    v_mul_f32 v47, v44, v45
    v_fma_f32 v46, -v45, v45, v46
    v_fmac_f32 v47, v45, v44
    v_mul_f32 v44, v46, v46
    v_mul_f32 v45, v46, v47
    v_fma_f32 v44, -v47, v47, v44
    v_fmac_f32 v45, v47, v46
    v_mul_f32 v48, v44, v46
    v_mul_f32 v49, v44, v47
    v_fma_f32 v48, -v45, v47, v48
    v_fmac_f32 v49, v45, v46
    v_mul_f32 v28, v44, v44
    v_mul_f32 v29, v44, v45
    v_fma_f32 v28, -v45, v45, v28
    v_fmac_f32 v29, v45, v44
    v_mov_b32 v26, 1.0
    v_mov_b32 v27, 0
    v_cndmask_b32 v26, v26, v46, s[48:49]
    v_cndmask_b32 v27, v27, v47, s[48:49]
    v_cndmask_b32 v26, v26, v44, s[50:51]
    v_cndmask_b32 v27, v27, v45, s[50:51]
    v_cndmask_b32 v26, v26, v48, s[52:53]
    v_cndmask_b32 v27, v27, v49, s[52:53]
    s_barrier
    ds_read_b128 v[160:163], v9 offset:32768
    ds_read_b128 v[164:167], v9 offset:34816
    ds_read_b128 v[128:131], v5 offset:32768
    ds_read_b128 v[132:135], v5 offset:34816
    ds_read_b128 v[136:139], v5 offset:36864
    ds_read_b128 v[140:143], v5 offset:38912
    ds_read_b128 v[144:147], v5 offset:40960
    ds_read_b128 v[148:151], v5 offset:43008
    ds_read_b128 v[152:155], v5 offset:45056
    ds_read_b128 v[156:159], v5 offset:47104
    s_setprio 3
    s_mov_b32 s30, 0
C_loop:
    s_cmp_eq_u32 s34, 0
    s_waitcnt lgkmcnt(0)
    s_cbranch_scc0 C_x0
    ds_read_b128 v[228:231], v58 offset:0
    ds_read_b128 v[232:235], v59 offset:0
    ds_read_b128 v[236:239], v58 offset:8192
    ds_read_b128 v[240:243], v59 offset:8192
C_x0:
    v_mfma_f32_16x16x32_bf16 v[64:67], v[128:131], v[160:163], v[64:67]
    ds_read_b128 v[200:203], v11 offset:32768
    v_mfma_f32_16x16x32_bf16 v[68:71], v[128:131], v[164:167], v[68:71]
    ds_read_b128 v[204:207], v11 offset:34816
    v_mfma_f32_16x16x32_bf16 v[76:79], v[132:135], v[164:167], v[76:79]
    ds_read_b128 v[168:171], v7 offset:32768
    v_mfma_f32_16x16x32_bf16 v[72:75], v[132:135], v[160:163], v[72:75]
    ds_read_b128 v[172:175], v7 offset:34816
    v_mfma_f32_16x16x32_bf16 v[80:83], v[136:139], v[160:163], v[80:83]
    ds_read_b128 v[176:179], v7 offset:36864
    v_mfma_f32_16x16x32_bf16 v[84:87], v[136:139], v[164:167], v[84:87]
    ds_read_b128 v[180:183], v7 offset:38912
    v_mfma_f32_16x16x32_bf16 v[92:95], v[140:143], v[164:167], v[92:95]
    ds_read_b128 v[184:187], v7 offset:40960
    v_mfma_f32_16x16x32_bf16 v[88:91], v[140:143], v[160:163], v[88:91]
    ds_read_b128 v[188:191], v7 offset:43008
    v_mfma_f32_16x16x32_bf16 v[96:99], v[144:147], v[160:163], v[96:99]
    ds_read_b128 v[192:195], v7 offset:45056
    v_mfma_f32_16x16x32_bf16 v[100:103], v[144:147], v[164:167], v[100:103]
    ds_read_b128 v[196:199], v7 offset:47104
    v_mfma_f32_16x16x32_bf16 v[108:111], v[148:151], v[164:167], v[108:111]
    v_mfma_f32_16x16x32_bf16 v[104:107], v[148:151], v[160:163], v[104:107]
    v_mfma_f32_16x16x32_bf16 v[112:115], v[152:155], v[160:163], v[112:115]
    v_mfma_f32_16x16x32_bf16 v[116:119], v[152:155], v[164:167], v[116:119]
    v_mfma_f32_16x16x32_bf16 v[124:127], v[156:159], v[164:167], v[124:127]
    v_mfma_f32_16x16x32_bf16 v[120:123], v[156:159], v[160:163], v[120:123]
    s_waitcnt lgkmcnt(0)
    s_barrier
    s_cmp_eq_u32 s30, 0
    s_cbranch_scc0 C_s0
    ds_read_b128 v[208:211], v37 offset:0
    ds_read_b128 v[212:215], v38 offset:1024
    ds_read_b128 v[216:219], v39 offset:2048
    ds_read_b128 v[220:223], v40 offset:3072
C_s0:
    v_mfma_f32_16x16x32_bf16 v[64:67], v[168:171], v[200:203], v[64:67]
    ds_read_b128 v[160:163], v8 offset:0
    v_mfma_f32_16x16x32_bf16 v[68:71], v[168:171], v[204:207], v[68:71]
    ds_read_b128 v[164:167], v8 offset:2048
    v_mfma_f32_16x16x32_bf16 v[76:79], v[172:175], v[204:207], v[76:79]
    ds_read_b128 v[128:131], v4 offset:0
    v_mfma_f32_16x16x32_bf16 v[72:75], v[172:175], v[200:203], v[72:75]
    ds_read_b128 v[132:135], v4 offset:2048
    v_mfma_f32_16x16x32_bf16 v[80:83], v[176:179], v[200:203], v[80:83]
    ds_read_b128 v[136:139], v4 offset:4096
    v_mfma_f32_16x16x32_bf16 v[84:87], v[176:179], v[204:207], v[84:87]
    ds_read_b128 v[140:143], v4 offset:6144
    v_mfma_f32_16x16x32_bf16 v[92:95], v[180:183], v[204:207], v[92:95]
    ds_read_b128 v[144:147], v4 offset:8192
    v_mfma_f32_16x16x32_bf16 v[88:91], v[180:183], v[200:203], v[88:91]
    ds_read_b128 v[148:151], v4 offset:10240
    v_mfma_f32_16x16x32_bf16 v[96:99], v[184:187], v[200:203], v[96:99]
    ds_read_b128 v[152:155], v4 offset:12288
    v_mfma_f32_16x16x32_bf16 v[100:103], v[184:187], v[204:207], v[100:103]
    ds_read_b128 v[156:159], v4 offset:14336
    v_mfma_f32_16x16x32_bf16 v[108:111], v[188:191], v[204:207], v[108:111]
    v_mfma_f32_16x16x32_bf16 v[104:107], v[188:191], v[200:203], v[104:107]
    v_mfma_f32_16x16x32_bf16 v[112:115], v[192:195], v[200:203], v[112:115]
    v_mfma_f32_16x16x32_bf16 v[116:119], v[192:195], v[204:207], v[116:119]
    v_mfma_f32_16x16x32_bf16 v[124:127], v[196:199], v[204:207], v[124:127]
    v_mfma_f32_16x16x32_bf16 v[120:123], v[196:199], v[200:203], v[120:123]
    s_cmp_eq_u32 s34, 1
    s_waitcnt lgkmcnt(0)
    s_cbranch_scc0 C_x1
    ds_read_b128 v[228:231], v58 offset:0
    ds_read_b128 v[232:235], v59 offset:0
    ds_read_b128 v[236:239], v58 offset:8192
    ds_read_b128 v[240:243], v59 offset:8192
C_x1:
    s_cmp_eq_u32 s30, 0
    s_cbranch_scc0 C_s1
    buffer_store_dwordx4 v[208:211], v41, s[68:71], 0 offen sc1
    buffer_store_dwordx4 v[212:215], v41, s[68:71], s36 offen sc1
    buffer_store_dwordx4 v[216:219], v41, s[68:71], s37 offen sc1
    buffer_store_dwordx4 v[220:223], v41, s[68:71], s38 offen sc1
C_s1:
    v_mfma_f32_16x16x32_bf16 v[64:67], v[128:131], v[160:163], v[64:67]
    ds_read_b128 v[200:203], v10 offset:0
    v_mfma_f32_16x16x32_bf16 v[68:71], v[128:131], v[164:167], v[68:71]
    ds_read_b128 v[204:207], v10 offset:2048
    v_mfma_f32_16x16x32_bf16 v[76:79], v[132:135], v[164:167], v[76:79]
    ds_read_b128 v[168:171], v6 offset:0
    v_mfma_f32_16x16x32_bf16 v[72:75], v[132:135], v[160:163], v[72:75]
    ds_read_b128 v[172:175], v6 offset:2048
    v_mfma_f32_16x16x32_bf16 v[80:83], v[136:139], v[160:163], v[80:83]
    ds_read_b128 v[176:179], v6 offset:4096
    v_mfma_f32_16x16x32_bf16 v[84:87], v[136:139], v[164:167], v[84:87]
    ds_read_b128 v[180:183], v6 offset:6144
    v_mfma_f32_16x16x32_bf16 v[92:95], v[140:143], v[164:167], v[92:95]
    ds_read_b128 v[184:187], v6 offset:8192
    v_mfma_f32_16x16x32_bf16 v[88:91], v[140:143], v[160:163], v[88:91]
    ds_read_b128 v[188:191], v6 offset:10240
    v_mfma_f32_16x16x32_bf16 v[96:99], v[144:147], v[160:163], v[96:99]
    ds_read_b128 v[192:195], v6 offset:12288
    v_mfma_f32_16x16x32_bf16 v[100:103], v[144:147], v[164:167], v[100:103]
    ds_read_b128 v[196:199], v6 offset:14336
    v_mfma_f32_16x16x32_bf16 v[108:111], v[148:151], v[164:167], v[108:111]
    ds_read_b64 v[54:55], v60
    v_mfma_f32_16x16x32_bf16 v[104:107], v[148:151], v[160:163], v[104:107]
    v_mfma_f32_16x16x32_bf16 v[112:115], v[152:155], v[160:163], v[112:115]
    v_mfma_f32_16x16x32_bf16 v[116:119], v[152:155], v[164:167], v[116:119]
    v_mfma_f32_16x16x32_bf16 v[124:127], v[156:159], v[164:167], v[124:127]
    v_mfma_f32_16x16x32_bf16 v[120:123], v[156:159], v[160:163], v[120:123]
    s_cmp_eq_u32 s30, 1
    s_cbranch_scc0 C_s2
    s_waitcnt vmcnt(0)
C_s2:
    s_waitcnt lgkmcnt(0)
    s_barrier
    v_mfma_f32_16x16x32_bf16 v[64:67], v[168:171], v[200:203], v[64:67]
    ds_read_b128 v[160:163], v8 offset:32768
    v_mfma_f32_16x16x32_bf16 v[68:71], v[168:171], v[204:207], v[68:71]
    ds_read_b128 v[164:167], v8 offset:34816
    v_mfma_f32_16x16x32_bf16 v[76:79], v[172:175], v[204:207], v[76:79]
    ds_read_b128 v[128:131], v4 offset:32768
    v_mfma_f32_16x16x32_bf16 v[72:75], v[172:175], v[200:203], v[72:75]
    ds_read_b128 v[132:135], v4 offset:34816
    v_mfma_f32_16x16x32_bf16 v[80:83], v[176:179], v[200:203], v[80:83]
    ds_read_b128 v[136:139], v4 offset:36864
    v_mfma_f32_16x16x32_bf16 v[84:87], v[176:179], v[204:207], v[84:87]
    ds_read_b128 v[140:143], v4 offset:38912
    v_mfma_f32_16x16x32_bf16 v[92:95], v[180:183], v[204:207], v[92:95]
    ds_read_b128 v[144:147], v4 offset:40960
    v_mfma_f32_16x16x32_bf16 v[88:91], v[180:183], v[200:203], v[88:91]
    ds_read_b128 v[148:151], v4 offset:43008
    v_mfma_f32_16x16x32_bf16 v[96:99], v[184:187], v[200:203], v[96:99]
    ds_read_b128 v[152:155], v4 offset:45056
    v_mfma_f32_16x16x32_bf16 v[100:103], v[184:187], v[204:207], v[100:103]
    ds_read_b128 v[156:159], v4 offset:47104
    v_mfma_f32_16x16x32_bf16 v[108:111], v[188:191], v[204:207], v[108:111]
    v_mfma_f32_16x16x32_bf16 v[104:107], v[188:191], v[200:203], v[104:107]
    v_mfma_f32_16x16x32_bf16 v[112:115], v[192:195], v[200:203], v[112:115]
    v_mfma_f32_16x16x32_bf16 v[116:119], v[192:195], v[204:207], v[116:119]
    v_mfma_f32_16x16x32_bf16 v[124:127], v[196:199], v[204:207], v[124:127]
    v_mfma_f32_16x16x32_bf16 v[120:123], v[196:199], v[200:203], v[120:123]
    s_cmp_eq_u32 s34, 2
    s_waitcnt lgkmcnt(0)
    s_cbranch_scc0 C_x2
    ds_read_b128 v[228:231], v58 offset:0
    ds_read_b128 v[232:235], v59 offset:0
    ds_read_b128 v[236:239], v58 offset:8192
    ds_read_b128 v[240:243], v59 offset:8192
C_x2:
    v_mfma_f32_16x16x32_bf16 v[64:67], v[128:131], v[160:163], v[64:67]
    ds_read_b128 v[200:203], v10 offset:32768
    v_mfma_f32_16x16x32_bf16 v[68:71], v[128:131], v[164:167], v[68:71]
    ds_read_b128 v[204:207], v10 offset:34816
    v_mfma_f32_16x16x32_bf16 v[76:79], v[132:135], v[164:167], v[76:79]
    ds_read_b128 v[168:171], v6 offset:32768
    v_mfma_f32_16x16x32_bf16 v[72:75], v[132:135], v[160:163], v[72:75]
    ds_read_b128 v[172:175], v6 offset:34816
    v_mfma_f32_16x16x32_bf16 v[80:83], v[136:139], v[160:163], v[80:83]
    ds_read_b128 v[176:179], v6 offset:36864
    v_mfma_f32_16x16x32_bf16 v[84:87], v[136:139], v[164:167], v[84:87]
    ds_read_b128 v[180:183], v6 offset:38912
    v_mfma_f32_16x16x32_bf16 v[92:95], v[140:143], v[164:167], v[92:95]
    ds_read_b128 v[184:187], v6 offset:40960
    v_mfma_f32_16x16x32_bf16 v[88:91], v[140:143], v[160:163], v[88:91]
    ds_read_b128 v[188:191], v6 offset:43008
    v_mfma_f32_16x16x32_bf16 v[96:99], v[144:147], v[160:163], v[96:99]
    ds_read_b128 v[192:195], v6 offset:45056
    v_mfma_f32_16x16x32_bf16 v[100:103], v[144:147], v[164:167], v[100:103]
    ds_read_b128 v[196:199], v6 offset:47104
    v_mfma_f32_16x16x32_bf16 v[108:111], v[148:151], v[164:167], v[108:111]
    v_mfma_f32_16x16x32_bf16 v[104:107], v[148:151], v[160:163], v[104:107]
    v_mfma_f32_16x16x32_bf16 v[112:115], v[152:155], v[160:163], v[112:115]
    v_mfma_f32_16x16x32_bf16 v[116:119], v[152:155], v[164:167], v[116:119]
    v_mfma_f32_16x16x32_bf16 v[124:127], v[156:159], v[164:167], v[124:127]
    v_mfma_f32_16x16x32_bf16 v[120:123], v[156:159], v[160:163], v[120:123]
    s_waitcnt lgkmcnt(0)
    s_barrier
    v_mfma_f32_16x16x32_bf16 v[64:67], v[168:171], v[200:203], v[64:67]
    ds_read_b128 v[160:163], v9 offset:0
    v_mfma_f32_16x16x32_bf16 v[68:71], v[168:171], v[204:207], v[68:71]
    ds_read_b128 v[164:167], v9 offset:2048
    v_mfma_f32_16x16x32_bf16 v[76:79], v[172:175], v[204:207], v[76:79]
    ds_read_b128 v[128:131], v5 offset:0
    v_mfma_f32_16x16x32_bf16 v[72:75], v[172:175], v[200:203], v[72:75]
    ds_read_b128 v[132:135], v5 offset:2048
    v_mfma_f32_16x16x32_bf16 v[80:83], v[176:179], v[200:203], v[80:83]
    ds_read_b128 v[136:139], v5 offset:4096
    v_mfma_f32_16x16x32_bf16 v[84:87], v[176:179], v[204:207], v[84:87]
    ds_read_b128 v[140:143], v5 offset:6144
    v_mfma_f32_16x16x32_bf16 v[92:95], v[180:183], v[204:207], v[92:95]
    ds_read_b128 v[144:147], v5 offset:8192
    v_mfma_f32_16x16x32_bf16 v[88:91], v[180:183], v[200:203], v[88:91]
    ds_read_b128 v[148:151], v5 offset:10240
    v_mfma_f32_16x16x32_bf16 v[96:99], v[184:187], v[200:203], v[96:99]
    ds_read_b128 v[152:155], v5 offset:12288
    v_mfma_f32_16x16x32_bf16 v[100:103], v[184:187], v[204:207], v[100:103]
    ds_read_b128 v[156:159], v5 offset:14336
    v_mfma_f32_16x16x32_bf16 v[108:111], v[188:191], v[204:207], v[108:111]
    v_mfma_f32_16x16x32_bf16 v[104:107], v[188:191], v[200:203], v[104:107]
    v_mfma_f32_16x16x32_bf16 v[112:115], v[192:195], v[200:203], v[112:115]
    v_mfma_f32_16x16x32_bf16 v[116:119], v[192:195], v[204:207], v[116:119]
    v_mfma_f32_16x16x32_bf16 v[124:127], v[196:199], v[204:207], v[124:127]
    v_mfma_f32_16x16x32_bf16 v[120:123], v[196:199], v[200:203], v[120:123]
    s_cmp_eq_u32 s34, 3
    s_waitcnt lgkmcnt(0)
    s_cbranch_scc0 C_x3
    ds_read_b128 v[228:231], v58 offset:0
    ds_read_b128 v[232:235], v59 offset:0
    ds_read_b128 v[236:239], v58 offset:8192
    ds_read_b128 v[240:243], v59 offset:8192
C_x3:
    v_mfma_f32_16x16x32_bf16 v[64:67], v[128:131], v[160:163], v[64:67]
    ds_read_b128 v[200:203], v11 offset:0
    v_mfma_f32_16x16x32_bf16 v[68:71], v[128:131], v[164:167], v[68:71]
    ds_read_b128 v[204:207], v11 offset:2048
    v_mfma_f32_16x16x32_bf16 v[76:79], v[132:135], v[164:167], v[76:79]
    ds_read_b128 v[168:171], v7 offset:0
    v_mfma_f32_16x16x32_bf16 v[72:75], v[132:135], v[160:163], v[72:75]
    ds_read_b128 v[172:175], v7 offset:2048
    v_mfma_f32_16x16x32_bf16 v[80:83], v[136:139], v[160:163], v[80:83]
    ds_read_b128 v[176:179], v7 offset:4096
    v_mfma_f32_16x16x32_bf16 v[84:87], v[136:139], v[164:167], v[84:87]
    ds_read_b128 v[180:183], v7 offset:6144
    v_mfma_f32_16x16x32_bf16 v[92:95], v[140:143], v[164:167], v[92:95]
    ds_read_b128 v[184:187], v7 offset:8192
    v_mfma_f32_16x16x32_bf16 v[88:91], v[140:143], v[160:163], v[88:91]
    ds_read_b128 v[188:191], v7 offset:10240
    v_mfma_f32_16x16x32_bf16 v[96:99], v[144:147], v[160:163], v[96:99]
    ds_read_b128 v[192:195], v7 offset:12288
    v_mfma_f32_16x16x32_bf16 v[100:103], v[144:147], v[164:167], v[100:103]
    ds_read_b128 v[196:199], v7 offset:14336
    v_mfma_f32_16x16x32_bf16 v[108:111], v[148:151], v[164:167], v[108:111]
    v_mfma_f32_16x16x32_bf16 v[104:107], v[148:151], v[160:163], v[104:107]
    v_mfma_f32_16x16x32_bf16 v[112:115], v[152:155], v[160:163], v[112:115]
    v_mfma_f32_16x16x32_bf16 v[116:119], v[152:155], v[164:167], v[116:119]
    v_mfma_f32_16x16x32_bf16 v[124:127], v[156:159], v[164:167], v[124:127]
    v_mfma_f32_16x16x32_bf16 v[120:123], v[156:159], v[160:163], v[120:123]
    s_cmp_eq_u32 s30, 3
    s_waitcnt lgkmcnt(0)
    s_cbranch_scc1 C_nobar
    s_barrier
C_nobar:
    v_mfma_f32_16x16x32_bf16 v[64:67], v[168:171], v[200:203], v[64:67]
    ds_read_b128 v[160:163], v9 offset:32768
    v_mfma_f32_16x16x32_bf16 v[68:71], v[168:171], v[204:207], v[68:71]
    ds_read_b128 v[164:167], v9 offset:34816
    v_mfma_f32_16x16x32_bf16 v[76:79], v[172:175], v[204:207], v[76:79]
    ds_read_b128 v[128:131], v5 offset:32768
    v_mfma_f32_16x16x32_bf16 v[72:75], v[172:175], v[200:203], v[72:75]
    ds_read_b128 v[132:135], v5 offset:34816
    v_mfma_f32_16x16x32_bf16 v[80:83], v[176:179], v[200:203], v[80:83]
    ds_read_b128 v[136:139], v5 offset:36864
    v_mfma_f32_16x16x32_bf16 v[84:87], v[176:179], v[204:207], v[84:87]
    ds_read_b128 v[140:143], v5 offset:38912
    v_mfma_f32_16x16x32_bf16 v[92:95], v[180:183], v[204:207], v[92:95]
    ds_read_b128 v[144:147], v5 offset:40960
    v_mfma_f32_16x16x32_bf16 v[88:91], v[180:183], v[200:203], v[88:91]
    ds_read_b128 v[148:151], v5 offset:43008
    v_mfma_f32_16x16x32_bf16 v[96:99], v[184:187], v[200:203], v[96:99]
    ds_read_b128 v[152:155], v5 offset:45056
    v_mfma_f32_16x16x32_bf16 v[100:103], v[184:187], v[204:207], v[100:103]
    ds_read_b128 v[156:159], v5 offset:47104
    v_mfma_f32_16x16x32_bf16 v[108:111], v[188:191], v[204:207], v[108:111]
    v_mfma_f32_16x16x32_bf16 v[104:107], v[188:191], v[200:203], v[104:107]
    v_mfma_f32_16x16x32_bf16 v[112:115], v[192:195], v[200:203], v[112:115]
    v_mfma_f32_16x16x32_bf16 v[116:119], v[192:195], v[204:207], v[116:119]
    v_mfma_f32_16x16x32_bf16 v[124:127], v[196:199], v[204:207], v[124:127]
    v_mfma_f32_16x16x32_bf16 v[120:123], v[196:199], v[200:203], v[120:123]
    s_add_u32 s30, s30, 1
    s_sub_u32 s34, s34, 4
    s_cmp_lt_u32 s30, 4
    s_cbranch_scc1 C_loop
    ds_write_b32 v63, v54 offset:16
    v_fma_f32 v46, v16, v64, v65
    v_fma_f32 v47, v16, v68, v69
    v_fmac_f32 v46, v18, v68
    v_fmac_f32 v47, v17, v64
    v_fma_f32 v44, v16, v46, v66
    v_fma_f32 v45, v16, v47, v70
    v_fmac_f32 v44, v18, v47
    v_fmac_f32 v45, v17, v46
    v_fma_f32 v46, v16, v44, v67
    v_fma_f32 v47, v16, v45, v71
    v_fmac_f32 v46, v18, v45
    v_fmac_f32 v47, v17, v44
    v_fma_f32 v44, v16, v46, v72
    v_fma_f32 v45, v16, v47, v76
    v_fmac_f32 v44, v18, v47
    v_fmac_f32 v45, v17, v46
    v_fma_f32 v46, v16, v44, v73
    v_fma_f32 v47, v16, v45, v77
    v_fmac_f32 v46, v18, v45
    v_fmac_f32 v47, v17, v44
    v_fma_f32 v44, v16, v46, v74
    v_fma_f32 v45, v16, v47, v78
    v_fmac_f32 v44, v18, v47
    v_fmac_f32 v45, v17, v46
    s_waitcnt lgkmcnt(0)
    v_fma_f32 v46, v16, v44, v75
    v_fma_f32 v47, v16, v45, v79
    v_fmac_f32 v46, v18, v45
    v_fmac_f32 v47, v17, v44
    v_fma_f32 v44, v16, v46, v80
    v_fma_f32 v45, v16, v47, v84
    v_fmac_f32 v44, v18, v47
    v_fmac_f32 v45, v17, v46
    v_fma_f32 v46, v16, v44, v81
    v_fma_f32 v47, v16, v45, v85
    v_fmac_f32 v46, v18, v45
    v_fmac_f32 v47, v17, v44
    v_fma_f32 v44, v16, v46, v82
    v_fma_f32 v45, v16, v47, v86
    v_fmac_f32 v44, v18, v47
    v_fmac_f32 v45, v17, v46
    v_fma_f32 v46, v16, v44, v83
    v_fma_f32 v47, v16, v45, v87
    v_fmac_f32 v46, v18, v45
    v_fmac_f32 v47, v17, v44
    v_fma_f32 v44, v16, v46, v88
    v_fma_f32 v45, v16, v47, v92
    v_fmac_f32 v44, v18, v47
    v_fmac_f32 v45, v17, v46
    v_fma_f32 v46, v16, v44, v89
    v_fma_f32 v47, v16, v45, v93
    v_fmac_f32 v46, v18, v45
    v_fmac_f32 v47, v17, v44
    v_fma_f32 v44, v16, v46, v90
    v_fma_f32 v45, v16, v47, v94
    v_fmac_f32 v44, v18, v47
    v_fmac_f32 v45, v17, v46
    v_fma_f32 v46, v16, v44, v91
    v_fma_f32 v47, v16, v45, v95
    v_fmac_f32 v46, v18, v45
    v_fmac_f32 v47, v17, v44
    v_fma_f32 v44, v16, v46, v96
    v_fma_f32 v45, v16, v47, v100
    v_fmac_f32 v44, v18, v47
    v_fmac_f32 v45, v17, v46
    v_fma_f32 v46, v16, v44, v97
    v_fma_f32 v47, v16, v45, v101
    v_fmac_f32 v46, v18, v45
    v_fmac_f32 v47, v17, v44
    v_fma_f32 v44, v16, v46, v98
    v_fma_f32 v45, v16, v47, v102
    v_fmac_f32 v44, v18, v47
    v_fmac_f32 v45, v17, v46
    v_fma_f32 v46, v16, v44, v99
    v_fma_f32 v47, v16, v45, v103
    v_fmac_f32 v46, v18, v45
    v_fmac_f32 v47, v17, v44
    v_fma_f32 v44, v16, v46, v104
    v_fma_f32 v45, v16, v47, v108
    v_fmac_f32 v44, v18, v47
    v_fmac_f32 v45, v17, v46
    v_fma_f32 v46, v16, v44, v105
    v_fma_f32 v47, v16, v45, v109
    v_fmac_f32 v46, v18, v45
    v_fmac_f32 v47, v17, v44
    v_fma_f32 v44, v16, v46, v106
    v_fma_f32 v45, v16, v47, v110
    v_fmac_f32 v44, v18, v47
    v_fmac_f32 v45, v17, v46
    v_fma_f32 v46, v16, v44, v107
    v_fma_f32 v47, v16, v45, v111
    v_fmac_f32 v46, v18, v45
    v_fmac_f32 v47, v17, v44
    v_fma_f32 v44, v16, v46, v112
    v_fma_f32 v45, v16, v47, v116
    v_fmac_f32 v44, v18, v47
    v_fmac_f32 v45, v17, v46
    v_fma_f32 v46, v16, v44, v113
    v_fma_f32 v47, v16, v45, v117
    v_fmac_f32 v46, v18, v45
    v_fmac_f32 v47, v17, v44
    v_fma_f32 v44, v16, v46, v114
    v_fma_f32 v45, v16, v47, v118
    v_fmac_f32 v44, v18, v47
    v_fmac_f32 v45, v17, v46
    v_fma_f32 v46, v16, v44, v115
    v_fma_f32 v47, v16, v45, v119
    v_fmac_f32 v46, v18, v45
    v_fmac_f32 v47, v17, v44
    v_fma_f32 v44, v16, v46, v120
    v_fma_f32 v45, v16, v47, v124
    v_fmac_f32 v44, v18, v47
    v_fmac_f32 v45, v17, v46
    v_fma_f32 v46, v16, v44, v121
    v_fma_f32 v47, v16, v45, v125
    v_fmac_f32 v46, v18, v45
    v_fmac_f32 v47, v17, v44
    v_fma_f32 v44, v16, v46, v122
    v_fma_f32 v45, v16, v47, v126
    v_fmac_f32 v44, v18, v47
    v_fmac_f32 v45, v17, v46
    v_fma_f32 v46, v16, v44, v123
    v_fma_f32 v47, v16, v45, v127
    v_fmac_f32 v46, v18, v45
    v_fmac_f32 v47, v17, v44
    v_mov_b32 v44, v46
    v_mov_b32 v45, v47
    s_nop 1
    v_permlane32_swap_b32 v46, v44
    v_permlane32_swap_b32 v47, v45
    v_mov_b32 v48, v46
    v_mov_b32 v49, v47
    v_mov_b32 v50, v44
    v_mov_b32 v51, v45
    s_nop 0
    v_permlane16_swap_b32 v46, v48
    v_permlane16_swap_b32 v47, v49
    v_permlane16_swap_b32 v44, v50
    v_permlane16_swap_b32 v45, v51
    v_fma_f32 v48, v46, v22, v48
    v_fma_f32 v49, v46, v23, v49
    v_fma_f32 v48, -v47, v23, v48
    v_fmac_f32 v49, v47, v22
    v_fma_f32 v44, v48, v22, v44
    v_fma_f32 v45, v48, v23, v45
    v_fma_f32 v44, -v49, v23, v44
    v_fmac_f32 v45, v49, v22
    v_fma_f32 v52, v44, v22, v50
    v_fma_f32 v53, v44, v23, v51
    v_fma_f32 v52, -v45, v23, v52
    v_fmac_f32 v53, v45, v22
    s_mov_b64 exec, 0xffff
    buffer_store_dwordx4 v[52:55], v34, s[12:15], 0 offen sc1
    s_mov_b64 exec, -1
    buffer_load_dwordx4 v[192:195], v30, s[12:15], 0 offen sc1
    buffer_load_dwordx4 v[196:199], v31, s[12:15], 0 offen sc1
    buffer_load_dwordx4 v[200:203], v32, s[12:15], 0 offen sc1
    buffer_load_dwordx4 v[204:207], v33, s[12:15], 0 offen sc1
    v_cndmask_b32 v50, 0, v46, s[48:49]
    v_cndmask_b32 v51, 0, v47, s[48:49]
    v_cndmask_b32 v50, v50, v48, s[50:51]
    v_cndmask_b32 v51, v51, v49, s[50:51]
    v_cndmask_b32 v50, v50, v44, s[52:53]
    v_cndmask_b32 v51, v51, v45, s[52:53]
    v_mul_f32 v56, v20, v50
    v_mul_f32 v57, v20, v51
    v_fma_f32 v56, -v21, v51, v56
    v_fmac_f32 v57, v21, v50
    v_mul_f32 v128, v20, v64
    v_fmac_f32 v128, v43, v68
    v_mul_f32 v68, v42, v68
    v_fmac_f32 v68, v43, v64
    v_mul_f32 v129, v20, v65
    v_fmac_f32 v129, v43, v69
    v_mul_f32 v69, v42, v69
    v_fmac_f32 v69, v43, v65
    v_mul_f32 v130, v20, v66
    v_fmac_f32 v130, v43, v70
    v_mul_f32 v70, v42, v70
    v_fmac_f32 v70, v43, v66
    v_mul_f32 v131, v20, v67
    v_fmac_f32 v131, v43, v71
    v_mul_f32 v71, v42, v71
    v_fmac_f32 v71, v43, v67
    v_mul_f32 v132, v20, v72
    v_fmac_f32 v132, v43, v76
    v_mul_f32 v76, v42, v76
    v_fmac_f32 v76, v43, v72
    v_mul_f32 v133, v20, v73
    v_fmac_f32 v133, v43, v77
    v_mul_f32 v77, v42, v77
    v_fmac_f32 v77, v43, v73
    v_mul_f32 v134, v20, v74
    v_fmac_f32 v134, v43, v78
    v_mul_f32 v78, v42, v78
    v_fmac_f32 v78, v43, v74
    v_mul_f32 v135, v20, v75
    v_fmac_f32 v135, v43, v79
    v_mul_f32 v79, v42, v79
    v_fmac_f32 v79, v43, v75
    v_mul_f32 v136, v20, v80
    v_fmac_f32 v136, v43, v84
    v_mul_f32 v84, v42, v84
    v_fmac_f32 v84, v43, v80
    v_mul_f32 v137, v20, v81
    v_fmac_f32 v137, v43, v85
    v_mul_f32 v85, v42, v85
    v_fmac_f32 v85, v43, v81
    v_mul_f32 v138, v20, v82
    v_fmac_f32 v138, v43, v86
    v_mul_f32 v86, v42, v86
    v_fmac_f32 v86, v43, v82
    v_mul_f32 v139, v20, v83
    v_fmac_f32 v139, v43, v87
    v_mul_f32 v87, v42, v87
    v_fmac_f32 v87, v43, v83
    v_mul_f32 v140, v20, v88
    v_fmac_f32 v140, v43, v92
    v_mul_f32 v92, v42, v92
    v_fmac_f32 v92, v43, v88
    v_mul_f32 v141, v20, v89
    v_fmac_f32 v141, v43, v93
    v_mul_f32 v93, v42, v93
    v_fmac_f32 v93, v43, v89
    v_mul_f32 v142, v20, v90
    v_fmac_f32 v142, v43, v94
    v_mul_f32 v94, v42, v94
    v_fmac_f32 v94, v43, v90
    v_mul_f32 v143, v20, v91
    v_fmac_f32 v143, v43, v95
    v_mul_f32 v95, v42, v95
    v_fmac_f32 v95, v43, v91
    v_mul_f32 v144, v20, v96
    v_fmac_f32 v144, v43, v100
    v_mul_f32 v100, v42, v100
    v_fmac_f32 v100, v43, v96
    v_mul_f32 v145, v20, v97
    v_fmac_f32 v145, v43, v101
    v_mul_f32 v101, v42, v101
    v_fmac_f32 v101, v43, v97
    v_mul_f32 v146, v20, v98
    v_fmac_f32 v146, v43, v102
    v_mul_f32 v102, v42, v102
    v_fmac_f32 v102, v43, v98
    v_mul_f32 v147, v20, v99
    v_fmac_f32 v147, v43, v103
    v_mul_f32 v103, v42, v103
    v_fmac_f32 v103, v43, v99
    v_mul_f32 v148, v20, v104
    v_fmac_f32 v148, v43, v108
    v_mul_f32 v108, v42, v108
    v_fmac_f32 v108, v43, v104
    v_mul_f32 v149, v20, v105
    v_fmac_f32 v149, v43, v109
    v_mul_f32 v109, v42, v109
    v_fmac_f32 v109, v43, v105
    v_mul_f32 v150, v20, v106
    v_fmac_f32 v150, v43, v110
    v_mul_f32 v110, v42, v110
    v_fmac_f32 v110, v43, v106
    v_mul_f32 v151, v20, v107
    v_fmac_f32 v151, v43, v111
    v_mul_f32 v111, v42, v111
    v_fmac_f32 v111, v43, v107
    v_mul_f32 v152, v20, v112
    v_fmac_f32 v152, v43, v116
    v_mul_f32 v116, v42, v116
    v_fmac_f32 v116, v43, v112
    v_mul_f32 v153, v20, v113
    v_fmac_f32 v153, v43, v117
    v_mul_f32 v117, v42, v117
    v_fmac_f32 v117, v43, v113
    v_mul_f32 v154, v20, v114
    v_fmac_f32 v154, v43, v118
    v_mul_f32 v118, v42, v118
    v_fmac_f32 v118, v43, v114
    v_mul_f32 v155, v20, v115
    v_fmac_f32 v155, v43, v119
    v_mul_f32 v119, v42, v119
    v_fmac_f32 v119, v43, v115
    v_mul_f32 v156, v20, v120
    v_fmac_f32 v156, v43, v124
    v_mul_f32 v124, v42, v124
    v_fmac_f32 v124, v43, v120
    v_mul_f32 v157, v20, v121
    v_fmac_f32 v157, v43, v125
    v_mul_f32 v125, v42, v125
    v_fmac_f32 v125, v43, v121
    v_mul_f32 v158, v20, v122
    v_fmac_f32 v158, v43, v126
    v_mul_f32 v126, v42, v126
    v_fmac_f32 v126, v43, v122
    v_mul_f32 v159, v20, v123
    v_fmac_f32 v159, v43, v127
    v_mul_f32 v127, v42, v127
    v_fmac_f32 v127, v43, v123
    s_mov_b32 s39, 0
C_chk:
    s_waitcnt vmcnt(0)
    v_cmp_eq_u32 vcc, v194, v54
    v_cmp_eq_u32 s[54:55], v195, v55
    s_and_b64 s[54:55], s[54:55], vcc
    s_or_b64 s[56:57], s[54:55], s[40:41]
    v_cmp_eq_u32 vcc, v198, v54
    v_cmp_eq_u32 s[54:55], v199, v55
    s_and_b64 s[54:55], s[54:55], vcc
    s_or_b64 s[58:59], s[54:55], s[42:43]
    v_cmp_eq_u32 vcc, v202, v54
    v_cmp_eq_u32 s[54:55], v203, v55
    s_and_b64 s[54:55], s[54:55], vcc
    s_or_b64 s[60:61], s[54:55], s[44:45]
    v_cmp_eq_u32 vcc, v206, v54
    v_cmp_eq_u32 s[54:55], v207, v55
    s_and_b64 s[54:55], s[54:55], vcc
    s_or_b64 s[62:63], s[54:55], s[46:47]
    s_and_b64 s[56:57], s[56:57], s[58:59]
    s_and_b64 s[60:61], s[60:61], s[62:63]
    s_and_b64 s[56:57], s[56:57], s[60:61]
    s_cmp_eq_u64 s[56:57], -1
    s_cbranch_scc1 C_ok
    s_add_u32 s39, s39, 1
    s_cmp_gt_u32 s39, 4096
    s_cbranch_scc1 C_ok
    buffer_load_dwordx4 v[192:195], v30, s[12:15], 0 offen sc1
    buffer_load_dwordx4 v[196:199], v31, s[12:15], 0 offen sc1
    buffer_load_dwordx4 v[200:203], v32, s[12:15], 0 offen sc1
    buffer_load_dwordx4 v[204:207], v33, s[12:15], 0 offen sc1
    s_branch C_chk
C_ok:
    v_fma_f32 v200, v204, v28, v200
    v_fma_f32 v201, v204, v29, v201
    v_fma_f32 v200, -v205, v29, v200
    v_fmac_f32 v201, v205, v28
    v_fma_f32 v196, v200, v28, v196
    v_fma_f32 v197, v200, v29, v197
    v_fma_f32 v196, -v201, v29, v196
    v_fmac_f32 v197, v201, v28
    v_fma_f32 v192, v196, v28, v192
    v_fma_f32 v193, v196, v29, v193
    v_fma_f32 v192, -v197, v29, v192
    v_fmac_f32 v193, v197, v28
    v_mul_f32 v44, v192, v26
    v_mul_f32 v45, v192, v27
    v_fma_f32 v44, -v193, v27, v44
    v_fmac_f32 v45, v193, v26
    v_mov_b32 v46, v44
    v_mov_b32 v47, v45
    s_nop 1
    v_permlane32_swap_b32 v44, v46
    v_permlane32_swap_b32 v45, v47
    v_add_f32 v44, v44, v46
    v_add_f32 v45, v45, v47
    v_mov_b32 v46, v44
    v_mov_b32 v47, v45
    s_nop 1
    v_permlane16_swap_b32 v44, v46
    v_permlane16_swap_b32 v45, v47
    v_add_f32 v44, v44, v46
    v_add_f32 v45, v45, v47
    v_fma_f32 v56, v24, v44, v56
    v_fma_f32 v57, v24, v45, v57
    v_fma_f32 v56, -v25, v45, v56
    v_fmac_f32 v57, v25, v44
    v_xor_b32 v57, 0x80000000, v57
    v_fmac_f32 v128, v16, v56
    v_fmac_f32 v68, v16, v57
    v_fmac_f32 v128, v17, v57
    v_fmac_f32 v68, v18, v56
    v_fmac_f32 v129, v16, v128
    v_fmac_f32 v69, v16, v68
    v_fmac_f32 v129, v17, v68
    v_fmac_f32 v69, v18, v128
    v_cvt_pk_bf16_f32 v160, v128, v129
    v_cvt_pk_bf16_f32 v164, v68, v69
    v_fmac_f32 v130, v16, v129
    v_fmac_f32 v70, v16, v69
    v_fmac_f32 v130, v17, v69
    v_fmac_f32 v70, v18, v129
    v_fmac_f32 v131, v16, v130
    v_fmac_f32 v71, v16, v70
    v_fmac_f32 v131, v17, v70
    v_fmac_f32 v71, v18, v130
    v_cvt_pk_bf16_f32 v161, v130, v131
    v_cvt_pk_bf16_f32 v165, v70, v71
    v_fmac_f32 v132, v16, v131
    v_fmac_f32 v76, v16, v71
    v_fmac_f32 v132, v17, v71
    v_fmac_f32 v76, v18, v131
    v_fmac_f32 v133, v16, v132
    v_fmac_f32 v77, v16, v76
    v_fmac_f32 v133, v17, v76
    v_fmac_f32 v77, v18, v132
    v_cvt_pk_bf16_f32 v162, v132, v133
    v_cvt_pk_bf16_f32 v166, v76, v77
    v_fmac_f32 v134, v16, v133
    v_fmac_f32 v78, v16, v77
    v_fmac_f32 v134, v17, v77
    v_fmac_f32 v78, v18, v133
    v_fmac_f32 v135, v16, v134
    v_fmac_f32 v79, v16, v78
    v_fmac_f32 v135, v17, v78
    v_fmac_f32 v79, v18, v134
    v_cvt_pk_bf16_f32 v163, v134, v135
    v_cvt_pk_bf16_f32 v167, v78, v79
    buffer_store_dwordx4 v[160:163], v35, s[8:11], 0 offen offset:0 sc1
    buffer_store_dwordx4 v[164:167], v35, s[8:11], s36 offen offset:0 sc1
    v_fmac_f32 v136, v16, v135
    v_fmac_f32 v84, v16, v79
    v_fmac_f32 v136, v17, v79
    v_fmac_f32 v84, v18, v135
    v_fmac_f32 v137, v16, v136
    v_fmac_f32 v85, v16, v84
    v_fmac_f32 v137, v17, v84
    v_fmac_f32 v85, v18, v136
    v_cvt_pk_bf16_f32 v168, v136, v137
    v_cvt_pk_bf16_f32 v172, v84, v85
    v_fmac_f32 v138, v16, v137
    v_fmac_f32 v86, v16, v85
    v_fmac_f32 v138, v17, v85
    v_fmac_f32 v86, v18, v137
    v_fmac_f32 v139, v16, v138
    v_fmac_f32 v87, v16, v86
    v_fmac_f32 v139, v17, v86
    v_fmac_f32 v87, v18, v138
    v_cvt_pk_bf16_f32 v169, v138, v139
    v_cvt_pk_bf16_f32 v173, v86, v87
    v_fmac_f32 v140, v16, v139
    v_fmac_f32 v92, v16, v87
    v_fmac_f32 v140, v17, v87
    v_fmac_f32 v92, v18, v139
    v_fmac_f32 v141, v16, v140
    v_fmac_f32 v93, v16, v92
    v_fmac_f32 v141, v17, v92
    v_fmac_f32 v93, v18, v140
    v_cvt_pk_bf16_f32 v170, v140, v141
    v_cvt_pk_bf16_f32 v174, v92, v93
    v_fmac_f32 v142, v16, v141
    v_fmac_f32 v94, v16, v93
    v_fmac_f32 v142, v17, v93
    v_fmac_f32 v94, v18, v141
    v_fmac_f32 v143, v16, v142
    v_fmac_f32 v95, v16, v94
    v_fmac_f32 v143, v17, v94
    v_fmac_f32 v95, v18, v142
    v_cvt_pk_bf16_f32 v171, v142, v143
    v_cvt_pk_bf16_f32 v175, v94, v95
    buffer_store_dwordx4 v[168:171], v36, s[8:11], 0 offen offset:1024 sc1
    buffer_store_dwordx4 v[172:175], v36, s[8:11], s36 offen offset:1024 sc1
    v_fmac_f32 v144, v16, v143
    v_fmac_f32 v100, v16, v95
    v_fmac_f32 v144, v17, v95
    v_fmac_f32 v100, v18, v143
    v_fmac_f32 v145, v16, v144
    v_fmac_f32 v101, v16, v100
    v_fmac_f32 v145, v17, v100
    v_fmac_f32 v101, v18, v144
    v_cvt_pk_bf16_f32 v176, v144, v145
    v_cvt_pk_bf16_f32 v180, v100, v101
    v_fmac_f32 v146, v16, v145
    v_fmac_f32 v102, v16, v101
    v_fmac_f32 v146, v17, v101
    v_fmac_f32 v102, v18, v145
    v_fmac_f32 v147, v16, v146
    v_fmac_f32 v103, v16, v102
    v_fmac_f32 v147, v17, v102
    v_fmac_f32 v103, v18, v146
    v_cvt_pk_bf16_f32 v177, v146, v147
    v_cvt_pk_bf16_f32 v181, v102, v103
    v_fmac_f32 v148, v16, v147
    v_fmac_f32 v108, v16, v103
    v_fmac_f32 v148, v17, v103
    v_fmac_f32 v108, v18, v147
    v_fmac_f32 v149, v16, v148
    v_fmac_f32 v109, v16, v108
    v_fmac_f32 v149, v17, v108
    v_fmac_f32 v109, v18, v148
    v_cvt_pk_bf16_f32 v178, v148, v149
    v_cvt_pk_bf16_f32 v182, v108, v109
    v_fmac_f32 v150, v16, v149
    v_fmac_f32 v110, v16, v109
    v_fmac_f32 v150, v17, v109
    v_fmac_f32 v110, v18, v149
    v_fmac_f32 v151, v16, v150
    v_fmac_f32 v111, v16, v110
    v_fmac_f32 v151, v17, v110
    v_fmac_f32 v111, v18, v150
    v_cvt_pk_bf16_f32 v179, v150, v151
    v_cvt_pk_bf16_f32 v183, v110, v111
    buffer_store_dwordx4 v[176:179], v35, s[8:11], 0 offen offset:2048 sc1
    buffer_store_dwordx4 v[180:183], v35, s[8:11], s36 offen offset:2048 sc1
    v_fmac_f32 v152, v16, v151
    v_fmac_f32 v116, v16, v111
    v_fmac_f32 v152, v17, v111
    v_fmac_f32 v116, v18, v151
    v_fmac_f32 v153, v16, v152
    v_fmac_f32 v117, v16, v116
    v_fmac_f32 v153, v17, v116
    v_fmac_f32 v117, v18, v152
    v_cvt_pk_bf16_f32 v184, v152, v153
    v_cvt_pk_bf16_f32 v188, v116, v117
    v_fmac_f32 v154, v16, v153
    v_fmac_f32 v118, v16, v117
    v_fmac_f32 v154, v17, v117
    v_fmac_f32 v118, v18, v153
    v_fmac_f32 v155, v16, v154
    v_fmac_f32 v119, v16, v118
    v_fmac_f32 v155, v17, v118
    v_fmac_f32 v119, v18, v154
    v_cvt_pk_bf16_f32 v185, v154, v155
    v_cvt_pk_bf16_f32 v189, v118, v119
    v_fmac_f32 v156, v16, v155
    v_fmac_f32 v124, v16, v119
    v_fmac_f32 v156, v17, v119
    v_fmac_f32 v124, v18, v155
    v_fmac_f32 v157, v16, v156
    v_fmac_f32 v125, v16, v124
    v_fmac_f32 v157, v17, v124
    v_fmac_f32 v125, v18, v156
    v_cvt_pk_bf16_f32 v186, v156, v157
    v_cvt_pk_bf16_f32 v190, v124, v125
    v_fmac_f32 v158, v16, v157
    v_fmac_f32 v126, v16, v125
    v_fmac_f32 v158, v17, v125
    v_fmac_f32 v126, v18, v157
    v_fmac_f32 v159, v16, v158
    v_fmac_f32 v127, v16, v126
    v_fmac_f32 v159, v17, v126
    v_fmac_f32 v127, v18, v158
    v_cvt_pk_bf16_f32 v187, v158, v159
    v_cvt_pk_bf16_f32 v191, v126, v127
    buffer_store_dwordx4 v[184:187], v36, s[8:11], 0 offen offset:3072 sc1
    buffer_store_dwordx4 v[188:191], v36, s[8:11], s36 offen offset:3072 sc1
    s_mov_b32 s39, 0
C_fsp:
    ds_read_b128 v[44:47], v60 offset:16
    s_add_u32 s39, s39, 1
    s_waitcnt lgkmcnt(0)
    v_xor_b32 v44, v44, v54
    v_xor_b32 v45, v45, v54
    v_xor_b32 v46, v46, v54
    v_xor_b32 v47, v47, v54
    v_or3_b32 v44, v44, v45, v46
    v_or_b32 v44, v44, v47
    s_cmp_gt_u32 s39, 4096
    s_cbranch_scc1 C_fok
    v_cmp_ne_u32 vcc, 0, v44
    s_cbranch_vccnz C_fsp
C_fok:
    ds_write_b128 v61, v[160:163] offset:0
    ds_write_b128 v61, v[164:167] offset:4096
    ds_write_b128 v62, v[168:171] offset:1024
    ds_write_b128 v62, v[172:175] offset:5120
    ds_write_b128 v61, v[176:179] offset:2048
    ds_write_b128 v61, v[180:183] offset:6144
    ds_write_b128 v62, v[184:187] offset:3072
    ds_write_b128 v62, v[188:191] offset:7168
    v_bfe_u32 v1, v2, 1, 1
    v_bfe_u32 v3, v2, 2, 2
    v_lshl_add_u32 v3, v13, 3, v3
    v_lshl_add_u32 v3, v1, 2, v3
    v_lshlrev_b32 v3, 4, v3
    v_lshl_add_u32 v3, v1, 10, v3
    v_and_b32 v1, 1, v2
    v_lshl_add_u32 v3, v1, 3, v3
    v_mov_b32 v8, v4
    v_mov_b32 v9, v6
    s_lshl_b32 s6, s5, 13
    s_add_u32 s6, s6, 65536
    v_add_u32 v4, s6, v3
    v_xor_b32 v6, 64, v4
    s_lshl_b32 s6, s5, 14
    s_add_u32 s6, s6, 98304
    v_add_u32 v5, s6, v3
    v_xor_b32 v7, 64, v5
    s_lshl_b32 s6, s3, 2
    s_add_u32 s6, s6, s5
    s_lshl_b32 s6, s6, 18
    s_lshl_b32 s7, s4, 8
    s_add_u32 s6, s6, s7
    s_add_u32 s6, s6, 4096
    v_lshlrev_b32 v10, 15, v13
    v_lshl_add_u32 v10, v12, 4, v10
    v_add_u32 v10, s6, v10
    v_lshlrev_b32 v1, 1, v13
    v_sub_u32 v1, v12, v1
    v_cmp_eq_u32 s[40:41], 0, v1
    v_cmp_eq_u32 s[42:43], 1, v1
    v_cmp_eq_u32 s[44:45], 8, v1
    v_cmp_eq_u32 s[46:47], 9, v1
    v_and_b32 v44, 0xffff, v244
    v_and_b32 v45, 0xffff0000, v244
    v_and_b32 v46, 0xffff, v245
    v_and_b32 v47, 0xffff0000, v245
    s_lshl_b32 s6, s3, 4
    s_add_u32 s6, s6, s4
    s_lshl_b32 s6, s6, 2
    s_lshl_b32 s6, s6, 7
    s_add_u32 s6, s6, 131072
    v_lshl_add_u32 v11, v12, 3, s6
    v_cndmask_b32 v96, 0, v44, s[40:41]
    v_mov_b32 v97, 0
    v_cndmask_b32 v98, 0, v44, s[42:43]
    v_mov_b32 v99, 0
    v_cndmask_b32 v100, 0, v44, s[44:45]
    v_mov_b32 v101, 0
    v_cndmask_b32 v102, 0, v44, s[46:47]
    v_mov_b32 v103, 0
    v_cndmask_b32 v104, 0, v45, s[40:41]
    v_mov_b32 v105, 0
    v_cndmask_b32 v106, 0, v45, s[42:43]
    v_mov_b32 v107, 0
    v_cndmask_b32 v108, 0, v45, s[44:45]
    v_mov_b32 v109, 0
    v_cndmask_b32 v110, 0, v45, s[46:47]
    v_mov_b32 v111, 0
    v_mov_b32 v112, 0
    v_cndmask_b32 v113, 0, v46, s[40:41]
    v_mov_b32 v114, 0
    v_cndmask_b32 v115, 0, v46, s[42:43]
    v_mov_b32 v116, 0
    v_cndmask_b32 v117, 0, v46, s[44:45]
    v_mov_b32 v118, 0
    v_cndmask_b32 v119, 0, v46, s[46:47]
    v_mov_b32 v120, 0
    v_cndmask_b32 v121, 0, v47, s[40:41]
    v_mov_b32 v122, 0
    v_cndmask_b32 v123, 0, v47, s[42:43]
    v_mov_b32 v124, 0
    v_cndmask_b32 v125, 0, v47, s[44:45]
    v_mov_b32 v126, 0
    v_cndmask_b32 v127, 0, v47, s[46:47]
    v_bfe_u32 v1, v2, 2, 2
    v_lshlrev_b32 v1, 14, v1
    v_and_b32 v3, 3, v2
    v_lshl_add_u32 v1, v3, 7, v1
    v_lshl_add_u32 v1, v13, 4, v1
    s_lshl_b32 s6, s5, 10
    s_add_u32 s6, s6, 106496
    v_add_u32 v16, s6, v1
    s_lshl_b32 s6, s33, 4
    s_add_u32 s6, s6, s32
    s_lshl_b32 s7, s6, 2
    s_add_u32 s7, s7, s5
    s_lshl_b32 s7, s7, 12
    v_lshlrev_b32 v1, 4, v2
    v_add_u32 v17, s7, v1
    s_lshl_b32 s7, s5, 8
    s_add_u32 s7, s7, s6
    s_lshl_b32 s7, s7, 7
    s_add_u32 s7, s7, 262144
    v_lshl_add_u32 v18, v12, 3, s7
    s_nop 1
    v_mfma_f32_16x16x32_bf16 v[64:67], v[228:231], v[96:99], 0
    v_mfma_f32_16x16x32_bf16 v[68:71], v[228:231], v[104:107], 0
    v_mfma_f32_16x16x32_bf16 v[72:75], v[228:231], v[112:115], 0
    v_mfma_f32_16x16x32_bf16 v[76:79], v[228:231], v[120:123], 0
    v_mfma_f32_16x16x32_bf16 v[80:83], v[236:239], v[96:99], 0
    v_mfma_f32_16x16x32_bf16 v[84:87], v[236:239], v[104:107], 0
    v_mfma_f32_16x16x32_bf16 v[88:91], v[236:239], v[112:115], 0
    v_mfma_f32_16x16x32_bf16 v[92:95], v[236:239], v[120:123], 0
    v_mfma_f32_16x16x32_bf16 v[64:67], v[232:235], v[100:103], v[64:67]
    v_mfma_f32_16x16x32_bf16 v[68:71], v[232:235], v[108:111], v[68:71]
    v_mfma_f32_16x16x32_bf16 v[72:75], v[232:235], v[116:119], v[72:75]
    v_mfma_f32_16x16x32_bf16 v[76:79], v[232:235], v[124:127], v[76:79]
    v_mfma_f32_16x16x32_bf16 v[80:83], v[240:243], v[100:103], v[80:83]
    v_mfma_f32_16x16x32_bf16 v[84:87], v[240:243], v[108:111], v[84:87]
    v_mfma_f32_16x16x32_bf16 v[88:91], v[240:243], v[116:119], v[88:91]
    v_mfma_f32_16x16x32_bf16 v[92:95], v[240:243], v[124:127], v[92:95]
    s_waitcnt vmcnt(0)
    ds_write_b32 v63, v54 offset:32
    ds_read_b128 v[44:47], v60 offset:32
    s_waitcnt lgkmcnt(0)
    v_xor_b32 v44, v44, v54
    v_xor_b32 v45, v45, v54
    v_xor_b32 v46, v46, v54
    v_xor_b32 v47, v47, v54
    v_or3_b32 v44, v44, v45, v46
    v_or_b32 v44, v44, v47
    v_cmp_ne_u32 vcc, 0, v44
    s_cbranch_vccnz C_nofl
    s_mov_b64 exec, 0xffff
    buffer_store_dwordx2 v[54:55], v11, s[72:75], 0 offen sc1
    s_mov_b64 exec, -1
C_nofl:
    s_setprio 0
    s_waitcnt lgkmcnt(0)
    s_barrier
    ds_read_b64_tr_b16 v[96:97], v4 offset:0
    ds_read_b64_tr_b16 v[98:99], v6 offset:0
    ds_read_b64_tr_b16 v[100:101], v4 offset:2048
    ds_read_b64_tr_b16 v[102:103], v6 offset:2048
    ds_read_b128 v[104:107], v8 offset:0
    ds_read_b128 v[108:111], v8 offset:16384
    ds_read_b128 v[112:115], v8 offset:32768
    ds_read_b128 v[116:119], v8 offset:49152
    s_mov_b32 s30, 0
C2_loop:
    s_waitcnt lgkmcnt(0)
    v_mfma_f32_16x16x32_bf16 v[64:67], v[96:99], v[104:107], v[64:67]
    ds_read_b64_tr_b16 v[120:121], v4 offset:512
    ds_read_b64_tr_b16 v[122:123], v6 offset:512
    v_mfma_f32_16x16x32_bf16 v[68:71], v[96:99], v[108:111], v[68:71]
    ds_read_b64_tr_b16 v[124:125], v4 offset:2560
    ds_read_b64_tr_b16 v[126:127], v6 offset:2560
    v_mfma_f32_16x16x32_bf16 v[72:75], v[96:99], v[112:115], v[72:75]
    ds_read_b128 v[128:131], v9 offset:0
    ds_read_b128 v[132:135], v9 offset:16384
    v_mfma_f32_16x16x32_bf16 v[76:79], v[96:99], v[116:119], v[76:79]
    ds_read_b128 v[136:139], v9 offset:32768
    ds_read_b128 v[140:143], v9 offset:49152
    v_mfma_f32_16x16x32_bf16 v[92:95], v[100:103], v[116:119], v[92:95]
    v_mfma_f32_16x16x32_bf16 v[88:91], v[100:103], v[112:115], v[88:91]
    v_mfma_f32_16x16x32_bf16 v[84:87], v[100:103], v[108:111], v[84:87]
    v_mfma_f32_16x16x32_bf16 v[80:83], v[100:103], v[104:107], v[80:83]
    s_waitcnt lgkmcnt(0)
    s_barrier
    v_mfma_f32_16x16x32_bf16 v[64:67], v[120:123], v[128:131], v[64:67]
    ds_read_b64_tr_b16 v[96:97], v4 offset:4096
    ds_read_b64_tr_b16 v[98:99], v6 offset:4096
    v_mfma_f32_16x16x32_bf16 v[68:71], v[120:123], v[132:135], v[68:71]
    ds_read_b64_tr_b16 v[100:101], v4 offset:6144
    ds_read_b64_tr_b16 v[102:103], v6 offset:6144
    v_mfma_f32_16x16x32_bf16 v[72:75], v[120:123], v[136:139], v[72:75]
    ds_read_b128 v[104:107], v8 offset:2048
    ds_read_b128 v[108:111], v8 offset:18432
    v_mfma_f32_16x16x32_bf16 v[76:79], v[120:123], v[140:143], v[76:79]
    ds_read_b128 v[112:115], v8 offset:34816
    ds_read_b128 v[116:119], v8 offset:51200
    v_mfma_f32_16x16x32_bf16 v[92:95], v[124:127], v[140:143], v[92:95]
    v_mfma_f32_16x16x32_bf16 v[88:91], v[124:127], v[136:139], v[88:91]
    v_mfma_f32_16x16x32_bf16 v[84:87], v[124:127], v[132:135], v[84:87]
    v_mfma_f32_16x16x32_bf16 v[80:83], v[124:127], v[128:131], v[80:83]
    s_waitcnt lgkmcnt(0)
    v_mfma_f32_16x16x32_bf16 v[64:67], v[96:99], v[104:107], v[64:67]
    ds_read_b64_tr_b16 v[120:121], v4 offset:4608
    ds_read_b64_tr_b16 v[122:123], v6 offset:4608
    v_mfma_f32_16x16x32_bf16 v[68:71], v[96:99], v[108:111], v[68:71]
    ds_read_b64_tr_b16 v[124:125], v4 offset:6656
    ds_read_b64_tr_b16 v[126:127], v6 offset:6656
    v_mfma_f32_16x16x32_bf16 v[72:75], v[96:99], v[112:115], v[72:75]
    ds_read_b128 v[128:131], v9 offset:2048
    ds_read_b128 v[132:135], v9 offset:18432
    v_mfma_f32_16x16x32_bf16 v[76:79], v[96:99], v[116:119], v[76:79]
    ds_read_b128 v[136:139], v9 offset:34816
    ds_read_b128 v[140:143], v9 offset:51200
    v_mfma_f32_16x16x32_bf16 v[92:95], v[100:103], v[116:119], v[92:95]
    v_mfma_f32_16x16x32_bf16 v[88:91], v[100:103], v[112:115], v[88:91]
    v_mfma_f32_16x16x32_bf16 v[84:87], v[100:103], v[108:111], v[84:87]
    v_mfma_f32_16x16x32_bf16 v[80:83], v[100:103], v[104:107], v[80:83]
    s_cmp_eq_u32 s30, 0
    s_cbranch_scc1 C2_zt
C2_zt_r:
    s_waitcnt lgkmcnt(0)
    s_barrier
    v_mfma_f32_16x16x32_bf16 v[64:67], v[120:123], v[128:131], v[64:67]
    ds_read_b64_tr_b16 v[96:97], v5 offset:0
    ds_read_b64_tr_b16 v[98:99], v7 offset:0
    v_mfma_f32_16x16x32_bf16 v[68:71], v[120:123], v[132:135], v[68:71]
    ds_read_b64_tr_b16 v[100:101], v5 offset:2048
    ds_read_b64_tr_b16 v[102:103], v7 offset:2048
    v_mfma_f32_16x16x32_bf16 v[72:75], v[120:123], v[136:139], v[72:75]
    ds_read_b128 v[104:107], v8 offset:4096
    ds_read_b128 v[108:111], v8 offset:20480
    v_mfma_f32_16x16x32_bf16 v[76:79], v[120:123], v[140:143], v[76:79]
    ds_read_b128 v[112:115], v8 offset:36864
    ds_read_b128 v[116:119], v8 offset:53248
    v_mfma_f32_16x16x32_bf16 v[92:95], v[124:127], v[140:143], v[92:95]
    v_mfma_f32_16x16x32_bf16 v[88:91], v[124:127], v[136:139], v[88:91]
    v_mfma_f32_16x16x32_bf16 v[84:87], v[124:127], v[132:135], v[84:87]
    v_mfma_f32_16x16x32_bf16 v[80:83], v[124:127], v[128:131], v[80:83]
    s_waitcnt lgkmcnt(0)
    v_mfma_f32_16x16x32_bf16 v[64:67], v[96:99], v[104:107], v[64:67]
    ds_read_b64_tr_b16 v[120:121], v5 offset:512
    ds_read_b64_tr_b16 v[122:123], v7 offset:512
    v_mfma_f32_16x16x32_bf16 v[68:71], v[96:99], v[108:111], v[68:71]
    ds_read_b64_tr_b16 v[124:125], v5 offset:2560
    ds_read_b64_tr_b16 v[126:127], v7 offset:2560
    v_mfma_f32_16x16x32_bf16 v[72:75], v[96:99], v[112:115], v[72:75]
    ds_read_b128 v[128:131], v9 offset:4096
    ds_read_b128 v[132:135], v9 offset:20480
    v_mfma_f32_16x16x32_bf16 v[76:79], v[96:99], v[116:119], v[76:79]
    ds_read_b128 v[136:139], v9 offset:36864
    ds_read_b128 v[140:143], v9 offset:53248
    v_mfma_f32_16x16x32_bf16 v[92:95], v[100:103], v[116:119], v[92:95]
    v_mfma_f32_16x16x32_bf16 v[88:91], v[100:103], v[112:115], v[88:91]
    v_mfma_f32_16x16x32_bf16 v[84:87], v[100:103], v[108:111], v[84:87]
    v_mfma_f32_16x16x32_bf16 v[80:83], v[100:103], v[104:107], v[80:83]
    s_waitcnt lgkmcnt(0)
    s_barrier
    v_mfma_f32_16x16x32_bf16 v[64:67], v[120:123], v[128:131], v[64:67]
    ds_read_b64_tr_b16 v[96:97], v5 offset:4096
    ds_read_b64_tr_b16 v[98:99], v7 offset:4096
    v_mfma_f32_16x16x32_bf16 v[68:71], v[120:123], v[132:135], v[68:71]
    ds_read_b64_tr_b16 v[100:101], v5 offset:6144
    ds_read_b64_tr_b16 v[102:103], v7 offset:6144
    v_mfma_f32_16x16x32_bf16 v[72:75], v[120:123], v[136:139], v[72:75]
    ds_read_b128 v[104:107], v8 offset:6144
    ds_read_b128 v[108:111], v8 offset:22528
    v_mfma_f32_16x16x32_bf16 v[76:79], v[120:123], v[140:143], v[76:79]
    ds_read_b128 v[112:115], v8 offset:38912
    ds_read_b128 v[116:119], v8 offset:55296
    v_mfma_f32_16x16x32_bf16 v[92:95], v[124:127], v[140:143], v[92:95]
    v_mfma_f32_16x16x32_bf16 v[88:91], v[124:127], v[136:139], v[88:91]
    v_mfma_f32_16x16x32_bf16 v[84:87], v[124:127], v[132:135], v[84:87]
    v_mfma_f32_16x16x32_bf16 v[80:83], v[124:127], v[128:131], v[80:83]
    s_waitcnt lgkmcnt(0)
    v_mfma_f32_16x16x32_bf16 v[64:67], v[96:99], v[104:107], v[64:67]
    ds_read_b64_tr_b16 v[120:121], v5 offset:4608
    ds_read_b64_tr_b16 v[122:123], v7 offset:4608
    v_mfma_f32_16x16x32_bf16 v[68:71], v[96:99], v[108:111], v[68:71]
    ds_read_b64_tr_b16 v[124:125], v5 offset:6656
    ds_read_b64_tr_b16 v[126:127], v7 offset:6656
    v_mfma_f32_16x16x32_bf16 v[72:75], v[96:99], v[112:115], v[72:75]
    ds_read_b128 v[128:131], v9 offset:6144
    ds_read_b128 v[132:135], v9 offset:22528
    v_mfma_f32_16x16x32_bf16 v[76:79], v[96:99], v[116:119], v[76:79]
    ds_read_b128 v[136:139], v9 offset:38912
    ds_read_b128 v[140:143], v9 offset:55296
    v_mfma_f32_16x16x32_bf16 v[92:95], v[100:103], v[116:119], v[92:95]
    v_mfma_f32_16x16x32_bf16 v[88:91], v[100:103], v[112:115], v[88:91]
    v_mfma_f32_16x16x32_bf16 v[84:87], v[100:103], v[108:111], v[84:87]
    v_mfma_f32_16x16x32_bf16 v[80:83], v[100:103], v[104:107], v[80:83]
    v_xor_b32 v8, 8192, v8
    v_xor_b32 v9, 8192, v9
    s_cmp_eq_u32 s30, 7
    s_waitcnt lgkmcnt(0)
    s_cbranch_scc1 C2_nobar
    s_barrier
C2_nobar:
    v_mfma_f32_16x16x32_bf16 v[64:67], v[120:123], v[128:131], v[64:67]
    ds_read_b64_tr_b16 v[96:97], v4 offset:0
    ds_read_b64_tr_b16 v[98:99], v6 offset:0
    v_mfma_f32_16x16x32_bf16 v[68:71], v[120:123], v[132:135], v[68:71]
    ds_read_b64_tr_b16 v[100:101], v4 offset:2048
    ds_read_b64_tr_b16 v[102:103], v6 offset:2048
    v_mfma_f32_16x16x32_bf16 v[72:75], v[120:123], v[136:139], v[72:75]
    ds_read_b128 v[104:107], v8 offset:0
    ds_read_b128 v[108:111], v8 offset:16384
    v_mfma_f32_16x16x32_bf16 v[76:79], v[120:123], v[140:143], v[76:79]
    ds_read_b128 v[112:115], v8 offset:32768
    ds_read_b128 v[116:119], v8 offset:49152
    v_mfma_f32_16x16x32_bf16 v[92:95], v[124:127], v[140:143], v[92:95]
    v_mfma_f32_16x16x32_bf16 v[88:91], v[124:127], v[136:139], v[88:91]
    v_mfma_f32_16x16x32_bf16 v[84:87], v[124:127], v[132:135], v[84:87]
    v_mfma_f32_16x16x32_bf16 v[80:83], v[124:127], v[128:131], v[80:83]
    s_cmp_eq_u32 s30, 1
    s_cbranch_scc1 C2_zf
C2_zf_r:
    s_add_u32 s30, s30, 1
    s_cmp_lt_u32 s30, 8
    s_cbranch_scc1 C2_loop
    s_nop 5
    v_mov_b32 v160, v64
    v_mov_b32 v161, v68
    v_mov_b32 v162, v72
    v_mov_b32 v163, v76
    s_mov_b32 s6, 0
    buffer_store_dwordx4 v[160:163], v10, s[76:79], s6 offen nt
    v_mov_b32 v164, v65
    v_mov_b32 v165, v69
    v_mov_b32 v166, v73
    v_mov_b32 v167, v77
    s_mov_b32 s6, 8192
    buffer_store_dwordx4 v[164:167], v10, s[76:79], s6 offen nt
    v_mov_b32 v168, v66
    v_mov_b32 v169, v70
    v_mov_b32 v170, v74
    v_mov_b32 v171, v78
    s_mov_b32 s6, 16384
    buffer_store_dwordx4 v[168:171], v10, s[76:79], s6 offen nt
    v_mov_b32 v172, v67
    v_mov_b32 v173, v71
    v_mov_b32 v174, v75
    v_mov_b32 v175, v79
    s_mov_b32 s6, 24576
    buffer_store_dwordx4 v[172:175], v10, s[76:79], s6 offen nt
    v_mov_b32 v176, v80
    v_mov_b32 v177, v84
    v_mov_b32 v178, v88
    v_mov_b32 v179, v92
    s_mov_b32 s6, 131072
    buffer_store_dwordx4 v[176:179], v10, s[76:79], s6 offen nt
    v_mov_b32 v180, v81
    v_mov_b32 v181, v85
    v_mov_b32 v182, v89
    v_mov_b32 v183, v93
    s_mov_b32 s6, 139264
    buffer_store_dwordx4 v[180:183], v10, s[76:79], s6 offen nt
    v_mov_b32 v184, v82
    v_mov_b32 v185, v86
    v_mov_b32 v186, v90
    v_mov_b32 v187, v94
    s_mov_b32 s6, 147456
    buffer_store_dwordx4 v[184:187], v10, s[76:79], s6 offen nt
    v_mov_b32 v188, v83
    v_mov_b32 v189, v87
    v_mov_b32 v190, v91
    v_mov_b32 v191, v95
    s_mov_b32 s6, 155648
    buffer_store_dwordx4 v[188:191], v10, s[76:79], s6 offen nt
K_fin:
K_done:
    s_endpgm
C2_zt:
    ds_read_b64_tr_b16 v[144:145], v16 offset:0
    ds_read_b64_tr_b16 v[146:147], v16 offset:8
    ds_read_b64_tr_b16 v[148:149], v16 offset:64
    ds_read_b64_tr_b16 v[150:151], v16 offset:72
    ds_read_b64_tr_b16 v[152:153], v16 offset:512
    ds_read_b64_tr_b16 v[154:155], v16 offset:520
    ds_read_b64_tr_b16 v[156:157], v16 offset:576
    ds_read_b64_tr_b16 v[158:159], v16 offset:584
    s_waitcnt lgkmcnt(0)
    buffer_store_dwordx4 v[144:147], v17, s[80:83], 0 offen offset:0 sc1
    buffer_store_dwordx4 v[148:151], v17, s[80:83], 0 offen offset:1024 sc1
    buffer_store_dwordx4 v[152:155], v17, s[80:83], 0 offen offset:2048 sc1
    buffer_store_dwordx4 v[156:159], v17, s[80:83], 0 offen offset:3072 sc1
    s_branch C2_zt_r
C2_zf:
    s_waitcnt vmcnt(0)
    s_mov_b64 exec, 0xffff
    buffer_store_dwordx2 v[54:55], v18, s[72:75], 0 offen sc1
    s_mov_b64 exec, -1
    s_branch C2_zf_r
.section .rodata,"a"
.p2align 6
.amdhsa_kernel concat_heads__ssm_conv_h3__ssm_conv_s5__prompt_kernel
  .amdhsa_next_free_vgpr 246
  .amdhsa_next_free_sgpr 102
  .amdhsa_accum_offset 248
  .amdhsa_group_segment_fixed_size 0
  .amdhsa_kernarg_size 144
  .amdhsa_user_sgpr_count 2
  .amdhsa_user_sgpr_kernarg_segment_ptr 1
  .amdhsa_system_sgpr_workgroup_id_x 1
.end_amdhsa_kernel
```

```asm
; @launch grid=(256,1,1) block=(512,1,1) lds=163840
.amdgcn_target "amdgcn-amd-amdhsa--gfx950"
.text
.p2align 8
.globl concat_heads__ssm_conv_h3__ssm_conv_s5__prompt_kernel
.type concat_heads__ssm_conv_h3__ssm_conv_s5__prompt_kernel,@function
concat_heads__ssm_conv_h3__ssm_conv_s5__prompt_kernel:
    s_cmp_ge_u32 s2, 256
    s_cbranch_scc1 K_done
    s_load_dwordx16 s[32:47], s[0:1], 0
    s_load_dwordx16 s[48:63], s[0:1], 64
    s_load_dwordx4 s[64:67], s[0:1], 128
    v_lshrrev_b32 v1, 6, v0
    v_and_b32 v2, 63, v0
    s_and_b32 s6, s2, 3
    v_readfirstlane_b32 s5, v1
    s_lshl_b32 s6, s6, 2
    s_lshr_b32 s7, s2, 3
    s_and_b32 s3, s7, 3
    s_add_u32 s3, s3, s6
    s_and_b32 s6, s2, 4
    s_lshl_b32 s6, s6, 1
    s_lshr_b32 s4, s7, 2
    s_add_u32 s4, s4, s6
    s_cmp_lt_u32 s5, 4
    s_cbranch_scc1 K_compute
    s_sub_u32 s6, s5, 4
    v_lshrrev_b32 v12, 3, v2
    v_and_b32 v13, 7, v2
    v_lshrrev_b32 v14, 4, v2
    v_xor_b32 v13, v13, v14
    v_lshlrev_b32 v13, 4, v13
    v_lshrrev_b32 v14, 5, v2
    v_and_b32 v15, 3, v12
    v_lshl_add_u32 v15, v14, 3, v15
    v_lshl_add_u32 v14, v12, 14, v13
    v_lshl_add_u32 v15, v15, 11, v13
    s_lshl_b32 s7, s3, 6
    s_add_u32 s7, s7, s6
    s_lshl_b32 s7, s7, 12
    v_add_u32 v4, s7, v14
    v_xor_b32 v5, 64, v4
    v_add_u32 v5, 0x1fc00, v5
    s_lshl_b32 s7, s4, 2
    s_add_u32 s7, s7, s6
    s_lshl_b32 s7, s7, 15
    v_add_u32 v8, s7, v15
    v_xor_b32 v9, 64, v8
    v_add_u32 v9, 0x1c00, v9
    s_and_b32 s30, s2, 3
    s_lshl_b32 s30, s30, 2
    s_and_b32 s31, s2, 4
    s_lshl_b32 s31, s31, 1
    s_add_u32 s30, s30, s31
    s_add_u32 s31, s3, s4
    s_and_b32 s31, s31, 1
    s_lshl_b32 s31, s31, 1
    s_add_u32 s30, s30, s31
    s_and_b32 s30, s30, 15
    s_lshl_b32 s100, s30, 7
    s_lshl_b32 s101, s6, 12
    s_waitcnt lgkmcnt(0)
    s_mov_b32 s8, s44
    s_mov_b32 s9, s45
    s_mov_b32 s10, 4194304
    s_mov_b32 s11, 0x00020000
    s_mov_b32 s12, s50
    s_mov_b32 s13, s51
    s_mov_b32 s14, 2097152
    s_mov_b32 s15, 0x00020000
    s_mov_b32 s16, s52
    s_mov_b32 s17, s53
    s_mov_b32 s18, 2097152
    s_mov_b32 s19, 0x00020000
    s_mov_b32 s58, s32
    s_mov_b32 s59, s33
    s_lshr_b32 s7, s2, 3
    s_and_b32 s32, s7, 15
    s_lshr_b32 s7, s7, 4
    s_and_b32 s33, s2, 7
    s_lshl_b32 s33, s33, 1
    s_add_u32 s33, s33, s7
    s_lshl_b32 s34, s33, 4
    s_add_u32 s34, s34, s32
    s_lshl_b32 s34, s34, 2
    s_add_u32 s34, s34, s6
    s_lshl_b32 s35, s34, 12
    s_lshr_b32 s7, s34, 1
    s_lshl_b32 s7, s7, 2
    s_load_dword s37, s[42:43], s7
    v_and_b32 v12, 15, v2
    v_lshrrev_b32 v13, 4, v2
    s_mov_b32 s68, s40
    s_mov_b32 s69, s41
    s_mov_b32 s70, 4194304
    s_mov_b32 s71, 0x00020000
    s_add_u32 s76, s66, 17825792
    s_addc_u32 s77, s67, 0
    s_mov_b32 s78, 393216
    s_mov_b32 s79, 0x00020000
    s_mov_b32 s24, s54
    s_mov_b32 s25, s55
    s_mov_b32 s26, 2097152
    s_mov_b32 s27, 0x00020000
    s_mov_b32 s28, s56
    s_mov_b32 s29, s57
    s_mov_b32 s30, 2097152
    s_mov_b32 s31, 0x00020000
    s_mov_b32 s40, s58
    s_mov_b32 s41, s59
    s_mov_b32 s42, 4194304
    s_mov_b32 s43, 0x00020000
    s_cmp_lt_u32 s6, 2
    s_cselect_b32 s52, s54, s56
    s_cselect_b32 s53, s55, s57
    s_mov_b32 s54, 2097152
    s_mov_b32 s55, 0x00020000
    s_waitcnt lgkmcnt(0)
    s_lshl_b32 s45, s6, 14
    v_lshlrev_b32 v16, 4, v13
    v_lshl_add_u32 v16, v12, 1, v16
    v_and_b32 v1, 1, v12
    v_mov_b32 v3, 98308
    v_mov_b32 v14, 102466
    v_cmp_eq_u32 vcc, 1, v1
    s_and_b32 s7, s34, 1
    s_lshl_b32 s7, s7, 4
    v_cndmask_b32 v3, v3, v14, vcc
    v_add3_u32 v16, v16, v3, s45
    v_add_u32 v17, 1024, v16
    v_add_u32 v18, 2048, v16
    v_add_u32 v19, 3072, v16
    s_add_u32 s47, s45, 107104
    v_lshlrev_b32 v1, 4, v13
    v_lshlrev_b32 v3, 5, v12
    v_sub_u32 v1, v1, v3
    v_add_u32 v20, s47, v1
    s_lshr_b32 s37, s37, s7
    s_and_b32 s37, s37, 0xffff
    v_lshlrev_b32 v1, 3, v13
    v_add_u32 v1, v1, v12
    v_sub_u32 v1, 15, v1
    v_and_b32 v3, 1, v1
    v_lshlrev_b32 v3, 4, v3
    v_lshlrev_b32 v3, v3, s37
    v_lshrrev_b32 v1, 1, v1
    v_cmp_eq_u32 vcc, 0, v1
    s_nop 1
    v_cndmask_b32 v24, 0, v3, vcc
    v_cmp_eq_u32 vcc, 1, v1
    s_nop 1
    v_cndmask_b32 v25, 0, v3, vcc
    v_cmp_eq_u32 vcc, 2, v1
    s_nop 1
    v_cndmask_b32 v26, 0, v3, vcc
    v_cmp_eq_u32 vcc, 3, v1
    s_nop 1
    v_cndmask_b32 v27, 0, v3, vcc
    s_add_u32 s7, s45, 106496
    v_lshlrev_b32 v1, 3, v2
    v_add_u32 v21, s7, v1
    v_lshlrev_b32 v10, 4, v2
    v_mov_b32 v7, 147328
    s_lshl_b32 s7, s6, 2
    v_add_u32 v6, s7, v7
    v_mov_b32 v1, 0
    ds_write_b32 v6, v1 offset:48
    ds_write_b32 v6, v1 offset:96
    v_mov_b32 v1, 2
    ds_write_b32 v6, v1 offset:64
    v_lshrrev_b32 v1, 3, v2
    v_and_b32 v3, 7, v2
    v_xor_b32 v3, v3, v13
    v_lshlrev_b32 v3, 4, v3
    v_lshl_add_u32 v3, v1, 13, v3
    s_lshl_b32 s7, s4, 6
    s_add_u32 s7, s7, s6
    s_lshl_b32 s7, s7, 11
    v_add_u32 v246, s7, v3
    v_xor_b32 v247, 64, v246
    v_add_u32 v247, 64512, v247
    v_xor_b32 v248, 32, v246
    v_xor_b32 v249, 32, v247
    s_lshl_b32 s38, s4, 7
    v_lshlrev_b32 v3, 11, v13
    v_lshl_add_u32 v3, v12, 3, v3
    s_lshl_b32 s7, s32, 2
    s_add_u32 s7, s7, s6
    s_lshl_b32 s7, s7, 9
    s_add_u32 s7, s7, s33
    s_lshl_b32 s7, s7, 7
    v_add_u32 v31, s7, v3
    s_lshr_b32 s46, s2, 3
    s_and_b32 s46, s46, 7
    s_lshr_b32 s46, s2, 4
    s_and_b32 s46, s46, 7
    s_add_u32 s7, s3, s4
    s_and_b32 s7, s7, 1
    s_cmp_eq_u32 s7, 0
    s_cselect_b32 s46, s46, 99
    s_lshl_b32 s39, s6, 11
    s_and_b32 s7, s3, 0
    s_lshl_b32 s7, s7, 7
    s_add_u32 s38, s38, s7
    s_and_b32 s20, s38, 1024
    s_xor_b32 s21, s20, 1024
    s_and_b32 s7, s3, 14
    s_and_b32 s47, s6, 1
    s_add_u32 s7, s7, s47
    s_add_u32 s7, s7, s4
    s_and_b32 s7, s7, 15
    s_lshl_b32 s7, s7, 7
    s_lshl_b32 s47, s4, 17
    s_add_u32 s7, s7, s47
    v_lshlrev_b32 v30, 11, v2
    v_add_u32 v30, s7, v30
    s_barrier
    s_add_u32 m0, s101, 98304
    s_nop 0
    buffer_load_dwordx4 v4, s[8:11], s100 offen lds
    buffer_load_dwordx4 v5, s[8:11], s100 offen offset:1024 lds
    buffer_load_dwordx4 v4, s[8:11], s100 offen offset:2048 lds
    buffer_load_dwordx4 v5, s[8:11], s100 offen offset:3072 lds
    s_add_u32 m0, s101, 114688
    s_nop 0
    buffer_load_dwordx4 v8, s[12:15], s100 offen lds
    buffer_load_dwordx4 v9, s[12:15], s100 offen offset:1024 lds
    s_add_u32 m0, s101, 116736
    s_nop 0
    buffer_load_dwordx4 v8, s[16:19], s100 offen lds
    buffer_load_dwordx4 v9, s[16:19], s100 offen offset:1024 lds
    s_add_u32 s100, s100, 128
    s_and_b32 s100, s100, 2047
    s_add_u32 m0, s101, 0
    s_nop 0
    buffer_load_dwordx4 v4, s[8:11], s100 offen lds
    buffer_load_dwordx4 v5, s[8:11], s100 offen offset:1024 lds
    buffer_load_dwordx4 v4, s[8:11], s100 offen offset:2048 lds
    buffer_load_dwordx4 v5, s[8:11], s100 offen offset:3072 lds
    s_add_u32 m0, s101, 16384
    s_nop 0
    buffer_load_dwordx4 v8, s[12:15], s100 offen lds
    buffer_load_dwordx4 v9, s[12:15], s100 offen offset:1024 lds
    s_add_u32 m0, s101, 18432
    s_nop 0
    buffer_load_dwordx4 v8, s[16:19], s100 offen lds
    buffer_load_dwordx4 v9, s[16:19], s100 offen offset:1024 lds
    s_add_u32 s100, s100, 128
    s_and_b32 s100, s100, 2047
    s_add_u32 m0, s101, 32768
    s_nop 0
    buffer_load_dwordx4 v4, s[8:11], s100 offen lds
    buffer_load_dwordx4 v5, s[8:11], s100 offen offset:1024 lds
    buffer_load_dwordx4 v4, s[8:11], s100 offen offset:2048 lds
    buffer_load_dwordx4 v5, s[8:11], s100 offen offset:3072 lds
    s_add_u32 m0, s101, 49152
    s_nop 0
    buffer_load_dwordx4 v8, s[12:15], s100 offen lds
    buffer_load_dwordx4 v9, s[12:15], s100 offen offset:1024 lds
    s_add_u32 m0, s101, 51200
    s_nop 0
    buffer_load_dwordx4 v8, s[16:19], s100 offen lds
    buffer_load_dwordx4 v9, s[16:19], s100 offen offset:1024 lds
    s_add_u32 s100, s100, 128
    s_and_b32 s100, s100, 2047
    s_waitcnt vmcnt(16)
    s_barrier
    s_add_u32 m0, s101, 65536
    s_nop 0
    buffer_load_dwordx4 v4, s[8:11], s100 offen lds
    buffer_load_dwordx4 v5, s[8:11], s100 offen offset:1024 lds
    buffer_load_dwordx4 v4, s[8:11], s100 offen offset:2048 lds
    buffer_load_dwordx4 v5, s[8:11], s100 offen offset:3072 lds
    s_add_u32 m0, s101, 81920
    s_nop 0
    buffer_load_dwordx4 v8, s[12:15], s100 offen lds
    buffer_load_dwordx4 v9, s[12:15], s100 offen offset:1024 lds
    s_add_u32 m0, s101, 83968
    s_nop 0
    buffer_load_dwordx4 v8, s[16:19], s100 offen lds
    buffer_load_dwordx4 v9, s[16:19], s100 offen offset:1024 lds
    s_add_u32 s100, s100, 128
    s_and_b32 s100, s100, 2047
    buffer_load_dwordx4 v[112:115], v10, s[68:71], s35 offen offset:0 nt
    buffer_load_dwordx4 v[116:119], v10, s[68:71], s35 offen offset:1024 nt
    buffer_load_dwordx4 v[120:123], v10, s[68:71], s35 offen offset:2048 nt
    buffer_load_dwordx4 v[124:127], v10, s[68:71], s35 offen offset:3072 nt
    s_waitcnt vmcnt(20) lgkmcnt(0)
    s_barrier
    s_add_u32 m0, s101, 98304
    s_nop 0
    buffer_load_dwordx4 v4, s[8:11], s100 offen lds
    buffer_load_dwordx4 v5, s[8:11], s100 offen offset:1024 lds
    buffer_load_dwordx4 v4, s[8:11], s100 offen offset:2048 lds
    buffer_load_dwordx4 v5, s[8:11], s100 offen offset:3072 lds
    s_waitcnt vmcnt(16)
    s_barrier
    s_add_u32 m0, s101, 114688
    s_nop 0
    buffer_load_dwordx4 v8, s[12:15], s100 offen lds
    buffer_load_dwordx4 v9, s[12:15], s100 offen offset:1024 lds
    s_add_u32 m0, s101, 116736
    s_nop 0
    buffer_load_dwordx4 v8, s[16:19], s100 offen lds
    buffer_load_dwordx4 v9, s[16:19], s100 offen offset:1024 lds
    s_add_u32 s100, s100, 128
    s_and_b32 s100, s100, 2047
    s_add_u32 m0, s101, 0
    s_nop 0
    buffer_load_dwordx4 v4, s[8:11], s100 offen lds
    buffer_load_dwordx4 v5, s[8:11], s100 offen offset:1024 lds
    buffer_load_dwordx4 v4, s[8:11], s100 offen offset:2048 lds
    buffer_load_dwordx4 v5, s[8:11], s100 offen offset:3072 lds
    s_waitcnt vmcnt(16)
    s_barrier
    s_add_u32 m0, s101, 16384
    s_nop 0
    buffer_load_dwordx4 v8, s[12:15], s100 offen lds
    buffer_load_dwordx4 v9, s[12:15], s100 offen offset:1024 lds
    s_add_u32 m0, s101, 18432
    s_nop 0
    buffer_load_dwordx4 v8, s[16:19], s100 offen lds
    buffer_load_dwordx4 v9, s[16:19], s100 offen offset:1024 lds
    s_add_u32 s100, s100, 128
    s_and_b32 s100, s100, 2047
    s_cmp_eq_u32 s46, 0
    s_cbranch_scc0 L_t0
    buffer_load_dword v240, v30, s[52:55], 0 offen
    buffer_load_dword v241, v30, s[52:55], 0 offen offset:64
    L_t0:
    s_add_u32 m0, s101, 32768
    s_nop 0
    buffer_load_dwordx4 v4, s[8:11], s100 offen lds
    buffer_load_dwordx4 v5, s[8:11], s100 offen offset:1024 lds
    buffer_load_dwordx4 v4, s[8:11], s100 offen offset:2048 lds
    buffer_load_dwordx4 v5, s[8:11], s100 offen offset:3072 lds
    s_waitcnt vmcnt(12)
    s_barrier
    s_add_u32 m0, s101, 49152
    s_nop 0
    buffer_load_dwordx4 v8, s[12:15], s100 offen lds
    buffer_load_dwordx4 v9, s[12:15], s100 offen offset:1024 lds
    s_add_u32 m0, s101, 51200
    s_nop 0
    buffer_load_dwordx4 v8, s[16:19], s100 offen lds
    buffer_load_dwordx4 v9, s[16:19], s100 offen offset:1024 lds
    s_add_u32 s100, s100, 128
    s_and_b32 s100, s100, 2047
    s_cmp_eq_u32 s46, 1
    s_cbranch_scc0 L_t1
    buffer_load_dword v240, v30, s[52:55], 0 offen
    buffer_load_dword v241, v30, s[52:55], 0 offen offset:64
    L_t1:
    s_add_u32 m0, s101, 65536
    s_nop 0
    buffer_load_dwordx4 v4, s[8:11], s100 offen lds
    buffer_load_dwordx4 v5, s[8:11], s100 offen offset:1024 lds
    buffer_load_dwordx4 v4, s[8:11], s100 offen offset:2048 lds
    buffer_load_dwordx4 v5, s[8:11], s100 offen offset:3072 lds
    s_waitcnt vmcnt(12)
    s_barrier
    s_add_u32 m0, s101, 81920
    s_nop 0
    buffer_load_dwordx4 v8, s[12:15], s100 offen lds
    buffer_load_dwordx4 v9, s[12:15], s100 offen offset:1024 lds
    s_add_u32 m0, s101, 83968
    s_nop 0
    buffer_load_dwordx4 v8, s[16:19], s100 offen lds
    buffer_load_dwordx4 v9, s[16:19], s100 offen offset:1024 lds
    s_add_u32 s100, s100, 128
    s_and_b32 s100, s100, 2047
    s_cmp_eq_u32 s46, 2
    s_cbranch_scc0 L_t2
    buffer_load_dword v240, v30, s[52:55], 0 offen
    buffer_load_dword v241, v30, s[52:55], 0 offen offset:64
    L_t2:
    s_add_u32 m0, s101, 98304
    s_nop 0
    buffer_load_dwordx4 v4, s[8:11], s100 offen lds
    buffer_load_dwordx4 v5, s[8:11], s100 offen offset:1024 lds
    buffer_load_dwordx4 v4, s[8:11], s100 offen offset:2048 lds
    buffer_load_dwordx4 v5, s[8:11], s100 offen offset:3072 lds
    v_mov_b32 v1, 147328
    ds_read_b64 v[28:29], v1
    s_waitcnt vmcnt(12)
    s_barrier
    s_add_u32 m0, s101, 114688
    s_nop 0
    buffer_load_dwordx4 v8, s[12:15], s100 offen lds
    buffer_load_dwordx4 v9, s[12:15], s100 offen offset:1024 lds
    s_add_u32 m0, s101, 116736
    s_nop 0
    buffer_load_dwordx4 v8, s[16:19], s100 offen lds
    buffer_load_dwordx4 v9, s[16:19], s100 offen offset:1024 lds
    s_add_u32 s100, s100, 128
    s_and_b32 s100, s100, 2047
    s_cmp_eq_u32 s46, 3
    s_cbranch_scc0 L_t3
    buffer_load_dword v240, v30, s[52:55], 0 offen
    buffer_load_dword v241, v30, s[52:55], 0 offen offset:64
    L_t3:
    s_add_u32 m0, s101, 0
    s_nop 0
    buffer_load_dwordx4 v4, s[8:11], s100 offen lds
    buffer_load_dwordx4 v5, s[8:11], s100 offen offset:1024 lds
    buffer_load_dwordx4 v4, s[8:11], s100 offen offset:2048 lds
    buffer_load_dwordx4 v5, s[8:11], s100 offen offset:3072 lds
    s_waitcnt vmcnt(12)
    s_barrier
    s_add_u32 m0, s101, 16384
    s_nop 0
    buffer_load_dwordx4 v8, s[12:15], s100 offen lds
    buffer_load_dwordx4 v9, s[12:15], s100 offen offset:1024 lds
    s_add_u32 m0, s101, 18432
    s_nop 0
    buffer_load_dwordx4 v8, s[16:19], s100 offen lds
    buffer_load_dwordx4 v9, s[16:19], s100 offen offset:1024 lds
    s_add_u32 s100, s100, 128
    s_and_b32 s100, s100, 2047
    s_cmp_eq_u32 s46, 4
    s_cbranch_scc0 L_t4
    buffer_load_dword v240, v30, s[52:55], 0 offen
    buffer_load_dword v241, v30, s[52:55], 0 offen offset:64
    L_t4:
    s_add_u32 m0, s101, 32768
    s_nop 0
    buffer_load_dwordx4 v4, s[8:11], s100 offen lds
    buffer_load_dwordx4 v5, s[8:11], s100 offen offset:1024 lds
    buffer_load_dwordx4 v4, s[8:11], s100 offen offset:2048 lds
    buffer_load_dwordx4 v5, s[8:11], s100 offen offset:3072 lds
    s_waitcnt vmcnt(12)
    s_barrier
    s_add_u32 m0, s101, 49152
    s_nop 0
    buffer_load_dwordx4 v8, s[12:15], s100 offen lds
    buffer_load_dwordx4 v9, s[12:15], s100 offen offset:1024 lds
    s_add_u32 m0, s101, 51200
    s_nop 0
    buffer_load_dwordx4 v8, s[16:19], s100 offen lds
    buffer_load_dwordx4 v9, s[16:19], s100 offen offset:1024 lds
    s_add_u32 s100, s100, 128
    s_and_b32 s100, s100, 2047
    s_cmp_eq_u32 s46, 5
    s_cbranch_scc0 L_t5
    buffer_load_dword v240, v30, s[52:55], 0 offen
    buffer_load_dword v241, v30, s[52:55], 0 offen offset:64
    L_t5:
    s_add_u32 m0, s101, 65536
    s_nop 0
    buffer_load_dwordx4 v4, s[8:11], s100 offen lds
    buffer_load_dwordx4 v5, s[8:11], s100 offen offset:1024 lds
    buffer_load_dwordx4 v4, s[8:11], s100 offen offset:2048 lds
    buffer_load_dwordx4 v5, s[8:11], s100 offen offset:3072 lds
    v_mov_b32 v32, 0
    v_mov_b32 v33, 0
    v_mov_b32 v34, 0
    v_mov_b32 v35, 0
    s_add_u32 s47, s45, 110720
    v_add_u32 v1, s47, v10
    v_and_b32 v3, 16, v10
    v_and_b32 v15, 32, v10
    v_mul_u32_u24 v15, 130, v15
    v_add3_u32 v3, v3, v15, s45
    v_add_u32 v3, 98304, v3
    v_cmp_gt_u32 vcc, 32, v2
    s_add_u32 s47, s45, 98336
    v_add_u32 v15, s47, v10
    v_cndmask_b32 v1, v3, v1, vcc
    v_mov_b32 v64, 0
    s_waitcnt vmcnt(60)
    v_mov_b32_dpp v68, v115 wave_ror:1 row_mask:0xf bank_mask:0xf
    v_mov_b32_dpp v72, v119 wave_ror:1 row_mask:0xf bank_mask:0xf
    v_mov_b32_dpp v76, v123 wave_ror:1 row_mask:0xf bank_mask:0xf
    v_mov_b32_dpp v64, v115 wave_shr:1 row_mask:0xf bank_mask:0xf
    v_mov_b32_dpp v68, v119 wave_shr:1 row_mask:0xf bank_mask:0xf
    v_mov_b32_dpp v72, v123 wave_shr:1 row_mask:0xf bank_mask:0xf
    v_mov_b32_dpp v76, v127 wave_shr:1 row_mask:0xf bank_mask:0xf
    v_alignbit_b32 v64, v112, v64, 16
    v_alignbit_b32 v65, v113, v112, 16
    v_alignbit_b32 v66, v114, v113, 16
    v_alignbit_b32 v67, v115, v114, 16
    v_alignbit_b32 v68, v116, v68, 16
    v_alignbit_b32 v69, v117, v116, 16
    v_alignbit_b32 v70, v118, v117, 16
    v_alignbit_b32 v71, v119, v118, 16
    v_alignbit_b32 v72, v120, v72, 16
    v_alignbit_b32 v73, v121, v120, 16
    v_alignbit_b32 v74, v122, v121, 16
    v_alignbit_b32 v75, v123, v122, 16
    v_alignbit_b32 v76, v124, v76, 16
    v_alignbit_b32 v77, v125, v124, 16
    v_alignbit_b32 v78, v126, v125, 16
    v_alignbit_b32 v79, v127, v126, 16
    s_waitcnt vmcnt(12)
    s_barrier
    s_add_u32 m0, s101, 81920
    s_nop 0
    buffer_load_dwordx4 v8, s[12:15], s100 offen lds
    buffer_load_dwordx4 v9, s[12:15], s100 offen offset:1024 lds
    s_add_u32 m0, s101, 83968
    s_nop 0
    buffer_load_dwordx4 v8, s[16:19], s100 offen lds
    buffer_load_dwordx4 v9, s[16:19], s100 offen offset:1024 lds
    s_add_u32 s100, s100, 128
    s_and_b32 s100, s100, 2047
    s_cmp_eq_u32 s46, 6
    s_cbranch_scc0 L_t6
    buffer_load_dword v240, v30, s[52:55], 0 offen
    buffer_load_dword v241, v30, s[52:55], 0 offen offset:64
    L_t6:
    s_add_u32 m0, s101, 98304
    s_nop 0
    buffer_load_dwordx4 v4, s[8:11], s100 offen lds
    buffer_load_dwordx4 v5, s[8:11], s100 offen offset:1024 lds
    buffer_load_dwordx4 v4, s[8:11], s100 offen offset:2048 lds
    buffer_load_dwordx4 v5, s[8:11], s100 offen offset:3072 lds
    s_waitcnt vmcnt(12)
    s_barrier
    s_add_u32 m0, s101, 114688
    s_nop 0
    buffer_load_dwordx4 v8, s[12:15], s100 offen lds
    buffer_load_dwordx4 v9, s[12:15], s100 offen offset:1024 lds
    s_add_u32 m0, s101, 116736
    s_nop 0
    buffer_load_dwordx4 v8, s[16:19], s100 offen lds
    buffer_load_dwordx4 v9, s[16:19], s100 offen offset:1024 lds
    s_add_u32 s100, s100, 128
    s_and_b32 s100, s100, 2047
    s_cmp_eq_u32 s46, 7
    s_cbranch_scc0 L_t7
    buffer_load_dword v240, v30, s[52:55], 0 offen
    buffer_load_dword v241, v30, s[52:55], 0 offen offset:64
    L_t7:
    s_add_u32 m0, s101, 0
    s_nop 0
    buffer_load_dwordx4 v4, s[8:11], s100 offen lds
    buffer_load_dwordx4 v5, s[8:11], s100 offen offset:1024 lds
    buffer_load_dwordx4 v4, s[8:11], s100 offen offset:2048 lds
    buffer_load_dwordx4 v5, s[8:11], s100 offen offset:3072 lds
    s_waitcnt vmcnt(12)
    s_barrier
    s_add_u32 m0, s101, 16384
    s_nop 0
    buffer_load_dwordx4 v8, s[12:15], s100 offen lds
    buffer_load_dwordx4 v9, s[12:15], s100 offen offset:1024 lds
    s_add_u32 m0, s101, 18432
    s_nop 0
    buffer_load_dwordx4 v8, s[16:19], s100 offen lds
    buffer_load_dwordx4 v9, s[16:19], s100 offen offset:1024 lds
    s_add_u32 s100, s100, 128
    s_and_b32 s100, s100, 2047
    s_add_u32 m0, s101, 32768
    s_nop 0
    buffer_load_dwordx4 v4, s[8:11], s100 offen lds
    buffer_load_dwordx4 v5, s[8:11], s100 offen offset:1024 lds
    buffer_load_dwordx4 v4, s[8:11], s100 offen offset:2048 lds
    buffer_load_dwordx4 v5, s[8:11], s100 offen offset:3072 lds
    s_waitcnt vmcnt(12)
    s_barrier
    s_add_u32 m0, s101, 49152
    s_nop 0
    buffer_load_dwordx4 v8, s[12:15], s100 offen lds
    buffer_load_dwordx4 v9, s[12:15], s100 offen offset:1024 lds
    s_add_u32 m0, s101, 51200
    s_nop 0
    buffer_load_dwordx4 v8, s[16:19], s100 offen lds
    buffer_load_dwordx4 v9, s[16:19], s100 offen offset:1024 lds
    s_add_u32 s100, s100, 128
    s_and_b32 s100, s100, 2047
    s_add_u32 m0, s101, 65536
    s_nop 0
    buffer_load_dwordx4 v4, s[8:11], s100 offen lds
    buffer_load_dwordx4 v5, s[8:11], s100 offen offset:1024 lds
    buffer_load_dwordx4 v4, s[8:11], s100 offen offset:2048 lds
    buffer_load_dwordx4 v5, s[8:11], s100 offen offset:3072 lds
    s_waitcnt vmcnt(12)
    s_barrier
    s_add_u32 m0, s101, 81920
    s_nop 0
    buffer_load_dwordx4 v8, s[12:15], s100 offen lds
    buffer_load_dwordx4 v9, s[12:15], s100 offen offset:1024 lds
    s_add_u32 m0, s101, 83968
    s_nop 0
    buffer_load_dwordx4 v8, s[16:19], s100 offen lds
    buffer_load_dwordx4 v9, s[16:19], s100 offen offset:1024 lds
    s_add_u32 s100, s100, 128
    s_and_b32 s100, s100, 2047
    s_mov_b32 s36, 0
    buffer_load_dwordx2 v[192:193], v31, s[40:43], s36 offen nt
    s_mov_b32 s36, 8192
    buffer_load_dwordx2 v[194:195], v31, s[40:43], s36 offen nt
    s_mov_b32 s36, 16384
    buffer_load_dwordx2 v[196:197], v31, s[40:43], s36 offen nt
    s_mov_b32 s36, 24576
    buffer_load_dwordx2 v[198:199], v31, s[40:43], s36 offen nt
    s_mov_b32 s36, 32768
    buffer_load_dwordx2 v[200:201], v31, s[40:43], s36 offen nt
    s_mov_b32 s36, 40960
    buffer_load_dwordx2 v[202:203], v31, s[40:43], s36 offen nt
    s_mov_b32 s36, 49152
    buffer_load_dwordx2 v[204:205], v31, s[40:43], s36 offen nt
    s_mov_b32 s36, 57344
    buffer_load_dwordx2 v[206:207], v31, s[40:43], s36 offen nt
    s_waitcnt vmcnt(16)
    s_barrier
    s_add_u32 s44, s38, 0
    s_and_b32 s44, s44, 1023
    s_or_b32 s44, s44, s20
    s_add_u32 m0, s39, 0
    s_nop 0
    buffer_load_dwordx4 v246, s[24:27], s44 offen offset:0 lds
    buffer_load_dwordx4 v247, s[24:27], s44 offen offset:1024 lds
    s_add_u32 m0, s39, 8192
    s_nop 0
    buffer_load_dwordx4 v248, s[28:31], s44 offen offset:0 lds
    buffer_load_dwordx4 v249, s[28:31], s44 offen offset:1024 lds
    s_add_u32 s44, s38, 128
    s_and_b32 s44, s44, 1023
    s_or_b32 s44, s44, s20
    s_add_u32 m0, s39, 16384
    s_nop 0
    buffer_load_dwordx4 v246, s[24:27], s44 offen offset:0 lds
    buffer_load_dwordx4 v247, s[24:27], s44 offen offset:1024 lds
    s_add_u32 m0, s39, 24576
    s_nop 0
    buffer_load_dwordx4 v248, s[28:31], s44 offen offset:0 lds
    buffer_load_dwordx4 v249, s[28:31], s44 offen offset:1024 lds
    s_waitcnt vmcnt(16)
    s_barrier
    ds_write_b128 v1, v[32:35]
    ds_write_b128 v15, v[112:115] offset:4160
    ds_write_b128 v15, v[64:67] offset:0
    ds_write_b128 v15, v[116:119] offset:5184
    ds_write_b128 v15, v[68:71] offset:1024
    ds_write_b128 v15, v[120:123] offset:6208
    ds_write_b128 v15, v[72:75] offset:2048
    ds_write_b128 v15, v[124:127] offset:7232
    ds_write_b128 v15, v[76:79] offset:3072
    s_mov_b32 s51, 0
L_g1d:
    ds_read_b128 v[242:245], v7 offset:16
    s_add_u32 s51, s51, 1
    s_waitcnt lgkmcnt(0)
    v_xor_b32 v242, v242, v28
    v_xor_b32 v243, v243, v28
    v_xor_b32 v244, v244, v28
    v_xor_b32 v245, v245, v28
    v_or3_b32 v242, v242, v243, v244
    v_or_b32 v242, v242, v245
    s_cmp_gt_u32 s51, 16384
    s_cbranch_scc1 L_g1d_ok
    v_cmp_ne_u32 vcc, 0, v242
    s_cbranch_vccnz L_g1d
L_g1d_ok:
    ds_read_b128 v[96:99], v20 offset:3584
    ds_read2_b32 v[64:65], v16 offset0:0 offset1:1
    ds_read2_b32 v[66:67], v16 offset0:2 offset1:3
    ds_read_b128 v[100:103], v20 offset:3072
    ds_read2_b32 v[68:69], v16 offset0:128 offset1:129
    ds_read2_b32 v[70:71], v16 offset0:130 offset1:131
    ds_read_b128 v[104:107], v20 offset:2560
    ds_read2_b32 v[72:73], v17 offset0:0 offset1:1
    ds_read2_b32 v[74:75], v17 offset0:2 offset1:3
    ds_read_b128 v[108:111], v20 offset:2048
    ds_read2_b32 v[76:77], v17 offset0:128 offset1:129
    ds_read2_b32 v[78:79], v17 offset0:130 offset1:131
    ds_read_b128 v[112:115], v20 offset:1536
    ds_read2_b32 v[80:81], v18 offset0:0 offset1:1
    ds_read2_b32 v[82:83], v18 offset0:2 offset1:3
    ds_read_b128 v[116:119], v20 offset:1024
    ds_read2_b32 v[84:85], v18 offset0:128 offset1:129
    ds_read2_b32 v[86:87], v18 offset0:130 offset1:131
    ds_read_b128 v[120:123], v20 offset:512
    ds_read2_b32 v[88:89], v19 offset0:0 offset1:1
    ds_read2_b32 v[90:91], v19 offset0:2 offset1:3
    ds_read_b128 v[124:127], v20 offset:0
    ds_read2_b32 v[92:93], v19 offset0:128 offset1:129
    ds_read2_b32 v[94:95], v19 offset0:130 offset1:131
    s_add_u32 s44, s38, 256
    s_and_b32 s44, s44, 1023
    s_or_b32 s44, s44, s20
    s_add_u32 m0, s39, 32768
    s_nop 0
    buffer_load_dwordx4 v246, s[24:27], s44 offen offset:0 lds
    buffer_load_dwordx4 v247, s[24:27], s44 offen offset:1024 lds
    s_add_u32 m0, s39, 40960
    s_nop 0
    buffer_load_dwordx4 v248, s[28:31], s44 offen offset:0 lds
    buffer_load_dwordx4 v249, s[28:31], s44 offen offset:1024 lds
    s_add_u32 s44, s38, 384
    s_and_b32 s44, s44, 1023
    s_or_b32 s44, s44, s20
    s_add_u32 m0, s39, 49152
    s_nop 0
    buffer_load_dwordx4 v246, s[24:27], s44 offen offset:0 lds
    buffer_load_dwordx4 v247, s[24:27], s44 offen offset:1024 lds
    s_add_u32 m0, s39, 57344
    s_nop 0
    buffer_load_dwordx4 v248, s[28:31], s44 offen offset:0 lds
    buffer_load_dwordx4 v249, s[28:31], s44 offen offset:1024 lds
    ds_read_b32 v1, v6 offset:64
    s_waitcnt lgkmcnt(0)
    v_cmp_gt_u32 vcc, 2, v1
    s_cbranch_vccnz L_g0
    L_g0_r:
    s_waitcnt lgkmcnt(0)
    v_mfma_f32_16x16x32_bf16 v[32:35], v[24:27], v[96:99], 0
    v_mfma_f32_16x16x32_bf16 v[36:39], v[24:27], v[100:103], 0
    v_mfma_f32_16x16x32_bf16 v[40:43], v[24:27], v[104:107], 0
    v_mfma_f32_16x16x32_bf16 v[44:47], v[24:27], v[108:111], 0
    v_mfma_f32_16x16x32_bf16 v[48:51], v[24:27], v[112:115], 0
    v_mfma_f32_16x16x32_bf16 v[52:55], v[24:27], v[116:119], 0
    v_mfma_f32_16x16x32_bf16 v[56:59], v[24:27], v[120:123], 0
    v_mfma_f32_16x16x32_bf16 v[60:63], v[24:27], v[124:127], 0
    s_mov_b32 s51, 0
L_conv:
    s_cmp_eq_u32 s51, 2
    s_cbranch_scc1 L_cs4
L_cr0:
    s_waitcnt lgkmcnt(0)
    v_mfma_f32_16x16x32_bf16 v[60:63], v[64:67], v[124:127], v[60:63]
    ds_read_b128 v[160:163], v20 offset:3648
    v_mfma_f32_16x16x32_bf16 v[56:59], v[64:67], v[120:123], v[56:59]
    ds_read2_b32 v[128:129], v16 offset0:16 offset1:17
    v_mfma_f32_16x16x32_bf16 v[52:55], v[64:67], v[116:119], v[52:55]
    ds_read2_b32 v[130:131], v16 offset0:18 offset1:19
    v_mfma_f32_16x16x32_bf16 v[48:51], v[64:67], v[112:115], v[48:51]
    ds_read_b128 v[164:167], v20 offset:3136
    v_mfma_f32_16x16x32_bf16 v[60:63], v[68:71], v[120:123], v[60:63]
    ds_read_b32 v1, v6 offset:64
    v_mfma_f32_16x16x32_bf16 v[56:59], v[68:71], v[116:119], v[56:59]
    ds_read2_b32 v[132:133], v16 offset0:144 offset1:145
    v_mfma_f32_16x16x32_bf16 v[52:55], v[68:71], v[112:115], v[52:55]
    ds_read2_b32 v[134:135], v16 offset0:146 offset1:147
    v_mfma_f32_16x16x32_bf16 v[44:47], v[64:67], v[108:111], v[44:47]
    ds_read_b128 v[168:171], v20 offset:2624
    v_mfma_f32_16x16x32_bf16 v[60:63], v[72:75], v[116:119], v[60:63]
    ds_read2_b32 v[136:137], v17 offset0:16 offset1:17
    v_mfma_f32_16x16x32_bf16 v[56:59], v[72:75], v[112:115], v[56:59]
    ds_read2_b32 v[138:139], v17 offset0:18 offset1:19
    v_mfma_f32_16x16x32_bf16 v[48:51], v[68:71], v[108:111], v[48:51]
    s_waitcnt lgkmcnt(5)
    v_cmp_gt_u32 vcc, 2, v1
    v_mfma_f32_16x16x32_bf16 v[52:55], v[72:75], v[108:111], v[52:55]
    ds_read_b128 v[172:175], v20 offset:2112
    s_cbranch_vccnz L_g1
    L_g1_r:
    v_mfma_f32_16x16x32_bf16 v[60:63], v[76:79], v[112:115], v[60:63]
    ds_read2_b32 v[140:141], v17 offset0:144 offset1:145
    v_mfma_f32_16x16x32_bf16 v[56:59], v[76:79], v[108:111], v[56:59]
    ds_read2_b32 v[142:143], v17 offset0:146 offset1:147
    v_mfma_f32_16x16x32_bf16 v[40:43], v[64:67], v[104:107], v[40:43]
    ds_read_b128 v[176:179], v20 offset:1600
    v_mfma_f32_16x16x32_bf16 v[44:47], v[68:71], v[104:107], v[44:47]
    ds_read2_b32 v[144:145], v18 offset0:16 offset1:17
    v_mfma_f32_16x16x32_bf16 v[60:63], v[80:83], v[108:111], v[60:63]
    ds_read_b32 v1, v6 offset:64
    v_mfma_f32_16x16x32_bf16 v[48:51], v[72:75], v[104:107], v[48:51]
    ds_read2_b32 v[146:147], v18 offset0:18 offset1:19
    v_mfma_f32_16x16x32_bf16 v[52:55], v[76:79], v[104:107], v[52:55]
    ds_read_b128 v[180:183], v20 offset:1088
    v_mfma_f32_16x16x32_bf16 v[56:59], v[80:83], v[104:107], v[56:59]
    ds_read2_b32 v[148:149], v18 offset0:144 offset1:145
    v_mfma_f32_16x16x32_bf16 v[60:63], v[84:87], v[104:107], v[60:63]
    ds_read2_b32 v[150:151], v18 offset0:146 offset1:147
    v_mfma_f32_16x16x32_bf16 v[36:39], v[64:67], v[100:103], v[36:39]
    ds_read_b128 v[184:187], v20 offset:576
    v_mfma_f32_16x16x32_bf16 v[40:43], v[68:71], v[100:103], v[40:43]
    s_waitcnt lgkmcnt(5)
    v_cmp_gt_u32 vcc, 2, v1
    v_mfma_f32_16x16x32_bf16 v[44:47], v[72:75], v[100:103], v[44:47]
    ds_read2_b32 v[152:153], v19 offset0:16 offset1:17
    s_cbranch_vccnz L_g2
    L_g2_r:
    v_mfma_f32_16x16x32_bf16 v[48:51], v[76:79], v[100:103], v[48:51]
    ds_read2_b32 v[154:155], v19 offset0:18 offset1:19
    v_mfma_f32_16x16x32_bf16 v[52:55], v[80:83], v[100:103], v[52:55]
    ds_read_b128 v[188:191], v20 offset:64
    v_mfma_f32_16x16x32_bf16 v[56:59], v[84:87], v[100:103], v[56:59]
    ds_read2_b32 v[156:157], v19 offset0:144 offset1:145
    v_mfma_f32_16x16x32_bf16 v[60:63], v[88:91], v[100:103], v[60:63]
    ds_read2_b32 v[158:159], v19 offset0:146 offset1:147
    v_mfma_f32_16x16x32_bf16 v[32:35], v[64:67], v[96:99], v[32:35]
    ds_read_b32 v1, v6 offset:64
    v_mfma_f32_16x16x32_bf16 v[36:39], v[68:71], v[96:99], v[36:39]
    v_mfma_f32_16x16x32_bf16 v[40:43], v[72:75], v[96:99], v[40:43]
    v_mfma_f32_16x16x32_bf16 v[44:47], v[76:79], v[96:99], v[44:47]
    v_mfma_f32_16x16x32_bf16 v[48:51], v[80:83], v[96:99], v[48:51]
    v_mfma_f32_16x16x32_bf16 v[52:55], v[84:87], v[96:99], v[52:55]
    v_mfma_f32_16x16x32_bf16 v[56:59], v[88:91], v[96:99], v[56:59]
    s_waitcnt lgkmcnt(0)
    v_cmp_gt_u32 vcc, 2, v1
    v_mfma_f32_16x16x32_bf16 v[60:63], v[92:95], v[96:99], v[60:63]
    s_cbranch_vccnz L_g3
    L_g3_r:
    s_cmp_eq_u32 s51, 0
    s_cbranch_scc1 L_cs1
L_cr1:
    s_waitcnt lgkmcnt(0)
    v_mfma_f32_16x16x32_bf16 v[60:63], v[128:131], v[188:191], v[60:63]
    ds_read_b128 v[96:99], v20 offset:3712
    v_mfma_f32_16x16x32_bf16 v[56:59], v[128:131], v[184:187], v[56:59]
    ds_read2_b32 v[64:65], v16 offset0:32 offset1:33
    v_mfma_f32_16x16x32_bf16 v[52:55], v[128:131], v[180:183], v[52:55]
    ds_read2_b32 v[66:67], v16 offset0:34 offset1:35
    v_mfma_f32_16x16x32_bf16 v[48:51], v[128:131], v[176:179], v[48:51]
    ds_read_b128 v[100:103], v20 offset:3200
    v_mfma_f32_16x16x32_bf16 v[60:63], v[132:135], v[184:187], v[60:63]
    ds_read_b32 v1, v6 offset:64
    v_mfma_f32_16x16x32_bf16 v[56:59], v[132:135], v[180:183], v[56:59]
    ds_read2_b32 v[68:69], v16 offset0:160 offset1:161
    v_mfma_f32_16x16x32_bf16 v[52:55], v[132:135], v[176:179], v[52:55]
    ds_read2_b32 v[70:71], v16 offset0:162 offset1:163
    v_mfma_f32_16x16x32_bf16 v[44:47], v[128:131], v[172:175], v[44:47]
    ds_read_b128 v[104:107], v20 offset:2688
    v_mfma_f32_16x16x32_bf16 v[60:63], v[136:139], v[180:183], v[60:63]
    ds_read2_b32 v[72:73], v17 offset0:32 offset1:33
    v_mfma_f32_16x16x32_bf16 v[56:59], v[136:139], v[176:179], v[56:59]
    ds_read2_b32 v[74:75], v17 offset0:34 offset1:35
    v_mfma_f32_16x16x32_bf16 v[48:51], v[132:135], v[172:175], v[48:51]
    s_waitcnt lgkmcnt(5)
    v_cmp_gt_u32 vcc, 2, v1
    v_mfma_f32_16x16x32_bf16 v[52:55], v[136:139], v[172:175], v[52:55]
    ds_read_b128 v[108:111], v20 offset:2176
    s_cbranch_vccnz L_g4
    L_g4_r:
    v_mfma_f32_16x16x32_bf16 v[60:63], v[140:143], v[176:179], v[60:63]
    ds_read2_b32 v[76:77], v17 offset0:160 offset1:161
    v_mfma_f32_16x16x32_bf16 v[56:59], v[140:143], v[172:175], v[56:59]
    ds_read2_b32 v[78:79], v17 offset0:162 offset1:163
    v_mfma_f32_16x16x32_bf16 v[40:43], v[128:131], v[168:171], v[40:43]
    ds_read_b128 v[112:115], v20 offset:1664
    v_mfma_f32_16x16x32_bf16 v[44:47], v[132:135], v[168:171], v[44:47]
    ds_read2_b32 v[80:81], v18 offset0:32 offset1:33
    v_mfma_f32_16x16x32_bf16 v[60:63], v[144:147], v[172:175], v[60:63]
    ds_read_b32 v1, v6 offset:64
    v_mfma_f32_16x16x32_bf16 v[48:51], v[136:139], v[168:171], v[48:51]
    ds_read2_b32 v[82:83], v18 offset0:34 offset1:35
    v_mfma_f32_16x16x32_bf16 v[52:55], v[140:143], v[168:171], v[52:55]
    ds_read_b128 v[116:119], v20 offset:1152
    v_mfma_f32_16x16x32_bf16 v[56:59], v[144:147], v[168:171], v[56:59]
    ds_read2_b32 v[84:85], v18 offset0:160 offset1:161
    v_mfma_f32_16x16x32_bf16 v[60:63], v[148:151], v[168:171], v[60:63]
    ds_read2_b32 v[86:87], v18 offset0:162 offset1:163
    v_mfma_f32_16x16x32_bf16 v[36:39], v[128:131], v[164:167], v[36:39]
    ds_read_b128 v[120:123], v20 offset:640
    v_mfma_f32_16x16x32_bf16 v[40:43], v[132:135], v[164:167], v[40:43]
    s_waitcnt lgkmcnt(5)
    v_cmp_gt_u32 vcc, 2, v1
    v_mfma_f32_16x16x32_bf16 v[44:47], v[136:139], v[164:167], v[44:47]
    ds_read2_b32 v[88:89], v19 offset0:32 offset1:33
    s_cbranch_vccnz L_g5
    L_g5_r:
    v_mfma_f32_16x16x32_bf16 v[48:51], v[140:143], v[164:167], v[48:51]
    ds_read2_b32 v[90:91], v19 offset0:34 offset1:35
    v_mfma_f32_16x16x32_bf16 v[52:55], v[144:147], v[164:167], v[52:55]
    ds_read_b128 v[124:127], v20 offset:128
    v_mfma_f32_16x16x32_bf16 v[56:59], v[148:151], v[164:167], v[56:59]
    ds_read2_b32 v[92:93], v19 offset0:160 offset1:161
    v_mfma_f32_16x16x32_bf16 v[60:63], v[152:155], v[164:167], v[60:63]
    ds_read2_b32 v[94:95], v19 offset0:162 offset1:163
    v_mfma_f32_16x16x32_bf16 v[32:35], v[128:131], v[160:163], v[32:35]
    ds_read_b32 v1, v6 offset:64
    v_mfma_f32_16x16x32_bf16 v[36:39], v[132:135], v[160:163], v[36:39]
    v_add_u32 v16, 128, v16
    v_mfma_f32_16x16x32_bf16 v[40:43], v[136:139], v[160:163], v[40:43]
    v_add_u32 v17, 128, v17
    v_mfma_f32_16x16x32_bf16 v[44:47], v[140:143], v[160:163], v[44:47]
    v_add_u32 v18, 128, v18
    v_mfma_f32_16x16x32_bf16 v[48:51], v[144:147], v[160:163], v[48:51]
    v_add_u32 v19, 128, v19
    v_mfma_f32_16x16x32_bf16 v[52:55], v[148:151], v[160:163], v[52:55]
    v_add_u32 v20, 128, v20
    v_mfma_f32_16x16x32_bf16 v[56:59], v[152:155], v[160:163], v[56:59]
    s_waitcnt lgkmcnt(0)
    v_cmp_gt_u32 vcc, 2, v1
    v_mfma_f32_16x16x32_bf16 v[60:63], v[156:159], v[160:163], v[60:63]
    s_cbranch_vccnz L_g6
    L_g6_r:
    s_add_u32 s51, s51, 1
    s_cmp_lt_u32 s51, 4
    s_cbranch_scc1 L_conv
    s_waitcnt lgkmcnt(0)
    s_nop 6
    v_cvt_pk_bf16_f32 v32, v32, v33
    v_cvt_pk_bf16_f32 v33, v34, v35
    ds_write_b64 v21, v[32:33] offset:0
    v_cvt_pk_bf16_f32 v34, v36, v37
    v_cvt_pk_bf16_f32 v35, v38, v39
    ds_write_b64 v21, v[34:35] offset:512
    v_cvt_pk_bf16_f32 v36, v40, v41
    v_cvt_pk_bf16_f32 v37, v42, v43
    ds_write_b64 v21, v[36:37] offset:1024
    v_cvt_pk_bf16_f32 v38, v44, v45
    v_cvt_pk_bf16_f32 v39, v46, v47
    ds_write_b64 v21, v[38:39] offset:1536
    v_cvt_pk_bf16_f32 v40, v48, v49
    v_cvt_pk_bf16_f32 v41, v50, v51
    ds_write_b64 v21, v[40:41] offset:2048
    v_cvt_pk_bf16_f32 v42, v52, v53
    v_cvt_pk_bf16_f32 v43, v54, v55
    ds_write_b64 v21, v[42:43] offset:2560
    v_cvt_pk_bf16_f32 v44, v56, v57
    v_cvt_pk_bf16_f32 v45, v58, v59
    ds_write_b64 v21, v[44:45] offset:3072
    v_cvt_pk_bf16_f32 v46, v60, v61
    v_cvt_pk_bf16_f32 v47, v62, v63
    ds_write_b64 v21, v[46:47] offset:3584
    ds_write_b32 v6, v28 offset:80
    s_add_u32 s8, s66, 4194304
    s_addc_u32 s9, s67, 0
    s_mov_b32 s10, 4194304
    s_mov_b32 s11, 0x00020000
    s_mov_b32 s12, s62
    s_mov_b32 s13, s63
    s_mov_b32 s14, 16777216
    s_mov_b32 s15, 0x00020000
    s_lshr_b32 s7, s32, 2
    s_lshl_b32 s7, s7, 4
    s_add_u32 s7, s7, s33
    s_lshl_b32 s7, s7, 11
    s_add_u32 s7, s7, 262144
    v_lshlrev_b32 v1, 7, v12
    v_add_u32 v16, s7, v1
    v_xor_b32 v1, v12, v13
    v_lshlrev_b32 v1, 4, v1
    v_lshl_add_u32 v3, v13, 14, v1
    s_lshl_b32 s47, s32, 2
    s_add_u32 s47, s47, s6
    s_lshl_b32 s7, s33, 10
    s_add_u32 s7, s7, s47
    s_lshl_b32 s7, s7, 8
    v_add_u32 v17, s7, v3
    v_xor_b32 v18, 64, v17
    v_add_u32 v18, 64512, v18
    v_xor_b32 v19, 128, v17
    v_add_u32 v19, 129024, v19
    v_xor_b32 v20, 192, v17
    v_add_u32 v20, 193536, v20
    s_add_u32 s35, s45, 98304
    v_lshl_add_u32 v1, v12, 8, v1
    v_add_u32 v24, s35, v1
    v_xor_b32 v25, 64, v24
    v_xor_b32 v26, 128, v24
    v_xor_b32 v27, 192, v24
    s_lshl_b32 s47, s47, 10
    s_add_u32 s47, s47, s33
    s_lshl_b32 s47, s47, 8
    v_lshlrev_b32 v1, 13, v13
    v_lshl_add_u32 v1, v12, 4, v1
    v_add_u32 v21, s47, v1
    v_bfe_u32 v1, v2, 2, 2
    v_lshlrev_b32 v1, 14, v1
    v_and_b32 v3, 3, v2
    v_lshl_add_u32 v1, v3, 7, v1
    v_lshl_add_u32 v1, v13, 4, v1
    s_lshl_b32 s7, s6, 10
    s_add_u32 s7, s7, 106496
    v_add_u32 v4, s7, v1
    s_lshl_b32 s7, s34, 12
    v_add_u32 v5, s7, v10
    s_lshr_b32 s47, s34, 2
    s_lshl_b32 s7, s6, 8
    s_add_u32 s7, s7, s47
    s_lshl_b32 s7, s7, 7
    s_add_u32 s7, s7, 262144
    v_lshl_add_u32 v8, v12, 3, s7
    v_add_u32 v9, s39, v10
    v_add_u32 v11, 0xc000, v9
    s_mov_b32 s51, 0
L_zd:
    ds_read_b128 v[44:47], v7 offset:80
    s_add_u32 s51, s51, 1
    s_waitcnt lgkmcnt(0)
    v_xor_b32 v44, v44, v28
    v_xor_b32 v45, v45, v28
    v_xor_b32 v46, v46, v28
    v_xor_b32 v47, v47, v28
    v_or3_b32 v44, v44, v45, v46
    v_or_b32 v44, v44, v47
    s_cmp_gt_u32 s51, 16384
    s_cbranch_scc1 L_zd_ok
    v_cmp_ne_u32 vcc, 0, v44
    s_cbranch_vccnz L_zd
L_zd_ok:
    ds_read_b64_tr_b16 v[44:45], v4 offset:0
    ds_read_b64_tr_b16 v[46:47], v4 offset:8
    ds_read_b64_tr_b16 v[48:49], v4 offset:64
    ds_read_b64_tr_b16 v[50:51], v4 offset:72
    ds_read_b64_tr_b16 v[52:53], v4 offset:512
    ds_read_b64_tr_b16 v[54:55], v4 offset:520
    ds_read_b64_tr_b16 v[56:57], v4 offset:576
    ds_read_b64_tr_b16 v[58:59], v4 offset:584
    s_waitcnt lgkmcnt(0)
    buffer_store_dwordx4 v[44:47], v5, s[8:11], 0 offen offset:0 sc1
    buffer_store_dwordx4 v[48:51], v5, s[8:11], 0 offen offset:1024 sc1
    buffer_store_dwordx4 v[52:55], v5, s[8:11], 0 offen offset:2048 sc1
    buffer_store_dwordx4 v[56:59], v5, s[8:11], 0 offen offset:3072 sc1
    s_waitcnt vmcnt(23)
    s_add_u32 s44, s38, 1408
    s_and_b32 s44, s44, 1023
    s_or_b32 s44, s44, s21
    buffer_load_dwordx4 v[208:211], v246, s[24:27], s44 offen offset:0
    s_waitcnt vmcnt(23)
    buffer_load_dwordx4 v[212:215], v247, s[24:27], s44 offen offset:1024
    s_waitcnt vmcnt(23)
    buffer_load_dwordx4 v[216:219], v248, s[28:31], s44 offen offset:0
    s_waitcnt vmcnt(23)
    buffer_load_dwordx4 v[220:223], v249, s[28:31], s44 offen offset:1024
    s_waitcnt vmcnt(23)
    s_add_u32 s44, s38, 1536
    s_and_b32 s44, s44, 1023
    s_or_b32 s44, s44, s21
    buffer_load_dwordx4 v[224:227], v246, s[24:27], s44 offen offset:0
    s_waitcnt vmcnt(23)
    buffer_load_dwordx4 v[228:231], v247, s[24:27], s44 offen offset:1024
    s_waitcnt vmcnt(23)
    buffer_load_dwordx4 v[232:235], v248, s[28:31], s44 offen offset:0
    s_waitcnt vmcnt(23)
    buffer_load_dwordx4 v[236:239], v249, s[28:31], s44 offen offset:1024
    s_waitcnt vmcnt(8)
    s_mov_b64 exec, 0xffff
    buffer_store_dwordx2 v[28:29], v8, s[76:79], 0 offen sc1
    s_mov_b64 exec, -1
    s_mov_b32 s51, 0
L_p1:
    ds_read_b128 v[32:35], v7 offset:96
    s_add_u32 s51, s51, 1
    s_waitcnt lgkmcnt(0)
    v_min3_u32 v32, v32, v33, v34
    v_min_u32 v32, v32, v35
    s_cmp_gt_u32 s51, 65536
    s_cbranch_scc1 L_p1_ok
    v_cmp_gt_u32 vcc, 1, v32
    s_cbranch_vccnz L_p1
L_p1_ok:
    s_waitcnt vmcnt(23)
    s_add_u32 s44, s38, 1664
    s_and_b32 s44, s44, 1023
    s_or_b32 s44, s44, s21
    buffer_load_dwordx4 v[64:67], v246, s[24:27], s44 offen offset:0
    s_waitcnt vmcnt(23)
    buffer_load_dwordx4 v[68:71], v247, s[24:27], s44 offen offset:1024
    s_waitcnt vmcnt(23)
    buffer_load_dwordx4 v[72:75], v248, s[28:31], s44 offen offset:0
    s_waitcnt vmcnt(23)
    buffer_load_dwordx4 v[76:79], v249, s[28:31], s44 offen offset:1024
    s_mov_b32 s51, 0
L_p2:
    ds_read_b128 v[32:35], v7 offset:96
    s_add_u32 s51, s51, 1
    s_waitcnt lgkmcnt(0)
    v_min3_u32 v32, v32, v33, v34
    v_min_u32 v32, v32, v35
    s_cmp_gt_u32 s51, 65536
    s_cbranch_scc1 L_p2_ok
    v_cmp_gt_u32 vcc, 2, v32
    s_cbranch_vccnz L_p2
L_p2_ok:
    s_waitcnt vmcnt(23)
    s_add_u32 s44, s38, 1792
    s_and_b32 s44, s44, 1023
    s_or_b32 s44, s44, s21
    buffer_load_dwordx4 v[80:83], v246, s[24:27], s44 offen offset:0
    s_waitcnt vmcnt(23)
    buffer_load_dwordx4 v[84:87], v247, s[24:27], s44 offen offset:1024
    s_waitcnt vmcnt(23)
    buffer_load_dwordx4 v[88:91], v248, s[28:31], s44 offen offset:0
    s_waitcnt vmcnt(23)
    buffer_load_dwordx4 v[92:95], v249, s[28:31], s44 offen offset:1024
    s_mov_b32 s51, 0
L_p3:
    ds_read_b128 v[32:35], v7 offset:96
    s_add_u32 s51, s51, 1
    s_waitcnt lgkmcnt(0)
    v_min3_u32 v32, v32, v33, v34
    v_min_u32 v32, v32, v35
    s_cmp_gt_u32 s51, 65536
    s_cbranch_scc1 L_p3_ok
    v_cmp_gt_u32 vcc, 3, v32
    s_cbranch_vccnz L_p3
L_p3_ok:
    s_waitcnt vmcnt(23)
    s_add_u32 s44, s38, 1920
    s_and_b32 s44, s44, 1023
    s_or_b32 s44, s44, s21
    buffer_load_dwordx4 v[96:99], v246, s[24:27], s44 offen offset:0
    s_waitcnt vmcnt(23)
    buffer_load_dwordx4 v[100:103], v247, s[24:27], s44 offen offset:1024
    s_waitcnt vmcnt(23)
    buffer_load_dwordx4 v[104:107], v248, s[28:31], s44 offen offset:0
    s_waitcnt vmcnt(23)
    buffer_load_dwordx4 v[108:111], v249, s[28:31], s44 offen offset:1024
    s_mov_b32 s51, 0
L_p6:
    ds_read_b128 v[32:35], v7 offset:96
    s_add_u32 s51, s51, 1
    s_waitcnt lgkmcnt(0)
    v_min3_u32 v32, v32, v33, v34
    v_min_u32 v32, v32, v35
    s_cmp_gt_u32 s51, 65536
    s_cbranch_scc1 L_p6_ok
    v_cmp_gt_u32 vcc, 6, v32
    s_cbranch_vccnz L_p6
L_p6_ok:
    v_mov_b32 v3, 12
    s_waitcnt vmcnt(17)
    ds_write_b128 v11, v[208:211] offset:32768
    ds_write_b128 v11, v[212:215] offset:33792
    ds_write_b128 v11, v[216:219] offset:40960
    ds_write_b128 v11, v[220:223] offset:41984
    ds_write_b32 v6, v3 offset:48
    buffer_load_dwordx2 v[22:23], v16, s[76:79], 0 offen sc1
    s_mov_b32 s51, 0
L_p7:
    ds_read_b128 v[32:35], v7 offset:96
    s_add_u32 s51, s51, 1
    s_waitcnt lgkmcnt(0)
    v_min3_u32 v32, v32, v33, v34
    v_min_u32 v32, v32, v35
    s_cmp_gt_u32 s51, 65536
    s_cbranch_scc1 L_p7_ok
    v_cmp_gt_u32 vcc, 7, v32
    s_cbranch_vccnz L_p7
L_p7_ok:
    v_mov_b32 v3, 13
    s_waitcnt vmcnt(14)
    ds_write_b128 v9, v[224:227] offset:0
    ds_write_b128 v9, v[228:231] offset:1024
    ds_write_b128 v9, v[232:235] offset:8192
    ds_write_b128 v9, v[236:239] offset:9216
    ds_write_b32 v6, v3 offset:48
    s_mov_b32 s51, 0
L_p8:
    ds_read_b128 v[32:35], v7 offset:96
    s_add_u32 s51, s51, 1
    s_waitcnt lgkmcnt(0)
    v_min3_u32 v32, v32, v33, v34
    v_min_u32 v32, v32, v35
    s_cmp_gt_u32 s51, 65536
    s_cbranch_scc1 L_p8_ok
    v_cmp_gt_u32 vcc, 8, v32
    s_cbranch_vccnz L_p8
L_p8_ok:
    v_mov_b32 v3, 14
    s_waitcnt vmcnt(9)
    ds_write_b128 v9, v[64:67] offset:16384
    ds_write_b128 v9, v[68:71] offset:17408
    ds_write_b128 v9, v[72:75] offset:24576
    ds_write_b128 v9, v[76:79] offset:25600
    ds_write_b32 v6, v3 offset:48
    s_waitcnt vmcnt(0)
    v_cmp_eq_u32 vcc, v22, v28
    v_cmp_eq_u32 s[48:49], v23, v29
    s_mov_b32 m0, s35
    s_and_b64 s[48:49], s[48:49], vcc
    s_cmp_eq_u64 s[48:49], -1
    s_cbranch_scc1 L_zspin_go
    s_mov_b32 s51, 0
L_zspin:
    buffer_load_dwordx2 v[22:23], v16, s[76:79], 0 offen sc1
    s_add_u32 s51, s51, 1
    s_waitcnt vmcnt(0)
    v_cmp_eq_u32 vcc, v22, v28
    v_cmp_eq_u32 s[48:49], v23, v29
    s_cmp_gt_u32 s51, 4096
    s_cbranch_scc1 L_zspin_go
    s_and_b64 s[48:49], s[48:49], vcc
    s_cmp_eq_u64 s[48:49], -1
    s_cbranch_scc0 L_zspin
L_zspin_go:
    buffer_load_dwordx4 v17, s[8:11], 0 offen offset:0 sc1 lds
    buffer_load_dwordx4 v18, s[8:11], 0 offen offset:1024 sc1 lds
    buffer_load_dwordx4 v19, s[8:11], 0 offen offset:2048 sc1 lds
    buffer_load_dwordx4 v20, s[8:11], 0 offen offset:3072 sc1 lds
    s_mov_b32 s51, 0
L_p9:
    ds_read_b128 v[32:35], v7 offset:96
    s_add_u32 s51, s51, 1
    s_waitcnt lgkmcnt(0)
    v_min3_u32 v32, v32, v33, v34
    v_min_u32 v32, v32, v35
    s_cmp_gt_u32 s51, 65536
    s_cbranch_scc1 L_p9_ok
    v_cmp_gt_u32 vcc, 9, v32
    s_cbranch_vccnz L_p9
L_p9_ok:
    v_mov_b32 v3, 15
    s_waitcnt vmcnt(9)
    ds_write_b128 v9, v[80:83] offset:32768
    ds_write_b128 v9, v[84:87] offset:33792
    ds_write_b128 v9, v[88:91] offset:40960
    ds_write_b128 v9, v[92:95] offset:41984
    ds_write_b32 v6, v3 offset:48
    s_mov_b32 s51, 0
L_p10:
    ds_read_b128 v[32:35], v7 offset:96
    s_add_u32 s51, s51, 1
    s_waitcnt lgkmcnt(0)
    v_min3_u32 v32, v32, v33, v34
    v_min_u32 v32, v32, v35
    s_cmp_gt_u32 s51, 65536
    s_cbranch_scc1 L_p10_ok
    v_cmp_gt_u32 vcc, 10, v32
    s_cbranch_vccnz L_p10
L_p10_ok:
    v_mov_b32 v3, 16
    s_waitcnt vmcnt(5)
    ds_write_b128 v11, v[96:99] offset:0
    ds_write_b128 v11, v[100:103] offset:1024
    ds_write_b128 v11, v[104:107] offset:8192
    ds_write_b128 v11, v[108:111] offset:9216
    ds_write_b32 v6, v3 offset:48
    s_waitcnt vmcnt(0) lgkmcnt(0)
    ds_read_b128 v[44:47], v24
    ds_read_b128 v[48:51], v25
    ds_read_b128 v[52:55], v26
    ds_read_b128 v[56:59], v27
    s_waitcnt lgkmcnt(3)
    v_lshlrev_b32 v1, 16, v44
    v_lshlrev_b32 v36, 16, v192
    v_mul_f32 v36, v36, v1
    v_and_b32 v1, 0xffff0000, v44
    v_and_b32 v37, 0xffff0000, v192
    v_mul_f32 v37, v37, v1
    v_lshlrev_b32 v1, 16, v45
    v_lshlrev_b32 v38, 16, v193
    v_mul_f32 v38, v38, v1
    v_and_b32 v1, 0xffff0000, v45
    v_and_b32 v39, 0xffff0000, v193
    v_mul_f32 v39, v39, v1
    s_mov_b32 s7, 0
    buffer_store_dwordx4 v[36:39], v21, s[12:15], s7 offen nt
    v_lshlrev_b32 v1, 16, v46
    v_lshlrev_b32 v40, 16, v200
    v_mul_f32 v40, v40, v1
    v_and_b32 v1, 0xffff0000, v46
    v_and_b32 v41, 0xffff0000, v200
    v_mul_f32 v41, v41, v1
    v_lshlrev_b32 v1, 16, v47
    v_lshlrev_b32 v42, 16, v201
    v_mul_f32 v42, v42, v1
    v_and_b32 v1, 0xffff0000, v47
    v_and_b32 v43, 0xffff0000, v201
    v_mul_f32 v43, v43, v1
    s_mov_b32 s7, 131072
    buffer_store_dwordx4 v[40:43], v21, s[12:15], s7 offen nt
    s_waitcnt lgkmcnt(2)
    v_lshlrev_b32 v1, 16, v48
    v_lshlrev_b32 v36, 16, v194
    v_mul_f32 v36, v36, v1
    v_and_b32 v1, 0xffff0000, v48
    v_and_b32 v37, 0xffff0000, v194
    v_mul_f32 v37, v37, v1
    v_lshlrev_b32 v1, 16, v49
    v_lshlrev_b32 v38, 16, v195
    v_mul_f32 v38, v38, v1
    v_and_b32 v1, 0xffff0000, v49
    v_and_b32 v39, 0xffff0000, v195
    v_mul_f32 v39, v39, v1
    s_mov_b32 s7, 32768
    buffer_store_dwordx4 v[36:39], v21, s[12:15], s7 offen nt
    v_lshlrev_b32 v1, 16, v50
    v_lshlrev_b32 v40, 16, v202
    v_mul_f32 v40, v40, v1
    v_and_b32 v1, 0xffff0000, v50
    v_and_b32 v41, 0xffff0000, v202
    v_mul_f32 v41, v41, v1
    v_lshlrev_b32 v1, 16, v51
    v_lshlrev_b32 v42, 16, v203
    v_mul_f32 v42, v42, v1
    v_and_b32 v1, 0xffff0000, v51
    v_and_b32 v43, 0xffff0000, v203
    v_mul_f32 v43, v43, v1
    s_mov_b32 s7, 163840
    buffer_store_dwordx4 v[40:43], v21, s[12:15], s7 offen nt
    s_waitcnt lgkmcnt(1)
    v_lshlrev_b32 v1, 16, v52
    v_lshlrev_b32 v36, 16, v196
    v_mul_f32 v36, v36, v1
    v_and_b32 v1, 0xffff0000, v52
    v_and_b32 v37, 0xffff0000, v196
    v_mul_f32 v37, v37, v1
    v_lshlrev_b32 v1, 16, v53
    v_lshlrev_b32 v38, 16, v197
    v_mul_f32 v38, v38, v1
    v_and_b32 v1, 0xffff0000, v53
    v_and_b32 v39, 0xffff0000, v197
    v_mul_f32 v39, v39, v1
    s_mov_b32 s7, 65536
    buffer_store_dwordx4 v[36:39], v21, s[12:15], s7 offen nt
    v_lshlrev_b32 v1, 16, v54
    v_lshlrev_b32 v40, 16, v204
    v_mul_f32 v40, v40, v1
    v_and_b32 v1, 0xffff0000, v54
    v_and_b32 v41, 0xffff0000, v204
    v_mul_f32 v41, v41, v1
    v_lshlrev_b32 v1, 16, v55
    v_lshlrev_b32 v42, 16, v205
    v_mul_f32 v42, v42, v1
    v_and_b32 v1, 0xffff0000, v55
    v_and_b32 v43, 0xffff0000, v205
    v_mul_f32 v43, v43, v1
    s_mov_b32 s7, 196608
    buffer_store_dwordx4 v[40:43], v21, s[12:15], s7 offen nt
    s_waitcnt lgkmcnt(0)
    v_lshlrev_b32 v1, 16, v56
    v_lshlrev_b32 v36, 16, v198
    v_mul_f32 v36, v36, v1
    v_and_b32 v1, 0xffff0000, v56
    v_and_b32 v37, 0xffff0000, v198
    v_mul_f32 v37, v37, v1
    v_lshlrev_b32 v1, 16, v57
    v_lshlrev_b32 v38, 16, v199
    v_mul_f32 v38, v38, v1
    v_and_b32 v1, 0xffff0000, v57
    v_and_b32 v39, 0xffff0000, v199
    v_mul_f32 v39, v39, v1
    s_mov_b32 s7, 98304
    buffer_store_dwordx4 v[36:39], v21, s[12:15], s7 offen nt
    v_lshlrev_b32 v1, 16, v58
    v_lshlrev_b32 v40, 16, v206
    v_mul_f32 v40, v40, v1
    v_and_b32 v1, 0xffff0000, v58
    v_and_b32 v41, 0xffff0000, v206
    v_mul_f32 v41, v41, v1
    v_lshlrev_b32 v1, 16, v59
    v_lshlrev_b32 v42, 16, v207
    v_mul_f32 v42, v42, v1
    v_and_b32 v1, 0xffff0000, v59
    v_and_b32 v43, 0xffff0000, v207
    v_mul_f32 v43, v43, v1
    s_mov_b32 s7, 229376
    buffer_store_dwordx4 v[40:43], v21, s[12:15], s7 offen nt
    s_endpgm
K_compute:
    v_and_b32 v12, 15, v2
    v_lshrrev_b32 v13, 4, v2
    s_lshr_b32 s7, s2, 3
    s_and_b32 s76, s7, 15
    s_lshr_b32 s7, s7, 4
    s_and_b32 s77, s2, 7
    s_lshl_b32 s77, s77, 1
    s_add_u32 s77, s77, s7
    s_lshl_b32 s7, s76, 2
    s_add_u32 s7, s7, s5
    s_lshl_b32 s7, s7, 16
    s_lshl_b32 s6, s77, 7
    s_add_u32 s7, s7, s6
    v_lshlrev_b32 v10, 14, v13
    v_lshl_add_u32 v10, v12, 3, v10
    v_add_u32 v10, s7, v10
    v_subrev_u32 v11, 0x1800, v10
    v_bfrev_b32 v9, 1
    v_cmp_gt_i32 vcc, 0, v11
    s_lshl_b32 s7, s77, 9
    v_lshlrev_b32 v15, 5, v12
    v_cndmask_b32 v11, v11, v9, vcc
    v_add_u32 v9, s7, v15
    s_mov_b32 s72, 4096
    s_mov_b32 s73, 8192
    s_mov_b32 s74, 12288
    s_lshl_b32 s6, s4, 2
    s_add_u32 s6, s6, s5
    s_lshl_b32 s6, s6, 4
    v_and_b32 v14, 3, v12
    v_and_b32 v1, 1, v13
    v_lshl_add_u32 v14, v1, 3, v14
    v_lshrrev_b32 v1, 1, v13
    v_lshl_add_u32 v14, v1, 2, v14
    v_add_u32 v14, s6, v14
    v_lshlrev_b32 v44, 1, v14
    s_lshl_b32 s6, s4, 7
    v_lshlrev_b32 v1, 3, v12
    v_add_u32 v1, s6, v1
    s_waitcnt lgkmcnt(0)
    s_mov_b32 s20, s58
    s_mov_b32 s21, s59
    s_mov_b32 s22, 2048
    s_mov_b32 s23, 0x00020000
    s_mov_b32 s24, s46
    s_mov_b32 s25, s47
    s_mov_b32 s26, 2048
    s_mov_b32 s27, 0x00020000
    s_mov_b32 s28, s48
    s_mov_b32 s29, s49
    s_mov_b32 s30, 2048
    s_mov_b32 s31, 0x00020000
    buffer_load_ushort v45, v44, s[20:23], 0 offen
    buffer_load_ushort v46, v44, s[24:27], 0 offen
    buffer_load_ushort v47, v44, s[28:31], 0 offen
    s_mov_b32 s8, s34
    s_mov_b32 s9, s35
    s_mov_b32 s10, 4194304
    s_mov_b32 s11, 0x00020000
    buffer_load_dwordx2 v[146:147], v10, s[8:11], 0 offen offset:0 nt
    buffer_load_dwordx2 v[148:149], v10, s[8:11], 0 offen offset:2048 nt
    buffer_load_dwordx2 v[150:151], v10, s[8:11], s72 offen offset:0 nt
    buffer_load_dwordx2 v[152:153], v10, s[8:11], s72 offen offset:2048 nt
    buffer_load_dwordx2 v[154:155], v10, s[8:11], s73 offen offset:0 nt
    buffer_load_dwordx2 v[156:157], v10, s[8:11], s73 offen offset:2048 nt
    buffer_load_dwordx2 v[158:159], v10, s[8:11], s74 offen offset:0 nt
    buffer_load_dwordx2 v[160:161], v10, s[8:11], s74 offen offset:2048 nt
    buffer_load_dwordx2 v[140:141], v11, s[8:11], 0 offen offset:0 nt
    buffer_load_dwordx2 v[142:143], v11, s[8:11], 0 offen offset:2048 nt
    buffer_load_dwordx2 v[144:145], v11, s[8:11], s72 offen offset:0 nt
    s_mov_b32 s68, s38
    s_mov_b32 s69, s39
    s_mov_b32 s70, 8192
    s_mov_b32 s71, 0x00020000
    buffer_load_dwordx4 v[128:131], v9, s[68:71], 0 offen
    buffer_load_dwordx4 v[132:135], v9, s[68:71], 0 offen offset:16
    s_mov_b32 s12, s36
    s_mov_b32 s13, s37
    s_mov_b32 s14, 4194304
    s_mov_b32 s15, 0x00020000
    buffer_load_dwordx2 v[162:163], v10, s[12:15], 0 offen offset:0 nt
    buffer_load_dwordx2 v[164:165], v10, s[12:15], 0 offen offset:2048 nt
    buffer_load_dwordx2 v[166:167], v10, s[12:15], s72 offen offset:0 nt
    buffer_load_dwordx2 v[168:169], v10, s[12:15], s72 offen offset:2048 nt
    buffer_load_dwordx2 v[170:171], v10, s[12:15], s73 offen offset:0 nt
    buffer_load_dwordx2 v[172:173], v10, s[12:15], s73 offen offset:2048 nt
    buffer_load_dwordx2 v[174:175], v10, s[12:15], s74 offen offset:0 nt
    buffer_load_dwordx2 v[176:177], v10, s[12:15], s74 offen offset:2048 nt
    s_barrier
    s_mov_b32 s80, s60
    s_mov_b32 s81, s61
    s_mov_b32 s82, 2048
    s_mov_b32 s83, 0x00020000
    buffer_load_dwordx2 v[242:243], v1, s[80:83], 0 offen
    s_lshl_b32 s7, s5, 2
    v_add_u32 v15, s7, v13
    v_sub_u32 v15, 15, v15
    v_xor_b32 v15, v15, v12
    v_lshlrev_b32 v15, 4, v15
    v_lshl_add_u32 v15, v12, 10, v15
    v_add_u32 v15, 147456, v15
    v_lshrrev_b32 v3, 1, v12
    v_xor_b32 v3, v3, v13
    v_lshlrev_b32 v3, 4, v3
    v_lshl_add_u32 v4, v12, 7, v3
    v_xor_b32 v6, 64, v4
    v_add_u32 v5, 0x10000, v4
    v_add_u32 v7, 0x10000, v6
    s_lshl_b32 s6, s5, 12
    s_add_u32 s6, s6, 16384
    v_add_u32 v8, s6, v4
    v_add_u32 v9, s6, v5
    v_add_u32 v10, s6, v6
    v_add_u32 v11, s6, v7
    s_mov_b32 s16, s64
    s_mov_b32 s17, s65
    s_mov_b32 s18, 256
    s_mov_b32 s19, 0x00020000
    s_or_b32 s6, s2, s5
    s_cmp_eq_u32 s6, 0
    s_cbranch_scc0 C_nonce_w
    s_memrealtime s[6:7]
    v_mov_b32 v1, 0
    s_waitcnt lgkmcnt(0)
    s_or_b32 s6, s6, 1
    v_mov_b32 v48, s6
    v_mov_b32 v49, s7
    s_mov_b64 exec, 1
    buffer_store_dwordx2 v[48:49], v1, s[16:19], 0 offen sc1
    s_mov_b64 exec, -1
C_nonce_w:
    s_add_u32 s8, s66, 8388608
    s_addc_u32 s9, s67, 0
    s_mov_b32 s10, 8388608
    s_mov_b32 s11, 0x00020000
    s_add_u32 s12, s66, 16777216
    s_addc_u32 s13, s67, 0
    s_mov_b32 s14, 262144
    s_mov_b32 s15, 0x00020000
    s_mov_b32 s68, s66
    s_mov_b32 s69, s67
    s_mov_b32 s70, 4194304
    s_mov_b32 s71, 0x00020000
    s_add_u32 s72, s66, 17825792
    s_addc_u32 s73, s67, 0
    s_mov_b32 s74, 393216
    s_mov_b32 s75, 0x00020000
    s_mov_b32 s76, s62
    s_mov_b32 s77, s63
    s_mov_b32 s78, 16777216
    s_mov_b32 s79, 0x00020000
    s_mov_b32 s24, s54
    s_mov_b32 s25, s55
    s_mov_b32 s26, 2097152
    s_mov_b32 s27, 0x00020000
    s_mov_b32 s80, s56
    s_mov_b32 s81, s57
    s_mov_b32 s82, 2097152
    s_mov_b32 s83, 0x00020000
    s_and_b32 s34, s2, 3
    s_lshl_b32 s34, s34, 2
    s_and_b32 s35, s2, 4
    s_lshl_b32 s35, s35, 1
    s_add_u32 s34, s34, s35
    s_add_u32 s35, s3, s4
    s_and_b32 s35, s35, 1
    s_lshl_b32 s35, s35, 1
    s_add_u32 s34, s34, s35
    s_and_b32 s34, s34, 15
    s_sub_u32 s34, s4, s34
    s_and_b32 s34, s34, 15
    s_lshl_b32 s6, s5, 12
    v_add_u32 v240, s6, v4
    v_xor_b32 v241, 64, v240
    v_mov_b32 v62, 147328
    s_lshr_b32 s7, s2, 3
    s_and_b32 s32, s7, 15
    s_lshr_b32 s7, s7, 4
    s_and_b32 s33, s2, 7
    s_lshl_b32 s33, s33, 1
    s_add_u32 s33, s33, s7
    s_mov_b32 s36, 16384
    s_mov_b32 s37, 32768
    s_mov_b32 s38, 49152
    s_lshl_b32 s6, s5, 2
    v_xor_b32 v1, s6, v12
    v_lshlrev_b32 v1, 4, v1
    v_lshl_add_u32 v1, v13, 8, v1
    s_lshl_b32 s6, s5, 12
    s_add_u32 s6, s6, 147456
    v_add_u32 v244, s6, v1
    v_xor_b32 v245, 16, v244
    v_xor_b32 v246, 32, v244
    v_xor_b32 v247, 48, v244
    s_lshl_b32 s6, s33, 2
    s_add_u32 s6, s6, s5
    s_lshl_b32 s6, s6, 16
    s_lshl_b32 s7, s32, 8
    s_sub_u32 s7, 3840, s7
    s_add_u32 s6, s6, s7
    v_lshlrev_b32 v1, 12, v13
    v_lshl_add_u32 v1, v12, 4, v1
    v_add_u32 v248, s6, v1
    s_lshl_b32 s6, s33, 2
    s_add_u32 s7, s6, s5
    s_lshl_b32 s7, s7, 4
    s_add_u32 s7, s7, s32
    s_lshl_b32 s20, s7, 3
    s_lshr_b32 s7, s32, 2
    s_add_u32 s7, s7, s6
    s_lshl_b32 s21, s7, 7
    s_lshl_b32 s7, s33, 4
    s_add_u32 s7, s7, s32
    s_lshl_b32 s7, s7, 2
    s_add_u32 s7, s7, s5
    s_lshl_b32 s22, s7, 12
    s_lshl_b32 s23, s5, 14
    s_add_u32 s23, s23, 106624
    s_lshl_b32 s6, s3, 14
    v_lshlrev_b32 v1, 4, v14
    v_add_u32 v60, s6, v1
    v_lshrrev_b32 v1, 2, v12
    v_lshlrev_b32 v1, 14, v1
    v_sub_u32 v1, v60, v1
    v_subrev_u32 v56, 0x4000, v1
    v_subrev_u32 v57, 0x14000, v1
    v_subrev_u32 v58, 0x24000, v1
    v_subrev_u32 v59, 0x34000, v1
    v_cmp_gt_i32 s[40:41], 0, v56
    v_cmp_gt_i32 s[42:43], 0, v57
    v_cmp_gt_i32 s[44:45], 0, v58
    v_cmp_gt_i32 s[46:47], 0, v59
    s_lshl_b32 s6, s3, 4
    s_add_u32 s6, s6, s4
    s_lshl_b32 s6, s6, 15
    s_lshl_b32 s7, s5, 10
    s_add_u32 s6, s6, s7
    v_lshlrev_b32 v1, 4, v2
    v_add_u32 v61, s6, v1
    s_lshl_b32 s7, s5, 2
    v_add_u32 v63, s7, v62
    s_mov_b32 s48, 0xaaaaaaaa
    s_mov_b32 s49, 0xaaaaaaaa
    s_mov_b32 s50, 0xcccccccc
    s_mov_b32 s51, 0xcccccccc
    s_mov_b32 s52, 0x000f000f
    s_mov_b32 s53, 0x000f000f
    v_mov_b32 v64, 0
    v_mov_b32 v65, 0
    v_mov_b32 v66, 0
    v_mov_b32 v67, 0
    v_mov_b32 v68, 0
    v_mov_b32 v69, 0
    v_mov_b32 v70, 0
    v_mov_b32 v71, 0
    v_mov_b32 v72, 0
    v_mov_b32 v73, 0
    v_mov_b32 v74, 0
    v_mov_b32 v75, 0
    v_mov_b32 v76, 0
    v_mov_b32 v77, 0
    v_mov_b32 v78, 0
    v_mov_b32 v79, 0
    v_mov_b32 v80, 0
    v_mov_b32 v81, 0
    v_mov_b32 v82, 0
    v_mov_b32 v83, 0
    v_mov_b32 v84, 0
    v_mov_b32 v85, 0
    v_mov_b32 v86, 0
    v_mov_b32 v87, 0
    v_mov_b32 v88, 0
    v_mov_b32 v89, 0
    v_mov_b32 v90, 0
    v_mov_b32 v91, 0
    v_mov_b32 v92, 0
    v_mov_b32 v93, 0
    v_mov_b32 v94, 0
    v_mov_b32 v95, 0
    v_mov_b32 v96, 0
    v_mov_b32 v97, 0
    v_mov_b32 v98, 0
    v_mov_b32 v99, 0
    v_mov_b32 v100, 0
    v_mov_b32 v101, 0
    v_mov_b32 v102, 0
    v_mov_b32 v103, 0
    v_mov_b32 v104, 0
    v_mov_b32 v105, 0
    v_mov_b32 v106, 0
    v_mov_b32 v107, 0
    v_mov_b32 v108, 0
    v_mov_b32 v109, 0
    v_mov_b32 v110, 0
    v_mov_b32 v111, 0
    v_mov_b32 v112, 0
    v_mov_b32 v113, 0
    v_mov_b32 v114, 0
    v_mov_b32 v115, 0
    v_mov_b32 v116, 0
    v_mov_b32 v117, 0
    v_mov_b32 v118, 0
    v_mov_b32 v119, 0
    v_mov_b32 v120, 0
    v_mov_b32 v121, 0
    v_mov_b32 v122, 0
    v_mov_b32 v123, 0
    v_mov_b32 v124, 0
    v_mov_b32 v125, 0
    v_mov_b32 v126, 0
    v_mov_b32 v127, 0
    s_waitcnt vmcnt(22)
    v_lshlrev_b32 v45, 16, v45
    v_lshlrev_b32 v46, 16, v46
    v_lshlrev_b32 v47, 16, v47
    v_mul_f32 v45, 0x3fb8aa3b, v45
    v_exp_f32 v45, v45
    s_nop 0
    v_cvt_pk_bf16_f32 v45, v45, v45
    v_lshlrev_b32 v45, 16, v45
    v_mul_f32 v52, v45, v46
    v_mul_f32 v53, v45, v47
    v_mul_f32 v52, 0x3fb8aa3b, v52
    v_exp_f32 v48, v52
    v_mul_f32 v53, 0.15915494, v53
    v_fract_f32 v53, v53
    v_cos_f32 v50, v53
    v_sin_f32 v51, v53
    s_nop 0
    v_mul_f32 v44, v48, v50
    v_mul_f32 v45, v48, v51
    v_add_f32 v48, -1.0, v44
    v_mul_f32 v49, v46, v46
    v_fmac_f32 v49, v47, v47
    v_rcp_f32 v49, v49
    v_mul_f32 v50, v48, v46
    v_fmac_f32 v50, v45, v47
    v_mul_f32 v51, v45, v46
    v_fma_f32 v51, -v48, v47, v51
    v_add_f32 v49, v49, v49
    v_mul_f32 v46, v50, v49
    v_mul_f32 v47, v51, v49
    v_lshlrev_b32 v54, 3, v12
    v_cvt_f32_u32 v54, v54
    v_lshrrev_b32 v55, 2, v12
    v_lshlrev_b32 v55, 7, v55
    v_cvt_f32_u32 v55, v55
    v_mov_b32_dpp v16, v44 quad_perm:[0,0,0,0] row_mask:0xf bank_mask:0xf
    v_mov_b32_dpp v20, v45 quad_perm:[0,0,0,0] row_mask:0xf bank_mask:0xf
    v_mov_b32_dpp v24, v46 quad_perm:[0,0,0,0] row_mask:0xf bank_mask:0xf
    v_mov_b32_dpp v28, v47 quad_perm:[0,0,0,0] row_mask:0xf bank_mask:0xf
    v_mov_b32_dpp v17, v44 quad_perm:[1,1,1,1] row_mask:0xf bank_mask:0xf
    v_mov_b32_dpp v21, v45 quad_perm:[1,1,1,1] row_mask:0xf bank_mask:0xf
    v_mov_b32_dpp v25, v46 quad_perm:[1,1,1,1] row_mask:0xf bank_mask:0xf
    v_mov_b32_dpp v29, v47 quad_perm:[1,1,1,1] row_mask:0xf bank_mask:0xf
    v_mov_b32_dpp v18, v44 quad_perm:[2,2,2,2] row_mask:0xf bank_mask:0xf
    v_mov_b32_dpp v22, v45 quad_perm:[2,2,2,2] row_mask:0xf bank_mask:0xf
    v_mov_b32_dpp v26, v46 quad_perm:[2,2,2,2] row_mask:0xf bank_mask:0xf
    v_mov_b32_dpp v30, v47 quad_perm:[2,2,2,2] row_mask:0xf bank_mask:0xf
    v_mov_b32_dpp v19, v44 quad_perm:[3,3,3,3] row_mask:0xf bank_mask:0xf
    v_mov_b32_dpp v23, v45 quad_perm:[3,3,3,3] row_mask:0xf bank_mask:0xf
    v_mov_b32_dpp v27, v46 quad_perm:[3,3,3,3] row_mask:0xf bank_mask:0xf
    v_mov_b32_dpp v31, v47 quad_perm:[3,3,3,3] row_mask:0xf bank_mask:0xf
    v_mul_f32_dpp v48, v52, v54 quad_perm:[0,0,0,0] row_mask:0xf bank_mask:0xf
    v_mul_f32_dpp v49, v53, v54 quad_perm:[0,0,0,0] row_mask:0xf bank_mask:0xf
    v_exp_f32 v48, v48
    v_fract_f32 v49, v49
    v_cos_f32 v50, v49
    v_sin_f32 v51, v49
    s_nop 0
    v_mul_f32 v32, v48, v50
    v_mul_f32 v36, v48, v51
    v_mul_f32_dpp v48, v52, v54 quad_perm:[1,1,1,1] row_mask:0xf bank_mask:0xf
    v_mul_f32_dpp v49, v53, v54 quad_perm:[1,1,1,1] row_mask:0xf bank_mask:0xf
    v_exp_f32 v48, v48
    v_fract_f32 v49, v49
    v_cos_f32 v50, v49
    v_sin_f32 v51, v49
    s_nop 0
    v_mul_f32 v33, v48, v50
    v_mul_f32 v37, v48, v51
    v_mul_f32_dpp v48, v52, v54 quad_perm:[2,2,2,2] row_mask:0xf bank_mask:0xf
    v_mul_f32_dpp v49, v53, v54 quad_perm:[2,2,2,2] row_mask:0xf bank_mask:0xf
    v_exp_f32 v48, v48
    v_fract_f32 v49, v49
    v_cos_f32 v50, v49
    v_sin_f32 v51, v49
    s_nop 0
    v_mul_f32 v34, v48, v50
    v_mul_f32 v38, v48, v51
    v_mul_f32_dpp v48, v52, v54 quad_perm:[3,3,3,3] row_mask:0xf bank_mask:0xf
    v_mul_f32_dpp v49, v53, v54 quad_perm:[3,3,3,3] row_mask:0xf bank_mask:0xf
    v_exp_f32 v48, v48
    v_fract_f32 v49, v49
    v_cos_f32 v50, v49
    v_sin_f32 v51, v49
    s_nop 0
    v_mul_f32 v35, v48, v50
    v_mul_f32 v39, v48, v51
    v_mul_f32 v48, v52, v55
    v_mul_f32 v49, v53, v55
    v_exp_f32 v48, v48
    v_fract_f32 v49, v49
    v_cos_f32 v50, v49
    v_sin_f32 v51, v49
    s_nop 0
    v_mul_f32 v40, v48, v50
    v_mul_f32 v41, v48, v51
    v_mul_f32 v48, 0x44000000, v52
    v_mul_f32 v49, 0x44000000, v53
    v_exp_f32 v48, v48
    v_fract_f32 v49, v49
    v_cos_f32 v50, v49
    v_sin_f32 v51, v49
    s_nop 0
    v_mul_f32 v42, v48, v50
    v_mul_f32 v43, v48, v51
    s_waitcnt vmcnt(9)
    v_lshlrev_b32 v136, 16, v128
    v_and_b32 v137, 0xffff0000, v128
    v_lshlrev_b32 v138, 16, v129
    v_and_b32 v139, 0xffff0000, v129
    v_lshlrev_b32 v178, 16, v140
    v_lshlrev_b32 v179, 16, v142
    v_lshlrev_b32 v180, 16, v144
    v_lshlrev_b32 v181, 16, v146
    v_lshlrev_b32 v182, 16, v148
    v_lshlrev_b32 v183, 16, v150
    v_lshlrev_b32 v184, 16, v152
    v_lshlrev_b32 v185, 16, v154
    v_lshlrev_b32 v186, 16, v156
    v_lshlrev_b32 v187, 16, v158
    v_lshlrev_b32 v188, 16, v160
    v_mul_f32 v190, v136, v181
    v_mul_f32 v191, v136, v182
    v_mul_f32 v192, v136, v183
    v_mul_f32 v193, v136, v184
    v_mul_f32 v194, v136, v185
    v_mul_f32 v195, v136, v186
    v_mul_f32 v196, v136, v187
    v_mul_f32 v197, v136, v188
    v_fmac_f32 v190, v137, v180
    v_fmac_f32 v191, v137, v181
    v_fmac_f32 v192, v137, v182
    v_fmac_f32 v193, v137, v183
    v_fmac_f32 v194, v137, v184
    v_fmac_f32 v195, v137, v185
    v_fmac_f32 v196, v137, v186
    v_fmac_f32 v197, v137, v187
    v_fmac_f32 v190, v138, v179
    v_fmac_f32 v191, v138, v180
    v_fmac_f32 v192, v138, v181
    v_fmac_f32 v193, v138, v182
    v_fmac_f32 v194, v138, v183
    v_fmac_f32 v195, v138, v184
    v_fmac_f32 v196, v138, v185
    v_fmac_f32 v197, v138, v186
    v_fmac_f32 v190, v139, v178
    v_fmac_f32 v191, v139, v179
    v_fmac_f32 v192, v139, v180
    v_fmac_f32 v193, v139, v181
    v_fmac_f32 v194, v139, v182
    v_fmac_f32 v195, v139, v183
    v_fmac_f32 v196, v139, v184
    v_fmac_f32 v197, v139, v185
    v_lshlrev_b32 v136, 16, v130
    v_and_b32 v137, 0xffff0000, v130
    v_lshlrev_b32 v138, 16, v131
    v_and_b32 v139, 0xffff0000, v131
    v_and_b32 v178, 0xffff0000, v140
    v_and_b32 v179, 0xffff0000, v142
    v_and_b32 v180, 0xffff0000, v144
    v_and_b32 v181, 0xffff0000, v146
    v_and_b32 v182, 0xffff0000, v148
    v_and_b32 v183, 0xffff0000, v150
    v_and_b32 v184, 0xffff0000, v152
    v_and_b32 v185, 0xffff0000, v154
    v_and_b32 v186, 0xffff0000, v156
    v_and_b32 v187, 0xffff0000, v158
    v_and_b32 v188, 0xffff0000, v160
    v_mul_f32 v198, v136, v181
    v_mul_f32 v199, v136, v182
    v_mul_f32 v200, v136, v183
    v_mul_f32 v201, v136, v184
    v_mul_f32 v202, v136, v185
    v_mul_f32 v203, v136, v186
    v_mul_f32 v204, v136, v187
    v_mul_f32 v205, v136, v188
    v_fmac_f32 v198, v137, v180
    v_fmac_f32 v199, v137, v181
    v_fmac_f32 v200, v137, v182
    v_fmac_f32 v201, v137, v183
    v_fmac_f32 v202, v137, v184
    v_fmac_f32 v203, v137, v185
    v_fmac_f32 v204, v137, v186
    v_fmac_f32 v205, v137, v187
    v_fmac_f32 v198, v138, v179
    v_fmac_f32 v199, v138, v180
    v_fmac_f32 v200, v138, v181
    v_fmac_f32 v201, v138, v182
    v_fmac_f32 v202, v138, v183
    v_fmac_f32 v203, v138, v184
    v_fmac_f32 v204, v138, v185
    v_fmac_f32 v205, v138, v186
    v_fmac_f32 v198, v139, v178
    v_fmac_f32 v199, v139, v179
    v_fmac_f32 v200, v139, v180
    v_fmac_f32 v201, v139, v181
    v_fmac_f32 v202, v139, v182
    v_fmac_f32 v203, v139, v183
    v_fmac_f32 v204, v139, v184
    v_fmac_f32 v205, v139, v185
    v_lshlrev_b32 v136, 16, v132
    v_and_b32 v137, 0xffff0000, v132
    v_lshlrev_b32 v138, 16, v133
    v_and_b32 v139, 0xffff0000, v133
    v_lshlrev_b32 v178, 16, v141
    v_lshlrev_b32 v179, 16, v143
    v_lshlrev_b32 v180, 16, v145
    v_lshlrev_b32 v181, 16, v147
    v_lshlrev_b32 v182, 16, v149
    v_lshlrev_b32 v183, 16, v151
    v_lshlrev_b32 v184, 16, v153
    v_lshlrev_b32 v185, 16, v155
    v_lshlrev_b32 v186, 16, v157
    v_lshlrev_b32 v187, 16, v159
    v_lshlrev_b32 v188, 16, v161
    v_mul_f32 v206, v136, v181
    v_mul_f32 v207, v136, v182
    v_mul_f32 v208, v136, v183
    v_mul_f32 v209, v136, v184
    v_mul_f32 v210, v136, v185
    v_mul_f32 v211, v136, v186
    v_mul_f32 v212, v136, v187
    v_mul_f32 v213, v136, v188
    v_fmac_f32 v206, v137, v180
    v_fmac_f32 v207, v137, v181
    v_fmac_f32 v208, v137, v182
    v_fmac_f32 v209, v137, v183
    v_fmac_f32 v210, v137, v184
    v_fmac_f32 v211, v137, v185
    v_fmac_f32 v212, v137, v186
    v_fmac_f32 v213, v137, v187
    v_fmac_f32 v206, v138, v179
    v_fmac_f32 v207, v138, v180
    v_fmac_f32 v208, v138, v181
    v_fmac_f32 v209, v138, v182
    v_fmac_f32 v210, v138, v183
    v_fmac_f32 v211, v138, v184
    v_fmac_f32 v212, v138, v185
    v_fmac_f32 v213, v138, v186
    v_fmac_f32 v206, v139, v178
    v_fmac_f32 v207, v139, v179
    v_fmac_f32 v208, v139, v180
    v_fmac_f32 v209, v139, v181
    v_fmac_f32 v210, v139, v182
    v_fmac_f32 v211, v139, v183
    v_fmac_f32 v212, v139, v184
    v_fmac_f32 v213, v139, v185
    v_lshlrev_b32 v136, 16, v134
    v_and_b32 v137, 0xffff0000, v134
    v_lshlrev_b32 v138, 16, v135
    v_and_b32 v139, 0xffff0000, v135
    v_and_b32 v178, 0xffff0000, v141
    v_and_b32 v179, 0xffff0000, v143
    v_and_b32 v180, 0xffff0000, v145
    v_and_b32 v181, 0xffff0000, v147
    v_and_b32 v182, 0xffff0000, v149
    v_and_b32 v183, 0xffff0000, v151
    v_and_b32 v184, 0xffff0000, v153
    v_and_b32 v185, 0xffff0000, v155
    v_and_b32 v186, 0xffff0000, v157
    v_and_b32 v187, 0xffff0000, v159
    v_and_b32 v188, 0xffff0000, v161
    v_mul_f32 v214, v136, v181
    v_mul_f32 v215, v136, v182
    v_mul_f32 v216, v136, v183
    v_mul_f32 v217, v136, v184
    v_mul_f32 v218, v136, v185
    v_mul_f32 v219, v136, v186
    v_mul_f32 v220, v136, v187
    v_mul_f32 v221, v136, v188
    v_fmac_f32 v214, v137, v180
    v_fmac_f32 v215, v137, v181
    v_fmac_f32 v216, v137, v182
    v_fmac_f32 v217, v137, v183
    v_fmac_f32 v218, v137, v184
    v_fmac_f32 v219, v137, v185
    v_fmac_f32 v220, v137, v186
    v_fmac_f32 v221, v137, v187
    v_fmac_f32 v214, v138, v179
    v_fmac_f32 v215, v138, v180
    v_fmac_f32 v216, v138, v181
    v_fmac_f32 v217, v138, v182
    v_fmac_f32 v218, v138, v183
    v_fmac_f32 v219, v138, v184
    v_fmac_f32 v220, v138, v185
    v_fmac_f32 v221, v138, v186
    v_fmac_f32 v214, v139, v178
    v_fmac_f32 v215, v139, v179
    v_fmac_f32 v216, v139, v180
    v_fmac_f32 v217, v139, v181
    v_fmac_f32 v218, v139, v182
    v_fmac_f32 v219, v139, v183
    v_fmac_f32 v220, v139, v184
    v_fmac_f32 v221, v139, v185
    s_waitcnt vmcnt(1)
    v_lshlrev_b32 v178, 16, v162
    v_lshlrev_b32 v179, 16, v164
    v_lshlrev_b32 v180, 16, v166
    v_lshlrev_b32 v181, 16, v168
    v_lshlrev_b32 v182, 16, v170
    v_lshlrev_b32 v183, 16, v172
    v_lshlrev_b32 v184, 16, v174
    v_lshlrev_b32 v185, 16, v176
    v_mul_f32 v190, v190, v178
    v_mul_f32 v191, v191, v179
    v_mul_f32 v192, v192, v180
    v_mul_f32 v193, v193, v181
    v_mul_f32 v194, v194, v182
    v_mul_f32 v195, v195, v183
    v_mul_f32 v196, v196, v184
    v_mul_f32 v197, v197, v185
    v_cvt_pk_bf16_f32 v224, v197, v196
    v_cvt_pk_bf16_f32 v225, v195, v194
    v_cvt_pk_bf16_f32 v226, v193, v192
    v_cvt_pk_bf16_f32 v227, v191, v190
    ds_write_b128 v15, v[224:227] offset:0
    v_and_b32 v178, 0xffff0000, v162
    v_and_b32 v179, 0xffff0000, v164
    v_and_b32 v180, 0xffff0000, v166
    v_and_b32 v181, 0xffff0000, v168
    v_and_b32 v182, 0xffff0000, v170
    v_and_b32 v183, 0xffff0000, v172
    v_and_b32 v184, 0xffff0000, v174
    v_and_b32 v185, 0xffff0000, v176
    v_mul_f32 v198, v198, v178
    v_mul_f32 v199, v199, v179
    v_mul_f32 v200, v200, v180
    v_mul_f32 v201, v201, v181
    v_mul_f32 v202, v202, v182
    v_mul_f32 v203, v203, v183
    v_mul_f32 v204, v204, v184
    v_mul_f32 v205, v205, v185
    v_cvt_pk_bf16_f32 v228, v205, v204
    v_cvt_pk_bf16_f32 v229, v203, v202
    v_cvt_pk_bf16_f32 v230, v201, v200
    v_cvt_pk_bf16_f32 v231, v199, v198
    ds_write_b128 v15, v[228:231] offset:256
    v_lshlrev_b32 v178, 16, v163
    v_lshlrev_b32 v179, 16, v165
    v_lshlrev_b32 v180, 16, v167
    v_lshlrev_b32 v181, 16, v169
    v_lshlrev_b32 v182, 16, v171
    v_lshlrev_b32 v183, 16, v173
    v_lshlrev_b32 v184, 16, v175
    v_lshlrev_b32 v185, 16, v177
    v_mul_f32 v206, v206, v178
    v_mul_f32 v207, v207, v179
    v_mul_f32 v208, v208, v180
    v_mul_f32 v209, v209, v181
    v_mul_f32 v210, v210, v182
    v_mul_f32 v211, v211, v183
    v_mul_f32 v212, v212, v184
    v_mul_f32 v213, v213, v185
    v_cvt_pk_bf16_f32 v232, v213, v212
    v_cvt_pk_bf16_f32 v233, v211, v210
    v_cvt_pk_bf16_f32 v234, v209, v208
    v_cvt_pk_bf16_f32 v235, v207, v206
    ds_write_b128 v15, v[232:235] offset:512
    v_and_b32 v178, 0xffff0000, v163
    v_and_b32 v179, 0xffff0000, v165
    v_and_b32 v180, 0xffff0000, v167
    v_and_b32 v181, 0xffff0000, v169
    v_and_b32 v182, 0xffff0000, v171
    v_and_b32 v183, 0xffff0000, v173
    v_and_b32 v184, 0xffff0000, v175
    v_and_b32 v185, 0xffff0000, v177
    v_mul_f32 v214, v214, v178
    v_mul_f32 v215, v215, v179
    v_mul_f32 v216, v216, v180
    v_mul_f32 v217, v217, v181
    v_mul_f32 v218, v218, v182
    v_mul_f32 v219, v219, v183
    v_mul_f32 v220, v220, v184
    v_mul_f32 v221, v221, v185
    v_cvt_pk_bf16_f32 v236, v221, v220
    v_cvt_pk_bf16_f32 v237, v219, v218
    v_cvt_pk_bf16_f32 v238, v217, v216
    v_cvt_pk_bf16_f32 v239, v215, v214
    ds_write_b128 v15, v[236:239] offset:768
    s_waitcnt lgkmcnt(0)
    s_barrier
    ds_read_b128 v[160:163], v9 offset:32768
    ds_read_b128 v[164:167], v9 offset:34816
    ds_read_b128 v[128:131], v5 offset:32768
    ds_read_b128 v[132:135], v5 offset:34816
    ds_read_b128 v[136:139], v5 offset:36864
    ds_read_b128 v[140:143], v5 offset:38912
    ds_read_b128 v[144:147], v5 offset:40960
    ds_read_b128 v[148:151], v5 offset:43008
    ds_read_b128 v[152:155], v5 offset:45056
    ds_read_b128 v[156:159], v5 offset:47104
    s_setprio 3
    ds_read_b128 v[224:227], v244 offset:0
    ds_read_b128 v[228:231], v245 offset:1024
    ds_read_b128 v[232:235], v246 offset:2048
    ds_read_b128 v[236:239], v247 offset:3072
    s_cmp_eq_u32 s34, 0
    s_waitcnt lgkmcnt(0)
    s_cbranch_scc1 C_x0
C_x0_r:
    buffer_store_dwordx4 v[224:227], v248, s[68:71], 0 offen sc1
    buffer_store_dwordx4 v[228:231], v248, s[68:71], s36 offen sc1
    buffer_store_dwordx4 v[232:235], v248, s[68:71], s37 offen sc1
    buffer_store_dwordx4 v[236:239], v248, s[68:71], s38 offen sc1
    buffer_load_dwordx2 v[54:55], off, s[16:19], 0 sc1
    v_lshlrev_b32 v246, 3, v12
    v_lshlrev_b32 v247, 4, v2
    v_mfma_f32_16x16x32_bf16 v[64:67], v[160:163], v[128:131], v[64:67]
    ds_read_b128 v[200:203], v11 offset:32768
    v_mfma_f32_16x16x32_bf16 v[68:71], v[164:167], v[128:131], v[68:71]
    ds_read_b128 v[204:207], v11 offset:34816
    v_mfma_f32_16x16x32_bf16 v[76:79], v[164:167], v[132:135], v[76:79]
    ds_read_b128 v[168:171], v7 offset:32768
    v_mfma_f32_16x16x32_bf16 v[72:75], v[160:163], v[132:135], v[72:75]
    ds_read_b128 v[172:175], v7 offset:34816
    v_mfma_f32_16x16x32_bf16 v[80:83], v[160:163], v[136:139], v[80:83]
    ds_read_b128 v[176:179], v7 offset:36864
    v_mfma_f32_16x16x32_bf16 v[84:87], v[164:167], v[136:139], v[84:87]
    ds_read_b128 v[180:183], v7 offset:38912
    v_mfma_f32_16x16x32_bf16 v[92:95], v[164:167], v[140:143], v[92:95]
    ds_read_b128 v[184:187], v7 offset:40960
    v_mfma_f32_16x16x32_bf16 v[88:91], v[160:163], v[140:143], v[88:91]
    ds_read_b128 v[188:191], v7 offset:43008
    v_mfma_f32_16x16x32_bf16 v[96:99], v[160:163], v[144:147], v[96:99]
    ds_read_b128 v[192:195], v7 offset:45056
    v_mfma_f32_16x16x32_bf16 v[100:103], v[164:167], v[144:147], v[100:103]
    ds_read_b128 v[196:199], v7 offset:47104
    v_mfma_f32_16x16x32_bf16 v[108:111], v[164:167], v[148:151], v[108:111]
    v_mfma_f32_16x16x32_bf16 v[104:107], v[160:163], v[148:151], v[104:107]
    v_mfma_f32_16x16x32_bf16 v[112:115], v[160:163], v[152:155], v[112:115]
    v_mfma_f32_16x16x32_bf16 v[116:119], v[164:167], v[152:155], v[116:119]
    v_mfma_f32_16x16x32_bf16 v[124:127], v[164:167], v[156:159], v[124:127]
    v_mfma_f32_16x16x32_bf16 v[120:123], v[160:163], v[156:159], v[120:123]
    s_waitcnt lgkmcnt(0)
    s_barrier
    v_mfma_f32_16x16x32_bf16 v[64:67], v[200:203], v[168:171], v[64:67]
    ds_read_b128 v[160:163], v8 offset:0
    v_mfma_f32_16x16x32_bf16 v[68:71], v[204:207], v[168:171], v[68:71]
    ds_read_b128 v[164:167], v8 offset:2048
    v_mfma_f32_16x16x32_bf16 v[76:79], v[204:207], v[172:175], v[76:79]
    ds_read_b128 v[128:131], v4 offset:0
    v_mfma_f32_16x16x32_bf16 v[72:75], v[200:203], v[172:175], v[72:75]
    ds_read_b128 v[132:135], v4 offset:2048
    v_mfma_f32_16x16x32_bf16 v[80:83], v[200:203], v[176:179], v[80:83]
    ds_read_b128 v[136:139], v4 offset:4096
    v_mfma_f32_16x16x32_bf16 v[84:87], v[204:207], v[176:179], v[84:87]
    ds_read_b128 v[140:143], v4 offset:6144
    v_mfma_f32_16x16x32_bf16 v[92:95], v[204:207], v[180:183], v[92:95]
    ds_read_b128 v[144:147], v4 offset:8192
    v_mfma_f32_16x16x32_bf16 v[88:91], v[200:203], v[180:183], v[88:91]
    ds_read_b128 v[148:151], v4 offset:10240
    v_mfma_f32_16x16x32_bf16 v[96:99], v[200:203], v[184:187], v[96:99]
    ds_read_b128 v[152:155], v4 offset:12288
    v_mfma_f32_16x16x32_bf16 v[100:103], v[204:207], v[184:187], v[100:103]
    ds_read_b128 v[156:159], v4 offset:14336
    v_mfma_f32_16x16x32_bf16 v[108:111], v[204:207], v[188:191], v[108:111]
    v_mfma_f32_16x16x32_bf16 v[104:107], v[200:203], v[188:191], v[104:107]
    v_mfma_f32_16x16x32_bf16 v[112:115], v[200:203], v[192:195], v[112:115]
    v_mfma_f32_16x16x32_bf16 v[116:119], v[204:207], v[192:195], v[116:119]
    v_mfma_f32_16x16x32_bf16 v[124:127], v[204:207], v[196:199], v[124:127]
    v_mfma_f32_16x16x32_bf16 v[120:123], v[200:203], v[196:199], v[120:123]
    s_cmp_eq_u32 s34, 1
    s_waitcnt lgkmcnt(0)
    s_cbranch_scc1 C_x1
C_x1_r:
    v_mfma_f32_16x16x32_bf16 v[64:67], v[160:163], v[128:131], v[64:67]
    ds_read_b128 v[200:203], v10 offset:0
    v_mfma_f32_16x16x32_bf16 v[68:71], v[164:167], v[128:131], v[68:71]
    ds_read_b128 v[204:207], v10 offset:2048
    v_mfma_f32_16x16x32_bf16 v[76:79], v[164:167], v[132:135], v[76:79]
    ds_read_b128 v[168:171], v6 offset:0
    v_mfma_f32_16x16x32_bf16 v[72:75], v[160:163], v[132:135], v[72:75]
    ds_read_b128 v[172:175], v6 offset:2048
    v_mfma_f32_16x16x32_bf16 v[80:83], v[160:163], v[136:139], v[80:83]
    ds_read_b128 v[176:179], v6 offset:4096
    v_mfma_f32_16x16x32_bf16 v[84:87], v[164:167], v[136:139], v[84:87]
    ds_read_b128 v[180:183], v6 offset:6144
    v_mfma_f32_16x16x32_bf16 v[92:95], v[164:167], v[140:143], v[92:95]
    ds_read_b128 v[184:187], v6 offset:8192
    v_mfma_f32_16x16x32_bf16 v[88:91], v[160:163], v[140:143], v[88:91]
    ds_read_b128 v[188:191], v6 offset:10240
    v_mfma_f32_16x16x32_bf16 v[96:99], v[160:163], v[144:147], v[96:99]
    ds_read_b128 v[192:195], v6 offset:12288
    v_mfma_f32_16x16x32_bf16 v[100:103], v[164:167], v[144:147], v[100:103]
    ds_read_b128 v[196:199], v6 offset:14336
    v_mfma_f32_16x16x32_bf16 v[108:111], v[164:167], v[148:151], v[108:111]
    v_mfma_f32_16x16x32_bf16 v[104:107], v[160:163], v[148:151], v[104:107]
    v_mfma_f32_16x16x32_bf16 v[112:115], v[160:163], v[152:155], v[112:115]
    v_mfma_f32_16x16x32_bf16 v[116:119], v[164:167], v[152:155], v[116:119]
    v_mfma_f32_16x16x32_bf16 v[124:127], v[164:167], v[156:159], v[124:127]
    v_mfma_f32_16x16x32_bf16 v[120:123], v[160:163], v[156:159], v[120:123]
    s_waitcnt lgkmcnt(0)
    s_barrier
    v_mfma_f32_16x16x32_bf16 v[64:67], v[200:203], v[168:171], v[64:67]
    ds_read_b128 v[160:163], v8 offset:32768
    v_mfma_f32_16x16x32_bf16 v[68:71], v[204:207], v[168:171], v[68:71]
    ds_read_b128 v[164:167], v8 offset:34816
    v_mfma_f32_16x16x32_bf16 v[76:79], v[204:207], v[172:175], v[76:79]
    ds_read_b128 v[128:131], v4 offset:32768
    v_mfma_f32_16x16x32_bf16 v[72:75], v[200:203], v[172:175], v[72:75]
    ds_read_b128 v[132:135], v4 offset:34816
    v_mfma_f32_16x16x32_bf16 v[80:83], v[200:203], v[176:179], v[80:83]
    ds_read_b128 v[136:139], v4 offset:36864
    v_mfma_f32_16x16x32_bf16 v[84:87], v[204:207], v[176:179], v[84:87]
    ds_read_b128 v[140:143], v4 offset:38912
    v_mfma_f32_16x16x32_bf16 v[92:95], v[204:207], v[180:183], v[92:95]
    ds_read_b128 v[144:147], v4 offset:40960
    v_mfma_f32_16x16x32_bf16 v[88:91], v[200:203], v[180:183], v[88:91]
    ds_read_b128 v[148:151], v4 offset:43008
    v_mfma_f32_16x16x32_bf16 v[96:99], v[200:203], v[184:187], v[96:99]
    ds_read_b128 v[152:155], v4 offset:45056
    v_mfma_f32_16x16x32_bf16 v[100:103], v[204:207], v[184:187], v[100:103]
    ds_read_b128 v[156:159], v4 offset:47104
    v_mfma_f32_16x16x32_bf16 v[108:111], v[204:207], v[188:191], v[108:111]
    v_mfma_f32_16x16x32_bf16 v[104:107], v[200:203], v[188:191], v[104:107]
    v_mfma_f32_16x16x32_bf16 v[112:115], v[200:203], v[192:195], v[112:115]
    v_mfma_f32_16x16x32_bf16 v[116:119], v[204:207], v[192:195], v[116:119]
    v_mfma_f32_16x16x32_bf16 v[124:127], v[204:207], v[196:199], v[124:127]
    v_mfma_f32_16x16x32_bf16 v[120:123], v[200:203], v[196:199], v[120:123]
    s_cmp_eq_u32 s34, 2
    s_waitcnt lgkmcnt(0)
    s_cbranch_scc1 C_x2
C_x2_r:
    v_mfma_f32_16x16x32_bf16 v[64:67], v[160:163], v[128:131], v[64:67]
    ds_read_b128 v[200:203], v10 offset:32768
    v_mfma_f32_16x16x32_bf16 v[68:71], v[164:167], v[128:131], v[68:71]
    ds_read_b128 v[204:207], v10 offset:34816
    v_mfma_f32_16x16x32_bf16 v[76:79], v[164:167], v[132:135], v[76:79]
    ds_read_b128 v[168:171], v6 offset:32768
    v_mfma_f32_16x16x32_bf16 v[72:75], v[160:163], v[132:135], v[72:75]
    ds_read_b128 v[172:175], v6 offset:34816
    v_mfma_f32_16x16x32_bf16 v[80:83], v[160:163], v[136:139], v[80:83]
    ds_read_b128 v[176:179], v6 offset:36864
    v_mfma_f32_16x16x32_bf16 v[84:87], v[164:167], v[136:139], v[84:87]
    ds_read_b128 v[180:183], v6 offset:38912
    v_mfma_f32_16x16x32_bf16 v[92:95], v[164:167], v[140:143], v[92:95]
    ds_read_b128 v[184:187], v6 offset:40960
    v_mfma_f32_16x16x32_bf16 v[88:91], v[160:163], v[140:143], v[88:91]
    ds_read_b128 v[188:191], v6 offset:43008
    v_mfma_f32_16x16x32_bf16 v[96:99], v[160:163], v[144:147], v[96:99]
    ds_read_b128 v[192:195], v6 offset:45056
    v_mfma_f32_16x16x32_bf16 v[100:103], v[164:167], v[144:147], v[100:103]
    ds_read_b128 v[196:199], v6 offset:47104
    v_mfma_f32_16x16x32_bf16 v[108:111], v[164:167], v[148:151], v[108:111]
    v_mfma_f32_16x16x32_bf16 v[104:107], v[160:163], v[148:151], v[104:107]
    v_mfma_f32_16x16x32_bf16 v[112:115], v[160:163], v[152:155], v[112:115]
    v_mfma_f32_16x16x32_bf16 v[116:119], v[164:167], v[152:155], v[116:119]
    v_mfma_f32_16x16x32_bf16 v[124:127], v[164:167], v[156:159], v[124:127]
    v_mfma_f32_16x16x32_bf16 v[120:123], v[160:163], v[156:159], v[120:123]
    s_waitcnt lgkmcnt(0)
    s_barrier
    v_mfma_f32_16x16x32_bf16 v[64:67], v[200:203], v[168:171], v[64:67]
    ds_read_b128 v[160:163], v9 offset:0
    v_mfma_f32_16x16x32_bf16 v[68:71], v[204:207], v[168:171], v[68:71]
    ds_read_b128 v[164:167], v9 offset:2048
    v_mfma_f32_16x16x32_bf16 v[76:79], v[204:207], v[172:175], v[76:79]
    ds_read_b128 v[128:131], v5 offset:0
    v_mfma_f32_16x16x32_bf16 v[72:75], v[200:203], v[172:175], v[72:75]
    ds_read_b128 v[132:135], v5 offset:2048
    v_mfma_f32_16x16x32_bf16 v[80:83], v[200:203], v[176:179], v[80:83]
    ds_read_b128 v[136:139], v5 offset:4096
    v_mfma_f32_16x16x32_bf16 v[84:87], v[204:207], v[176:179], v[84:87]
    ds_read_b128 v[140:143], v5 offset:6144
    v_mfma_f32_16x16x32_bf16 v[92:95], v[204:207], v[180:183], v[92:95]
    ds_read_b128 v[144:147], v5 offset:8192
    v_mfma_f32_16x16x32_bf16 v[88:91], v[200:203], v[180:183], v[88:91]
    ds_read_b128 v[148:151], v5 offset:10240
    v_mfma_f32_16x16x32_bf16 v[96:99], v[200:203], v[184:187], v[96:99]
    ds_read_b128 v[152:155], v5 offset:12288
    v_mfma_f32_16x16x32_bf16 v[100:103], v[204:207], v[184:187], v[100:103]
    ds_read_b128 v[156:159], v5 offset:14336
    v_mfma_f32_16x16x32_bf16 v[108:111], v[204:207], v[188:191], v[108:111]
    v_mfma_f32_16x16x32_bf16 v[104:107], v[200:203], v[188:191], v[104:107]
    v_mfma_f32_16x16x32_bf16 v[112:115], v[200:203], v[192:195], v[112:115]
    v_mfma_f32_16x16x32_bf16 v[116:119], v[204:207], v[192:195], v[116:119]
    v_mfma_f32_16x16x32_bf16 v[124:127], v[204:207], v[196:199], v[124:127]
    v_mfma_f32_16x16x32_bf16 v[120:123], v[200:203], v[196:199], v[120:123]
    s_cmp_eq_u32 s34, 3
    s_waitcnt lgkmcnt(0)
    s_cbranch_scc1 C_x3
C_x3_r:
    v_mfma_f32_16x16x32_bf16 v[64:67], v[160:163], v[128:131], v[64:67]
    ds_read_b128 v[200:203], v11 offset:0
    v_mfma_f32_16x16x32_bf16 v[68:71], v[164:167], v[128:131], v[68:71]
    ds_read_b128 v[204:207], v11 offset:2048
    v_mfma_f32_16x16x32_bf16 v[76:79], v[164:167], v[132:135], v[76:79]
    ds_read_b128 v[168:171], v7 offset:0
    v_mfma_f32_16x16x32_bf16 v[72:75], v[160:163], v[132:135], v[72:75]
    ds_read_b128 v[172:175], v7 offset:2048
    v_mfma_f32_16x16x32_bf16 v[80:83], v[160:163], v[136:139], v[80:83]
    ds_read_b128 v[176:179], v7 offset:4096
    v_mfma_f32_16x16x32_bf16 v[84:87], v[164:167], v[136:139], v[84:87]
    ds_read_b128 v[180:183], v7 offset:6144
    v_mfma_f32_16x16x32_bf16 v[92:95], v[164:167], v[140:143], v[92:95]
    ds_read_b128 v[184:187], v7 offset:8192
    v_mfma_f32_16x16x32_bf16 v[88:91], v[160:163], v[140:143], v[88:91]
    ds_read_b128 v[188:191], v7 offset:10240
    v_mfma_f32_16x16x32_bf16 v[96:99], v[160:163], v[144:147], v[96:99]
    ds_read_b128 v[192:195], v7 offset:12288
    v_mfma_f32_16x16x32_bf16 v[100:103], v[164:167], v[144:147], v[100:103]
    ds_read_b128 v[196:199], v7 offset:14336
    v_mfma_f32_16x16x32_bf16 v[108:111], v[164:167], v[148:151], v[108:111]
    v_mfma_f32_16x16x32_bf16 v[104:107], v[160:163], v[148:151], v[104:107]
    v_mfma_f32_16x16x32_bf16 v[112:115], v[160:163], v[152:155], v[112:115]
    v_mfma_f32_16x16x32_bf16 v[116:119], v[164:167], v[152:155], v[116:119]
    v_mfma_f32_16x16x32_bf16 v[124:127], v[164:167], v[156:159], v[124:127]
    v_mfma_f32_16x16x32_bf16 v[120:123], v[160:163], v[156:159], v[120:123]
    s_waitcnt lgkmcnt(0)
    s_barrier
    v_mfma_f32_16x16x32_bf16 v[64:67], v[200:203], v[168:171], v[64:67]
    ds_read_b128 v[160:163], v9 offset:32768
    v_mfma_f32_16x16x32_bf16 v[68:71], v[204:207], v[168:171], v[68:71]
    ds_read_b128 v[164:167], v9 offset:34816
    v_mfma_f32_16x16x32_bf16 v[76:79], v[204:207], v[172:175], v[76:79]
    ds_read_b128 v[128:131], v5 offset:32768
    v_mfma_f32_16x16x32_bf16 v[72:75], v[200:203], v[172:175], v[72:75]
    ds_read_b128 v[132:135], v5 offset:34816
    v_mfma_f32_16x16x32_bf16 v[80:83], v[200:203], v[176:179], v[80:83]
    ds_read_b128 v[136:139], v5 offset:36864
    v_mfma_f32_16x16x32_bf16 v[84:87], v[204:207], v[176:179], v[84:87]
    ds_read_b128 v[140:143], v5 offset:38912
    v_mfma_f32_16x16x32_bf16 v[92:95], v[204:207], v[180:183], v[92:95]
    ds_read_b128 v[144:147], v5 offset:40960
    v_mfma_f32_16x16x32_bf16 v[88:91], v[200:203], v[180:183], v[88:91]
    ds_read_b128 v[148:151], v5 offset:43008
    v_mfma_f32_16x16x32_bf16 v[96:99], v[200:203], v[184:187], v[96:99]
    ds_read_b128 v[152:155], v5 offset:45056
    v_mfma_f32_16x16x32_bf16 v[100:103], v[204:207], v[184:187], v[100:103]
    ds_read_b128 v[156:159], v5 offset:47104
    v_mfma_f32_16x16x32_bf16 v[108:111], v[204:207], v[188:191], v[108:111]
    v_mfma_f32_16x16x32_bf16 v[104:107], v[200:203], v[188:191], v[104:107]
    v_mfma_f32_16x16x32_bf16 v[112:115], v[200:203], v[192:195], v[112:115]
    v_mfma_f32_16x16x32_bf16 v[116:119], v[204:207], v[192:195], v[116:119]
    v_mfma_f32_16x16x32_bf16 v[124:127], v[204:207], v[196:199], v[124:127]
    v_mfma_f32_16x16x32_bf16 v[120:123], v[200:203], v[196:199], v[120:123]
    s_cmp_eq_u32 s34, 4
    s_waitcnt lgkmcnt(0)
    s_cbranch_scc1 C_x4
C_x4_r:
    v_mfma_f32_16x16x32_bf16 v[64:67], v[160:163], v[128:131], v[64:67]
    ds_read_b128 v[200:203], v11 offset:32768
    v_mfma_f32_16x16x32_bf16 v[68:71], v[164:167], v[128:131], v[68:71]
    ds_read_b128 v[204:207], v11 offset:34816
    v_mfma_f32_16x16x32_bf16 v[76:79], v[164:167], v[132:135], v[76:79]
    ds_read_b128 v[168:171], v7 offset:32768
    v_mfma_f32_16x16x32_bf16 v[72:75], v[160:163], v[132:135], v[72:75]
    ds_read_b128 v[172:175], v7 offset:34816
    v_mfma_f32_16x16x32_bf16 v[80:83], v[160:163], v[136:139], v[80:83]
    ds_read_b128 v[176:179], v7 offset:36864
    v_mfma_f32_16x16x32_bf16 v[84:87], v[164:167], v[136:139], v[84:87]
    ds_read_b128 v[180:183], v7 offset:38912
    v_mfma_f32_16x16x32_bf16 v[92:95], v[164:167], v[140:143], v[92:95]
    ds_read_b128 v[184:187], v7 offset:40960
    v_mfma_f32_16x16x32_bf16 v[88:91], v[160:163], v[140:143], v[88:91]
    ds_read_b128 v[188:191], v7 offset:43008
    v_mfma_f32_16x16x32_bf16 v[96:99], v[160:163], v[144:147], v[96:99]
    ds_read_b128 v[192:195], v7 offset:45056
    v_mfma_f32_16x16x32_bf16 v[100:103], v[164:167], v[144:147], v[100:103]
    ds_read_b128 v[196:199], v7 offset:47104
    v_mfma_f32_16x16x32_bf16 v[108:111], v[164:167], v[148:151], v[108:111]
    v_mfma_f32_16x16x32_bf16 v[104:107], v[160:163], v[148:151], v[104:107]
    v_mfma_f32_16x16x32_bf16 v[112:115], v[160:163], v[152:155], v[112:115]
    v_mfma_f32_16x16x32_bf16 v[116:119], v[164:167], v[152:155], v[116:119]
    v_mfma_f32_16x16x32_bf16 v[124:127], v[164:167], v[156:159], v[124:127]
    v_mfma_f32_16x16x32_bf16 v[120:123], v[160:163], v[156:159], v[120:123]
    s_waitcnt vmcnt(0)
    v_readfirstlane_b32 s7, v54
    s_cmp_lg_u32 s7, 0
    s_cbranch_scc0 C_non
C_non_r:
    s_mov_b64 exec, 1
    buffer_store_dwordx2 v[54:55], off, s[72:75], s20 sc1
    ds_write_b64 v62, v[54:55]
    s_mov_b64 exec, -1
    s_waitcnt lgkmcnt(0)
    s_barrier
    v_mfma_f32_16x16x32_bf16 v[64:67], v[200:203], v[168:171], v[64:67]
    ds_read_b128 v[160:163], v8 offset:0
    v_mfma_f32_16x16x32_bf16 v[68:71], v[204:207], v[168:171], v[68:71]
    ds_read_b128 v[164:167], v8 offset:2048
    v_mfma_f32_16x16x32_bf16 v[76:79], v[204:207], v[172:175], v[76:79]
    ds_read_b128 v[128:131], v4 offset:0
    v_mfma_f32_16x16x32_bf16 v[72:75], v[200:203], v[172:175], v[72:75]
    ds_read_b128 v[132:135], v4 offset:2048
    v_mfma_f32_16x16x32_bf16 v[80:83], v[200:203], v[176:179], v[80:83]
    ds_read_b128 v[136:139], v4 offset:4096
    v_mfma_f32_16x16x32_bf16 v[84:87], v[204:207], v[176:179], v[84:87]
    ds_read_b128 v[140:143], v4 offset:6144
    v_mfma_f32_16x16x32_bf16 v[92:95], v[204:207], v[180:183], v[92:95]
    ds_read_b128 v[144:147], v4 offset:8192
    v_mfma_f32_16x16x32_bf16 v[88:91], v[200:203], v[180:183], v[88:91]
    ds_read_b128 v[148:151], v4 offset:10240
    v_mfma_f32_16x16x32_bf16 v[96:99], v[200:203], v[184:187], v[96:99]
    ds_read_b128 v[152:155], v4 offset:12288
    v_mfma_f32_16x16x32_bf16 v[100:103], v[204:207], v[184:187], v[100:103]
    ds_read_b128 v[156:159], v4 offset:14336
    v_mfma_f32_16x16x32_bf16 v[108:111], v[204:207], v[188:191], v[108:111]
    v_mfma_f32_16x16x32_bf16 v[104:107], v[200:203], v[188:191], v[104:107]
    v_mfma_f32_16x16x32_bf16 v[112:115], v[200:203], v[192:195], v[112:115]
    v_mfma_f32_16x16x32_bf16 v[116:119], v[204:207], v[192:195], v[116:119]
    v_mfma_f32_16x16x32_bf16 v[124:127], v[204:207], v[196:199], v[124:127]
    v_mfma_f32_16x16x32_bf16 v[120:123], v[200:203], v[196:199], v[120:123]
    s_cmp_eq_u32 s34, 5
    s_waitcnt lgkmcnt(0)
    s_cbranch_scc1 C_x5
C_x5_r:
    v_mfma_f32_16x16x32_bf16 v[64:67], v[160:163], v[128:131], v[64:67]
    ds_read_b128 v[200:203], v10 offset:0
    v_mfma_f32_16x16x32_bf16 v[68:71], v[164:167], v[128:131], v[68:71]
    ds_read_b128 v[204:207], v10 offset:2048
    v_mfma_f32_16x16x32_bf16 v[76:79], v[164:167], v[132:135], v[76:79]
    ds_read_b128 v[168:171], v6 offset:0
    v_mfma_f32_16x16x32_bf16 v[72:75], v[160:163], v[132:135], v[72:75]
    ds_read_b128 v[172:175], v6 offset:2048
    v_mfma_f32_16x16x32_bf16 v[80:83], v[160:163], v[136:139], v[80:83]
    ds_read_b128 v[176:179], v6 offset:4096
    v_mfma_f32_16x16x32_bf16 v[84:87], v[164:167], v[136:139], v[84:87]
    ds_read_b128 v[180:183], v6 offset:6144
    v_mfma_f32_16x16x32_bf16 v[92:95], v[164:167], v[140:143], v[92:95]
    ds_read_b128 v[184:187], v6 offset:8192
    v_mfma_f32_16x16x32_bf16 v[88:91], v[160:163], v[140:143], v[88:91]
    ds_read_b128 v[188:191], v6 offset:10240
    v_mfma_f32_16x16x32_bf16 v[96:99], v[160:163], v[144:147], v[96:99]
    ds_read_b128 v[192:195], v6 offset:12288
    v_mfma_f32_16x16x32_bf16 v[100:103], v[164:167], v[144:147], v[100:103]
    ds_read_b128 v[196:199], v6 offset:14336
    v_mfma_f32_16x16x32_bf16 v[108:111], v[164:167], v[148:151], v[108:111]
    v_mfma_f32_16x16x32_bf16 v[104:107], v[160:163], v[148:151], v[104:107]
    v_mfma_f32_16x16x32_bf16 v[112:115], v[160:163], v[152:155], v[112:115]
    v_mfma_f32_16x16x32_bf16 v[116:119], v[164:167], v[152:155], v[116:119]
    v_mfma_f32_16x16x32_bf16 v[124:127], v[164:167], v[156:159], v[124:127]
    v_mfma_f32_16x16x32_bf16 v[120:123], v[160:163], v[156:159], v[120:123]
    s_waitcnt lgkmcnt(0)
    s_barrier
    v_mfma_f32_16x16x32_bf16 v[64:67], v[200:203], v[168:171], v[64:67]
    ds_read_b128 v[160:163], v8 offset:32768
    v_mfma_f32_16x16x32_bf16 v[68:71], v[204:207], v[168:171], v[68:71]
    ds_read_b128 v[164:167], v8 offset:34816
    v_mfma_f32_16x16x32_bf16 v[76:79], v[204:207], v[172:175], v[76:79]
    ds_read_b128 v[128:131], v4 offset:32768
    v_mfma_f32_16x16x32_bf16 v[72:75], v[200:203], v[172:175], v[72:75]
    ds_read_b128 v[132:135], v4 offset:34816
    v_mfma_f32_16x16x32_bf16 v[80:83], v[200:203], v[176:179], v[80:83]
    ds_read_b128 v[136:139], v4 offset:36864
    v_mfma_f32_16x16x32_bf16 v[84:87], v[204:207], v[176:179], v[84:87]
    ds_read_b128 v[140:143], v4 offset:38912
    v_mfma_f32_16x16x32_bf16 v[92:95], v[204:207], v[180:183], v[92:95]
    ds_read_b128 v[144:147], v4 offset:40960
    v_mfma_f32_16x16x32_bf16 v[88:91], v[200:203], v[180:183], v[88:91]
    ds_read_b128 v[148:151], v4 offset:43008
    v_mfma_f32_16x16x32_bf16 v[96:99], v[200:203], v[184:187], v[96:99]
    ds_read_b128 v[152:155], v4 offset:45056
    v_mfma_f32_16x16x32_bf16 v[100:103], v[204:207], v[184:187], v[100:103]
    ds_read_b128 v[156:159], v4 offset:47104
    v_mfma_f32_16x16x32_bf16 v[108:111], v[204:207], v[188:191], v[108:111]
    v_mfma_f32_16x16x32_bf16 v[104:107], v[200:203], v[188:191], v[104:107]
    v_mfma_f32_16x16x32_bf16 v[112:115], v[200:203], v[192:195], v[112:115]
    v_mfma_f32_16x16x32_bf16 v[116:119], v[204:207], v[192:195], v[116:119]
    v_mfma_f32_16x16x32_bf16 v[124:127], v[204:207], v[196:199], v[124:127]
    v_mfma_f32_16x16x32_bf16 v[120:123], v[200:203], v[196:199], v[120:123]
    s_cmp_eq_u32 s34, 6
    s_waitcnt lgkmcnt(0)
    s_cbranch_scc1 C_x6
C_x6_r:
    v_mfma_f32_16x16x32_bf16 v[64:67], v[160:163], v[128:131], v[64:67]
    ds_read_b128 v[200:203], v10 offset:32768
    v_mfma_f32_16x16x32_bf16 v[68:71], v[164:167], v[128:131], v[68:71]
    ds_read_b128 v[204:207], v10 offset:34816
    v_mfma_f32_16x16x32_bf16 v[76:79], v[164:167], v[132:135], v[76:79]
    ds_read_b128 v[168:171], v6 offset:32768
    v_mfma_f32_16x16x32_bf16 v[72:75], v[160:163], v[132:135], v[72:75]
    ds_read_b128 v[172:175], v6 offset:34816
    v_mfma_f32_16x16x32_bf16 v[80:83], v[160:163], v[136:139], v[80:83]
    ds_read_b128 v[176:179], v6 offset:36864
    v_mfma_f32_16x16x32_bf16 v[84:87], v[164:167], v[136:139], v[84:87]
    ds_read_b128 v[180:183], v6 offset:38912
    v_mfma_f32_16x16x32_bf16 v[92:95], v[164:167], v[140:143], v[92:95]
    ds_read_b128 v[184:187], v6 offset:40960
    v_mfma_f32_16x16x32_bf16 v[88:91], v[160:163], v[140:143], v[88:91]
    ds_read_b128 v[188:191], v6 offset:43008
    v_mfma_f32_16x16x32_bf16 v[96:99], v[160:163], v[144:147], v[96:99]
    ds_read_b128 v[192:195], v6 offset:45056
    v_mfma_f32_16x16x32_bf16 v[100:103], v[164:167], v[144:147], v[100:103]
    ds_read_b128 v[196:199], v6 offset:47104
    v_mfma_f32_16x16x32_bf16 v[108:111], v[164:167], v[148:151], v[108:111]
    v_mfma_f32_16x16x32_bf16 v[104:107], v[160:163], v[148:151], v[104:107]
    v_mfma_f32_16x16x32_bf16 v[112:115], v[160:163], v[152:155], v[112:115]
    v_mfma_f32_16x16x32_bf16 v[116:119], v[164:167], v[152:155], v[116:119]
    v_mfma_f32_16x16x32_bf16 v[124:127], v[164:167], v[156:159], v[124:127]
    v_mfma_f32_16x16x32_bf16 v[120:123], v[160:163], v[156:159], v[120:123]
    s_waitcnt lgkmcnt(0)
    s_barrier
    v_mfma_f32_16x16x32_bf16 v[64:67], v[200:203], v[168:171], v[64:67]
    ds_read_b128 v[160:163], v9 offset:0
    v_mfma_f32_16x16x32_bf16 v[68:71], v[204:207], v[168:171], v[68:71]
    ds_read_b128 v[164:167], v9 offset:2048
    v_mfma_f32_16x16x32_bf16 v[76:79], v[204:207], v[172:175], v[76:79]
    ds_read_b128 v[128:131], v5 offset:0
    v_mfma_f32_16x16x32_bf16 v[72:75], v[200:203], v[172:175], v[72:75]
    ds_read_b128 v[132:135], v5 offset:2048
    v_mfma_f32_16x16x32_bf16 v[80:83], v[200:203], v[176:179], v[80:83]
    ds_read_b128 v[136:139], v5 offset:4096
    v_mfma_f32_16x16x32_bf16 v[84:87], v[204:207], v[176:179], v[84:87]
    ds_read_b128 v[140:143], v5 offset:6144
    v_mfma_f32_16x16x32_bf16 v[92:95], v[204:207], v[180:183], v[92:95]
    ds_read_b128 v[144:147], v5 offset:8192
    v_mfma_f32_16x16x32_bf16 v[88:91], v[200:203], v[180:183], v[88:91]
    ds_read_b128 v[148:151], v5 offset:10240
    v_mfma_f32_16x16x32_bf16 v[96:99], v[200:203], v[184:187], v[96:99]
    ds_read_b128 v[152:155], v5 offset:12288
    v_mfma_f32_16x16x32_bf16 v[100:103], v[204:207], v[184:187], v[100:103]
    ds_read_b128 v[156:159], v5 offset:14336
    v_mfma_f32_16x16x32_bf16 v[108:111], v[204:207], v[188:191], v[108:111]
    v_mfma_f32_16x16x32_bf16 v[104:107], v[200:203], v[188:191], v[104:107]
    v_mfma_f32_16x16x32_bf16 v[112:115], v[200:203], v[192:195], v[112:115]
    v_mfma_f32_16x16x32_bf16 v[116:119], v[204:207], v[192:195], v[116:119]
    v_mfma_f32_16x16x32_bf16 v[124:127], v[204:207], v[196:199], v[124:127]
    v_mfma_f32_16x16x32_bf16 v[120:123], v[200:203], v[196:199], v[120:123]
    s_cmp_eq_u32 s34, 7
    s_waitcnt lgkmcnt(0)
    s_cbranch_scc1 C_x7
C_x7_r:
    v_mfma_f32_16x16x32_bf16 v[64:67], v[160:163], v[128:131], v[64:67]
    ds_read_b128 v[200:203], v11 offset:0
    v_mfma_f32_16x16x32_bf16 v[68:71], v[164:167], v[128:131], v[68:71]
    ds_read_b128 v[204:207], v11 offset:2048
    v_mfma_f32_16x16x32_bf16 v[76:79], v[164:167], v[132:135], v[76:79]
    ds_read_b128 v[168:171], v7 offset:0
    v_mfma_f32_16x16x32_bf16 v[72:75], v[160:163], v[132:135], v[72:75]
    ds_read_b128 v[172:175], v7 offset:2048
    v_mfma_f32_16x16x32_bf16 v[80:83], v[160:163], v[136:139], v[80:83]
    ds_read_b128 v[176:179], v7 offset:4096
    v_mfma_f32_16x16x32_bf16 v[84:87], v[164:167], v[136:139], v[84:87]
    ds_read_b128 v[180:183], v7 offset:6144
    v_mfma_f32_16x16x32_bf16 v[92:95], v[164:167], v[140:143], v[92:95]
    ds_read_b128 v[184:187], v7 offset:8192
    v_mfma_f32_16x16x32_bf16 v[88:91], v[160:163], v[140:143], v[88:91]
    ds_read_b128 v[188:191], v7 offset:10240
    v_mfma_f32_16x16x32_bf16 v[96:99], v[160:163], v[144:147], v[96:99]
    ds_read_b128 v[192:195], v7 offset:12288
    v_mfma_f32_16x16x32_bf16 v[100:103], v[164:167], v[144:147], v[100:103]
    ds_read_b128 v[196:199], v7 offset:14336
    v_mfma_f32_16x16x32_bf16 v[108:111], v[164:167], v[148:151], v[108:111]
    v_mfma_f32_16x16x32_bf16 v[104:107], v[160:163], v[148:151], v[104:107]
    v_mfma_f32_16x16x32_bf16 v[112:115], v[160:163], v[152:155], v[112:115]
    v_mfma_f32_16x16x32_bf16 v[116:119], v[164:167], v[152:155], v[116:119]
    v_mfma_f32_16x16x32_bf16 v[124:127], v[164:167], v[156:159], v[124:127]
    v_mfma_f32_16x16x32_bf16 v[120:123], v[160:163], v[156:159], v[120:123]
    s_waitcnt lgkmcnt(0)
    s_barrier
    v_mfma_f32_16x16x32_bf16 v[64:67], v[200:203], v[168:171], v[64:67]
    ds_read_b128 v[160:163], v9 offset:32768
    v_mfma_f32_16x16x32_bf16 v[68:71], v[204:207], v[168:171], v[68:71]
    ds_read_b128 v[164:167], v9 offset:34816
    v_mfma_f32_16x16x32_bf16 v[76:79], v[204:207], v[172:175], v[76:79]
    ds_read_b128 v[128:131], v5 offset:32768
    v_mfma_f32_16x16x32_bf16 v[72:75], v[200:203], v[172:175], v[72:75]
    ds_read_b128 v[132:135], v5 offset:34816
    v_mfma_f32_16x16x32_bf16 v[80:83], v[200:203], v[176:179], v[80:83]
    ds_read_b128 v[136:139], v5 offset:36864
    v_mfma_f32_16x16x32_bf16 v[84:87], v[204:207], v[176:179], v[84:87]
    ds_read_b128 v[140:143], v5 offset:38912
    v_mfma_f32_16x16x32_bf16 v[92:95], v[204:207], v[180:183], v[92:95]
    ds_read_b128 v[144:147], v5 offset:40960
    v_mfma_f32_16x16x32_bf16 v[88:91], v[200:203], v[180:183], v[88:91]
    ds_read_b128 v[148:151], v5 offset:43008
    v_mfma_f32_16x16x32_bf16 v[96:99], v[200:203], v[184:187], v[96:99]
    ds_read_b128 v[152:155], v5 offset:45056
    v_mfma_f32_16x16x32_bf16 v[100:103], v[204:207], v[184:187], v[100:103]
    ds_read_b128 v[156:159], v5 offset:47104
    v_mfma_f32_16x16x32_bf16 v[108:111], v[204:207], v[188:191], v[108:111]
    v_mfma_f32_16x16x32_bf16 v[104:107], v[200:203], v[188:191], v[104:107]
    v_mfma_f32_16x16x32_bf16 v[112:115], v[200:203], v[192:195], v[112:115]
    v_mfma_f32_16x16x32_bf16 v[116:119], v[204:207], v[192:195], v[116:119]
    v_mfma_f32_16x16x32_bf16 v[124:127], v[204:207], v[196:199], v[124:127]
    v_mfma_f32_16x16x32_bf16 v[120:123], v[200:203], v[196:199], v[120:123]
    s_cmp_eq_u32 s34, 8
    s_waitcnt lgkmcnt(0)
    s_cbranch_scc1 C_x8
C_x8_r:
    v_mfma_f32_16x16x32_bf16 v[64:67], v[160:163], v[128:131], v[64:67]
    ds_read_b128 v[200:203], v11 offset:32768
    v_mfma_f32_16x16x32_bf16 v[68:71], v[164:167], v[128:131], v[68:71]
    ds_read_b128 v[204:207], v11 offset:34816
    v_mfma_f32_16x16x32_bf16 v[76:79], v[164:167], v[132:135], v[76:79]
    ds_read_b128 v[168:171], v7 offset:32768
    v_mfma_f32_16x16x32_bf16 v[72:75], v[160:163], v[132:135], v[72:75]
    ds_read_b128 v[172:175], v7 offset:34816
    v_mfma_f32_16x16x32_bf16 v[80:83], v[160:163], v[136:139], v[80:83]
    ds_read_b128 v[176:179], v7 offset:36864
    v_mfma_f32_16x16x32_bf16 v[84:87], v[164:167], v[136:139], v[84:87]
    ds_read_b128 v[180:183], v7 offset:38912
    v_mfma_f32_16x16x32_bf16 v[92:95], v[164:167], v[140:143], v[92:95]
    ds_read_b128 v[184:187], v7 offset:40960
    v_mfma_f32_16x16x32_bf16 v[88:91], v[160:163], v[140:143], v[88:91]
    ds_read_b128 v[188:191], v7 offset:43008
    v_mfma_f32_16x16x32_bf16 v[96:99], v[160:163], v[144:147], v[96:99]
    ds_read_b128 v[192:195], v7 offset:45056
    v_mfma_f32_16x16x32_bf16 v[100:103], v[164:167], v[144:147], v[100:103]
    ds_read_b128 v[196:199], v7 offset:47104
    v_mfma_f32_16x16x32_bf16 v[108:111], v[164:167], v[148:151], v[108:111]
    v_mfma_f32_16x16x32_bf16 v[104:107], v[160:163], v[148:151], v[104:107]
    v_mfma_f32_16x16x32_bf16 v[112:115], v[160:163], v[152:155], v[112:115]
    v_mfma_f32_16x16x32_bf16 v[116:119], v[164:167], v[152:155], v[116:119]
    v_mfma_f32_16x16x32_bf16 v[124:127], v[164:167], v[156:159], v[124:127]
    v_mfma_f32_16x16x32_bf16 v[120:123], v[160:163], v[156:159], v[120:123]
    s_waitcnt lgkmcnt(0)
    s_barrier
    v_mfma_f32_16x16x32_bf16 v[64:67], v[200:203], v[168:171], v[64:67]
    ds_read_b128 v[160:163], v8 offset:0
    v_mfma_f32_16x16x32_bf16 v[68:71], v[204:207], v[168:171], v[68:71]
    ds_read_b128 v[164:167], v8 offset:2048
    v_mfma_f32_16x16x32_bf16 v[76:79], v[204:207], v[172:175], v[76:79]
    ds_read_b128 v[128:131], v4 offset:0
    v_mfma_f32_16x16x32_bf16 v[72:75], v[200:203], v[172:175], v[72:75]
    ds_read_b128 v[132:135], v4 offset:2048
    v_mfma_f32_16x16x32_bf16 v[80:83], v[200:203], v[176:179], v[80:83]
    ds_read_b128 v[136:139], v4 offset:4096
    v_mfma_f32_16x16x32_bf16 v[84:87], v[204:207], v[176:179], v[84:87]
    ds_read_b128 v[140:143], v4 offset:6144
    v_mfma_f32_16x16x32_bf16 v[92:95], v[204:207], v[180:183], v[92:95]
    ds_read_b128 v[144:147], v4 offset:8192
    v_mfma_f32_16x16x32_bf16 v[88:91], v[200:203], v[180:183], v[88:91]
    ds_read_b128 v[148:151], v4 offset:10240
    v_mfma_f32_16x16x32_bf16 v[96:99], v[200:203], v[184:187], v[96:99]
    ds_read_b128 v[152:155], v4 offset:12288
    v_mfma_f32_16x16x32_bf16 v[100:103], v[204:207], v[184:187], v[100:103]
    ds_read_b128 v[156:159], v4 offset:14336
    v_mfma_f32_16x16x32_bf16 v[108:111], v[204:207], v[188:191], v[108:111]
    v_mfma_f32_16x16x32_bf16 v[104:107], v[200:203], v[188:191], v[104:107]
    v_mfma_f32_16x16x32_bf16 v[112:115], v[200:203], v[192:195], v[112:115]
    v_mfma_f32_16x16x32_bf16 v[116:119], v[204:207], v[192:195], v[116:119]
    v_mfma_f32_16x16x32_bf16 v[124:127], v[204:207], v[196:199], v[124:127]
    v_mfma_f32_16x16x32_bf16 v[120:123], v[200:203], v[196:199], v[120:123]
    s_cmp_eq_u32 s34, 9
    s_waitcnt lgkmcnt(0)
    s_cbranch_scc1 C_x9
C_x9_r:
    v_mfma_f32_16x16x32_bf16 v[64:67], v[160:163], v[128:131], v[64:67]
    ds_read_b128 v[200:203], v10 offset:0
    v_mfma_f32_16x16x32_bf16 v[68:71], v[164:167], v[128:131], v[68:71]
    ds_read_b128 v[204:207], v10 offset:2048
    v_mfma_f32_16x16x32_bf16 v[76:79], v[164:167], v[132:135], v[76:79]
    ds_read_b128 v[168:171], v6 offset:0
    v_mfma_f32_16x16x32_bf16 v[72:75], v[160:163], v[132:135], v[72:75]
    ds_read_b128 v[172:175], v6 offset:2048
    v_mfma_f32_16x16x32_bf16 v[80:83], v[160:163], v[136:139], v[80:83]
    ds_read_b128 v[176:179], v6 offset:4096
    v_mfma_f32_16x16x32_bf16 v[84:87], v[164:167], v[136:139], v[84:87]
    ds_read_b128 v[180:183], v6 offset:6144
    v_mfma_f32_16x16x32_bf16 v[92:95], v[164:167], v[140:143], v[92:95]
    ds_read_b128 v[184:187], v6 offset:8192
    v_mfma_f32_16x16x32_bf16 v[88:91], v[160:163], v[140:143], v[88:91]
    ds_read_b128 v[188:191], v6 offset:10240
    v_mfma_f32_16x16x32_bf16 v[96:99], v[160:163], v[144:147], v[96:99]
    ds_read_b128 v[192:195], v6 offset:12288
    v_mfma_f32_16x16x32_bf16 v[100:103], v[164:167], v[144:147], v[100:103]
    ds_read_b128 v[196:199], v6 offset:14336
    v_mfma_f32_16x16x32_bf16 v[108:111], v[164:167], v[148:151], v[108:111]
    v_mfma_f32_16x16x32_bf16 v[104:107], v[160:163], v[148:151], v[104:107]
    v_mfma_f32_16x16x32_bf16 v[112:115], v[160:163], v[152:155], v[112:115]
    v_mfma_f32_16x16x32_bf16 v[116:119], v[164:167], v[152:155], v[116:119]
    v_mfma_f32_16x16x32_bf16 v[124:127], v[164:167], v[156:159], v[124:127]
    v_mfma_f32_16x16x32_bf16 v[120:123], v[160:163], v[156:159], v[120:123]
    s_waitcnt lgkmcnt(0)
    s_barrier
    v_mfma_f32_16x16x32_bf16 v[64:67], v[200:203], v[168:171], v[64:67]
    ds_read_b128 v[160:163], v8 offset:32768
    v_mfma_f32_16x16x32_bf16 v[68:71], v[204:207], v[168:171], v[68:71]
    ds_read_b128 v[164:167], v8 offset:34816
    v_mfma_f32_16x16x32_bf16 v[76:79], v[204:207], v[172:175], v[76:79]
    ds_read_b128 v[128:131], v4 offset:32768
    v_mfma_f32_16x16x32_bf16 v[72:75], v[200:203], v[172:175], v[72:75]
    ds_read_b128 v[132:135], v4 offset:34816
    v_mfma_f32_16x16x32_bf16 v[80:83], v[200:203], v[176:179], v[80:83]
    ds_read_b128 v[136:139], v4 offset:36864
    v_mfma_f32_16x16x32_bf16 v[84:87], v[204:207], v[176:179], v[84:87]
    ds_read_b128 v[140:143], v4 offset:38912
    v_mfma_f32_16x16x32_bf16 v[92:95], v[204:207], v[180:183], v[92:95]
    ds_read_b128 v[144:147], v4 offset:40960
    v_mfma_f32_16x16x32_bf16 v[88:91], v[200:203], v[180:183], v[88:91]
    ds_read_b128 v[148:151], v4 offset:43008
    v_mfma_f32_16x16x32_bf16 v[96:99], v[200:203], v[184:187], v[96:99]
    ds_read_b128 v[152:155], v4 offset:45056
    v_mfma_f32_16x16x32_bf16 v[100:103], v[204:207], v[184:187], v[100:103]
    ds_read_b128 v[156:159], v4 offset:47104
    v_mfma_f32_16x16x32_bf16 v[108:111], v[204:207], v[188:191], v[108:111]
    v_mfma_f32_16x16x32_bf16 v[104:107], v[200:203], v[188:191], v[104:107]
    v_mfma_f32_16x16x32_bf16 v[112:115], v[200:203], v[192:195], v[112:115]
    v_mfma_f32_16x16x32_bf16 v[116:119], v[204:207], v[192:195], v[116:119]
    v_mfma_f32_16x16x32_bf16 v[124:127], v[204:207], v[196:199], v[124:127]
    v_mfma_f32_16x16x32_bf16 v[120:123], v[200:203], v[196:199], v[120:123]
    s_cmp_eq_u32 s34, 10
    s_waitcnt lgkmcnt(0)
    s_cbranch_scc1 C_x10
C_x10_r:
    v_mfma_f32_16x16x32_bf16 v[64:67], v[160:163], v[128:131], v[64:67]
    ds_read_b128 v[200:203], v10 offset:32768
    v_mfma_f32_16x16x32_bf16 v[68:71], v[164:167], v[128:131], v[68:71]
    ds_read_b128 v[204:207], v10 offset:34816
    v_mfma_f32_16x16x32_bf16 v[76:79], v[164:167], v[132:135], v[76:79]
    ds_read_b128 v[168:171], v6 offset:32768
    v_mfma_f32_16x16x32_bf16 v[72:75], v[160:163], v[132:135], v[72:75]
    ds_read_b128 v[172:175], v6 offset:34816
    v_mfma_f32_16x16x32_bf16 v[80:83], v[160:163], v[136:139], v[80:83]
    ds_read_b128 v[176:179], v6 offset:36864
    v_mfma_f32_16x16x32_bf16 v[84:87], v[164:167], v[136:139], v[84:87]
    ds_read_b128 v[180:183], v6 offset:38912
    v_mfma_f32_16x16x32_bf16 v[92:95], v[164:167], v[140:143], v[92:95]
    ds_read_b128 v[184:187], v6 offset:40960
    v_mfma_f32_16x16x32_bf16 v[88:91], v[160:163], v[140:143], v[88:91]
    ds_read_b128 v[188:191], v6 offset:43008
    v_mfma_f32_16x16x32_bf16 v[96:99], v[160:163], v[144:147], v[96:99]
    ds_read_b128 v[192:195], v6 offset:45056
    v_mfma_f32_16x16x32_bf16 v[100:103], v[164:167], v[144:147], v[100:103]
    ds_read_b128 v[196:199], v6 offset:47104
    v_mfma_f32_16x16x32_bf16 v[108:111], v[164:167], v[148:151], v[108:111]
    v_mfma_f32_16x16x32_bf16 v[104:107], v[160:163], v[148:151], v[104:107]
    v_mfma_f32_16x16x32_bf16 v[112:115], v[160:163], v[152:155], v[112:115]
    v_mfma_f32_16x16x32_bf16 v[116:119], v[164:167], v[152:155], v[116:119]
    v_mfma_f32_16x16x32_bf16 v[124:127], v[164:167], v[156:159], v[124:127]
    v_mfma_f32_16x16x32_bf16 v[120:123], v[160:163], v[156:159], v[120:123]
    buffer_load_dwordx2 v[244:245], v246, s[72:75], s21 offen sc1
    s_waitcnt lgkmcnt(0)
    s_barrier
    v_mfma_f32_16x16x32_bf16 v[64:67], v[200:203], v[168:171], v[64:67]
    ds_read_b128 v[160:163], v9 offset:0
    v_mfma_f32_16x16x32_bf16 v[68:71], v[204:207], v[168:171], v[68:71]
    ds_read_b128 v[164:167], v9 offset:2048
    v_mfma_f32_16x16x32_bf16 v[76:79], v[204:207], v[172:175], v[76:79]
    ds_read_b128 v[128:131], v5 offset:0
    v_mfma_f32_16x16x32_bf16 v[72:75], v[200:203], v[172:175], v[72:75]
    ds_read_b128 v[132:135], v5 offset:2048
    v_mfma_f32_16x16x32_bf16 v[80:83], v[200:203], v[176:179], v[80:83]
    ds_read_b128 v[136:139], v5 offset:4096
    v_mfma_f32_16x16x32_bf16 v[84:87], v[204:207], v[176:179], v[84:87]
    ds_read_b128 v[140:143], v5 offset:6144
    v_mfma_f32_16x16x32_bf16 v[92:95], v[204:207], v[180:183], v[92:95]
    ds_read_b128 v[144:147], v5 offset:8192
    v_mfma_f32_16x16x32_bf16 v[88:91], v[200:203], v[180:183], v[88:91]
    ds_read_b128 v[148:151], v5 offset:10240
    v_mfma_f32_16x16x32_bf16 v[96:99], v[200:203], v[184:187], v[96:99]
    ds_read_b128 v[152:155], v5 offset:12288
    v_mfma_f32_16x16x32_bf16 v[100:103], v[204:207], v[184:187], v[100:103]
    ds_read_b128 v[156:159], v5 offset:14336
    v_mfma_f32_16x16x32_bf16 v[108:111], v[204:207], v[188:191], v[108:111]
    v_mfma_f32_16x16x32_bf16 v[104:107], v[200:203], v[188:191], v[104:107]
    v_mfma_f32_16x16x32_bf16 v[112:115], v[200:203], v[192:195], v[112:115]
    v_mfma_f32_16x16x32_bf16 v[116:119], v[204:207], v[192:195], v[116:119]
    v_mfma_f32_16x16x32_bf16 v[124:127], v[204:207], v[196:199], v[124:127]
    v_mfma_f32_16x16x32_bf16 v[120:123], v[200:203], v[196:199], v[120:123]
    s_cmp_eq_u32 s34, 11
    s_waitcnt lgkmcnt(0)
    s_cbranch_scc1 C_x11
C_x11_r:
    v_mfma_f32_16x16x32_bf16 v[64:67], v[160:163], v[128:131], v[64:67]
    ds_read_b128 v[200:203], v11 offset:0
    v_mfma_f32_16x16x32_bf16 v[68:71], v[164:167], v[128:131], v[68:71]
    ds_read_b128 v[204:207], v11 offset:2048
    v_mfma_f32_16x16x32_bf16 v[76:79], v[164:167], v[132:135], v[76:79]
    ds_read_b128 v[168:171], v7 offset:0
    v_mfma_f32_16x16x32_bf16 v[72:75], v[160:163], v[132:135], v[72:75]
    ds_read_b128 v[172:175], v7 offset:2048
    v_mfma_f32_16x16x32_bf16 v[80:83], v[160:163], v[136:139], v[80:83]
    ds_read_b128 v[176:179], v7 offset:4096
    v_mfma_f32_16x16x32_bf16 v[84:87], v[164:167], v[136:139], v[84:87]
    ds_read_b128 v[180:183], v7 offset:6144
    v_mfma_f32_16x16x32_bf16 v[92:95], v[164:167], v[140:143], v[92:95]
    ds_read_b128 v[184:187], v7 offset:8192
    v_mfma_f32_16x16x32_bf16 v[88:91], v[160:163], v[140:143], v[88:91]
    ds_read_b128 v[188:191], v7 offset:10240
    v_mfma_f32_16x16x32_bf16 v[96:99], v[160:163], v[144:147], v[96:99]
    ds_read_b128 v[192:195], v7 offset:12288
    v_mfma_f32_16x16x32_bf16 v[100:103], v[164:167], v[144:147], v[100:103]
    ds_read_b128 v[196:199], v7 offset:14336
    v_mfma_f32_16x16x32_bf16 v[108:111], v[164:167], v[148:151], v[108:111]
    v_mfma_f32_16x16x32_bf16 v[104:107], v[160:163], v[148:151], v[104:107]
    v_mfma_f32_16x16x32_bf16 v[112:115], v[160:163], v[152:155], v[112:115]
    v_mfma_f32_16x16x32_bf16 v[116:119], v[164:167], v[152:155], v[116:119]
    v_mfma_f32_16x16x32_bf16 v[124:127], v[164:167], v[156:159], v[124:127]
    v_mfma_f32_16x16x32_bf16 v[120:123], v[160:163], v[156:159], v[120:123]
    s_waitcnt lgkmcnt(0)
    s_barrier
    v_mfma_f32_16x16x32_bf16 v[64:67], v[200:203], v[168:171], v[64:67]
    ds_read_b128 v[160:163], v9 offset:32768
    v_mfma_f32_16x16x32_bf16 v[68:71], v[204:207], v[168:171], v[68:71]
    ds_read_b128 v[164:167], v9 offset:34816
    v_mfma_f32_16x16x32_bf16 v[76:79], v[204:207], v[172:175], v[76:79]
    ds_read_b128 v[128:131], v5 offset:32768
    v_mfma_f32_16x16x32_bf16 v[72:75], v[200:203], v[172:175], v[72:75]
    ds_read_b128 v[132:135], v5 offset:34816
    v_mfma_f32_16x16x32_bf16 v[80:83], v[200:203], v[176:179], v[80:83]
    ds_read_b128 v[136:139], v5 offset:36864
    v_mfma_f32_16x16x32_bf16 v[84:87], v[204:207], v[176:179], v[84:87]
    ds_read_b128 v[140:143], v5 offset:38912
    v_mfma_f32_16x16x32_bf16 v[92:95], v[204:207], v[180:183], v[92:95]
    ds_read_b128 v[144:147], v5 offset:40960
    v_mfma_f32_16x16x32_bf16 v[88:91], v[200:203], v[180:183], v[88:91]
    ds_read_b128 v[148:151], v5 offset:43008
    v_mfma_f32_16x16x32_bf16 v[96:99], v[200:203], v[184:187], v[96:99]
    ds_read_b128 v[152:155], v5 offset:45056
    v_mfma_f32_16x16x32_bf16 v[100:103], v[204:207], v[184:187], v[100:103]
    ds_read_b128 v[156:159], v5 offset:47104
    v_mfma_f32_16x16x32_bf16 v[108:111], v[204:207], v[188:191], v[108:111]
    v_mfma_f32_16x16x32_bf16 v[104:107], v[200:203], v[188:191], v[104:107]
    v_mfma_f32_16x16x32_bf16 v[112:115], v[200:203], v[192:195], v[112:115]
    v_mfma_f32_16x16x32_bf16 v[116:119], v[204:207], v[192:195], v[116:119]
    v_mfma_f32_16x16x32_bf16 v[124:127], v[204:207], v[196:199], v[124:127]
    v_mfma_f32_16x16x32_bf16 v[120:123], v[200:203], v[196:199], v[120:123]
    s_cmp_eq_u32 s34, 12
    s_waitcnt lgkmcnt(0)
    s_cbranch_scc1 C_x12
C_x12_r:
    v_mfma_f32_16x16x32_bf16 v[64:67], v[160:163], v[128:131], v[64:67]
    ds_read_b128 v[200:203], v11 offset:32768
    v_mfma_f32_16x16x32_bf16 v[68:71], v[164:167], v[128:131], v[68:71]
    ds_read_b128 v[204:207], v11 offset:34816
    v_mfma_f32_16x16x32_bf16 v[76:79], v[164:167], v[132:135], v[76:79]
    ds_read_b128 v[168:171], v7 offset:32768
    v_mfma_f32_16x16x32_bf16 v[72:75], v[160:163], v[132:135], v[72:75]
    ds_read_b128 v[172:175], v7 offset:34816
    v_mfma_f32_16x16x32_bf16 v[80:83], v[160:163], v[136:139], v[80:83]
    ds_read_b128 v[176:179], v7 offset:36864
    v_mfma_f32_16x16x32_bf16 v[84:87], v[164:167], v[136:139], v[84:87]
    ds_read_b128 v[180:183], v7 offset:38912
    v_mfma_f32_16x16x32_bf16 v[92:95], v[164:167], v[140:143], v[92:95]
    ds_read_b128 v[184:187], v7 offset:40960
    v_mfma_f32_16x16x32_bf16 v[88:91], v[160:163], v[140:143], v[88:91]
    ds_read_b128 v[188:191], v7 offset:43008
    v_mfma_f32_16x16x32_bf16 v[96:99], v[160:163], v[144:147], v[96:99]
    ds_read_b128 v[192:195], v7 offset:45056
    v_mfma_f32_16x16x32_bf16 v[100:103], v[164:167], v[144:147], v[100:103]
    ds_read_b128 v[196:199], v7 offset:47104
    v_mfma_f32_16x16x32_bf16 v[108:111], v[164:167], v[148:151], v[108:111]
    v_mfma_f32_16x16x32_bf16 v[104:107], v[160:163], v[148:151], v[104:107]
    v_mfma_f32_16x16x32_bf16 v[112:115], v[160:163], v[152:155], v[112:115]
    v_mfma_f32_16x16x32_bf16 v[116:119], v[164:167], v[152:155], v[116:119]
    v_mfma_f32_16x16x32_bf16 v[124:127], v[164:167], v[156:159], v[124:127]
    v_mfma_f32_16x16x32_bf16 v[120:123], v[160:163], v[156:159], v[120:123]
    s_waitcnt lgkmcnt(0)
    s_barrier
    v_mfma_f32_16x16x32_bf16 v[64:67], v[200:203], v[168:171], v[64:67]
    ds_read_b128 v[160:163], v8 offset:0
    v_mfma_f32_16x16x32_bf16 v[68:71], v[204:207], v[168:171], v[68:71]
    ds_read_b128 v[164:167], v8 offset:2048
    v_mfma_f32_16x16x32_bf16 v[76:79], v[204:207], v[172:175], v[76:79]
    ds_read_b128 v[128:131], v4 offset:0
    v_mfma_f32_16x16x32_bf16 v[72:75], v[200:203], v[172:175], v[72:75]
    ds_read_b128 v[132:135], v4 offset:2048
    v_mfma_f32_16x16x32_bf16 v[80:83], v[200:203], v[176:179], v[80:83]
    ds_read_b128 v[136:139], v4 offset:4096
    v_mfma_f32_16x16x32_bf16 v[84:87], v[204:207], v[176:179], v[84:87]
    ds_read_b128 v[140:143], v4 offset:6144
    v_mfma_f32_16x16x32_bf16 v[92:95], v[204:207], v[180:183], v[92:95]
    ds_read_b128 v[144:147], v4 offset:8192
    v_mfma_f32_16x16x32_bf16 v[88:91], v[200:203], v[180:183], v[88:91]
    ds_read_b128 v[148:151], v4 offset:10240
    v_mfma_f32_16x16x32_bf16 v[96:99], v[200:203], v[184:187], v[96:99]
    ds_read_b128 v[152:155], v4 offset:12288
    v_mfma_f32_16x16x32_bf16 v[100:103], v[204:207], v[184:187], v[100:103]
    ds_read_b128 v[156:159], v4 offset:14336
    v_mfma_f32_16x16x32_bf16 v[108:111], v[204:207], v[188:191], v[108:111]
    v_mfma_f32_16x16x32_bf16 v[104:107], v[200:203], v[188:191], v[104:107]
    v_mfma_f32_16x16x32_bf16 v[112:115], v[200:203], v[192:195], v[112:115]
    v_mfma_f32_16x16x32_bf16 v[116:119], v[204:207], v[192:195], v[116:119]
    v_mfma_f32_16x16x32_bf16 v[124:127], v[204:207], v[196:199], v[124:127]
    v_mfma_f32_16x16x32_bf16 v[120:123], v[200:203], v[196:199], v[120:123]
    s_cmp_eq_u32 s34, 13
    s_waitcnt lgkmcnt(0)
    s_cbranch_scc1 C_x13
C_x13_r:
    s_waitcnt vmcnt(0)
    v_cmp_eq_u32 vcc, v244, v54
    v_cmp_eq_u32 s[54:55], v245, v55
    s_mov_b32 m0, s23
    s_and_b64 s[54:55], s[54:55], vcc
    s_cmp_eq_u64 s[54:55], -1
    s_cbranch_scc0 C_kvp
C_kvp_r:
    buffer_load_dwordx4 v247, s[68:71], s22 offen offset:0 sc1 lds
    buffer_load_dwordx4 v247, s[68:71], s22 offen offset:1024 sc1 lds
    buffer_load_dwordx4 v247, s[68:71], s22 offen offset:2048 sc1 lds
    buffer_load_dwordx4 v247, s[68:71], s22 offen offset:3072 sc1 lds
    v_mfma_f32_16x16x32_bf16 v[64:67], v[160:163], v[128:131], v[64:67]
    ds_read_b128 v[200:203], v10 offset:0
    v_mfma_f32_16x16x32_bf16 v[68:71], v[164:167], v[128:131], v[68:71]
    ds_read_b128 v[204:207], v10 offset:2048
    v_mfma_f32_16x16x32_bf16 v[76:79], v[164:167], v[132:135], v[76:79]
    ds_read_b128 v[168:171], v6 offset:0
    v_mfma_f32_16x16x32_bf16 v[72:75], v[160:163], v[132:135], v[72:75]
    ds_read_b128 v[172:175], v6 offset:2048
    v_mfma_f32_16x16x32_bf16 v[80:83], v[160:163], v[136:139], v[80:83]
    ds_read_b128 v[176:179], v6 offset:4096
    v_mfma_f32_16x16x32_bf16 v[84:87], v[164:167], v[136:139], v[84:87]
    ds_read_b128 v[180:183], v6 offset:6144
    v_mfma_f32_16x16x32_bf16 v[92:95], v[164:167], v[140:143], v[92:95]
    ds_read_b128 v[184:187], v6 offset:8192
    v_mfma_f32_16x16x32_bf16 v[88:91], v[160:163], v[140:143], v[88:91]
    ds_read_b128 v[188:191], v6 offset:10240
    v_mfma_f32_16x16x32_bf16 v[96:99], v[160:163], v[144:147], v[96:99]
    ds_read_b128 v[192:195], v6 offset:12288
    v_mfma_f32_16x16x32_bf16 v[100:103], v[164:167], v[144:147], v[100:103]
    ds_read_b128 v[196:199], v6 offset:14336
    v_mfma_f32_16x16x32_bf16 v[108:111], v[164:167], v[148:151], v[108:111]
    v_mfma_f32_16x16x32_bf16 v[104:107], v[160:163], v[148:151], v[104:107]
    v_mfma_f32_16x16x32_bf16 v[112:115], v[160:163], v[152:155], v[112:115]
    v_mfma_f32_16x16x32_bf16 v[116:119], v[164:167], v[152:155], v[116:119]
    v_mfma_f32_16x16x32_bf16 v[124:127], v[164:167], v[156:159], v[124:127]
    v_mfma_f32_16x16x32_bf16 v[120:123], v[160:163], v[156:159], v[120:123]
    s_waitcnt lgkmcnt(0)
    s_barrier
    v_mfma_f32_16x16x32_bf16 v[64:67], v[200:203], v[168:171], v[64:67]
    ds_read_b128 v[160:163], v8 offset:32768
    v_mfma_f32_16x16x32_bf16 v[68:71], v[204:207], v[168:171], v[68:71]
    ds_read_b128 v[164:167], v8 offset:34816
    v_mfma_f32_16x16x32_bf16 v[76:79], v[204:207], v[172:175], v[76:79]
    ds_read_b128 v[128:131], v4 offset:32768
    v_mfma_f32_16x16x32_bf16 v[72:75], v[200:203], v[172:175], v[72:75]
    ds_read_b128 v[132:135], v4 offset:34816
    v_mfma_f32_16x16x32_bf16 v[80:83], v[200:203], v[176:179], v[80:83]
    ds_read_b128 v[136:139], v4 offset:36864
    v_mfma_f32_16x16x32_bf16 v[84:87], v[204:207], v[176:179], v[84:87]
    ds_read_b128 v[140:143], v4 offset:38912
    v_mfma_f32_16x16x32_bf16 v[92:95], v[204:207], v[180:183], v[92:95]
    ds_read_b128 v[144:147], v4 offset:40960
    v_mfma_f32_16x16x32_bf16 v[88:91], v[200:203], v[180:183], v[88:91]
    ds_read_b128 v[148:151], v4 offset:43008
    v_mfma_f32_16x16x32_bf16 v[96:99], v[200:203], v[184:187], v[96:99]
    ds_read_b128 v[152:155], v4 offset:45056
    v_mfma_f32_16x16x32_bf16 v[100:103], v[204:207], v[184:187], v[100:103]
    ds_read_b128 v[156:159], v4 offset:47104
    v_mfma_f32_16x16x32_bf16 v[108:111], v[204:207], v[188:191], v[108:111]
    v_mfma_f32_16x16x32_bf16 v[104:107], v[200:203], v[188:191], v[104:107]
    v_mfma_f32_16x16x32_bf16 v[112:115], v[200:203], v[192:195], v[112:115]
    v_mfma_f32_16x16x32_bf16 v[116:119], v[204:207], v[192:195], v[116:119]
    v_mfma_f32_16x16x32_bf16 v[124:127], v[204:207], v[196:199], v[124:127]
    v_mfma_f32_16x16x32_bf16 v[120:123], v[200:203], v[196:199], v[120:123]
    s_cmp_eq_u32 s34, 14
    s_waitcnt lgkmcnt(0)
    s_cbranch_scc1 C_x14
C_x14_r:
    v_mfma_f32_16x16x32_bf16 v[64:67], v[160:163], v[128:131], v[64:67]
    ds_read_b128 v[200:203], v10 offset:32768
    v_mfma_f32_16x16x32_bf16 v[68:71], v[164:167], v[128:131], v[68:71]
    ds_read_b128 v[204:207], v10 offset:34816
    v_mfma_f32_16x16x32_bf16 v[76:79], v[164:167], v[132:135], v[76:79]
    ds_read_b128 v[168:171], v6 offset:32768
    v_mfma_f32_16x16x32_bf16 v[72:75], v[160:163], v[132:135], v[72:75]
    ds_read_b128 v[172:175], v6 offset:34816
    v_mfma_f32_16x16x32_bf16 v[80:83], v[160:163], v[136:139], v[80:83]
    ds_read_b128 v[176:179], v6 offset:36864
    v_mfma_f32_16x16x32_bf16 v[84:87], v[164:167], v[136:139], v[84:87]
    ds_read_b128 v[180:183], v6 offset:38912
    v_mfma_f32_16x16x32_bf16 v[92:95], v[164:167], v[140:143], v[92:95]
    ds_read_b128 v[184:187], v6 offset:40960
    v_mfma_f32_16x16x32_bf16 v[88:91], v[160:163], v[140:143], v[88:91]
    ds_read_b128 v[188:191], v6 offset:43008
    v_mfma_f32_16x16x32_bf16 v[96:99], v[160:163], v[144:147], v[96:99]
    ds_read_b128 v[192:195], v6 offset:45056
    v_mfma_f32_16x16x32_bf16 v[100:103], v[164:167], v[144:147], v[100:103]
    ds_read_b128 v[196:199], v6 offset:47104
    v_mfma_f32_16x16x32_bf16 v[108:111], v[164:167], v[148:151], v[108:111]
    v_mfma_f32_16x16x32_bf16 v[104:107], v[160:163], v[148:151], v[104:107]
    v_mfma_f32_16x16x32_bf16 v[112:115], v[160:163], v[152:155], v[112:115]
    v_mfma_f32_16x16x32_bf16 v[116:119], v[164:167], v[152:155], v[116:119]
    v_mfma_f32_16x16x32_bf16 v[124:127], v[164:167], v[156:159], v[124:127]
    v_mfma_f32_16x16x32_bf16 v[120:123], v[160:163], v[156:159], v[120:123]
    s_waitcnt lgkmcnt(0)
    s_barrier
    v_mfma_f32_16x16x32_bf16 v[64:67], v[200:203], v[168:171], v[64:67]
    ds_read_b128 v[160:163], v9 offset:0
    v_mfma_f32_16x16x32_bf16 v[68:71], v[204:207], v[168:171], v[68:71]
    ds_read_b128 v[164:167], v9 offset:2048
    v_mfma_f32_16x16x32_bf16 v[76:79], v[204:207], v[172:175], v[76:79]
    ds_read_b128 v[128:131], v5 offset:0
    v_mfma_f32_16x16x32_bf16 v[72:75], v[200:203], v[172:175], v[72:75]
    ds_read_b128 v[132:135], v5 offset:2048
    v_mfma_f32_16x16x32_bf16 v[80:83], v[200:203], v[176:179], v[80:83]
    ds_read_b128 v[136:139], v5 offset:4096
    v_mfma_f32_16x16x32_bf16 v[84:87], v[204:207], v[176:179], v[84:87]
    ds_read_b128 v[140:143], v5 offset:6144
    v_mfma_f32_16x16x32_bf16 v[92:95], v[204:207], v[180:183], v[92:95]
    ds_read_b128 v[144:147], v5 offset:8192
    v_mfma_f32_16x16x32_bf16 v[88:91], v[200:203], v[180:183], v[88:91]
    ds_read_b128 v[148:151], v5 offset:10240
    v_mfma_f32_16x16x32_bf16 v[96:99], v[200:203], v[184:187], v[96:99]
    ds_read_b128 v[152:155], v5 offset:12288
    v_mfma_f32_16x16x32_bf16 v[100:103], v[204:207], v[184:187], v[100:103]
    ds_read_b128 v[156:159], v5 offset:14336
    v_mfma_f32_16x16x32_bf16 v[108:111], v[204:207], v[188:191], v[108:111]
    v_mfma_f32_16x16x32_bf16 v[104:107], v[200:203], v[188:191], v[104:107]
    v_mfma_f32_16x16x32_bf16 v[112:115], v[200:203], v[192:195], v[112:115]
    v_mfma_f32_16x16x32_bf16 v[116:119], v[204:207], v[192:195], v[116:119]
    v_mfma_f32_16x16x32_bf16 v[124:127], v[204:207], v[196:199], v[124:127]
    v_mfma_f32_16x16x32_bf16 v[120:123], v[200:203], v[196:199], v[120:123]
    s_cmp_eq_u32 s34, 15
    s_waitcnt lgkmcnt(0)
    s_cbranch_scc1 C_x15
C_x15_r:
    v_mfma_f32_16x16x32_bf16 v[64:67], v[160:163], v[128:131], v[64:67]
    ds_read_b128 v[200:203], v11 offset:0
    v_mfma_f32_16x16x32_bf16 v[68:71], v[164:167], v[128:131], v[68:71]
    ds_read_b128 v[204:207], v11 offset:2048
    v_mfma_f32_16x16x32_bf16 v[76:79], v[164:167], v[132:135], v[76:79]
    ds_read_b128 v[168:171], v7 offset:0
    v_mfma_f32_16x16x32_bf16 v[72:75], v[160:163], v[132:135], v[72:75]
    ds_read_b128 v[172:175], v7 offset:2048
    v_mfma_f32_16x16x32_bf16 v[80:83], v[160:163], v[136:139], v[80:83]
    ds_read_b128 v[176:179], v7 offset:4096
    v_mfma_f32_16x16x32_bf16 v[84:87], v[164:167], v[136:139], v[84:87]
    ds_read_b128 v[180:183], v7 offset:6144
    v_mfma_f32_16x16x32_bf16 v[92:95], v[164:167], v[140:143], v[92:95]
    ds_read_b128 v[184:187], v7 offset:8192
    v_mfma_f32_16x16x32_bf16 v[88:91], v[160:163], v[140:143], v[88:91]
    ds_read_b128 v[188:191], v7 offset:10240
    v_mfma_f32_16x16x32_bf16 v[96:99], v[160:163], v[144:147], v[96:99]
    ds_read_b128 v[192:195], v7 offset:12288
    v_mfma_f32_16x16x32_bf16 v[100:103], v[164:167], v[144:147], v[100:103]
    ds_read_b128 v[196:199], v7 offset:14336
    v_mfma_f32_16x16x32_bf16 v[108:111], v[164:167], v[148:151], v[108:111]
    v_mfma_f32_16x16x32_bf16 v[104:107], v[160:163], v[148:151], v[104:107]
    v_mfma_f32_16x16x32_bf16 v[112:115], v[160:163], v[152:155], v[112:115]
    v_mfma_f32_16x16x32_bf16 v[116:119], v[164:167], v[152:155], v[116:119]
    v_mfma_f32_16x16x32_bf16 v[124:127], v[164:167], v[156:159], v[124:127]
    v_mfma_f32_16x16x32_bf16 v[120:123], v[160:163], v[156:159], v[120:123]
    s_waitcnt vmcnt(0)
    s_waitcnt lgkmcnt(0)
    v_mov_b32 v3, 1
    v_mov_b32 v15, 2
    ds_write_b32 v63, v3 offset:64
    ds_write_b32 v63, v54 offset:16
    v_mfma_f32_16x16x32_bf16 v[64:67], v[200:203], v[168:171], v[64:67]
    v_mfma_f32_16x16x32_bf16 v[68:71], v[204:207], v[168:171], v[68:71]
    v_mfma_f32_16x16x32_bf16 v[76:79], v[204:207], v[172:175], v[76:79]
    v_mfma_f32_16x16x32_bf16 v[72:75], v[200:203], v[172:175], v[72:75]
    v_mfma_f32_16x16x32_bf16 v[80:83], v[200:203], v[176:179], v[80:83]
    v_mfma_f32_16x16x32_bf16 v[84:87], v[204:207], v[176:179], v[84:87]
    v_mfma_f32_16x16x32_bf16 v[92:95], v[204:207], v[180:183], v[92:95]
    v_mfma_f32_16x16x32_bf16 v[88:91], v[200:203], v[180:183], v[88:91]
    v_mfma_f32_16x16x32_bf16 v[96:99], v[200:203], v[184:187], v[96:99]
    v_mfma_f32_16x16x32_bf16 v[100:103], v[204:207], v[184:187], v[100:103]
    v_mfma_f32_16x16x32_bf16 v[108:111], v[204:207], v[188:191], v[108:111]
    v_mfma_f32_16x16x32_bf16 v[104:107], v[200:203], v[188:191], v[104:107]
    v_mfma_f32_16x16x32_bf16 v[112:115], v[200:203], v[192:195], v[112:115]
    v_mfma_f32_16x16x32_bf16 v[116:119], v[204:207], v[192:195], v[116:119]
    v_mfma_f32_16x16x32_bf16 v[124:127], v[204:207], v[196:199], v[124:127]
    v_mfma_f32_16x16x32_bf16 v[120:123], v[200:203], v[196:199], v[120:123]
    s_nop 3
    v_pk_fma_f32 v[136:137], v[16:17], v[64:65], v[72:73]
    v_pk_fma_f32 v[140:141], v[16:17], v[68:69], v[76:77]
    v_pk_fma_f32 v[138:139], v[18:19], v[66:67], v[74:75]
    v_pk_fma_f32 v[142:143], v[18:19], v[70:71], v[78:79]
    v_pk_fma_f32 v[136:137], v[20:21], v[68:69], v[136:137] neg_lo:[1,0,0] neg_hi:[1,0,0]
    v_pk_fma_f32 v[140:141], v[20:21], v[64:65], v[140:141]
    v_pk_fma_f32 v[138:139], v[22:23], v[70:71], v[138:139] neg_lo:[1,0,0] neg_hi:[1,0,0]
    v_pk_fma_f32 v[142:143], v[22:23], v[66:67], v[142:143]
    v_pk_fma_f32 v[128:129], v[16:17], v[136:137], v[80:81]
    v_pk_fma_f32 v[132:133], v[16:17], v[140:141], v[84:85]
    v_pk_fma_f32 v[130:131], v[18:19], v[138:139], v[82:83]
    v_pk_fma_f32 v[134:135], v[18:19], v[142:143], v[86:87]
    v_pk_fma_f32 v[128:129], v[20:21], v[140:141], v[128:129] neg_lo:[1,0,0] neg_hi:[1,0,0]
    v_pk_fma_f32 v[132:133], v[20:21], v[136:137], v[132:133]
    v_pk_fma_f32 v[130:131], v[22:23], v[142:143], v[130:131] neg_lo:[1,0,0] neg_hi:[1,0,0]
    v_pk_fma_f32 v[134:135], v[22:23], v[138:139], v[134:135]
    v_pk_fma_f32 v[136:137], v[16:17], v[128:129], v[88:89]
    v_pk_fma_f32 v[140:141], v[16:17], v[132:133], v[92:93]
    v_pk_fma_f32 v[138:139], v[18:19], v[130:131], v[90:91]
    v_pk_fma_f32 v[142:143], v[18:19], v[134:135], v[94:95]
    v_pk_fma_f32 v[136:137], v[20:21], v[132:133], v[136:137] neg_lo:[1,0,0] neg_hi:[1,0,0]
    v_pk_fma_f32 v[140:141], v[20:21], v[128:129], v[140:141]
    v_pk_fma_f32 v[138:139], v[22:23], v[134:135], v[138:139] neg_lo:[1,0,0] neg_hi:[1,0,0]
    v_pk_fma_f32 v[142:143], v[22:23], v[130:131], v[142:143]
    v_pk_fma_f32 v[128:129], v[16:17], v[136:137], v[96:97]
    v_pk_fma_f32 v[132:133], v[16:17], v[140:141], v[100:101]
    v_pk_fma_f32 v[130:131], v[18:19], v[138:139], v[98:99]
    v_pk_fma_f32 v[134:135], v[18:19], v[142:143], v[102:103]
    v_pk_fma_f32 v[128:129], v[20:21], v[140:141], v[128:129] neg_lo:[1,0,0] neg_hi:[1,0,0]
    v_pk_fma_f32 v[132:133], v[20:21], v[136:137], v[132:133]
    v_pk_fma_f32 v[130:131], v[22:23], v[142:143], v[130:131] neg_lo:[1,0,0] neg_hi:[1,0,0]
    v_pk_fma_f32 v[134:135], v[22:23], v[138:139], v[134:135]
    v_pk_fma_f32 v[136:137], v[16:17], v[128:129], v[104:105]
    v_pk_fma_f32 v[140:141], v[16:17], v[132:133], v[108:109]
    v_pk_fma_f32 v[138:139], v[18:19], v[130:131], v[106:107]
    v_pk_fma_f32 v[142:143], v[18:19], v[134:135], v[110:111]
    v_pk_fma_f32 v[136:137], v[20:21], v[132:133], v[136:137] neg_lo:[1,0,0] neg_hi:[1,0,0]
    v_pk_fma_f32 v[140:141], v[20:21], v[128:129], v[140:141]
    v_pk_fma_f32 v[138:139], v[22:23], v[134:135], v[138:139] neg_lo:[1,0,0] neg_hi:[1,0,0]
    v_pk_fma_f32 v[142:143], v[22:23], v[130:131], v[142:143]
    v_pk_fma_f32 v[128:129], v[16:17], v[136:137], v[112:113]
    v_pk_fma_f32 v[132:133], v[16:17], v[140:141], v[116:117]
    v_pk_fma_f32 v[130:131], v[18:19], v[138:139], v[114:115]
    v_pk_fma_f32 v[134:135], v[18:19], v[142:143], v[118:119]
    v_pk_fma_f32 v[128:129], v[20:21], v[140:141], v[128:129] neg_lo:[1,0,0] neg_hi:[1,0,0]
    v_pk_fma_f32 v[132:133], v[20:21], v[136:137], v[132:133]
    v_pk_fma_f32 v[130:131], v[22:23], v[142:143], v[130:131] neg_lo:[1,0,0] neg_hi:[1,0,0]
    v_pk_fma_f32 v[134:135], v[22:23], v[138:139], v[134:135]
    v_pk_fma_f32 v[136:137], v[16:17], v[128:129], v[120:121]
    v_pk_fma_f32 v[140:141], v[16:17], v[132:133], v[124:125]
    v_pk_fma_f32 v[138:139], v[18:19], v[130:131], v[122:123]
    v_pk_fma_f32 v[142:143], v[18:19], v[134:135], v[126:127]
    v_pk_fma_f32 v[136:137], v[20:21], v[132:133], v[136:137] neg_lo:[1,0,0] neg_hi:[1,0,0]
    v_pk_fma_f32 v[140:141], v[20:21], v[128:129], v[140:141]
    v_pk_fma_f32 v[138:139], v[22:23], v[134:135], v[138:139] neg_lo:[1,0,0] neg_hi:[1,0,0]
    v_pk_fma_f32 v[142:143], v[22:23], v[130:131], v[142:143]
    v_mul_f32_dpp v144, v32, v136 row_mirror row_mask:0xf bank_mask:0xf
    v_mul_f32_dpp v148, v32, v140 row_mirror row_mask:0xf bank_mask:0xf
    v_mul_f32_dpp v145, v33, v137 row_mirror row_mask:0xf bank_mask:0xf
    v_mul_f32_dpp v149, v33, v141 row_mirror row_mask:0xf bank_mask:0xf
    v_mul_f32_dpp v146, v34, v138 row_mirror row_mask:0xf bank_mask:0xf
    v_mul_f32_dpp v150, v34, v142 row_mirror row_mask:0xf bank_mask:0xf
    v_mul_f32_dpp v147, v35, v139 row_mirror row_mask:0xf bank_mask:0xf
    v_mul_f32_dpp v151, v35, v143 row_mirror row_mask:0xf bank_mask:0xf
    v_fmac_f32_dpp v144, -v36, v140 row_mirror row_mask:0xf bank_mask:0xf
    v_fmac_f32_dpp v148, v36, v136 row_mirror row_mask:0xf bank_mask:0xf
    v_fmac_f32_dpp v145, -v37, v141 row_mirror row_mask:0xf bank_mask:0xf
    v_fmac_f32_dpp v149, v37, v137 row_mirror row_mask:0xf bank_mask:0xf
    v_fmac_f32_dpp v146, -v38, v142 row_mirror row_mask:0xf bank_mask:0xf
    v_fmac_f32_dpp v150, v38, v138 row_mirror row_mask:0xf bank_mask:0xf
    v_fmac_f32_dpp v147, -v39, v143 row_mirror row_mask:0xf bank_mask:0xf
    v_fmac_f32_dpp v151, v39, v139 row_mirror row_mask:0xf bank_mask:0xf
    v_add_f32_dpp v144, v144, v144 quad_perm:[1,0,3,2] row_mask:0xf bank_mask:0xf
    v_add_f32_dpp v148, v148, v148 quad_perm:[1,0,3,2] row_mask:0xf bank_mask:0xf
    v_add_f32_dpp v145, v145, v145 quad_perm:[1,0,3,2] row_mask:0xf bank_mask:0xf
    v_add_f32_dpp v149, v149, v149 quad_perm:[1,0,3,2] row_mask:0xf bank_mask:0xf
    v_add_f32_dpp v146, v146, v146 quad_perm:[1,0,3,2] row_mask:0xf bank_mask:0xf
    v_add_f32_dpp v150, v150, v150 quad_perm:[1,0,3,2] row_mask:0xf bank_mask:0xf
    v_add_f32_dpp v147, v147, v147 quad_perm:[1,0,3,2] row_mask:0xf bank_mask:0xf
    v_add_f32_dpp v151, v151, v151 quad_perm:[1,0,3,2] row_mask:0xf bank_mask:0xf
    v_cndmask_b32 v44, v144, v145, s[48:49]
    v_cndmask_b32 v45, v146, v147, s[48:49]
    v_cndmask_b32 v46, v148, v149, s[48:49]
    v_cndmask_b32 v47, v150, v151, s[48:49]
    s_nop 0
    v_add_f32_dpp v44, v44, v44 quad_perm:[2,3,0,1] row_mask:0xf bank_mask:0xf
    v_add_f32_dpp v45, v45, v45 quad_perm:[2,3,0,1] row_mask:0xf bank_mask:0xf
    v_add_f32_dpp v46, v46, v46 quad_perm:[2,3,0,1] row_mask:0xf bank_mask:0xf
    v_add_f32_dpp v47, v47, v47 quad_perm:[2,3,0,1] row_mask:0xf bank_mask:0xf
    v_cndmask_b32 v52, v44, v45, s[50:51]
    v_cndmask_b32 v53, v46, v47, s[50:51]
    s_nop 0
    v_add_f32_dpp v52, v52, v52 row_ror:4 row_mask:0xf bank_mask:0xf
    v_add_f32_dpp v53, v53, v53 row_ror:4 row_mask:0xf bank_mask:0xf
    s_nop 0
    v_add_f32_dpp v52, v52, v52 row_ror:8 row_mask:0xf bank_mask:0xf
    v_add_f32_dpp v53, v53, v53 row_ror:8 row_mask:0xf bank_mask:0xf
    s_mov_b64 exec, s[52:53]
    buffer_store_dwordx4 v[52:55], v60, s[12:15], 0 offen sc1
    s_mov_b64 exec, -1
    buffer_load_dwordx4 v[152:155], v56, s[12:15], 0 offen sc1
    buffer_load_dwordx4 v[156:159], v57, s[12:15], 0 offen sc1
    buffer_load_dwordx4 v[160:163], v58, s[12:15], 0 offen sc1
    buffer_load_dwordx4 v[164:167], v59, s[12:15], 0 offen sc1
    ds_write_b32 v63, v15 offset:64
    v_mov_b32_dpp v128, v136 row_shr:1 row_mask:0xf bank_mask:0xf bound_ctrl:0
    v_mov_b32_dpp v129, v137 row_shr:1 row_mask:0xf bank_mask:0xf bound_ctrl:0
    v_mov_b32_dpp v130, v138 row_shr:1 row_mask:0xf bank_mask:0xf bound_ctrl:0
    v_mov_b32_dpp v131, v139 row_shr:1 row_mask:0xf bank_mask:0xf bound_ctrl:0
    v_mov_b32_dpp v132, v140 row_shr:1 row_mask:0xf bank_mask:0xf bound_ctrl:0
    v_mov_b32_dpp v133, v141 row_shr:1 row_mask:0xf bank_mask:0xf bound_ctrl:0
    v_mov_b32_dpp v134, v142 row_shr:1 row_mask:0xf bank_mask:0xf bound_ctrl:0
    v_mov_b32_dpp v135, v143 row_shr:1 row_mask:0xf bank_mask:0xf bound_ctrl:0
    s_nop 0
    v_mov_b32_dpp v168, v128 row_shr:1 row_mask:0xf bank_mask:0xf bound_ctrl:0
    v_mov_b32_dpp v169, v129 row_shr:1 row_mask:0xf bank_mask:0xf bound_ctrl:0
    v_mov_b32_dpp v170, v130 row_shr:1 row_mask:0xf bank_mask:0xf bound_ctrl:0
    v_mov_b32_dpp v171, v131 row_shr:1 row_mask:0xf bank_mask:0xf bound_ctrl:0
    v_mov_b32_dpp v172, v132 row_shr:1 row_mask:0xf bank_mask:0xf bound_ctrl:0
    v_mov_b32_dpp v173, v133 row_shr:1 row_mask:0xf bank_mask:0xf bound_ctrl:0
    v_mov_b32_dpp v174, v134 row_shr:1 row_mask:0xf bank_mask:0xf bound_ctrl:0
    v_mov_b32_dpp v175, v135 row_shr:1 row_mask:0xf bank_mask:0xf bound_ctrl:0
    v_fmac_f32_dpp v128, v32, v168 row_newbcast:1 row_mask:0xf bank_mask:0xf
    v_fmac_f32_dpp v129, v33, v169 row_newbcast:1 row_mask:0xf bank_mask:0xf
    v_fmac_f32_dpp v130, v34, v170 row_newbcast:1 row_mask:0xf bank_mask:0xf
    v_fmac_f32_dpp v131, v35, v171 row_newbcast:1 row_mask:0xf bank_mask:0xf
    v_fmac_f32_dpp v132, v32, v172 row_newbcast:1 row_mask:0xf bank_mask:0xf
    v_fmac_f32_dpp v133, v33, v173 row_newbcast:1 row_mask:0xf bank_mask:0xf
    v_fmac_f32_dpp v134, v34, v174 row_newbcast:1 row_mask:0xf bank_mask:0xf
    v_fmac_f32_dpp v135, v35, v175 row_newbcast:1 row_mask:0xf bank_mask:0xf
    v_fmac_f32_dpp v128, -v36, v172 row_newbcast:1 row_mask:0xf bank_mask:0xf
    v_fmac_f32_dpp v129, -v37, v173 row_newbcast:1 row_mask:0xf bank_mask:0xf
    v_fmac_f32_dpp v130, -v38, v174 row_newbcast:1 row_mask:0xf bank_mask:0xf
    v_fmac_f32_dpp v131, -v39, v175 row_newbcast:1 row_mask:0xf bank_mask:0xf
    v_fmac_f32_dpp v132, v36, v168 row_newbcast:1 row_mask:0xf bank_mask:0xf
    v_fmac_f32_dpp v133, v37, v169 row_newbcast:1 row_mask:0xf bank_mask:0xf
    v_fmac_f32_dpp v134, v38, v170 row_newbcast:1 row_mask:0xf bank_mask:0xf
    v_fmac_f32_dpp v135, v39, v171 row_newbcast:1 row_mask:0xf bank_mask:0xf
    v_mov_b32_dpp v168, v128 row_shr:2 row_mask:0xf bank_mask:0xf bound_ctrl:0
    v_mov_b32_dpp v169, v129 row_shr:2 row_mask:0xf bank_mask:0xf bound_ctrl:0
    v_mov_b32_dpp v170, v130 row_shr:2 row_mask:0xf bank_mask:0xf bound_ctrl:0
    v_mov_b32_dpp v171, v131 row_shr:2 row_mask:0xf bank_mask:0xf bound_ctrl:0
    v_mov_b32_dpp v172, v132 row_shr:2 row_mask:0xf bank_mask:0xf bound_ctrl:0
    v_mov_b32_dpp v173, v133 row_shr:2 row_mask:0xf bank_mask:0xf bound_ctrl:0
    v_mov_b32_dpp v174, v134 row_shr:2 row_mask:0xf bank_mask:0xf bound_ctrl:0
    v_mov_b32_dpp v175, v135 row_shr:2 row_mask:0xf bank_mask:0xf bound_ctrl:0
    v_fmac_f32_dpp v128, v32, v168 row_newbcast:2 row_mask:0xf bank_mask:0xf
    v_fmac_f32_dpp v129, v33, v169 row_newbcast:2 row_mask:0xf bank_mask:0xf
    v_fmac_f32_dpp v130, v34, v170 row_newbcast:2 row_mask:0xf bank_mask:0xf
    v_fmac_f32_dpp v131, v35, v171 row_newbcast:2 row_mask:0xf bank_mask:0xf
    v_fmac_f32_dpp v132, v32, v172 row_newbcast:2 row_mask:0xf bank_mask:0xf
    v_fmac_f32_dpp v133, v33, v173 row_newbcast:2 row_mask:0xf bank_mask:0xf
    v_fmac_f32_dpp v134, v34, v174 row_newbcast:2 row_mask:0xf bank_mask:0xf
    v_fmac_f32_dpp v135, v35, v175 row_newbcast:2 row_mask:0xf bank_mask:0xf
    v_fmac_f32_dpp v128, -v36, v172 row_newbcast:2 row_mask:0xf bank_mask:0xf
    v_fmac_f32_dpp v129, -v37, v173 row_newbcast:2 row_mask:0xf bank_mask:0xf
    v_fmac_f32_dpp v130, -v38, v174 row_newbcast:2 row_mask:0xf bank_mask:0xf
    v_fmac_f32_dpp v131, -v39, v175 row_newbcast:2 row_mask:0xf bank_mask:0xf
    v_fmac_f32_dpp v132, v36, v168 row_newbcast:2 row_mask:0xf bank_mask:0xf
    v_fmac_f32_dpp v133, v37, v169 row_newbcast:2 row_mask:0xf bank_mask:0xf
    v_fmac_f32_dpp v134, v38, v170 row_newbcast:2 row_mask:0xf bank_mask:0xf
    v_fmac_f32_dpp v135, v39, v171 row_newbcast:2 row_mask:0xf bank_mask:0xf
    v_mov_b32_dpp v168, v128 row_shr:4 row_mask:0xf bank_mask:0xf bound_ctrl:0
    v_mov_b32_dpp v169, v129 row_shr:4 row_mask:0xf bank_mask:0xf bound_ctrl:0
    v_mov_b32_dpp v170, v130 row_shr:4 row_mask:0xf bank_mask:0xf bound_ctrl:0
    v_mov_b32_dpp v171, v131 row_shr:4 row_mask:0xf bank_mask:0xf bound_ctrl:0
    v_mov_b32_dpp v172, v132 row_shr:4 row_mask:0xf bank_mask:0xf bound_ctrl:0
    v_mov_b32_dpp v173, v133 row_shr:4 row_mask:0xf bank_mask:0xf bound_ctrl:0
    v_mov_b32_dpp v174, v134 row_shr:4 row_mask:0xf bank_mask:0xf bound_ctrl:0
    v_mov_b32_dpp v175, v135 row_shr:4 row_mask:0xf bank_mask:0xf bound_ctrl:0
    v_fmac_f32_dpp v128, v32, v168 row_newbcast:4 row_mask:0xf bank_mask:0xf
    v_fmac_f32_dpp v129, v33, v169 row_newbcast:4 row_mask:0xf bank_mask:0xf
    v_fmac_f32_dpp v130, v34, v170 row_newbcast:4 row_mask:0xf bank_mask:0xf
    v_fmac_f32_dpp v131, v35, v171 row_newbcast:4 row_mask:0xf bank_mask:0xf
    v_fmac_f32_dpp v132, v32, v172 row_newbcast:4 row_mask:0xf bank_mask:0xf
    v_fmac_f32_dpp v133, v33, v173 row_newbcast:4 row_mask:0xf bank_mask:0xf
    v_fmac_f32_dpp v134, v34, v174 row_newbcast:4 row_mask:0xf bank_mask:0xf
    v_fmac_f32_dpp v135, v35, v175 row_newbcast:4 row_mask:0xf bank_mask:0xf
    v_fmac_f32_dpp v128, -v36, v172 row_newbcast:4 row_mask:0xf bank_mask:0xf
    v_fmac_f32_dpp v129, -v37, v173 row_newbcast:4 row_mask:0xf bank_mask:0xf
    v_fmac_f32_dpp v130, -v38, v174 row_newbcast:4 row_mask:0xf bank_mask:0xf
    v_fmac_f32_dpp v131, -v39, v175 row_newbcast:4 row_mask:0xf bank_mask:0xf
    v_fmac_f32_dpp v132, v36, v168 row_newbcast:4 row_mask:0xf bank_mask:0xf
    v_fmac_f32_dpp v133, v37, v169 row_newbcast:4 row_mask:0xf bank_mask:0xf
    v_fmac_f32_dpp v134, v38, v170 row_newbcast:4 row_mask:0xf bank_mask:0xf
    v_fmac_f32_dpp v135, v39, v171 row_newbcast:4 row_mask:0xf bank_mask:0xf
    v_mov_b32_dpp v168, v128 row_shr:8 row_mask:0xf bank_mask:0xf bound_ctrl:0
    v_mov_b32_dpp v169, v129 row_shr:8 row_mask:0xf bank_mask:0xf bound_ctrl:0
    v_mov_b32_dpp v170, v130 row_shr:8 row_mask:0xf bank_mask:0xf bound_ctrl:0
    v_mov_b32_dpp v171, v131 row_shr:8 row_mask:0xf bank_mask:0xf bound_ctrl:0
    v_mov_b32_dpp v172, v132 row_shr:8 row_mask:0xf bank_mask:0xf bound_ctrl:0
    v_mov_b32_dpp v173, v133 row_shr:8 row_mask:0xf bank_mask:0xf bound_ctrl:0
    v_mov_b32_dpp v174, v134 row_shr:8 row_mask:0xf bank_mask:0xf bound_ctrl:0
    v_mov_b32_dpp v175, v135 row_shr:8 row_mask:0xf bank_mask:0xf bound_ctrl:0
    v_fmac_f32_dpp v128, v32, v168 row_newbcast:8 row_mask:0xf bank_mask:0xf
    v_fmac_f32_dpp v129, v33, v169 row_newbcast:8 row_mask:0xf bank_mask:0xf
    v_fmac_f32_dpp v130, v34, v170 row_newbcast:8 row_mask:0xf bank_mask:0xf
    v_fmac_f32_dpp v131, v35, v171 row_newbcast:8 row_mask:0xf bank_mask:0xf
    v_fmac_f32_dpp v132, v32, v172 row_newbcast:8 row_mask:0xf bank_mask:0xf
    v_fmac_f32_dpp v133, v33, v173 row_newbcast:8 row_mask:0xf bank_mask:0xf
    v_fmac_f32_dpp v134, v34, v174 row_newbcast:8 row_mask:0xf bank_mask:0xf
    v_fmac_f32_dpp v135, v35, v175 row_newbcast:8 row_mask:0xf bank_mask:0xf
    v_fmac_f32_dpp v128, -v36, v172 row_newbcast:8 row_mask:0xf bank_mask:0xf
    v_fmac_f32_dpp v129, -v37, v173 row_newbcast:8 row_mask:0xf bank_mask:0xf
    v_fmac_f32_dpp v130, -v38, v174 row_newbcast:8 row_mask:0xf bank_mask:0xf
    v_fmac_f32_dpp v131, -v39, v175 row_newbcast:8 row_mask:0xf bank_mask:0xf
    v_fmac_f32_dpp v132, v36, v168 row_newbcast:8 row_mask:0xf bank_mask:0xf
    v_fmac_f32_dpp v133, v37, v169 row_newbcast:8 row_mask:0xf bank_mask:0xf
    v_fmac_f32_dpp v134, v38, v170 row_newbcast:8 row_mask:0xf bank_mask:0xf
    v_fmac_f32_dpp v135, v39, v171 row_newbcast:8 row_mask:0xf bank_mask:0xf
    v_mul_f32 v184, v24, v128
    v_mul_f32 v185, v25, v129
    v_mul_f32 v188, -v24, v132
    v_mul_f32 v189, -v25, v133
    v_mul_f32 v186, v26, v130
    v_mul_f32 v187, v27, v131
    v_mul_f32 v190, -v26, v134
    v_mul_f32 v191, -v27, v135
    v_fma_f32 v184, -v28, v132, v184
    v_fma_f32 v185, -v29, v133, v185
    v_fma_f32 v188, -v28, v128, v188
    v_fma_f32 v189, -v29, v129, v189
    v_fma_f32 v186, -v30, v134, v186
    v_fma_f32 v187, -v31, v135, v187
    v_fma_f32 v190, -v30, v130, v190
    v_fma_f32 v191, -v31, v131, v191
    v_mul_f32 v192, v24, v32
    v_mul_f32 v193, v25, v33
    v_mul_f32 v196, v24, v36
    v_mul_f32 v197, v25, v37
    v_mul_f32 v194, v26, v34
    v_mul_f32 v195, v27, v35
    v_mul_f32 v198, v26, v38
    v_mul_f32 v199, v27, v39
    v_fma_f32 v192, -v28, v36, v192
    v_fma_f32 v193, -v29, v37, v193
    v_fmac_f32 v196, v28, v32
    v_fmac_f32 v197, v29, v33
    v_fma_f32 v194, -v30, v38, v194
    v_fma_f32 v195, -v31, v39, v195
    v_fmac_f32 v198, v30, v34
    v_fmac_f32 v199, v31, v35
    v_mul_f32 v200, v24, v64
    v_mul_f32 v201, v25, v65
    v_mul_f32 v202, v26, v66
    v_mul_f32 v203, v27, v67
    v_fma_f32 v200, -v28, v68, v200
    v_fma_f32 v201, -v29, v69, v201
    v_fma_f32 v202, -v30, v70, v202
    v_fma_f32 v203, -v31, v71, v203
    v_mul_f32 v68, -v24, v68
    v_mul_f32 v69, -v25, v69
    v_mul_f32 v70, -v26, v70
    v_mul_f32 v71, -v27, v71
    v_fma_f32 v68, -v28, v64, v68
    v_fma_f32 v69, -v29, v65, v69
    v_fma_f32 v70, -v30, v66, v70
    v_fma_f32 v71, -v31, v67, v71
    v_mul_f32 v64, v24, v72
    v_mul_f32 v65, v25, v73
    v_mul_f32 v66, v26, v74
    v_mul_f32 v67, v27, v75
    v_fma_f32 v64, -v28, v76, v64
    v_fma_f32 v65, -v29, v77, v65
    v_fma_f32 v66, -v30, v78, v66
    v_fma_f32 v67, -v31, v79, v67
    v_mul_f32 v76, -v24, v76
    v_mul_f32 v77, -v25, v77
    v_mul_f32 v78, -v26, v78
    v_mul_f32 v79, -v27, v79
    v_fma_f32 v76, -v28, v72, v76
    v_fma_f32 v77, -v29, v73, v77
    v_fma_f32 v78, -v30, v74, v78
    v_fma_f32 v79, -v31, v75, v79
    v_mul_f32 v72, v24, v80
    v_mul_f32 v73, v25, v81
    v_mul_f32 v74, v26, v82
    v_mul_f32 v75, v27, v83
    v_fma_f32 v72, -v28, v84, v72
    v_fma_f32 v73, -v29, v85, v73
    v_fma_f32 v74, -v30, v86, v74
    v_fma_f32 v75, -v31, v87, v75
    v_mul_f32 v84, -v24, v84
    v_mul_f32 v85, -v25, v85
    v_mul_f32 v86, -v26, v86
    v_mul_f32 v87, -v27, v87
    v_fma_f32 v84, -v28, v80, v84
    v_fma_f32 v85, -v29, v81, v85
    v_fma_f32 v86, -v30, v82, v86
    v_fma_f32 v87, -v31, v83, v87
    v_mul_f32 v80, v24, v88
    v_mul_f32 v81, v25, v89
    v_mul_f32 v82, v26, v90
    v_mul_f32 v83, v27, v91
    v_fma_f32 v80, -v28, v92, v80
    v_fma_f32 v81, -v29, v93, v81
    v_fma_f32 v82, -v30, v94, v82
    v_fma_f32 v83, -v31, v95, v83
    v_mul_f32 v92, -v24, v92
    v_mul_f32 v93, -v25, v93
    v_mul_f32 v94, -v26, v94
    v_mul_f32 v95, -v27, v95
    v_fma_f32 v92, -v28, v88, v92
    v_fma_f32 v93, -v29, v89, v93
    v_fma_f32 v94, -v30, v90, v94
    v_fma_f32 v95, -v31, v91, v95
    v_mul_f32 v88, v24, v96
    v_mul_f32 v89, v25, v97
    v_mul_f32 v90, v26, v98
    v_mul_f32 v91, v27, v99
    v_fma_f32 v88, -v28, v100, v88
    v_fma_f32 v89, -v29, v101, v89
    v_fma_f32 v90, -v30, v102, v90
    v_fma_f32 v91, -v31, v103, v91
    v_mul_f32 v100, -v24, v100
    v_mul_f32 v101, -v25, v101
    v_mul_f32 v102, -v26, v102
    v_mul_f32 v103, -v27, v103
    v_fma_f32 v100, -v28, v96, v100
    v_fma_f32 v101, -v29, v97, v101
    v_fma_f32 v102, -v30, v98, v102
    v_fma_f32 v103, -v31, v99, v103
    v_mul_f32 v96, v24, v104
    v_mul_f32 v97, v25, v105
    v_mul_f32 v98, v26, v106
    v_mul_f32 v99, v27, v107
    v_fma_f32 v96, -v28, v108, v96
    v_fma_f32 v97, -v29, v109, v97
    v_fma_f32 v98, -v30, v110, v98
    v_fma_f32 v99, -v31, v111, v99
    v_mul_f32 v108, -v24, v108
    v_mul_f32 v109, -v25, v109
    v_mul_f32 v110, -v26, v110
    v_mul_f32 v111, -v27, v111
    v_fma_f32 v108, -v28, v104, v108
    v_fma_f32 v109, -v29, v105, v109
    v_fma_f32 v110, -v30, v106, v110
    v_fma_f32 v111, -v31, v107, v111
    v_mul_f32 v104, v24, v112
    v_mul_f32 v105, v25, v113
    v_mul_f32 v106, v26, v114
    v_mul_f32 v107, v27, v115
    v_fma_f32 v104, -v28, v116, v104
    v_fma_f32 v105, -v29, v117, v105
    v_fma_f32 v106, -v30, v118, v106
    v_fma_f32 v107, -v31, v119, v107
    v_mul_f32 v116, -v24, v116
    v_mul_f32 v117, -v25, v117
    v_mul_f32 v118, -v26, v118
    v_mul_f32 v119, -v27, v119
    v_fma_f32 v116, -v28, v112, v116
    v_fma_f32 v117, -v29, v113, v117
    v_fma_f32 v118, -v30, v114, v118
    v_fma_f32 v119, -v31, v115, v119
    v_mul_f32 v112, v24, v120
    v_mul_f32 v113, v25, v121
    v_mul_f32 v114, v26, v122
    v_mul_f32 v115, v27, v123
    v_fma_f32 v112, -v28, v124, v112
    v_fma_f32 v113, -v29, v125, v113
    v_fma_f32 v114, -v30, v126, v114
    v_fma_f32 v115, -v31, v127, v115
    v_mul_f32 v124, -v24, v124
    v_mul_f32 v125, -v25, v125
    v_mul_f32 v126, -v26, v126
    v_mul_f32 v127, -v27, v127
    v_fma_f32 v124, -v28, v120, v124
    v_fma_f32 v125, -v29, v121, v125
    v_fma_f32 v126, -v30, v122, v126
    v_fma_f32 v127, -v31, v123, v127
    s_and_b32 s7, s3, 0
    s_add_u32 s7, s7, s4
    s_and_b32 s36, s7, 15
    v_lshrrev_b32 v1, 3, v2
    v_and_b32 v44, 7, v2
    v_xor_b32 v44, v44, v13
    v_lshlrev_b32 v44, 4, v44
    v_lshl_add_u32 v44, v1, 13, v44
    s_lshl_b32 s7, s4, 6
    s_add_u32 s7, s7, s5
    s_lshl_b32 s7, s7, 11
    v_add_u32 v244, s7, v44
    v_xor_b32 v245, 64, v244
    v_add_u32 v245, 64512, v245
    v_xor_b32 v246, 32, v244
    v_xor_b32 v247, 32, v245
    s_lshl_b32 s20, s36, 7
    s_and_b32 s22, s20, 1024
    s_xor_b32 s23, s22, 1024
    s_lshl_b32 s21, s5, 11
    s_mov_b32 s39, 0
C_chk:
    s_waitcnt vmcnt(0)
    v_cmp_eq_u32 vcc, v154, v54
    v_cmp_eq_u32 s[54:55], v155, v55
    s_and_b64 s[54:55], s[54:55], vcc
    s_or_b64 s[56:57], s[54:55], s[40:41]
    v_cmp_eq_u32 vcc, v158, v54
    v_cmp_eq_u32 s[54:55], v159, v55
    s_and_b64 s[54:55], s[54:55], vcc
    s_or_b64 s[58:59], s[54:55], s[42:43]
    v_cmp_eq_u32 vcc, v162, v54
    v_cmp_eq_u32 s[54:55], v163, v55
    s_and_b64 s[54:55], s[54:55], vcc
    s_or_b64 s[60:61], s[54:55], s[44:45]
    v_cmp_eq_u32 vcc, v166, v54
    v_cmp_eq_u32 s[54:55], v167, v55
    s_and_b64 s[54:55], s[54:55], vcc
    s_or_b64 s[62:63], s[54:55], s[46:47]
    s_and_b64 s[56:57], s[56:57], s[58:59]
    s_and_b64 s[60:61], s[60:61], s[62:63]
    s_and_b64 s[56:57], s[56:57], s[60:61]
    s_cmp_eq_u64 s[56:57], -1
    s_cbranch_scc1 C_ok
    s_add_u32 s39, s39, 1
    s_cmp_gt_u32 s39, 4096
    s_cbranch_scc1 C_ok
    buffer_load_dwordx4 v[152:155], v56, s[12:15], 0 offen sc1
    buffer_load_dwordx4 v[156:159], v57, s[12:15], 0 offen sc1
    buffer_load_dwordx4 v[160:163], v58, s[12:15], 0 offen sc1
    buffer_load_dwordx4 v[164:167], v59, s[12:15], 0 offen sc1
    s_branch C_chk
C_ok:
    ds_write_b32 v63, v3 offset:64
    v_fma_f32 v160, v164, v42, v160
    v_fma_f32 v161, v164, v43, v161
    v_fma_f32 v160, -v165, v43, v160
    v_fmac_f32 v161, v165, v42
    v_fma_f32 v156, v160, v42, v156
    v_fma_f32 v157, v160, v43, v157
    v_fma_f32 v156, -v161, v43, v156
    v_fmac_f32 v157, v161, v42
    v_fma_f32 v152, v156, v42, v152
    v_fma_f32 v153, v156, v43, v153
    v_fma_f32 v152, -v157, v43, v152
    v_fmac_f32 v153, v157, v42
    v_mul_f32 v44, v152, v40
    v_mul_f32 v45, v152, v41
    v_fma_f32 v44, -v153, v41, v44
    v_fmac_f32 v45, v153, v40
    s_nop 0
    v_add_f32_dpp v44, v44, v44 row_ror:4 row_mask:0xf bank_mask:0xf
    v_add_f32_dpp v45, v45, v45 row_ror:4 row_mask:0xf bank_mask:0xf
    s_nop 0
    v_add_f32_dpp v44, v44, v44 row_ror:8 row_mask:0xf bank_mask:0xf
    v_add_f32_dpp v45, v45, v45 row_ror:8 row_mask:0xf bank_mask:0xf
    s_nop 0
    v_mov_b32_dpp v168, v44 quad_perm:[0,0,0,0] row_mask:0xf bank_mask:0xf
    v_mov_b32_dpp v172, v45 quad_perm:[0,0,0,0] row_mask:0xf bank_mask:0xf
    v_mov_b32_dpp v169, v44 quad_perm:[1,1,1,1] row_mask:0xf bank_mask:0xf
    v_mov_b32_dpp v173, v45 quad_perm:[1,1,1,1] row_mask:0xf bank_mask:0xf
    v_mov_b32_dpp v170, v44 quad_perm:[2,2,2,2] row_mask:0xf bank_mask:0xf
    v_mov_b32_dpp v174, v45 quad_perm:[2,2,2,2] row_mask:0xf bank_mask:0xf
    v_mov_b32_dpp v171, v44 quad_perm:[3,3,3,3] row_mask:0xf bank_mask:0xf
    v_mov_b32_dpp v175, v45 quad_perm:[3,3,3,3] row_mask:0xf bank_mask:0xf
    v_pk_fma_f32 v[184:185], v[192:193], v[168:169], v[184:185]
    v_pk_fma_f32 v[188:189], v[192:193], v[172:173], v[188:189] neg_lo:[1,0,0] neg_hi:[1,0,0]
    v_pk_fma_f32 v[186:187], v[194:195], v[170:171], v[186:187]
    v_pk_fma_f32 v[190:191], v[194:195], v[174:175], v[190:191] neg_lo:[1,0,0] neg_hi:[1,0,0]
    v_pk_fma_f32 v[184:185], v[196:197], v[172:173], v[184:185] neg_lo:[1,0,0] neg_hi:[1,0,0]
    v_pk_fma_f32 v[188:189], v[196:197], v[168:169], v[188:189] neg_lo:[1,0,0] neg_hi:[1,0,0]
    v_pk_fma_f32 v[186:187], v[198:199], v[174:175], v[186:187] neg_lo:[1,0,0] neg_hi:[1,0,0]
    v_pk_fma_f32 v[190:191], v[198:199], v[170:171], v[190:191] neg_lo:[1,0,0] neg_hi:[1,0,0]
    v_pk_fma_f32 v[200:201], v[16:17], v[184:185], v[200:201]
    v_pk_fma_f32 v[68:69], v[16:17], v[188:189], v[68:69]
    v_pk_fma_f32 v[202:203], v[18:19], v[186:187], v[202:203]
    v_pk_fma_f32 v[70:71], v[18:19], v[190:191], v[70:71]
    v_pk_fma_f32 v[200:201], v[20:21], v[188:189], v[200:201]
    v_pk_fma_f32 v[68:69], v[20:21], v[184:185], v[68:69] neg_lo:[1,0,0] neg_hi:[1,0,0]
    v_pk_fma_f32 v[202:203], v[22:23], v[190:191], v[202:203]
    v_pk_fma_f32 v[70:71], v[22:23], v[186:187], v[70:71] neg_lo:[1,0,0] neg_hi:[1,0,0]
    v_cvt_pk_bf16_f32 v128, v200, v201
    v_cvt_pk_bf16_f32 v130, v68, v69
    v_cvt_pk_bf16_f32 v129, v202, v203
    v_cvt_pk_bf16_f32 v131, v70, v71
    v_pk_fma_f32 v[64:65], v[16:17], v[200:201], v[64:65]
    v_pk_fma_f32 v[76:77], v[16:17], v[68:69], v[76:77]
    v_pk_fma_f32 v[66:67], v[18:19], v[202:203], v[66:67]
    v_pk_fma_f32 v[78:79], v[18:19], v[70:71], v[78:79]
    v_pk_fma_f32 v[64:65], v[20:21], v[68:69], v[64:65]
    v_pk_fma_f32 v[76:77], v[20:21], v[200:201], v[76:77] neg_lo:[1,0,0] neg_hi:[1,0,0]
    v_pk_fma_f32 v[66:67], v[22:23], v[70:71], v[66:67]
    v_pk_fma_f32 v[78:79], v[22:23], v[202:203], v[78:79] neg_lo:[1,0,0] neg_hi:[1,0,0]
    v_permlane32_swap_b32 v128, v130
    v_permlane32_swap_b32 v129, v131
    s_mov_b32 s6, 0
    buffer_store_dwordx4 v[128:131], v61, s[8:11], s6 offen sc1
    v_cvt_pk_bf16_f32 v132, v64, v65
    v_cvt_pk_bf16_f32 v134, v76, v77
    v_cvt_pk_bf16_f32 v133, v66, v67
    v_cvt_pk_bf16_f32 v135, v78, v79
    v_pk_fma_f32 v[72:73], v[16:17], v[64:65], v[72:73]
    v_pk_fma_f32 v[84:85], v[16:17], v[76:77], v[84:85]
    v_pk_fma_f32 v[74:75], v[18:19], v[66:67], v[74:75]
    v_pk_fma_f32 v[86:87], v[18:19], v[78:79], v[86:87]
    v_pk_fma_f32 v[72:73], v[20:21], v[76:77], v[72:73]
    v_pk_fma_f32 v[84:85], v[20:21], v[64:65], v[84:85] neg_lo:[1,0,0] neg_hi:[1,0,0]
    v_pk_fma_f32 v[74:75], v[22:23], v[78:79], v[74:75]
    v_pk_fma_f32 v[86:87], v[22:23], v[66:67], v[86:87] neg_lo:[1,0,0] neg_hi:[1,0,0]
    v_permlane32_swap_b32 v132, v134
    v_permlane32_swap_b32 v133, v135
    s_mov_b32 s6, 4096
    buffer_store_dwordx4 v[132:135], v61, s[8:11], s6 offen sc1
    v_cvt_pk_bf16_f32 v136, v72, v73
    v_cvt_pk_bf16_f32 v138, v84, v85
    v_cvt_pk_bf16_f32 v137, v74, v75
    v_cvt_pk_bf16_f32 v139, v86, v87
    v_pk_fma_f32 v[80:81], v[16:17], v[72:73], v[80:81]
    v_pk_fma_f32 v[92:93], v[16:17], v[84:85], v[92:93]
    v_pk_fma_f32 v[82:83], v[18:19], v[74:75], v[82:83]
    v_pk_fma_f32 v[94:95], v[18:19], v[86:87], v[94:95]
    v_pk_fma_f32 v[80:81], v[20:21], v[84:85], v[80:81]
    v_pk_fma_f32 v[92:93], v[20:21], v[72:73], v[92:93] neg_lo:[1,0,0] neg_hi:[1,0,0]
    v_pk_fma_f32 v[82:83], v[22:23], v[86:87], v[82:83]
    v_pk_fma_f32 v[94:95], v[22:23], v[74:75], v[94:95] neg_lo:[1,0,0] neg_hi:[1,0,0]
    v_permlane32_swap_b32 v136, v138
    v_permlane32_swap_b32 v137, v139
    s_mov_b32 s6, 8192
    buffer_store_dwordx4 v[136:139], v61, s[8:11], s6 offen sc1
    v_cvt_pk_bf16_f32 v140, v80, v81
    v_cvt_pk_bf16_f32 v142, v92, v93
    v_cvt_pk_bf16_f32 v141, v82, v83
    v_cvt_pk_bf16_f32 v143, v94, v95
    v_pk_fma_f32 v[88:89], v[16:17], v[80:81], v[88:89]
    v_pk_fma_f32 v[100:101], v[16:17], v[92:93], v[100:101]
    v_pk_fma_f32 v[90:91], v[18:19], v[82:83], v[90:91]
    v_pk_fma_f32 v[102:103], v[18:19], v[94:95], v[102:103]
    v_pk_fma_f32 v[88:89], v[20:21], v[92:93], v[88:89]
    v_pk_fma_f32 v[100:101], v[20:21], v[80:81], v[100:101] neg_lo:[1,0,0] neg_hi:[1,0,0]
    v_pk_fma_f32 v[90:91], v[22:23], v[94:95], v[90:91]
    v_pk_fma_f32 v[102:103], v[22:23], v[82:83], v[102:103] neg_lo:[1,0,0] neg_hi:[1,0,0]
    v_permlane32_swap_b32 v140, v142
    v_permlane32_swap_b32 v141, v143
    s_mov_b32 s6, 12288
    buffer_store_dwordx4 v[140:143], v61, s[8:11], s6 offen sc1
    v_cvt_pk_bf16_f32 v144, v88, v89
    v_cvt_pk_bf16_f32 v146, v100, v101
    v_cvt_pk_bf16_f32 v145, v90, v91
    v_cvt_pk_bf16_f32 v147, v102, v103
    v_pk_fma_f32 v[96:97], v[16:17], v[88:89], v[96:97]
    v_pk_fma_f32 v[108:109], v[16:17], v[100:101], v[108:109]
    v_pk_fma_f32 v[98:99], v[18:19], v[90:91], v[98:99]
    v_pk_fma_f32 v[110:111], v[18:19], v[102:103], v[110:111]
    v_pk_fma_f32 v[96:97], v[20:21], v[100:101], v[96:97]
    v_pk_fma_f32 v[108:109], v[20:21], v[88:89], v[108:109] neg_lo:[1,0,0] neg_hi:[1,0,0]
    v_pk_fma_f32 v[98:99], v[22:23], v[102:103], v[98:99]
    v_pk_fma_f32 v[110:111], v[22:23], v[90:91], v[110:111] neg_lo:[1,0,0] neg_hi:[1,0,0]
    v_permlane32_swap_b32 v144, v146
    v_permlane32_swap_b32 v145, v147
    s_mov_b32 s6, 16384
    buffer_store_dwordx4 v[144:147], v61, s[8:11], s6 offen sc1
    v_cvt_pk_bf16_f32 v148, v96, v97
    v_cvt_pk_bf16_f32 v150, v108, v109
    v_cvt_pk_bf16_f32 v149, v98, v99
    v_cvt_pk_bf16_f32 v151, v110, v111
    v_pk_fma_f32 v[104:105], v[16:17], v[96:97], v[104:105]
    v_pk_fma_f32 v[116:117], v[16:17], v[108:109], v[116:117]
    v_pk_fma_f32 v[106:107], v[18:19], v[98:99], v[106:107]
    v_pk_fma_f32 v[118:119], v[18:19], v[110:111], v[118:119]
    v_pk_fma_f32 v[104:105], v[20:21], v[108:109], v[104:105]
    v_pk_fma_f32 v[116:117], v[20:21], v[96:97], v[116:117] neg_lo:[1,0,0] neg_hi:[1,0,0]
    v_pk_fma_f32 v[106:107], v[22:23], v[110:111], v[106:107]
    v_pk_fma_f32 v[118:119], v[22:23], v[98:99], v[118:119] neg_lo:[1,0,0] neg_hi:[1,0,0]
    v_permlane32_swap_b32 v148, v150
    v_permlane32_swap_b32 v149, v151
    s_mov_b32 s6, 20480
    buffer_store_dwordx4 v[148:151], v61, s[8:11], s6 offen sc1
    v_cvt_pk_bf16_f32 v152, v104, v105
    v_cvt_pk_bf16_f32 v154, v116, v117
    v_cvt_pk_bf16_f32 v153, v106, v107
    v_cvt_pk_bf16_f32 v155, v118, v119
    v_pk_fma_f32 v[112:113], v[16:17], v[104:105], v[112:113]
    v_pk_fma_f32 v[124:125], v[16:17], v[116:117], v[124:125]
    v_pk_fma_f32 v[114:115], v[18:19], v[106:107], v[114:115]
    v_pk_fma_f32 v[126:127], v[18:19], v[118:119], v[126:127]
    v_pk_fma_f32 v[112:113], v[20:21], v[116:117], v[112:113]
    v_pk_fma_f32 v[124:125], v[20:21], v[104:105], v[124:125] neg_lo:[1,0,0] neg_hi:[1,0,0]
    v_pk_fma_f32 v[114:115], v[22:23], v[118:119], v[114:115]
    v_pk_fma_f32 v[126:127], v[22:23], v[106:107], v[126:127] neg_lo:[1,0,0] neg_hi:[1,0,0]
    v_permlane32_swap_b32 v152, v154
    v_permlane32_swap_b32 v153, v155
    s_mov_b32 s6, 24576
    buffer_store_dwordx4 v[152:155], v61, s[8:11], s6 offen sc1
    v_cvt_pk_bf16_f32 v156, v112, v113
    v_cvt_pk_bf16_f32 v158, v124, v125
    v_cvt_pk_bf16_f32 v157, v114, v115
    v_cvt_pk_bf16_f32 v159, v126, v127
    s_nop 0
    v_permlane32_swap_b32 v156, v158
    v_permlane32_swap_b32 v157, v159
    s_mov_b32 s6, 28672
    buffer_store_dwordx4 v[156:159], v61, s[8:11], s6 offen sc1
    ds_write_b32 v63, v15 offset:64
    v_lshlrev_b32 v1, 4, v2
    v_add_u32 v52, s21, v1
    v_add_u32 v53, 0xc000, v52
    v_lshrrev_b32 v1, 1, v13
    v_lshl_add_u32 v8, v1, 13, v4
    v_xor_b32 v9, 32, v8
    v_xor_b32 v10, 64, v8
    v_xor_b32 v11, 96, v8
    s_lshl_b32 s6, s3, 6
    s_add_u32 s6, s6, s5
    s_lshl_b32 s6, s6, 13
    v_lshlrev_b32 v1, 4, v2
    v_add_u32 v48, s6, v1
    v_add_u32 v49, 4096, v48
    s_lshl_b32 s6, s6, 1
    s_lshl_b32 s7, s4, 8
    s_add_u32 s6, s6, s7
    s_add_u32 s6, s6, 4096
    v_lshlrev_b32 v50, 18, v13
    v_lshl_add_u32 v50, v12, 4, v50
    v_add_u32 v50, s6, v50
    v_lshlrev_b32 v1, 1, v13
    v_sub_u32 v1, v12, v1
    v_cmp_eq_u32 s[40:41], 0, v1
    v_cmp_eq_u32 s[42:43], 1, v1
    v_cmp_eq_u32 s[44:45], 8, v1
    v_cmp_eq_u32 s[46:47], 9, v1
    v_and_b32 v56, 0xffff, v242
    v_and_b32 v57, 0xffff0000, v242
    v_and_b32 v58, 0xffff, v243
    v_and_b32 v59, 0xffff0000, v243
    s_lshl_b32 s7, s3, 13
    s_add_u32 s7, s7, 131072
    v_lshrrev_b32 v1, 2, v2
    v_xor_b32 v3, s36, v1
    v_add_u32 v1, s36, v1
    v_and_b32 v1, 7, v1
    v_and_b32 v3, 8, v3
    v_or_b32 v1, v1, v3
    v_lshlrev_b32 v1, 9, v1
    v_add_u32 v51, s7, v1
    s_lshl_b32 s6, s4, 9
    s_add_u32 s6, s6, s7
    v_lshl_add_u32 v3, v12, 3, s6
    s_lshl_b32 s38, s36, 15
    s_and_b32 s30, s38, 0x40000
    s_xor_b32 s31, s30, 0x40000
    s_xor_b32 s35, s38, 0x40000
    s_lshl_b32 s6, s3, 19
    s_lshl_b32 s7, s5, 13
    s_add_u32 s6, s6, s7
    v_lshlrev_b32 v1, 7, v2
    v_add_u32 v60, s6, v1
    s_mov_b32 s34, 1
    s_mov_b32 s37, 0
    v_cndmask_b32 v64, 0, v56, s[40:41]
    v_mov_b32 v65, 0
    v_cndmask_b32 v66, 0, v56, s[42:43]
    v_mov_b32 v67, 0
    v_cndmask_b32 v68, 0, v56, s[44:45]
    v_mov_b32 v69, 0
    v_cndmask_b32 v70, 0, v56, s[46:47]
    v_mov_b32 v71, 0
    v_cndmask_b32 v72, 0, v57, s[40:41]
    v_mov_b32 v73, 0
    v_cndmask_b32 v74, 0, v57, s[42:43]
    v_mov_b32 v75, 0
    v_cndmask_b32 v76, 0, v57, s[44:45]
    v_mov_b32 v77, 0
    v_cndmask_b32 v78, 0, v57, s[46:47]
    v_mov_b32 v79, 0
    v_mov_b32 v80, 0
    v_cndmask_b32 v81, 0, v58, s[40:41]
    v_mov_b32 v82, 0
    v_cndmask_b32 v83, 0, v58, s[42:43]
    v_mov_b32 v84, 0
    v_cndmask_b32 v85, 0, v58, s[44:45]
    v_mov_b32 v86, 0
    v_cndmask_b32 v87, 0, v58, s[46:47]
    v_mov_b32 v88, 0
    v_cndmask_b32 v89, 0, v59, s[40:41]
    v_mov_b32 v90, 0
    v_cndmask_b32 v91, 0, v59, s[42:43]
    v_mov_b32 v92, 0
    v_cndmask_b32 v93, 0, v59, s[44:45]
    v_mov_b32 v94, 0
    v_cndmask_b32 v95, 0, v59, s[46:47]
    v_add_u32 v4, 0xc000, v8
    v_add_u32 v5, 0xc000, v9
    v_add_u32 v6, 0xc000, v10
    v_add_u32 v7, 0xc000, v11
    v_mfma_f32_16x16x32_bf16 v[16:19], v[208:211], v[64:67], 0
    v_mfma_f32_16x16x32_bf16 v[20:23], v[208:211], v[72:75], 0
    v_mfma_f32_16x16x32_bf16 v[24:27], v[208:211], v[80:83], 0
    v_mfma_f32_16x16x32_bf16 v[28:31], v[208:211], v[88:91], 0
    v_mfma_f32_16x16x32_bf16 v[32:35], v[216:219], v[64:67], 0
    v_mfma_f32_16x16x32_bf16 v[36:39], v[216:219], v[72:75], 0
    v_mfma_f32_16x16x32_bf16 v[40:43], v[216:219], v[80:83], 0
    v_mfma_f32_16x16x32_bf16 v[44:47], v[216:219], v[88:91], 0
    v_mfma_f32_16x16x32_bf16 v[16:19], v[212:215], v[68:71], v[16:19]
    v_mfma_f32_16x16x32_bf16 v[20:23], v[212:215], v[76:79], v[20:23]
    v_mfma_f32_16x16x32_bf16 v[24:27], v[212:215], v[84:87], v[24:27]
    v_mfma_f32_16x16x32_bf16 v[28:31], v[212:215], v[92:95], v[28:31]
    v_mfma_f32_16x16x32_bf16 v[32:35], v[220:223], v[68:71], v[32:35]
    v_mfma_f32_16x16x32_bf16 v[36:39], v[220:223], v[76:79], v[36:39]
    v_mfma_f32_16x16x32_bf16 v[40:43], v[220:223], v[84:87], v[40:43]
    v_mfma_f32_16x16x32_bf16 v[44:47], v[220:223], v[92:95], v[44:47]
    buffer_load_dwordx2 v[240:241], v51, s[72:75], 0 offen sc1
    s_waitcnt vmcnt(1)
    ds_write_b32 v63, v54 offset:32
    ds_read_b128 v[56:59], v62 offset:32
    s_waitcnt lgkmcnt(0)
    v_xor_b32 v56, v56, v54
    v_xor_b32 v57, v57, v54
    v_xor_b32 v58, v58, v54
    v_xor_b32 v59, v59, v54
    v_or3_b32 v56, v56, v57, v58
    v_or_b32 v56, v56, v59
    v_cmp_ne_u32 vcc, 0, v56
    s_mov_b32 s39, 0
    s_cbranch_vccnz C_nofl
    s_mov_b64 exec, 65535
    buffer_store_dwordx2 v[54:55], v3, s[72:75], 0 offen sc1
    s_mov_b64 exec, -1
    s_branch C_own
C_nofl:
    ds_read_b128 v[56:59], v62 offset:32
    s_waitcnt lgkmcnt(0)
    v_xor_b32 v56, v56, v54
    v_xor_b32 v57, v57, v54
    v_xor_b32 v58, v58, v54
    v_xor_b32 v59, v59, v54
    v_or3_b32 v56, v56, v57, v58
    v_or_b32 v56, v56, v59
    v_cmp_ne_u32 vcc, 0, v56
    s_add_u32 s39, s39, 1
    s_cmp_gt_u32 s39, 16384
    s_cbranch_scc1 C_own
    s_cbranch_vccnz C_nofl
C_own:
    ds_read_b128 v[12:15], v62 offset:48
    buffer_load_dwordx4 v[64:67], v48, s[8:11], s38 offen offset:0 sc1
    buffer_load_dwordx4 v[68:71], v49, s[8:11], s38 offen offset:0 sc1
    buffer_load_dwordx4 v[72:75], v48, s[8:11], s38 offen offset:1024 sc1
    buffer_load_dwordx4 v[76:79], v49, s[8:11], s38 offen offset:1024 sc1
    buffer_load_dwordx4 v[80:83], v48, s[8:11], s38 offen offset:2048 sc1
    buffer_load_dwordx4 v[84:87], v49, s[8:11], s38 offen offset:2048 sc1
    buffer_load_dwordx4 v[88:91], v48, s[8:11], s38 offen offset:3072 sc1
    buffer_load_dwordx4 v[92:95], v49, s[8:11], s38 offen offset:3072 sc1
    s_add_u32 s38, s38, 32768
    s_and_b32 s38, s38, 0x3ffff
    s_or_b32 s38, s38, s30
    s_add_u32 s7, s20, 768
    s_and_b32 s7, s7, 1023
    s_or_b32 s7, s7, s22
    buffer_load_dwordx4 v[160:163], v244, s[24:27], s7 offen offset:0
    buffer_load_dwordx4 v[164:167], v245, s[24:27], s7 offen offset:1024
    buffer_load_dwordx4 v[168:171], v246, s[80:83], s7 offen offset:0
    buffer_load_dwordx4 v[172:175], v247, s[80:83], s7 offen offset:1024
    s_add_u32 s7, s20, 896
    s_and_b32 s7, s7, 1023
    s_or_b32 s7, s7, s22
    buffer_load_dwordx4 v[176:179], v244, s[24:27], s7 offen offset:0
    buffer_load_dwordx4 v[180:183], v245, s[24:27], s7 offen offset:1024
    buffer_load_dwordx4 v[184:187], v246, s[80:83], s7 offen offset:0
    buffer_load_dwordx4 v[188:191], v247, s[80:83], s7 offen offset:1024
    s_add_u32 s7, s20, 1024
    s_and_b32 s7, s7, 1023
    s_or_b32 s7, s7, s23
    buffer_load_dwordx4 v[192:195], v244, s[24:27], s7 offen offset:0
    buffer_load_dwordx4 v[196:199], v245, s[24:27], s7 offen offset:1024
    buffer_load_dwordx4 v[200:203], v246, s[80:83], s7 offen offset:0
    buffer_load_dwordx4 v[204:207], v247, s[80:83], s7 offen offset:1024
    s_add_u32 s7, s20, 1152
    s_and_b32 s7, s7, 1023
    s_or_b32 s7, s7, s23
    buffer_load_dwordx4 v[224:227], v244, s[24:27], s7 offen offset:0
    buffer_load_dwordx4 v[228:231], v245, s[24:27], s7 offen offset:1024
    buffer_load_dwordx4 v[232:235], v246, s[80:83], s7 offen offset:0
    buffer_load_dwordx4 v[236:239], v247, s[80:83], s7 offen offset:1024
    s_add_u32 s7, s20, 1280
    s_and_b32 s7, s7, 1023
    s_or_b32 s7, s7, s23
    buffer_load_dwordx4 v[208:211], v244, s[24:27], s7 offen offset:0
    buffer_load_dwordx4 v[212:215], v245, s[24:27], s7 offen offset:1024
    buffer_load_dwordx4 v[216:219], v246, s[80:83], s7 offen offset:0
    buffer_load_dwordx4 v[220:223], v247, s[80:83], s7 offen offset:1024
    s_waitcnt vmcnt(28)
    v_cmp_eq_u32 vcc, v240, v54
    v_cmp_eq_u32 s[54:55], v241, v55
    s_nop 0
    s_and_b64 s[54:55], s[54:55], vcc
    s_or_b32 s54, s54, 15
    s_ff0_i32_b64 s7, s[54:55]
    s_lshr_b32 s7, s7, 2
    s_max_u32 s37, s37, s7
    s_cmp_gt_u32 s37, 1
    s_cbranch_scc0 C2_h1
    C2_h1_r:
    buffer_load_dwordx4 v[96:99], v48, s[8:11], s38 offen offset:0 sc1
    buffer_load_dwordx4 v[100:103], v49, s[8:11], s38 offen offset:0 sc1
    buffer_load_dwordx4 v[104:107], v48, s[8:11], s38 offen offset:1024 sc1
    buffer_load_dwordx4 v[108:111], v49, s[8:11], s38 offen offset:1024 sc1
    buffer_load_dwordx4 v[112:115], v48, s[8:11], s38 offen offset:2048 sc1
    buffer_load_dwordx4 v[116:119], v49, s[8:11], s38 offen offset:2048 sc1
    s_waitcnt lgkmcnt(0)
    v_min3_u32 v12, v12, v13, v14
    v_min_u32 v12, v12, v15
    v_cmp_gt_u32 vcc, 6, v12
    s_cbranch_vccnz C_crdy
    C_crdy_r:
    s_setprio 3
    ds_read_b128 v[128:131], v8 offset:0
    ds_read_b128 v[132:135], v8 offset:2048
    ds_read_b128 v[136:139], v8 offset:4096
    ds_read_b128 v[140:143], v8 offset:6144
    s_waitcnt vmcnt(32) lgkmcnt(0)
    v_mfma_f32_16x16x32_bf16 v[16:19], v[64:67], v[128:131], v[16:19]
    ds_read_b128 v[144:147], v9 offset:0
    ds_read_b128 v[148:151], v9 offset:2048
    v_mfma_f32_16x16x32_bf16 v[20:23], v[64:67], v[132:135], v[20:23]
    ds_read_b128 v[152:155], v9 offset:4096
    ds_read_b128 v[156:159], v9 offset:6144
    v_mfma_f32_16x16x32_bf16 v[24:27], v[64:67], v[136:139], v[24:27]
    buffer_load_dwordx2 v[242:243], v51, s[72:75], 0 offen sc1
    v_mfma_f32_16x16x32_bf16 v[28:31], v[64:67], v[140:143], v[28:31]
    buffer_load_dwordx4 v[120:123], v48, s[8:11], s38 offen offset:3072 sc1
    v_mfma_f32_16x16x32_bf16 v[44:47], v[68:71], v[140:143], v[44:47]
    buffer_load_dwordx4 v[124:127], v49, s[8:11], s38 offen offset:3072 sc1
    s_add_u32 s38, s38, 32768
    s_and_b32 s38, s38, 0x3ffff
    s_or_b32 s38, s38, s30
    v_mfma_f32_16x16x32_bf16 v[40:43], v[68:71], v[136:139], v[40:43]
    v_mfma_f32_16x16x32_bf16 v[36:39], v[68:71], v[132:135], v[36:39]
    v_mfma_f32_16x16x32_bf16 v[32:35], v[68:71], v[128:131], v[32:35]
    s_waitcnt vmcnt(33) lgkmcnt(0)
    v_mfma_f32_16x16x32_bf16 v[16:19], v[72:75], v[144:147], v[16:19]
    ds_read_b128 v[128:131], v10 offset:0
    ds_read_b128 v[132:135], v10 offset:2048
    v_mfma_f32_16x16x32_bf16 v[20:23], v[72:75], v[148:151], v[20:23]
    ds_read_b128 v[136:139], v10 offset:4096
    ds_read_b128 v[140:143], v10 offset:6144
    v_mfma_f32_16x16x32_bf16 v[24:27], v[72:75], v[152:155], v[24:27]
    s_cmp_gt_u32 s37, 2
    s_cbranch_scc0 C2_h2
    C2_h2_r:
    buffer_load_dwordx4 v[64:67], v48, s[8:11], s38 offen offset:0 sc1
    v_mfma_f32_16x16x32_bf16 v[28:31], v[72:75], v[156:159], v[28:31]
    buffer_load_dwordx4 v[68:71], v49, s[8:11], s38 offen offset:0 sc1
    v_mfma_f32_16x16x32_bf16 v[44:47], v[76:79], v[156:159], v[44:47]
    v_mfma_f32_16x16x32_bf16 v[40:43], v[76:79], v[152:155], v[40:43]
    v_mfma_f32_16x16x32_bf16 v[36:39], v[76:79], v[148:151], v[36:39]
    v_mfma_f32_16x16x32_bf16 v[32:35], v[76:79], v[144:147], v[32:35]
    s_waitcnt vmcnt(33) lgkmcnt(0)
    v_mfma_f32_16x16x32_bf16 v[16:19], v[80:83], v[128:131], v[16:19]
    ds_read_b128 v[144:147], v11 offset:0
    ds_read_b128 v[148:151], v11 offset:2048
    v_mfma_f32_16x16x32_bf16 v[20:23], v[80:83], v[132:135], v[20:23]
    ds_read_b128 v[152:155], v11 offset:4096
    ds_read_b128 v[156:159], v11 offset:6144
    v_mfma_f32_16x16x32_bf16 v[24:27], v[80:83], v[136:139], v[24:27]
    buffer_load_dwordx4 v[72:75], v48, s[8:11], s38 offen offset:1024 sc1
    v_mfma_f32_16x16x32_bf16 v[28:31], v[80:83], v[140:143], v[28:31]
    buffer_load_dwordx4 v[76:79], v49, s[8:11], s38 offen offset:1024 sc1
    v_mfma_f32_16x16x32_bf16 v[44:47], v[84:87], v[140:143], v[44:47]
    v_mfma_f32_16x16x32_bf16 v[40:43], v[84:87], v[136:139], v[40:43]
    v_mfma_f32_16x16x32_bf16 v[36:39], v[84:87], v[132:135], v[36:39]
    v_mfma_f32_16x16x32_bf16 v[32:35], v[84:87], v[128:131], v[32:35]
    s_waitcnt vmcnt(33) lgkmcnt(0)
    v_mfma_f32_16x16x32_bf16 v[16:19], v[88:91], v[144:147], v[16:19]
    ds_read_b128 v[128:131], v8 offset:16384
    ds_read_b128 v[132:135], v8 offset:18432
    v_mfma_f32_16x16x32_bf16 v[20:23], v[88:91], v[148:151], v[20:23]
    ds_read_b128 v[136:139], v8 offset:20480
    ds_read_b128 v[140:143], v8 offset:22528
    v_mfma_f32_16x16x32_bf16 v[24:27], v[88:91], v[152:155], v[24:27]
    v_mov_b32 v1, 1
    ds_write_b32 v63, v1 offset:96
    v_mfma_f32_16x16x32_bf16 v[28:31], v[88:91], v[156:159], v[28:31]
    buffer_load_dwordx4 v[80:83], v48, s[8:11], s38 offen offset:2048 sc1
    v_mfma_f32_16x16x32_bf16 v[44:47], v[92:95], v[156:159], v[44:47]
    buffer_load_dwordx4 v[84:87], v49, s[8:11], s38 offen offset:2048 sc1
    v_mfma_f32_16x16x32_bf16 v[40:43], v[92:95], v[152:155], v[40:43]
    v_mfma_f32_16x16x32_bf16 v[36:39], v[92:95], v[148:151], v[36:39]
    v_mfma_f32_16x16x32_bf16 v[32:35], v[92:95], v[144:147], v[32:35]
    s_waitcnt vmcnt(13) lgkmcnt(1)
    v_mfma_f32_16x16x32_bf16 v[16:19], v[96:99], v[128:131], v[16:19]
    ds_read_b128 v[144:147], v9 offset:16384
    ds_read_b128 v[148:151], v9 offset:18432
    v_mfma_f32_16x16x32_bf16 v[20:23], v[96:99], v[132:135], v[20:23]
    ds_read_b128 v[152:155], v9 offset:20480
    ds_read_b128 v[156:159], v9 offset:22528
    v_mfma_f32_16x16x32_bf16 v[24:27], v[96:99], v[136:139], v[24:27]
    buffer_load_dwordx2 v[244:245], v51, s[72:75], 0 offen sc1
    v_mfma_f32_16x16x32_bf16 v[28:31], v[96:99], v[140:143], v[28:31]
    buffer_load_dwordx4 v[88:91], v48, s[8:11], s38 offen offset:3072 sc1
    v_mfma_f32_16x16x32_bf16 v[44:47], v[100:103], v[140:143], v[44:47]
    buffer_load_dwordx4 v[92:95], v49, s[8:11], s38 offen offset:3072 sc1
    s_add_u32 s38, s38, 32768
    s_and_b32 s38, s38, 0x3ffff
    s_or_b32 s38, s38, s30
    v_mfma_f32_16x16x32_bf16 v[40:43], v[100:103], v[136:139], v[40:43]
    v_mfma_f32_16x16x32_bf16 v[36:39], v[100:103], v[132:135], v[36:39]
    v_mfma_f32_16x16x32_bf16 v[32:35], v[100:103], v[128:131], v[32:35]
    s_waitcnt vmcnt(14) lgkmcnt(0)
    v_mfma_f32_16x16x32_bf16 v[16:19], v[104:107], v[144:147], v[16:19]
    ds_read_b128 v[128:131], v10 offset:16384
    ds_read_b128 v[132:135], v10 offset:18432
    v_mfma_f32_16x16x32_bf16 v[20:23], v[104:107], v[148:151], v[20:23]
    ds_read_b128 v[136:139], v10 offset:20480
    ds_read_b128 v[140:143], v10 offset:22528
    v_mfma_f32_16x16x32_bf16 v[24:27], v[104:107], v[152:155], v[24:27]
    s_cmp_gt_u32 s37, 3
    s_cbranch_scc0 C2_h3
    C2_h3_r:
    buffer_load_dwordx4 v[96:99], v48, s[8:11], s38 offen offset:0 sc1
    v_mfma_f32_16x16x32_bf16 v[28:31], v[104:107], v[156:159], v[28:31]
    buffer_load_dwordx4 v[100:103], v49, s[8:11], s38 offen offset:0 sc1
    v_mfma_f32_16x16x32_bf16 v[44:47], v[108:111], v[156:159], v[44:47]
    v_mfma_f32_16x16x32_bf16 v[40:43], v[108:111], v[152:155], v[40:43]
    v_mfma_f32_16x16x32_bf16 v[36:39], v[108:111], v[148:151], v[36:39]
    v_mfma_f32_16x16x32_bf16 v[32:35], v[108:111], v[144:147], v[32:35]
    s_waitcnt vmcnt(14) lgkmcnt(0)
    v_mfma_f32_16x16x32_bf16 v[16:19], v[112:115], v[128:131], v[16:19]
    ds_read_b128 v[144:147], v11 offset:16384
    ds_read_b128 v[148:151], v11 offset:18432
    v_mfma_f32_16x16x32_bf16 v[20:23], v[112:115], v[132:135], v[20:23]
    ds_read_b128 v[152:155], v11 offset:20480
    ds_read_b128 v[156:159], v11 offset:22528
    v_mfma_f32_16x16x32_bf16 v[24:27], v[112:115], v[136:139], v[24:27]
    buffer_load_dwordx4 v[104:107], v48, s[8:11], s38 offen offset:1024 sc1
    v_mfma_f32_16x16x32_bf16 v[28:31], v[112:115], v[140:143], v[28:31]
    buffer_load_dwordx4 v[108:111], v49, s[8:11], s38 offen offset:1024 sc1
    v_mfma_f32_16x16x32_bf16 v[44:47], v[116:119], v[140:143], v[44:47]
    v_mfma_f32_16x16x32_bf16 v[40:43], v[116:119], v[136:139], v[40:43]
    v_mfma_f32_16x16x32_bf16 v[36:39], v[116:119], v[132:135], v[36:39]
    v_mfma_f32_16x16x32_bf16 v[32:35], v[116:119], v[128:131], v[32:35]
    s_waitcnt vmcnt(13) lgkmcnt(0)
    v_mfma_f32_16x16x32_bf16 v[16:19], v[120:123], v[144:147], v[16:19]
    ds_read_b128 v[128:131], v8 offset:32768
    ds_read_b128 v[132:135], v8 offset:34816
    v_mfma_f32_16x16x32_bf16 v[20:23], v[120:123], v[148:151], v[20:23]
    ds_read_b128 v[136:139], v8 offset:36864
    ds_read_b128 v[140:143], v8 offset:38912
    v_mfma_f32_16x16x32_bf16 v[24:27], v[120:123], v[152:155], v[24:27]
    v_mov_b32 v1, 2
    ds_write_b32 v63, v1 offset:96
    v_mfma_f32_16x16x32_bf16 v[28:31], v[120:123], v[156:159], v[28:31]
    ds_read_b128 v[56:59], v62 offset:96
    v_mfma_f32_16x16x32_bf16 v[44:47], v[124:127], v[156:159], v[44:47]
    buffer_load_dwordx4 v[112:115], v48, s[8:11], s38 offen offset:2048 sc1
    v_mfma_f32_16x16x32_bf16 v[40:43], v[124:127], v[152:155], v[40:43]
    buffer_load_dwordx4 v[116:119], v49, s[8:11], s38 offen offset:2048 sc1
    v_mfma_f32_16x16x32_bf16 v[36:39], v[124:127], v[148:151], v[36:39]
    v_mfma_f32_16x16x32_bf16 v[32:35], v[124:127], v[144:147], v[32:35]
    s_waitcnt vmcnt(13) lgkmcnt(0)
    v_mfma_f32_16x16x32_bf16 v[16:19], v[64:67], v[128:131], v[16:19]
    ds_read_b128 v[144:147], v9 offset:32768
    ds_read_b128 v[148:151], v9 offset:34816
    v_mfma_f32_16x16x32_bf16 v[20:23], v[64:67], v[132:135], v[20:23]
    ds_read_b128 v[152:155], v9 offset:36864
    ds_read_b128 v[156:159], v9 offset:38912
    v_mfma_f32_16x16x32_bf16 v[24:27], v[64:67], v[136:139], v[24:27]
    buffer_load_dwordx2 v[240:241], v51, s[72:75], 0 offen sc1
    v_cmp_eq_u32 vcc, v242, v54
    v_cmp_eq_u32 s[54:55], v243, v55
    s_nop 0
    s_and_b64 s[54:55], s[54:55], vcc
    s_or_b32 s54, s54, 15
    s_ff0_i32_b64 s7, s[54:55]
    s_lshr_b32 s7, s7, 2
    s_max_u32 s37, s37, s7
    v_mfma_f32_16x16x32_bf16 v[28:31], v[64:67], v[140:143], v[28:31]
    buffer_load_dwordx4 v[120:123], v48, s[8:11], s38 offen offset:3072 sc1
    buffer_load_dwordx4 v[124:127], v49, s[8:11], s38 offen offset:3072 sc1
    s_add_u32 s38, s38, 32768
    s_and_b32 s38, s38, 0x3ffff
    s_or_b32 s38, s38, s30
    v_mfma_f32_16x16x32_bf16 v[44:47], v[68:71], v[140:143], v[44:47]
    v_min3_u32 v56, v56, v57, v58
    v_min_u32 v56, v56, v59
    v_mfma_f32_16x16x32_bf16 v[40:43], v[68:71], v[136:139], v[40:43]
    v_cmp_gt_u32 vcc, 1, v56
    v_mfma_f32_16x16x32_bf16 v[36:39], v[68:71], v[132:135], v[36:39]
    s_cbranch_vccnz C2_p2
    C2_p2_r:
    v_mfma_f32_16x16x32_bf16 v[32:35], v[68:71], v[128:131], v[32:35]
    ds_write_b128 v52, v[160:163] offset:0
    s_waitcnt vmcnt(14) lgkmcnt(1)
    v_mfma_f32_16x16x32_bf16 v[16:19], v[72:75], v[144:147], v[16:19]
    ds_read_b128 v[128:131], v10 offset:32768
    ds_read_b128 v[132:135], v10 offset:34816
    v_mfma_f32_16x16x32_bf16 v[20:23], v[72:75], v[148:151], v[20:23]
    ds_read_b128 v[136:139], v10 offset:36864
    ds_read_b128 v[140:143], v10 offset:38912
    v_mfma_f32_16x16x32_bf16 v[24:27], v[72:75], v[152:155], v[24:27]
    s_cmp_gt_u32 s37, 4
    s_cbranch_scc0 C2_h4
    C2_h4_r:
    buffer_load_dwordx4 v[64:67], v48, s[8:11], s38 offen offset:0 sc1
    v_mfma_f32_16x16x32_bf16 v[28:31], v[72:75], v[156:159], v[28:31]
    buffer_load_dwordx4 v[68:71], v49, s[8:11], s38 offen offset:0 sc1
    v_mfma_f32_16x16x32_bf16 v[44:47], v[76:79], v[156:159], v[44:47]
    ds_write_b128 v52, v[164:167] offset:1024
    v_mfma_f32_16x16x32_bf16 v[40:43], v[76:79], v[152:155], v[40:43]
    v_mfma_f32_16x16x32_bf16 v[36:39], v[76:79], v[148:151], v[36:39]
    v_mfma_f32_16x16x32_bf16 v[32:35], v[76:79], v[144:147], v[32:35]
    s_waitcnt vmcnt(14) lgkmcnt(1)
    v_mfma_f32_16x16x32_bf16 v[16:19], v[80:83], v[128:131], v[16:19]
    ds_read_b128 v[144:147], v11 offset:32768
    ds_read_b128 v[148:151], v11 offset:34816
    v_mfma_f32_16x16x32_bf16 v[20:23], v[80:83], v[132:135], v[20:23]
    ds_read_b128 v[152:155], v11 offset:36864
    ds_read_b128 v[156:159], v11 offset:38912
    v_mfma_f32_16x16x32_bf16 v[24:27], v[80:83], v[136:139], v[24:27]
    buffer_load_dwordx4 v[72:75], v48, s[8:11], s38 offen offset:1024 sc1
    v_mfma_f32_16x16x32_bf16 v[28:31], v[80:83], v[140:143], v[28:31]
    buffer_load_dwordx4 v[76:79], v49, s[8:11], s38 offen offset:1024 sc1
    v_mfma_f32_16x16x32_bf16 v[44:47], v[84:87], v[140:143], v[44:47]
    ds_write_b128 v52, v[168:171] offset:8192
    v_mfma_f32_16x16x32_bf16 v[40:43], v[84:87], v[136:139], v[40:43]
    v_mfma_f32_16x16x32_bf16 v[36:39], v[84:87], v[132:135], v[36:39]
    v_mfma_f32_16x16x32_bf16 v[32:35], v[84:87], v[128:131], v[32:35]
    s_waitcnt vmcnt(13) lgkmcnt(1)
    v_mfma_f32_16x16x32_bf16 v[16:19], v[88:91], v[144:147], v[16:19]
    ds_read_b128 v[128:131], v4 offset:0
    ds_read_b128 v[132:135], v4 offset:2048
    v_mfma_f32_16x16x32_bf16 v[20:23], v[88:91], v[148:151], v[20:23]
    ds_read_b128 v[136:139], v4 offset:4096
    ds_read_b128 v[140:143], v4 offset:6144
    v_mfma_f32_16x16x32_bf16 v[24:27], v[88:91], v[152:155], v[24:27]
    ds_write_b128 v52, v[172:175] offset:9216
    v_mfma_f32_16x16x32_bf16 v[28:31], v[88:91], v[156:159], v[28:31]
    v_mov_b32 v1, 3
    ds_write_b32 v63, v1 offset:96
    v_mfma_f32_16x16x32_bf16 v[44:47], v[92:95], v[156:159], v[44:47]
    ds_read_b128 v[56:59], v62 offset:96
    v_mfma_f32_16x16x32_bf16 v[40:43], v[92:95], v[152:155], v[40:43]
    buffer_load_dwordx4 v[80:83], v48, s[8:11], s38 offen offset:2048 sc1
    v_mfma_f32_16x16x32_bf16 v[36:39], v[92:95], v[148:151], v[36:39]
    buffer_load_dwordx4 v[84:87], v49, s[8:11], s38 offen offset:2048 sc1
    v_mfma_f32_16x16x32_bf16 v[32:35], v[92:95], v[144:147], v[32:35]
    s_waitcnt vmcnt(13) lgkmcnt(0)
    v_mfma_f32_16x16x32_bf16 v[16:19], v[96:99], v[128:131], v[16:19]
    ds_read_b128 v[144:147], v5 offset:0
    ds_read_b128 v[148:151], v5 offset:2048
    v_mfma_f32_16x16x32_bf16 v[20:23], v[96:99], v[132:135], v[20:23]
    ds_read_b128 v[152:155], v5 offset:4096
    ds_read_b128 v[156:159], v5 offset:6144
    v_mfma_f32_16x16x32_bf16 v[24:27], v[96:99], v[136:139], v[24:27]
    v_cmp_eq_u32 vcc, v244, v54
    v_cmp_eq_u32 s[54:55], v245, v55
    s_nop 0
    s_and_b64 s[54:55], s[54:55], vcc
    s_or_b32 s54, s54, 15
    s_ff0_i32_b64 s7, s[54:55]
    s_lshr_b32 s7, s7, 2
    s_max_u32 s37, s37, s7
    buffer_load_dwordx4 v[88:91], v48, s[8:11], s38 offen offset:3072 sc1
    v_mfma_f32_16x16x32_bf16 v[28:31], v[96:99], v[140:143], v[28:31]
    buffer_load_dwordx4 v[92:95], v49, s[8:11], s38 offen offset:3072 sc1
    s_add_u32 s38, s38, 32768
    s_and_b32 s38, s38, 0x3ffff
    s_or_b32 s38, s38, s30
    v_min3_u32 v56, v56, v57, v58
    v_mfma_f32_16x16x32_bf16 v[44:47], v[100:103], v[140:143], v[44:47]
    v_min_u32 v56, v56, v59
    v_mfma_f32_16x16x32_bf16 v[40:43], v[100:103], v[136:139], v[40:43]
    v_cmp_gt_u32 vcc, 2, v56
    v_mfma_f32_16x16x32_bf16 v[36:39], v[100:103], v[132:135], v[36:39]
    s_cbranch_vccnz C2_p3
    C2_p3_r:
    v_mfma_f32_16x16x32_bf16 v[32:35], v[100:103], v[128:131], v[32:35]
    ds_write_b128 v52, v[176:179] offset:16384
    s_waitcnt vmcnt(13) lgkmcnt(1)
    v_mfma_f32_16x16x32_bf16 v[16:19], v[104:107], v[144:147], v[16:19]
    ds_read_b128 v[128:131], v6 offset:0
    ds_read_b128 v[132:135], v6 offset:2048
    v_mfma_f32_16x16x32_bf16 v[20:23], v[104:107], v[148:151], v[20:23]
    ds_read_b128 v[136:139], v6 offset:4096
    ds_read_b128 v[140:143], v6 offset:6144
    v_mfma_f32_16x16x32_bf16 v[24:27], v[104:107], v[152:155], v[24:27]
    s_cmp_gt_u32 s37, 5
    s_cbranch_scc0 C2_h5
    C2_h5_r:
    buffer_load_dwordx4 v[96:99], v48, s[8:11], s38 offen offset:0 sc1
    v_mfma_f32_16x16x32_bf16 v[28:31], v[104:107], v[156:159], v[28:31]
    buffer_load_dwordx4 v[100:103], v49, s[8:11], s38 offen offset:0 sc1
    v_mfma_f32_16x16x32_bf16 v[44:47], v[108:111], v[156:159], v[44:47]
    ds_write_b128 v52, v[180:183] offset:17408
    v_mfma_f32_16x16x32_bf16 v[40:43], v[108:111], v[152:155], v[40:43]
    v_mfma_f32_16x16x32_bf16 v[36:39], v[108:111], v[148:151], v[36:39]
    v_mfma_f32_16x16x32_bf16 v[32:35], v[108:111], v[144:147], v[32:35]
    s_waitcnt vmcnt(13) lgkmcnt(1)
    v_mfma_f32_16x16x32_bf16 v[16:19], v[112:115], v[128:131], v[16:19]
    ds_read_b128 v[144:147], v7 offset:0
    ds_read_b128 v[148:151], v7 offset:2048
    v_mfma_f32_16x16x32_bf16 v[20:23], v[112:115], v[132:135], v[20:23]
    ds_read_b128 v[152:155], v7 offset:4096
    ds_read_b128 v[156:159], v7 offset:6144
    v_mfma_f32_16x16x32_bf16 v[24:27], v[112:115], v[136:139], v[24:27]
    buffer_load_dwordx4 v[104:107], v48, s[8:11], s38 offen offset:1024 sc1
    v_mfma_f32_16x16x32_bf16 v[28:31], v[112:115], v[140:143], v[28:31]
    buffer_load_dwordx4 v[108:111], v49, s[8:11], s38 offen offset:1024 sc1
    v_mfma_f32_16x16x32_bf16 v[44:47], v[116:119], v[140:143], v[44:47]
    ds_write_b128 v52, v[184:187] offset:24576
    v_mfma_f32_16x16x32_bf16 v[40:43], v[116:119], v[136:139], v[40:43]
    v_mfma_f32_16x16x32_bf16 v[36:39], v[116:119], v[132:135], v[36:39]
    v_mfma_f32_16x16x32_bf16 v[32:35], v[116:119], v[128:131], v[32:35]
    s_waitcnt vmcnt(12) lgkmcnt(1)
    v_mfma_f32_16x16x32_bf16 v[16:19], v[120:123], v[144:147], v[16:19]
    ds_read_b128 v[128:131], v4 offset:16384
    ds_read_b128 v[132:135], v4 offset:18432
    v_mfma_f32_16x16x32_bf16 v[20:23], v[120:123], v[148:151], v[20:23]
    ds_read_b128 v[136:139], v4 offset:20480
    ds_read_b128 v[140:143], v4 offset:22528
    v_mfma_f32_16x16x32_bf16 v[24:27], v[120:123], v[152:155], v[24:27]
    ds_write_b128 v52, v[188:191] offset:25600
    v_mfma_f32_16x16x32_bf16 v[28:31], v[120:123], v[156:159], v[28:31]
    v_mov_b32 v1, 4
    ds_write_b32 v63, v1 offset:96
    v_mfma_f32_16x16x32_bf16 v[44:47], v[124:127], v[156:159], v[44:47]
    ds_read_b128 v[56:59], v62 offset:96
    v_mfma_f32_16x16x32_bf16 v[40:43], v[124:127], v[152:155], v[40:43]
    buffer_load_dwordx4 v[112:115], v48, s[8:11], s38 offen offset:2048 sc1
    v_mfma_f32_16x16x32_bf16 v[36:39], v[124:127], v[148:151], v[36:39]
    buffer_load_dwordx4 v[116:119], v49, s[8:11], s38 offen offset:2048 sc1
    v_mfma_f32_16x16x32_bf16 v[32:35], v[124:127], v[144:147], v[32:35]
    s_waitcnt vmcnt(12) lgkmcnt(0)
    v_mfma_f32_16x16x32_bf16 v[16:19], v[64:67], v[128:131], v[16:19]
    ds_read_b128 v[144:147], v5 offset:16384
    ds_read_b128 v[148:151], v5 offset:18432
    v_mfma_f32_16x16x32_bf16 v[20:23], v[64:67], v[132:135], v[20:23]
    ds_read_b128 v[152:155], v5 offset:20480
    ds_read_b128 v[156:159], v5 offset:22528
    v_mfma_f32_16x16x32_bf16 v[24:27], v[64:67], v[136:139], v[24:27]
    v_cmp_eq_u32 vcc, v240, v54
    v_cmp_eq_u32 s[54:55], v241, v55
    s_nop 0
    s_and_b64 s[54:55], s[54:55], vcc
    s_or_b32 s54, s54, 15
    s_ff0_i32_b64 s7, s[54:55]
    s_lshr_b32 s7, s7, 2
    s_max_u32 s37, s37, s7
    buffer_load_dwordx4 v[120:123], v48, s[8:11], s38 offen offset:3072 sc1
    v_mfma_f32_16x16x32_bf16 v[28:31], v[64:67], v[140:143], v[28:31]
    buffer_load_dwordx4 v[124:127], v49, s[8:11], s38 offen offset:3072 sc1
    s_add_u32 s38, s38, 32768
    s_and_b32 s38, s38, 0x3ffff
    s_or_b32 s38, s38, s30
    v_min3_u32 v56, v56, v57, v58
    v_mfma_f32_16x16x32_bf16 v[44:47], v[68:71], v[140:143], v[44:47]
    v_min_u32 v56, v56, v59
    v_mfma_f32_16x16x32_bf16 v[40:43], v[68:71], v[136:139], v[40:43]
    v_cmp_gt_u32 vcc, 3, v56
    v_mfma_f32_16x16x32_bf16 v[36:39], v[68:71], v[132:135], v[36:39]
    s_cbranch_vccnz C2_p4
    C2_p4_r:
    v_mfma_f32_16x16x32_bf16 v[32:35], v[68:71], v[128:131], v[32:35]
    ds_write_b128 v52, v[192:195] offset:32768
    s_waitcnt vmcnt(12) lgkmcnt(1)
    v_mfma_f32_16x16x32_bf16 v[16:19], v[72:75], v[144:147], v[16:19]
    ds_read_b128 v[128:131], v6 offset:16384
    ds_read_b128 v[132:135], v6 offset:18432
    v_mfma_f32_16x16x32_bf16 v[20:23], v[72:75], v[148:151], v[20:23]
    ds_read_b128 v[136:139], v6 offset:20480
    ds_read_b128 v[140:143], v6 offset:22528
    v_mfma_f32_16x16x32_bf16 v[24:27], v[72:75], v[152:155], v[24:27]
    s_cmp_gt_u32 s37, 6
    s_cbranch_scc0 C2_h6
    C2_h6_r:
    buffer_load_dwordx4 v[64:67], v48, s[8:11], s38 offen offset:0 sc1
    v_mfma_f32_16x16x32_bf16 v[28:31], v[72:75], v[156:159], v[28:31]
    buffer_load_dwordx4 v[68:71], v49, s[8:11], s38 offen offset:0 sc1
    v_mfma_f32_16x16x32_bf16 v[44:47], v[76:79], v[156:159], v[44:47]
    ds_write_b128 v52, v[196:199] offset:33792
    v_mfma_f32_16x16x32_bf16 v[40:43], v[76:79], v[152:155], v[40:43]
    v_mfma_f32_16x16x32_bf16 v[36:39], v[76:79], v[148:151], v[36:39]
    v_mfma_f32_16x16x32_bf16 v[32:35], v[76:79], v[144:147], v[32:35]
    s_waitcnt vmcnt(12) lgkmcnt(1)
    v_mfma_f32_16x16x32_bf16 v[16:19], v[80:83], v[128:131], v[16:19]
    ds_read_b128 v[144:147], v7 offset:16384
    ds_read_b128 v[148:151], v7 offset:18432
    v_mfma_f32_16x16x32_bf16 v[20:23], v[80:83], v[132:135], v[20:23]
    ds_read_b128 v[152:155], v7 offset:20480
    ds_read_b128 v[156:159], v7 offset:22528
    v_mfma_f32_16x16x32_bf16 v[24:27], v[80:83], v[136:139], v[24:27]
    buffer_load_dwordx4 v[72:75], v48, s[8:11], s38 offen offset:1024 sc1
    v_mfma_f32_16x16x32_bf16 v[28:31], v[80:83], v[140:143], v[28:31]
    buffer_load_dwordx4 v[76:79], v49, s[8:11], s38 offen offset:1024 sc1
    v_mfma_f32_16x16x32_bf16 v[44:47], v[84:87], v[140:143], v[44:47]
    ds_write_b128 v52, v[200:203] offset:40960
    v_mfma_f32_16x16x32_bf16 v[40:43], v[84:87], v[136:139], v[40:43]
    v_mfma_f32_16x16x32_bf16 v[36:39], v[84:87], v[132:135], v[36:39]
    v_mfma_f32_16x16x32_bf16 v[32:35], v[84:87], v[128:131], v[32:35]
    s_waitcnt vmcnt(12) lgkmcnt(1)
    v_mfma_f32_16x16x32_bf16 v[16:19], v[88:91], v[144:147], v[16:19]
    ds_read_b128 v[128:131], v4 offset:32768
    ds_read_b128 v[132:135], v4 offset:34816
    v_mfma_f32_16x16x32_bf16 v[20:23], v[88:91], v[148:151], v[20:23]
    ds_read_b128 v[136:139], v4 offset:36864
    ds_read_b128 v[140:143], v4 offset:38912
    v_mfma_f32_16x16x32_bf16 v[24:27], v[88:91], v[152:155], v[24:27]
    ds_write_b128 v52, v[204:207] offset:41984
    v_mfma_f32_16x16x32_bf16 v[28:31], v[88:91], v[156:159], v[28:31]
    v_mov_b32 v1, 5
    ds_write_b32 v63, v1 offset:96
    v_mfma_f32_16x16x32_bf16 v[44:47], v[92:95], v[156:159], v[44:47]
    ds_read_b128 v[56:59], v62 offset:96
    v_mfma_f32_16x16x32_bf16 v[40:43], v[92:95], v[152:155], v[40:43]
    buffer_load_dwordx4 v[80:83], v48, s[8:11], s38 offen offset:2048 sc1
    v_mfma_f32_16x16x32_bf16 v[36:39], v[92:95], v[148:151], v[36:39]
    buffer_load_dwordx4 v[84:87], v49, s[8:11], s38 offen offset:2048 sc1
    v_mfma_f32_16x16x32_bf16 v[32:35], v[92:95], v[144:147], v[32:35]
    s_waitcnt vmcnt(12) lgkmcnt(0)
    v_mfma_f32_16x16x32_bf16 v[16:19], v[96:99], v[128:131], v[16:19]
    ds_read_b128 v[144:147], v5 offset:32768
    ds_read_b128 v[148:151], v5 offset:34816
    v_mfma_f32_16x16x32_bf16 v[20:23], v[96:99], v[132:135], v[20:23]
    ds_read_b128 v[152:155], v5 offset:36864
    ds_read_b128 v[156:159], v5 offset:38912
    v_mfma_f32_16x16x32_bf16 v[24:27], v[96:99], v[136:139], v[24:27]
    buffer_load_dwordx4 v[88:91], v48, s[8:11], s38 offen offset:3072 sc1
    buffer_load_dwordx4 v[92:95], v49, s[8:11], s38 offen offset:3072 sc1
    s_add_u32 s38, s38, 32768
    s_and_b32 s38, s38, 0x3ffff
    s_or_b32 s38, s38, s30
    v_mfma_f32_16x16x32_bf16 v[28:31], v[96:99], v[140:143], v[28:31]
    v_min3_u32 v56, v56, v57, v58
    v_mfma_f32_16x16x32_bf16 v[44:47], v[100:103], v[140:143], v[44:47]
    v_min_u32 v56, v56, v59
    v_mfma_f32_16x16x32_bf16 v[40:43], v[100:103], v[136:139], v[40:43]
    v_cmp_gt_u32 vcc, 4, v56
    v_mfma_f32_16x16x32_bf16 v[36:39], v[100:103], v[132:135], v[36:39]
    s_cbranch_vccnz C2_p5
    C2_p5_r:
    v_mfma_f32_16x16x32_bf16 v[32:35], v[100:103], v[128:131], v[32:35]
    ds_write_b128 v53, v[224:227] offset:0
    s_waitcnt vmcnt(12) lgkmcnt(1)
    v_mfma_f32_16x16x32_bf16 v[16:19], v[104:107], v[144:147], v[16:19]
    ds_read_b128 v[128:131], v6 offset:32768
    ds_read_b128 v[132:135], v6 offset:34816
    v_mfma_f32_16x16x32_bf16 v[20:23], v[104:107], v[148:151], v[20:23]
    ds_read_b128 v[136:139], v6 offset:36864
    ds_read_b128 v[140:143], v6 offset:38912
    v_mfma_f32_16x16x32_bf16 v[24:27], v[104:107], v[152:155], v[24:27]
    s_cmp_gt_u32 s37, 7
    s_cbranch_scc0 C2_h7
    C2_h7_r:
    buffer_load_dwordx4 v[96:99], v48, s[8:11], s38 offen offset:0 sc1
    v_mfma_f32_16x16x32_bf16 v[28:31], v[104:107], v[156:159], v[28:31]
    buffer_load_dwordx4 v[100:103], v49, s[8:11], s38 offen offset:0 sc1
    v_mfma_f32_16x16x32_bf16 v[44:47], v[108:111], v[156:159], v[44:47]
    ds_write_b128 v53, v[228:231] offset:1024
    v_mfma_f32_16x16x32_bf16 v[40:43], v[108:111], v[152:155], v[40:43]
    v_mfma_f32_16x16x32_bf16 v[36:39], v[108:111], v[148:151], v[36:39]
    v_mfma_f32_16x16x32_bf16 v[32:35], v[108:111], v[144:147], v[32:35]
    s_waitcnt vmcnt(12) lgkmcnt(1)
    v_mfma_f32_16x16x32_bf16 v[16:19], v[112:115], v[128:131], v[16:19]
    ds_read_b128 v[144:147], v7 offset:32768
    ds_read_b128 v[148:151], v7 offset:34816
    v_mfma_f32_16x16x32_bf16 v[20:23], v[112:115], v[132:135], v[20:23]
    ds_read_b128 v[152:155], v7 offset:36864
    ds_read_b128 v[156:159], v7 offset:38912
    v_mfma_f32_16x16x32_bf16 v[24:27], v[112:115], v[136:139], v[24:27]
    buffer_load_dwordx4 v[104:107], v48, s[8:11], s38 offen offset:1024 sc1
    v_mfma_f32_16x16x32_bf16 v[28:31], v[112:115], v[140:143], v[28:31]
    buffer_load_dwordx4 v[108:111], v49, s[8:11], s38 offen offset:1024 sc1
    v_mfma_f32_16x16x32_bf16 v[44:47], v[116:119], v[140:143], v[44:47]
    ds_write_b128 v53, v[232:235] offset:8192
    v_mfma_f32_16x16x32_bf16 v[40:43], v[116:119], v[136:139], v[40:43]
    v_mfma_f32_16x16x32_bf16 v[36:39], v[116:119], v[132:135], v[36:39]
    v_mfma_f32_16x16x32_bf16 v[32:35], v[116:119], v[128:131], v[32:35]
    s_waitcnt vmcnt(12) lgkmcnt(1)
    v_mfma_f32_16x16x32_bf16 v[16:19], v[120:123], v[144:147], v[16:19]
    ds_read_b128 v[128:131], v8 offset:0
    ds_read_b128 v[132:135], v8 offset:2048
    v_mfma_f32_16x16x32_bf16 v[20:23], v[120:123], v[148:151], v[20:23]
    ds_read_b128 v[136:139], v8 offset:4096
    ds_read_b128 v[140:143], v8 offset:6144
    v_mfma_f32_16x16x32_bf16 v[24:27], v[120:123], v[152:155], v[24:27]
    ds_write_b128 v53, v[236:239] offset:9216
    v_mfma_f32_16x16x32_bf16 v[28:31], v[120:123], v[156:159], v[28:31]
    v_mov_b32 v1, 6
    ds_write_b32 v63, v1 offset:96
    v_mfma_f32_16x16x32_bf16 v[44:47], v[124:127], v[156:159], v[44:47]
    ds_read_b128 v[56:59], v62 offset:96
    v_mfma_f32_16x16x32_bf16 v[40:43], v[124:127], v[152:155], v[40:43]
    buffer_load_dwordx4 v[112:115], v48, s[8:11], s38 offen offset:2048 sc1
    v_mfma_f32_16x16x32_bf16 v[36:39], v[124:127], v[148:151], v[36:39]
    buffer_load_dwordx4 v[116:119], v49, s[8:11], s38 offen offset:2048 sc1
    v_mfma_f32_16x16x32_bf16 v[32:35], v[124:127], v[144:147], v[32:35]
    s_waitcnt vmcnt(12) lgkmcnt(0)
    v_mfma_f32_16x16x32_bf16 v[16:19], v[64:67], v[128:131], v[16:19]
    ds_read_b128 v[144:147], v9 offset:0
    ds_read_b128 v[148:151], v9 offset:2048
    v_mfma_f32_16x16x32_bf16 v[20:23], v[64:67], v[132:135], v[20:23]
    ds_read_b128 v[152:155], v9 offset:4096
    ds_read_b128 v[156:159], v9 offset:6144
    v_mfma_f32_16x16x32_bf16 v[24:27], v[64:67], v[136:139], v[24:27]
    buffer_load_dwordx4 v[120:123], v48, s[8:11], s38 offen offset:3072 sc1
    buffer_load_dwordx4 v[124:127], v49, s[8:11], s38 offen offset:3072 sc1
    s_add_u32 s38, s38, 32768
    s_and_b32 s38, s38, 0x3ffff
    s_or_b32 s38, s38, s31
    v_mfma_f32_16x16x32_bf16 v[28:31], v[64:67], v[140:143], v[28:31]
    v_min3_u32 v56, v56, v57, v58
    v_mfma_f32_16x16x32_bf16 v[44:47], v[68:71], v[140:143], v[44:47]
    v_min_u32 v56, v56, v59
    v_mfma_f32_16x16x32_bf16 v[40:43], v[68:71], v[136:139], v[40:43]
    v_cmp_gt_u32 vcc, 5, v56
    v_mfma_f32_16x16x32_bf16 v[36:39], v[68:71], v[132:135], v[36:39]
    s_cbranch_vccnz C2_p6
    C2_p6_r:
    v_mfma_f32_16x16x32_bf16 v[32:35], v[68:71], v[128:131], v[32:35]
    ds_write_b128 v53, v[208:211] offset:16384
    s_waitcnt vmcnt(12) lgkmcnt(1)
    v_mfma_f32_16x16x32_bf16 v[16:19], v[72:75], v[144:147], v[16:19]
    ds_read_b128 v[128:131], v10 offset:0
    ds_read_b128 v[132:135], v10 offset:2048
    v_mfma_f32_16x16x32_bf16 v[20:23], v[72:75], v[148:151], v[20:23]
    ds_read_b128 v[136:139], v10 offset:4096
    ds_read_b128 v[140:143], v10 offset:6144
    v_mfma_f32_16x16x32_bf16 v[24:27], v[72:75], v[152:155], v[24:27]
    s_cmp_gt_u32 s37, 8
    s_cbranch_scc0 C2_h8
    C2_h8_r:
    buffer_load_dwordx4 v[64:67], v48, s[8:11], s38 offen offset:0 sc1
    v_mfma_f32_16x16x32_bf16 v[28:31], v[72:75], v[156:159], v[28:31]
    buffer_load_dwordx4 v[68:71], v49, s[8:11], s38 offen offset:0 sc1
    v_mfma_f32_16x16x32_bf16 v[44:47], v[76:79], v[156:159], v[44:47]
    ds_write_b128 v53, v[212:215] offset:17408
    v_mfma_f32_16x16x32_bf16 v[40:43], v[76:79], v[152:155], v[40:43]
    v_mfma_f32_16x16x32_bf16 v[36:39], v[76:79], v[148:151], v[36:39]
    v_mfma_f32_16x16x32_bf16 v[32:35], v[76:79], v[144:147], v[32:35]
    s_waitcnt vmcnt(12) lgkmcnt(1)
    v_mfma_f32_16x16x32_bf16 v[16:19], v[80:83], v[128:131], v[16:19]
    ds_read_b128 v[144:147], v11 offset:0
    ds_read_b128 v[148:151], v11 offset:2048
    v_mfma_f32_16x16x32_bf16 v[20:23], v[80:83], v[132:135], v[20:23]
    ds_read_b128 v[152:155], v11 offset:4096
    ds_read_b128 v[156:159], v11 offset:6144
    v_mfma_f32_16x16x32_bf16 v[24:27], v[80:83], v[136:139], v[24:27]
    buffer_load_dwordx4 v[72:75], v48, s[8:11], s38 offen offset:1024 sc1
    v_mfma_f32_16x16x32_bf16 v[28:31], v[80:83], v[140:143], v[28:31]
    buffer_load_dwordx4 v[76:79], v49, s[8:11], s38 offen offset:1024 sc1
    v_mfma_f32_16x16x32_bf16 v[44:47], v[84:87], v[140:143], v[44:47]
    ds_write_b128 v53, v[216:219] offset:24576
    v_mfma_f32_16x16x32_bf16 v[40:43], v[84:87], v[136:139], v[40:43]
    v_mfma_f32_16x16x32_bf16 v[36:39], v[84:87], v[132:135], v[36:39]
    v_mfma_f32_16x16x32_bf16 v[32:35], v[84:87], v[128:131], v[32:35]
    s_waitcnt vmcnt(12) lgkmcnt(1)
    v_mfma_f32_16x16x32_bf16 v[16:19], v[88:91], v[144:147], v[16:19]
    ds_read_b128 v[128:131], v8 offset:16384
    ds_read_b128 v[132:135], v8 offset:18432
    v_mfma_f32_16x16x32_bf16 v[20:23], v[88:91], v[148:151], v[20:23]
    ds_read_b128 v[136:139], v8 offset:20480
    ds_read_b128 v[140:143], v8 offset:22528
    v_mfma_f32_16x16x32_bf16 v[24:27], v[88:91], v[152:155], v[24:27]
    ds_write_b128 v53, v[220:223] offset:25600
    v_mfma_f32_16x16x32_bf16 v[28:31], v[88:91], v[156:159], v[28:31]
    v_mov_b32 v1, 7
    ds_write_b32 v63, v1 offset:96
    v_mfma_f32_16x16x32_bf16 v[44:47], v[92:95], v[156:159], v[44:47]
    ds_read_b128 v[56:59], v62 offset:96
    v_mfma_f32_16x16x32_bf16 v[40:43], v[92:95], v[152:155], v[40:43]
    buffer_load_dwordx4 v[80:83], v48, s[8:11], s38 offen offset:2048 sc1
    v_mfma_f32_16x16x32_bf16 v[36:39], v[92:95], v[148:151], v[36:39]
    buffer_load_dwordx4 v[84:87], v49, s[8:11], s38 offen offset:2048 sc1
    v_mfma_f32_16x16x32_bf16 v[32:35], v[92:95], v[144:147], v[32:35]
    s_waitcnt vmcnt(12) lgkmcnt(0)
    v_mfma_f32_16x16x32_bf16 v[16:19], v[96:99], v[128:131], v[16:19]
    ds_read_b128 v[144:147], v9 offset:16384
    ds_read_b128 v[148:151], v9 offset:18432
    v_mfma_f32_16x16x32_bf16 v[20:23], v[96:99], v[132:135], v[20:23]
    ds_read_b128 v[152:155], v9 offset:20480
    ds_read_b128 v[156:159], v9 offset:22528
    v_mfma_f32_16x16x32_bf16 v[24:27], v[96:99], v[136:139], v[24:27]
    buffer_load_dwordx4 v[88:91], v48, s[8:11], s38 offen offset:3072 sc1
    v_mfma_f32_16x16x32_bf16 v[28:31], v[96:99], v[140:143], v[28:31]
    buffer_load_dwordx4 v[92:95], v49, s[8:11], s38 offen offset:3072 sc1
    s_add_u32 s38, s38, 32768
    s_and_b32 s38, s38, 0x3ffff
    s_or_b32 s38, s38, s31
    v_mfma_f32_16x16x32_bf16 v[44:47], v[100:103], v[140:143], v[44:47]
    v_min3_u32 v56, v56, v57, v58
    v_mfma_f32_16x16x32_bf16 v[40:43], v[100:103], v[136:139], v[40:43]
    v_min_u32 v56, v56, v59
    v_mfma_f32_16x16x32_bf16 v[36:39], v[100:103], v[132:135], v[36:39]
    v_cmp_gt_u32 vcc, 6, v56
    v_mfma_f32_16x16x32_bf16 v[32:35], v[100:103], v[128:131], v[32:35]
    s_cbranch_vccnz C2_p7
    C2_p7_r:
    s_waitcnt vmcnt(12) lgkmcnt(0)
    v_mfma_f32_16x16x32_bf16 v[16:19], v[104:107], v[144:147], v[16:19]
    ds_read_b128 v[128:131], v10 offset:16384
    ds_read_b128 v[132:135], v10 offset:18432
    v_mfma_f32_16x16x32_bf16 v[20:23], v[104:107], v[148:151], v[20:23]
    ds_read_b128 v[136:139], v10 offset:20480
    ds_read_b128 v[140:143], v10 offset:22528
    v_mfma_f32_16x16x32_bf16 v[24:27], v[104:107], v[152:155], v[24:27]
    s_cmp_gt_u32 s37, 9
    s_cbranch_scc0 C2_h9
    C2_h9_r:
    buffer_load_dwordx4 v[96:99], v48, s[8:11], s38 offen offset:0 sc1
    v_mfma_f32_16x16x32_bf16 v[28:31], v[104:107], v[156:159], v[28:31]
    buffer_load_dwordx4 v[100:103], v49, s[8:11], s38 offen offset:0 sc1
    v_mfma_f32_16x16x32_bf16 v[44:47], v[108:111], v[156:159], v[44:47]
    v_mfma_f32_16x16x32_bf16 v[40:43], v[108:111], v[152:155], v[40:43]
    v_mfma_f32_16x16x32_bf16 v[36:39], v[108:111], v[148:151], v[36:39]
    v_mfma_f32_16x16x32_bf16 v[32:35], v[108:111], v[144:147], v[32:35]
    s_waitcnt vmcnt(12) lgkmcnt(0)
    v_mfma_f32_16x16x32_bf16 v[16:19], v[112:115], v[128:131], v[16:19]
    ds_read_b128 v[144:147], v11 offset:16384
    ds_read_b128 v[148:151], v11 offset:18432
    v_mfma_f32_16x16x32_bf16 v[20:23], v[112:115], v[132:135], v[20:23]
    ds_read_b128 v[152:155], v11 offset:20480
    ds_read_b128 v[156:159], v11 offset:22528
    v_mfma_f32_16x16x32_bf16 v[24:27], v[112:115], v[136:139], v[24:27]
    buffer_load_dwordx4 v[104:107], v48, s[8:11], s38 offen offset:1024 sc1
    v_mfma_f32_16x16x32_bf16 v[28:31], v[112:115], v[140:143], v[28:31]
    buffer_load_dwordx4 v[108:111], v49, s[8:11], s38 offen offset:1024 sc1
    v_mfma_f32_16x16x32_bf16 v[44:47], v[116:119], v[140:143], v[44:47]
    v_mfma_f32_16x16x32_bf16 v[40:43], v[116:119], v[136:139], v[40:43]
    v_mfma_f32_16x16x32_bf16 v[36:39], v[116:119], v[132:135], v[36:39]
    v_mfma_f32_16x16x32_bf16 v[32:35], v[116:119], v[128:131], v[32:35]
    s_waitcnt vmcnt(12) lgkmcnt(0)
    v_mfma_f32_16x16x32_bf16 v[16:19], v[120:123], v[144:147], v[16:19]
    ds_read_b128 v[128:131], v8 offset:32768
    ds_read_b128 v[132:135], v8 offset:34816
    v_mfma_f32_16x16x32_bf16 v[20:23], v[120:123], v[148:151], v[20:23]
    ds_read_b128 v[136:139], v8 offset:36864
    ds_read_b128 v[140:143], v8 offset:38912
    v_mfma_f32_16x16x32_bf16 v[24:27], v[120:123], v[152:155], v[24:27]
    v_mov_b32 v1, 8
    ds_write_b32 v63, v1 offset:96
    v_mfma_f32_16x16x32_bf16 v[28:31], v[120:123], v[156:159], v[28:31]
    ds_read_b128 v[56:59], v62 offset:96
    v_mfma_f32_16x16x32_bf16 v[44:47], v[124:127], v[156:159], v[44:47]
    buffer_load_dwordx4 v[112:115], v48, s[8:11], s38 offen offset:2048 sc1
    v_mfma_f32_16x16x32_bf16 v[40:43], v[124:127], v[152:155], v[40:43]
    buffer_load_dwordx4 v[116:119], v49, s[8:11], s38 offen offset:2048 sc1
    v_mfma_f32_16x16x32_bf16 v[36:39], v[124:127], v[148:151], v[36:39]
    v_mfma_f32_16x16x32_bf16 v[32:35], v[124:127], v[144:147], v[32:35]
    s_waitcnt vmcnt(12) lgkmcnt(0)
    v_mfma_f32_16x16x32_bf16 v[16:19], v[64:67], v[128:131], v[16:19]
    ds_read_b128 v[144:147], v9 offset:32768
    ds_read_b128 v[148:151], v9 offset:34816
    v_mfma_f32_16x16x32_bf16 v[20:23], v[64:67], v[132:135], v[20:23]
    ds_read_b128 v[152:155], v9 offset:36864
    ds_read_b128 v[156:159], v9 offset:38912
    v_mfma_f32_16x16x32_bf16 v[24:27], v[64:67], v[136:139], v[24:27]
    buffer_load_dwordx4 v[120:123], v48, s[8:11], s38 offen offset:3072 sc1
    v_mfma_f32_16x16x32_bf16 v[28:31], v[64:67], v[140:143], v[28:31]
    buffer_load_dwordx4 v[124:127], v49, s[8:11], s38 offen offset:3072 sc1
    s_add_u32 s38, s38, 32768
    s_and_b32 s38, s38, 0x3ffff
    s_or_b32 s38, s38, s31
    v_mfma_f32_16x16x32_bf16 v[44:47], v[68:71], v[140:143], v[44:47]
    v_min3_u32 v56, v56, v57, v58
    v_mfma_f32_16x16x32_bf16 v[40:43], v[68:71], v[136:139], v[40:43]
    v_min_u32 v56, v56, v59
    v_mfma_f32_16x16x32_bf16 v[36:39], v[68:71], v[132:135], v[36:39]
    v_cmp_gt_u32 vcc, 7, v56
    v_mfma_f32_16x16x32_bf16 v[32:35], v[68:71], v[128:131], v[32:35]
    s_cbranch_vccnz C2_p8
    C2_p8_r:
    s_waitcnt vmcnt(12) lgkmcnt(0)
    v_mfma_f32_16x16x32_bf16 v[16:19], v[72:75], v[144:147], v[16:19]
    ds_read_b128 v[128:131], v10 offset:32768
    ds_read_b128 v[132:135], v10 offset:34816
    v_mfma_f32_16x16x32_bf16 v[20:23], v[72:75], v[148:151], v[20:23]
    ds_read_b128 v[136:139], v10 offset:36864
    ds_read_b128 v[140:143], v10 offset:38912
    v_mfma_f32_16x16x32_bf16 v[24:27], v[72:75], v[152:155], v[24:27]
    s_cmp_gt_u32 s37, 10
    s_cbranch_scc0 C2_h10
    C2_h10_r:
    buffer_load_dwordx4 v[64:67], v48, s[8:11], s38 offen offset:0 sc1
    v_mfma_f32_16x16x32_bf16 v[28:31], v[72:75], v[156:159], v[28:31]
    buffer_load_dwordx4 v[68:71], v49, s[8:11], s38 offen offset:0 sc1
    v_mfma_f32_16x16x32_bf16 v[44:47], v[76:79], v[156:159], v[44:47]
    v_mfma_f32_16x16x32_bf16 v[40:43], v[76:79], v[152:155], v[40:43]
    v_mfma_f32_16x16x32_bf16 v[36:39], v[76:79], v[148:151], v[36:39]
    v_mfma_f32_16x16x32_bf16 v[32:35], v[76:79], v[144:147], v[32:35]
    s_waitcnt vmcnt(12) lgkmcnt(0)
    v_mfma_f32_16x16x32_bf16 v[16:19], v[80:83], v[128:131], v[16:19]
    ds_read_b128 v[144:147], v11 offset:32768
    ds_read_b128 v[148:151], v11 offset:34816
    v_mfma_f32_16x16x32_bf16 v[20:23], v[80:83], v[132:135], v[20:23]
    ds_read_b128 v[152:155], v11 offset:36864
    ds_read_b128 v[156:159], v11 offset:38912
    v_mfma_f32_16x16x32_bf16 v[24:27], v[80:83], v[136:139], v[24:27]
    buffer_load_dwordx4 v[72:75], v48, s[8:11], s38 offen offset:1024 sc1
    v_mfma_f32_16x16x32_bf16 v[28:31], v[80:83], v[140:143], v[28:31]
    buffer_load_dwordx4 v[76:79], v49, s[8:11], s38 offen offset:1024 sc1
    v_mfma_f32_16x16x32_bf16 v[44:47], v[84:87], v[140:143], v[44:47]
    v_mfma_f32_16x16x32_bf16 v[40:43], v[84:87], v[136:139], v[40:43]
    v_mfma_f32_16x16x32_bf16 v[36:39], v[84:87], v[132:135], v[36:39]
    v_mfma_f32_16x16x32_bf16 v[32:35], v[84:87], v[128:131], v[32:35]
    s_waitcnt vmcnt(12) lgkmcnt(0)
    v_mfma_f32_16x16x32_bf16 v[16:19], v[88:91], v[144:147], v[16:19]
    ds_read_b128 v[128:131], v4 offset:0
    ds_read_b128 v[132:135], v4 offset:2048
    v_mfma_f32_16x16x32_bf16 v[20:23], v[88:91], v[148:151], v[20:23]
    ds_read_b128 v[136:139], v4 offset:4096
    ds_read_b128 v[140:143], v4 offset:6144
    v_mfma_f32_16x16x32_bf16 v[24:27], v[88:91], v[152:155], v[24:27]
    v_mov_b32 v1, 9
    ds_write_b32 v63, v1 offset:96
    v_mfma_f32_16x16x32_bf16 v[28:31], v[88:91], v[156:159], v[28:31]
    buffer_load_dwordx4 v[80:83], v48, s[8:11], s38 offen offset:2048 sc1
    v_mfma_f32_16x16x32_bf16 v[44:47], v[92:95], v[156:159], v[44:47]
    buffer_load_dwordx4 v[84:87], v49, s[8:11], s38 offen offset:2048 sc1
    v_mfma_f32_16x16x32_bf16 v[40:43], v[92:95], v[152:155], v[40:43]
    v_mfma_f32_16x16x32_bf16 v[36:39], v[92:95], v[148:151], v[36:39]
    v_mfma_f32_16x16x32_bf16 v[32:35], v[92:95], v[144:147], v[32:35]
    s_waitcnt vmcnt(12) lgkmcnt(1)
    v_mfma_f32_16x16x32_bf16 v[16:19], v[96:99], v[128:131], v[16:19]
    ds_read_b128 v[144:147], v5 offset:0
    ds_read_b128 v[148:151], v5 offset:2048
    v_mfma_f32_16x16x32_bf16 v[20:23], v[96:99], v[132:135], v[20:23]
    ds_read_b128 v[152:155], v5 offset:4096
    ds_read_b128 v[156:159], v5 offset:6144
    v_mfma_f32_16x16x32_bf16 v[24:27], v[96:99], v[136:139], v[24:27]
    buffer_load_dwordx4 v[88:91], v48, s[8:11], s38 offen offset:3072 sc1
    v_mfma_f32_16x16x32_bf16 v[28:31], v[96:99], v[140:143], v[28:31]
    buffer_load_dwordx4 v[92:95], v49, s[8:11], s38 offen offset:3072 sc1
    s_add_u32 s38, s38, 32768
    s_and_b32 s38, s38, 0x3ffff
    s_or_b32 s38, s38, s31
    v_mfma_f32_16x16x32_bf16 v[44:47], v[100:103], v[140:143], v[44:47]
    v_mfma_f32_16x16x32_bf16 v[40:43], v[100:103], v[136:139], v[40:43]
    v_mfma_f32_16x16x32_bf16 v[36:39], v[100:103], v[132:135], v[36:39]
    v_mfma_f32_16x16x32_bf16 v[32:35], v[100:103], v[128:131], v[32:35]
    s_waitcnt vmcnt(12) lgkmcnt(0)
    v_mfma_f32_16x16x32_bf16 v[16:19], v[104:107], v[144:147], v[16:19]
    ds_read_b128 v[128:131], v6 offset:0
    ds_read_b128 v[132:135], v6 offset:2048
    v_mfma_f32_16x16x32_bf16 v[20:23], v[104:107], v[148:151], v[20:23]
    ds_read_b128 v[136:139], v6 offset:4096
    ds_read_b128 v[140:143], v6 offset:6144
    v_mfma_f32_16x16x32_bf16 v[24:27], v[104:107], v[152:155], v[24:27]
    s_cmp_gt_u32 s37, 11
    s_cbranch_scc0 C2_h11
    C2_h11_r:
    buffer_load_dwordx4 v[96:99], v48, s[8:11], s38 offen offset:0 sc1
    v_mfma_f32_16x16x32_bf16 v[28:31], v[104:107], v[156:159], v[28:31]
    buffer_load_dwordx4 v[100:103], v49, s[8:11], s38 offen offset:0 sc1
    v_mfma_f32_16x16x32_bf16 v[44:47], v[108:111], v[156:159], v[44:47]
    v_mfma_f32_16x16x32_bf16 v[40:43], v[108:111], v[152:155], v[40:43]
    v_mfma_f32_16x16x32_bf16 v[36:39], v[108:111], v[148:151], v[36:39]
    v_mfma_f32_16x16x32_bf16 v[32:35], v[108:111], v[144:147], v[32:35]
    s_waitcnt vmcnt(12) lgkmcnt(0)
    v_mfma_f32_16x16x32_bf16 v[16:19], v[112:115], v[128:131], v[16:19]
    ds_read_b128 v[144:147], v7 offset:0
    ds_read_b128 v[148:151], v7 offset:2048
    v_mfma_f32_16x16x32_bf16 v[20:23], v[112:115], v[132:135], v[20:23]
    ds_read_b128 v[152:155], v7 offset:4096
    ds_read_b128 v[156:159], v7 offset:6144
    v_mfma_f32_16x16x32_bf16 v[24:27], v[112:115], v[136:139], v[24:27]
    buffer_load_dwordx4 v[104:107], v48, s[8:11], s38 offen offset:1024 sc1
    v_mfma_f32_16x16x32_bf16 v[28:31], v[112:115], v[140:143], v[28:31]
    buffer_load_dwordx4 v[108:111], v49, s[8:11], s38 offen offset:1024 sc1
    v_mfma_f32_16x16x32_bf16 v[44:47], v[116:119], v[140:143], v[44:47]
    v_mfma_f32_16x16x32_bf16 v[40:43], v[116:119], v[136:139], v[40:43]
    v_mfma_f32_16x16x32_bf16 v[36:39], v[116:119], v[132:135], v[36:39]
    v_mfma_f32_16x16x32_bf16 v[32:35], v[116:119], v[128:131], v[32:35]
    s_waitcnt vmcnt(12) lgkmcnt(0)
    v_mfma_f32_16x16x32_bf16 v[16:19], v[120:123], v[144:147], v[16:19]
    ds_read_b128 v[128:131], v4 offset:16384
    ds_read_b128 v[132:135], v4 offset:18432
    v_mfma_f32_16x16x32_bf16 v[20:23], v[120:123], v[148:151], v[20:23]
    ds_read_b128 v[136:139], v4 offset:20480
    ds_read_b128 v[140:143], v4 offset:22528
    v_mfma_f32_16x16x32_bf16 v[24:27], v[120:123], v[152:155], v[24:27]
    v_mov_b32 v1, 10
    ds_write_b32 v63, v1 offset:96
    v_mfma_f32_16x16x32_bf16 v[28:31], v[120:123], v[156:159], v[28:31]
    ds_read_b128 v[12:15], v62 offset:48
    v_mfma_f32_16x16x32_bf16 v[44:47], v[124:127], v[156:159], v[44:47]
    buffer_load_dwordx4 v[112:115], v48, s[8:11], s38 offen offset:2048 sc1
    v_mfma_f32_16x16x32_bf16 v[40:43], v[124:127], v[152:155], v[40:43]
    buffer_load_dwordx4 v[116:119], v49, s[8:11], s38 offen offset:2048 sc1
    v_mfma_f32_16x16x32_bf16 v[36:39], v[124:127], v[148:151], v[36:39]
    v_mfma_f32_16x16x32_bf16 v[32:35], v[124:127], v[144:147], v[32:35]
    s_waitcnt vmcnt(12) lgkmcnt(0)
    v_mfma_f32_16x16x32_bf16 v[16:19], v[64:67], v[128:131], v[16:19]
    ds_read_b128 v[144:147], v5 offset:16384
    ds_read_b128 v[148:151], v5 offset:18432
    v_mfma_f32_16x16x32_bf16 v[20:23], v[64:67], v[132:135], v[20:23]
    ds_read_b128 v[152:155], v5 offset:20480
    ds_read_b128 v[156:159], v5 offset:22528
    v_mfma_f32_16x16x32_bf16 v[24:27], v[64:67], v[136:139], v[24:27]
    buffer_load_dwordx4 v[120:123], v48, s[8:11], s38 offen offset:3072 sc1
    v_mfma_f32_16x16x32_bf16 v[28:31], v[64:67], v[140:143], v[28:31]
    buffer_load_dwordx4 v[124:127], v49, s[8:11], s38 offen offset:3072 sc1
    s_add_u32 s38, s38, 32768
    s_and_b32 s38, s38, 0x3ffff
    s_or_b32 s38, s38, s31
    v_mfma_f32_16x16x32_bf16 v[44:47], v[68:71], v[140:143], v[44:47]
    v_min3_u32 v12, v12, v13, v14
    v_mfma_f32_16x16x32_bf16 v[40:43], v[68:71], v[136:139], v[40:43]
    v_min_u32 v12, v12, v15
    v_mfma_f32_16x16x32_bf16 v[36:39], v[68:71], v[132:135], v[36:39]
    v_cmp_gt_u32 vcc, 12, v12
    v_mfma_f32_16x16x32_bf16 v[32:35], v[68:71], v[128:131], v[32:35]
    s_cbranch_vccnz C2_q10
    C2_q10_r:
    s_waitcnt vmcnt(12) lgkmcnt(0)
    v_mfma_f32_16x16x32_bf16 v[16:19], v[72:75], v[144:147], v[16:19]
    ds_read_b128 v[128:131], v6 offset:16384
    ds_read_b128 v[132:135], v6 offset:18432
    v_mfma_f32_16x16x32_bf16 v[20:23], v[72:75], v[148:151], v[20:23]
    ds_read_b128 v[136:139], v6 offset:20480
    ds_read_b128 v[140:143], v6 offset:22528
    v_mfma_f32_16x16x32_bf16 v[24:27], v[72:75], v[152:155], v[24:27]
    s_cmp_gt_u32 s37, 12
    s_cbranch_scc0 C2_h12
    C2_h12_r:
    buffer_load_dwordx4 v[64:67], v48, s[8:11], s38 offen offset:0 sc1
    v_mfma_f32_16x16x32_bf16 v[28:31], v[72:75], v[156:159], v[28:31]
    buffer_load_dwordx4 v[68:71], v49, s[8:11], s38 offen offset:0 sc1
    v_mfma_f32_16x16x32_bf16 v[44:47], v[76:79], v[156:159], v[44:47]
    v_mfma_f32_16x16x32_bf16 v[40:43], v[76:79], v[152:155], v[40:43]
    v_mfma_f32_16x16x32_bf16 v[36:39], v[76:79], v[148:151], v[36:39]
    v_mfma_f32_16x16x32_bf16 v[32:35], v[76:79], v[144:147], v[32:35]
    s_waitcnt vmcnt(12) lgkmcnt(0)
    v_mfma_f32_16x16x32_bf16 v[16:19], v[80:83], v[128:131], v[16:19]
    ds_read_b128 v[144:147], v7 offset:16384
    ds_read_b128 v[148:151], v7 offset:18432
    v_mfma_f32_16x16x32_bf16 v[20:23], v[80:83], v[132:135], v[20:23]
    ds_read_b128 v[152:155], v7 offset:20480
    ds_read_b128 v[156:159], v7 offset:22528
    v_mfma_f32_16x16x32_bf16 v[24:27], v[80:83], v[136:139], v[24:27]
    buffer_load_dwordx4 v[72:75], v48, s[8:11], s38 offen offset:1024 sc1
    v_mfma_f32_16x16x32_bf16 v[28:31], v[80:83], v[140:143], v[28:31]
    buffer_load_dwordx4 v[76:79], v49, s[8:11], s38 offen offset:1024 sc1
    v_mfma_f32_16x16x32_bf16 v[44:47], v[84:87], v[140:143], v[44:47]
    v_mfma_f32_16x16x32_bf16 v[40:43], v[84:87], v[136:139], v[40:43]
    v_mfma_f32_16x16x32_bf16 v[36:39], v[84:87], v[132:135], v[36:39]
    v_mfma_f32_16x16x32_bf16 v[32:35], v[84:87], v[128:131], v[32:35]
    s_waitcnt vmcnt(12) lgkmcnt(0)
    v_mfma_f32_16x16x32_bf16 v[16:19], v[88:91], v[144:147], v[16:19]
    ds_read_b128 v[128:131], v4 offset:32768
    ds_read_b128 v[132:135], v4 offset:34816
    v_mfma_f32_16x16x32_bf16 v[20:23], v[88:91], v[148:151], v[20:23]
    ds_read_b128 v[136:139], v4 offset:36864
    ds_read_b128 v[140:143], v4 offset:38912
    v_mfma_f32_16x16x32_bf16 v[24:27], v[88:91], v[152:155], v[24:27]
    v_mov_b32 v1, 11
    ds_write_b32 v63, v1 offset:96
    v_mfma_f32_16x16x32_bf16 v[28:31], v[88:91], v[156:159], v[28:31]
    ds_read_b128 v[12:15], v62 offset:48
    v_mfma_f32_16x16x32_bf16 v[44:47], v[92:95], v[156:159], v[44:47]
    buffer_load_dwordx4 v[80:83], v48, s[8:11], s38 offen offset:2048 sc1
    v_mfma_f32_16x16x32_bf16 v[40:43], v[92:95], v[152:155], v[40:43]
    buffer_load_dwordx4 v[84:87], v49, s[8:11], s38 offen offset:2048 sc1
    v_mfma_f32_16x16x32_bf16 v[36:39], v[92:95], v[148:151], v[36:39]
    v_mfma_f32_16x16x32_bf16 v[32:35], v[92:95], v[144:147], v[32:35]
    s_waitcnt vmcnt(12) lgkmcnt(0)
    v_mfma_f32_16x16x32_bf16 v[16:19], v[96:99], v[128:131], v[16:19]
    ds_read_b128 v[144:147], v5 offset:32768
    ds_read_b128 v[148:151], v5 offset:34816
    v_mfma_f32_16x16x32_bf16 v[20:23], v[96:99], v[132:135], v[20:23]
    ds_read_b128 v[152:155], v5 offset:36864
    ds_read_b128 v[156:159], v5 offset:38912
    v_mfma_f32_16x16x32_bf16 v[24:27], v[96:99], v[136:139], v[24:27]
    buffer_load_dwordx4 v[88:91], v48, s[8:11], s38 offen offset:3072 sc1
    v_mfma_f32_16x16x32_bf16 v[28:31], v[96:99], v[140:143], v[28:31]
    buffer_load_dwordx4 v[92:95], v49, s[8:11], s38 offen offset:3072 sc1
    s_add_u32 s38, s38, 32768
    s_and_b32 s38, s38, 0x3ffff
    s_or_b32 s38, s38, s31
    v_mfma_f32_16x16x32_bf16 v[44:47], v[100:103], v[140:143], v[44:47]
    v_min3_u32 v12, v12, v13, v14
    v_mfma_f32_16x16x32_bf16 v[40:43], v[100:103], v[136:139], v[40:43]
    v_min_u32 v12, v12, v15
    v_mfma_f32_16x16x32_bf16 v[36:39], v[100:103], v[132:135], v[36:39]
    v_cmp_gt_u32 vcc, 13, v12
    v_mfma_f32_16x16x32_bf16 v[32:35], v[100:103], v[128:131], v[32:35]
    s_cbranch_vccnz C2_q11
    C2_q11_r:
    s_waitcnt vmcnt(12) lgkmcnt(0)
    v_mfma_f32_16x16x32_bf16 v[16:19], v[104:107], v[144:147], v[16:19]
    ds_read_b128 v[128:131], v6 offset:32768
    ds_read_b128 v[132:135], v6 offset:34816
    v_mfma_f32_16x16x32_bf16 v[20:23], v[104:107], v[148:151], v[20:23]
    ds_read_b128 v[136:139], v6 offset:36864
    ds_read_b128 v[140:143], v6 offset:38912
    v_mfma_f32_16x16x32_bf16 v[24:27], v[104:107], v[152:155], v[24:27]
    s_cmp_gt_u32 s37, 13
    s_cbranch_scc0 C2_h13
    C2_h13_r:
    buffer_load_dwordx4 v[96:99], v48, s[8:11], s38 offen offset:0 sc1
    v_mfma_f32_16x16x32_bf16 v[28:31], v[104:107], v[156:159], v[28:31]
    buffer_load_dwordx4 v[100:103], v49, s[8:11], s38 offen offset:0 sc1
    v_mfma_f32_16x16x32_bf16 v[44:47], v[108:111], v[156:159], v[44:47]
    v_mfma_f32_16x16x32_bf16 v[40:43], v[108:111], v[152:155], v[40:43]
    v_mfma_f32_16x16x32_bf16 v[36:39], v[108:111], v[148:151], v[36:39]
    v_mfma_f32_16x16x32_bf16 v[32:35], v[108:111], v[144:147], v[32:35]
    s_waitcnt vmcnt(12) lgkmcnt(0)
    v_mfma_f32_16x16x32_bf16 v[16:19], v[112:115], v[128:131], v[16:19]
    ds_read_b128 v[144:147], v7 offset:32768
    ds_read_b128 v[148:151], v7 offset:34816
    v_mfma_f32_16x16x32_bf16 v[20:23], v[112:115], v[132:135], v[20:23]
    ds_read_b128 v[152:155], v7 offset:36864
    ds_read_b128 v[156:159], v7 offset:38912
    v_mfma_f32_16x16x32_bf16 v[24:27], v[112:115], v[136:139], v[24:27]
    buffer_load_dwordx4 v[104:107], v48, s[8:11], s38 offen offset:1024 sc1
    v_mfma_f32_16x16x32_bf16 v[28:31], v[112:115], v[140:143], v[28:31]
    buffer_load_dwordx4 v[108:111], v49, s[8:11], s38 offen offset:1024 sc1
    v_mfma_f32_16x16x32_bf16 v[44:47], v[116:119], v[140:143], v[44:47]
    v_mfma_f32_16x16x32_bf16 v[40:43], v[116:119], v[136:139], v[40:43]
    v_mfma_f32_16x16x32_bf16 v[36:39], v[116:119], v[132:135], v[36:39]
    v_mfma_f32_16x16x32_bf16 v[32:35], v[116:119], v[128:131], v[32:35]
    s_waitcnt vmcnt(12) lgkmcnt(0)
    v_mfma_f32_16x16x32_bf16 v[16:19], v[120:123], v[144:147], v[16:19]
    ds_read_b128 v[128:131], v8 offset:0
    ds_read_b128 v[132:135], v8 offset:2048
    v_mfma_f32_16x16x32_bf16 v[20:23], v[120:123], v[148:151], v[20:23]
    ds_read_b128 v[136:139], v8 offset:4096
    ds_read_b128 v[140:143], v8 offset:6144
    v_mfma_f32_16x16x32_bf16 v[24:27], v[120:123], v[152:155], v[24:27]
    v_mov_b32 v1, 12
    ds_write_b32 v63, v1 offset:96
    v_mfma_f32_16x16x32_bf16 v[28:31], v[120:123], v[156:159], v[28:31]
    ds_read_b128 v[12:15], v62 offset:48
    v_mfma_f32_16x16x32_bf16 v[44:47], v[124:127], v[156:159], v[44:47]
    buffer_load_dwordx4 v[112:115], v48, s[8:11], s38 offen offset:2048 sc1
    v_mfma_f32_16x16x32_bf16 v[40:43], v[124:127], v[152:155], v[40:43]
    buffer_load_dwordx4 v[116:119], v49, s[8:11], s38 offen offset:2048 sc1
    v_mfma_f32_16x16x32_bf16 v[36:39], v[124:127], v[148:151], v[36:39]
    v_mfma_f32_16x16x32_bf16 v[32:35], v[124:127], v[144:147], v[32:35]
    s_waitcnt vmcnt(12) lgkmcnt(0)
    v_mfma_f32_16x16x32_bf16 v[16:19], v[64:67], v[128:131], v[16:19]
    ds_read_b128 v[144:147], v9 offset:0
    ds_read_b128 v[148:151], v9 offset:2048
    v_mfma_f32_16x16x32_bf16 v[20:23], v[64:67], v[132:135], v[20:23]
    ds_read_b128 v[152:155], v9 offset:4096
    ds_read_b128 v[156:159], v9 offset:6144
    v_mfma_f32_16x16x32_bf16 v[24:27], v[64:67], v[136:139], v[24:27]
    buffer_load_dwordx4 v[120:123], v48, s[8:11], s38 offen offset:3072 sc1
    v_mfma_f32_16x16x32_bf16 v[28:31], v[64:67], v[140:143], v[28:31]
    buffer_load_dwordx4 v[124:127], v49, s[8:11], s38 offen offset:3072 sc1
    s_add_u32 s38, s38, 32768
    s_and_b32 s38, s38, 0x3ffff
    s_or_b32 s38, s38, s31
    v_mfma_f32_16x16x32_bf16 v[44:47], v[68:71], v[140:143], v[44:47]
    v_min3_u32 v12, v12, v13, v14
    v_mfma_f32_16x16x32_bf16 v[40:43], v[68:71], v[136:139], v[40:43]
    v_min_u32 v12, v12, v15
    v_mfma_f32_16x16x32_bf16 v[36:39], v[68:71], v[132:135], v[36:39]
    v_cmp_gt_u32 vcc, 14, v12
    v_mfma_f32_16x16x32_bf16 v[32:35], v[68:71], v[128:131], v[32:35]
    s_cbranch_vccnz C2_q12
    C2_q12_r:
    s_waitcnt vmcnt(12) lgkmcnt(0)
    v_mfma_f32_16x16x32_bf16 v[16:19], v[72:75], v[144:147], v[16:19]
    ds_read_b128 v[128:131], v10 offset:0
    ds_read_b128 v[132:135], v10 offset:2048
    v_mfma_f32_16x16x32_bf16 v[20:23], v[72:75], v[148:151], v[20:23]
    ds_read_b128 v[136:139], v10 offset:4096
    ds_read_b128 v[140:143], v10 offset:6144
    v_mfma_f32_16x16x32_bf16 v[24:27], v[72:75], v[152:155], v[24:27]
    s_cmp_gt_u32 s37, 14
    s_cbranch_scc0 C2_h14
    C2_h14_r:
    buffer_load_dwordx4 v[64:67], v48, s[8:11], s38 offen offset:0 sc1
    v_mfma_f32_16x16x32_bf16 v[28:31], v[72:75], v[156:159], v[28:31]
    buffer_load_dwordx4 v[68:71], v49, s[8:11], s38 offen offset:0 sc1
    v_mfma_f32_16x16x32_bf16 v[44:47], v[76:79], v[156:159], v[44:47]
    v_mfma_f32_16x16x32_bf16 v[40:43], v[76:79], v[152:155], v[40:43]
    v_mfma_f32_16x16x32_bf16 v[36:39], v[76:79], v[148:151], v[36:39]
    v_mfma_f32_16x16x32_bf16 v[32:35], v[76:79], v[144:147], v[32:35]
    s_waitcnt vmcnt(12) lgkmcnt(0)
    v_mfma_f32_16x16x32_bf16 v[16:19], v[80:83], v[128:131], v[16:19]
    ds_read_b128 v[144:147], v11 offset:0
    ds_read_b128 v[148:151], v11 offset:2048
    v_mfma_f32_16x16x32_bf16 v[20:23], v[80:83], v[132:135], v[20:23]
    ds_read_b128 v[152:155], v11 offset:4096
    ds_read_b128 v[156:159], v11 offset:6144
    v_mfma_f32_16x16x32_bf16 v[24:27], v[80:83], v[136:139], v[24:27]
    buffer_load_dwordx4 v[72:75], v48, s[8:11], s38 offen offset:1024 sc1
    v_mfma_f32_16x16x32_bf16 v[28:31], v[80:83], v[140:143], v[28:31]
    buffer_load_dwordx4 v[76:79], v49, s[8:11], s38 offen offset:1024 sc1
    v_mfma_f32_16x16x32_bf16 v[44:47], v[84:87], v[140:143], v[44:47]
    v_mfma_f32_16x16x32_bf16 v[40:43], v[84:87], v[136:139], v[40:43]
    v_mfma_f32_16x16x32_bf16 v[36:39], v[84:87], v[132:135], v[36:39]
    v_mfma_f32_16x16x32_bf16 v[32:35], v[84:87], v[128:131], v[32:35]
    s_waitcnt vmcnt(12) lgkmcnt(0)
    v_mfma_f32_16x16x32_bf16 v[16:19], v[88:91], v[144:147], v[16:19]
    ds_read_b128 v[128:131], v8 offset:16384
    ds_read_b128 v[132:135], v8 offset:18432
    v_mfma_f32_16x16x32_bf16 v[20:23], v[88:91], v[148:151], v[20:23]
    ds_read_b128 v[136:139], v8 offset:20480
    ds_read_b128 v[140:143], v8 offset:22528
    v_mfma_f32_16x16x32_bf16 v[24:27], v[88:91], v[152:155], v[24:27]
    v_mov_b32 v1, 13
    ds_write_b32 v63, v1 offset:96
    v_mfma_f32_16x16x32_bf16 v[28:31], v[88:91], v[156:159], v[28:31]
    ds_read_b128 v[12:15], v62 offset:48
    v_mfma_f32_16x16x32_bf16 v[44:47], v[92:95], v[156:159], v[44:47]
    buffer_load_dwordx4 v[80:83], v48, s[8:11], s38 offen offset:2048 sc1
    v_mfma_f32_16x16x32_bf16 v[40:43], v[92:95], v[152:155], v[40:43]
    buffer_load_dwordx4 v[84:87], v49, s[8:11], s38 offen offset:2048 sc1
    v_mfma_f32_16x16x32_bf16 v[36:39], v[92:95], v[148:151], v[36:39]
    v_mfma_f32_16x16x32_bf16 v[32:35], v[92:95], v[144:147], v[32:35]
    s_waitcnt vmcnt(12) lgkmcnt(0)
    v_mfma_f32_16x16x32_bf16 v[16:19], v[96:99], v[128:131], v[16:19]
    ds_read_b128 v[144:147], v9 offset:16384
    ds_read_b128 v[148:151], v9 offset:18432
    v_mfma_f32_16x16x32_bf16 v[20:23], v[96:99], v[132:135], v[20:23]
    ds_read_b128 v[152:155], v9 offset:20480
    ds_read_b128 v[156:159], v9 offset:22528
    v_mfma_f32_16x16x32_bf16 v[24:27], v[96:99], v[136:139], v[24:27]
    buffer_load_dwordx4 v[88:91], v48, s[8:11], s38 offen offset:3072 sc1
    v_mfma_f32_16x16x32_bf16 v[28:31], v[96:99], v[140:143], v[28:31]
    buffer_load_dwordx4 v[92:95], v49, s[8:11], s38 offen offset:3072 sc1
    s_add_u32 s38, s38, 32768
    s_and_b32 s38, s38, 0x3ffff
    s_or_b32 s38, s38, s31
    v_mfma_f32_16x16x32_bf16 v[44:47], v[100:103], v[140:143], v[44:47]
    v_min3_u32 v12, v12, v13, v14
    v_mfma_f32_16x16x32_bf16 v[40:43], v[100:103], v[136:139], v[40:43]
    v_min_u32 v12, v12, v15
    v_mfma_f32_16x16x32_bf16 v[36:39], v[100:103], v[132:135], v[36:39]
    v_cmp_gt_u32 vcc, 15, v12
    v_mfma_f32_16x16x32_bf16 v[32:35], v[100:103], v[128:131], v[32:35]
    s_cbranch_vccnz C2_q13
    C2_q13_r:
    s_waitcnt vmcnt(12) lgkmcnt(0)
    v_mfma_f32_16x16x32_bf16 v[16:19], v[104:107], v[144:147], v[16:19]
    ds_read_b128 v[128:131], v10 offset:16384
    ds_read_b128 v[132:135], v10 offset:18432
    v_mfma_f32_16x16x32_bf16 v[20:23], v[104:107], v[148:151], v[20:23]
    ds_read_b128 v[136:139], v10 offset:20480
    ds_read_b128 v[140:143], v10 offset:22528
    v_mfma_f32_16x16x32_bf16 v[24:27], v[104:107], v[152:155], v[24:27]
    s_cmp_gt_u32 s37, 15
    s_cbranch_scc0 C2_h15
    C2_h15_r:
    buffer_load_dwordx4 v[96:99], v48, s[8:11], s38 offen offset:0 sc1
    v_mfma_f32_16x16x32_bf16 v[28:31], v[104:107], v[156:159], v[28:31]
    buffer_load_dwordx4 v[100:103], v49, s[8:11], s38 offen offset:0 sc1
    v_mfma_f32_16x16x32_bf16 v[44:47], v[108:111], v[156:159], v[44:47]
    v_mfma_f32_16x16x32_bf16 v[40:43], v[108:111], v[152:155], v[40:43]
    v_mfma_f32_16x16x32_bf16 v[36:39], v[108:111], v[148:151], v[36:39]
    v_mfma_f32_16x16x32_bf16 v[32:35], v[108:111], v[144:147], v[32:35]
    s_waitcnt vmcnt(12) lgkmcnt(0)
    v_mfma_f32_16x16x32_bf16 v[16:19], v[112:115], v[128:131], v[16:19]
    ds_read_b128 v[144:147], v11 offset:16384
    ds_read_b128 v[148:151], v11 offset:18432
    v_mfma_f32_16x16x32_bf16 v[20:23], v[112:115], v[132:135], v[20:23]
    ds_read_b128 v[152:155], v11 offset:20480
    ds_read_b128 v[156:159], v11 offset:22528
    v_mfma_f32_16x16x32_bf16 v[24:27], v[112:115], v[136:139], v[24:27]
    buffer_load_dwordx4 v[104:107], v48, s[8:11], s38 offen offset:1024 sc1
    v_mfma_f32_16x16x32_bf16 v[28:31], v[112:115], v[140:143], v[28:31]
    buffer_load_dwordx4 v[108:111], v49, s[8:11], s38 offen offset:1024 sc1
    v_mfma_f32_16x16x32_bf16 v[44:47], v[116:119], v[140:143], v[44:47]
    v_mfma_f32_16x16x32_bf16 v[40:43], v[116:119], v[136:139], v[40:43]
    v_mfma_f32_16x16x32_bf16 v[36:39], v[116:119], v[132:135], v[36:39]
    v_mfma_f32_16x16x32_bf16 v[32:35], v[116:119], v[128:131], v[32:35]
    s_waitcnt vmcnt(12) lgkmcnt(0)
    v_mfma_f32_16x16x32_bf16 v[16:19], v[120:123], v[144:147], v[16:19]
    ds_read_b128 v[128:131], v8 offset:32768
    ds_read_b128 v[132:135], v8 offset:34816
    v_mfma_f32_16x16x32_bf16 v[20:23], v[120:123], v[148:151], v[20:23]
    ds_read_b128 v[136:139], v8 offset:36864
    ds_read_b128 v[140:143], v8 offset:38912
    v_mfma_f32_16x16x32_bf16 v[24:27], v[120:123], v[152:155], v[24:27]
    v_mov_b32 v1, 14
    ds_write_b32 v63, v1 offset:96
    v_mfma_f32_16x16x32_bf16 v[28:31], v[120:123], v[156:159], v[28:31]
    ds_read_b128 v[12:15], v62 offset:48
    v_mfma_f32_16x16x32_bf16 v[44:47], v[124:127], v[156:159], v[44:47]
    buffer_load_dwordx4 v[112:115], v48, s[8:11], s38 offen offset:2048 sc1
    v_mfma_f32_16x16x32_bf16 v[40:43], v[124:127], v[152:155], v[40:43]
    buffer_load_dwordx4 v[116:119], v49, s[8:11], s38 offen offset:2048 sc1
    v_mfma_f32_16x16x32_bf16 v[36:39], v[124:127], v[148:151], v[36:39]
    v_mfma_f32_16x16x32_bf16 v[32:35], v[124:127], v[144:147], v[32:35]
    s_waitcnt vmcnt(12) lgkmcnt(0)
    v_mfma_f32_16x16x32_bf16 v[16:19], v[64:67], v[128:131], v[16:19]
    ds_read_b128 v[144:147], v9 offset:32768
    ds_read_b128 v[148:151], v9 offset:34816
    v_mfma_f32_16x16x32_bf16 v[20:23], v[64:67], v[132:135], v[20:23]
    ds_read_b128 v[152:155], v9 offset:36864
    ds_read_b128 v[156:159], v9 offset:38912
    v_mfma_f32_16x16x32_bf16 v[24:27], v[64:67], v[136:139], v[24:27]
    buffer_load_dwordx4 v[120:123], v48, s[8:11], s38 offen offset:3072 sc1
    v_mfma_f32_16x16x32_bf16 v[28:31], v[64:67], v[140:143], v[28:31]
    buffer_load_dwordx4 v[124:127], v49, s[8:11], s38 offen offset:3072 sc1
    s_add_u32 s38, s38, 32768
    s_and_b32 s38, s38, 0x3ffff
    s_or_b32 s38, s38, s30
    v_mfma_f32_16x16x32_bf16 v[44:47], v[68:71], v[140:143], v[44:47]
    v_min3_u32 v12, v12, v13, v14
    v_mfma_f32_16x16x32_bf16 v[40:43], v[68:71], v[136:139], v[40:43]
    v_min_u32 v12, v12, v15
    v_mfma_f32_16x16x32_bf16 v[36:39], v[68:71], v[132:135], v[36:39]
    v_cmp_gt_u32 vcc, 16, v12
    v_mfma_f32_16x16x32_bf16 v[32:35], v[68:71], v[128:131], v[32:35]
    s_cbranch_vccnz C2_q14
    C2_q14_r:
    s_waitcnt vmcnt(12) lgkmcnt(0)
    v_mfma_f32_16x16x32_bf16 v[16:19], v[72:75], v[144:147], v[16:19]
    ds_read_b128 v[128:131], v10 offset:32768
    ds_read_b128 v[132:135], v10 offset:34816
    v_mfma_f32_16x16x32_bf16 v[20:23], v[72:75], v[148:151], v[20:23]
    ds_read_b128 v[136:139], v10 offset:36864
    ds_read_b128 v[140:143], v10 offset:38912
    v_mfma_f32_16x16x32_bf16 v[24:27], v[72:75], v[152:155], v[24:27]
    v_mfma_f32_16x16x32_bf16 v[28:31], v[72:75], v[156:159], v[28:31]
    v_mfma_f32_16x16x32_bf16 v[44:47], v[76:79], v[156:159], v[44:47]
    v_mfma_f32_16x16x32_bf16 v[40:43], v[76:79], v[152:155], v[40:43]
    v_mfma_f32_16x16x32_bf16 v[36:39], v[76:79], v[148:151], v[36:39]
    v_mfma_f32_16x16x32_bf16 v[32:35], v[76:79], v[144:147], v[32:35]
    s_waitcnt vmcnt(10) lgkmcnt(0)
    v_mfma_f32_16x16x32_bf16 v[16:19], v[80:83], v[128:131], v[16:19]
    ds_read_b128 v[144:147], v11 offset:32768
    ds_read_b128 v[148:151], v11 offset:34816
    v_mfma_f32_16x16x32_bf16 v[20:23], v[80:83], v[132:135], v[20:23]
    ds_read_b128 v[152:155], v11 offset:36864
    ds_read_b128 v[156:159], v11 offset:38912
    v_mfma_f32_16x16x32_bf16 v[24:27], v[80:83], v[136:139], v[24:27]
    v_mfma_f32_16x16x32_bf16 v[28:31], v[80:83], v[140:143], v[28:31]
    v_mfma_f32_16x16x32_bf16 v[44:47], v[84:87], v[140:143], v[44:47]
    v_mfma_f32_16x16x32_bf16 v[40:43], v[84:87], v[136:139], v[40:43]
    v_mfma_f32_16x16x32_bf16 v[36:39], v[84:87], v[132:135], v[36:39]
    v_mfma_f32_16x16x32_bf16 v[32:35], v[84:87], v[128:131], v[32:35]
    s_waitcnt vmcnt(8) lgkmcnt(0)
    v_mfma_f32_16x16x32_bf16 v[16:19], v[88:91], v[144:147], v[16:19]
    ds_read_b128 v[128:131], v4 offset:0
    ds_read_b128 v[132:135], v4 offset:2048
    v_mfma_f32_16x16x32_bf16 v[20:23], v[88:91], v[148:151], v[20:23]
    ds_read_b128 v[136:139], v4 offset:4096
    ds_read_b128 v[140:143], v4 offset:6144
    v_mfma_f32_16x16x32_bf16 v[24:27], v[88:91], v[152:155], v[24:27]
    v_mov_b32 v1, 15
    ds_write_b32 v63, v1 offset:96
    v_mfma_f32_16x16x32_bf16 v[28:31], v[88:91], v[156:159], v[28:31]
    v_mfma_f32_16x16x32_bf16 v[44:47], v[92:95], v[156:159], v[44:47]
    v_mfma_f32_16x16x32_bf16 v[40:43], v[92:95], v[152:155], v[40:43]
    v_mfma_f32_16x16x32_bf16 v[36:39], v[92:95], v[148:151], v[36:39]
    v_mfma_f32_16x16x32_bf16 v[32:35], v[92:95], v[144:147], v[32:35]
    s_waitcnt vmcnt(6) lgkmcnt(1)
    v_mfma_f32_16x16x32_bf16 v[16:19], v[96:99], v[128:131], v[16:19]
    ds_read_b128 v[144:147], v5 offset:0
    ds_read_b128 v[148:151], v5 offset:2048
    v_mfma_f32_16x16x32_bf16 v[20:23], v[96:99], v[132:135], v[20:23]
    ds_read_b128 v[152:155], v5 offset:4096
    ds_read_b128 v[156:159], v5 offset:6144
    v_mfma_f32_16x16x32_bf16 v[24:27], v[96:99], v[136:139], v[24:27]
    v_mfma_f32_16x16x32_bf16 v[28:31], v[96:99], v[140:143], v[28:31]
    v_mfma_f32_16x16x32_bf16 v[44:47], v[100:103], v[140:143], v[44:47]
    v_mfma_f32_16x16x32_bf16 v[40:43], v[100:103], v[136:139], v[40:43]
    v_mfma_f32_16x16x32_bf16 v[36:39], v[100:103], v[132:135], v[36:39]
    v_mfma_f32_16x16x32_bf16 v[32:35], v[100:103], v[128:131], v[32:35]
    s_waitcnt vmcnt(4) lgkmcnt(0)
    v_mfma_f32_16x16x32_bf16 v[16:19], v[104:107], v[144:147], v[16:19]
    ds_read_b128 v[128:131], v6 offset:0
    ds_read_b128 v[132:135], v6 offset:2048
    v_mfma_f32_16x16x32_bf16 v[20:23], v[104:107], v[148:151], v[20:23]
    ds_read_b128 v[136:139], v6 offset:4096
    ds_read_b128 v[140:143], v6 offset:6144
    v_mfma_f32_16x16x32_bf16 v[24:27], v[104:107], v[152:155], v[24:27]
    v_mfma_f32_16x16x32_bf16 v[28:31], v[104:107], v[156:159], v[28:31]
    v_mfma_f32_16x16x32_bf16 v[44:47], v[108:111], v[156:159], v[44:47]
    v_mfma_f32_16x16x32_bf16 v[40:43], v[108:111], v[152:155], v[40:43]
    v_mfma_f32_16x16x32_bf16 v[36:39], v[108:111], v[148:151], v[36:39]
    v_mfma_f32_16x16x32_bf16 v[32:35], v[108:111], v[144:147], v[32:35]
    s_waitcnt vmcnt(2) lgkmcnt(0)
    v_mfma_f32_16x16x32_bf16 v[16:19], v[112:115], v[128:131], v[16:19]
    ds_read_b128 v[144:147], v7 offset:0
    ds_read_b128 v[148:151], v7 offset:2048
    v_mfma_f32_16x16x32_bf16 v[20:23], v[112:115], v[132:135], v[20:23]
    ds_read_b128 v[152:155], v7 offset:4096
    ds_read_b128 v[156:159], v7 offset:6144
    v_mfma_f32_16x16x32_bf16 v[24:27], v[112:115], v[136:139], v[24:27]
    v_mfma_f32_16x16x32_bf16 v[28:31], v[112:115], v[140:143], v[28:31]
    v_mfma_f32_16x16x32_bf16 v[44:47], v[116:119], v[140:143], v[44:47]
    v_mfma_f32_16x16x32_bf16 v[40:43], v[116:119], v[136:139], v[40:43]
    v_mfma_f32_16x16x32_bf16 v[36:39], v[116:119], v[132:135], v[36:39]
    v_mfma_f32_16x16x32_bf16 v[32:35], v[116:119], v[128:131], v[32:35]
    s_waitcnt vmcnt(0) lgkmcnt(0)
    v_mfma_f32_16x16x32_bf16 v[16:19], v[120:123], v[144:147], v[16:19]
    v_mfma_f32_16x16x32_bf16 v[20:23], v[120:123], v[148:151], v[20:23]
    v_mfma_f32_16x16x32_bf16 v[24:27], v[120:123], v[152:155], v[24:27]
    v_mfma_f32_16x16x32_bf16 v[28:31], v[120:123], v[156:159], v[28:31]
    v_mfma_f32_16x16x32_bf16 v[44:47], v[124:127], v[156:159], v[44:47]
    v_mfma_f32_16x16x32_bf16 v[40:43], v[124:127], v[152:155], v[40:43]
    v_mfma_f32_16x16x32_bf16 v[36:39], v[124:127], v[148:151], v[36:39]
    v_mfma_f32_16x16x32_bf16 v[32:35], v[124:127], v[144:147], v[32:35]
    s_nop 5
    v_mov_b32 v64, v16
    v_mov_b32 v65, v20
    v_mov_b32 v66, v24
    v_mov_b32 v67, v28
    s_mov_b32 s6, 0
    buffer_store_dwordx4 v[64:67], v50, s[76:79], s6 offen nt
    v_mov_b32 v68, v17
    v_mov_b32 v69, v21
    v_mov_b32 v70, v25
    v_mov_b32 v71, v29
    s_mov_b32 s6, 65536
    buffer_store_dwordx4 v[68:71], v50, s[76:79], s6 offen nt
    v_mov_b32 v72, v18
    v_mov_b32 v73, v22
    v_mov_b32 v74, v26
    v_mov_b32 v75, v30
    s_mov_b32 s6, 131072
    buffer_store_dwordx4 v[72:75], v50, s[76:79], s6 offen nt
    v_mov_b32 v76, v19
    v_mov_b32 v77, v23
    v_mov_b32 v78, v27
    v_mov_b32 v79, v31
    s_mov_b32 s6, 196608
    buffer_store_dwordx4 v[76:79], v50, s[76:79], s6 offen nt
    v_mov_b32 v80, v32
    v_mov_b32 v81, v36
    v_mov_b32 v82, v40
    v_mov_b32 v83, v44
    s_mov_b32 s6, 8192
    buffer_store_dwordx4 v[80:83], v50, s[76:79], s6 offen nt
    v_mov_b32 v84, v33
    v_mov_b32 v85, v37
    v_mov_b32 v86, v41
    v_mov_b32 v87, v45
    s_mov_b32 s6, 73728
    buffer_store_dwordx4 v[84:87], v50, s[76:79], s6 offen nt
    v_mov_b32 v88, v34
    v_mov_b32 v89, v38
    v_mov_b32 v90, v42
    v_mov_b32 v91, v46
    s_mov_b32 s6, 139264
    buffer_store_dwordx4 v[88:91], v50, s[76:79], s6 offen nt
    v_mov_b32 v92, v35
    v_mov_b32 v93, v39
    v_mov_b32 v94, v43
    v_mov_b32 v95, v47
    s_mov_b32 s6, 204800
    buffer_store_dwordx4 v[92:95], v50, s[76:79], s6 offen nt
K_fin:
K_done:
    s_endpgm
L_g0:
    s_mov_b32 s50, 0
L_g0_s:
    ds_read_b32 v1, v6 offset:64
    s_add_u32 s50, s50, 1
    s_waitcnt lgkmcnt(0)
    v_readfirstlane_b32 s7, v1
    s_cmp_gt_u32 s50, 4096
    s_cbranch_scc1 L_g0_r
    s_cmp_lt_u32 s7, 2
    s_cbranch_scc1 L_g0_s
    s_branch L_g0_r
L_cs1:
    s_add_u32 s44, s38, 512
    s_and_b32 s44, s44, 1023
    s_or_b32 s44, s44, s20
    s_add_u32 m0, s39, 65536
    s_nop 0
    buffer_load_dwordx4 v246, s[24:27], s44 offen offset:0 lds
    buffer_load_dwordx4 v247, s[24:27], s44 offen offset:1024 lds
    s_add_u32 m0, s39, 73728
    s_nop 0
    buffer_load_dwordx4 v248, s[28:31], s44 offen offset:0 lds
    buffer_load_dwordx4 v249, s[28:31], s44 offen offset:1024 lds
    s_add_u32 s44, s38, 640
    s_and_b32 s44, s44, 1023
    s_or_b32 s44, s44, s20
    s_add_u32 m0, s39, 81920
    s_nop 0
    buffer_load_dwordx4 v246, s[24:27], s44 offen offset:0 lds
    buffer_load_dwordx4 v247, s[24:27], s44 offen offset:1024 lds
    s_add_u32 m0, s39, 90112
    s_nop 0
    buffer_load_dwordx4 v248, s[28:31], s44 offen offset:0 lds
    buffer_load_dwordx4 v249, s[28:31], s44 offen offset:1024 lds
    s_branch L_cr1
L_cs4:
    v_mov_b32 v3, 6
    s_waitcnt vmcnt(0)
    ds_write_b32 v6, v3 offset:48
    s_branch L_cr0
L_g1:
    s_mov_b32 s50, 0
L_g1_s:
    ds_read_b32 v1, v6 offset:64
    s_add_u32 s50, s50, 1
    s_waitcnt lgkmcnt(0)
    v_readfirstlane_b32 s7, v1
    s_cmp_gt_u32 s50, 4096
    s_cbranch_scc1 L_g1_r
    s_cmp_lt_u32 s7, 2
    s_cbranch_scc1 L_g1_s
    s_branch L_g1_r
L_g2:
    s_mov_b32 s50, 0
L_g2_s:
    ds_read_b32 v1, v6 offset:64
    s_add_u32 s50, s50, 1
    s_waitcnt lgkmcnt(0)
    v_readfirstlane_b32 s7, v1
    s_cmp_gt_u32 s50, 4096
    s_cbranch_scc1 L_g2_r
    s_cmp_lt_u32 s7, 2
    s_cbranch_scc1 L_g2_s
    s_branch L_g2_r
L_g3:
    s_mov_b32 s50, 0
L_g3_s:
    ds_read_b32 v1, v6 offset:64
    s_add_u32 s50, s50, 1
    s_waitcnt lgkmcnt(0)
    v_readfirstlane_b32 s7, v1
    s_cmp_gt_u32 s50, 4096
    s_cbranch_scc1 L_g3_r
    s_cmp_lt_u32 s7, 2
    s_cbranch_scc1 L_g3_s
    s_branch L_g3_r
L_g4:
    s_mov_b32 s50, 0
L_g4_s:
    ds_read_b32 v1, v6 offset:64
    s_add_u32 s50, s50, 1
    s_waitcnt lgkmcnt(0)
    v_readfirstlane_b32 s7, v1
    s_cmp_gt_u32 s50, 4096
    s_cbranch_scc1 L_g4_r
    s_cmp_lt_u32 s7, 2
    s_cbranch_scc1 L_g4_s
    s_branch L_g4_r
L_g5:
    s_mov_b32 s50, 0
L_g5_s:
    ds_read_b32 v1, v6 offset:64
    s_add_u32 s50, s50, 1
    s_waitcnt lgkmcnt(0)
    v_readfirstlane_b32 s7, v1
    s_cmp_gt_u32 s50, 4096
    s_cbranch_scc1 L_g5_r
    s_cmp_lt_u32 s7, 2
    s_cbranch_scc1 L_g5_s
    s_branch L_g5_r
L_g6:
    s_mov_b32 s50, 0
L_g6_s:
    ds_read_b32 v1, v6 offset:64
    s_add_u32 s50, s50, 1
    s_waitcnt lgkmcnt(0)
    v_readfirstlane_b32 s7, v1
    s_cmp_gt_u32 s50, 4096
    s_cbranch_scc1 L_g6_r
    s_cmp_lt_u32 s7, 2
    s_cbranch_scc1 L_g6_s
    s_branch L_g6_r
C_x0:
    v_add_u32 v240, 98304, v240
    v_add_u32 v241, 98304, v241
    ds_read_b128 v[208:211], v240 offset:0
    ds_read_b128 v[212:215], v241 offset:0
    ds_read_b128 v[216:219], v240 offset:2048
    ds_read_b128 v[220:223], v241 offset:2048
    s_branch C_x0_r
C_x1:
    v_add_u32 v240, 0, v240
    v_add_u32 v241, 0, v241
    ds_read_b128 v[208:211], v240 offset:0
    ds_read_b128 v[212:215], v241 offset:0
    ds_read_b128 v[216:219], v240 offset:2048
    ds_read_b128 v[220:223], v241 offset:2048
    s_branch C_x1_r
C_x2:
    v_add_u32 v240, 32768, v240
    v_add_u32 v241, 32768, v241
    ds_read_b128 v[208:211], v240 offset:0
    ds_read_b128 v[212:215], v241 offset:0
    ds_read_b128 v[216:219], v240 offset:2048
    ds_read_b128 v[220:223], v241 offset:2048
    s_branch C_x2_r
C_x3:
    v_add_u32 v240, 65536, v240
    v_add_u32 v241, 65536, v241
    ds_read_b128 v[208:211], v240 offset:0
    ds_read_b128 v[212:215], v241 offset:0
    ds_read_b128 v[216:219], v240 offset:2048
    ds_read_b128 v[220:223], v241 offset:2048
    s_branch C_x3_r
C_x4:
    v_add_u32 v240, 98304, v240
    v_add_u32 v241, 98304, v241
    ds_read_b128 v[208:211], v240 offset:0
    ds_read_b128 v[212:215], v241 offset:0
    ds_read_b128 v[216:219], v240 offset:2048
    ds_read_b128 v[220:223], v241 offset:2048
    s_branch C_x4_r
C_non:
    s_mov_b32 s39, 0
C_non_s:
    buffer_load_dwordx2 v[54:55], off, s[16:19], 0 sc1
    s_add_u32 s39, s39, 1
    s_waitcnt vmcnt(0)
    s_cmp_gt_u32 s39, 4096
    s_cbranch_scc1 C_non_r
    v_readfirstlane_b32 s7, v54
    s_cmp_lg_u32 s7, 0
    s_cbranch_scc0 C_non_s
    s_branch C_non_r
C_x5:
    v_add_u32 v240, 0, v240
    v_add_u32 v241, 0, v241
    ds_read_b128 v[208:211], v240 offset:0
    ds_read_b128 v[212:215], v241 offset:0
    ds_read_b128 v[216:219], v240 offset:2048
    ds_read_b128 v[220:223], v241 offset:2048
    s_branch C_x5_r
C_x6:
    v_add_u32 v240, 32768, v240
    v_add_u32 v241, 32768, v241
    ds_read_b128 v[208:211], v240 offset:0
    ds_read_b128 v[212:215], v241 offset:0
    ds_read_b128 v[216:219], v240 offset:2048
    ds_read_b128 v[220:223], v241 offset:2048
    s_branch C_x6_r
C_x7:
    v_add_u32 v240, 65536, v240
    v_add_u32 v241, 65536, v241
    ds_read_b128 v[208:211], v240 offset:0
    ds_read_b128 v[212:215], v241 offset:0
    ds_read_b128 v[216:219], v240 offset:2048
    ds_read_b128 v[220:223], v241 offset:2048
    s_branch C_x7_r
C_x8:
    v_add_u32 v240, 98304, v240
    v_add_u32 v241, 98304, v241
    ds_read_b128 v[208:211], v240 offset:0
    ds_read_b128 v[212:215], v241 offset:0
    ds_read_b128 v[216:219], v240 offset:2048
    ds_read_b128 v[220:223], v241 offset:2048
    s_branch C_x8_r
C_x9:
    v_add_u32 v240, 0, v240
    v_add_u32 v241, 0, v241
    ds_read_b128 v[208:211], v240 offset:0
    ds_read_b128 v[212:215], v241 offset:0
    ds_read_b128 v[216:219], v240 offset:2048
    ds_read_b128 v[220:223], v241 offset:2048
    s_branch C_x9_r
C_x10:
    v_add_u32 v240, 32768, v240
    v_add_u32 v241, 32768, v241
    ds_read_b128 v[208:211], v240 offset:0
    ds_read_b128 v[212:215], v241 offset:0
    ds_read_b128 v[216:219], v240 offset:2048
    ds_read_b128 v[220:223], v241 offset:2048
    s_branch C_x10_r
C_x11:
    v_add_u32 v240, 65536, v240
    v_add_u32 v241, 65536, v241
    ds_read_b128 v[208:211], v240 offset:0
    ds_read_b128 v[212:215], v241 offset:0
    ds_read_b128 v[216:219], v240 offset:2048
    ds_read_b128 v[220:223], v241 offset:2048
    s_branch C_x11_r
C_x12:
    v_add_u32 v240, 98304, v240
    v_add_u32 v241, 98304, v241
    ds_read_b128 v[208:211], v240 offset:0
    ds_read_b128 v[212:215], v241 offset:0
    ds_read_b128 v[216:219], v240 offset:2048
    ds_read_b128 v[220:223], v241 offset:2048
    s_branch C_x12_r
C_x13:
    v_add_u32 v240, 0, v240
    v_add_u32 v241, 0, v241
    ds_read_b128 v[208:211], v240 offset:0
    ds_read_b128 v[212:215], v241 offset:0
    ds_read_b128 v[216:219], v240 offset:2048
    ds_read_b128 v[220:223], v241 offset:2048
    s_branch C_x13_r
C_kvp:
    s_mov_b32 s39, 0
C_kvp_s:
    buffer_load_dwordx2 v[244:245], v246, s[72:75], s21 offen sc1
    s_add_u32 s39, s39, 1
    s_waitcnt vmcnt(0)
    s_cmp_gt_u32 s39, 4096
    s_cbranch_scc1 C_kvp_r
    v_cmp_eq_u32 vcc, v244, v54
    v_cmp_eq_u32 s[54:55], v245, v55
    s_mov_b32 m0, s23
    s_and_b64 s[54:55], s[54:55], vcc
    s_cmp_eq_u64 s[54:55], -1
    s_cbranch_scc0 C_kvp_s
    s_branch C_kvp_r
C_x14:
    v_add_u32 v240, 32768, v240
    v_add_u32 v241, 32768, v241
    ds_read_b128 v[208:211], v240 offset:0
    ds_read_b128 v[212:215], v241 offset:0
    ds_read_b128 v[216:219], v240 offset:2048
    ds_read_b128 v[220:223], v241 offset:2048
    s_branch C_x14_r
C_x15:
    v_add_u32 v240, 65536, v240
    v_add_u32 v241, 65536, v241
    ds_read_b128 v[208:211], v240 offset:0
    ds_read_b128 v[212:215], v241 offset:0
    ds_read_b128 v[216:219], v240 offset:2048
    ds_read_b128 v[220:223], v241 offset:2048
    s_branch C_x15_r
C2_h1:
    s_mov_b32 s39, 0
C2_h1_s:
    buffer_load_dwordx2 v[248:249], v51, s[72:75], 0 offen sc1
    s_add_u32 s39, s39, 1
    s_waitcnt vmcnt(0)
    s_cmp_gt_u32 s39, 4096
    s_cbranch_scc1 C2_h1_r
    v_cmp_eq_u32 vcc, v248, v54
    v_cmp_eq_u32 s[54:55], v249, v55
    s_nop 0
    s_and_b64 s[54:55], s[54:55], vcc
    s_or_b32 s54, s54, 15
    s_ff0_i32_b64 s7, s[54:55]
    s_lshr_b32 s7, s7, 2
    s_max_u32 s37, s37, s7
    s_cmp_gt_u32 s37, 1
    s_cbranch_scc0 C2_h1_s
    s_branch C2_h1_r
C_crdy:
    s_mov_b32 s39, 0
C_crdy_s:
    ds_read_b128 v[12:15], v62 offset:48
    s_add_u32 s39, s39, 1
    s_waitcnt lgkmcnt(0)
    v_min3_u32 v12, v12, v13, v14
    v_min_u32 v12, v12, v15
    v_cmp_gt_u32 vcc, 6, v12
    s_cmp_gt_u32 s39, 65536
    s_cbranch_scc1 C_crdy_r
    s_cbranch_vccnz C_crdy_s
    s_branch C_crdy_r
C2_h2:
    s_mov_b32 s39, 0
C2_h2_s:
    buffer_load_dwordx2 v[248:249], v51, s[72:75], 0 offen sc1
    s_add_u32 s39, s39, 1
    s_waitcnt vmcnt(0)
    s_cmp_gt_u32 s39, 4096
    s_cbranch_scc1 C2_h2_r
    v_cmp_eq_u32 vcc, v248, v54
    v_cmp_eq_u32 s[54:55], v249, v55
    s_nop 0
    s_and_b64 s[54:55], s[54:55], vcc
    s_or_b32 s54, s54, 15
    s_ff0_i32_b64 s7, s[54:55]
    s_lshr_b32 s7, s7, 2
    s_max_u32 s37, s37, s7
    s_cmp_gt_u32 s37, 2
    s_cbranch_scc0 C2_h2_s
    s_branch C2_h2_r
C2_h3:
    s_mov_b32 s39, 0
C2_h3_s:
    buffer_load_dwordx2 v[248:249], v51, s[72:75], 0 offen sc1
    s_add_u32 s39, s39, 1
    s_waitcnt vmcnt(0)
    s_cmp_gt_u32 s39, 4096
    s_cbranch_scc1 C2_h3_r
    v_cmp_eq_u32 vcc, v248, v54
    v_cmp_eq_u32 s[54:55], v249, v55
    s_nop 0
    s_and_b64 s[54:55], s[54:55], vcc
    s_or_b32 s54, s54, 15
    s_ff0_i32_b64 s7, s[54:55]
    s_lshr_b32 s7, s7, 2
    s_max_u32 s37, s37, s7
    s_cmp_gt_u32 s37, 3
    s_cbranch_scc0 C2_h3_s
    s_branch C2_h3_r
C2_p2:
    s_mov_b32 s39, 0
C2_p2_s:
    ds_read_b128 v[56:59], v62 offset:96
    s_add_u32 s39, s39, 1
    s_waitcnt lgkmcnt(0)
    v_min3_u32 v56, v56, v57, v58
    v_min_u32 v56, v56, v59
    v_cmp_gt_u32 vcc, 1, v56
    s_cmp_gt_u32 s39, 65536
    s_cbranch_scc1 C2_p2_r
    s_cbranch_vccnz C2_p2_s
    s_branch C2_p2_r
C2_h4:
    s_mov_b32 s39, 0
C2_h4_s:
    buffer_load_dwordx2 v[248:249], v51, s[72:75], 0 offen sc1
    s_add_u32 s39, s39, 1
    s_waitcnt vmcnt(0)
    s_cmp_gt_u32 s39, 4096
    s_cbranch_scc1 C2_h4_r
    v_cmp_eq_u32 vcc, v248, v54
    v_cmp_eq_u32 s[54:55], v249, v55
    s_nop 0
    s_and_b64 s[54:55], s[54:55], vcc
    s_or_b32 s54, s54, 15
    s_ff0_i32_b64 s7, s[54:55]
    s_lshr_b32 s7, s7, 2
    s_max_u32 s37, s37, s7
    s_cmp_gt_u32 s37, 4
    s_cbranch_scc0 C2_h4_s
    s_branch C2_h4_r
C2_p3:
    s_mov_b32 s39, 0
C2_p3_s:
    ds_read_b128 v[56:59], v62 offset:96
    s_add_u32 s39, s39, 1
    s_waitcnt lgkmcnt(0)
    v_min3_u32 v56, v56, v57, v58
    v_min_u32 v56, v56, v59
    v_cmp_gt_u32 vcc, 2, v56
    s_cmp_gt_u32 s39, 65536
    s_cbranch_scc1 C2_p3_r
    s_cbranch_vccnz C2_p3_s
    s_branch C2_p3_r
C2_h5:
    s_mov_b32 s39, 0
C2_h5_s:
    buffer_load_dwordx2 v[248:249], v51, s[72:75], 0 offen sc1
    s_add_u32 s39, s39, 1
    s_waitcnt vmcnt(0)
    s_cmp_gt_u32 s39, 4096
    s_cbranch_scc1 C2_h5_r
    v_cmp_eq_u32 vcc, v248, v54
    v_cmp_eq_u32 s[54:55], v249, v55
    s_nop 0
    s_and_b64 s[54:55], s[54:55], vcc
    s_or_b32 s54, s54, 15
    s_ff0_i32_b64 s7, s[54:55]
    s_lshr_b32 s7, s7, 2
    s_max_u32 s37, s37, s7
    s_cmp_gt_u32 s37, 5
    s_cbranch_scc0 C2_h5_s
    s_branch C2_h5_r
C2_p4:
    s_mov_b32 s39, 0
C2_p4_s:
    ds_read_b128 v[56:59], v62 offset:96
    s_add_u32 s39, s39, 1
    s_waitcnt lgkmcnt(0)
    v_min3_u32 v56, v56, v57, v58
    v_min_u32 v56, v56, v59
    v_cmp_gt_u32 vcc, 3, v56
    s_cmp_gt_u32 s39, 65536
    s_cbranch_scc1 C2_p4_r
    s_cbranch_vccnz C2_p4_s
    s_branch C2_p4_r
C2_h6:
    s_mov_b32 s39, 0
C2_h6_s:
    buffer_load_dwordx2 v[248:249], v51, s[72:75], 0 offen sc1
    s_add_u32 s39, s39, 1
    s_waitcnt vmcnt(0)
    s_cmp_gt_u32 s39, 4096
    s_cbranch_scc1 C2_h6_r
    v_cmp_eq_u32 vcc, v248, v54
    v_cmp_eq_u32 s[54:55], v249, v55
    s_nop 0
    s_and_b64 s[54:55], s[54:55], vcc
    s_or_b32 s54, s54, 15
    s_ff0_i32_b64 s7, s[54:55]
    s_lshr_b32 s7, s7, 2
    s_max_u32 s37, s37, s7
    s_cmp_gt_u32 s37, 6
    s_cbranch_scc0 C2_h6_s
    s_branch C2_h6_r
C2_p5:
    s_mov_b32 s39, 0
C2_p5_s:
    ds_read_b128 v[56:59], v62 offset:96
    s_add_u32 s39, s39, 1
    s_waitcnt lgkmcnt(0)
    v_min3_u32 v56, v56, v57, v58
    v_min_u32 v56, v56, v59
    v_cmp_gt_u32 vcc, 4, v56
    s_cmp_gt_u32 s39, 65536
    s_cbranch_scc1 C2_p5_r
    s_cbranch_vccnz C2_p5_s
    s_branch C2_p5_r
C2_h7:
    s_mov_b32 s39, 0
C2_h7_s:
    buffer_load_dwordx2 v[248:249], v51, s[72:75], 0 offen sc1
    s_add_u32 s39, s39, 1
    s_waitcnt vmcnt(0)
    s_cmp_gt_u32 s39, 4096
    s_cbranch_scc1 C2_h7_r
    v_cmp_eq_u32 vcc, v248, v54
    v_cmp_eq_u32 s[54:55], v249, v55
    s_nop 0
    s_and_b64 s[54:55], s[54:55], vcc
    s_or_b32 s54, s54, 15
    s_ff0_i32_b64 s7, s[54:55]
    s_lshr_b32 s7, s7, 2
    s_max_u32 s37, s37, s7
    s_cmp_gt_u32 s37, 7
    s_cbranch_scc0 C2_h7_s
    s_branch C2_h7_r
C2_p6:
    s_mov_b32 s39, 0
C2_p6_s:
    ds_read_b128 v[56:59], v62 offset:96
    s_add_u32 s39, s39, 1
    s_waitcnt lgkmcnt(0)
    v_min3_u32 v56, v56, v57, v58
    v_min_u32 v56, v56, v59
    v_cmp_gt_u32 vcc, 5, v56
    s_cmp_gt_u32 s39, 65536
    s_cbranch_scc1 C2_p6_r
    s_cbranch_vccnz C2_p6_s
    s_branch C2_p6_r
C2_h8:
    s_mov_b32 s39, 0
C2_h8_s:
    buffer_load_dwordx2 v[248:249], v51, s[72:75], 0 offen sc1
    s_add_u32 s39, s39, 1
    s_waitcnt vmcnt(0)
    s_cmp_gt_u32 s39, 4096
    s_cbranch_scc1 C2_h8_r
    v_cmp_eq_u32 vcc, v248, v54
    v_cmp_eq_u32 s[54:55], v249, v55
    s_nop 0
    s_and_b64 s[54:55], s[54:55], vcc
    s_or_b32 s54, s54, 15
    s_ff0_i32_b64 s7, s[54:55]
    s_lshr_b32 s7, s7, 2
    s_max_u32 s37, s37, s7
    s_cmp_gt_u32 s37, 8
    s_cbranch_scc0 C2_h8_s
    s_branch C2_h8_r
C2_p7:
    s_mov_b32 s39, 0
C2_p7_s:
    ds_read_b128 v[56:59], v62 offset:96
    s_add_u32 s39, s39, 1
    s_waitcnt lgkmcnt(0)
    v_min3_u32 v56, v56, v57, v58
    v_min_u32 v56, v56, v59
    v_cmp_gt_u32 vcc, 6, v56
    s_cmp_gt_u32 s39, 65536
    s_cbranch_scc1 C2_p7_r
    s_cbranch_vccnz C2_p7_s
    s_branch C2_p7_r
C2_h9:
    s_mov_b32 s39, 0
C2_h9_s:
    buffer_load_dwordx2 v[248:249], v51, s[72:75], 0 offen sc1
    s_add_u32 s39, s39, 1
    s_waitcnt vmcnt(0)
    s_cmp_gt_u32 s39, 4096
    s_cbranch_scc1 C2_h9_r
    v_cmp_eq_u32 vcc, v248, v54
    v_cmp_eq_u32 s[54:55], v249, v55
    s_nop 0
    s_and_b64 s[54:55], s[54:55], vcc
    s_or_b32 s54, s54, 15
    s_ff0_i32_b64 s7, s[54:55]
    s_lshr_b32 s7, s7, 2
    s_max_u32 s37, s37, s7
    s_cmp_gt_u32 s37, 9
    s_cbranch_scc0 C2_h9_s
    s_branch C2_h9_r
C2_p8:
    s_mov_b32 s39, 0
C2_p8_s:
    ds_read_b128 v[56:59], v62 offset:96
    s_add_u32 s39, s39, 1
    s_waitcnt lgkmcnt(0)
    v_min3_u32 v56, v56, v57, v58
    v_min_u32 v56, v56, v59
    v_cmp_gt_u32 vcc, 7, v56
    s_cmp_gt_u32 s39, 65536
    s_cbranch_scc1 C2_p8_r
    s_cbranch_vccnz C2_p8_s
    s_branch C2_p8_r
C2_h10:
    s_mov_b32 s39, 0
C2_h10_s:
    buffer_load_dwordx2 v[248:249], v51, s[72:75], 0 offen sc1
    s_add_u32 s39, s39, 1
    s_waitcnt vmcnt(0)
    s_cmp_gt_u32 s39, 4096
    s_cbranch_scc1 C2_h10_r
    v_cmp_eq_u32 vcc, v248, v54
    v_cmp_eq_u32 s[54:55], v249, v55
    s_nop 0
    s_and_b64 s[54:55], s[54:55], vcc
    s_or_b32 s54, s54, 15
    s_ff0_i32_b64 s7, s[54:55]
    s_lshr_b32 s7, s7, 2
    s_max_u32 s37, s37, s7
    s_cmp_gt_u32 s37, 10
    s_cbranch_scc0 C2_h10_s
    s_branch C2_h10_r
C2_h11:
    s_mov_b32 s39, 0
C2_h11_s:
    buffer_load_dwordx2 v[248:249], v51, s[72:75], 0 offen sc1
    s_add_u32 s39, s39, 1
    s_waitcnt vmcnt(0)
    s_cmp_gt_u32 s39, 4096
    s_cbranch_scc1 C2_h11_r
    v_cmp_eq_u32 vcc, v248, v54
    v_cmp_eq_u32 s[54:55], v249, v55
    s_nop 0
    s_and_b64 s[54:55], s[54:55], vcc
    s_or_b32 s54, s54, 15
    s_ff0_i32_b64 s7, s[54:55]
    s_lshr_b32 s7, s7, 2
    s_max_u32 s37, s37, s7
    s_cmp_gt_u32 s37, 11
    s_cbranch_scc0 C2_h11_s
    s_branch C2_h11_r
C2_q10:
    s_mov_b32 s39, 0
C2_q10_s:
    ds_read_b128 v[12:15], v62 offset:48
    s_add_u32 s39, s39, 1
    s_waitcnt lgkmcnt(0)
    v_min3_u32 v12, v12, v13, v14
    v_min_u32 v12, v12, v15
    v_cmp_gt_u32 vcc, 12, v12
    s_cmp_gt_u32 s39, 65536
    s_cbranch_scc1 C2_q10_r
    s_cbranch_vccnz C2_q10_s
    s_branch C2_q10_r
C2_h12:
    s_mov_b32 s39, 0
C2_h12_s:
    buffer_load_dwordx2 v[248:249], v51, s[72:75], 0 offen sc1
    s_add_u32 s39, s39, 1
    s_waitcnt vmcnt(0)
    s_cmp_gt_u32 s39, 4096
    s_cbranch_scc1 C2_h12_r
    v_cmp_eq_u32 vcc, v248, v54
    v_cmp_eq_u32 s[54:55], v249, v55
    s_nop 0
    s_and_b64 s[54:55], s[54:55], vcc
    s_or_b32 s54, s54, 15
    s_ff0_i32_b64 s7, s[54:55]
    s_lshr_b32 s7, s7, 2
    s_max_u32 s37, s37, s7
    s_cmp_gt_u32 s37, 12
    s_cbranch_scc0 C2_h12_s
    s_branch C2_h12_r
C2_q11:
    s_mov_b32 s39, 0
C2_q11_s:
    ds_read_b128 v[12:15], v62 offset:48
    s_add_u32 s39, s39, 1
    s_waitcnt lgkmcnt(0)
    v_min3_u32 v12, v12, v13, v14
    v_min_u32 v12, v12, v15
    v_cmp_gt_u32 vcc, 13, v12
    s_cmp_gt_u32 s39, 65536
    s_cbranch_scc1 C2_q11_r
    s_cbranch_vccnz C2_q11_s
    s_branch C2_q11_r
C2_h13:
    s_mov_b32 s39, 0
C2_h13_s:
    buffer_load_dwordx2 v[248:249], v51, s[72:75], 0 offen sc1
    s_add_u32 s39, s39, 1
    s_waitcnt vmcnt(0)
    s_cmp_gt_u32 s39, 4096
    s_cbranch_scc1 C2_h13_r
    v_cmp_eq_u32 vcc, v248, v54
    v_cmp_eq_u32 s[54:55], v249, v55
    s_nop 0
    s_and_b64 s[54:55], s[54:55], vcc
    s_or_b32 s54, s54, 15
    s_ff0_i32_b64 s7, s[54:55]
    s_lshr_b32 s7, s7, 2
    s_max_u32 s37, s37, s7
    s_cmp_gt_u32 s37, 13
    s_cbranch_scc0 C2_h13_s
    s_branch C2_h13_r
C2_q12:
    s_mov_b32 s39, 0
C2_q12_s:
    ds_read_b128 v[12:15], v62 offset:48
    s_add_u32 s39, s39, 1
    s_waitcnt lgkmcnt(0)
    v_min3_u32 v12, v12, v13, v14
    v_min_u32 v12, v12, v15
    v_cmp_gt_u32 vcc, 14, v12
    s_cmp_gt_u32 s39, 65536
    s_cbranch_scc1 C2_q12_r
    s_cbranch_vccnz C2_q12_s
    s_branch C2_q12_r
C2_h14:
    s_mov_b32 s39, 0
C2_h14_s:
    buffer_load_dwordx2 v[248:249], v51, s[72:75], 0 offen sc1
    s_add_u32 s39, s39, 1
    s_waitcnt vmcnt(0)
    s_cmp_gt_u32 s39, 4096
    s_cbranch_scc1 C2_h14_r
    v_cmp_eq_u32 vcc, v248, v54
    v_cmp_eq_u32 s[54:55], v249, v55
    s_nop 0
    s_and_b64 s[54:55], s[54:55], vcc
    s_or_b32 s54, s54, 15
    s_ff0_i32_b64 s7, s[54:55]
    s_lshr_b32 s7, s7, 2
    s_max_u32 s37, s37, s7
    s_cmp_gt_u32 s37, 14
    s_cbranch_scc0 C2_h14_s
    s_branch C2_h14_r
C2_q13:
    s_mov_b32 s39, 0
C2_q13_s:
    ds_read_b128 v[12:15], v62 offset:48
    s_add_u32 s39, s39, 1
    s_waitcnt lgkmcnt(0)
    v_min3_u32 v12, v12, v13, v14
    v_min_u32 v12, v12, v15
    v_cmp_gt_u32 vcc, 15, v12
    s_cmp_gt_u32 s39, 65536
    s_cbranch_scc1 C2_q13_r
    s_cbranch_vccnz C2_q13_s
    s_branch C2_q13_r
C2_h15:
    s_mov_b32 s39, 0
C2_h15_s:
    buffer_load_dwordx2 v[248:249], v51, s[72:75], 0 offen sc1
    s_add_u32 s39, s39, 1
    s_waitcnt vmcnt(0)
    s_cmp_gt_u32 s39, 4096
    s_cbranch_scc1 C2_h15_r
    v_cmp_eq_u32 vcc, v248, v54
    v_cmp_eq_u32 s[54:55], v249, v55
    s_nop 0
    s_and_b64 s[54:55], s[54:55], vcc
    s_or_b32 s54, s54, 15
    s_ff0_i32_b64 s7, s[54:55]
    s_lshr_b32 s7, s7, 2
    s_max_u32 s37, s37, s7
    s_cmp_gt_u32 s37, 15
    s_cbranch_scc0 C2_h15_s
    s_branch C2_h15_r
C2_q14:
    s_mov_b32 s39, 0
C2_q14_s:
    ds_read_b128 v[12:15], v62 offset:48
    s_add_u32 s39, s39, 1
    s_waitcnt lgkmcnt(0)
    v_min3_u32 v12, v12, v13, v14
    v_min_u32 v12, v12, v15
    v_cmp_gt_u32 vcc, 16, v12
    s_cmp_gt_u32 s39, 65536
    s_cbranch_scc1 C2_q14_r
    s_cbranch_vccnz C2_q14_s
    s_branch C2_q14_r
.section .rodata,"a"
.p2align 6
.amdhsa_kernel concat_heads__ssm_conv_h3__ssm_conv_s5__prompt_kernel
  .amdhsa_next_free_vgpr 252
  .amdhsa_next_free_sgpr 102
  .amdhsa_accum_offset 252
  .amdhsa_group_segment_fixed_size 0
  .amdhsa_kernarg_size 144
  .amdhsa_user_sgpr_count 2
  .amdhsa_user_sgpr_kernarg_segment_ptr 1
  .amdhsa_system_sgpr_workgroup_id_x 1
.end_amdhsa_kernel
```

```asm
; @launch grid=(256,1,1) block=(512,1,1) lds=163840
.amdgcn_target "amdgcn-amd-amdhsa--gfx950"
.text
.p2align 8
.globl concat_heads__ssm_conv_h3__ssm_conv_s5__prompt_kernel
.type concat_heads__ssm_conv_h3__ssm_conv_s5__prompt_kernel,@function
concat_heads__ssm_conv_h3__ssm_conv_s5__prompt_kernel:
    s_cmp_ge_u32 s2, 256
    s_cbranch_scc1 K_done
    s_load_dwordx16 s[32:47], s[0:1], 0
    s_load_dwordx16 s[48:63], s[0:1], 64
    s_load_dwordx4 s[64:67], s[0:1], 128
    v_lshrrev_b32 v1, 6, v0
    v_and_b32 v2, 63, v0
    s_and_b32 s6, s2, 3
    v_readfirstlane_b32 s5, v1
    s_lshl_b32 s6, s6, 2
    s_lshr_b32 s7, s2, 3
    s_and_b32 s3, s7, 3
    s_add_u32 s3, s3, s6
    s_and_b32 s6, s2, 4
    s_lshl_b32 s6, s6, 1
    s_lshr_b32 s4, s7, 2
    s_add_u32 s4, s4, s6
    s_cmp_lt_u32 s5, 4
    s_cbranch_scc1 K_compute
    s_sub_u32 s6, s5, 4
    v_lshrrev_b32 v12, 3, v2
    v_and_b32 v13, 7, v2
    v_lshrrev_b32 v14, 4, v2
    v_xor_b32 v13, v13, v14
    v_lshlrev_b32 v13, 4, v13
    v_lshrrev_b32 v14, 5, v2
    v_and_b32 v15, 3, v12
    v_lshl_add_u32 v15, v14, 3, v15
    v_lshl_add_u32 v14, v12, 14, v13
    v_lshl_add_u32 v15, v15, 11, v13
    s_lshl_b32 s7, s3, 6
    s_add_u32 s7, s7, s6
    s_lshl_b32 s7, s7, 12
    v_add_u32 v4, s7, v14
    v_xor_b32 v5, 64, v4
    v_add_u32 v5, 0x1fc00, v5
    s_lshl_b32 s7, s4, 2
    s_add_u32 s7, s7, s6
    s_lshl_b32 s7, s7, 15
    v_add_u32 v8, s7, v15
    v_xor_b32 v9, 64, v8
    v_add_u32 v9, 0x1c00, v9
    s_and_b32 s30, s2, 3
    s_lshl_b32 s30, s30, 2
    s_and_b32 s31, s2, 4
    s_lshl_b32 s31, s31, 1
    s_add_u32 s30, s30, s31
    s_add_u32 s31, s3, s4
    s_and_b32 s31, s31, 1
    s_lshl_b32 s31, s31, 1
    s_add_u32 s30, s30, s31
    s_and_b32 s30, s30, 15
    s_lshl_b32 s100, s30, 7
    s_lshl_b32 s101, s6, 12
    s_waitcnt lgkmcnt(0)
    s_mov_b32 s8, s44
    s_mov_b32 s9, s45
    s_mov_b32 s10, 4194304
    s_mov_b32 s11, 0x00020000
    s_mov_b32 s12, s50
    s_mov_b32 s13, s51
    s_mov_b32 s14, 2097152
    s_mov_b32 s15, 0x00020000
    s_mov_b32 s16, s52
    s_mov_b32 s17, s53
    s_mov_b32 s18, 2097152
    s_mov_b32 s19, 0x00020000
    s_mov_b32 s58, s32
    s_mov_b32 s59, s33
    s_lshr_b32 s7, s2, 3
    s_and_b32 s32, s7, 15
    s_lshr_b32 s7, s7, 4
    s_and_b32 s33, s2, 7
    s_lshl_b32 s33, s33, 1
    s_add_u32 s33, s33, s7
    s_lshl_b32 s34, s33, 4
    s_add_u32 s34, s34, s32
    s_lshl_b32 s34, s34, 2
    s_add_u32 s34, s34, s6
    s_lshl_b32 s35, s34, 12
    s_lshr_b32 s7, s34, 1
    s_lshl_b32 s7, s7, 2
    s_load_dword s37, s[42:43], s7
    v_and_b32 v12, 15, v2
    v_lshrrev_b32 v13, 4, v2
    s_mov_b32 s68, s40
    s_mov_b32 s69, s41
    s_mov_b32 s70, 4194304
    s_mov_b32 s71, 0x00020000
    s_add_u32 s76, s66, 17825792
    s_addc_u32 s77, s67, 0
    s_mov_b32 s78, 393216
    s_mov_b32 s79, 0x00020000
    s_mov_b32 s24, s54
    s_mov_b32 s25, s55
    s_mov_b32 s26, 2097152
    s_mov_b32 s27, 0x00020000
    s_mov_b32 s28, s56
    s_mov_b32 s29, s57
    s_mov_b32 s30, 2097152
    s_mov_b32 s31, 0x00020000
    s_mov_b32 s40, s58
    s_mov_b32 s41, s59
    s_mov_b32 s42, 4194304
    s_mov_b32 s43, 0x00020000
    s_cmp_lt_u32 s6, 2
    s_cselect_b32 s52, s54, s56
    s_cselect_b32 s53, s55, s57
    s_mov_b32 s54, 2097152
    s_mov_b32 s55, 0x00020000
    s_waitcnt lgkmcnt(0)
    s_lshl_b32 s45, s6, 14
    v_lshlrev_b32 v16, 4, v13
    v_lshl_add_u32 v16, v12, 1, v16
    v_and_b32 v1, 1, v12
    v_mov_b32 v3, 98308
    v_mov_b32 v14, 102466
    v_cmp_eq_u32 vcc, 1, v1
    s_and_b32 s7, s34, 1
    s_lshl_b32 s7, s7, 4
    v_cndmask_b32 v3, v3, v14, vcc
    v_add3_u32 v16, v16, v3, s45
    v_add_u32 v17, 1024, v16
    v_add_u32 v18, 2048, v16
    v_add_u32 v19, 3072, v16
    s_add_u32 s47, s45, 107104
    v_lshlrev_b32 v1, 4, v13
    v_lshlrev_b32 v3, 5, v12
    v_sub_u32 v1, v1, v3
    v_add_u32 v20, s47, v1
    s_lshr_b32 s37, s37, s7
    s_and_b32 s37, s37, 0xffff
    v_lshlrev_b32 v1, 3, v13
    v_add_u32 v1, v1, v12
    v_sub_u32 v1, 15, v1
    v_and_b32 v3, 1, v1
    v_lshlrev_b32 v3, 4, v3
    v_lshlrev_b32 v3, v3, s37
    v_lshrrev_b32 v1, 1, v1
    v_cmp_eq_u32 vcc, 0, v1
    s_nop 1
    v_cndmask_b32 v24, 0, v3, vcc
    v_cmp_eq_u32 vcc, 1, v1
    s_nop 1
    v_cndmask_b32 v25, 0, v3, vcc
    v_cmp_eq_u32 vcc, 2, v1
    s_nop 1
    v_cndmask_b32 v26, 0, v3, vcc
    v_cmp_eq_u32 vcc, 3, v1
    s_nop 1
    v_cndmask_b32 v27, 0, v3, vcc
    s_add_u32 s7, s45, 106496
    v_lshlrev_b32 v1, 3, v2
    v_add_u32 v21, s7, v1
    v_lshlrev_b32 v10, 4, v2
    v_mov_b32 v7, 147328
    s_lshl_b32 s7, s6, 2
    v_add_u32 v6, s7, v7
    v_mov_b32 v1, 0
    ds_write_b32 v6, v1 offset:48
    ds_write_b32 v6, v1 offset:96
    v_mov_b32 v1, 2
    ds_write_b32 v6, v1 offset:64
    v_lshrrev_b32 v1, 3, v2
    v_and_b32 v3, 7, v2
    v_xor_b32 v3, v3, v13
    v_lshlrev_b32 v3, 4, v3
    v_lshl_add_u32 v3, v1, 13, v3
    s_lshl_b32 s7, s4, 6
    s_add_u32 s7, s7, s6
    s_lshl_b32 s7, s7, 11
    v_add_u32 v246, s7, v3
    v_xor_b32 v247, 64, v246
    v_add_u32 v247, 64512, v247
    v_xor_b32 v248, 32, v246
    v_xor_b32 v249, 32, v247
    s_lshl_b32 s38, s4, 7
    v_lshlrev_b32 v3, 11, v13
    v_lshl_add_u32 v3, v12, 3, v3
    s_lshl_b32 s7, s32, 2
    s_add_u32 s7, s7, s6
    s_lshl_b32 s7, s7, 9
    s_add_u32 s7, s7, s33
    s_lshl_b32 s7, s7, 7
    v_add_u32 v31, s7, v3
    s_lshr_b32 s46, s2, 3
    s_and_b32 s46, s46, 7
    s_lshr_b32 s46, s2, 4
    s_and_b32 s46, s46, 7
    s_add_u32 s7, s3, s4
    s_and_b32 s7, s7, 1
    s_cmp_eq_u32 s7, 0
    s_cselect_b32 s46, s46, 99
    s_lshl_b32 s39, s6, 11
    s_and_b32 s7, s3, 0
    s_lshl_b32 s7, s7, 7
    s_add_u32 s38, s38, s7
    s_and_b32 s20, s38, 1024
    s_xor_b32 s21, s20, 1024
    s_and_b32 s7, s3, 3
    s_lshl_b32 s7, s7, 1
    s_and_b32 s47, s6, 1
    s_add_u32 s7, s7, s47
    s_lshl_b32 s7, s7, 7
    s_or_b32 s7, s7, s21
    s_lshl_b32 s47, s4, 17
    s_add_u32 s7, s7, s47
    v_lshlrev_b32 v11, 11, v2
    v_add_u32 v11, s7, v11
    s_and_b32 s7, s3, 14
    s_and_b32 s47, s6, 1
    s_add_u32 s7, s7, s47
    s_add_u32 s7, s7, s4
    s_and_b32 s7, s7, 15
    s_lshl_b32 s7, s7, 7
    s_lshl_b32 s47, s4, 17
    s_add_u32 s7, s7, s47
    v_lshlrev_b32 v30, 11, v2
    v_add_u32 v30, s7, v30
    s_barrier
    s_add_u32 m0, s101, 98304
    s_nop 0
    buffer_load_dwordx4 v4, s[8:11], s100 offen lds
    buffer_load_dwordx4 v5, s[8:11], s100 offen offset:1024 lds
    buffer_load_dwordx4 v4, s[8:11], s100 offen offset:2048 lds
    buffer_load_dwordx4 v5, s[8:11], s100 offen offset:3072 lds
    s_add_u32 m0, s101, 114688
    s_nop 0
    buffer_load_dwordx4 v8, s[12:15], s100 offen lds
    buffer_load_dwordx4 v9, s[12:15], s100 offen offset:1024 lds
    s_add_u32 m0, s101, 116736
    s_nop 0
    buffer_load_dwordx4 v8, s[16:19], s100 offen lds
    buffer_load_dwordx4 v9, s[16:19], s100 offen offset:1024 lds
    s_add_u32 s100, s100, 128
    s_and_b32 s100, s100, 2047
    s_add_u32 m0, s101, 0
    s_nop 0
    buffer_load_dwordx4 v4, s[8:11], s100 offen lds
    buffer_load_dwordx4 v5, s[8:11], s100 offen offset:1024 lds
    buffer_load_dwordx4 v4, s[8:11], s100 offen offset:2048 lds
    buffer_load_dwordx4 v5, s[8:11], s100 offen offset:3072 lds
    s_add_u32 m0, s101, 16384
    s_nop 0
    buffer_load_dwordx4 v8, s[12:15], s100 offen lds
    buffer_load_dwordx4 v9, s[12:15], s100 offen offset:1024 lds
    s_add_u32 m0, s101, 18432
    s_nop 0
    buffer_load_dwordx4 v8, s[16:19], s100 offen lds
    buffer_load_dwordx4 v9, s[16:19], s100 offen offset:1024 lds
    s_add_u32 s100, s100, 128
    s_and_b32 s100, s100, 2047
    s_add_u32 m0, s101, 32768
    s_nop 0
    buffer_load_dwordx4 v4, s[8:11], s100 offen lds
    buffer_load_dwordx4 v5, s[8:11], s100 offen offset:1024 lds
    buffer_load_dwordx4 v4, s[8:11], s100 offen offset:2048 lds
    buffer_load_dwordx4 v5, s[8:11], s100 offen offset:3072 lds
    s_add_u32 m0, s101, 49152
    s_nop 0
    buffer_load_dwordx4 v8, s[12:15], s100 offen lds
    buffer_load_dwordx4 v9, s[12:15], s100 offen offset:1024 lds
    s_add_u32 m0, s101, 51200
    s_nop 0
    buffer_load_dwordx4 v8, s[16:19], s100 offen lds
    buffer_load_dwordx4 v9, s[16:19], s100 offen offset:1024 lds
    s_add_u32 s100, s100, 128
    s_and_b32 s100, s100, 2047
    s_waitcnt vmcnt(16)
    s_barrier
    s_add_u32 m0, s101, 65536
    s_nop 0
    buffer_load_dwordx4 v4, s[8:11], s100 offen lds
    buffer_load_dwordx4 v5, s[8:11], s100 offen offset:1024 lds
    buffer_load_dwordx4 v4, s[8:11], s100 offen offset:2048 lds
    buffer_load_dwordx4 v5, s[8:11], s100 offen offset:3072 lds
    s_add_u32 m0, s101, 81920
    s_nop 0
    buffer_load_dwordx4 v8, s[12:15], s100 offen lds
    buffer_load_dwordx4 v9, s[12:15], s100 offen offset:1024 lds
    s_add_u32 m0, s101, 83968
    s_nop 0
    buffer_load_dwordx4 v8, s[16:19], s100 offen lds
    buffer_load_dwordx4 v9, s[16:19], s100 offen offset:1024 lds
    s_add_u32 s100, s100, 128
    s_and_b32 s100, s100, 2047
    buffer_load_dwordx4 v[112:115], v10, s[68:71], s35 offen offset:0 nt
    buffer_load_dwordx4 v[116:119], v10, s[68:71], s35 offen offset:1024 nt
    buffer_load_dwordx4 v[120:123], v10, s[68:71], s35 offen offset:2048 nt
    buffer_load_dwordx4 v[124:127], v10, s[68:71], s35 offen offset:3072 nt
    s_waitcnt vmcnt(20) lgkmcnt(0)
    s_barrier
    s_add_u32 m0, s101, 98304
    s_nop 0
    buffer_load_dwordx4 v4, s[8:11], s100 offen lds
    buffer_load_dwordx4 v5, s[8:11], s100 offen offset:1024 lds
    buffer_load_dwordx4 v4, s[8:11], s100 offen offset:2048 lds
    buffer_load_dwordx4 v5, s[8:11], s100 offen offset:3072 lds
    s_waitcnt vmcnt(16)
    s_barrier
    s_add_u32 m0, s101, 114688
    s_nop 0
    buffer_load_dwordx4 v8, s[12:15], s100 offen lds
    buffer_load_dwordx4 v9, s[12:15], s100 offen offset:1024 lds
    s_add_u32 m0, s101, 116736
    s_nop 0
    buffer_load_dwordx4 v8, s[16:19], s100 offen lds
    buffer_load_dwordx4 v9, s[16:19], s100 offen offset:1024 lds
    s_add_u32 s100, s100, 128
    s_and_b32 s100, s100, 2047
    s_add_u32 m0, s101, 0
    s_nop 0
    buffer_load_dwordx4 v4, s[8:11], s100 offen lds
    buffer_load_dwordx4 v5, s[8:11], s100 offen offset:1024 lds
    buffer_load_dwordx4 v4, s[8:11], s100 offen offset:2048 lds
    buffer_load_dwordx4 v5, s[8:11], s100 offen offset:3072 lds
    s_waitcnt vmcnt(16)
    s_barrier
    s_add_u32 m0, s101, 16384
    s_nop 0
    buffer_load_dwordx4 v8, s[12:15], s100 offen lds
    buffer_load_dwordx4 v9, s[12:15], s100 offen offset:1024 lds
    s_add_u32 m0, s101, 18432
    s_nop 0
    buffer_load_dwordx4 v8, s[16:19], s100 offen lds
    buffer_load_dwordx4 v9, s[16:19], s100 offen offset:1024 lds
    s_add_u32 s100, s100, 128
    s_and_b32 s100, s100, 2047
    s_cmp_eq_u32 s46, 0
    s_cbranch_scc0 L_t0
    buffer_load_dword v240, v30, s[52:55], 0 offen
    buffer_load_dword v241, v30, s[52:55], 0 offen offset:64
    L_t0:
    s_add_u32 m0, s101, 32768
    s_nop 0
    buffer_load_dwordx4 v4, s[8:11], s100 offen lds
    buffer_load_dwordx4 v5, s[8:11], s100 offen offset:1024 lds
    buffer_load_dwordx4 v4, s[8:11], s100 offen offset:2048 lds
    buffer_load_dwordx4 v5, s[8:11], s100 offen offset:3072 lds
    s_waitcnt vmcnt(12)
    s_barrier
    s_add_u32 m0, s101, 49152
    s_nop 0
    buffer_load_dwordx4 v8, s[12:15], s100 offen lds
    buffer_load_dwordx4 v9, s[12:15], s100 offen offset:1024 lds
    s_add_u32 m0, s101, 51200
    s_nop 0
    buffer_load_dwordx4 v8, s[16:19], s100 offen lds
    buffer_load_dwordx4 v9, s[16:19], s100 offen offset:1024 lds
    s_add_u32 s100, s100, 128
    s_and_b32 s100, s100, 2047
    s_cmp_eq_u32 s46, 1
    s_cbranch_scc0 L_t1
    buffer_load_dword v240, v30, s[52:55], 0 offen
    buffer_load_dword v241, v30, s[52:55], 0 offen offset:64
    L_t1:
    s_add_u32 m0, s101, 65536
    s_nop 0
    buffer_load_dwordx4 v4, s[8:11], s100 offen lds
    buffer_load_dwordx4 v5, s[8:11], s100 offen offset:1024 lds
    buffer_load_dwordx4 v4, s[8:11], s100 offen offset:2048 lds
    buffer_load_dwordx4 v5, s[8:11], s100 offen offset:3072 lds
    s_waitcnt vmcnt(12)
    s_barrier
    s_add_u32 m0, s101, 81920
    s_nop 0
    buffer_load_dwordx4 v8, s[12:15], s100 offen lds
    buffer_load_dwordx4 v9, s[12:15], s100 offen offset:1024 lds
    s_add_u32 m0, s101, 83968
    s_nop 0
    buffer_load_dwordx4 v8, s[16:19], s100 offen lds
    buffer_load_dwordx4 v9, s[16:19], s100 offen offset:1024 lds
    s_add_u32 s100, s100, 128
    s_and_b32 s100, s100, 2047
    s_cmp_eq_u32 s46, 2
    s_cbranch_scc0 L_t2
    buffer_load_dword v240, v30, s[52:55], 0 offen
    buffer_load_dword v241, v30, s[52:55], 0 offen offset:64
    L_t2:
    s_add_u32 m0, s101, 98304
    s_nop 0
    buffer_load_dwordx4 v4, s[8:11], s100 offen lds
    buffer_load_dwordx4 v5, s[8:11], s100 offen offset:1024 lds
    buffer_load_dwordx4 v4, s[8:11], s100 offen offset:2048 lds
    buffer_load_dwordx4 v5, s[8:11], s100 offen offset:3072 lds
    v_mov_b32 v1, 147328
    ds_read_b64 v[28:29], v1
    s_waitcnt vmcnt(12)
    s_barrier
    s_add_u32 m0, s101, 114688
    s_nop 0
    buffer_load_dwordx4 v8, s[12:15], s100 offen lds
    buffer_load_dwordx4 v9, s[12:15], s100 offen offset:1024 lds
    s_add_u32 m0, s101, 116736
    s_nop 0
    buffer_load_dwordx4 v8, s[16:19], s100 offen lds
    buffer_load_dwordx4 v9, s[16:19], s100 offen offset:1024 lds
    s_add_u32 s100, s100, 128
    s_and_b32 s100, s100, 2047
    s_cmp_eq_u32 s46, 3
    s_cbranch_scc0 L_t3
    buffer_load_dword v240, v30, s[52:55], 0 offen
    buffer_load_dword v241, v30, s[52:55], 0 offen offset:64
    L_t3:
    s_add_u32 m0, s101, 0
    s_nop 0
    buffer_load_dwordx4 v4, s[8:11], s100 offen lds
    buffer_load_dwordx4 v5, s[8:11], s100 offen offset:1024 lds
    buffer_load_dwordx4 v4, s[8:11], s100 offen offset:2048 lds
    buffer_load_dwordx4 v5, s[8:11], s100 offen offset:3072 lds
    s_waitcnt vmcnt(12)
    s_barrier
    s_add_u32 m0, s101, 16384
    s_nop 0
    buffer_load_dwordx4 v8, s[12:15], s100 offen lds
    buffer_load_dwordx4 v9, s[12:15], s100 offen offset:1024 lds
    s_add_u32 m0, s101, 18432
    s_nop 0
    buffer_load_dwordx4 v8, s[16:19], s100 offen lds
    buffer_load_dwordx4 v9, s[16:19], s100 offen offset:1024 lds
    s_add_u32 s100, s100, 128
    s_and_b32 s100, s100, 2047
    s_cmp_eq_u32 s46, 4
    s_cbranch_scc0 L_t4
    buffer_load_dword v240, v30, s[52:55], 0 offen
    buffer_load_dword v241, v30, s[52:55], 0 offen offset:64
    L_t4:
    s_add_u32 m0, s101, 32768
    s_nop 0
    buffer_load_dwordx4 v4, s[8:11], s100 offen lds
    buffer_load_dwordx4 v5, s[8:11], s100 offen offset:1024 lds
    buffer_load_dwordx4 v4, s[8:11], s100 offen offset:2048 lds
    buffer_load_dwordx4 v5, s[8:11], s100 offen offset:3072 lds
    s_waitcnt vmcnt(12)
    s_barrier
    s_add_u32 m0, s101, 49152
    s_nop 0
    buffer_load_dwordx4 v8, s[12:15], s100 offen lds
    buffer_load_dwordx4 v9, s[12:15], s100 offen offset:1024 lds
    s_add_u32 m0, s101, 51200
    s_nop 0
    buffer_load_dwordx4 v8, s[16:19], s100 offen lds
    buffer_load_dwordx4 v9, s[16:19], s100 offen offset:1024 lds
    s_add_u32 s100, s100, 128
    s_and_b32 s100, s100, 2047
    s_cmp_eq_u32 s46, 5
    s_cbranch_scc0 L_t5
    buffer_load_dword v240, v30, s[52:55], 0 offen
    buffer_load_dword v241, v30, s[52:55], 0 offen offset:64
    L_t5:
    s_add_u32 m0, s101, 65536
    s_nop 0
    buffer_load_dwordx4 v4, s[8:11], s100 offen lds
    buffer_load_dwordx4 v5, s[8:11], s100 offen offset:1024 lds
    buffer_load_dwordx4 v4, s[8:11], s100 offen offset:2048 lds
    buffer_load_dwordx4 v5, s[8:11], s100 offen offset:3072 lds
    v_mov_b32 v32, 0
    v_mov_b32 v33, 0
    v_mov_b32 v34, 0
    v_mov_b32 v35, 0
    s_add_u32 s47, s45, 110720
    v_add_u32 v1, s47, v10
    v_and_b32 v3, 16, v10
    v_and_b32 v15, 32, v10
    v_mul_u32_u24 v15, 130, v15
    v_add3_u32 v3, v3, v15, s45
    v_add_u32 v3, 98304, v3
    v_cmp_gt_u32 vcc, 32, v2
    s_add_u32 s47, s45, 98336
    v_add_u32 v15, s47, v10
    v_cndmask_b32 v1, v3, v1, vcc
    v_mov_b32 v64, 0
    s_waitcnt vmcnt(60)
    v_mov_b32_dpp v68, v115 wave_ror:1 row_mask:0xf bank_mask:0xf
    v_mov_b32_dpp v72, v119 wave_ror:1 row_mask:0xf bank_mask:0xf
    v_mov_b32_dpp v76, v123 wave_ror:1 row_mask:0xf bank_mask:0xf
    v_mov_b32_dpp v64, v115 wave_shr:1 row_mask:0xf bank_mask:0xf
    v_mov_b32_dpp v68, v119 wave_shr:1 row_mask:0xf bank_mask:0xf
    v_mov_b32_dpp v72, v123 wave_shr:1 row_mask:0xf bank_mask:0xf
    v_mov_b32_dpp v76, v127 wave_shr:1 row_mask:0xf bank_mask:0xf
    v_alignbit_b32 v64, v112, v64, 16
    v_alignbit_b32 v65, v113, v112, 16
    v_alignbit_b32 v66, v114, v113, 16
    v_alignbit_b32 v67, v115, v114, 16
    v_alignbit_b32 v68, v116, v68, 16
    v_alignbit_b32 v69, v117, v116, 16
    v_alignbit_b32 v70, v118, v117, 16
    v_alignbit_b32 v71, v119, v118, 16
    v_alignbit_b32 v72, v120, v72, 16
    v_alignbit_b32 v73, v121, v120, 16
    v_alignbit_b32 v74, v122, v121, 16
    v_alignbit_b32 v75, v123, v122, 16
    v_alignbit_b32 v76, v124, v76, 16
    v_alignbit_b32 v77, v125, v124, 16
    v_alignbit_b32 v78, v126, v125, 16
    v_alignbit_b32 v79, v127, v126, 16
    s_waitcnt vmcnt(12)
    s_barrier
    s_add_u32 m0, s101, 81920
    s_nop 0
    buffer_load_dwordx4 v8, s[12:15], s100 offen lds
    buffer_load_dwordx4 v9, s[12:15], s100 offen offset:1024 lds
    s_add_u32 m0, s101, 83968
    s_nop 0
    buffer_load_dwordx4 v8, s[16:19], s100 offen lds
    buffer_load_dwordx4 v9, s[16:19], s100 offen offset:1024 lds
    s_add_u32 s100, s100, 128
    s_and_b32 s100, s100, 2047
    s_cmp_eq_u32 s46, 6
    s_cbranch_scc0 L_t6
    buffer_load_dword v240, v30, s[52:55], 0 offen
    buffer_load_dword v241, v30, s[52:55], 0 offen offset:64
    L_t6:
    s_add_u32 m0, s101, 98304
    s_nop 0
    buffer_load_dwordx4 v4, s[8:11], s100 offen lds
    buffer_load_dwordx4 v5, s[8:11], s100 offen offset:1024 lds
    buffer_load_dwordx4 v4, s[8:11], s100 offen offset:2048 lds
    buffer_load_dwordx4 v5, s[8:11], s100 offen offset:3072 lds
    s_waitcnt vmcnt(12)
    s_barrier
    s_add_u32 m0, s101, 114688
    s_nop 0
    buffer_load_dwordx4 v8, s[12:15], s100 offen lds
    buffer_load_dwordx4 v9, s[12:15], s100 offen offset:1024 lds
    s_add_u32 m0, s101, 116736
    s_nop 0
    buffer_load_dwordx4 v8, s[16:19], s100 offen lds
    buffer_load_dwordx4 v9, s[16:19], s100 offen offset:1024 lds
    s_add_u32 s100, s100, 128
    s_and_b32 s100, s100, 2047
    s_cmp_eq_u32 s46, 7
    s_cbranch_scc0 L_t7
    buffer_load_dword v240, v30, s[52:55], 0 offen
    buffer_load_dword v241, v30, s[52:55], 0 offen offset:64
    L_t7:
    s_add_u32 m0, s101, 0
    s_nop 0
    buffer_load_dwordx4 v4, s[8:11], s100 offen lds
    buffer_load_dwordx4 v5, s[8:11], s100 offen offset:1024 lds
    buffer_load_dwordx4 v4, s[8:11], s100 offen offset:2048 lds
    buffer_load_dwordx4 v5, s[8:11], s100 offen offset:3072 lds
    s_waitcnt vmcnt(12)
    s_barrier
    s_add_u32 m0, s101, 16384
    s_nop 0
    buffer_load_dwordx4 v8, s[12:15], s100 offen lds
    buffer_load_dwordx4 v9, s[12:15], s100 offen offset:1024 lds
    s_add_u32 m0, s101, 18432
    s_nop 0
    buffer_load_dwordx4 v8, s[16:19], s100 offen lds
    buffer_load_dwordx4 v9, s[16:19], s100 offen offset:1024 lds
    s_add_u32 s100, s100, 128
    s_and_b32 s100, s100, 2047
    s_add_u32 m0, s101, 32768
    s_nop 0
    buffer_load_dwordx4 v4, s[8:11], s100 offen lds
    buffer_load_dwordx4 v5, s[8:11], s100 offen offset:1024 lds
    buffer_load_dwordx4 v4, s[8:11], s100 offen offset:2048 lds
    buffer_load_dwordx4 v5, s[8:11], s100 offen offset:3072 lds
    s_waitcnt vmcnt(12)
    s_barrier
    s_add_u32 m0, s101, 49152
    s_nop 0
    buffer_load_dwordx4 v8, s[12:15], s100 offen lds
    buffer_load_dwordx4 v9, s[12:15], s100 offen offset:1024 lds
    s_add_u32 m0, s101, 51200
    s_nop 0
    buffer_load_dwordx4 v8, s[16:19], s100 offen lds
    buffer_load_dwordx4 v9, s[16:19], s100 offen offset:1024 lds
    s_add_u32 s100, s100, 128
    s_and_b32 s100, s100, 2047
    s_add_u32 m0, s101, 65536
    s_nop 0
    buffer_load_dwordx4 v4, s[8:11], s100 offen lds
    buffer_load_dwordx4 v5, s[8:11], s100 offen offset:1024 lds
    buffer_load_dwordx4 v4, s[8:11], s100 offen offset:2048 lds
    buffer_load_dwordx4 v5, s[8:11], s100 offen offset:3072 lds
    s_waitcnt vmcnt(12)
    s_barrier
    s_add_u32 m0, s101, 81920
    s_nop 0
    buffer_load_dwordx4 v8, s[12:15], s100 offen lds
    buffer_load_dwordx4 v9, s[12:15], s100 offen offset:1024 lds
    s_add_u32 m0, s101, 83968
    s_nop 0
    buffer_load_dwordx4 v8, s[16:19], s100 offen lds
    buffer_load_dwordx4 v9, s[16:19], s100 offen offset:1024 lds
    s_add_u32 s100, s100, 128
    s_and_b32 s100, s100, 2047
    s_mov_b32 s36, 0
    buffer_load_dwordx2 v[192:193], v31, s[40:43], s36 offen nt
    s_mov_b32 s36, 8192
    buffer_load_dwordx2 v[194:195], v31, s[40:43], s36 offen nt
    s_mov_b32 s36, 16384
    buffer_load_dwordx2 v[196:197], v31, s[40:43], s36 offen nt
    s_mov_b32 s36, 24576
    buffer_load_dwordx2 v[198:199], v31, s[40:43], s36 offen nt
    s_mov_b32 s36, 32768
    buffer_load_dwordx2 v[200:201], v31, s[40:43], s36 offen nt
    s_mov_b32 s36, 40960
    buffer_load_dwordx2 v[202:203], v31, s[40:43], s36 offen nt
    s_mov_b32 s36, 49152
    buffer_load_dwordx2 v[204:205], v31, s[40:43], s36 offen nt
    s_mov_b32 s36, 57344
    buffer_load_dwordx2 v[206:207], v31, s[40:43], s36 offen nt
    s_waitcnt vmcnt(16)
    s_barrier
    s_add_u32 s44, s38, 0
    s_and_b32 s44, s44, 1023
    s_or_b32 s44, s44, s20
    s_add_u32 m0, s39, 0
    s_nop 0
    buffer_load_dwordx4 v246, s[24:27], s44 offen offset:0 lds
    buffer_load_dwordx4 v247, s[24:27], s44 offen offset:1024 lds
    s_add_u32 m0, s39, 8192
    s_nop 0
    buffer_load_dwordx4 v248, s[28:31], s44 offen offset:0 lds
    buffer_load_dwordx4 v249, s[28:31], s44 offen offset:1024 lds
    s_add_u32 s44, s38, 128
    s_and_b32 s44, s44, 1023
    s_or_b32 s44, s44, s20
    s_add_u32 m0, s39, 16384
    s_nop 0
    buffer_load_dwordx4 v246, s[24:27], s44 offen offset:0 lds
    buffer_load_dwordx4 v247, s[24:27], s44 offen offset:1024 lds
    s_add_u32 m0, s39, 24576
    s_nop 0
    buffer_load_dwordx4 v248, s[28:31], s44 offen offset:0 lds
    buffer_load_dwordx4 v249, s[28:31], s44 offen offset:1024 lds
    s_waitcnt vmcnt(16)
    s_barrier
    ds_write_b128 v1, v[32:35]
    ds_write_b128 v15, v[112:115] offset:4160
    ds_write_b128 v15, v[64:67] offset:0
    ds_write_b128 v15, v[116:119] offset:5184
    ds_write_b128 v15, v[68:71] offset:1024
    ds_write_b128 v15, v[120:123] offset:6208
    ds_write_b128 v15, v[72:75] offset:2048
    ds_write_b128 v15, v[124:127] offset:7232
    ds_write_b128 v15, v[76:79] offset:3072
    s_mov_b32 s51, 0
L_g1d:
    ds_read_b128 v[242:245], v7 offset:16
    s_add_u32 s51, s51, 1
    s_waitcnt lgkmcnt(0)
    v_xor_b32 v242, v242, v28
    v_xor_b32 v243, v243, v28
    v_xor_b32 v244, v244, v28
    v_xor_b32 v245, v245, v28
    v_or3_b32 v242, v242, v243, v244
    v_or_b32 v242, v242, v245
    s_cmp_gt_u32 s51, 16384
    s_cbranch_scc1 L_g1d_ok
    v_cmp_ne_u32 vcc, 0, v242
    s_cbranch_vccnz L_g1d
L_g1d_ok:
    ds_read_b128 v[96:99], v20 offset:3584
    ds_read2_b32 v[64:65], v16 offset0:0 offset1:1
    ds_read2_b32 v[66:67], v16 offset0:2 offset1:3
    ds_read_b128 v[100:103], v20 offset:3072
    ds_read2_b32 v[68:69], v16 offset0:128 offset1:129
    ds_read2_b32 v[70:71], v16 offset0:130 offset1:131
    ds_read_b128 v[104:107], v20 offset:2560
    ds_read2_b32 v[72:73], v17 offset0:0 offset1:1
    ds_read2_b32 v[74:75], v17 offset0:2 offset1:3
    ds_read_b128 v[108:111], v20 offset:2048
    ds_read2_b32 v[76:77], v17 offset0:128 offset1:129
    ds_read2_b32 v[78:79], v17 offset0:130 offset1:131
    ds_read_b128 v[112:115], v20 offset:1536
    ds_read2_b32 v[80:81], v18 offset0:0 offset1:1
    ds_read2_b32 v[82:83], v18 offset0:2 offset1:3
    ds_read_b128 v[116:119], v20 offset:1024
    ds_read2_b32 v[84:85], v18 offset0:128 offset1:129
    ds_read2_b32 v[86:87], v18 offset0:130 offset1:131
    ds_read_b128 v[120:123], v20 offset:512
    ds_read2_b32 v[88:89], v19 offset0:0 offset1:1
    ds_read2_b32 v[90:91], v19 offset0:2 offset1:3
    ds_read_b128 v[124:127], v20 offset:0
    ds_read2_b32 v[92:93], v19 offset0:128 offset1:129
    ds_read2_b32 v[94:95], v19 offset0:130 offset1:131
    s_add_u32 s44, s38, 256
    s_and_b32 s44, s44, 1023
    s_or_b32 s44, s44, s20
    s_add_u32 m0, s39, 32768
    s_nop 0
    buffer_load_dwordx4 v246, s[24:27], s44 offen offset:0 lds
    buffer_load_dwordx4 v247, s[24:27], s44 offen offset:1024 lds
    s_add_u32 m0, s39, 40960
    s_nop 0
    buffer_load_dwordx4 v248, s[28:31], s44 offen offset:0 lds
    buffer_load_dwordx4 v249, s[28:31], s44 offen offset:1024 lds
    s_add_u32 s44, s38, 384
    s_and_b32 s44, s44, 1023
    s_or_b32 s44, s44, s20
    s_add_u32 m0, s39, 49152
    s_nop 0
    buffer_load_dwordx4 v246, s[24:27], s44 offen offset:0 lds
    buffer_load_dwordx4 v247, s[24:27], s44 offen offset:1024 lds
    s_add_u32 m0, s39, 57344
    s_nop 0
    buffer_load_dwordx4 v248, s[28:31], s44 offen offset:0 lds
    buffer_load_dwordx4 v249, s[28:31], s44 offen offset:1024 lds
    ds_read_b32 v1, v6 offset:64
    s_waitcnt lgkmcnt(0)
    v_cmp_gt_u32 vcc, 2, v1
    s_cbranch_vccnz L_g0
    L_g0_r:
    s_waitcnt lgkmcnt(0)
    v_mfma_f32_16x16x32_bf16 v[32:35], v[24:27], v[96:99], 0
    v_mfma_f32_16x16x32_bf16 v[36:39], v[24:27], v[100:103], 0
    v_mfma_f32_16x16x32_bf16 v[40:43], v[24:27], v[104:107], 0
    v_mfma_f32_16x16x32_bf16 v[44:47], v[24:27], v[108:111], 0
    v_mfma_f32_16x16x32_bf16 v[48:51], v[24:27], v[112:115], 0
    v_mfma_f32_16x16x32_bf16 v[52:55], v[24:27], v[116:119], 0
    v_mfma_f32_16x16x32_bf16 v[56:59], v[24:27], v[120:123], 0
    v_mfma_f32_16x16x32_bf16 v[60:63], v[24:27], v[124:127], 0
    s_mov_b32 s51, 0
L_conv:
    s_cmp_eq_u32 s51, 2
    s_cbranch_scc1 L_cs4
L_cr0:
    s_waitcnt lgkmcnt(0)
    v_mfma_f32_16x16x32_bf16 v[60:63], v[64:67], v[124:127], v[60:63]
    ds_read_b128 v[160:163], v20 offset:3648
    v_mfma_f32_16x16x32_bf16 v[56:59], v[64:67], v[120:123], v[56:59]
    ds_read2_b32 v[128:129], v16 offset0:16 offset1:17
    v_mfma_f32_16x16x32_bf16 v[52:55], v[64:67], v[116:119], v[52:55]
    ds_read2_b32 v[130:131], v16 offset0:18 offset1:19
    v_mfma_f32_16x16x32_bf16 v[48:51], v[64:67], v[112:115], v[48:51]
    ds_read_b128 v[164:167], v20 offset:3136
    v_mfma_f32_16x16x32_bf16 v[60:63], v[68:71], v[120:123], v[60:63]
    ds_read_b32 v1, v6 offset:64
    v_mfma_f32_16x16x32_bf16 v[56:59], v[68:71], v[116:119], v[56:59]
    ds_read2_b32 v[132:133], v16 offset0:144 offset1:145
    v_mfma_f32_16x16x32_bf16 v[52:55], v[68:71], v[112:115], v[52:55]
    ds_read2_b32 v[134:135], v16 offset0:146 offset1:147
    v_mfma_f32_16x16x32_bf16 v[44:47], v[64:67], v[108:111], v[44:47]
    ds_read_b128 v[168:171], v20 offset:2624
    v_mfma_f32_16x16x32_bf16 v[60:63], v[72:75], v[116:119], v[60:63]
    ds_read2_b32 v[136:137], v17 offset0:16 offset1:17
    v_mfma_f32_16x16x32_bf16 v[56:59], v[72:75], v[112:115], v[56:59]
    ds_read2_b32 v[138:139], v17 offset0:18 offset1:19
    v_mfma_f32_16x16x32_bf16 v[48:51], v[68:71], v[108:111], v[48:51]
    s_waitcnt lgkmcnt(5)
    v_cmp_gt_u32 vcc, 2, v1
    v_mfma_f32_16x16x32_bf16 v[52:55], v[72:75], v[108:111], v[52:55]
    ds_read_b128 v[172:175], v20 offset:2112
    s_cbranch_vccnz L_g1
    L_g1_r:
    v_mfma_f32_16x16x32_bf16 v[60:63], v[76:79], v[112:115], v[60:63]
    ds_read2_b32 v[140:141], v17 offset0:144 offset1:145
    v_mfma_f32_16x16x32_bf16 v[56:59], v[76:79], v[108:111], v[56:59]
    ds_read2_b32 v[142:143], v17 offset0:146 offset1:147
    v_mfma_f32_16x16x32_bf16 v[40:43], v[64:67], v[104:107], v[40:43]
    ds_read_b128 v[176:179], v20 offset:1600
    v_mfma_f32_16x16x32_bf16 v[44:47], v[68:71], v[104:107], v[44:47]
    ds_read2_b32 v[144:145], v18 offset0:16 offset1:17
    v_mfma_f32_16x16x32_bf16 v[60:63], v[80:83], v[108:111], v[60:63]
    ds_read_b32 v1, v6 offset:64
    v_mfma_f32_16x16x32_bf16 v[48:51], v[72:75], v[104:107], v[48:51]
    ds_read2_b32 v[146:147], v18 offset0:18 offset1:19
    v_mfma_f32_16x16x32_bf16 v[52:55], v[76:79], v[104:107], v[52:55]
    ds_read_b128 v[180:183], v20 offset:1088
    v_mfma_f32_16x16x32_bf16 v[56:59], v[80:83], v[104:107], v[56:59]
    ds_read2_b32 v[148:149], v18 offset0:144 offset1:145
    v_mfma_f32_16x16x32_bf16 v[60:63], v[84:87], v[104:107], v[60:63]
    ds_read2_b32 v[150:151], v18 offset0:146 offset1:147
    v_mfma_f32_16x16x32_bf16 v[36:39], v[64:67], v[100:103], v[36:39]
    ds_read_b128 v[184:187], v20 offset:576
    v_mfma_f32_16x16x32_bf16 v[40:43], v[68:71], v[100:103], v[40:43]
    s_waitcnt lgkmcnt(5)
    v_cmp_gt_u32 vcc, 2, v1
    v_mfma_f32_16x16x32_bf16 v[44:47], v[72:75], v[100:103], v[44:47]
    ds_read2_b32 v[152:153], v19 offset0:16 offset1:17
    s_cbranch_vccnz L_g2
    L_g2_r:
    v_mfma_f32_16x16x32_bf16 v[48:51], v[76:79], v[100:103], v[48:51]
    ds_read2_b32 v[154:155], v19 offset0:18 offset1:19
    v_mfma_f32_16x16x32_bf16 v[52:55], v[80:83], v[100:103], v[52:55]
    ds_read_b128 v[188:191], v20 offset:64
    v_mfma_f32_16x16x32_bf16 v[56:59], v[84:87], v[100:103], v[56:59]
    ds_read2_b32 v[156:157], v19 offset0:144 offset1:145
    v_mfma_f32_16x16x32_bf16 v[60:63], v[88:91], v[100:103], v[60:63]
    ds_read2_b32 v[158:159], v19 offset0:146 offset1:147
    v_mfma_f32_16x16x32_bf16 v[32:35], v[64:67], v[96:99], v[32:35]
    ds_read_b32 v1, v6 offset:64
    v_mfma_f32_16x16x32_bf16 v[36:39], v[68:71], v[96:99], v[36:39]
    v_mfma_f32_16x16x32_bf16 v[40:43], v[72:75], v[96:99], v[40:43]
    v_mfma_f32_16x16x32_bf16 v[44:47], v[76:79], v[96:99], v[44:47]
    v_mfma_f32_16x16x32_bf16 v[48:51], v[80:83], v[96:99], v[48:51]
    v_mfma_f32_16x16x32_bf16 v[52:55], v[84:87], v[96:99], v[52:55]
    v_mfma_f32_16x16x32_bf16 v[56:59], v[88:91], v[96:99], v[56:59]
    s_waitcnt lgkmcnt(0)
    v_cmp_gt_u32 vcc, 2, v1
    v_mfma_f32_16x16x32_bf16 v[60:63], v[92:95], v[96:99], v[60:63]
    s_cbranch_vccnz L_g3
    L_g3_r:
    s_cmp_eq_u32 s51, 0
    s_cbranch_scc1 L_cs1
L_cr1:
    s_waitcnt lgkmcnt(0)
    v_mfma_f32_16x16x32_bf16 v[60:63], v[128:131], v[188:191], v[60:63]
    ds_read_b128 v[96:99], v20 offset:3712
    v_mfma_f32_16x16x32_bf16 v[56:59], v[128:131], v[184:187], v[56:59]
    ds_read2_b32 v[64:65], v16 offset0:32 offset1:33
    v_mfma_f32_16x16x32_bf16 v[52:55], v[128:131], v[180:183], v[52:55]
    ds_read2_b32 v[66:67], v16 offset0:34 offset1:35
    v_mfma_f32_16x16x32_bf16 v[48:51], v[128:131], v[176:179], v[48:51]
    ds_read_b128 v[100:103], v20 offset:3200
    v_mfma_f32_16x16x32_bf16 v[60:63], v[132:135], v[184:187], v[60:63]
    ds_read_b32 v1, v6 offset:64
    v_mfma_f32_16x16x32_bf16 v[56:59], v[132:135], v[180:183], v[56:59]
    ds_read2_b32 v[68:69], v16 offset0:160 offset1:161
    v_mfma_f32_16x16x32_bf16 v[52:55], v[132:135], v[176:179], v[52:55]
    ds_read2_b32 v[70:71], v16 offset0:162 offset1:163
    v_mfma_f32_16x16x32_bf16 v[44:47], v[128:131], v[172:175], v[44:47]
    ds_read_b128 v[104:107], v20 offset:2688
    v_mfma_f32_16x16x32_bf16 v[60:63], v[136:139], v[180:183], v[60:63]
    ds_read2_b32 v[72:73], v17 offset0:32 offset1:33
    v_mfma_f32_16x16x32_bf16 v[56:59], v[136:139], v[176:179], v[56:59]
    ds_read2_b32 v[74:75], v17 offset0:34 offset1:35
    v_mfma_f32_16x16x32_bf16 v[48:51], v[132:135], v[172:175], v[48:51]
    s_waitcnt lgkmcnt(5)
    v_cmp_gt_u32 vcc, 2, v1
    v_mfma_f32_16x16x32_bf16 v[52:55], v[136:139], v[172:175], v[52:55]
    ds_read_b128 v[108:111], v20 offset:2176
    s_cbranch_vccnz L_g4
    L_g4_r:
    v_mfma_f32_16x16x32_bf16 v[60:63], v[140:143], v[176:179], v[60:63]
    ds_read2_b32 v[76:77], v17 offset0:160 offset1:161
    v_mfma_f32_16x16x32_bf16 v[56:59], v[140:143], v[172:175], v[56:59]
    ds_read2_b32 v[78:79], v17 offset0:162 offset1:163
    v_mfma_f32_16x16x32_bf16 v[40:43], v[128:131], v[168:171], v[40:43]
    ds_read_b128 v[112:115], v20 offset:1664
    v_mfma_f32_16x16x32_bf16 v[44:47], v[132:135], v[168:171], v[44:47]
    ds_read2_b32 v[80:81], v18 offset0:32 offset1:33
    v_mfma_f32_16x16x32_bf16 v[60:63], v[144:147], v[172:175], v[60:63]
    ds_read_b32 v1, v6 offset:64
    v_mfma_f32_16x16x32_bf16 v[48:51], v[136:139], v[168:171], v[48:51]
    ds_read2_b32 v[82:83], v18 offset0:34 offset1:35
    v_mfma_f32_16x16x32_bf16 v[52:55], v[140:143], v[168:171], v[52:55]
    ds_read_b128 v[116:119], v20 offset:1152
    v_mfma_f32_16x16x32_bf16 v[56:59], v[144:147], v[168:171], v[56:59]
    ds_read2_b32 v[84:85], v18 offset0:160 offset1:161
    v_mfma_f32_16x16x32_bf16 v[60:63], v[148:151], v[168:171], v[60:63]
    ds_read2_b32 v[86:87], v18 offset0:162 offset1:163
    v_mfma_f32_16x16x32_bf16 v[36:39], v[128:131], v[164:167], v[36:39]
    ds_read_b128 v[120:123], v20 offset:640
    v_mfma_f32_16x16x32_bf16 v[40:43], v[132:135], v[164:167], v[40:43]
    s_waitcnt lgkmcnt(5)
    v_cmp_gt_u32 vcc, 2, v1
    v_mfma_f32_16x16x32_bf16 v[44:47], v[136:139], v[164:167], v[44:47]
    ds_read2_b32 v[88:89], v19 offset0:32 offset1:33
    s_cbranch_vccnz L_g5
    L_g5_r:
    v_mfma_f32_16x16x32_bf16 v[48:51], v[140:143], v[164:167], v[48:51]
    ds_read2_b32 v[90:91], v19 offset0:34 offset1:35
    v_mfma_f32_16x16x32_bf16 v[52:55], v[144:147], v[164:167], v[52:55]
    ds_read_b128 v[124:127], v20 offset:128
    v_mfma_f32_16x16x32_bf16 v[56:59], v[148:151], v[164:167], v[56:59]
    ds_read2_b32 v[92:93], v19 offset0:160 offset1:161
    v_mfma_f32_16x16x32_bf16 v[60:63], v[152:155], v[164:167], v[60:63]
    ds_read2_b32 v[94:95], v19 offset0:162 offset1:163
    v_mfma_f32_16x16x32_bf16 v[32:35], v[128:131], v[160:163], v[32:35]
    ds_read_b32 v1, v6 offset:64
    v_mfma_f32_16x16x32_bf16 v[36:39], v[132:135], v[160:163], v[36:39]
    v_add_u32 v16, 128, v16
    v_mfma_f32_16x16x32_bf16 v[40:43], v[136:139], v[160:163], v[40:43]
    v_add_u32 v17, 128, v17
    v_mfma_f32_16x16x32_bf16 v[44:47], v[140:143], v[160:163], v[44:47]
    v_add_u32 v18, 128, v18
    v_mfma_f32_16x16x32_bf16 v[48:51], v[144:147], v[160:163], v[48:51]
    v_add_u32 v19, 128, v19
    v_mfma_f32_16x16x32_bf16 v[52:55], v[148:151], v[160:163], v[52:55]
    v_add_u32 v20, 128, v20
    v_mfma_f32_16x16x32_bf16 v[56:59], v[152:155], v[160:163], v[56:59]
    s_waitcnt lgkmcnt(0)
    v_cmp_gt_u32 vcc, 2, v1
    v_mfma_f32_16x16x32_bf16 v[60:63], v[156:159], v[160:163], v[60:63]
    s_cbranch_vccnz L_g6
    L_g6_r:
    s_add_u32 s51, s51, 1
    s_cmp_lt_u32 s51, 4
    s_cbranch_scc1 L_conv
    s_waitcnt lgkmcnt(0)
    s_nop 6
    v_cvt_pk_bf16_f32 v32, v32, v33
    v_cvt_pk_bf16_f32 v33, v34, v35
    ds_write_b64 v21, v[32:33] offset:0
    v_cvt_pk_bf16_f32 v34, v36, v37
    v_cvt_pk_bf16_f32 v35, v38, v39
    ds_write_b64 v21, v[34:35] offset:512
    v_cvt_pk_bf16_f32 v36, v40, v41
    v_cvt_pk_bf16_f32 v37, v42, v43
    ds_write_b64 v21, v[36:37] offset:1024
    v_cvt_pk_bf16_f32 v38, v44, v45
    v_cvt_pk_bf16_f32 v39, v46, v47
    ds_write_b64 v21, v[38:39] offset:1536
    v_cvt_pk_bf16_f32 v40, v48, v49
    v_cvt_pk_bf16_f32 v41, v50, v51
    ds_write_b64 v21, v[40:41] offset:2048
    v_cvt_pk_bf16_f32 v42, v52, v53
    v_cvt_pk_bf16_f32 v43, v54, v55
    ds_write_b64 v21, v[42:43] offset:2560
    v_cvt_pk_bf16_f32 v44, v56, v57
    v_cvt_pk_bf16_f32 v45, v58, v59
    ds_write_b64 v21, v[44:45] offset:3072
    v_cvt_pk_bf16_f32 v46, v60, v61
    v_cvt_pk_bf16_f32 v47, v62, v63
    ds_write_b64 v21, v[46:47] offset:3584
    ds_write_b32 v6, v28 offset:80
    s_add_u32 s8, s66, 4194304
    s_addc_u32 s9, s67, 0
    s_mov_b32 s10, 4194304
    s_mov_b32 s11, 0x00020000
    s_mov_b32 s12, s62
    s_mov_b32 s13, s63
    s_mov_b32 s14, 16777216
    s_mov_b32 s15, 0x00020000
    s_lshr_b32 s7, s32, 2
    s_lshl_b32 s7, s7, 4
    s_add_u32 s7, s7, s33
    s_lshl_b32 s7, s7, 11
    s_add_u32 s7, s7, 262144
    v_lshlrev_b32 v1, 7, v12
    v_add_u32 v16, s7, v1
    v_xor_b32 v1, v12, v13
    v_lshlrev_b32 v1, 4, v1
    v_lshl_add_u32 v3, v13, 14, v1
    s_lshl_b32 s47, s32, 2
    s_add_u32 s47, s47, s6
    s_lshl_b32 s7, s33, 10
    s_add_u32 s7, s7, s47
    s_lshl_b32 s7, s7, 8
    v_add_u32 v17, s7, v3
    v_xor_b32 v18, 64, v17
    v_add_u32 v18, 64512, v18
    v_xor_b32 v19, 128, v17
    v_add_u32 v19, 129024, v19
    v_xor_b32 v20, 192, v17
    v_add_u32 v20, 193536, v20
    s_add_u32 s35, s45, 98304
    v_lshl_add_u32 v1, v12, 8, v1
    v_add_u32 v24, s35, v1
    v_xor_b32 v25, 64, v24
    v_xor_b32 v26, 128, v24
    v_xor_b32 v27, 192, v24
    s_lshl_b32 s47, s47, 10
    s_add_u32 s47, s47, s33
    s_lshl_b32 s47, s47, 8
    v_lshlrev_b32 v1, 13, v13
    v_lshl_add_u32 v1, v12, 4, v1
    v_add_u32 v21, s47, v1
    v_bfe_u32 v1, v2, 2, 2
    v_lshlrev_b32 v1, 14, v1
    v_and_b32 v3, 3, v2
    v_lshl_add_u32 v1, v3, 7, v1
    v_lshl_add_u32 v1, v13, 4, v1
    s_lshl_b32 s7, s6, 10
    s_add_u32 s7, s7, 106496
    v_add_u32 v4, s7, v1
    s_lshl_b32 s7, s34, 12
    v_add_u32 v5, s7, v10
    s_lshr_b32 s47, s34, 2
    s_lshl_b32 s7, s6, 8
    s_add_u32 s7, s7, s47
    s_lshl_b32 s7, s7, 7
    s_add_u32 s7, s7, 262144
    v_lshl_add_u32 v8, v12, 3, s7
    v_add_u32 v9, s39, v10
    v_add_u32 v11, 0xc000, v9
    s_mov_b32 s51, 0
L_zd:
    ds_read_b128 v[44:47], v7 offset:80
    s_add_u32 s51, s51, 1
    s_waitcnt lgkmcnt(0)
    v_xor_b32 v44, v44, v28
    v_xor_b32 v45, v45, v28
    v_xor_b32 v46, v46, v28
    v_xor_b32 v47, v47, v28
    v_or3_b32 v44, v44, v45, v46
    v_or_b32 v44, v44, v47
    s_cmp_gt_u32 s51, 16384
    s_cbranch_scc1 L_zd_ok
    v_cmp_ne_u32 vcc, 0, v44
    s_cbranch_vccnz L_zd
L_zd_ok:
    ds_read_b64_tr_b16 v[44:45], v4 offset:0
    ds_read_b64_tr_b16 v[46:47], v4 offset:8
    ds_read_b64_tr_b16 v[48:49], v4 offset:64
    ds_read_b64_tr_b16 v[50:51], v4 offset:72
    ds_read_b64_tr_b16 v[52:53], v4 offset:512
    ds_read_b64_tr_b16 v[54:55], v4 offset:520
    ds_read_b64_tr_b16 v[56:57], v4 offset:576
    ds_read_b64_tr_b16 v[58:59], v4 offset:584
    s_waitcnt lgkmcnt(0)
    buffer_store_dwordx4 v[44:47], v5, s[8:11], 0 offen offset:0 sc1
    buffer_store_dwordx4 v[48:51], v5, s[8:11], 0 offen offset:1024 sc1
    buffer_store_dwordx4 v[52:55], v5, s[8:11], 0 offen offset:2048 sc1
    buffer_store_dwordx4 v[56:59], v5, s[8:11], 0 offen offset:3072 sc1
    s_waitcnt vmcnt(23)
    s_add_u32 s44, s38, 1408
    s_and_b32 s44, s44, 1023
    s_or_b32 s44, s44, s21
    buffer_load_dwordx4 v[208:211], v246, s[24:27], s44 offen offset:0
    s_waitcnt vmcnt(23)
    buffer_load_dwordx4 v[212:215], v247, s[24:27], s44 offen offset:1024
    s_waitcnt vmcnt(23)
    buffer_load_dwordx4 v[216:219], v248, s[28:31], s44 offen offset:0
    s_waitcnt vmcnt(23)
    buffer_load_dwordx4 v[220:223], v249, s[28:31], s44 offen offset:1024
    s_waitcnt vmcnt(23)
    s_add_u32 s44, s38, 1536
    s_and_b32 s44, s44, 1023
    s_or_b32 s44, s44, s21
    buffer_load_dwordx4 v[224:227], v246, s[24:27], s44 offen offset:0
    s_waitcnt vmcnt(23)
    buffer_load_dwordx4 v[228:231], v247, s[24:27], s44 offen offset:1024
    s_waitcnt vmcnt(23)
    buffer_load_dwordx4 v[232:235], v248, s[28:31], s44 offen offset:0
    s_waitcnt vmcnt(23)
    buffer_load_dwordx4 v[236:239], v249, s[28:31], s44 offen offset:1024
    s_waitcnt vmcnt(8)
    s_mov_b64 exec, 0xffff
    buffer_store_dwordx2 v[28:29], v8, s[76:79], 0 offen sc1
    s_mov_b64 exec, -1
    s_mov_b32 s51, 0
L_p1:
    ds_read_b128 v[32:35], v7 offset:96
    s_add_u32 s51, s51, 1
    s_waitcnt lgkmcnt(0)
    v_min3_u32 v32, v32, v33, v34
    v_min_u32 v32, v32, v35
    s_cmp_gt_u32 s51, 65536
    s_cbranch_scc1 L_p1_ok
    v_cmp_gt_u32 vcc, 1, v32
    s_cbranch_vccnz L_p1
L_p1_ok:
    s_waitcnt vmcnt(23)
    s_add_u32 s44, s38, 1664
    s_and_b32 s44, s44, 1023
    s_or_b32 s44, s44, s21
    buffer_load_dwordx4 v[64:67], v246, s[24:27], s44 offen offset:0
    s_waitcnt vmcnt(23)
    buffer_load_dwordx4 v[68:71], v247, s[24:27], s44 offen offset:1024
    s_waitcnt vmcnt(23)
    buffer_load_dwordx4 v[72:75], v248, s[28:31], s44 offen offset:0
    s_waitcnt vmcnt(23)
    buffer_load_dwordx4 v[76:79], v249, s[28:31], s44 offen offset:1024
    s_mov_b32 s51, 0
L_p2:
    ds_read_b128 v[32:35], v7 offset:96
    s_add_u32 s51, s51, 1
    s_waitcnt lgkmcnt(0)
    v_min3_u32 v32, v32, v33, v34
    v_min_u32 v32, v32, v35
    s_cmp_gt_u32 s51, 65536
    s_cbranch_scc1 L_p2_ok
    v_cmp_gt_u32 vcc, 2, v32
    s_cbranch_vccnz L_p2
L_p2_ok:
    s_waitcnt vmcnt(23)
    s_add_u32 s44, s38, 1792
    s_and_b32 s44, s44, 1023
    s_or_b32 s44, s44, s21
    buffer_load_dwordx4 v[80:83], v246, s[24:27], s44 offen offset:0
    s_waitcnt vmcnt(23)
    buffer_load_dwordx4 v[84:87], v247, s[24:27], s44 offen offset:1024
    s_waitcnt vmcnt(23)
    buffer_load_dwordx4 v[88:91], v248, s[28:31], s44 offen offset:0
    s_waitcnt vmcnt(23)
    buffer_load_dwordx4 v[92:95], v249, s[28:31], s44 offen offset:1024
    s_mov_b32 s51, 0
L_p3:
    ds_read_b128 v[32:35], v7 offset:96
    s_add_u32 s51, s51, 1
    s_waitcnt lgkmcnt(0)
    v_min3_u32 v32, v32, v33, v34
    v_min_u32 v32, v32, v35
    s_cmp_gt_u32 s51, 65536
    s_cbranch_scc1 L_p3_ok
    v_cmp_gt_u32 vcc, 3, v32
    s_cbranch_vccnz L_p3
L_p3_ok:
    s_waitcnt vmcnt(23)
    s_add_u32 s44, s38, 1920
    s_and_b32 s44, s44, 1023
    s_or_b32 s44, s44, s21
    buffer_load_dwordx4 v[96:99], v246, s[24:27], s44 offen offset:0
    s_waitcnt vmcnt(23)
    buffer_load_dwordx4 v[100:103], v247, s[24:27], s44 offen offset:1024
    s_waitcnt vmcnt(23)
    buffer_load_dwordx4 v[104:107], v248, s[28:31], s44 offen offset:0
    s_waitcnt vmcnt(23)
    buffer_load_dwordx4 v[108:111], v249, s[28:31], s44 offen offset:1024
    s_mov_b32 s51, 0
L_p6:
    ds_read_b128 v[32:35], v7 offset:96
    s_add_u32 s51, s51, 1
    s_waitcnt lgkmcnt(0)
    v_min3_u32 v32, v32, v33, v34
    v_min_u32 v32, v32, v35
    s_cmp_gt_u32 s51, 65536
    s_cbranch_scc1 L_p6_ok
    v_cmp_gt_u32 vcc, 6, v32
    s_cbranch_vccnz L_p6
L_p6_ok:
    v_mov_b32 v3, 12
    s_waitcnt vmcnt(17)
    ds_write_b128 v11, v[208:211] offset:32768
    ds_write_b128 v11, v[212:215] offset:33792
    ds_write_b128 v11, v[216:219] offset:40960
    ds_write_b128 v11, v[220:223] offset:41984
    ds_write_b32 v6, v3 offset:48
    buffer_load_dwordx2 v[22:23], v16, s[76:79], 0 offen sc1
    s_mov_b32 s51, 0
L_p7:
    ds_read_b128 v[32:35], v7 offset:96
    s_add_u32 s51, s51, 1
    s_waitcnt lgkmcnt(0)
    v_min3_u32 v32, v32, v33, v34
    v_min_u32 v32, v32, v35
    s_cmp_gt_u32 s51, 65536
    s_cbranch_scc1 L_p7_ok
    v_cmp_gt_u32 vcc, 7, v32
    s_cbranch_vccnz L_p7
L_p7_ok:
    v_mov_b32 v3, 13
    s_waitcnt vmcnt(14)
    ds_write_b128 v9, v[224:227] offset:0
    ds_write_b128 v9, v[228:231] offset:1024
    ds_write_b128 v9, v[232:235] offset:8192
    ds_write_b128 v9, v[236:239] offset:9216
    ds_write_b32 v6, v3 offset:48
    s_mov_b32 s51, 0
L_p8:
    ds_read_b128 v[32:35], v7 offset:96
    s_add_u32 s51, s51, 1
    s_waitcnt lgkmcnt(0)
    v_min3_u32 v32, v32, v33, v34
    v_min_u32 v32, v32, v35
    s_cmp_gt_u32 s51, 65536
    s_cbranch_scc1 L_p8_ok
    v_cmp_gt_u32 vcc, 8, v32
    s_cbranch_vccnz L_p8
L_p8_ok:
    v_mov_b32 v3, 14
    s_waitcnt vmcnt(9)
    ds_write_b128 v9, v[64:67] offset:16384
    ds_write_b128 v9, v[68:71] offset:17408
    ds_write_b128 v9, v[72:75] offset:24576
    ds_write_b128 v9, v[76:79] offset:25600
    ds_write_b32 v6, v3 offset:48
    s_waitcnt vmcnt(0)
    v_cmp_eq_u32 vcc, v22, v28
    v_cmp_eq_u32 s[48:49], v23, v29
    s_mov_b32 m0, s35
    s_and_b64 s[48:49], s[48:49], vcc
    s_cmp_eq_u64 s[48:49], -1
    s_cbranch_scc1 L_zspin_go
    s_mov_b32 s51, 0
L_zspin:
    buffer_load_dwordx2 v[22:23], v16, s[76:79], 0 offen sc1
    s_add_u32 s51, s51, 1
    s_waitcnt vmcnt(0)
    v_cmp_eq_u32 vcc, v22, v28
    v_cmp_eq_u32 s[48:49], v23, v29
    s_cmp_gt_u32 s51, 4096
    s_cbranch_scc1 L_zspin_go
    s_and_b64 s[48:49], s[48:49], vcc
    s_cmp_eq_u64 s[48:49], -1
    s_cbranch_scc0 L_zspin
L_zspin_go:
    buffer_load_dwordx4 v17, s[8:11], 0 offen offset:0 sc1 lds
    buffer_load_dwordx4 v18, s[8:11], 0 offen offset:1024 sc1 lds
    buffer_load_dwordx4 v19, s[8:11], 0 offen offset:2048 sc1 lds
    buffer_load_dwordx4 v20, s[8:11], 0 offen offset:3072 sc1 lds
    s_mov_b32 s51, 0
L_p9:
    ds_read_b128 v[32:35], v7 offset:96
    s_add_u32 s51, s51, 1
    s_waitcnt lgkmcnt(0)
    v_min3_u32 v32, v32, v33, v34
    v_min_u32 v32, v32, v35
    s_cmp_gt_u32 s51, 65536
    s_cbranch_scc1 L_p9_ok
    v_cmp_gt_u32 vcc, 9, v32
    s_cbranch_vccnz L_p9
L_p9_ok:
    v_mov_b32 v3, 15
    s_waitcnt vmcnt(9)
    ds_write_b128 v9, v[80:83] offset:32768
    ds_write_b128 v9, v[84:87] offset:33792
    ds_write_b128 v9, v[88:91] offset:40960
    ds_write_b128 v9, v[92:95] offset:41984
    ds_write_b32 v6, v3 offset:48
    s_mov_b32 s51, 0
L_p10:
    ds_read_b128 v[32:35], v7 offset:96
    s_add_u32 s51, s51, 1
    s_waitcnt lgkmcnt(0)
    v_min3_u32 v32, v32, v33, v34
    v_min_u32 v32, v32, v35
    s_cmp_gt_u32 s51, 65536
    s_cbranch_scc1 L_p10_ok
    v_cmp_gt_u32 vcc, 10, v32
    s_cbranch_vccnz L_p10
L_p10_ok:
    v_mov_b32 v3, 16
    s_waitcnt vmcnt(5)
    ds_write_b128 v11, v[96:99] offset:0
    ds_write_b128 v11, v[100:103] offset:1024
    ds_write_b128 v11, v[104:107] offset:8192
    ds_write_b128 v11, v[108:111] offset:9216
    ds_write_b32 v6, v3 offset:48
    s_waitcnt vmcnt(0) lgkmcnt(0)
    ds_read_b128 v[44:47], v24
    ds_read_b128 v[48:51], v25
    ds_read_b128 v[52:55], v26
    ds_read_b128 v[56:59], v27
    s_waitcnt lgkmcnt(3)
    v_lshlrev_b32 v1, 16, v44
    v_lshlrev_b32 v36, 16, v192
    v_mul_f32 v36, v36, v1
    v_and_b32 v1, 0xffff0000, v44
    v_and_b32 v37, 0xffff0000, v192
    v_mul_f32 v37, v37, v1
    v_lshlrev_b32 v1, 16, v45
    v_lshlrev_b32 v38, 16, v193
    v_mul_f32 v38, v38, v1
    v_and_b32 v1, 0xffff0000, v45
    v_and_b32 v39, 0xffff0000, v193
    v_mul_f32 v39, v39, v1
    s_mov_b32 s7, 0
    buffer_store_dwordx4 v[36:39], v21, s[12:15], s7 offen nt
    v_lshlrev_b32 v1, 16, v46
    v_lshlrev_b32 v40, 16, v200
    v_mul_f32 v40, v40, v1
    v_and_b32 v1, 0xffff0000, v46
    v_and_b32 v41, 0xffff0000, v200
    v_mul_f32 v41, v41, v1
    v_lshlrev_b32 v1, 16, v47
    v_lshlrev_b32 v42, 16, v201
    v_mul_f32 v42, v42, v1
    v_and_b32 v1, 0xffff0000, v47
    v_and_b32 v43, 0xffff0000, v201
    v_mul_f32 v43, v43, v1
    s_mov_b32 s7, 131072
    buffer_store_dwordx4 v[40:43], v21, s[12:15], s7 offen nt
    s_waitcnt lgkmcnt(2)
    v_lshlrev_b32 v1, 16, v48
    v_lshlrev_b32 v36, 16, v194
    v_mul_f32 v36, v36, v1
    v_and_b32 v1, 0xffff0000, v48
    v_and_b32 v37, 0xffff0000, v194
    v_mul_f32 v37, v37, v1
    v_lshlrev_b32 v1, 16, v49
    v_lshlrev_b32 v38, 16, v195
    v_mul_f32 v38, v38, v1
    v_and_b32 v1, 0xffff0000, v49
    v_and_b32 v39, 0xffff0000, v195
    v_mul_f32 v39, v39, v1
    s_mov_b32 s7, 32768
    buffer_store_dwordx4 v[36:39], v21, s[12:15], s7 offen nt
    v_lshlrev_b32 v1, 16, v50
    v_lshlrev_b32 v40, 16, v202
    v_mul_f32 v40, v40, v1
    v_and_b32 v1, 0xffff0000, v50
    v_and_b32 v41, 0xffff0000, v202
    v_mul_f32 v41, v41, v1
    v_lshlrev_b32 v1, 16, v51
    v_lshlrev_b32 v42, 16, v203
    v_mul_f32 v42, v42, v1
    v_and_b32 v1, 0xffff0000, v51
    v_and_b32 v43, 0xffff0000, v203
    v_mul_f32 v43, v43, v1
    s_mov_b32 s7, 163840
    buffer_store_dwordx4 v[40:43], v21, s[12:15], s7 offen nt
    s_waitcnt lgkmcnt(1)
    v_lshlrev_b32 v1, 16, v52
    v_lshlrev_b32 v36, 16, v196
    v_mul_f32 v36, v36, v1
    v_and_b32 v1, 0xffff0000, v52
    v_and_b32 v37, 0xffff0000, v196
    v_mul_f32 v37, v37, v1
    v_lshlrev_b32 v1, 16, v53
    v_lshlrev_b32 v38, 16, v197
    v_mul_f32 v38, v38, v1
    v_and_b32 v1, 0xffff0000, v53
    v_and_b32 v39, 0xffff0000, v197
    v_mul_f32 v39, v39, v1
    s_mov_b32 s7, 65536
    buffer_store_dwordx4 v[36:39], v21, s[12:15], s7 offen nt
    v_lshlrev_b32 v1, 16, v54
    v_lshlrev_b32 v40, 16, v204
    v_mul_f32 v40, v40, v1
    v_and_b32 v1, 0xffff0000, v54
    v_and_b32 v41, 0xffff0000, v204
    v_mul_f32 v41, v41, v1
    v_lshlrev_b32 v1, 16, v55
    v_lshlrev_b32 v42, 16, v205
    v_mul_f32 v42, v42, v1
    v_and_b32 v1, 0xffff0000, v55
    v_and_b32 v43, 0xffff0000, v205
    v_mul_f32 v43, v43, v1
    s_mov_b32 s7, 196608
    buffer_store_dwordx4 v[40:43], v21, s[12:15], s7 offen nt
    s_waitcnt lgkmcnt(0)
    v_lshlrev_b32 v1, 16, v56
    v_lshlrev_b32 v36, 16, v198
    v_mul_f32 v36, v36, v1
    v_and_b32 v1, 0xffff0000, v56
    v_and_b32 v37, 0xffff0000, v198
    v_mul_f32 v37, v37, v1
    v_lshlrev_b32 v1, 16, v57
    v_lshlrev_b32 v38, 16, v199
    v_mul_f32 v38, v38, v1
    v_and_b32 v1, 0xffff0000, v57
    v_and_b32 v39, 0xffff0000, v199
    v_mul_f32 v39, v39, v1
    s_mov_b32 s7, 98304
    buffer_store_dwordx4 v[36:39], v21, s[12:15], s7 offen nt
    v_lshlrev_b32 v1, 16, v58
    v_lshlrev_b32 v40, 16, v206
    v_mul_f32 v40, v40, v1
    v_and_b32 v1, 0xffff0000, v58
    v_and_b32 v41, 0xffff0000, v206
    v_mul_f32 v41, v41, v1
    v_lshlrev_b32 v1, 16, v59
    v_lshlrev_b32 v42, 16, v207
    v_mul_f32 v42, v42, v1
    v_and_b32 v1, 0xffff0000, v59
    v_and_b32 v43, 0xffff0000, v207
    v_mul_f32 v43, v43, v1
    s_mov_b32 s7, 229376
    buffer_store_dwordx4 v[40:43], v21, s[12:15], s7 offen nt
    s_endpgm
K_compute:
    v_and_b32 v12, 15, v2
    v_lshrrev_b32 v13, 4, v2
    s_lshr_b32 s7, s2, 3
    s_and_b32 s76, s7, 15
    s_lshr_b32 s7, s7, 4
    s_and_b32 s77, s2, 7
    s_lshl_b32 s77, s77, 1
    s_add_u32 s77, s77, s7
    s_lshl_b32 s7, s76, 2
    s_add_u32 s7, s7, s5
    s_lshl_b32 s7, s7, 16
    s_lshl_b32 s6, s77, 7
    s_add_u32 s7, s7, s6
    v_lshlrev_b32 v10, 14, v13
    v_lshl_add_u32 v10, v12, 3, v10
    v_add_u32 v10, s7, v10
    v_subrev_u32 v11, 0x1800, v10
    v_bfrev_b32 v9, 1
    v_cmp_gt_i32 vcc, 0, v11
    s_lshl_b32 s7, s77, 9
    v_lshlrev_b32 v15, 5, v12
    v_cndmask_b32 v11, v11, v9, vcc
    v_add_u32 v9, s7, v15
    s_mov_b32 s72, 4096
    s_mov_b32 s73, 8192
    s_mov_b32 s74, 12288
    s_lshl_b32 s6, s4, 2
    s_add_u32 s6, s6, s5
    s_lshl_b32 s6, s6, 4
    v_and_b32 v14, 3, v12
    v_and_b32 v1, 1, v13
    v_lshl_add_u32 v14, v1, 3, v14
    v_lshrrev_b32 v1, 1, v13
    v_lshl_add_u32 v14, v1, 2, v14
    v_add_u32 v14, s6, v14
    v_lshlrev_b32 v44, 1, v14
    s_lshl_b32 s6, s4, 7
    v_lshlrev_b32 v1, 3, v12
    v_add_u32 v1, s6, v1
    s_waitcnt lgkmcnt(0)
    s_mov_b32 s20, s58
    s_mov_b32 s21, s59
    s_mov_b32 s22, 2048
    s_mov_b32 s23, 0x00020000
    s_mov_b32 s24, s46
    s_mov_b32 s25, s47
    s_mov_b32 s26, 2048
    s_mov_b32 s27, 0x00020000
    s_mov_b32 s28, s48
    s_mov_b32 s29, s49
    s_mov_b32 s30, 2048
    s_mov_b32 s31, 0x00020000
    buffer_load_ushort v45, v44, s[20:23], 0 offen
    buffer_load_ushort v46, v44, s[24:27], 0 offen
    buffer_load_ushort v47, v44, s[28:31], 0 offen
    s_mov_b32 s8, s34
    s_mov_b32 s9, s35
    s_mov_b32 s10, 4194304
    s_mov_b32 s11, 0x00020000
    buffer_load_dwordx2 v[146:147], v10, s[8:11], 0 offen offset:0 nt
    buffer_load_dwordx2 v[148:149], v10, s[8:11], 0 offen offset:2048 nt
    buffer_load_dwordx2 v[150:151], v10, s[8:11], s72 offen offset:0 nt
    buffer_load_dwordx2 v[152:153], v10, s[8:11], s72 offen offset:2048 nt
    buffer_load_dwordx2 v[154:155], v10, s[8:11], s73 offen offset:0 nt
    buffer_load_dwordx2 v[156:157], v10, s[8:11], s73 offen offset:2048 nt
    buffer_load_dwordx2 v[158:159], v10, s[8:11], s74 offen offset:0 nt
    buffer_load_dwordx2 v[160:161], v10, s[8:11], s74 offen offset:2048 nt
    buffer_load_dwordx2 v[140:141], v11, s[8:11], 0 offen offset:0 nt
    buffer_load_dwordx2 v[142:143], v11, s[8:11], 0 offen offset:2048 nt
    buffer_load_dwordx2 v[144:145], v11, s[8:11], s72 offen offset:0 nt
    s_mov_b32 s68, s38
    s_mov_b32 s69, s39
    s_mov_b32 s70, 8192
    s_mov_b32 s71, 0x00020000
    buffer_load_dwordx4 v[128:131], v9, s[68:71], 0 offen
    buffer_load_dwordx4 v[132:135], v9, s[68:71], 0 offen offset:16
    s_mov_b32 s12, s36
    s_mov_b32 s13, s37
    s_mov_b32 s14, 4194304
    s_mov_b32 s15, 0x00020000
    buffer_load_dwordx2 v[162:163], v10, s[12:15], 0 offen offset:0 nt
    buffer_load_dwordx2 v[164:165], v10, s[12:15], 0 offen offset:2048 nt
    buffer_load_dwordx2 v[166:167], v10, s[12:15], s72 offen offset:0 nt
    buffer_load_dwordx2 v[168:169], v10, s[12:15], s72 offen offset:2048 nt
    buffer_load_dwordx2 v[170:171], v10, s[12:15], s73 offen offset:0 nt
    buffer_load_dwordx2 v[172:173], v10, s[12:15], s73 offen offset:2048 nt
    buffer_load_dwordx2 v[174:175], v10, s[12:15], s74 offen offset:0 nt
    buffer_load_dwordx2 v[176:177], v10, s[12:15], s74 offen offset:2048 nt
    s_barrier
    s_mov_b32 s80, s60
    s_mov_b32 s81, s61
    s_mov_b32 s82, 2048
    s_mov_b32 s83, 0x00020000
    buffer_load_dwordx2 v[242:243], v1, s[80:83], 0 offen
    s_lshl_b32 s7, s5, 2
    v_add_u32 v15, s7, v13
    v_sub_u32 v15, 15, v15
    v_xor_b32 v15, v15, v12
    v_lshlrev_b32 v15, 4, v15
    v_lshl_add_u32 v15, v12, 10, v15
    v_add_u32 v15, 147456, v15
    v_lshrrev_b32 v3, 1, v12
    v_xor_b32 v3, v3, v13
    v_lshlrev_b32 v3, 4, v3
    v_lshl_add_u32 v4, v12, 7, v3
    v_xor_b32 v6, 64, v4
    v_add_u32 v5, 0x10000, v4
    v_add_u32 v7, 0x10000, v6
    s_lshl_b32 s6, s5, 12
    s_add_u32 s6, s6, 16384
    v_add_u32 v8, s6, v4
    v_add_u32 v9, s6, v5
    v_add_u32 v10, s6, v6
    v_add_u32 v11, s6, v7
    s_mov_b32 s16, s64
    s_mov_b32 s17, s65
    s_mov_b32 s18, 256
    s_mov_b32 s19, 0x00020000
    s_or_b32 s6, s2, s5
    s_cmp_eq_u32 s6, 0
    s_cbranch_scc0 C_nonce_w
    s_memrealtime s[6:7]
    v_mov_b32 v1, 0
    s_waitcnt lgkmcnt(0)
    s_or_b32 s6, s6, 1
    v_mov_b32 v48, s6
    v_mov_b32 v49, s7
    s_mov_b64 exec, 1
    buffer_store_dwordx2 v[48:49], v1, s[16:19], 0 offen sc1
    s_mov_b64 exec, -1
C_nonce_w:
    s_add_u32 s8, s66, 8388608
    s_addc_u32 s9, s67, 0
    s_mov_b32 s10, 8388608
    s_mov_b32 s11, 0x00020000
    s_add_u32 s12, s66, 16777216
    s_addc_u32 s13, s67, 0
    s_mov_b32 s14, 262144
    s_mov_b32 s15, 0x00020000
    s_mov_b32 s68, s66
    s_mov_b32 s69, s67
    s_mov_b32 s70, 4194304
    s_mov_b32 s71, 0x00020000
    s_add_u32 s72, s66, 17825792
    s_addc_u32 s73, s67, 0
    s_mov_b32 s74, 393216
    s_mov_b32 s75, 0x00020000
    s_mov_b32 s76, s62
    s_mov_b32 s77, s63
    s_mov_b32 s78, 16777216
    s_mov_b32 s79, 0x00020000
    s_mov_b32 s24, s54
    s_mov_b32 s25, s55
    s_mov_b32 s26, 2097152
    s_mov_b32 s27, 0x00020000
    s_mov_b32 s80, s56
    s_mov_b32 s81, s57
    s_mov_b32 s82, 2097152
    s_mov_b32 s83, 0x00020000
    s_and_b32 s34, s2, 3
    s_lshl_b32 s34, s34, 2
    s_and_b32 s35, s2, 4
    s_lshl_b32 s35, s35, 1
    s_add_u32 s34, s34, s35
    s_add_u32 s35, s3, s4
    s_and_b32 s35, s35, 1
    s_lshl_b32 s35, s35, 1
    s_add_u32 s34, s34, s35
    s_and_b32 s34, s34, 15
    s_sub_u32 s34, s4, s34
    s_and_b32 s34, s34, 15
    s_lshl_b32 s6, s5, 12
    v_add_u32 v240, s6, v4
    v_xor_b32 v241, 64, v240
    v_mov_b32 v62, 147328
    s_lshr_b32 s7, s2, 3
    s_and_b32 s32, s7, 15
    s_lshr_b32 s7, s7, 4
    s_and_b32 s33, s2, 7
    s_lshl_b32 s33, s33, 1
    s_add_u32 s33, s33, s7
    s_mov_b32 s36, 16384
    s_mov_b32 s37, 32768
    s_mov_b32 s38, 49152
    s_lshl_b32 s6, s5, 2
    v_xor_b32 v1, s6, v12
    v_lshlrev_b32 v1, 4, v1
    v_lshl_add_u32 v1, v13, 8, v1
    s_lshl_b32 s6, s5, 12
    s_add_u32 s6, s6, 147456
    v_add_u32 v244, s6, v1
    v_xor_b32 v245, 16, v244
    v_xor_b32 v246, 32, v244
    v_xor_b32 v247, 48, v244
    s_lshl_b32 s6, s33, 2
    s_add_u32 s6, s6, s5
    s_lshl_b32 s6, s6, 16
    s_lshl_b32 s7, s32, 8
    s_sub_u32 s7, 3840, s7
    s_add_u32 s6, s6, s7
    v_lshlrev_b32 v1, 12, v13
    v_lshl_add_u32 v1, v12, 4, v1
    v_add_u32 v248, s6, v1
    s_lshl_b32 s6, s33, 2
    s_add_u32 s7, s6, s5
    s_lshl_b32 s7, s7, 4
    s_add_u32 s7, s7, s32
    s_lshl_b32 s20, s7, 3
    s_lshr_b32 s7, s32, 2
    s_add_u32 s7, s7, s6
    s_lshl_b32 s21, s7, 7
    s_lshl_b32 s7, s33, 4
    s_add_u32 s7, s7, s32
    s_lshl_b32 s7, s7, 2
    s_add_u32 s7, s7, s5
    s_lshl_b32 s22, s7, 12
    s_lshl_b32 s23, s5, 14
    s_add_u32 s23, s23, 106624
    s_lshl_b32 s6, s3, 14
    v_lshlrev_b32 v1, 4, v14
    v_add_u32 v60, s6, v1
    v_lshrrev_b32 v1, 2, v12
    v_lshlrev_b32 v1, 14, v1
    v_sub_u32 v1, v60, v1
    v_subrev_u32 v56, 0x4000, v1
    v_subrev_u32 v57, 0x14000, v1
    v_subrev_u32 v58, 0x24000, v1
    v_subrev_u32 v59, 0x34000, v1
    v_cmp_gt_i32 s[40:41], 0, v56
    v_cmp_gt_i32 s[42:43], 0, v57
    v_cmp_gt_i32 s[44:45], 0, v58
    v_cmp_gt_i32 s[46:47], 0, v59
    s_lshl_b32 s6, s3, 4
    s_add_u32 s6, s6, s4
    s_lshl_b32 s6, s6, 15
    s_lshl_b32 s7, s5, 10
    s_add_u32 s6, s6, s7
    v_lshlrev_b32 v1, 4, v2
    v_add_u32 v61, s6, v1
    s_lshl_b32 s7, s5, 2
    v_add_u32 v63, s7, v62
    s_mov_b32 s48, 0xaaaaaaaa
    s_mov_b32 s49, 0xaaaaaaaa
    s_mov_b32 s50, 0xcccccccc
    s_mov_b32 s51, 0xcccccccc
    s_mov_b32 s52, 0x000f000f
    s_mov_b32 s53, 0x000f000f
    v_mov_b32 v64, 0
    v_mov_b32 v65, 0
    v_mov_b32 v66, 0
    v_mov_b32 v67, 0
    v_mov_b32 v68, 0
    v_mov_b32 v69, 0
    v_mov_b32 v70, 0
    v_mov_b32 v71, 0
    v_mov_b32 v72, 0
    v_mov_b32 v73, 0
    v_mov_b32 v74, 0
    v_mov_b32 v75, 0
    v_mov_b32 v76, 0
    v_mov_b32 v77, 0
    v_mov_b32 v78, 0
    v_mov_b32 v79, 0
    v_mov_b32 v80, 0
    v_mov_b32 v81, 0
    v_mov_b32 v82, 0
    v_mov_b32 v83, 0
    v_mov_b32 v84, 0
    v_mov_b32 v85, 0
    v_mov_b32 v86, 0
    v_mov_b32 v87, 0
    v_mov_b32 v88, 0
    v_mov_b32 v89, 0
    v_mov_b32 v90, 0
    v_mov_b32 v91, 0
    v_mov_b32 v92, 0
    v_mov_b32 v93, 0
    v_mov_b32 v94, 0
    v_mov_b32 v95, 0
    v_mov_b32 v96, 0
    v_mov_b32 v97, 0
    v_mov_b32 v98, 0
    v_mov_b32 v99, 0
    v_mov_b32 v100, 0
    v_mov_b32 v101, 0
    v_mov_b32 v102, 0
    v_mov_b32 v103, 0
    v_mov_b32 v104, 0
    v_mov_b32 v105, 0
    v_mov_b32 v106, 0
    v_mov_b32 v107, 0
    v_mov_b32 v108, 0
    v_mov_b32 v109, 0
    v_mov_b32 v110, 0
    v_mov_b32 v111, 0
    v_mov_b32 v112, 0
    v_mov_b32 v113, 0
    v_mov_b32 v114, 0
    v_mov_b32 v115, 0
    v_mov_b32 v116, 0
    v_mov_b32 v117, 0
    v_mov_b32 v118, 0
    v_mov_b32 v119, 0
    v_mov_b32 v120, 0
    v_mov_b32 v121, 0
    v_mov_b32 v122, 0
    v_mov_b32 v123, 0
    v_mov_b32 v124, 0
    v_mov_b32 v125, 0
    v_mov_b32 v126, 0
    v_mov_b32 v127, 0
    s_waitcnt vmcnt(22)
    v_lshlrev_b32 v45, 16, v45
    v_lshlrev_b32 v46, 16, v46
    v_lshlrev_b32 v47, 16, v47
    v_mul_f32 v45, 0x3fb8aa3b, v45
    v_exp_f32 v45, v45
    s_nop 0
    v_cvt_pk_bf16_f32 v45, v45, v45
    v_lshlrev_b32 v45, 16, v45
    v_mul_f32 v52, v45, v46
    v_mul_f32 v53, v45, v47
    v_mul_f32 v52, 0x3fb8aa3b, v52
    v_exp_f32 v48, v52
    v_mul_f32 v53, 0.15915494, v53
    v_fract_f32 v53, v53
    v_cos_f32 v50, v53
    v_sin_f32 v51, v53
    s_nop 0
    v_mul_f32 v44, v48, v50
    v_mul_f32 v45, v48, v51
    v_add_f32 v48, -1.0, v44
    v_mul_f32 v49, v46, v46
    v_fmac_f32 v49, v47, v47
    v_rcp_f32 v49, v49
    v_mul_f32 v50, v48, v46
    v_fmac_f32 v50, v45, v47
    v_mul_f32 v51, v45, v46
    v_fma_f32 v51, -v48, v47, v51
    v_add_f32 v49, v49, v49
    v_mul_f32 v46, v50, v49
    v_mul_f32 v47, v51, v49
    v_lshlrev_b32 v54, 3, v12
    v_cvt_f32_u32 v54, v54
    v_lshrrev_b32 v55, 2, v12
    v_lshlrev_b32 v55, 7, v55
    v_cvt_f32_u32 v55, v55
    v_mov_b32_dpp v16, v44 quad_perm:[0,0,0,0] row_mask:0xf bank_mask:0xf
    v_mov_b32_dpp v20, v45 quad_perm:[0,0,0,0] row_mask:0xf bank_mask:0xf
    v_mov_b32_dpp v24, v46 quad_perm:[0,0,0,0] row_mask:0xf bank_mask:0xf
    v_mov_b32_dpp v28, v47 quad_perm:[0,0,0,0] row_mask:0xf bank_mask:0xf
    v_mov_b32_dpp v17, v44 quad_perm:[1,1,1,1] row_mask:0xf bank_mask:0xf
    v_mov_b32_dpp v21, v45 quad_perm:[1,1,1,1] row_mask:0xf bank_mask:0xf
    v_mov_b32_dpp v25, v46 quad_perm:[1,1,1,1] row_mask:0xf bank_mask:0xf
    v_mov_b32_dpp v29, v47 quad_perm:[1,1,1,1] row_mask:0xf bank_mask:0xf
    v_mov_b32_dpp v18, v44 quad_perm:[2,2,2,2] row_mask:0xf bank_mask:0xf
    v_mov_b32_dpp v22, v45 quad_perm:[2,2,2,2] row_mask:0xf bank_mask:0xf
    v_mov_b32_dpp v26, v46 quad_perm:[2,2,2,2] row_mask:0xf bank_mask:0xf
    v_mov_b32_dpp v30, v47 quad_perm:[2,2,2,2] row_mask:0xf bank_mask:0xf
    v_mov_b32_dpp v19, v44 quad_perm:[3,3,3,3] row_mask:0xf bank_mask:0xf
    v_mov_b32_dpp v23, v45 quad_perm:[3,3,3,3] row_mask:0xf bank_mask:0xf
    v_mov_b32_dpp v27, v46 quad_perm:[3,3,3,3] row_mask:0xf bank_mask:0xf
    v_mov_b32_dpp v31, v47 quad_perm:[3,3,3,3] row_mask:0xf bank_mask:0xf
    v_mul_f32_dpp v48, v52, v54 quad_perm:[0,0,0,0] row_mask:0xf bank_mask:0xf
    v_mul_f32_dpp v49, v53, v54 quad_perm:[0,0,0,0] row_mask:0xf bank_mask:0xf
    v_exp_f32 v48, v48
    v_fract_f32 v49, v49
    v_cos_f32 v50, v49
    v_sin_f32 v51, v49
    s_nop 0
    v_mul_f32 v32, v48, v50
    v_mul_f32 v36, v48, v51
    v_mul_f32_dpp v48, v52, v54 quad_perm:[1,1,1,1] row_mask:0xf bank_mask:0xf
    v_mul_f32_dpp v49, v53, v54 quad_perm:[1,1,1,1] row_mask:0xf bank_mask:0xf
    v_exp_f32 v48, v48
    v_fract_f32 v49, v49
    v_cos_f32 v50, v49
    v_sin_f32 v51, v49
    s_nop 0
    v_mul_f32 v33, v48, v50
    v_mul_f32 v37, v48, v51
    v_mul_f32_dpp v48, v52, v54 quad_perm:[2,2,2,2] row_mask:0xf bank_mask:0xf
    v_mul_f32_dpp v49, v53, v54 quad_perm:[2,2,2,2] row_mask:0xf bank_mask:0xf
    v_exp_f32 v48, v48
    v_fract_f32 v49, v49
    v_cos_f32 v50, v49
    v_sin_f32 v51, v49
    s_nop 0
    v_mul_f32 v34, v48, v50
    v_mul_f32 v38, v48, v51
    v_mul_f32_dpp v48, v52, v54 quad_perm:[3,3,3,3] row_mask:0xf bank_mask:0xf
    v_mul_f32_dpp v49, v53, v54 quad_perm:[3,3,3,3] row_mask:0xf bank_mask:0xf
    v_exp_f32 v48, v48
    v_fract_f32 v49, v49
    v_cos_f32 v50, v49
    v_sin_f32 v51, v49
    s_nop 0
    v_mul_f32 v35, v48, v50
    v_mul_f32 v39, v48, v51
    v_mul_f32 v48, v52, v55
    v_mul_f32 v49, v53, v55
    v_exp_f32 v48, v48
    v_fract_f32 v49, v49
    v_cos_f32 v50, v49
    v_sin_f32 v51, v49
    s_nop 0
    v_mul_f32 v40, v48, v50
    v_mul_f32 v41, v48, v51
    v_mul_f32 v48, 0x44000000, v52
    v_mul_f32 v49, 0x44000000, v53
    v_exp_f32 v48, v48
    v_fract_f32 v49, v49
    v_cos_f32 v50, v49
    v_sin_f32 v51, v49
    s_nop 0
    v_mul_f32 v42, v48, v50
    v_mul_f32 v43, v48, v51
    s_waitcnt vmcnt(9)
    v_lshlrev_b32 v136, 16, v128
    v_and_b32 v137, 0xffff0000, v128
    v_lshlrev_b32 v138, 16, v129
    v_and_b32 v139, 0xffff0000, v129
    v_lshlrev_b32 v178, 16, v140
    v_lshlrev_b32 v179, 16, v142
    v_lshlrev_b32 v180, 16, v144
    v_lshlrev_b32 v181, 16, v146
    v_lshlrev_b32 v182, 16, v148
    v_lshlrev_b32 v183, 16, v150
    v_lshlrev_b32 v184, 16, v152
    v_lshlrev_b32 v185, 16, v154
    v_lshlrev_b32 v186, 16, v156
    v_lshlrev_b32 v187, 16, v158
    v_lshlrev_b32 v188, 16, v160
    v_mul_f32 v190, v136, v181
    v_mul_f32 v191, v136, v182
    v_mul_f32 v192, v136, v183
    v_mul_f32 v193, v136, v184
    v_mul_f32 v194, v136, v185
    v_mul_f32 v195, v136, v186
    v_mul_f32 v196, v136, v187
    v_mul_f32 v197, v136, v188
    v_fmac_f32 v190, v137, v180
    v_fmac_f32 v191, v137, v181
    v_fmac_f32 v192, v137, v182
    v_fmac_f32 v193, v137, v183
    v_fmac_f32 v194, v137, v184
    v_fmac_f32 v195, v137, v185
    v_fmac_f32 v196, v137, v186
    v_fmac_f32 v197, v137, v187
    v_fmac_f32 v190, v138, v179
    v_fmac_f32 v191, v138, v180
    v_fmac_f32 v192, v138, v181
    v_fmac_f32 v193, v138, v182
    v_fmac_f32 v194, v138, v183
    v_fmac_f32 v195, v138, v184
    v_fmac_f32 v196, v138, v185
    v_fmac_f32 v197, v138, v186
    v_fmac_f32 v190, v139, v178
    v_fmac_f32 v191, v139, v179
    v_fmac_f32 v192, v139, v180
    v_fmac_f32 v193, v139, v181
    v_fmac_f32 v194, v139, v182
    v_fmac_f32 v195, v139, v183
    v_fmac_f32 v196, v139, v184
    v_fmac_f32 v197, v139, v185
    v_lshlrev_b32 v136, 16, v130
    v_and_b32 v137, 0xffff0000, v130
    v_lshlrev_b32 v138, 16, v131
    v_and_b32 v139, 0xffff0000, v131
    v_and_b32 v178, 0xffff0000, v140
    v_and_b32 v179, 0xffff0000, v142
    v_and_b32 v180, 0xffff0000, v144
    v_and_b32 v181, 0xffff0000, v146
    v_and_b32 v182, 0xffff0000, v148
    v_and_b32 v183, 0xffff0000, v150
    v_and_b32 v184, 0xffff0000, v152
    v_and_b32 v185, 0xffff0000, v154
    v_and_b32 v186, 0xffff0000, v156
    v_and_b32 v187, 0xffff0000, v158
    v_and_b32 v188, 0xffff0000, v160
    v_mul_f32 v198, v136, v181
    v_mul_f32 v199, v136, v182
    v_mul_f32 v200, v136, v183
    v_mul_f32 v201, v136, v184
    v_mul_f32 v202, v136, v185
    v_mul_f32 v203, v136, v186
    v_mul_f32 v204, v136, v187
    v_mul_f32 v205, v136, v188
    v_fmac_f32 v198, v137, v180
    v_fmac_f32 v199, v137, v181
    v_fmac_f32 v200, v137, v182
    v_fmac_f32 v201, v137, v183
    v_fmac_f32 v202, v137, v184
    v_fmac_f32 v203, v137, v185
    v_fmac_f32 v204, v137, v186
    v_fmac_f32 v205, v137, v187
    v_fmac_f32 v198, v138, v179
    v_fmac_f32 v199, v138, v180
    v_fmac_f32 v200, v138, v181
    v_fmac_f32 v201, v138, v182
    v_fmac_f32 v202, v138, v183
    v_fmac_f32 v203, v138, v184
    v_fmac_f32 v204, v138, v185
    v_fmac_f32 v205, v138, v186
    v_fmac_f32 v198, v139, v178
    v_fmac_f32 v199, v139, v179
    v_fmac_f32 v200, v139, v180
    v_fmac_f32 v201, v139, v181
    v_fmac_f32 v202, v139, v182
    v_fmac_f32 v203, v139, v183
    v_fmac_f32 v204, v139, v184
    v_fmac_f32 v205, v139, v185
    v_lshlrev_b32 v136, 16, v132
    v_and_b32 v137, 0xffff0000, v132
    v_lshlrev_b32 v138, 16, v133
    v_and_b32 v139, 0xffff0000, v133
    v_lshlrev_b32 v178, 16, v141
    v_lshlrev_b32 v179, 16, v143
    v_lshlrev_b32 v180, 16, v145
    v_lshlrev_b32 v181, 16, v147
    v_lshlrev_b32 v182, 16, v149
    v_lshlrev_b32 v183, 16, v151
    v_lshlrev_b32 v184, 16, v153
    v_lshlrev_b32 v185, 16, v155
    v_lshlrev_b32 v186, 16, v157
    v_lshlrev_b32 v187, 16, v159
    v_lshlrev_b32 v188, 16, v161
    v_mul_f32 v206, v136, v181
    v_mul_f32 v207, v136, v182
    v_mul_f32 v208, v136, v183
    v_mul_f32 v209, v136, v184
    v_mul_f32 v210, v136, v185
    v_mul_f32 v211, v136, v186
    v_mul_f32 v212, v136, v187
    v_mul_f32 v213, v136, v188
    v_fmac_f32 v206, v137, v180
    v_fmac_f32 v207, v137, v181
    v_fmac_f32 v208, v137, v182
    v_fmac_f32 v209, v137, v183
    v_fmac_f32 v210, v137, v184
    v_fmac_f32 v211, v137, v185
    v_fmac_f32 v212, v137, v186
    v_fmac_f32 v213, v137, v187
    v_fmac_f32 v206, v138, v179
    v_fmac_f32 v207, v138, v180
    v_fmac_f32 v208, v138, v181
    v_fmac_f32 v209, v138, v182
    v_fmac_f32 v210, v138, v183
    v_fmac_f32 v211, v138, v184
    v_fmac_f32 v212, v138, v185
    v_fmac_f32 v213, v138, v186
    v_fmac_f32 v206, v139, v178
    v_fmac_f32 v207, v139, v179
    v_fmac_f32 v208, v139, v180
    v_fmac_f32 v209, v139, v181
    v_fmac_f32 v210, v139, v182
    v_fmac_f32 v211, v139, v183
    v_fmac_f32 v212, v139, v184
    v_fmac_f32 v213, v139, v185
    v_lshlrev_b32 v136, 16, v134
    v_and_b32 v137, 0xffff0000, v134
    v_lshlrev_b32 v138, 16, v135
    v_and_b32 v139, 0xffff0000, v135
    v_and_b32 v178, 0xffff0000, v141
    v_and_b32 v179, 0xffff0000, v143
    v_and_b32 v180, 0xffff0000, v145
    v_and_b32 v181, 0xffff0000, v147
    v_and_b32 v182, 0xffff0000, v149
    v_and_b32 v183, 0xffff0000, v151
    v_and_b32 v184, 0xffff0000, v153
    v_and_b32 v185, 0xffff0000, v155
    v_and_b32 v186, 0xffff0000, v157
    v_and_b32 v187, 0xffff0000, v159
    v_and_b32 v188, 0xffff0000, v161
    v_mul_f32 v214, v136, v181
    v_mul_f32 v215, v136, v182
    v_mul_f32 v216, v136, v183
    v_mul_f32 v217, v136, v184
    v_mul_f32 v218, v136, v185
    v_mul_f32 v219, v136, v186
    v_mul_f32 v220, v136, v187
    v_mul_f32 v221, v136, v188
    v_fmac_f32 v214, v137, v180
    v_fmac_f32 v215, v137, v181
    v_fmac_f32 v216, v137, v182
    v_fmac_f32 v217, v137, v183
    v_fmac_f32 v218, v137, v184
    v_fmac_f32 v219, v137, v185
    v_fmac_f32 v220, v137, v186
    v_fmac_f32 v221, v137, v187
    v_fmac_f32 v214, v138, v179
    v_fmac_f32 v215, v138, v180
    v_fmac_f32 v216, v138, v181
    v_fmac_f32 v217, v138, v182
    v_fmac_f32 v218, v138, v183
    v_fmac_f32 v219, v138, v184
    v_fmac_f32 v220, v138, v185
    v_fmac_f32 v221, v138, v186
    v_fmac_f32 v214, v139, v178
    v_fmac_f32 v215, v139, v179
    v_fmac_f32 v216, v139, v180
    v_fmac_f32 v217, v139, v181
    v_fmac_f32 v218, v139, v182
    v_fmac_f32 v219, v139, v183
    v_fmac_f32 v220, v139, v184
    v_fmac_f32 v221, v139, v185
    s_waitcnt vmcnt(1)
    v_lshlrev_b32 v178, 16, v162
    v_lshlrev_b32 v179, 16, v164
    v_lshlrev_b32 v180, 16, v166
    v_lshlrev_b32 v181, 16, v168
    v_lshlrev_b32 v182, 16, v170
    v_lshlrev_b32 v183, 16, v172
    v_lshlrev_b32 v184, 16, v174
    v_lshlrev_b32 v185, 16, v176
    v_mul_f32 v190, v190, v178
    v_mul_f32 v191, v191, v179
    v_mul_f32 v192, v192, v180
    v_mul_f32 v193, v193, v181
    v_mul_f32 v194, v194, v182
    v_mul_f32 v195, v195, v183
    v_mul_f32 v196, v196, v184
    v_mul_f32 v197, v197, v185
    v_cvt_pk_bf16_f32 v224, v197, v196
    v_cvt_pk_bf16_f32 v225, v195, v194
    v_cvt_pk_bf16_f32 v226, v193, v192
    v_cvt_pk_bf16_f32 v227, v191, v190
    ds_write_b128 v15, v[224:227] offset:0
    v_and_b32 v178, 0xffff0000, v162
    v_and_b32 v179, 0xffff0000, v164
    v_and_b32 v180, 0xffff0000, v166
    v_and_b32 v181, 0xffff0000, v168
    v_and_b32 v182, 0xffff0000, v170
    v_and_b32 v183, 0xffff0000, v172
    v_and_b32 v184, 0xffff0000, v174
    v_and_b32 v185, 0xffff0000, v176
    v_mul_f32 v198, v198, v178
    v_mul_f32 v199, v199, v179
    v_mul_f32 v200, v200, v180
    v_mul_f32 v201, v201, v181
    v_mul_f32 v202, v202, v182
    v_mul_f32 v203, v203, v183
    v_mul_f32 v204, v204, v184
    v_mul_f32 v205, v205, v185
    v_cvt_pk_bf16_f32 v228, v205, v204
    v_cvt_pk_bf16_f32 v229, v203, v202
    v_cvt_pk_bf16_f32 v230, v201, v200
    v_cvt_pk_bf16_f32 v231, v199, v198
    ds_write_b128 v15, v[228:231] offset:256
    v_lshlrev_b32 v178, 16, v163
    v_lshlrev_b32 v179, 16, v165
    v_lshlrev_b32 v180, 16, v167
    v_lshlrev_b32 v181, 16, v169
    v_lshlrev_b32 v182, 16, v171
    v_lshlrev_b32 v183, 16, v173
    v_lshlrev_b32 v184, 16, v175
    v_lshlrev_b32 v185, 16, v177
    v_mul_f32 v206, v206, v178
    v_mul_f32 v207, v207, v179
    v_mul_f32 v208, v208, v180
    v_mul_f32 v209, v209, v181
    v_mul_f32 v210, v210, v182
    v_mul_f32 v211, v211, v183
    v_mul_f32 v212, v212, v184
    v_mul_f32 v213, v213, v185
    v_cvt_pk_bf16_f32 v232, v213, v212
    v_cvt_pk_bf16_f32 v233, v211, v210
    v_cvt_pk_bf16_f32 v234, v209, v208
    v_cvt_pk_bf16_f32 v235, v207, v206
    ds_write_b128 v15, v[232:235] offset:512
    v_and_b32 v178, 0xffff0000, v163
    v_and_b32 v179, 0xffff0000, v165
    v_and_b32 v180, 0xffff0000, v167
    v_and_b32 v181, 0xffff0000, v169
    v_and_b32 v182, 0xffff0000, v171
    v_and_b32 v183, 0xffff0000, v173
    v_and_b32 v184, 0xffff0000, v175
    v_and_b32 v185, 0xffff0000, v177
    v_mul_f32 v214, v214, v178
    v_mul_f32 v215, v215, v179
    v_mul_f32 v216, v216, v180
    v_mul_f32 v217, v217, v181
    v_mul_f32 v218, v218, v182
    v_mul_f32 v219, v219, v183
    v_mul_f32 v220, v220, v184
    v_mul_f32 v221, v221, v185
    v_cvt_pk_bf16_f32 v236, v221, v220
    v_cvt_pk_bf16_f32 v237, v219, v218
    v_cvt_pk_bf16_f32 v238, v217, v216
    v_cvt_pk_bf16_f32 v239, v215, v214
    ds_write_b128 v15, v[236:239] offset:768
    s_waitcnt lgkmcnt(0)
    s_barrier
    ds_read_b128 v[160:163], v9 offset:32768
    ds_read_b128 v[164:167], v9 offset:34816
    ds_read_b128 v[128:131], v5 offset:32768
    ds_read_b128 v[132:135], v5 offset:34816
    ds_read_b128 v[136:139], v5 offset:36864
    ds_read_b128 v[140:143], v5 offset:38912
    ds_read_b128 v[144:147], v5 offset:40960
    ds_read_b128 v[148:151], v5 offset:43008
    ds_read_b128 v[152:155], v5 offset:45056
    ds_read_b128 v[156:159], v5 offset:47104
    s_setprio 3
    ds_read_b128 v[224:227], v244 offset:0
    ds_read_b128 v[228:231], v245 offset:1024
    ds_read_b128 v[232:235], v246 offset:2048
    ds_read_b128 v[236:239], v247 offset:3072
    s_cmp_eq_u32 s34, 0
    s_waitcnt lgkmcnt(0)
    s_cbranch_scc1 C_x0
C_x0_r:
    buffer_store_dwordx4 v[224:227], v248, s[68:71], 0 offen sc1
    buffer_store_dwordx4 v[228:231], v248, s[68:71], s36 offen sc1
    buffer_store_dwordx4 v[232:235], v248, s[68:71], s37 offen sc1
    buffer_store_dwordx4 v[236:239], v248, s[68:71], s38 offen sc1
    buffer_load_dwordx2 v[54:55], off, s[16:19], 0 sc1
    v_lshlrev_b32 v246, 3, v12
    v_lshlrev_b32 v247, 4, v2
    v_mfma_f32_16x16x32_bf16 v[64:67], v[160:163], v[128:131], v[64:67]
    ds_read_b128 v[200:203], v11 offset:32768
    v_mfma_f32_16x16x32_bf16 v[68:71], v[164:167], v[128:131], v[68:71]
    ds_read_b128 v[204:207], v11 offset:34816
    v_mfma_f32_16x16x32_bf16 v[76:79], v[164:167], v[132:135], v[76:79]
    ds_read_b128 v[168:171], v7 offset:32768
    v_mfma_f32_16x16x32_bf16 v[72:75], v[160:163], v[132:135], v[72:75]
    ds_read_b128 v[172:175], v7 offset:34816
    v_mfma_f32_16x16x32_bf16 v[80:83], v[160:163], v[136:139], v[80:83]
    ds_read_b128 v[176:179], v7 offset:36864
    v_mfma_f32_16x16x32_bf16 v[84:87], v[164:167], v[136:139], v[84:87]
    ds_read_b128 v[180:183], v7 offset:38912
    v_mfma_f32_16x16x32_bf16 v[92:95], v[164:167], v[140:143], v[92:95]
    ds_read_b128 v[184:187], v7 offset:40960
    v_mfma_f32_16x16x32_bf16 v[88:91], v[160:163], v[140:143], v[88:91]
    ds_read_b128 v[188:191], v7 offset:43008
    v_mfma_f32_16x16x32_bf16 v[96:99], v[160:163], v[144:147], v[96:99]
    ds_read_b128 v[192:195], v7 offset:45056
    v_mfma_f32_16x16x32_bf16 v[100:103], v[164:167], v[144:147], v[100:103]
    ds_read_b128 v[196:199], v7 offset:47104
    v_mfma_f32_16x16x32_bf16 v[108:111], v[164:167], v[148:151], v[108:111]
    v_mfma_f32_16x16x32_bf16 v[104:107], v[160:163], v[148:151], v[104:107]
    v_mfma_f32_16x16x32_bf16 v[112:115], v[160:163], v[152:155], v[112:115]
    v_mfma_f32_16x16x32_bf16 v[116:119], v[164:167], v[152:155], v[116:119]
    v_mfma_f32_16x16x32_bf16 v[124:127], v[164:167], v[156:159], v[124:127]
    v_mfma_f32_16x16x32_bf16 v[120:123], v[160:163], v[156:159], v[120:123]
    s_waitcnt lgkmcnt(0)
    s_barrier
    v_mfma_f32_16x16x32_bf16 v[64:67], v[200:203], v[168:171], v[64:67]
    ds_read_b128 v[160:163], v8 offset:0
    v_mfma_f32_16x16x32_bf16 v[68:71], v[204:207], v[168:171], v[68:71]
    ds_read_b128 v[164:167], v8 offset:2048
    v_mfma_f32_16x16x32_bf16 v[76:79], v[204:207], v[172:175], v[76:79]
    ds_read_b128 v[128:131], v4 offset:0
    v_mfma_f32_16x16x32_bf16 v[72:75], v[200:203], v[172:175], v[72:75]
    ds_read_b128 v[132:135], v4 offset:2048
    v_mfma_f32_16x16x32_bf16 v[80:83], v[200:203], v[176:179], v[80:83]
    ds_read_b128 v[136:139], v4 offset:4096
    v_mfma_f32_16x16x32_bf16 v[84:87], v[204:207], v[176:179], v[84:87]
    ds_read_b128 v[140:143], v4 offset:6144
    v_mfma_f32_16x16x32_bf16 v[92:95], v[204:207], v[180:183], v[92:95]
    ds_read_b128 v[144:147], v4 offset:8192
    v_mfma_f32_16x16x32_bf16 v[88:91], v[200:203], v[180:183], v[88:91]
    ds_read_b128 v[148:151], v4 offset:10240
    v_mfma_f32_16x16x32_bf16 v[96:99], v[200:203], v[184:187], v[96:99]
    ds_read_b128 v[152:155], v4 offset:12288
    v_mfma_f32_16x16x32_bf16 v[100:103], v[204:207], v[184:187], v[100:103]
    ds_read_b128 v[156:159], v4 offset:14336
    v_mfma_f32_16x16x32_bf16 v[108:111], v[204:207], v[188:191], v[108:111]
    v_mfma_f32_16x16x32_bf16 v[104:107], v[200:203], v[188:191], v[104:107]
    v_mfma_f32_16x16x32_bf16 v[112:115], v[200:203], v[192:195], v[112:115]
    v_mfma_f32_16x16x32_bf16 v[116:119], v[204:207], v[192:195], v[116:119]
    v_mfma_f32_16x16x32_bf16 v[124:127], v[204:207], v[196:199], v[124:127]
    v_mfma_f32_16x16x32_bf16 v[120:123], v[200:203], v[196:199], v[120:123]
    s_cmp_eq_u32 s34, 1
    s_waitcnt lgkmcnt(0)
    s_cbranch_scc1 C_x1
C_x1_r:
    v_mfma_f32_16x16x32_bf16 v[64:67], v[160:163], v[128:131], v[64:67]
    ds_read_b128 v[200:203], v10 offset:0
    v_mfma_f32_16x16x32_bf16 v[68:71], v[164:167], v[128:131], v[68:71]
    ds_read_b128 v[204:207], v10 offset:2048
    v_mfma_f32_16x16x32_bf16 v[76:79], v[164:167], v[132:135], v[76:79]
    ds_read_b128 v[168:171], v6 offset:0
    v_mfma_f32_16x16x32_bf16 v[72:75], v[160:163], v[132:135], v[72:75]
    ds_read_b128 v[172:175], v6 offset:2048
    v_mfma_f32_16x16x32_bf16 v[80:83], v[160:163], v[136:139], v[80:83]
    ds_read_b128 v[176:179], v6 offset:4096
    v_mfma_f32_16x16x32_bf16 v[84:87], v[164:167], v[136:139], v[84:87]
    ds_read_b128 v[180:183], v6 offset:6144
    v_mfma_f32_16x16x32_bf16 v[92:95], v[164:167], v[140:143], v[92:95]
    ds_read_b128 v[184:187], v6 offset:8192
    v_mfma_f32_16x16x32_bf16 v[88:91], v[160:163], v[140:143], v[88:91]
    ds_read_b128 v[188:191], v6 offset:10240
    v_mfma_f32_16x16x32_bf16 v[96:99], v[160:163], v[144:147], v[96:99]
    ds_read_b128 v[192:195], v6 offset:12288
    v_mfma_f32_16x16x32_bf16 v[100:103], v[164:167], v[144:147], v[100:103]
    ds_read_b128 v[196:199], v6 offset:14336
    v_mfma_f32_16x16x32_bf16 v[108:111], v[164:167], v[148:151], v[108:111]
    v_mfma_f32_16x16x32_bf16 v[104:107], v[160:163], v[148:151], v[104:107]
    v_mfma_f32_16x16x32_bf16 v[112:115], v[160:163], v[152:155], v[112:115]
    v_mfma_f32_16x16x32_bf16 v[116:119], v[164:167], v[152:155], v[116:119]
    v_mfma_f32_16x16x32_bf16 v[124:127], v[164:167], v[156:159], v[124:127]
    v_mfma_f32_16x16x32_bf16 v[120:123], v[160:163], v[156:159], v[120:123]
    s_waitcnt lgkmcnt(0)
    s_barrier
    v_mfma_f32_16x16x32_bf16 v[64:67], v[200:203], v[168:171], v[64:67]
    ds_read_b128 v[160:163], v8 offset:32768
    v_mfma_f32_16x16x32_bf16 v[68:71], v[204:207], v[168:171], v[68:71]
    ds_read_b128 v[164:167], v8 offset:34816
    v_mfma_f32_16x16x32_bf16 v[76:79], v[204:207], v[172:175], v[76:79]
    ds_read_b128 v[128:131], v4 offset:32768
    v_mfma_f32_16x16x32_bf16 v[72:75], v[200:203], v[172:175], v[72:75]
    ds_read_b128 v[132:135], v4 offset:34816
    v_mfma_f32_16x16x32_bf16 v[80:83], v[200:203], v[176:179], v[80:83]
    ds_read_b128 v[136:139], v4 offset:36864
    v_mfma_f32_16x16x32_bf16 v[84:87], v[204:207], v[176:179], v[84:87]
    ds_read_b128 v[140:143], v4 offset:38912
    v_mfma_f32_16x16x32_bf16 v[92:95], v[204:207], v[180:183], v[92:95]
    ds_read_b128 v[144:147], v4 offset:40960
    v_mfma_f32_16x16x32_bf16 v[88:91], v[200:203], v[180:183], v[88:91]
    ds_read_b128 v[148:151], v4 offset:43008
    v_mfma_f32_16x16x32_bf16 v[96:99], v[200:203], v[184:187], v[96:99]
    ds_read_b128 v[152:155], v4 offset:45056
    v_mfma_f32_16x16x32_bf16 v[100:103], v[204:207], v[184:187], v[100:103]
    ds_read_b128 v[156:159], v4 offset:47104
    v_mfma_f32_16x16x32_bf16 v[108:111], v[204:207], v[188:191], v[108:111]
    v_mfma_f32_16x16x32_bf16 v[104:107], v[200:203], v[188:191], v[104:107]
    v_mfma_f32_16x16x32_bf16 v[112:115], v[200:203], v[192:195], v[112:115]
    v_mfma_f32_16x16x32_bf16 v[116:119], v[204:207], v[192:195], v[116:119]
    v_mfma_f32_16x16x32_bf16 v[124:127], v[204:207], v[196:199], v[124:127]
    v_mfma_f32_16x16x32_bf16 v[120:123], v[200:203], v[196:199], v[120:123]
    s_cmp_eq_u32 s34, 2
    s_waitcnt lgkmcnt(0)
    s_cbranch_scc1 C_x2
C_x2_r:
    v_mfma_f32_16x16x32_bf16 v[64:67], v[160:163], v[128:131], v[64:67]
    ds_read_b128 v[200:203], v10 offset:32768
    v_mfma_f32_16x16x32_bf16 v[68:71], v[164:167], v[128:131], v[68:71]
    ds_read_b128 v[204:207], v10 offset:34816
    v_mfma_f32_16x16x32_bf16 v[76:79], v[164:167], v[132:135], v[76:79]
    ds_read_b128 v[168:171], v6 offset:32768
    v_mfma_f32_16x16x32_bf16 v[72:75], v[160:163], v[132:135], v[72:75]
    ds_read_b128 v[172:175], v6 offset:34816
    v_mfma_f32_16x16x32_bf16 v[80:83], v[160:163], v[136:139], v[80:83]
    ds_read_b128 v[176:179], v6 offset:36864
    v_mfma_f32_16x16x32_bf16 v[84:87], v[164:167], v[136:139], v[84:87]
    ds_read_b128 v[180:183], v6 offset:38912
    v_mfma_f32_16x16x32_bf16 v[92:95], v[164:167], v[140:143], v[92:95]
    ds_read_b128 v[184:187], v6 offset:40960
    v_mfma_f32_16x16x32_bf16 v[88:91], v[160:163], v[140:143], v[88:91]
    ds_read_b128 v[188:191], v6 offset:43008
    v_mfma_f32_16x16x32_bf16 v[96:99], v[160:163], v[144:147], v[96:99]
    ds_read_b128 v[192:195], v6 offset:45056
    v_mfma_f32_16x16x32_bf16 v[100:103], v[164:167], v[144:147], v[100:103]
    ds_read_b128 v[196:199], v6 offset:47104
    v_mfma_f32_16x16x32_bf16 v[108:111], v[164:167], v[148:151], v[108:111]
    v_mfma_f32_16x16x32_bf16 v[104:107], v[160:163], v[148:151], v[104:107]
    v_mfma_f32_16x16x32_bf16 v[112:115], v[160:163], v[152:155], v[112:115]
    v_mfma_f32_16x16x32_bf16 v[116:119], v[164:167], v[152:155], v[116:119]
    v_mfma_f32_16x16x32_bf16 v[124:127], v[164:167], v[156:159], v[124:127]
    v_mfma_f32_16x16x32_bf16 v[120:123], v[160:163], v[156:159], v[120:123]
    s_waitcnt lgkmcnt(0)
    s_barrier
    v_mfma_f32_16x16x32_bf16 v[64:67], v[200:203], v[168:171], v[64:67]
    ds_read_b128 v[160:163], v9 offset:0
    v_mfma_f32_16x16x32_bf16 v[68:71], v[204:207], v[168:171], v[68:71]
    ds_read_b128 v[164:167], v9 offset:2048
    v_mfma_f32_16x16x32_bf16 v[76:79], v[204:207], v[172:175], v[76:79]
    ds_read_b128 v[128:131], v5 offset:0
    v_mfma_f32_16x16x32_bf16 v[72:75], v[200:203], v[172:175], v[72:75]
    ds_read_b128 v[132:135], v5 offset:2048
    v_mfma_f32_16x16x32_bf16 v[80:83], v[200:203], v[176:179], v[80:83]
    ds_read_b128 v[136:139], v5 offset:4096
    v_mfma_f32_16x16x32_bf16 v[84:87], v[204:207], v[176:179], v[84:87]
    ds_read_b128 v[140:143], v5 offset:6144
    v_mfma_f32_16x16x32_bf16 v[92:95], v[204:207], v[180:183], v[92:95]
    ds_read_b128 v[144:147], v5 offset:8192
    v_mfma_f32_16x16x32_bf16 v[88:91], v[200:203], v[180:183], v[88:91]
    ds_read_b128 v[148:151], v5 offset:10240
    v_mfma_f32_16x16x32_bf16 v[96:99], v[200:203], v[184:187], v[96:99]
    ds_read_b128 v[152:155], v5 offset:12288
    v_mfma_f32_16x16x32_bf16 v[100:103], v[204:207], v[184:187], v[100:103]
    ds_read_b128 v[156:159], v5 offset:14336
    v_mfma_f32_16x16x32_bf16 v[108:111], v[204:207], v[188:191], v[108:111]
    v_mfma_f32_16x16x32_bf16 v[104:107], v[200:203], v[188:191], v[104:107]
    v_mfma_f32_16x16x32_bf16 v[112:115], v[200:203], v[192:195], v[112:115]
    v_mfma_f32_16x16x32_bf16 v[116:119], v[204:207], v[192:195], v[116:119]
    v_mfma_f32_16x16x32_bf16 v[124:127], v[204:207], v[196:199], v[124:127]
    v_mfma_f32_16x16x32_bf16 v[120:123], v[200:203], v[196:199], v[120:123]
    s_cmp_eq_u32 s34, 3
    s_waitcnt lgkmcnt(0)
    s_cbranch_scc1 C_x3
C_x3_r:
    v_mfma_f32_16x16x32_bf16 v[64:67], v[160:163], v[128:131], v[64:67]
    ds_read_b128 v[200:203], v11 offset:0
    v_mfma_f32_16x16x32_bf16 v[68:71], v[164:167], v[128:131], v[68:71]
    ds_read_b128 v[204:207], v11 offset:2048
    v_mfma_f32_16x16x32_bf16 v[76:79], v[164:167], v[132:135], v[76:79]
    ds_read_b128 v[168:171], v7 offset:0
    v_mfma_f32_16x16x32_bf16 v[72:75], v[160:163], v[132:135], v[72:75]
    ds_read_b128 v[172:175], v7 offset:2048
    v_mfma_f32_16x16x32_bf16 v[80:83], v[160:163], v[136:139], v[80:83]
    ds_read_b128 v[176:179], v7 offset:4096
    v_mfma_f32_16x16x32_bf16 v[84:87], v[164:167], v[136:139], v[84:87]
    ds_read_b128 v[180:183], v7 offset:6144
    v_mfma_f32_16x16x32_bf16 v[92:95], v[164:167], v[140:143], v[92:95]
    ds_read_b128 v[184:187], v7 offset:8192
    v_mfma_f32_16x16x32_bf16 v[88:91], v[160:163], v[140:143], v[88:91]
    ds_read_b128 v[188:191], v7 offset:10240
    v_mfma_f32_16x16x32_bf16 v[96:99], v[160:163], v[144:147], v[96:99]
    ds_read_b128 v[192:195], v7 offset:12288
    v_mfma_f32_16x16x32_bf16 v[100:103], v[164:167], v[144:147], v[100:103]
    ds_read_b128 v[196:199], v7 offset:14336
    v_mfma_f32_16x16x32_bf16 v[108:111], v[164:167], v[148:151], v[108:111]
    v_mfma_f32_16x16x32_bf16 v[104:107], v[160:163], v[148:151], v[104:107]
    v_mfma_f32_16x16x32_bf16 v[112:115], v[160:163], v[152:155], v[112:115]
    v_mfma_f32_16x16x32_bf16 v[116:119], v[164:167], v[152:155], v[116:119]
    v_mfma_f32_16x16x32_bf16 v[124:127], v[164:167], v[156:159], v[124:127]
    v_mfma_f32_16x16x32_bf16 v[120:123], v[160:163], v[156:159], v[120:123]
    s_waitcnt lgkmcnt(0)
    s_barrier
    v_mfma_f32_16x16x32_bf16 v[64:67], v[200:203], v[168:171], v[64:67]
    ds_read_b128 v[160:163], v9 offset:32768
    v_mfma_f32_16x16x32_bf16 v[68:71], v[204:207], v[168:171], v[68:71]
    ds_read_b128 v[164:167], v9 offset:34816
    v_mfma_f32_16x16x32_bf16 v[76:79], v[204:207], v[172:175], v[76:79]
    ds_read_b128 v[128:131], v5 offset:32768
    v_mfma_f32_16x16x32_bf16 v[72:75], v[200:203], v[172:175], v[72:75]
    ds_read_b128 v[132:135], v5 offset:34816
    v_mfma_f32_16x16x32_bf16 v[80:83], v[200:203], v[176:179], v[80:83]
    ds_read_b128 v[136:139], v5 offset:36864
    v_mfma_f32_16x16x32_bf16 v[84:87], v[204:207], v[176:179], v[84:87]
    ds_read_b128 v[140:143], v5 offset:38912
    v_mfma_f32_16x16x32_bf16 v[92:95], v[204:207], v[180:183], v[92:95]
    ds_read_b128 v[144:147], v5 offset:40960
    v_mfma_f32_16x16x32_bf16 v[88:91], v[200:203], v[180:183], v[88:91]
    ds_read_b128 v[148:151], v5 offset:43008
    v_mfma_f32_16x16x32_bf16 v[96:99], v[200:203], v[184:187], v[96:99]
    ds_read_b128 v[152:155], v5 offset:45056
    v_mfma_f32_16x16x32_bf16 v[100:103], v[204:207], v[184:187], v[100:103]
    ds_read_b128 v[156:159], v5 offset:47104
    v_mfma_f32_16x16x32_bf16 v[108:111], v[204:207], v[188:191], v[108:111]
    v_mfma_f32_16x16x32_bf16 v[104:107], v[200:203], v[188:191], v[104:107]
    v_mfma_f32_16x16x32_bf16 v[112:115], v[200:203], v[192:195], v[112:115]
    v_mfma_f32_16x16x32_bf16 v[116:119], v[204:207], v[192:195], v[116:119]
    v_mfma_f32_16x16x32_bf16 v[124:127], v[204:207], v[196:199], v[124:127]
    v_mfma_f32_16x16x32_bf16 v[120:123], v[200:203], v[196:199], v[120:123]
    s_cmp_eq_u32 s34, 4
    s_waitcnt lgkmcnt(0)
    s_cbranch_scc1 C_x4
C_x4_r:
    v_mfma_f32_16x16x32_bf16 v[64:67], v[160:163], v[128:131], v[64:67]
    ds_read_b128 v[200:203], v11 offset:32768
    v_mfma_f32_16x16x32_bf16 v[68:71], v[164:167], v[128:131], v[68:71]
    ds_read_b128 v[204:207], v11 offset:34816
    v_mfma_f32_16x16x32_bf16 v[76:79], v[164:167], v[132:135], v[76:79]
    ds_read_b128 v[168:171], v7 offset:32768
    v_mfma_f32_16x16x32_bf16 v[72:75], v[160:163], v[132:135], v[72:75]
    ds_read_b128 v[172:175], v7 offset:34816
    v_mfma_f32_16x16x32_bf16 v[80:83], v[160:163], v[136:139], v[80:83]
    ds_read_b128 v[176:179], v7 offset:36864
    v_mfma_f32_16x16x32_bf16 v[84:87], v[164:167], v[136:139], v[84:87]
    ds_read_b128 v[180:183], v7 offset:38912
    v_mfma_f32_16x16x32_bf16 v[92:95], v[164:167], v[140:143], v[92:95]
    ds_read_b128 v[184:187], v7 offset:40960
    v_mfma_f32_16x16x32_bf16 v[88:91], v[160:163], v[140:143], v[88:91]
    ds_read_b128 v[188:191], v7 offset:43008
    v_mfma_f32_16x16x32_bf16 v[96:99], v[160:163], v[144:147], v[96:99]
    ds_read_b128 v[192:195], v7 offset:45056
    v_mfma_f32_16x16x32_bf16 v[100:103], v[164:167], v[144:147], v[100:103]
    ds_read_b128 v[196:199], v7 offset:47104
    v_mfma_f32_16x16x32_bf16 v[108:111], v[164:167], v[148:151], v[108:111]
    v_mfma_f32_16x16x32_bf16 v[104:107], v[160:163], v[148:151], v[104:107]
    v_mfma_f32_16x16x32_bf16 v[112:115], v[160:163], v[152:155], v[112:115]
    v_mfma_f32_16x16x32_bf16 v[116:119], v[164:167], v[152:155], v[116:119]
    v_mfma_f32_16x16x32_bf16 v[124:127], v[164:167], v[156:159], v[124:127]
    v_mfma_f32_16x16x32_bf16 v[120:123], v[160:163], v[156:159], v[120:123]
    s_waitcnt vmcnt(0)
    v_readfirstlane_b32 s7, v54
    s_cmp_lg_u32 s7, 0
    s_cbranch_scc0 C_non
C_non_r:
    s_mov_b64 exec, 1
    buffer_store_dwordx2 v[54:55], off, s[72:75], s20 sc1
    ds_write_b64 v62, v[54:55]
    s_mov_b64 exec, -1
    s_waitcnt lgkmcnt(0)
    s_barrier
    v_mfma_f32_16x16x32_bf16 v[64:67], v[200:203], v[168:171], v[64:67]
    ds_read_b128 v[160:163], v8 offset:0
    v_mfma_f32_16x16x32_bf16 v[68:71], v[204:207], v[168:171], v[68:71]
    ds_read_b128 v[164:167], v8 offset:2048
    v_mfma_f32_16x16x32_bf16 v[76:79], v[204:207], v[172:175], v[76:79]
    ds_read_b128 v[128:131], v4 offset:0
    v_mfma_f32_16x16x32_bf16 v[72:75], v[200:203], v[172:175], v[72:75]
    ds_read_b128 v[132:135], v4 offset:2048
    v_mfma_f32_16x16x32_bf16 v[80:83], v[200:203], v[176:179], v[80:83]
    ds_read_b128 v[136:139], v4 offset:4096
    v_mfma_f32_16x16x32_bf16 v[84:87], v[204:207], v[176:179], v[84:87]
    ds_read_b128 v[140:143], v4 offset:6144
    v_mfma_f32_16x16x32_bf16 v[92:95], v[204:207], v[180:183], v[92:95]
    ds_read_b128 v[144:147], v4 offset:8192
    v_mfma_f32_16x16x32_bf16 v[88:91], v[200:203], v[180:183], v[88:91]
    ds_read_b128 v[148:151], v4 offset:10240
    v_mfma_f32_16x16x32_bf16 v[96:99], v[200:203], v[184:187], v[96:99]
    ds_read_b128 v[152:155], v4 offset:12288
    v_mfma_f32_16x16x32_bf16 v[100:103], v[204:207], v[184:187], v[100:103]
    ds_read_b128 v[156:159], v4 offset:14336
    v_mfma_f32_16x16x32_bf16 v[108:111], v[204:207], v[188:191], v[108:111]
    v_mfma_f32_16x16x32_bf16 v[104:107], v[200:203], v[188:191], v[104:107]
    v_mfma_f32_16x16x32_bf16 v[112:115], v[200:203], v[192:195], v[112:115]
    v_mfma_f32_16x16x32_bf16 v[116:119], v[204:207], v[192:195], v[116:119]
    v_mfma_f32_16x16x32_bf16 v[124:127], v[204:207], v[196:199], v[124:127]
    v_mfma_f32_16x16x32_bf16 v[120:123], v[200:203], v[196:199], v[120:123]
    s_cmp_eq_u32 s34, 5
    s_waitcnt lgkmcnt(0)
    s_cbranch_scc1 C_x5
C_x5_r:
    v_mfma_f32_16x16x32_bf16 v[64:67], v[160:163], v[128:131], v[64:67]
    ds_read_b128 v[200:203], v10 offset:0
    v_mfma_f32_16x16x32_bf16 v[68:71], v[164:167], v[128:131], v[68:71]
    ds_read_b128 v[204:207], v10 offset:2048
    v_mfma_f32_16x16x32_bf16 v[76:79], v[164:167], v[132:135], v[76:79]
    ds_read_b128 v[168:171], v6 offset:0
    v_mfma_f32_16x16x32_bf16 v[72:75], v[160:163], v[132:135], v[72:75]
    ds_read_b128 v[172:175], v6 offset:2048
    v_mfma_f32_16x16x32_bf16 v[80:83], v[160:163], v[136:139], v[80:83]
    ds_read_b128 v[176:179], v6 offset:4096
    v_mfma_f32_16x16x32_bf16 v[84:87], v[164:167], v[136:139], v[84:87]
    ds_read_b128 v[180:183], v6 offset:6144
    v_mfma_f32_16x16x32_bf16 v[92:95], v[164:167], v[140:143], v[92:95]
    ds_read_b128 v[184:187], v6 offset:8192
    v_mfma_f32_16x16x32_bf16 v[88:91], v[160:163], v[140:143], v[88:91]
    ds_read_b128 v[188:191], v6 offset:10240
    v_mfma_f32_16x16x32_bf16 v[96:99], v[160:163], v[144:147], v[96:99]
    ds_read_b128 v[192:195], v6 offset:12288
    v_mfma_f32_16x16x32_bf16 v[100:103], v[164:167], v[144:147], v[100:103]
    ds_read_b128 v[196:199], v6 offset:14336
    v_mfma_f32_16x16x32_bf16 v[108:111], v[164:167], v[148:151], v[108:111]
    v_mfma_f32_16x16x32_bf16 v[104:107], v[160:163], v[148:151], v[104:107]
    v_mfma_f32_16x16x32_bf16 v[112:115], v[160:163], v[152:155], v[112:115]
    v_mfma_f32_16x16x32_bf16 v[116:119], v[164:167], v[152:155], v[116:119]
    v_mfma_f32_16x16x32_bf16 v[124:127], v[164:167], v[156:159], v[124:127]
    v_mfma_f32_16x16x32_bf16 v[120:123], v[160:163], v[156:159], v[120:123]
    s_waitcnt lgkmcnt(0)
    s_barrier
    v_mfma_f32_16x16x32_bf16 v[64:67], v[200:203], v[168:171], v[64:67]
    ds_read_b128 v[160:163], v8 offset:32768
    v_mfma_f32_16x16x32_bf16 v[68:71], v[204:207], v[168:171], v[68:71]
    ds_read_b128 v[164:167], v8 offset:34816
    v_mfma_f32_16x16x32_bf16 v[76:79], v[204:207], v[172:175], v[76:79]
    ds_read_b128 v[128:131], v4 offset:32768
    v_mfma_f32_16x16x32_bf16 v[72:75], v[200:203], v[172:175], v[72:75]
    ds_read_b128 v[132:135], v4 offset:34816
    v_mfma_f32_16x16x32_bf16 v[80:83], v[200:203], v[176:179], v[80:83]
    ds_read_b128 v[136:139], v4 offset:36864
    v_mfma_f32_16x16x32_bf16 v[84:87], v[204:207], v[176:179], v[84:87]
    ds_read_b128 v[140:143], v4 offset:38912
    v_mfma_f32_16x16x32_bf16 v[92:95], v[204:207], v[180:183], v[92:95]
    ds_read_b128 v[144:147], v4 offset:40960
    v_mfma_f32_16x16x32_bf16 v[88:91], v[200:203], v[180:183], v[88:91]
    ds_read_b128 v[148:151], v4 offset:43008
    v_mfma_f32_16x16x32_bf16 v[96:99], v[200:203], v[184:187], v[96:99]
    ds_read_b128 v[152:155], v4 offset:45056
    v_mfma_f32_16x16x32_bf16 v[100:103], v[204:207], v[184:187], v[100:103]
    ds_read_b128 v[156:159], v4 offset:47104
    v_mfma_f32_16x16x32_bf16 v[108:111], v[204:207], v[188:191], v[108:111]
    v_mfma_f32_16x16x32_bf16 v[104:107], v[200:203], v[188:191], v[104:107]
    v_mfma_f32_16x16x32_bf16 v[112:115], v[200:203], v[192:195], v[112:115]
    v_mfma_f32_16x16x32_bf16 v[116:119], v[204:207], v[192:195], v[116:119]
    v_mfma_f32_16x16x32_bf16 v[124:127], v[204:207], v[196:199], v[124:127]
    v_mfma_f32_16x16x32_bf16 v[120:123], v[200:203], v[196:199], v[120:123]
    s_cmp_eq_u32 s34, 6
    s_waitcnt lgkmcnt(0)
    s_cbranch_scc1 C_x6
C_x6_r:
    v_mfma_f32_16x16x32_bf16 v[64:67], v[160:163], v[128:131], v[64:67]
    ds_read_b128 v[200:203], v10 offset:32768
    v_mfma_f32_16x16x32_bf16 v[68:71], v[164:167], v[128:131], v[68:71]
    ds_read_b128 v[204:207], v10 offset:34816
    v_mfma_f32_16x16x32_bf16 v[76:79], v[164:167], v[132:135], v[76:79]
    ds_read_b128 v[168:171], v6 offset:32768
    v_mfma_f32_16x16x32_bf16 v[72:75], v[160:163], v[132:135], v[72:75]
    ds_read_b128 v[172:175], v6 offset:34816
    v_mfma_f32_16x16x32_bf16 v[80:83], v[160:163], v[136:139], v[80:83]
    ds_read_b128 v[176:179], v6 offset:36864
    v_mfma_f32_16x16x32_bf16 v[84:87], v[164:167], v[136:139], v[84:87]
    ds_read_b128 v[180:183], v6 offset:38912
    v_mfma_f32_16x16x32_bf16 v[92:95], v[164:167], v[140:143], v[92:95]
    ds_read_b128 v[184:187], v6 offset:40960
    v_mfma_f32_16x16x32_bf16 v[88:91], v[160:163], v[140:143], v[88:91]
    ds_read_b128 v[188:191], v6 offset:43008
    v_mfma_f32_16x16x32_bf16 v[96:99], v[160:163], v[144:147], v[96:99]
    ds_read_b128 v[192:195], v6 offset:45056
    v_mfma_f32_16x16x32_bf16 v[100:103], v[164:167], v[144:147], v[100:103]
    ds_read_b128 v[196:199], v6 offset:47104
    v_mfma_f32_16x16x32_bf16 v[108:111], v[164:167], v[148:151], v[108:111]
    v_mfma_f32_16x16x32_bf16 v[104:107], v[160:163], v[148:151], v[104:107]
    v_mfma_f32_16x16x32_bf16 v[112:115], v[160:163], v[152:155], v[112:115]
    v_mfma_f32_16x16x32_bf16 v[116:119], v[164:167], v[152:155], v[116:119]
    v_mfma_f32_16x16x32_bf16 v[124:127], v[164:167], v[156:159], v[124:127]
    v_mfma_f32_16x16x32_bf16 v[120:123], v[160:163], v[156:159], v[120:123]
    s_waitcnt lgkmcnt(0)
    s_barrier
    v_mfma_f32_16x16x32_bf16 v[64:67], v[200:203], v[168:171], v[64:67]
    ds_read_b128 v[160:163], v9 offset:0
    v_mfma_f32_16x16x32_bf16 v[68:71], v[204:207], v[168:171], v[68:71]
    ds_read_b128 v[164:167], v9 offset:2048
    v_mfma_f32_16x16x32_bf16 v[76:79], v[204:207], v[172:175], v[76:79]
    ds_read_b128 v[128:131], v5 offset:0
    v_mfma_f32_16x16x32_bf16 v[72:75], v[200:203], v[172:175], v[72:75]
    ds_read_b128 v[132:135], v5 offset:2048
    v_mfma_f32_16x16x32_bf16 v[80:83], v[200:203], v[176:179], v[80:83]
    ds_read_b128 v[136:139], v5 offset:4096
    v_mfma_f32_16x16x32_bf16 v[84:87], v[204:207], v[176:179], v[84:87]
    ds_read_b128 v[140:143], v5 offset:6144
    v_mfma_f32_16x16x32_bf16 v[92:95], v[204:207], v[180:183], v[92:95]
    ds_read_b128 v[144:147], v5 offset:8192
    v_mfma_f32_16x16x32_bf16 v[88:91], v[200:203], v[180:183], v[88:91]
    ds_read_b128 v[148:151], v5 offset:10240
    v_mfma_f32_16x16x32_bf16 v[96:99], v[200:203], v[184:187], v[96:99]
    ds_read_b128 v[152:155], v5 offset:12288
    v_mfma_f32_16x16x32_bf16 v[100:103], v[204:207], v[184:187], v[100:103]
    ds_read_b128 v[156:159], v5 offset:14336
    v_mfma_f32_16x16x32_bf16 v[108:111], v[204:207], v[188:191], v[108:111]
    v_mfma_f32_16x16x32_bf16 v[104:107], v[200:203], v[188:191], v[104:107]
    v_mfma_f32_16x16x32_bf16 v[112:115], v[200:203], v[192:195], v[112:115]
    v_mfma_f32_16x16x32_bf16 v[116:119], v[204:207], v[192:195], v[116:119]
    v_mfma_f32_16x16x32_bf16 v[124:127], v[204:207], v[196:199], v[124:127]
    v_mfma_f32_16x16x32_bf16 v[120:123], v[200:203], v[196:199], v[120:123]
    s_cmp_eq_u32 s34, 7
    s_waitcnt lgkmcnt(0)
    s_cbranch_scc1 C_x7
C_x7_r:
    v_mfma_f32_16x16x32_bf16 v[64:67], v[160:163], v[128:131], v[64:67]
    ds_read_b128 v[200:203], v11 offset:0
    v_mfma_f32_16x16x32_bf16 v[68:71], v[164:167], v[128:131], v[68:71]
    ds_read_b128 v[204:207], v11 offset:2048
    v_mfma_f32_16x16x32_bf16 v[76:79], v[164:167], v[132:135], v[76:79]
    ds_read_b128 v[168:171], v7 offset:0
    v_mfma_f32_16x16x32_bf16 v[72:75], v[160:163], v[132:135], v[72:75]
    ds_read_b128 v[172:175], v7 offset:2048
    v_mfma_f32_16x16x32_bf16 v[80:83], v[160:163], v[136:139], v[80:83]
    ds_read_b128 v[176:179], v7 offset:4096
    v_mfma_f32_16x16x32_bf16 v[84:87], v[164:167], v[136:139], v[84:87]
    ds_read_b128 v[180:183], v7 offset:6144
    v_mfma_f32_16x16x32_bf16 v[92:95], v[164:167], v[140:143], v[92:95]
    ds_read_b128 v[184:187], v7 offset:8192
    v_mfma_f32_16x16x32_bf16 v[88:91], v[160:163], v[140:143], v[88:91]
    ds_read_b128 v[188:191], v7 offset:10240
    v_mfma_f32_16x16x32_bf16 v[96:99], v[160:163], v[144:147], v[96:99]
    ds_read_b128 v[192:195], v7 offset:12288
    v_mfma_f32_16x16x32_bf16 v[100:103], v[164:167], v[144:147], v[100:103]
    ds_read_b128 v[196:199], v7 offset:14336
    v_mfma_f32_16x16x32_bf16 v[108:111], v[164:167], v[148:151], v[108:111]
    v_mfma_f32_16x16x32_bf16 v[104:107], v[160:163], v[148:151], v[104:107]
    v_mfma_f32_16x16x32_bf16 v[112:115], v[160:163], v[152:155], v[112:115]
    v_mfma_f32_16x16x32_bf16 v[116:119], v[164:167], v[152:155], v[116:119]
    v_mfma_f32_16x16x32_bf16 v[124:127], v[164:167], v[156:159], v[124:127]
    v_mfma_f32_16x16x32_bf16 v[120:123], v[160:163], v[156:159], v[120:123]
    s_waitcnt lgkmcnt(0)
    s_barrier
    v_mfma_f32_16x16x32_bf16 v[64:67], v[200:203], v[168:171], v[64:67]
    ds_read_b128 v[160:163], v9 offset:32768
    v_mfma_f32_16x16x32_bf16 v[68:71], v[204:207], v[168:171], v[68:71]
    ds_read_b128 v[164:167], v9 offset:34816
    v_mfma_f32_16x16x32_bf16 v[76:79], v[204:207], v[172:175], v[76:79]
    ds_read_b128 v[128:131], v5 offset:32768
    v_mfma_f32_16x16x32_bf16 v[72:75], v[200:203], v[172:175], v[72:75]
    ds_read_b128 v[132:135], v5 offset:34816
    v_mfma_f32_16x16x32_bf16 v[80:83], v[200:203], v[176:179], v[80:83]
    ds_read_b128 v[136:139], v5 offset:36864
    v_mfma_f32_16x16x32_bf16 v[84:87], v[204:207], v[176:179], v[84:87]
    ds_read_b128 v[140:143], v5 offset:38912
    v_mfma_f32_16x16x32_bf16 v[92:95], v[204:207], v[180:183], v[92:95]
    ds_read_b128 v[144:147], v5 offset:40960
    v_mfma_f32_16x16x32_bf16 v[88:91], v[200:203], v[180:183], v[88:91]
    ds_read_b128 v[148:151], v5 offset:43008
    v_mfma_f32_16x16x32_bf16 v[96:99], v[200:203], v[184:187], v[96:99]
    ds_read_b128 v[152:155], v5 offset:45056
    v_mfma_f32_16x16x32_bf16 v[100:103], v[204:207], v[184:187], v[100:103]
    ds_read_b128 v[156:159], v5 offset:47104
    v_mfma_f32_16x16x32_bf16 v[108:111], v[204:207], v[188:191], v[108:111]
    v_mfma_f32_16x16x32_bf16 v[104:107], v[200:203], v[188:191], v[104:107]
    v_mfma_f32_16x16x32_bf16 v[112:115], v[200:203], v[192:195], v[112:115]
    v_mfma_f32_16x16x32_bf16 v[116:119], v[204:207], v[192:195], v[116:119]
    v_mfma_f32_16x16x32_bf16 v[124:127], v[204:207], v[196:199], v[124:127]
    v_mfma_f32_16x16x32_bf16 v[120:123], v[200:203], v[196:199], v[120:123]
    s_cmp_eq_u32 s34, 8
    s_waitcnt lgkmcnt(0)
    s_cbranch_scc1 C_x8
C_x8_r:
    v_mfma_f32_16x16x32_bf16 v[64:67], v[160:163], v[128:131], v[64:67]
    ds_read_b128 v[200:203], v11 offset:32768
    v_mfma_f32_16x16x32_bf16 v[68:71], v[164:167], v[128:131], v[68:71]
    ds_read_b128 v[204:207], v11 offset:34816
    v_mfma_f32_16x16x32_bf16 v[76:79], v[164:167], v[132:135], v[76:79]
    ds_read_b128 v[168:171], v7 offset:32768
    v_mfma_f32_16x16x32_bf16 v[72:75], v[160:163], v[132:135], v[72:75]
    ds_read_b128 v[172:175], v7 offset:34816
    v_mfma_f32_16x16x32_bf16 v[80:83], v[160:163], v[136:139], v[80:83]
    ds_read_b128 v[176:179], v7 offset:36864
    v_mfma_f32_16x16x32_bf16 v[84:87], v[164:167], v[136:139], v[84:87]
    ds_read_b128 v[180:183], v7 offset:38912
    v_mfma_f32_16x16x32_bf16 v[92:95], v[164:167], v[140:143], v[92:95]
    ds_read_b128 v[184:187], v7 offset:40960
    v_mfma_f32_16x16x32_bf16 v[88:91], v[160:163], v[140:143], v[88:91]
    ds_read_b128 v[188:191], v7 offset:43008
    v_mfma_f32_16x16x32_bf16 v[96:99], v[160:163], v[144:147], v[96:99]
    ds_read_b128 v[192:195], v7 offset:45056
    v_mfma_f32_16x16x32_bf16 v[100:103], v[164:167], v[144:147], v[100:103]
    ds_read_b128 v[196:199], v7 offset:47104
    v_mfma_f32_16x16x32_bf16 v[108:111], v[164:167], v[148:151], v[108:111]
    v_mfma_f32_16x16x32_bf16 v[104:107], v[160:163], v[148:151], v[104:107]
    v_mfma_f32_16x16x32_bf16 v[112:115], v[160:163], v[152:155], v[112:115]
    v_mfma_f32_16x16x32_bf16 v[116:119], v[164:167], v[152:155], v[116:119]
    v_mfma_f32_16x16x32_bf16 v[124:127], v[164:167], v[156:159], v[124:127]
    v_mfma_f32_16x16x32_bf16 v[120:123], v[160:163], v[156:159], v[120:123]
    s_waitcnt lgkmcnt(0)
    s_barrier
    v_mfma_f32_16x16x32_bf16 v[64:67], v[200:203], v[168:171], v[64:67]
    ds_read_b128 v[160:163], v8 offset:0
    v_mfma_f32_16x16x32_bf16 v[68:71], v[204:207], v[168:171], v[68:71]
    ds_read_b128 v[164:167], v8 offset:2048
    v_mfma_f32_16x16x32_bf16 v[76:79], v[204:207], v[172:175], v[76:79]
    ds_read_b128 v[128:131], v4 offset:0
    v_mfma_f32_16x16x32_bf16 v[72:75], v[200:203], v[172:175], v[72:75]
    ds_read_b128 v[132:135], v4 offset:2048
    v_mfma_f32_16x16x32_bf16 v[80:83], v[200:203], v[176:179], v[80:83]
    ds_read_b128 v[136:139], v4 offset:4096
    v_mfma_f32_16x16x32_bf16 v[84:87], v[204:207], v[176:179], v[84:87]
    ds_read_b128 v[140:143], v4 offset:6144
    v_mfma_f32_16x16x32_bf16 v[92:95], v[204:207], v[180:183], v[92:95]
    ds_read_b128 v[144:147], v4 offset:8192
    v_mfma_f32_16x16x32_bf16 v[88:91], v[200:203], v[180:183], v[88:91]
    ds_read_b128 v[148:151], v4 offset:10240
    v_mfma_f32_16x16x32_bf16 v[96:99], v[200:203], v[184:187], v[96:99]
    ds_read_b128 v[152:155], v4 offset:12288
    v_mfma_f32_16x16x32_bf16 v[100:103], v[204:207], v[184:187], v[100:103]
    ds_read_b128 v[156:159], v4 offset:14336
    v_mfma_f32_16x16x32_bf16 v[108:111], v[204:207], v[188:191], v[108:111]
    v_mfma_f32_16x16x32_bf16 v[104:107], v[200:203], v[188:191], v[104:107]
    v_mfma_f32_16x16x32_bf16 v[112:115], v[200:203], v[192:195], v[112:115]
    v_mfma_f32_16x16x32_bf16 v[116:119], v[204:207], v[192:195], v[116:119]
    v_mfma_f32_16x16x32_bf16 v[124:127], v[204:207], v[196:199], v[124:127]
    v_mfma_f32_16x16x32_bf16 v[120:123], v[200:203], v[196:199], v[120:123]
    s_cmp_eq_u32 s34, 9
    s_waitcnt lgkmcnt(0)
    s_cbranch_scc1 C_x9
C_x9_r:
    v_mfma_f32_16x16x32_bf16 v[64:67], v[160:163], v[128:131], v[64:67]
    ds_read_b128 v[200:203], v10 offset:0
    v_mfma_f32_16x16x32_bf16 v[68:71], v[164:167], v[128:131], v[68:71]
    ds_read_b128 v[204:207], v10 offset:2048
    v_mfma_f32_16x16x32_bf16 v[76:79], v[164:167], v[132:135], v[76:79]
    ds_read_b128 v[168:171], v6 offset:0
    v_mfma_f32_16x16x32_bf16 v[72:75], v[160:163], v[132:135], v[72:75]
    ds_read_b128 v[172:175], v6 offset:2048
    v_mfma_f32_16x16x32_bf16 v[80:83], v[160:163], v[136:139], v[80:83]
    ds_read_b128 v[176:179], v6 offset:4096
    v_mfma_f32_16x16x32_bf16 v[84:87], v[164:167], v[136:139], v[84:87]
    ds_read_b128 v[180:183], v6 offset:6144
    v_mfma_f32_16x16x32_bf16 v[92:95], v[164:167], v[140:143], v[92:95]
    ds_read_b128 v[184:187], v6 offset:8192
    v_mfma_f32_16x16x32_bf16 v[88:91], v[160:163], v[140:143], v[88:91]
    ds_read_b128 v[188:191], v6 offset:10240
    v_mfma_f32_16x16x32_bf16 v[96:99], v[160:163], v[144:147], v[96:99]
    ds_read_b128 v[192:195], v6 offset:12288
    v_mfma_f32_16x16x32_bf16 v[100:103], v[164:167], v[144:147], v[100:103]
    ds_read_b128 v[196:199], v6 offset:14336
    v_mfma_f32_16x16x32_bf16 v[108:111], v[164:167], v[148:151], v[108:111]
    v_mfma_f32_16x16x32_bf16 v[104:107], v[160:163], v[148:151], v[104:107]
    v_mfma_f32_16x16x32_bf16 v[112:115], v[160:163], v[152:155], v[112:115]
    v_mfma_f32_16x16x32_bf16 v[116:119], v[164:167], v[152:155], v[116:119]
    v_mfma_f32_16x16x32_bf16 v[124:127], v[164:167], v[156:159], v[124:127]
    v_mfma_f32_16x16x32_bf16 v[120:123], v[160:163], v[156:159], v[120:123]
    s_waitcnt lgkmcnt(0)
    s_barrier
    v_mfma_f32_16x16x32_bf16 v[64:67], v[200:203], v[168:171], v[64:67]
    ds_read_b128 v[160:163], v8 offset:32768
    v_mfma_f32_16x16x32_bf16 v[68:71], v[204:207], v[168:171], v[68:71]
    ds_read_b128 v[164:167], v8 offset:34816
    v_mfma_f32_16x16x32_bf16 v[76:79], v[204:207], v[172:175], v[76:79]
    ds_read_b128 v[128:131], v4 offset:32768
    v_mfma_f32_16x16x32_bf16 v[72:75], v[200:203], v[172:175], v[72:75]
    ds_read_b128 v[132:135], v4 offset:34816
    v_mfma_f32_16x16x32_bf16 v[80:83], v[200:203], v[176:179], v[80:83]
    ds_read_b128 v[136:139], v4 offset:36864
    v_mfma_f32_16x16x32_bf16 v[84:87], v[204:207], v[176:179], v[84:87]
    ds_read_b128 v[140:143], v4 offset:38912
    v_mfma_f32_16x16x32_bf16 v[92:95], v[204:207], v[180:183], v[92:95]
    ds_read_b128 v[144:147], v4 offset:40960
    v_mfma_f32_16x16x32_bf16 v[88:91], v[200:203], v[180:183], v[88:91]
    ds_read_b128 v[148:151], v4 offset:43008
    v_mfma_f32_16x16x32_bf16 v[96:99], v[200:203], v[184:187], v[96:99]
    ds_read_b128 v[152:155], v4 offset:45056
    v_mfma_f32_16x16x32_bf16 v[100:103], v[204:207], v[184:187], v[100:103]
    ds_read_b128 v[156:159], v4 offset:47104
    v_mfma_f32_16x16x32_bf16 v[108:111], v[204:207], v[188:191], v[108:111]
    v_mfma_f32_16x16x32_bf16 v[104:107], v[200:203], v[188:191], v[104:107]
    v_mfma_f32_16x16x32_bf16 v[112:115], v[200:203], v[192:195], v[112:115]
    v_mfma_f32_16x16x32_bf16 v[116:119], v[204:207], v[192:195], v[116:119]
    v_mfma_f32_16x16x32_bf16 v[124:127], v[204:207], v[196:199], v[124:127]
    v_mfma_f32_16x16x32_bf16 v[120:123], v[200:203], v[196:199], v[120:123]
    s_cmp_eq_u32 s34, 10
    s_waitcnt lgkmcnt(0)
    s_cbranch_scc1 C_x10
C_x10_r:
    v_mfma_f32_16x16x32_bf16 v[64:67], v[160:163], v[128:131], v[64:67]
    ds_read_b128 v[200:203], v10 offset:32768
    v_mfma_f32_16x16x32_bf16 v[68:71], v[164:167], v[128:131], v[68:71]
    ds_read_b128 v[204:207], v10 offset:34816
    v_mfma_f32_16x16x32_bf16 v[76:79], v[164:167], v[132:135], v[76:79]
    ds_read_b128 v[168:171], v6 offset:32768
    v_mfma_f32_16x16x32_bf16 v[72:75], v[160:163], v[132:135], v[72:75]
    ds_read_b128 v[172:175], v6 offset:34816
    v_mfma_f32_16x16x32_bf16 v[80:83], v[160:163], v[136:139], v[80:83]
    ds_read_b128 v[176:179], v6 offset:36864
    v_mfma_f32_16x16x32_bf16 v[84:87], v[164:167], v[136:139], v[84:87]
    ds_read_b128 v[180:183], v6 offset:38912
    v_mfma_f32_16x16x32_bf16 v[92:95], v[164:167], v[140:143], v[92:95]
    ds_read_b128 v[184:187], v6 offset:40960
    v_mfma_f32_16x16x32_bf16 v[88:91], v[160:163], v[140:143], v[88:91]
    ds_read_b128 v[188:191], v6 offset:43008
    v_mfma_f32_16x16x32_bf16 v[96:99], v[160:163], v[144:147], v[96:99]
    ds_read_b128 v[192:195], v6 offset:45056
    v_mfma_f32_16x16x32_bf16 v[100:103], v[164:167], v[144:147], v[100:103]
    ds_read_b128 v[196:199], v6 offset:47104
    v_mfma_f32_16x16x32_bf16 v[108:111], v[164:167], v[148:151], v[108:111]
    v_mfma_f32_16x16x32_bf16 v[104:107], v[160:163], v[148:151], v[104:107]
    v_mfma_f32_16x16x32_bf16 v[112:115], v[160:163], v[152:155], v[112:115]
    v_mfma_f32_16x16x32_bf16 v[116:119], v[164:167], v[152:155], v[116:119]
    v_mfma_f32_16x16x32_bf16 v[124:127], v[164:167], v[156:159], v[124:127]
    v_mfma_f32_16x16x32_bf16 v[120:123], v[160:163], v[156:159], v[120:123]
    buffer_load_dwordx2 v[244:245], v246, s[72:75], s21 offen sc1
    s_waitcnt lgkmcnt(0)
    s_barrier
    v_mfma_f32_16x16x32_bf16 v[64:67], v[200:203], v[168:171], v[64:67]
    ds_read_b128 v[160:163], v9 offset:0
    v_mfma_f32_16x16x32_bf16 v[68:71], v[204:207], v[168:171], v[68:71]
    ds_read_b128 v[164:167], v9 offset:2048
    v_mfma_f32_16x16x32_bf16 v[76:79], v[204:207], v[172:175], v[76:79]
    ds_read_b128 v[128:131], v5 offset:0
    v_mfma_f32_16x16x32_bf16 v[72:75], v[200:203], v[172:175], v[72:75]
    ds_read_b128 v[132:135], v5 offset:2048
    v_mfma_f32_16x16x32_bf16 v[80:83], v[200:203], v[176:179], v[80:83]
    ds_read_b128 v[136:139], v5 offset:4096
    v_mfma_f32_16x16x32_bf16 v[84:87], v[204:207], v[176:179], v[84:87]
    ds_read_b128 v[140:143], v5 offset:6144
    v_mfma_f32_16x16x32_bf16 v[92:95], v[204:207], v[180:183], v[92:95]
    ds_read_b128 v[144:147], v5 offset:8192
    v_mfma_f32_16x16x32_bf16 v[88:91], v[200:203], v[180:183], v[88:91]
    ds_read_b128 v[148:151], v5 offset:10240
    v_mfma_f32_16x16x32_bf16 v[96:99], v[200:203], v[184:187], v[96:99]
    ds_read_b128 v[152:155], v5 offset:12288
    v_mfma_f32_16x16x32_bf16 v[100:103], v[204:207], v[184:187], v[100:103]
    ds_read_b128 v[156:159], v5 offset:14336
    v_mfma_f32_16x16x32_bf16 v[108:111], v[204:207], v[188:191], v[108:111]
    v_mfma_f32_16x16x32_bf16 v[104:107], v[200:203], v[188:191], v[104:107]
    v_mfma_f32_16x16x32_bf16 v[112:115], v[200:203], v[192:195], v[112:115]
    v_mfma_f32_16x16x32_bf16 v[116:119], v[204:207], v[192:195], v[116:119]
    v_mfma_f32_16x16x32_bf16 v[124:127], v[204:207], v[196:199], v[124:127]
    v_mfma_f32_16x16x32_bf16 v[120:123], v[200:203], v[196:199], v[120:123]
    s_cmp_eq_u32 s34, 11
    s_waitcnt lgkmcnt(0)
    s_cbranch_scc1 C_x11
C_x11_r:
    v_mfma_f32_16x16x32_bf16 v[64:67], v[160:163], v[128:131], v[64:67]
    ds_read_b128 v[200:203], v11 offset:0
    v_mfma_f32_16x16x32_bf16 v[68:71], v[164:167], v[128:131], v[68:71]
    ds_read_b128 v[204:207], v11 offset:2048
    v_mfma_f32_16x16x32_bf16 v[76:79], v[164:167], v[132:135], v[76:79]
    ds_read_b128 v[168:171], v7 offset:0
    v_mfma_f32_16x16x32_bf16 v[72:75], v[160:163], v[132:135], v[72:75]
    ds_read_b128 v[172:175], v7 offset:2048
    v_mfma_f32_16x16x32_bf16 v[80:83], v[160:163], v[136:139], v[80:83]
    ds_read_b128 v[176:179], v7 offset:4096
    v_mfma_f32_16x16x32_bf16 v[84:87], v[164:167], v[136:139], v[84:87]
    ds_read_b128 v[180:183], v7 offset:6144
    v_mfma_f32_16x16x32_bf16 v[92:95], v[164:167], v[140:143], v[92:95]
    ds_read_b128 v[184:187], v7 offset:8192
    v_mfma_f32_16x16x32_bf16 v[88:91], v[160:163], v[140:143], v[88:91]
    ds_read_b128 v[188:191], v7 offset:10240
    v_mfma_f32_16x16x32_bf16 v[96:99], v[160:163], v[144:147], v[96:99]
    ds_read_b128 v[192:195], v7 offset:12288
    v_mfma_f32_16x16x32_bf16 v[100:103], v[164:167], v[144:147], v[100:103]
    ds_read_b128 v[196:199], v7 offset:14336
    v_mfma_f32_16x16x32_bf16 v[108:111], v[164:167], v[148:151], v[108:111]
    v_mfma_f32_16x16x32_bf16 v[104:107], v[160:163], v[148:151], v[104:107]
    v_mfma_f32_16x16x32_bf16 v[112:115], v[160:163], v[152:155], v[112:115]
    v_mfma_f32_16x16x32_bf16 v[116:119], v[164:167], v[152:155], v[116:119]
    v_mfma_f32_16x16x32_bf16 v[124:127], v[164:167], v[156:159], v[124:127]
    v_mfma_f32_16x16x32_bf16 v[120:123], v[160:163], v[156:159], v[120:123]
    s_waitcnt lgkmcnt(0)
    s_barrier
    v_mfma_f32_16x16x32_bf16 v[64:67], v[200:203], v[168:171], v[64:67]
    ds_read_b128 v[160:163], v9 offset:32768
    v_mfma_f32_16x16x32_bf16 v[68:71], v[204:207], v[168:171], v[68:71]
    ds_read_b128 v[164:167], v9 offset:34816
    v_mfma_f32_16x16x32_bf16 v[76:79], v[204:207], v[172:175], v[76:79]
    ds_read_b128 v[128:131], v5 offset:32768
    v_mfma_f32_16x16x32_bf16 v[72:75], v[200:203], v[172:175], v[72:75]
    ds_read_b128 v[132:135], v5 offset:34816
    v_mfma_f32_16x16x32_bf16 v[80:83], v[200:203], v[176:179], v[80:83]
    ds_read_b128 v[136:139], v5 offset:36864
    v_mfma_f32_16x16x32_bf16 v[84:87], v[204:207], v[176:179], v[84:87]
    ds_read_b128 v[140:143], v5 offset:38912
    v_mfma_f32_16x16x32_bf16 v[92:95], v[204:207], v[180:183], v[92:95]
    ds_read_b128 v[144:147], v5 offset:40960
    v_mfma_f32_16x16x32_bf16 v[88:91], v[200:203], v[180:183], v[88:91]
    ds_read_b128 v[148:151], v5 offset:43008
    v_mfma_f32_16x16x32_bf16 v[96:99], v[200:203], v[184:187], v[96:99]
    ds_read_b128 v[152:155], v5 offset:45056
    v_mfma_f32_16x16x32_bf16 v[100:103], v[204:207], v[184:187], v[100:103]
    ds_read_b128 v[156:159], v5 offset:47104
    v_mfma_f32_16x16x32_bf16 v[108:111], v[204:207], v[188:191], v[108:111]
    v_mfma_f32_16x16x32_bf16 v[104:107], v[200:203], v[188:191], v[104:107]
    v_mfma_f32_16x16x32_bf16 v[112:115], v[200:203], v[192:195], v[112:115]
    v_mfma_f32_16x16x32_bf16 v[116:119], v[204:207], v[192:195], v[116:119]
    v_mfma_f32_16x16x32_bf16 v[124:127], v[204:207], v[196:199], v[124:127]
    v_mfma_f32_16x16x32_bf16 v[120:123], v[200:203], v[196:199], v[120:123]
    s_cmp_eq_u32 s34, 12
    s_waitcnt lgkmcnt(0)
    s_cbranch_scc1 C_x12
C_x12_r:
    v_mfma_f32_16x16x32_bf16 v[64:67], v[160:163], v[128:131], v[64:67]
    ds_read_b128 v[200:203], v11 offset:32768
    v_mfma_f32_16x16x32_bf16 v[68:71], v[164:167], v[128:131], v[68:71]
    ds_read_b128 v[204:207], v11 offset:34816
    v_mfma_f32_16x16x32_bf16 v[76:79], v[164:167], v[132:135], v[76:79]
    ds_read_b128 v[168:171], v7 offset:32768
    v_mfma_f32_16x16x32_bf16 v[72:75], v[160:163], v[132:135], v[72:75]
    ds_read_b128 v[172:175], v7 offset:34816
    v_mfma_f32_16x16x32_bf16 v[80:83], v[160:163], v[136:139], v[80:83]
    ds_read_b128 v[176:179], v7 offset:36864
    v_mfma_f32_16x16x32_bf16 v[84:87], v[164:167], v[136:139], v[84:87]
    ds_read_b128 v[180:183], v7 offset:38912
    v_mfma_f32_16x16x32_bf16 v[92:95], v[164:167], v[140:143], v[92:95]
    ds_read_b128 v[184:187], v7 offset:40960
    v_mfma_f32_16x16x32_bf16 v[88:91], v[160:163], v[140:143], v[88:91]
    ds_read_b128 v[188:191], v7 offset:43008
    v_mfma_f32_16x16x32_bf16 v[96:99], v[160:163], v[144:147], v[96:99]
    ds_read_b128 v[192:195], v7 offset:45056
    v_mfma_f32_16x16x32_bf16 v[100:103], v[164:167], v[144:147], v[100:103]
    ds_read_b128 v[196:199], v7 offset:47104
    v_mfma_f32_16x16x32_bf16 v[108:111], v[164:167], v[148:151], v[108:111]
    v_mfma_f32_16x16x32_bf16 v[104:107], v[160:163], v[148:151], v[104:107]
    v_mfma_f32_16x16x32_bf16 v[112:115], v[160:163], v[152:155], v[112:115]
    v_mfma_f32_16x16x32_bf16 v[116:119], v[164:167], v[152:155], v[116:119]
    v_mfma_f32_16x16x32_bf16 v[124:127], v[164:167], v[156:159], v[124:127]
    v_mfma_f32_16x16x32_bf16 v[120:123], v[160:163], v[156:159], v[120:123]
    s_waitcnt lgkmcnt(0)
    s_barrier
    v_mfma_f32_16x16x32_bf16 v[64:67], v[200:203], v[168:171], v[64:67]
    ds_read_b128 v[160:163], v8 offset:0
    v_mfma_f32_16x16x32_bf16 v[68:71], v[204:207], v[168:171], v[68:71]
    ds_read_b128 v[164:167], v8 offset:2048
    v_mfma_f32_16x16x32_bf16 v[76:79], v[204:207], v[172:175], v[76:79]
    ds_read_b128 v[128:131], v4 offset:0
    v_mfma_f32_16x16x32_bf16 v[72:75], v[200:203], v[172:175], v[72:75]
    ds_read_b128 v[132:135], v4 offset:2048
    v_mfma_f32_16x16x32_bf16 v[80:83], v[200:203], v[176:179], v[80:83]
    ds_read_b128 v[136:139], v4 offset:4096
    v_mfma_f32_16x16x32_bf16 v[84:87], v[204:207], v[176:179], v[84:87]
    ds_read_b128 v[140:143], v4 offset:6144
    v_mfma_f32_16x16x32_bf16 v[92:95], v[204:207], v[180:183], v[92:95]
    ds_read_b128 v[144:147], v4 offset:8192
    v_mfma_f32_16x16x32_bf16 v[88:91], v[200:203], v[180:183], v[88:91]
    ds_read_b128 v[148:151], v4 offset:10240
    v_mfma_f32_16x16x32_bf16 v[96:99], v[200:203], v[184:187], v[96:99]
    ds_read_b128 v[152:155], v4 offset:12288
    v_mfma_f32_16x16x32_bf16 v[100:103], v[204:207], v[184:187], v[100:103]
    ds_read_b128 v[156:159], v4 offset:14336
    v_mfma_f32_16x16x32_bf16 v[108:111], v[204:207], v[188:191], v[108:111]
    v_mfma_f32_16x16x32_bf16 v[104:107], v[200:203], v[188:191], v[104:107]
    v_mfma_f32_16x16x32_bf16 v[112:115], v[200:203], v[192:195], v[112:115]
    v_mfma_f32_16x16x32_bf16 v[116:119], v[204:207], v[192:195], v[116:119]
    v_mfma_f32_16x16x32_bf16 v[124:127], v[204:207], v[196:199], v[124:127]
    v_mfma_f32_16x16x32_bf16 v[120:123], v[200:203], v[196:199], v[120:123]
    s_cmp_eq_u32 s34, 13
    s_waitcnt lgkmcnt(0)
    s_cbranch_scc1 C_x13
C_x13_r:
    s_waitcnt vmcnt(0)
    v_cmp_eq_u32 vcc, v244, v54
    v_cmp_eq_u32 s[54:55], v245, v55
    s_mov_b32 m0, s23
    s_and_b64 s[54:55], s[54:55], vcc
    s_cmp_eq_u64 s[54:55], -1
    s_cbranch_scc0 C_kvp
C_kvp_r:
    buffer_load_dwordx4 v247, s[68:71], s22 offen offset:0 sc1 lds
    buffer_load_dwordx4 v247, s[68:71], s22 offen offset:1024 sc1 lds
    buffer_load_dwordx4 v247, s[68:71], s22 offen offset:2048 sc1 lds
    buffer_load_dwordx4 v247, s[68:71], s22 offen offset:3072 sc1 lds
    v_mfma_f32_16x16x32_bf16 v[64:67], v[160:163], v[128:131], v[64:67]
    ds_read_b128 v[200:203], v10 offset:0
    v_mfma_f32_16x16x32_bf16 v[68:71], v[164:167], v[128:131], v[68:71]
    ds_read_b128 v[204:207], v10 offset:2048
    v_mfma_f32_16x16x32_bf16 v[76:79], v[164:167], v[132:135], v[76:79]
    ds_read_b128 v[168:171], v6 offset:0
    v_mfma_f32_16x16x32_bf16 v[72:75], v[160:163], v[132:135], v[72:75]
    ds_read_b128 v[172:175], v6 offset:2048
    v_mfma_f32_16x16x32_bf16 v[80:83], v[160:163], v[136:139], v[80:83]
    ds_read_b128 v[176:179], v6 offset:4096
    v_mfma_f32_16x16x32_bf16 v[84:87], v[164:167], v[136:139], v[84:87]
    ds_read_b128 v[180:183], v6 offset:6144
    v_mfma_f32_16x16x32_bf16 v[92:95], v[164:167], v[140:143], v[92:95]
    ds_read_b128 v[184:187], v6 offset:8192
    v_mfma_f32_16x16x32_bf16 v[88:91], v[160:163], v[140:143], v[88:91]
    ds_read_b128 v[188:191], v6 offset:10240
    v_mfma_f32_16x16x32_bf16 v[96:99], v[160:163], v[144:147], v[96:99]
    ds_read_b128 v[192:195], v6 offset:12288
    v_mfma_f32_16x16x32_bf16 v[100:103], v[164:167], v[144:147], v[100:103]
    ds_read_b128 v[196:199], v6 offset:14336
    v_mfma_f32_16x16x32_bf16 v[108:111], v[164:167], v[148:151], v[108:111]
    v_mfma_f32_16x16x32_bf16 v[104:107], v[160:163], v[148:151], v[104:107]
    v_mfma_f32_16x16x32_bf16 v[112:115], v[160:163], v[152:155], v[112:115]
    v_mfma_f32_16x16x32_bf16 v[116:119], v[164:167], v[152:155], v[116:119]
    v_mfma_f32_16x16x32_bf16 v[124:127], v[164:167], v[156:159], v[124:127]
    v_mfma_f32_16x16x32_bf16 v[120:123], v[160:163], v[156:159], v[120:123]
    s_waitcnt lgkmcnt(0)
    s_barrier
    v_mfma_f32_16x16x32_bf16 v[64:67], v[200:203], v[168:171], v[64:67]
    ds_read_b128 v[160:163], v8 offset:32768
    v_mfma_f32_16x16x32_bf16 v[68:71], v[204:207], v[168:171], v[68:71]
    ds_read_b128 v[164:167], v8 offset:34816
    v_mfma_f32_16x16x32_bf16 v[76:79], v[204:207], v[172:175], v[76:79]
    ds_read_b128 v[128:131], v4 offset:32768
    v_mfma_f32_16x16x32_bf16 v[72:75], v[200:203], v[172:175], v[72:75]
    ds_read_b128 v[132:135], v4 offset:34816
    v_mfma_f32_16x16x32_bf16 v[80:83], v[200:203], v[176:179], v[80:83]
    ds_read_b128 v[136:139], v4 offset:36864
    v_mfma_f32_16x16x32_bf16 v[84:87], v[204:207], v[176:179], v[84:87]
    ds_read_b128 v[140:143], v4 offset:38912
    v_mfma_f32_16x16x32_bf16 v[92:95], v[204:207], v[180:183], v[92:95]
    ds_read_b128 v[144:147], v4 offset:40960
    v_mfma_f32_16x16x32_bf16 v[88:91], v[200:203], v[180:183], v[88:91]
    ds_read_b128 v[148:151], v4 offset:43008
    v_mfma_f32_16x16x32_bf16 v[96:99], v[200:203], v[184:187], v[96:99]
    ds_read_b128 v[152:155], v4 offset:45056
    v_mfma_f32_16x16x32_bf16 v[100:103], v[204:207], v[184:187], v[100:103]
    ds_read_b128 v[156:159], v4 offset:47104
    v_mfma_f32_16x16x32_bf16 v[108:111], v[204:207], v[188:191], v[108:111]
    v_mfma_f32_16x16x32_bf16 v[104:107], v[200:203], v[188:191], v[104:107]
    v_mfma_f32_16x16x32_bf16 v[112:115], v[200:203], v[192:195], v[112:115]
    v_mfma_f32_16x16x32_bf16 v[116:119], v[204:207], v[192:195], v[116:119]
    v_mfma_f32_16x16x32_bf16 v[124:127], v[204:207], v[196:199], v[124:127]
    v_mfma_f32_16x16x32_bf16 v[120:123], v[200:203], v[196:199], v[120:123]
    s_cmp_eq_u32 s34, 14
    s_waitcnt lgkmcnt(0)
    s_cbranch_scc1 C_x14
C_x14_r:
    v_mfma_f32_16x16x32_bf16 v[64:67], v[160:163], v[128:131], v[64:67]
    ds_read_b128 v[200:203], v10 offset:32768
    v_mfma_f32_16x16x32_bf16 v[68:71], v[164:167], v[128:131], v[68:71]
    ds_read_b128 v[204:207], v10 offset:34816
    v_mfma_f32_16x16x32_bf16 v[76:79], v[164:167], v[132:135], v[76:79]
    ds_read_b128 v[168:171], v6 offset:32768
    v_mfma_f32_16x16x32_bf16 v[72:75], v[160:163], v[132:135], v[72:75]
    ds_read_b128 v[172:175], v6 offset:34816
    v_mfma_f32_16x16x32_bf16 v[80:83], v[160:163], v[136:139], v[80:83]
    ds_read_b128 v[176:179], v6 offset:36864
    v_mfma_f32_16x16x32_bf16 v[84:87], v[164:167], v[136:139], v[84:87]
    ds_read_b128 v[180:183], v6 offset:38912
    v_mfma_f32_16x16x32_bf16 v[92:95], v[164:167], v[140:143], v[92:95]
    ds_read_b128 v[184:187], v6 offset:40960
    v_mfma_f32_16x16x32_bf16 v[88:91], v[160:163], v[140:143], v[88:91]
    ds_read_b128 v[188:191], v6 offset:43008
    v_mfma_f32_16x16x32_bf16 v[96:99], v[160:163], v[144:147], v[96:99]
    ds_read_b128 v[192:195], v6 offset:45056
    v_mfma_f32_16x16x32_bf16 v[100:103], v[164:167], v[144:147], v[100:103]
    ds_read_b128 v[196:199], v6 offset:47104
    v_mfma_f32_16x16x32_bf16 v[108:111], v[164:167], v[148:151], v[108:111]
    v_mfma_f32_16x16x32_bf16 v[104:107], v[160:163], v[148:151], v[104:107]
    v_mfma_f32_16x16x32_bf16 v[112:115], v[160:163], v[152:155], v[112:115]
    v_mfma_f32_16x16x32_bf16 v[116:119], v[164:167], v[152:155], v[116:119]
    v_mfma_f32_16x16x32_bf16 v[124:127], v[164:167], v[156:159], v[124:127]
    v_mfma_f32_16x16x32_bf16 v[120:123], v[160:163], v[156:159], v[120:123]
    s_waitcnt lgkmcnt(0)
    s_barrier
    v_mfma_f32_16x16x32_bf16 v[64:67], v[200:203], v[168:171], v[64:67]
    ds_read_b128 v[160:163], v9 offset:0
    v_mfma_f32_16x16x32_bf16 v[68:71], v[204:207], v[168:171], v[68:71]
    ds_read_b128 v[164:167], v9 offset:2048
    v_mfma_f32_16x16x32_bf16 v[76:79], v[204:207], v[172:175], v[76:79]
    ds_read_b128 v[128:131], v5 offset:0
    v_mfma_f32_16x16x32_bf16 v[72:75], v[200:203], v[172:175], v[72:75]
    ds_read_b128 v[132:135], v5 offset:2048
    v_mfma_f32_16x16x32_bf16 v[80:83], v[200:203], v[176:179], v[80:83]
    ds_read_b128 v[136:139], v5 offset:4096
    v_mfma_f32_16x16x32_bf16 v[84:87], v[204:207], v[176:179], v[84:87]
    ds_read_b128 v[140:143], v5 offset:6144
    v_mfma_f32_16x16x32_bf16 v[92:95], v[204:207], v[180:183], v[92:95]
    ds_read_b128 v[144:147], v5 offset:8192
    v_mfma_f32_16x16x32_bf16 v[88:91], v[200:203], v[180:183], v[88:91]
    ds_read_b128 v[148:151], v5 offset:10240
    v_mfma_f32_16x16x32_bf16 v[96:99], v[200:203], v[184:187], v[96:99]
    ds_read_b128 v[152:155], v5 offset:12288
    v_mfma_f32_16x16x32_bf16 v[100:103], v[204:207], v[184:187], v[100:103]
    ds_read_b128 v[156:159], v5 offset:14336
    v_mfma_f32_16x16x32_bf16 v[108:111], v[204:207], v[188:191], v[108:111]
    v_mfma_f32_16x16x32_bf16 v[104:107], v[200:203], v[188:191], v[104:107]
    v_mfma_f32_16x16x32_bf16 v[112:115], v[200:203], v[192:195], v[112:115]
    v_mfma_f32_16x16x32_bf16 v[116:119], v[204:207], v[192:195], v[116:119]
    v_mfma_f32_16x16x32_bf16 v[124:127], v[204:207], v[196:199], v[124:127]
    v_mfma_f32_16x16x32_bf16 v[120:123], v[200:203], v[196:199], v[120:123]
    s_cmp_eq_u32 s34, 15
    s_waitcnt lgkmcnt(0)
    s_cbranch_scc1 C_x15
C_x15_r:
    v_mfma_f32_16x16x32_bf16 v[64:67], v[160:163], v[128:131], v[64:67]
    ds_read_b128 v[200:203], v11 offset:0
    v_mfma_f32_16x16x32_bf16 v[68:71], v[164:167], v[128:131], v[68:71]
    ds_read_b128 v[204:207], v11 offset:2048
    v_mfma_f32_16x16x32_bf16 v[76:79], v[164:167], v[132:135], v[76:79]
    ds_read_b128 v[168:171], v7 offset:0
    v_mfma_f32_16x16x32_bf16 v[72:75], v[160:163], v[132:135], v[72:75]
    ds_read_b128 v[172:175], v7 offset:2048
    v_mfma_f32_16x16x32_bf16 v[80:83], v[160:163], v[136:139], v[80:83]
    ds_read_b128 v[176:179], v7 offset:4096
    v_mfma_f32_16x16x32_bf16 v[84:87], v[164:167], v[136:139], v[84:87]
    ds_read_b128 v[180:183], v7 offset:6144
    v_mfma_f32_16x16x32_bf16 v[92:95], v[164:167], v[140:143], v[92:95]
    ds_read_b128 v[184:187], v7 offset:8192
    v_mfma_f32_16x16x32_bf16 v[88:91], v[160:163], v[140:143], v[88:91]
    ds_read_b128 v[188:191], v7 offset:10240
    v_mfma_f32_16x16x32_bf16 v[96:99], v[160:163], v[144:147], v[96:99]
    ds_read_b128 v[192:195], v7 offset:12288
    v_mfma_f32_16x16x32_bf16 v[100:103], v[164:167], v[144:147], v[100:103]
    ds_read_b128 v[196:199], v7 offset:14336
    v_mfma_f32_16x16x32_bf16 v[108:111], v[164:167], v[148:151], v[108:111]
    v_mfma_f32_16x16x32_bf16 v[104:107], v[160:163], v[148:151], v[104:107]
    v_mfma_f32_16x16x32_bf16 v[112:115], v[160:163], v[152:155], v[112:115]
    v_mfma_f32_16x16x32_bf16 v[116:119], v[164:167], v[152:155], v[116:119]
    v_mfma_f32_16x16x32_bf16 v[124:127], v[164:167], v[156:159], v[124:127]
    v_mfma_f32_16x16x32_bf16 v[120:123], v[160:163], v[156:159], v[120:123]
    s_waitcnt vmcnt(0)
    s_waitcnt lgkmcnt(0)
    v_mov_b32 v3, 1
    v_mov_b32 v15, 2
    ds_write_b32 v63, v3 offset:64
    ds_write_b32 v63, v54 offset:16
    v_mfma_f32_16x16x32_bf16 v[64:67], v[200:203], v[168:171], v[64:67]
    v_mfma_f32_16x16x32_bf16 v[68:71], v[204:207], v[168:171], v[68:71]
    v_mfma_f32_16x16x32_bf16 v[76:79], v[204:207], v[172:175], v[76:79]
    v_mfma_f32_16x16x32_bf16 v[72:75], v[200:203], v[172:175], v[72:75]
    v_mfma_f32_16x16x32_bf16 v[80:83], v[200:203], v[176:179], v[80:83]
    v_mfma_f32_16x16x32_bf16 v[84:87], v[204:207], v[176:179], v[84:87]
    v_mfma_f32_16x16x32_bf16 v[92:95], v[204:207], v[180:183], v[92:95]
    v_mfma_f32_16x16x32_bf16 v[88:91], v[200:203], v[180:183], v[88:91]
    v_mfma_f32_16x16x32_bf16 v[96:99], v[200:203], v[184:187], v[96:99]
    v_mfma_f32_16x16x32_bf16 v[100:103], v[204:207], v[184:187], v[100:103]
    v_mfma_f32_16x16x32_bf16 v[108:111], v[204:207], v[188:191], v[108:111]
    v_mfma_f32_16x16x32_bf16 v[104:107], v[200:203], v[188:191], v[104:107]
    v_mfma_f32_16x16x32_bf16 v[112:115], v[200:203], v[192:195], v[112:115]
    v_mfma_f32_16x16x32_bf16 v[116:119], v[204:207], v[192:195], v[116:119]
    v_mfma_f32_16x16x32_bf16 v[124:127], v[204:207], v[196:199], v[124:127]
    v_mfma_f32_16x16x32_bf16 v[120:123], v[200:203], v[196:199], v[120:123]
    s_nop 3
    v_pk_fma_f32 v[136:137], v[16:17], v[64:65], v[72:73]
    v_pk_fma_f32 v[140:141], v[16:17], v[68:69], v[76:77]
    v_pk_fma_f32 v[138:139], v[18:19], v[66:67], v[74:75]
    v_pk_fma_f32 v[142:143], v[18:19], v[70:71], v[78:79]
    v_pk_fma_f32 v[136:137], v[20:21], v[68:69], v[136:137] neg_lo:[1,0,0] neg_hi:[1,0,0]
    v_pk_fma_f32 v[140:141], v[20:21], v[64:65], v[140:141]
    v_pk_fma_f32 v[138:139], v[22:23], v[70:71], v[138:139] neg_lo:[1,0,0] neg_hi:[1,0,0]
    v_pk_fma_f32 v[142:143], v[22:23], v[66:67], v[142:143]
    v_pk_fma_f32 v[128:129], v[16:17], v[136:137], v[80:81]
    v_pk_fma_f32 v[132:133], v[16:17], v[140:141], v[84:85]
    v_pk_fma_f32 v[130:131], v[18:19], v[138:139], v[82:83]
    v_pk_fma_f32 v[134:135], v[18:19], v[142:143], v[86:87]
    v_pk_fma_f32 v[128:129], v[20:21], v[140:141], v[128:129] neg_lo:[1,0,0] neg_hi:[1,0,0]
    v_pk_fma_f32 v[132:133], v[20:21], v[136:137], v[132:133]
    v_pk_fma_f32 v[130:131], v[22:23], v[142:143], v[130:131] neg_lo:[1,0,0] neg_hi:[1,0,0]
    v_pk_fma_f32 v[134:135], v[22:23], v[138:139], v[134:135]
    v_pk_fma_f32 v[136:137], v[16:17], v[128:129], v[88:89]
    v_pk_fma_f32 v[140:141], v[16:17], v[132:133], v[92:93]
    v_pk_fma_f32 v[138:139], v[18:19], v[130:131], v[90:91]
    v_pk_fma_f32 v[142:143], v[18:19], v[134:135], v[94:95]
    v_pk_fma_f32 v[136:137], v[20:21], v[132:133], v[136:137] neg_lo:[1,0,0] neg_hi:[1,0,0]
    v_pk_fma_f32 v[140:141], v[20:21], v[128:129], v[140:141]
    v_pk_fma_f32 v[138:139], v[22:23], v[134:135], v[138:139] neg_lo:[1,0,0] neg_hi:[1,0,0]
    v_pk_fma_f32 v[142:143], v[22:23], v[130:131], v[142:143]
    v_pk_fma_f32 v[128:129], v[16:17], v[136:137], v[96:97]
    v_pk_fma_f32 v[132:133], v[16:17], v[140:141], v[100:101]
    v_pk_fma_f32 v[130:131], v[18:19], v[138:139], v[98:99]
    v_pk_fma_f32 v[134:135], v[18:19], v[142:143], v[102:103]
    v_pk_fma_f32 v[128:129], v[20:21], v[140:141], v[128:129] neg_lo:[1,0,0] neg_hi:[1,0,0]
    v_pk_fma_f32 v[132:133], v[20:21], v[136:137], v[132:133]
    v_pk_fma_f32 v[130:131], v[22:23], v[142:143], v[130:131] neg_lo:[1,0,0] neg_hi:[1,0,0]
    v_pk_fma_f32 v[134:135], v[22:23], v[138:139], v[134:135]
    v_pk_fma_f32 v[136:137], v[16:17], v[128:129], v[104:105]
    v_pk_fma_f32 v[140:141], v[16:17], v[132:133], v[108:109]
    v_pk_fma_f32 v[138:139], v[18:19], v[130:131], v[106:107]
    v_pk_fma_f32 v[142:143], v[18:19], v[134:135], v[110:111]
    v_pk_fma_f32 v[136:137], v[20:21], v[132:133], v[136:137] neg_lo:[1,0,0] neg_hi:[1,0,0]
    v_pk_fma_f32 v[140:141], v[20:21], v[128:129], v[140:141]
    v_pk_fma_f32 v[138:139], v[22:23], v[134:135], v[138:139] neg_lo:[1,0,0] neg_hi:[1,0,0]
    v_pk_fma_f32 v[142:143], v[22:23], v[130:131], v[142:143]
    v_pk_fma_f32 v[128:129], v[16:17], v[136:137], v[112:113]
    v_pk_fma_f32 v[132:133], v[16:17], v[140:141], v[116:117]
    v_pk_fma_f32 v[130:131], v[18:19], v[138:139], v[114:115]
    v_pk_fma_f32 v[134:135], v[18:19], v[142:143], v[118:119]
    v_pk_fma_f32 v[128:129], v[20:21], v[140:141], v[128:129] neg_lo:[1,0,0] neg_hi:[1,0,0]
    v_pk_fma_f32 v[132:133], v[20:21], v[136:137], v[132:133]
    v_pk_fma_f32 v[130:131], v[22:23], v[142:143], v[130:131] neg_lo:[1,0,0] neg_hi:[1,0,0]
    v_pk_fma_f32 v[134:135], v[22:23], v[138:139], v[134:135]
    v_pk_fma_f32 v[136:137], v[16:17], v[128:129], v[120:121]
    v_pk_fma_f32 v[140:141], v[16:17], v[132:133], v[124:125]
    v_pk_fma_f32 v[138:139], v[18:19], v[130:131], v[122:123]
    v_pk_fma_f32 v[142:143], v[18:19], v[134:135], v[126:127]
    v_pk_fma_f32 v[136:137], v[20:21], v[132:133], v[136:137] neg_lo:[1,0,0] neg_hi:[1,0,0]
    v_pk_fma_f32 v[140:141], v[20:21], v[128:129], v[140:141]
    v_pk_fma_f32 v[138:139], v[22:23], v[134:135], v[138:139] neg_lo:[1,0,0] neg_hi:[1,0,0]
    v_pk_fma_f32 v[142:143], v[22:23], v[130:131], v[142:143]
    v_mul_f32_dpp v144, v32, v136 row_mirror row_mask:0xf bank_mask:0xf
    v_mul_f32_dpp v148, v32, v140 row_mirror row_mask:0xf bank_mask:0xf
    v_mul_f32_dpp v145, v33, v137 row_mirror row_mask:0xf bank_mask:0xf
    v_mul_f32_dpp v149, v33, v141 row_mirror row_mask:0xf bank_mask:0xf
    v_mul_f32_dpp v146, v34, v138 row_mirror row_mask:0xf bank_mask:0xf
    v_mul_f32_dpp v150, v34, v142 row_mirror row_mask:0xf bank_mask:0xf
    v_mul_f32_dpp v147, v35, v139 row_mirror row_mask:0xf bank_mask:0xf
    v_mul_f32_dpp v151, v35, v143 row_mirror row_mask:0xf bank_mask:0xf
    v_fmac_f32_dpp v144, -v36, v140 row_mirror row_mask:0xf bank_mask:0xf
    v_fmac_f32_dpp v148, v36, v136 row_mirror row_mask:0xf bank_mask:0xf
    v_fmac_f32_dpp v145, -v37, v141 row_mirror row_mask:0xf bank_mask:0xf
    v_fmac_f32_dpp v149, v37, v137 row_mirror row_mask:0xf bank_mask:0xf
    v_fmac_f32_dpp v146, -v38, v142 row_mirror row_mask:0xf bank_mask:0xf
    v_fmac_f32_dpp v150, v38, v138 row_mirror row_mask:0xf bank_mask:0xf
    v_fmac_f32_dpp v147, -v39, v143 row_mirror row_mask:0xf bank_mask:0xf
    v_fmac_f32_dpp v151, v39, v139 row_mirror row_mask:0xf bank_mask:0xf
    v_add_f32_dpp v144, v144, v144 quad_perm:[1,0,3,2] row_mask:0xf bank_mask:0xf
    v_add_f32_dpp v148, v148, v148 quad_perm:[1,0,3,2] row_mask:0xf bank_mask:0xf
    v_add_f32_dpp v145, v145, v145 quad_perm:[1,0,3,2] row_mask:0xf bank_mask:0xf
    v_add_f32_dpp v149, v149, v149 quad_perm:[1,0,3,2] row_mask:0xf bank_mask:0xf
    v_add_f32_dpp v146, v146, v146 quad_perm:[1,0,3,2] row_mask:0xf bank_mask:0xf
    v_add_f32_dpp v150, v150, v150 quad_perm:[1,0,3,2] row_mask:0xf bank_mask:0xf
    v_add_f32_dpp v147, v147, v147 quad_perm:[1,0,3,2] row_mask:0xf bank_mask:0xf
    v_add_f32_dpp v151, v151, v151 quad_perm:[1,0,3,2] row_mask:0xf bank_mask:0xf
    v_cndmask_b32 v44, v144, v145, s[48:49]
    v_cndmask_b32 v45, v146, v147, s[48:49]
    v_cndmask_b32 v46, v148, v149, s[48:49]
    v_cndmask_b32 v47, v150, v151, s[48:49]
    s_nop 0
    v_add_f32_dpp v44, v44, v44 quad_perm:[2,3,0,1] row_mask:0xf bank_mask:0xf
    v_add_f32_dpp v45, v45, v45 quad_perm:[2,3,0,1] row_mask:0xf bank_mask:0xf
    v_add_f32_dpp v46, v46, v46 quad_perm:[2,3,0,1] row_mask:0xf bank_mask:0xf
    v_add_f32_dpp v47, v47, v47 quad_perm:[2,3,0,1] row_mask:0xf bank_mask:0xf
    v_cndmask_b32 v52, v44, v45, s[50:51]
    v_cndmask_b32 v53, v46, v47, s[50:51]
    s_nop 0
    v_add_f32_dpp v52, v52, v52 row_ror:4 row_mask:0xf bank_mask:0xf
    v_add_f32_dpp v53, v53, v53 row_ror:4 row_mask:0xf bank_mask:0xf
    s_nop 0
    v_add_f32_dpp v52, v52, v52 row_ror:8 row_mask:0xf bank_mask:0xf
    v_add_f32_dpp v53, v53, v53 row_ror:8 row_mask:0xf bank_mask:0xf
    s_mov_b64 exec, s[52:53]
    buffer_store_dwordx4 v[52:55], v60, s[12:15], 0 offen sc1
    s_mov_b64 exec, -1
    ds_write_b32 v63, v15 offset:64
    s_and_b32 s7, s3, 0
    s_add_u32 s7, s7, s4
    s_and_b32 s36, s7, 15
    v_lshrrev_b32 v1, 3, v2
    v_and_b32 v44, 7, v2
    v_xor_b32 v44, v44, v13
    v_lshlrev_b32 v44, 4, v44
    v_lshl_add_u32 v44, v1, 13, v44
    s_lshl_b32 s7, s4, 6
    s_add_u32 s7, s7, s5
    s_lshl_b32 s7, s7, 11
    v_add_u32 v244, s7, v44
    v_xor_b32 v245, 64, v244
    v_add_u32 v245, 64512, v245
    v_xor_b32 v246, 32, v244
    v_xor_b32 v247, 32, v245
    s_lshl_b32 s20, s36, 7
    s_and_b32 s22, s20, 1024
    s_xor_b32 s23, s22, 1024
    s_lshl_b32 s21, s5, 11
    s_add_u32 s7, s20, 768
    s_and_b32 s7, s7, 1023
    s_or_b32 s7, s7, s22
    buffer_load_dwordx4 v[160:163], v244, s[24:27], s7 offen offset:0
    buffer_load_dwordx4 v[164:167], v245, s[24:27], s7 offen offset:1024
    buffer_load_dwordx4 v[168:171], v246, s[80:83], s7 offen offset:0
    buffer_load_dwordx4 v[172:175], v247, s[80:83], s7 offen offset:1024
    s_add_u32 s7, s20, 896
    s_and_b32 s7, s7, 1023
    s_or_b32 s7, s7, s22
    buffer_load_dwordx4 v[176:179], v244, s[24:27], s7 offen offset:0
    buffer_load_dwordx4 v[180:183], v245, s[24:27], s7 offen offset:1024
    buffer_load_dwordx4 v[184:187], v246, s[80:83], s7 offen offset:0
    buffer_load_dwordx4 v[188:191], v247, s[80:83], s7 offen offset:1024
    s_add_u32 s7, s20, 1024
    s_and_b32 s7, s7, 1023
    s_or_b32 s7, s7, s23
    buffer_load_dwordx4 v[192:195], v244, s[24:27], s7 offen offset:0
    buffer_load_dwordx4 v[196:199], v245, s[24:27], s7 offen offset:1024
    buffer_load_dwordx4 v[200:203], v246, s[80:83], s7 offen offset:0
    buffer_load_dwordx4 v[204:207], v247, s[80:83], s7 offen offset:1024
    s_add_u32 s7, s20, 1152
    s_and_b32 s7, s7, 1023
    s_or_b32 s7, s7, s23
    buffer_load_dwordx4 v[224:227], v244, s[24:27], s7 offen offset:0
    buffer_load_dwordx4 v[228:231], v245, s[24:27], s7 offen offset:1024
    buffer_load_dwordx4 v[232:235], v246, s[80:83], s7 offen offset:0
    buffer_load_dwordx4 v[236:239], v247, s[80:83], s7 offen offset:1024
    v_mov_b32_dpp v128, v136 row_shr:1 row_mask:0xf bank_mask:0xf bound_ctrl:0
    v_mov_b32_dpp v129, v137 row_shr:1 row_mask:0xf bank_mask:0xf bound_ctrl:0
    v_mov_b32_dpp v130, v138 row_shr:1 row_mask:0xf bank_mask:0xf bound_ctrl:0
    v_mov_b32_dpp v131, v139 row_shr:1 row_mask:0xf bank_mask:0xf bound_ctrl:0
    v_mov_b32_dpp v132, v140 row_shr:1 row_mask:0xf bank_mask:0xf bound_ctrl:0
    v_mov_b32_dpp v133, v141 row_shr:1 row_mask:0xf bank_mask:0xf bound_ctrl:0
    v_mov_b32_dpp v134, v142 row_shr:1 row_mask:0xf bank_mask:0xf bound_ctrl:0
    v_mov_b32_dpp v135, v143 row_shr:1 row_mask:0xf bank_mask:0xf bound_ctrl:0
    s_nop 0
    v_mov_b32_dpp v144, v128 row_shr:1 row_mask:0xf bank_mask:0xf bound_ctrl:0
    v_mov_b32_dpp v145, v129 row_shr:1 row_mask:0xf bank_mask:0xf bound_ctrl:0
    v_mov_b32_dpp v146, v130 row_shr:1 row_mask:0xf bank_mask:0xf bound_ctrl:0
    v_mov_b32_dpp v147, v131 row_shr:1 row_mask:0xf bank_mask:0xf bound_ctrl:0
    v_mov_b32_dpp v148, v132 row_shr:1 row_mask:0xf bank_mask:0xf bound_ctrl:0
    v_mov_b32_dpp v149, v133 row_shr:1 row_mask:0xf bank_mask:0xf bound_ctrl:0
    v_mov_b32_dpp v150, v134 row_shr:1 row_mask:0xf bank_mask:0xf bound_ctrl:0
    v_mov_b32_dpp v151, v135 row_shr:1 row_mask:0xf bank_mask:0xf bound_ctrl:0
    v_fmac_f32_dpp v128, v32, v144 row_newbcast:1 row_mask:0xf bank_mask:0xf
    v_fmac_f32_dpp v129, v33, v145 row_newbcast:1 row_mask:0xf bank_mask:0xf
    v_fmac_f32_dpp v130, v34, v146 row_newbcast:1 row_mask:0xf bank_mask:0xf
    v_fmac_f32_dpp v131, v35, v147 row_newbcast:1 row_mask:0xf bank_mask:0xf
    v_fmac_f32_dpp v132, v32, v148 row_newbcast:1 row_mask:0xf bank_mask:0xf
    v_fmac_f32_dpp v133, v33, v149 row_newbcast:1 row_mask:0xf bank_mask:0xf
    v_fmac_f32_dpp v134, v34, v150 row_newbcast:1 row_mask:0xf bank_mask:0xf
    v_fmac_f32_dpp v135, v35, v151 row_newbcast:1 row_mask:0xf bank_mask:0xf
    v_fmac_f32_dpp v128, -v36, v148 row_newbcast:1 row_mask:0xf bank_mask:0xf
    v_fmac_f32_dpp v129, -v37, v149 row_newbcast:1 row_mask:0xf bank_mask:0xf
    v_fmac_f32_dpp v130, -v38, v150 row_newbcast:1 row_mask:0xf bank_mask:0xf
    v_fmac_f32_dpp v131, -v39, v151 row_newbcast:1 row_mask:0xf bank_mask:0xf
    v_fmac_f32_dpp v132, v36, v144 row_newbcast:1 row_mask:0xf bank_mask:0xf
    v_fmac_f32_dpp v133, v37, v145 row_newbcast:1 row_mask:0xf bank_mask:0xf
    v_fmac_f32_dpp v134, v38, v146 row_newbcast:1 row_mask:0xf bank_mask:0xf
    v_fmac_f32_dpp v135, v39, v147 row_newbcast:1 row_mask:0xf bank_mask:0xf
    v_mov_b32_dpp v144, v128 row_shr:2 row_mask:0xf bank_mask:0xf bound_ctrl:0
    v_mov_b32_dpp v145, v129 row_shr:2 row_mask:0xf bank_mask:0xf bound_ctrl:0
    v_mov_b32_dpp v146, v130 row_shr:2 row_mask:0xf bank_mask:0xf bound_ctrl:0
    v_mov_b32_dpp v147, v131 row_shr:2 row_mask:0xf bank_mask:0xf bound_ctrl:0
    v_mov_b32_dpp v148, v132 row_shr:2 row_mask:0xf bank_mask:0xf bound_ctrl:0
    v_mov_b32_dpp v149, v133 row_shr:2 row_mask:0xf bank_mask:0xf bound_ctrl:0
    v_mov_b32_dpp v150, v134 row_shr:2 row_mask:0xf bank_mask:0xf bound_ctrl:0
    v_mov_b32_dpp v151, v135 row_shr:2 row_mask:0xf bank_mask:0xf bound_ctrl:0
    v_fmac_f32_dpp v128, v32, v144 row_newbcast:2 row_mask:0xf bank_mask:0xf
    v_fmac_f32_dpp v129, v33, v145 row_newbcast:2 row_mask:0xf bank_mask:0xf
    v_fmac_f32_dpp v130, v34, v146 row_newbcast:2 row_mask:0xf bank_mask:0xf
    v_fmac_f32_dpp v131, v35, v147 row_newbcast:2 row_mask:0xf bank_mask:0xf
    v_fmac_f32_dpp v132, v32, v148 row_newbcast:2 row_mask:0xf bank_mask:0xf
    v_fmac_f32_dpp v133, v33, v149 row_newbcast:2 row_mask:0xf bank_mask:0xf
    v_fmac_f32_dpp v134, v34, v150 row_newbcast:2 row_mask:0xf bank_mask:0xf
    v_fmac_f32_dpp v135, v35, v151 row_newbcast:2 row_mask:0xf bank_mask:0xf
    v_fmac_f32_dpp v128, -v36, v148 row_newbcast:2 row_mask:0xf bank_mask:0xf
    v_fmac_f32_dpp v129, -v37, v149 row_newbcast:2 row_mask:0xf bank_mask:0xf
    v_fmac_f32_dpp v130, -v38, v150 row_newbcast:2 row_mask:0xf bank_mask:0xf
    v_fmac_f32_dpp v131, -v39, v151 row_newbcast:2 row_mask:0xf bank_mask:0xf
    v_fmac_f32_dpp v132, v36, v144 row_newbcast:2 row_mask:0xf bank_mask:0xf
    v_fmac_f32_dpp v133, v37, v145 row_newbcast:2 row_mask:0xf bank_mask:0xf
    v_fmac_f32_dpp v134, v38, v146 row_newbcast:2 row_mask:0xf bank_mask:0xf
    v_fmac_f32_dpp v135, v39, v147 row_newbcast:2 row_mask:0xf bank_mask:0xf
    v_mov_b32_dpp v144, v128 row_shr:4 row_mask:0xf bank_mask:0xf bound_ctrl:0
    v_mov_b32_dpp v145, v129 row_shr:4 row_mask:0xf bank_mask:0xf bound_ctrl:0
    v_mov_b32_dpp v146, v130 row_shr:4 row_mask:0xf bank_mask:0xf bound_ctrl:0
    v_mov_b32_dpp v147, v131 row_shr:4 row_mask:0xf bank_mask:0xf bound_ctrl:0
    v_mov_b32_dpp v148, v132 row_shr:4 row_mask:0xf bank_mask:0xf bound_ctrl:0
    v_mov_b32_dpp v149, v133 row_shr:4 row_mask:0xf bank_mask:0xf bound_ctrl:0
    v_mov_b32_dpp v150, v134 row_shr:4 row_mask:0xf bank_mask:0xf bound_ctrl:0
    v_mov_b32_dpp v151, v135 row_shr:4 row_mask:0xf bank_mask:0xf bound_ctrl:0
    v_fmac_f32_dpp v128, v32, v144 row_newbcast:4 row_mask:0xf bank_mask:0xf
    v_fmac_f32_dpp v129, v33, v145 row_newbcast:4 row_mask:0xf bank_mask:0xf
    v_fmac_f32_dpp v130, v34, v146 row_newbcast:4 row_mask:0xf bank_mask:0xf
    v_fmac_f32_dpp v131, v35, v147 row_newbcast:4 row_mask:0xf bank_mask:0xf
    v_fmac_f32_dpp v132, v32, v148 row_newbcast:4 row_mask:0xf bank_mask:0xf
    v_fmac_f32_dpp v133, v33, v149 row_newbcast:4 row_mask:0xf bank_mask:0xf
    v_fmac_f32_dpp v134, v34, v150 row_newbcast:4 row_mask:0xf bank_mask:0xf
    v_fmac_f32_dpp v135, v35, v151 row_newbcast:4 row_mask:0xf bank_mask:0xf
    v_fmac_f32_dpp v128, -v36, v148 row_newbcast:4 row_mask:0xf bank_mask:0xf
    v_fmac_f32_dpp v129, -v37, v149 row_newbcast:4 row_mask:0xf bank_mask:0xf
    v_fmac_f32_dpp v130, -v38, v150 row_newbcast:4 row_mask:0xf bank_mask:0xf
    v_fmac_f32_dpp v131, -v39, v151 row_newbcast:4 row_mask:0xf bank_mask:0xf
    v_fmac_f32_dpp v132, v36, v144 row_newbcast:4 row_mask:0xf bank_mask:0xf
    v_fmac_f32_dpp v133, v37, v145 row_newbcast:4 row_mask:0xf bank_mask:0xf
    v_fmac_f32_dpp v134, v38, v146 row_newbcast:4 row_mask:0xf bank_mask:0xf
    v_fmac_f32_dpp v135, v39, v147 row_newbcast:4 row_mask:0xf bank_mask:0xf
    v_mov_b32_dpp v144, v128 row_shr:8 row_mask:0xf bank_mask:0xf bound_ctrl:0
    v_mov_b32_dpp v145, v129 row_shr:8 row_mask:0xf bank_mask:0xf bound_ctrl:0
    v_mov_b32_dpp v146, v130 row_shr:8 row_mask:0xf bank_mask:0xf bound_ctrl:0
    v_mov_b32_dpp v147, v131 row_shr:8 row_mask:0xf bank_mask:0xf bound_ctrl:0
    v_mov_b32_dpp v148, v132 row_shr:8 row_mask:0xf bank_mask:0xf bound_ctrl:0
    v_mov_b32_dpp v149, v133 row_shr:8 row_mask:0xf bank_mask:0xf bound_ctrl:0
    v_mov_b32_dpp v150, v134 row_shr:8 row_mask:0xf bank_mask:0xf bound_ctrl:0
    v_mov_b32_dpp v151, v135 row_shr:8 row_mask:0xf bank_mask:0xf bound_ctrl:0
    v_fmac_f32_dpp v128, v32, v144 row_newbcast:8 row_mask:0xf bank_mask:0xf
    v_fmac_f32_dpp v129, v33, v145 row_newbcast:8 row_mask:0xf bank_mask:0xf
    v_fmac_f32_dpp v130, v34, v146 row_newbcast:8 row_mask:0xf bank_mask:0xf
    v_fmac_f32_dpp v131, v35, v147 row_newbcast:8 row_mask:0xf bank_mask:0xf
    v_fmac_f32_dpp v132, v32, v148 row_newbcast:8 row_mask:0xf bank_mask:0xf
    v_fmac_f32_dpp v133, v33, v149 row_newbcast:8 row_mask:0xf bank_mask:0xf
    v_fmac_f32_dpp v134, v34, v150 row_newbcast:8 row_mask:0xf bank_mask:0xf
    v_fmac_f32_dpp v135, v35, v151 row_newbcast:8 row_mask:0xf bank_mask:0xf
    v_fmac_f32_dpp v128, -v36, v148 row_newbcast:8 row_mask:0xf bank_mask:0xf
    v_fmac_f32_dpp v129, -v37, v149 row_newbcast:8 row_mask:0xf bank_mask:0xf
    v_fmac_f32_dpp v130, -v38, v150 row_newbcast:8 row_mask:0xf bank_mask:0xf
    v_fmac_f32_dpp v131, -v39, v151 row_newbcast:8 row_mask:0xf bank_mask:0xf
    v_fmac_f32_dpp v132, v36, v144 row_newbcast:8 row_mask:0xf bank_mask:0xf
    v_fmac_f32_dpp v133, v37, v145 row_newbcast:8 row_mask:0xf bank_mask:0xf
    v_fmac_f32_dpp v134, v38, v146 row_newbcast:8 row_mask:0xf bank_mask:0xf
    v_fmac_f32_dpp v135, v39, v147 row_newbcast:8 row_mask:0xf bank_mask:0xf
    v_mul_f32 v152, v24, v128
    v_mul_f32 v153, v25, v129
    v_mul_f32 v156, -v24, v132
    v_mul_f32 v157, -v25, v133
    v_mul_f32 v154, v26, v130
    v_mul_f32 v155, v27, v131
    v_mul_f32 v158, -v26, v134
    v_mul_f32 v159, -v27, v135
    v_fma_f32 v152, -v28, v132, v152
    v_fma_f32 v153, -v29, v133, v153
    v_fma_f32 v156, -v28, v128, v156
    v_fma_f32 v157, -v29, v129, v157
    v_fma_f32 v154, -v30, v134, v154
    v_fma_f32 v155, -v31, v135, v155
    v_fma_f32 v158, -v30, v130, v158
    v_fma_f32 v159, -v31, v131, v159
    v_mul_f32 v136, v24, v32
    v_mul_f32 v137, v25, v33
    v_mul_f32 v140, v24, v36
    v_mul_f32 v141, v25, v37
    v_mul_f32 v138, v26, v34
    v_mul_f32 v139, v27, v35
    v_mul_f32 v142, v26, v38
    v_mul_f32 v143, v27, v39
    v_fma_f32 v136, -v28, v36, v136
    v_fma_f32 v137, -v29, v37, v137
    v_fmac_f32 v140, v28, v32
    v_fmac_f32 v141, v29, v33
    v_fma_f32 v138, -v30, v38, v138
    v_fma_f32 v139, -v31, v39, v139
    v_fmac_f32 v142, v30, v34
    v_fmac_f32 v143, v31, v35
    v_mul_f32 v48, v24, v64
    v_mul_f32 v49, v25, v65
    v_mul_f32 v50, v26, v66
    v_mul_f32 v51, v27, v67
    v_fma_f32 v48, -v28, v68, v48
    v_fma_f32 v49, -v29, v69, v49
    v_fma_f32 v50, -v30, v70, v50
    v_fma_f32 v51, -v31, v71, v51
    v_mul_f32 v68, -v24, v68
    v_mul_f32 v69, -v25, v69
    v_mul_f32 v70, -v26, v70
    v_mul_f32 v71, -v27, v71
    v_fma_f32 v68, -v28, v64, v68
    v_fma_f32 v69, -v29, v65, v69
    v_fma_f32 v70, -v30, v66, v70
    v_fma_f32 v71, -v31, v67, v71
    v_mul_f32 v64, v24, v72
    v_mul_f32 v65, v25, v73
    v_mul_f32 v66, v26, v74
    v_mul_f32 v67, v27, v75
    v_fma_f32 v64, -v28, v76, v64
    v_fma_f32 v65, -v29, v77, v65
    v_fma_f32 v66, -v30, v78, v66
    v_fma_f32 v67, -v31, v79, v67
    v_mul_f32 v76, -v24, v76
    v_mul_f32 v77, -v25, v77
    v_mul_f32 v78, -v26, v78
    v_mul_f32 v79, -v27, v79
    v_fma_f32 v76, -v28, v72, v76
    v_fma_f32 v77, -v29, v73, v77
    v_fma_f32 v78, -v30, v74, v78
    v_fma_f32 v79, -v31, v75, v79
    v_mul_f32 v72, v24, v80
    v_mul_f32 v73, v25, v81
    v_mul_f32 v74, v26, v82
    v_mul_f32 v75, v27, v83
    v_fma_f32 v72, -v28, v84, v72
    v_fma_f32 v73, -v29, v85, v73
    v_fma_f32 v74, -v30, v86, v74
    v_fma_f32 v75, -v31, v87, v75
    v_mul_f32 v84, -v24, v84
    v_mul_f32 v85, -v25, v85
    v_mul_f32 v86, -v26, v86
    v_mul_f32 v87, -v27, v87
    v_fma_f32 v84, -v28, v80, v84
    v_fma_f32 v85, -v29, v81, v85
    v_fma_f32 v86, -v30, v82, v86
    v_fma_f32 v87, -v31, v83, v87
    v_mul_f32 v80, v24, v88
    v_mul_f32 v81, v25, v89
    v_mul_f32 v82, v26, v90
    v_mul_f32 v83, v27, v91
    v_fma_f32 v80, -v28, v92, v80
    v_fma_f32 v81, -v29, v93, v81
    v_fma_f32 v82, -v30, v94, v82
    v_fma_f32 v83, -v31, v95, v83
    v_mul_f32 v92, -v24, v92
    v_mul_f32 v93, -v25, v93
    v_mul_f32 v94, -v26, v94
    v_mul_f32 v95, -v27, v95
    v_fma_f32 v92, -v28, v88, v92
    v_fma_f32 v93, -v29, v89, v93
    v_fma_f32 v94, -v30, v90, v94
    v_fma_f32 v95, -v31, v91, v95
    v_mul_f32 v88, v24, v96
    v_mul_f32 v89, v25, v97
    v_mul_f32 v90, v26, v98
    v_mul_f32 v91, v27, v99
    v_fma_f32 v88, -v28, v100, v88
    v_fma_f32 v89, -v29, v101, v89
    v_fma_f32 v90, -v30, v102, v90
    v_fma_f32 v91, -v31, v103, v91
    v_mul_f32 v100, -v24, v100
    v_mul_f32 v101, -v25, v101
    v_mul_f32 v102, -v26, v102
    v_mul_f32 v103, -v27, v103
    v_fma_f32 v100, -v28, v96, v100
    v_fma_f32 v101, -v29, v97, v101
    v_fma_f32 v102, -v30, v98, v102
    v_fma_f32 v103, -v31, v99, v103
    v_mul_f32 v96, v24, v104
    v_mul_f32 v97, v25, v105
    v_mul_f32 v98, v26, v106
    v_mul_f32 v99, v27, v107
    v_fma_f32 v96, -v28, v108, v96
    v_fma_f32 v97, -v29, v109, v97
    v_fma_f32 v98, -v30, v110, v98
    v_fma_f32 v99, -v31, v111, v99
    v_mul_f32 v108, -v24, v108
    v_mul_f32 v109, -v25, v109
    v_mul_f32 v110, -v26, v110
    v_mul_f32 v111, -v27, v111
    v_fma_f32 v108, -v28, v104, v108
    v_fma_f32 v109, -v29, v105, v109
    v_fma_f32 v110, -v30, v106, v110
    v_fma_f32 v111, -v31, v107, v111
    v_mul_f32 v104, v24, v112
    v_mul_f32 v105, v25, v113
    v_mul_f32 v106, v26, v114
    v_mul_f32 v107, v27, v115
    v_fma_f32 v104, -v28, v116, v104
    v_fma_f32 v105, -v29, v117, v105
    v_fma_f32 v106, -v30, v118, v106
    v_fma_f32 v107, -v31, v119, v107
    v_mul_f32 v116, -v24, v116
    v_mul_f32 v117, -v25, v117
    v_mul_f32 v118, -v26, v118
    v_mul_f32 v119, -v27, v119
    v_fma_f32 v116, -v28, v112, v116
    v_fma_f32 v117, -v29, v113, v117
    v_fma_f32 v118, -v30, v114, v118
    v_fma_f32 v119, -v31, v115, v119
    v_mul_f32 v112, v24, v120
    v_mul_f32 v113, v25, v121
    v_mul_f32 v114, v26, v122
    v_mul_f32 v115, v27, v123
    v_fma_f32 v112, -v28, v124, v112
    v_fma_f32 v113, -v29, v125, v113
    v_fma_f32 v114, -v30, v126, v114
    v_fma_f32 v115, -v31, v127, v115
    v_mul_f32 v124, -v24, v124
    v_mul_f32 v125, -v25, v125
    v_mul_f32 v126, -v26, v126
    v_mul_f32 v127, -v27, v127
    v_fma_f32 v124, -v28, v120, v124
    v_fma_f32 v125, -v29, v121, v125
    v_fma_f32 v126, -v30, v122, v126
    v_fma_f32 v127, -v31, v123, v127
    buffer_load_dwordx4 v[24:27], v56, s[12:15], 0 offen sc1
    buffer_load_dwordx4 v[28:31], v57, s[12:15], 0 offen sc1
    buffer_load_dwordx4 v[32:35], v58, s[12:15], 0 offen sc1
    buffer_load_dwordx4 v[36:39], v59, s[12:15], 0 offen sc1
    s_mov_b32 s39, 0
C_chk:
    s_waitcnt vmcnt(0)
    v_cmp_eq_u32 vcc, v26, v54
    v_cmp_eq_u32 s[54:55], v27, v55
    s_and_b64 s[54:55], s[54:55], vcc
    s_or_b64 s[56:57], s[54:55], s[40:41]
    v_cmp_eq_u32 vcc, v30, v54
    v_cmp_eq_u32 s[54:55], v31, v55
    s_and_b64 s[54:55], s[54:55], vcc
    s_or_b64 s[58:59], s[54:55], s[42:43]
    v_cmp_eq_u32 vcc, v34, v54
    v_cmp_eq_u32 s[54:55], v35, v55
    s_and_b64 s[54:55], s[54:55], vcc
    s_or_b64 s[60:61], s[54:55], s[44:45]
    v_cmp_eq_u32 vcc, v38, v54
    v_cmp_eq_u32 s[54:55], v39, v55
    s_and_b64 s[54:55], s[54:55], vcc
    s_or_b64 s[62:63], s[54:55], s[46:47]
    s_and_b64 s[56:57], s[56:57], s[58:59]
    s_and_b64 s[60:61], s[60:61], s[62:63]
    s_and_b64 s[56:57], s[56:57], s[60:61]
    s_cmp_eq_u64 s[56:57], -1
    s_cbranch_scc1 C_ok
    s_add_u32 s39, s39, 1
    s_cmp_gt_u32 s39, 4096
    s_cbranch_scc1 C_ok
    buffer_load_dwordx4 v[24:27], v56, s[12:15], 0 offen sc1
    buffer_load_dwordx4 v[28:31], v57, s[12:15], 0 offen sc1
    buffer_load_dwordx4 v[32:35], v58, s[12:15], 0 offen sc1
    buffer_load_dwordx4 v[36:39], v59, s[12:15], 0 offen sc1
    s_branch C_chk
C_ok:
    ds_write_b32 v63, v3 offset:64
    v_fma_f32 v32, v36, v42, v32
    v_fma_f32 v33, v36, v43, v33
    v_fma_f32 v32, -v37, v43, v32
    v_fmac_f32 v33, v37, v42
    v_fma_f32 v28, v32, v42, v28
    v_fma_f32 v29, v32, v43, v29
    v_fma_f32 v28, -v33, v43, v28
    v_fmac_f32 v29, v33, v42
    v_fma_f32 v24, v28, v42, v24
    v_fma_f32 v25, v28, v43, v25
    v_fma_f32 v24, -v29, v43, v24
    v_fmac_f32 v25, v29, v42
    v_mul_f32 v44, v24, v40
    v_mul_f32 v45, v24, v41
    v_fma_f32 v44, -v25, v41, v44
    v_fmac_f32 v45, v25, v40
    s_nop 0
    v_add_f32_dpp v44, v44, v44 row_ror:4 row_mask:0xf bank_mask:0xf
    v_add_f32_dpp v45, v45, v45 row_ror:4 row_mask:0xf bank_mask:0xf
    s_nop 0
    v_add_f32_dpp v44, v44, v44 row_ror:8 row_mask:0xf bank_mask:0xf
    v_add_f32_dpp v45, v45, v45 row_ror:8 row_mask:0xf bank_mask:0xf
    s_nop 0
    v_mov_b32_dpp v144, v44 quad_perm:[0,0,0,0] row_mask:0xf bank_mask:0xf
    v_mov_b32_dpp v148, v45 quad_perm:[0,0,0,0] row_mask:0xf bank_mask:0xf
    v_mov_b32_dpp v145, v44 quad_perm:[1,1,1,1] row_mask:0xf bank_mask:0xf
    v_mov_b32_dpp v149, v45 quad_perm:[1,1,1,1] row_mask:0xf bank_mask:0xf
    v_mov_b32_dpp v146, v44 quad_perm:[2,2,2,2] row_mask:0xf bank_mask:0xf
    v_mov_b32_dpp v150, v45 quad_perm:[2,2,2,2] row_mask:0xf bank_mask:0xf
    v_mov_b32_dpp v147, v44 quad_perm:[3,3,3,3] row_mask:0xf bank_mask:0xf
    v_mov_b32_dpp v151, v45 quad_perm:[3,3,3,3] row_mask:0xf bank_mask:0xf
    v_pk_fma_f32 v[152:153], v[136:137], v[144:145], v[152:153]
    v_pk_fma_f32 v[156:157], v[136:137], v[148:149], v[156:157] neg_lo:[1,0,0] neg_hi:[1,0,0]
    v_pk_fma_f32 v[154:155], v[138:139], v[146:147], v[154:155]
    v_pk_fma_f32 v[158:159], v[138:139], v[150:151], v[158:159] neg_lo:[1,0,0] neg_hi:[1,0,0]
    v_pk_fma_f32 v[152:153], v[140:141], v[148:149], v[152:153] neg_lo:[1,0,0] neg_hi:[1,0,0]
    v_pk_fma_f32 v[156:157], v[140:141], v[144:145], v[156:157] neg_lo:[1,0,0] neg_hi:[1,0,0]
    v_pk_fma_f32 v[154:155], v[142:143], v[150:151], v[154:155] neg_lo:[1,0,0] neg_hi:[1,0,0]
    v_pk_fma_f32 v[158:159], v[142:143], v[146:147], v[158:159] neg_lo:[1,0,0] neg_hi:[1,0,0]
    v_pk_fma_f32 v[48:49], v[16:17], v[152:153], v[48:49]
    v_pk_fma_f32 v[68:69], v[16:17], v[156:157], v[68:69]
    v_pk_fma_f32 v[50:51], v[18:19], v[154:155], v[50:51]
    v_pk_fma_f32 v[70:71], v[18:19], v[158:159], v[70:71]
    v_pk_fma_f32 v[48:49], v[20:21], v[156:157], v[48:49]
    v_pk_fma_f32 v[68:69], v[20:21], v[152:153], v[68:69] neg_lo:[1,0,0] neg_hi:[1,0,0]
    v_pk_fma_f32 v[50:51], v[22:23], v[158:159], v[50:51]
    v_pk_fma_f32 v[70:71], v[22:23], v[154:155], v[70:71] neg_lo:[1,0,0] neg_hi:[1,0,0]
    v_cvt_pk_bf16_f32 v128, v48, v49
    v_cvt_pk_bf16_f32 v130, v68, v69
    v_cvt_pk_bf16_f32 v129, v50, v51
    v_cvt_pk_bf16_f32 v131, v70, v71
    v_pk_fma_f32 v[64:65], v[16:17], v[48:49], v[64:65]
    v_pk_fma_f32 v[76:77], v[16:17], v[68:69], v[76:77]
    v_pk_fma_f32 v[66:67], v[18:19], v[50:51], v[66:67]
    v_pk_fma_f32 v[78:79], v[18:19], v[70:71], v[78:79]
    v_pk_fma_f32 v[64:65], v[20:21], v[68:69], v[64:65]
    v_pk_fma_f32 v[76:77], v[20:21], v[48:49], v[76:77] neg_lo:[1,0,0] neg_hi:[1,0,0]
    v_pk_fma_f32 v[66:67], v[22:23], v[70:71], v[66:67]
    v_pk_fma_f32 v[78:79], v[22:23], v[50:51], v[78:79] neg_lo:[1,0,0] neg_hi:[1,0,0]
    v_permlane32_swap_b32 v128, v130
    v_permlane32_swap_b32 v129, v131
    s_mov_b32 s6, 0
    buffer_store_dwordx4 v[128:131], v61, s[8:11], s6 offen sc1
    v_cvt_pk_bf16_f32 v132, v64, v65
    v_cvt_pk_bf16_f32 v134, v76, v77
    v_cvt_pk_bf16_f32 v133, v66, v67
    v_cvt_pk_bf16_f32 v135, v78, v79
    v_pk_fma_f32 v[72:73], v[16:17], v[64:65], v[72:73]
    v_pk_fma_f32 v[84:85], v[16:17], v[76:77], v[84:85]
    v_pk_fma_f32 v[74:75], v[18:19], v[66:67], v[74:75]
    v_pk_fma_f32 v[86:87], v[18:19], v[78:79], v[86:87]
    v_pk_fma_f32 v[72:73], v[20:21], v[76:77], v[72:73]
    v_pk_fma_f32 v[84:85], v[20:21], v[64:65], v[84:85] neg_lo:[1,0,0] neg_hi:[1,0,0]
    v_pk_fma_f32 v[74:75], v[22:23], v[78:79], v[74:75]
    v_pk_fma_f32 v[86:87], v[22:23], v[66:67], v[86:87] neg_lo:[1,0,0] neg_hi:[1,0,0]
    v_permlane32_swap_b32 v132, v134
    v_permlane32_swap_b32 v133, v135
    s_mov_b32 s6, 4096
    buffer_store_dwordx4 v[132:135], v61, s[8:11], s6 offen sc1
    v_cvt_pk_bf16_f32 v136, v72, v73
    v_cvt_pk_bf16_f32 v138, v84, v85
    v_cvt_pk_bf16_f32 v137, v74, v75
    v_cvt_pk_bf16_f32 v139, v86, v87
    v_pk_fma_f32 v[80:81], v[16:17], v[72:73], v[80:81]
    v_pk_fma_f32 v[92:93], v[16:17], v[84:85], v[92:93]
    v_pk_fma_f32 v[82:83], v[18:19], v[74:75], v[82:83]
    v_pk_fma_f32 v[94:95], v[18:19], v[86:87], v[94:95]
    v_pk_fma_f32 v[80:81], v[20:21], v[84:85], v[80:81]
    v_pk_fma_f32 v[92:93], v[20:21], v[72:73], v[92:93] neg_lo:[1,0,0] neg_hi:[1,0,0]
    v_pk_fma_f32 v[82:83], v[22:23], v[86:87], v[82:83]
    v_pk_fma_f32 v[94:95], v[22:23], v[74:75], v[94:95] neg_lo:[1,0,0] neg_hi:[1,0,0]
    v_permlane32_swap_b32 v136, v138
    v_permlane32_swap_b32 v137, v139
    s_mov_b32 s6, 8192
    buffer_store_dwordx4 v[136:139], v61, s[8:11], s6 offen sc1
    v_cvt_pk_bf16_f32 v140, v80, v81
    v_cvt_pk_bf16_f32 v142, v92, v93
    v_cvt_pk_bf16_f32 v141, v82, v83
    v_cvt_pk_bf16_f32 v143, v94, v95
    v_pk_fma_f32 v[88:89], v[16:17], v[80:81], v[88:89]
    v_pk_fma_f32 v[100:101], v[16:17], v[92:93], v[100:101]
    v_pk_fma_f32 v[90:91], v[18:19], v[82:83], v[90:91]
    v_pk_fma_f32 v[102:103], v[18:19], v[94:95], v[102:103]
    v_pk_fma_f32 v[88:89], v[20:21], v[92:93], v[88:89]
    v_pk_fma_f32 v[100:101], v[20:21], v[80:81], v[100:101] neg_lo:[1,0,0] neg_hi:[1,0,0]
    v_pk_fma_f32 v[90:91], v[22:23], v[94:95], v[90:91]
    v_pk_fma_f32 v[102:103], v[22:23], v[82:83], v[102:103] neg_lo:[1,0,0] neg_hi:[1,0,0]
    v_permlane32_swap_b32 v140, v142
    v_permlane32_swap_b32 v141, v143
    s_mov_b32 s6, 12288
    buffer_store_dwordx4 v[140:143], v61, s[8:11], s6 offen sc1
    v_cvt_pk_bf16_f32 v144, v88, v89
    v_cvt_pk_bf16_f32 v146, v100, v101
    v_cvt_pk_bf16_f32 v145, v90, v91
    v_cvt_pk_bf16_f32 v147, v102, v103
    v_pk_fma_f32 v[96:97], v[16:17], v[88:89], v[96:97]
    v_pk_fma_f32 v[108:109], v[16:17], v[100:101], v[108:109]
    v_pk_fma_f32 v[98:99], v[18:19], v[90:91], v[98:99]
    v_pk_fma_f32 v[110:111], v[18:19], v[102:103], v[110:111]
    v_pk_fma_f32 v[96:97], v[20:21], v[100:101], v[96:97]
    v_pk_fma_f32 v[108:109], v[20:21], v[88:89], v[108:109] neg_lo:[1,0,0] neg_hi:[1,0,0]
    v_pk_fma_f32 v[98:99], v[22:23], v[102:103], v[98:99]
    v_pk_fma_f32 v[110:111], v[22:23], v[90:91], v[110:111] neg_lo:[1,0,0] neg_hi:[1,0,0]
    v_permlane32_swap_b32 v144, v146
    v_permlane32_swap_b32 v145, v147
    s_mov_b32 s6, 16384
    buffer_store_dwordx4 v[144:147], v61, s[8:11], s6 offen sc1
    v_cvt_pk_bf16_f32 v148, v96, v97
    v_cvt_pk_bf16_f32 v150, v108, v109
    v_cvt_pk_bf16_f32 v149, v98, v99
    v_cvt_pk_bf16_f32 v151, v110, v111
    v_pk_fma_f32 v[104:105], v[16:17], v[96:97], v[104:105]
    v_pk_fma_f32 v[116:117], v[16:17], v[108:109], v[116:117]
    v_pk_fma_f32 v[106:107], v[18:19], v[98:99], v[106:107]
    v_pk_fma_f32 v[118:119], v[18:19], v[110:111], v[118:119]
    v_pk_fma_f32 v[104:105], v[20:21], v[108:109], v[104:105]
    v_pk_fma_f32 v[116:117], v[20:21], v[96:97], v[116:117] neg_lo:[1,0,0] neg_hi:[1,0,0]
    v_pk_fma_f32 v[106:107], v[22:23], v[110:111], v[106:107]
    v_pk_fma_f32 v[118:119], v[22:23], v[98:99], v[118:119] neg_lo:[1,0,0] neg_hi:[1,0,0]
    v_permlane32_swap_b32 v148, v150
    v_permlane32_swap_b32 v149, v151
    s_mov_b32 s6, 20480
    buffer_store_dwordx4 v[148:151], v61, s[8:11], s6 offen sc1
    v_cvt_pk_bf16_f32 v152, v104, v105
    v_cvt_pk_bf16_f32 v154, v116, v117
    v_cvt_pk_bf16_f32 v153, v106, v107
    v_cvt_pk_bf16_f32 v155, v118, v119
    v_pk_fma_f32 v[112:113], v[16:17], v[104:105], v[112:113]
    v_pk_fma_f32 v[124:125], v[16:17], v[116:117], v[124:125]
    v_pk_fma_f32 v[114:115], v[18:19], v[106:107], v[114:115]
    v_pk_fma_f32 v[126:127], v[18:19], v[118:119], v[126:127]
    v_pk_fma_f32 v[112:113], v[20:21], v[116:117], v[112:113]
    v_pk_fma_f32 v[124:125], v[20:21], v[104:105], v[124:125] neg_lo:[1,0,0] neg_hi:[1,0,0]
    v_pk_fma_f32 v[114:115], v[22:23], v[118:119], v[114:115]
    v_pk_fma_f32 v[126:127], v[22:23], v[106:107], v[126:127] neg_lo:[1,0,0] neg_hi:[1,0,0]
    v_permlane32_swap_b32 v152, v154
    v_permlane32_swap_b32 v153, v155
    s_mov_b32 s6, 24576
    buffer_store_dwordx4 v[152:155], v61, s[8:11], s6 offen sc1
    v_cvt_pk_bf16_f32 v156, v112, v113
    v_cvt_pk_bf16_f32 v158, v124, v125
    v_cvt_pk_bf16_f32 v157, v114, v115
    v_cvt_pk_bf16_f32 v159, v126, v127
    s_nop 0
    v_permlane32_swap_b32 v156, v158
    v_permlane32_swap_b32 v157, v159
    s_mov_b32 s6, 28672
    buffer_store_dwordx4 v[156:159], v61, s[8:11], s6 offen sc1
    ds_write_b32 v63, v15 offset:64
    v_lshlrev_b32 v1, 4, v2
    v_add_u32 v52, s21, v1
    v_add_u32 v53, 0xc000, v52
    v_lshrrev_b32 v1, 1, v13
    v_lshl_add_u32 v8, v1, 13, v4
    v_xor_b32 v9, 32, v8
    v_xor_b32 v10, 64, v8
    v_xor_b32 v11, 96, v8
    s_lshl_b32 s6, s3, 6
    s_add_u32 s6, s6, s5
    s_lshl_b32 s6, s6, 13
    v_lshlrev_b32 v1, 4, v2
    v_add_u32 v48, s6, v1
    v_add_u32 v49, 4096, v48
    s_lshl_b32 s6, s6, 1
    s_lshl_b32 s7, s4, 8
    s_add_u32 s6, s6, s7
    s_add_u32 s6, s6, 4096
    v_lshlrev_b32 v50, 18, v13
    v_lshl_add_u32 v50, v12, 4, v50
    v_add_u32 v50, s6, v50
    v_lshlrev_b32 v1, 1, v13
    v_sub_u32 v1, v12, v1
    v_cmp_eq_u32 s[40:41], 0, v1
    v_cmp_eq_u32 s[42:43], 1, v1
    v_cmp_eq_u32 s[44:45], 8, v1
    v_cmp_eq_u32 s[46:47], 9, v1
    v_and_b32 v56, 0xffff, v242
    v_and_b32 v57, 0xffff0000, v242
    v_and_b32 v58, 0xffff, v243
    v_and_b32 v59, 0xffff0000, v243
    s_lshl_b32 s7, s3, 13
    s_add_u32 s7, s7, 131072
    v_lshrrev_b32 v1, 2, v2
    v_xor_b32 v3, s36, v1
    v_add_u32 v1, s36, v1
    v_and_b32 v1, 7, v1
    v_and_b32 v3, 8, v3
    v_or_b32 v1, v1, v3
    v_lshlrev_b32 v1, 9, v1
    v_add_u32 v51, s7, v1
    s_lshl_b32 s6, s4, 9
    s_add_u32 s6, s6, s7
    v_lshl_add_u32 v3, v12, 3, s6
    s_lshl_b32 s38, s36, 15
    s_and_b32 s30, s38, 0x40000
    s_xor_b32 s31, s30, 0x40000
    s_xor_b32 s35, s38, 0x40000
    s_lshl_b32 s6, s3, 19
    s_lshl_b32 s7, s5, 13
    s_add_u32 s6, s6, s7
    v_lshlrev_b32 v1, 7, v2
    v_add_u32 v60, s6, v1
    s_mov_b32 s34, 1
    s_mov_b32 s37, 0
    v_cndmask_b32 v64, 0, v56, s[40:41]
    v_mov_b32 v65, 0
    v_cndmask_b32 v66, 0, v56, s[42:43]
    v_mov_b32 v67, 0
    v_cndmask_b32 v68, 0, v56, s[44:45]
    v_mov_b32 v69, 0
    v_cndmask_b32 v70, 0, v56, s[46:47]
    v_mov_b32 v71, 0
    v_cndmask_b32 v72, 0, v57, s[40:41]
    v_mov_b32 v73, 0
    v_cndmask_b32 v74, 0, v57, s[42:43]
    v_mov_b32 v75, 0
    v_cndmask_b32 v76, 0, v57, s[44:45]
    v_mov_b32 v77, 0
    v_cndmask_b32 v78, 0, v57, s[46:47]
    v_mov_b32 v79, 0
    v_mov_b32 v80, 0
    v_cndmask_b32 v81, 0, v58, s[40:41]
    v_mov_b32 v82, 0
    v_cndmask_b32 v83, 0, v58, s[42:43]
    v_mov_b32 v84, 0
    v_cndmask_b32 v85, 0, v58, s[44:45]
    v_mov_b32 v86, 0
    v_cndmask_b32 v87, 0, v58, s[46:47]
    v_mov_b32 v88, 0
    v_cndmask_b32 v89, 0, v59, s[40:41]
    v_mov_b32 v90, 0
    v_cndmask_b32 v91, 0, v59, s[42:43]
    v_mov_b32 v92, 0
    v_cndmask_b32 v93, 0, v59, s[44:45]
    v_mov_b32 v94, 0
    v_cndmask_b32 v95, 0, v59, s[46:47]
    v_add_u32 v4, 0xc000, v8
    v_add_u32 v5, 0xc000, v9
    v_add_u32 v6, 0xc000, v10
    v_add_u32 v7, 0xc000, v11
    v_mfma_f32_16x16x32_bf16 v[16:19], v[208:211], v[64:67], 0
    v_mfma_f32_16x16x32_bf16 v[20:23], v[208:211], v[72:75], 0
    v_mfma_f32_16x16x32_bf16 v[24:27], v[208:211], v[80:83], 0
    v_mfma_f32_16x16x32_bf16 v[28:31], v[208:211], v[88:91], 0
    v_mfma_f32_16x16x32_bf16 v[32:35], v[216:219], v[64:67], 0
    v_mfma_f32_16x16x32_bf16 v[36:39], v[216:219], v[72:75], 0
    v_mfma_f32_16x16x32_bf16 v[40:43], v[216:219], v[80:83], 0
    v_mfma_f32_16x16x32_bf16 v[44:47], v[216:219], v[88:91], 0
    v_mfma_f32_16x16x32_bf16 v[16:19], v[212:215], v[68:71], v[16:19]
    v_mfma_f32_16x16x32_bf16 v[20:23], v[212:215], v[76:79], v[20:23]
    v_mfma_f32_16x16x32_bf16 v[24:27], v[212:215], v[84:87], v[24:27]
    v_mfma_f32_16x16x32_bf16 v[28:31], v[212:215], v[92:95], v[28:31]
    v_mfma_f32_16x16x32_bf16 v[32:35], v[220:223], v[68:71], v[32:35]
    v_mfma_f32_16x16x32_bf16 v[36:39], v[220:223], v[76:79], v[36:39]
    v_mfma_f32_16x16x32_bf16 v[40:43], v[220:223], v[84:87], v[40:43]
    v_mfma_f32_16x16x32_bf16 v[44:47], v[220:223], v[92:95], v[44:47]
    buffer_load_dwordx2 v[240:241], v51, s[72:75], 0 offen sc1
    s_waitcnt vmcnt(1)
    ds_write_b32 v63, v54 offset:32
    ds_read_b128 v[56:59], v62 offset:32
    s_waitcnt lgkmcnt(0)
    v_xor_b32 v56, v56, v54
    v_xor_b32 v57, v57, v54
    v_xor_b32 v58, v58, v54
    v_xor_b32 v59, v59, v54
    v_or3_b32 v56, v56, v57, v58
    v_or_b32 v56, v56, v59
    v_cmp_ne_u32 vcc, 0, v56
    s_mov_b32 s39, 0
    s_cbranch_vccnz C_nofl
    s_mov_b64 exec, 65535
    buffer_store_dwordx2 v[54:55], v3, s[72:75], 0 offen sc1
    s_mov_b64 exec, -1
    s_branch C_own
C_nofl:
    ds_read_b128 v[56:59], v62 offset:32
    s_waitcnt lgkmcnt(0)
    v_xor_b32 v56, v56, v54
    v_xor_b32 v57, v57, v54
    v_xor_b32 v58, v58, v54
    v_xor_b32 v59, v59, v54
    v_or3_b32 v56, v56, v57, v58
    v_or_b32 v56, v56, v59
    v_cmp_ne_u32 vcc, 0, v56
    s_add_u32 s39, s39, 1
    s_cmp_gt_u32 s39, 16384
    s_cbranch_scc1 C_own
    s_cbranch_vccnz C_nofl
C_own:
    ds_read_b128 v[12:15], v62 offset:48
    buffer_load_dwordx4 v[64:67], v48, s[8:11], s38 offen offset:0 sc1
    buffer_load_dwordx4 v[68:71], v49, s[8:11], s38 offen offset:0 sc1
    buffer_load_dwordx4 v[72:75], v48, s[8:11], s38 offen offset:1024 sc1
    buffer_load_dwordx4 v[76:79], v49, s[8:11], s38 offen offset:1024 sc1
    buffer_load_dwordx4 v[80:83], v48, s[8:11], s38 offen offset:2048 sc1
    buffer_load_dwordx4 v[84:87], v49, s[8:11], s38 offen offset:2048 sc1
    buffer_load_dwordx4 v[88:91], v48, s[8:11], s38 offen offset:3072 sc1
    buffer_load_dwordx4 v[92:95], v49, s[8:11], s38 offen offset:3072 sc1
    s_add_u32 s38, s38, 32768
    s_and_b32 s38, s38, 0x3ffff
    s_or_b32 s38, s38, s30
    s_add_u32 s7, s20, 1280
    s_and_b32 s7, s7, 1023
    s_or_b32 s7, s7, s23
    buffer_load_dwordx4 v[208:211], v244, s[24:27], s7 offen offset:0
    buffer_load_dwordx4 v[212:215], v245, s[24:27], s7 offen offset:1024
    buffer_load_dwordx4 v[216:219], v246, s[80:83], s7 offen offset:0
    buffer_load_dwordx4 v[220:223], v247, s[80:83], s7 offen offset:1024
    s_waitcnt vmcnt(12)
    v_cmp_eq_u32 vcc, v240, v54
    v_cmp_eq_u32 s[54:55], v241, v55
    s_nop 0
    s_and_b64 s[54:55], s[54:55], vcc
    s_or_b32 s54, s54, 15
    s_ff0_i32_b64 s7, s[54:55]
    s_lshr_b32 s7, s7, 2
    s_max_u32 s37, s37, s7
    s_cmp_gt_u32 s37, 1
    s_cbranch_scc0 C2_h1
    C2_h1_r:
    buffer_load_dwordx4 v[96:99], v48, s[8:11], s38 offen offset:0 sc1
    buffer_load_dwordx4 v[100:103], v49, s[8:11], s38 offen offset:0 sc1
    buffer_load_dwordx4 v[104:107], v48, s[8:11], s38 offen offset:1024 sc1
    buffer_load_dwordx4 v[108:111], v49, s[8:11], s38 offen offset:1024 sc1
    buffer_load_dwordx4 v[112:115], v48, s[8:11], s38 offen offset:2048 sc1
    buffer_load_dwordx4 v[116:119], v49, s[8:11], s38 offen offset:2048 sc1
    s_waitcnt lgkmcnt(0)
    v_min3_u32 v12, v12, v13, v14
    v_min_u32 v12, v12, v15
    v_cmp_gt_u32 vcc, 6, v12
    s_cbranch_vccnz C_crdy
    C_crdy_r:
    s_setprio 3
    ds_read_b128 v[128:131], v8 offset:0
    ds_read_b128 v[132:135], v8 offset:2048
    ds_read_b128 v[136:139], v8 offset:4096
    ds_read_b128 v[140:143], v8 offset:6144
    s_waitcnt vmcnt(16) lgkmcnt(0)
    v_mfma_f32_16x16x32_bf16 v[16:19], v[64:67], v[128:131], v[16:19]
    ds_read_b128 v[144:147], v9 offset:0
    ds_read_b128 v[148:151], v9 offset:2048
    v_mfma_f32_16x16x32_bf16 v[20:23], v[64:67], v[132:135], v[20:23]
    ds_read_b128 v[152:155], v9 offset:4096
    ds_read_b128 v[156:159], v9 offset:6144
    v_mfma_f32_16x16x32_bf16 v[24:27], v[64:67], v[136:139], v[24:27]
    buffer_load_dwordx2 v[244:245], v51, s[72:75], 0 offen sc1
    v_mfma_f32_16x16x32_bf16 v[28:31], v[64:67], v[140:143], v[28:31]
    buffer_load_dwordx4 v[120:123], v48, s[8:11], s38 offen offset:3072 sc1
    v_mfma_f32_16x16x32_bf16 v[44:47], v[68:71], v[140:143], v[44:47]
    buffer_load_dwordx4 v[124:127], v49, s[8:11], s38 offen offset:3072 sc1
    s_add_u32 s38, s38, 32768
    s_and_b32 s38, s38, 0x3ffff
    s_or_b32 s38, s38, s30
    v_mfma_f32_16x16x32_bf16 v[40:43], v[68:71], v[136:139], v[40:43]
    v_mfma_f32_16x16x32_bf16 v[36:39], v[68:71], v[132:135], v[36:39]
    v_mfma_f32_16x16x32_bf16 v[32:35], v[68:71], v[128:131], v[32:35]
    s_waitcnt vmcnt(17) lgkmcnt(0)
    v_mfma_f32_16x16x32_bf16 v[16:19], v[72:75], v[144:147], v[16:19]
    ds_read_b128 v[128:131], v10 offset:0
    ds_read_b128 v[132:135], v10 offset:2048
    v_mfma_f32_16x16x32_bf16 v[20:23], v[72:75], v[148:151], v[20:23]
    ds_read_b128 v[136:139], v10 offset:4096
    ds_read_b128 v[140:143], v10 offset:6144
    v_mfma_f32_16x16x32_bf16 v[24:27], v[72:75], v[152:155], v[24:27]
    s_cmp_gt_u32 s37, 2
    s_cbranch_scc0 C2_h2
    C2_h2_r:
    buffer_load_dwordx4 v[64:67], v48, s[8:11], s38 offen offset:0 sc1
    v_mfma_f32_16x16x32_bf16 v[28:31], v[72:75], v[156:159], v[28:31]
    buffer_load_dwordx4 v[68:71], v49, s[8:11], s38 offen offset:0 sc1
    v_mfma_f32_16x16x32_bf16 v[44:47], v[76:79], v[156:159], v[44:47]
    v_mfma_f32_16x16x32_bf16 v[40:43], v[76:79], v[152:155], v[40:43]
    v_mfma_f32_16x16x32_bf16 v[36:39], v[76:79], v[148:151], v[36:39]
    v_mfma_f32_16x16x32_bf16 v[32:35], v[76:79], v[144:147], v[32:35]
    s_waitcnt vmcnt(17) lgkmcnt(0)
    v_mfma_f32_16x16x32_bf16 v[16:19], v[80:83], v[128:131], v[16:19]
    ds_read_b128 v[144:147], v11 offset:0
    ds_read_b128 v[148:151], v11 offset:2048
    v_mfma_f32_16x16x32_bf16 v[20:23], v[80:83], v[132:135], v[20:23]
    ds_read_b128 v[152:155], v11 offset:4096
    ds_read_b128 v[156:159], v11 offset:6144
    v_mfma_f32_16x16x32_bf16 v[24:27], v[80:83], v[136:139], v[24:27]
    buffer_load_dwordx4 v[72:75], v48, s[8:11], s38 offen offset:1024 sc1
    v_mfma_f32_16x16x32_bf16 v[28:31], v[80:83], v[140:143], v[28:31]
    buffer_load_dwordx4 v[76:79], v49, s[8:11], s38 offen offset:1024 sc1
    v_mfma_f32_16x16x32_bf16 v[44:47], v[84:87], v[140:143], v[44:47]
    v_mfma_f32_16x16x32_bf16 v[40:43], v[84:87], v[136:139], v[40:43]
    v_mfma_f32_16x16x32_bf16 v[36:39], v[84:87], v[132:135], v[36:39]
    v_mfma_f32_16x16x32_bf16 v[32:35], v[84:87], v[128:131], v[32:35]
    s_waitcnt vmcnt(17) lgkmcnt(0)
    v_mfma_f32_16x16x32_bf16 v[16:19], v[88:91], v[144:147], v[16:19]
    ds_read_b128 v[128:131], v8 offset:16384
    ds_read_b128 v[132:135], v8 offset:18432
    v_mfma_f32_16x16x32_bf16 v[20:23], v[88:91], v[148:151], v[20:23]
    ds_read_b128 v[136:139], v8 offset:20480
    ds_read_b128 v[140:143], v8 offset:22528
    v_mfma_f32_16x16x32_bf16 v[24:27], v[88:91], v[152:155], v[24:27]
    v_mov_b32 v1, 1
    ds_write_b32 v63, v1 offset:96
    v_mfma_f32_16x16x32_bf16 v[28:31], v[88:91], v[156:159], v[28:31]
    buffer_load_dwordx4 v[80:83], v48, s[8:11], s38 offen offset:2048 sc1
    v_mfma_f32_16x16x32_bf16 v[44:47], v[92:95], v[156:159], v[44:47]
    buffer_load_dwordx4 v[84:87], v49, s[8:11], s38 offen offset:2048 sc1
    v_mfma_f32_16x16x32_bf16 v[40:43], v[92:95], v[152:155], v[40:43]
    v_mfma_f32_16x16x32_bf16 v[36:39], v[92:95], v[148:151], v[36:39]
    v_mfma_f32_16x16x32_bf16 v[32:35], v[92:95], v[144:147], v[32:35]
    s_waitcnt vmcnt(13) lgkmcnt(1)
    v_mfma_f32_16x16x32_bf16 v[16:19], v[96:99], v[128:131], v[16:19]
    ds_read_b128 v[144:147], v9 offset:16384
    ds_read_b128 v[148:151], v9 offset:18432
    v_mfma_f32_16x16x32_bf16 v[20:23], v[96:99], v[132:135], v[20:23]
    ds_read_b128 v[152:155], v9 offset:20480
    ds_read_b128 v[156:159], v9 offset:22528
    v_mfma_f32_16x16x32_bf16 v[24:27], v[96:99], v[136:139], v[24:27]
    buffer_load_dwordx2 v[240:241], v51, s[72:75], 0 offen sc1
    v_mfma_f32_16x16x32_bf16 v[28:31], v[96:99], v[140:143], v[28:31]
    buffer_load_dwordx4 v[88:91], v48, s[8:11], s38 offen offset:3072 sc1
    v_mfma_f32_16x16x32_bf16 v[44:47], v[100:103], v[140:143], v[44:47]
    buffer_load_dwordx4 v[92:95], v49, s[8:11], s38 offen offset:3072 sc1
    s_add_u32 s38, s38, 32768
    s_and_b32 s38, s38, 0x3ffff
    s_or_b32 s38, s38, s30
    v_mfma_f32_16x16x32_bf16 v[40:43], v[100:103], v[136:139], v[40:43]
    v_mfma_f32_16x16x32_bf16 v[36:39], v[100:103], v[132:135], v[36:39]
    v_mfma_f32_16x16x32_bf16 v[32:35], v[100:103], v[128:131], v[32:35]
    s_waitcnt vmcnt(14) lgkmcnt(0)
    v_mfma_f32_16x16x32_bf16 v[16:19], v[104:107], v[144:147], v[16:19]
    ds_read_b128 v[128:131], v10 offset:16384
    ds_read_b128 v[132:135], v10 offset:18432
    v_mfma_f32_16x16x32_bf16 v[20:23], v[104:107], v[148:151], v[20:23]
    ds_read_b128 v[136:139], v10 offset:20480
    ds_read_b128 v[140:143], v10 offset:22528
    v_mfma_f32_16x16x32_bf16 v[24:27], v[104:107], v[152:155], v[24:27]
    s_cmp_gt_u32 s37, 3
    s_cbranch_scc0 C2_h3
    C2_h3_r:
    buffer_load_dwordx4 v[96:99], v48, s[8:11], s38 offen offset:0 sc1
    v_mfma_f32_16x16x32_bf16 v[28:31], v[104:107], v[156:159], v[28:31]
    buffer_load_dwordx4 v[100:103], v49, s[8:11], s38 offen offset:0 sc1
    v_mfma_f32_16x16x32_bf16 v[44:47], v[108:111], v[156:159], v[44:47]
    v_mfma_f32_16x16x32_bf16 v[40:43], v[108:111], v[152:155], v[40:43]
    v_mfma_f32_16x16x32_bf16 v[36:39], v[108:111], v[148:151], v[36:39]
    v_mfma_f32_16x16x32_bf16 v[32:35], v[108:111], v[144:147], v[32:35]
    s_waitcnt vmcnt(14) lgkmcnt(0)
    v_mfma_f32_16x16x32_bf16 v[16:19], v[112:115], v[128:131], v[16:19]
    ds_read_b128 v[144:147], v11 offset:16384
    ds_read_b128 v[148:151], v11 offset:18432
    v_mfma_f32_16x16x32_bf16 v[20:23], v[112:115], v[132:135], v[20:23]
    ds_read_b128 v[152:155], v11 offset:20480
    ds_read_b128 v[156:159], v11 offset:22528
    v_mfma_f32_16x16x32_bf16 v[24:27], v[112:115], v[136:139], v[24:27]
    buffer_load_dwordx4 v[104:107], v48, s[8:11], s38 offen offset:1024 sc1
    v_mfma_f32_16x16x32_bf16 v[28:31], v[112:115], v[140:143], v[28:31]
    buffer_load_dwordx4 v[108:111], v49, s[8:11], s38 offen offset:1024 sc1
    v_mfma_f32_16x16x32_bf16 v[44:47], v[116:119], v[140:143], v[44:47]
    v_mfma_f32_16x16x32_bf16 v[40:43], v[116:119], v[136:139], v[40:43]
    v_mfma_f32_16x16x32_bf16 v[36:39], v[116:119], v[132:135], v[36:39]
    v_mfma_f32_16x16x32_bf16 v[32:35], v[116:119], v[128:131], v[32:35]
    s_waitcnt vmcnt(13) lgkmcnt(0)
    v_mfma_f32_16x16x32_bf16 v[16:19], v[120:123], v[144:147], v[16:19]
    ds_read_b128 v[128:131], v8 offset:32768
    ds_read_b128 v[132:135], v8 offset:34816
    v_mfma_f32_16x16x32_bf16 v[20:23], v[120:123], v[148:151], v[20:23]
    ds_read_b128 v[136:139], v8 offset:36864
    ds_read_b128 v[140:143], v8 offset:38912
    v_mfma_f32_16x16x32_bf16 v[24:27], v[120:123], v[152:155], v[24:27]
    v_mov_b32 v1, 2
    ds_write_b32 v63, v1 offset:96
    v_mfma_f32_16x16x32_bf16 v[28:31], v[120:123], v[156:159], v[28:31]
    ds_read_b128 v[56:59], v62 offset:96
    v_mfma_f32_16x16x32_bf16 v[44:47], v[124:127], v[156:159], v[44:47]
    buffer_load_dwordx4 v[112:115], v48, s[8:11], s38 offen offset:2048 sc1
    v_mfma_f32_16x16x32_bf16 v[40:43], v[124:127], v[152:155], v[40:43]
    buffer_load_dwordx4 v[116:119], v49, s[8:11], s38 offen offset:2048 sc1
    v_mfma_f32_16x16x32_bf16 v[36:39], v[124:127], v[148:151], v[36:39]
    v_mfma_f32_16x16x32_bf16 v[32:35], v[124:127], v[144:147], v[32:35]
    s_waitcnt vmcnt(13) lgkmcnt(0)
    v_mfma_f32_16x16x32_bf16 v[16:19], v[64:67], v[128:131], v[16:19]
    ds_read_b128 v[144:147], v9 offset:32768
    ds_read_b128 v[148:151], v9 offset:34816
    v_mfma_f32_16x16x32_bf16 v[20:23], v[64:67], v[132:135], v[20:23]
    ds_read_b128 v[152:155], v9 offset:36864
    ds_read_b128 v[156:159], v9 offset:38912
    v_mfma_f32_16x16x32_bf16 v[24:27], v[64:67], v[136:139], v[24:27]
    buffer_load_dwordx2 v[242:243], v51, s[72:75], 0 offen sc1
    v_cmp_eq_u32 vcc, v244, v54
    v_cmp_eq_u32 s[54:55], v245, v55
    s_nop 0
    s_and_b64 s[54:55], s[54:55], vcc
    s_or_b32 s54, s54, 15
    s_ff0_i32_b64 s7, s[54:55]
    s_lshr_b32 s7, s7, 2
    s_max_u32 s37, s37, s7
    v_mfma_f32_16x16x32_bf16 v[28:31], v[64:67], v[140:143], v[28:31]
    buffer_load_dwordx4 v[120:123], v48, s[8:11], s38 offen offset:3072 sc1
    buffer_load_dwordx4 v[124:127], v49, s[8:11], s38 offen offset:3072 sc1
    s_add_u32 s38, s38, 32768
    s_and_b32 s38, s38, 0x3ffff
    s_or_b32 s38, s38, s30
    v_mfma_f32_16x16x32_bf16 v[44:47], v[68:71], v[140:143], v[44:47]
    v_min3_u32 v56, v56, v57, v58
    v_min_u32 v56, v56, v59
    v_mfma_f32_16x16x32_bf16 v[40:43], v[68:71], v[136:139], v[40:43]
    v_cmp_gt_u32 vcc, 1, v56
    v_mfma_f32_16x16x32_bf16 v[36:39], v[68:71], v[132:135], v[36:39]
    s_cbranch_vccnz C2_p2
    C2_p2_r:
    v_mfma_f32_16x16x32_bf16 v[32:35], v[68:71], v[128:131], v[32:35]
    ds_write_b128 v52, v[160:163] offset:0
    s_waitcnt vmcnt(14) lgkmcnt(1)
    v_mfma_f32_16x16x32_bf16 v[16:19], v[72:75], v[144:147], v[16:19]
    ds_read_b128 v[128:131], v10 offset:32768
    ds_read_b128 v[132:135], v10 offset:34816
    v_mfma_f32_16x16x32_bf16 v[20:23], v[72:75], v[148:151], v[20:23]
    ds_read_b128 v[136:139], v10 offset:36864
    ds_read_b128 v[140:143], v10 offset:38912
    v_mfma_f32_16x16x32_bf16 v[24:27], v[72:75], v[152:155], v[24:27]
    s_cmp_gt_u32 s37, 4
    s_cbranch_scc0 C2_h4
    C2_h4_r:
    buffer_load_dwordx4 v[64:67], v48, s[8:11], s38 offen offset:0 sc1
    v_mfma_f32_16x16x32_bf16 v[28:31], v[72:75], v[156:159], v[28:31]
    buffer_load_dwordx4 v[68:71], v49, s[8:11], s38 offen offset:0 sc1
    v_mfma_f32_16x16x32_bf16 v[44:47], v[76:79], v[156:159], v[44:47]
    ds_write_b128 v52, v[164:167] offset:1024
    v_mfma_f32_16x16x32_bf16 v[40:43], v[76:79], v[152:155], v[40:43]
    v_mfma_f32_16x16x32_bf16 v[36:39], v[76:79], v[148:151], v[36:39]
    v_mfma_f32_16x16x32_bf16 v[32:35], v[76:79], v[144:147], v[32:35]
    s_waitcnt vmcnt(14) lgkmcnt(1)
    v_mfma_f32_16x16x32_bf16 v[16:19], v[80:83], v[128:131], v[16:19]
    ds_read_b128 v[144:147], v11 offset:32768
    ds_read_b128 v[148:151], v11 offset:34816
    v_mfma_f32_16x16x32_bf16 v[20:23], v[80:83], v[132:135], v[20:23]
    ds_read_b128 v[152:155], v11 offset:36864
    ds_read_b128 v[156:159], v11 offset:38912
    v_mfma_f32_16x16x32_bf16 v[24:27], v[80:83], v[136:139], v[24:27]
    buffer_load_dwordx4 v[72:75], v48, s[8:11], s38 offen offset:1024 sc1
    v_mfma_f32_16x16x32_bf16 v[28:31], v[80:83], v[140:143], v[28:31]
    buffer_load_dwordx4 v[76:79], v49, s[8:11], s38 offen offset:1024 sc1
    v_mfma_f32_16x16x32_bf16 v[44:47], v[84:87], v[140:143], v[44:47]
    ds_write_b128 v52, v[168:171] offset:8192
    v_mfma_f32_16x16x32_bf16 v[40:43], v[84:87], v[136:139], v[40:43]
    v_mfma_f32_16x16x32_bf16 v[36:39], v[84:87], v[132:135], v[36:39]
    v_mfma_f32_16x16x32_bf16 v[32:35], v[84:87], v[128:131], v[32:35]
    s_waitcnt vmcnt(13) lgkmcnt(1)
    v_mfma_f32_16x16x32_bf16 v[16:19], v[88:91], v[144:147], v[16:19]
    ds_read_b128 v[128:131], v4 offset:0
    ds_read_b128 v[132:135], v4 offset:2048
    v_mfma_f32_16x16x32_bf16 v[20:23], v[88:91], v[148:151], v[20:23]
    ds_read_b128 v[136:139], v4 offset:4096
    ds_read_b128 v[140:143], v4 offset:6144
    v_mfma_f32_16x16x32_bf16 v[24:27], v[88:91], v[152:155], v[24:27]
    ds_write_b128 v52, v[172:175] offset:9216
    v_mfma_f32_16x16x32_bf16 v[28:31], v[88:91], v[156:159], v[28:31]
    v_mov_b32 v1, 3
    ds_write_b32 v63, v1 offset:96
    v_mfma_f32_16x16x32_bf16 v[44:47], v[92:95], v[156:159], v[44:47]
    ds_read_b128 v[56:59], v62 offset:96
    v_mfma_f32_16x16x32_bf16 v[40:43], v[92:95], v[152:155], v[40:43]
    buffer_load_dwordx4 v[80:83], v48, s[8:11], s38 offen offset:2048 sc1
    v_mfma_f32_16x16x32_bf16 v[36:39], v[92:95], v[148:151], v[36:39]
    buffer_load_dwordx4 v[84:87], v49, s[8:11], s38 offen offset:2048 sc1
    v_mfma_f32_16x16x32_bf16 v[32:35], v[92:95], v[144:147], v[32:35]
    s_waitcnt vmcnt(13) lgkmcnt(0)
    v_mfma_f32_16x16x32_bf16 v[16:19], v[96:99], v[128:131], v[16:19]
    ds_read_b128 v[144:147], v5 offset:0
    ds_read_b128 v[148:151], v5 offset:2048
    v_mfma_f32_16x16x32_bf16 v[20:23], v[96:99], v[132:135], v[20:23]
    ds_read_b128 v[152:155], v5 offset:4096
    ds_read_b128 v[156:159], v5 offset:6144
    v_mfma_f32_16x16x32_bf16 v[24:27], v[96:99], v[136:139], v[24:27]
    v_cmp_eq_u32 vcc, v240, v54
    v_cmp_eq_u32 s[54:55], v241, v55
    s_nop 0
    s_and_b64 s[54:55], s[54:55], vcc
    s_or_b32 s54, s54, 15
    s_ff0_i32_b64 s7, s[54:55]
    s_lshr_b32 s7, s7, 2
    s_max_u32 s37, s37, s7
    buffer_load_dwordx4 v[88:91], v48, s[8:11], s38 offen offset:3072 sc1
    v_mfma_f32_16x16x32_bf16 v[28:31], v[96:99], v[140:143], v[28:31]
    buffer_load_dwordx4 v[92:95], v49, s[8:11], s38 offen offset:3072 sc1
    s_add_u32 s38, s38, 32768
    s_and_b32 s38, s38, 0x3ffff
    s_or_b32 s38, s38, s30
    v_min3_u32 v56, v56, v57, v58
    v_mfma_f32_16x16x32_bf16 v[44:47], v[100:103], v[140:143], v[44:47]
    v_min_u32 v56, v56, v59
    v_mfma_f32_16x16x32_bf16 v[40:43], v[100:103], v[136:139], v[40:43]
    v_cmp_gt_u32 vcc, 2, v56
    v_mfma_f32_16x16x32_bf16 v[36:39], v[100:103], v[132:135], v[36:39]
    s_cbranch_vccnz C2_p3
    C2_p3_r:
    v_mfma_f32_16x16x32_bf16 v[32:35], v[100:103], v[128:131], v[32:35]
    ds_write_b128 v52, v[176:179] offset:16384
    s_waitcnt vmcnt(13) lgkmcnt(1)
    v_mfma_f32_16x16x32_bf16 v[16:19], v[104:107], v[144:147], v[16:19]
    ds_read_b128 v[128:131], v6 offset:0
    ds_read_b128 v[132:135], v6 offset:2048
    v_mfma_f32_16x16x32_bf16 v[20:23], v[104:107], v[148:151], v[20:23]
    ds_read_b128 v[136:139], v6 offset:4096
    ds_read_b128 v[140:143], v6 offset:6144
    v_mfma_f32_16x16x32_bf16 v[24:27], v[104:107], v[152:155], v[24:27]
    s_cmp_gt_u32 s37, 5
    s_cbranch_scc0 C2_h5
    C2_h5_r:
    buffer_load_dwordx4 v[96:99], v48, s[8:11], s38 offen offset:0 sc1
    v_mfma_f32_16x16x32_bf16 v[28:31], v[104:107], v[156:159], v[28:31]
    buffer_load_dwordx4 v[100:103], v49, s[8:11], s38 offen offset:0 sc1
    v_mfma_f32_16x16x32_bf16 v[44:47], v[108:111], v[156:159], v[44:47]
    ds_write_b128 v52, v[180:183] offset:17408
    v_mfma_f32_16x16x32_bf16 v[40:43], v[108:111], v[152:155], v[40:43]
    v_mfma_f32_16x16x32_bf16 v[36:39], v[108:111], v[148:151], v[36:39]
    v_mfma_f32_16x16x32_bf16 v[32:35], v[108:111], v[144:147], v[32:35]
    s_waitcnt vmcnt(13) lgkmcnt(1)
    v_mfma_f32_16x16x32_bf16 v[16:19], v[112:115], v[128:131], v[16:19]
    ds_read_b128 v[144:147], v7 offset:0
    ds_read_b128 v[148:151], v7 offset:2048
    v_mfma_f32_16x16x32_bf16 v[20:23], v[112:115], v[132:135], v[20:23]
    ds_read_b128 v[152:155], v7 offset:4096
    ds_read_b128 v[156:159], v7 offset:6144
    v_mfma_f32_16x16x32_bf16 v[24:27], v[112:115], v[136:139], v[24:27]
    buffer_load_dwordx4 v[104:107], v48, s[8:11], s38 offen offset:1024 sc1
    v_mfma_f32_16x16x32_bf16 v[28:31], v[112:115], v[140:143], v[28:31]
    buffer_load_dwordx4 v[108:111], v49, s[8:11], s38 offen offset:1024 sc1
    v_mfma_f32_16x16x32_bf16 v[44:47], v[116:119], v[140:143], v[44:47]
    ds_write_b128 v52, v[184:187] offset:24576
    v_mfma_f32_16x16x32_bf16 v[40:43], v[116:119], v[136:139], v[40:43]
    v_mfma_f32_16x16x32_bf16 v[36:39], v[116:119], v[132:135], v[36:39]
    v_mfma_f32_16x16x32_bf16 v[32:35], v[116:119], v[128:131], v[32:35]
    s_waitcnt vmcnt(12) lgkmcnt(1)
    v_mfma_f32_16x16x32_bf16 v[16:19], v[120:123], v[144:147], v[16:19]
    ds_read_b128 v[128:131], v4 offset:16384
    ds_read_b128 v[132:135], v4 offset:18432
    v_mfma_f32_16x16x32_bf16 v[20:23], v[120:123], v[148:151], v[20:23]
    ds_read_b128 v[136:139], v4 offset:20480
    ds_read_b128 v[140:143], v4 offset:22528
    v_mfma_f32_16x16x32_bf16 v[24:27], v[120:123], v[152:155], v[24:27]
    ds_write_b128 v52, v[188:191] offset:25600
    v_mfma_f32_16x16x32_bf16 v[28:31], v[120:123], v[156:159], v[28:31]
    v_mov_b32 v1, 4
    ds_write_b32 v63, v1 offset:96
    v_mfma_f32_16x16x32_bf16 v[44:47], v[124:127], v[156:159], v[44:47]
    ds_read_b128 v[56:59], v62 offset:96
    v_mfma_f32_16x16x32_bf16 v[40:43], v[124:127], v[152:155], v[40:43]
    buffer_load_dwordx4 v[112:115], v48, s[8:11], s38 offen offset:2048 sc1
    v_mfma_f32_16x16x32_bf16 v[36:39], v[124:127], v[148:151], v[36:39]
    buffer_load_dwordx4 v[116:119], v49, s[8:11], s38 offen offset:2048 sc1
    v_mfma_f32_16x16x32_bf16 v[32:35], v[124:127], v[144:147], v[32:35]
    s_waitcnt vmcnt(12) lgkmcnt(0)
    v_mfma_f32_16x16x32_bf16 v[16:19], v[64:67], v[128:131], v[16:19]
    ds_read_b128 v[144:147], v5 offset:16384
    ds_read_b128 v[148:151], v5 offset:18432
    v_mfma_f32_16x16x32_bf16 v[20:23], v[64:67], v[132:135], v[20:23]
    ds_read_b128 v[152:155], v5 offset:20480
    ds_read_b128 v[156:159], v5 offset:22528
    v_mfma_f32_16x16x32_bf16 v[24:27], v[64:67], v[136:139], v[24:27]
    v_cmp_eq_u32 vcc, v242, v54
    v_cmp_eq_u32 s[54:55], v243, v55
    s_nop 0
    s_and_b64 s[54:55], s[54:55], vcc
    s_or_b32 s54, s54, 15
    s_ff0_i32_b64 s7, s[54:55]
    s_lshr_b32 s7, s7, 2
    s_max_u32 s37, s37, s7
    buffer_load_dwordx4 v[120:123], v48, s[8:11], s38 offen offset:3072 sc1
    v_mfma_f32_16x16x32_bf16 v[28:31], v[64:67], v[140:143], v[28:31]
    buffer_load_dwordx4 v[124:127], v49, s[8:11], s38 offen offset:3072 sc1
    s_add_u32 s38, s38, 32768
    s_and_b32 s38, s38, 0x3ffff
    s_or_b32 s38, s38, s30
    v_min3_u32 v56, v56, v57, v58
    v_mfma_f32_16x16x32_bf16 v[44:47], v[68:71], v[140:143], v[44:47]
    v_min_u32 v56, v56, v59
    v_mfma_f32_16x16x32_bf16 v[40:43], v[68:71], v[136:139], v[40:43]
    v_cmp_gt_u32 vcc, 3, v56
    v_mfma_f32_16x16x32_bf16 v[36:39], v[68:71], v[132:135], v[36:39]
    s_cbranch_vccnz C2_p4
    C2_p4_r:
    v_mfma_f32_16x16x32_bf16 v[32:35], v[68:71], v[128:131], v[32:35]
    ds_write_b128 v52, v[192:195] offset:32768
    s_waitcnt vmcnt(12) lgkmcnt(1)
    v_mfma_f32_16x16x32_bf16 v[16:19], v[72:75], v[144:147], v[16:19]
    ds_read_b128 v[128:131], v6 offset:16384
    ds_read_b128 v[132:135], v6 offset:18432
    v_mfma_f32_16x16x32_bf16 v[20:23], v[72:75], v[148:151], v[20:23]
    ds_read_b128 v[136:139], v6 offset:20480
    ds_read_b128 v[140:143], v6 offset:22528
    v_mfma_f32_16x16x32_bf16 v[24:27], v[72:75], v[152:155], v[24:27]
    s_cmp_gt_u32 s37, 6
    s_cbranch_scc0 C2_h6
    C2_h6_r:
    buffer_load_dwordx4 v[64:67], v48, s[8:11], s38 offen offset:0 sc1
    v_mfma_f32_16x16x32_bf16 v[28:31], v[72:75], v[156:159], v[28:31]
    buffer_load_dwordx4 v[68:71], v49, s[8:11], s38 offen offset:0 sc1
    v_mfma_f32_16x16x32_bf16 v[44:47], v[76:79], v[156:159], v[44:47]
    ds_write_b128 v52, v[196:199] offset:33792
    v_mfma_f32_16x16x32_bf16 v[40:43], v[76:79], v[152:155], v[40:43]
    v_mfma_f32_16x16x32_bf16 v[36:39], v[76:79], v[148:151], v[36:39]
    v_mfma_f32_16x16x32_bf16 v[32:35], v[76:79], v[144:147], v[32:35]
    s_waitcnt vmcnt(12) lgkmcnt(1)
    v_mfma_f32_16x16x32_bf16 v[16:19], v[80:83], v[128:131], v[16:19]
    ds_read_b128 v[144:147], v7 offset:16384
    ds_read_b128 v[148:151], v7 offset:18432
    v_mfma_f32_16x16x32_bf16 v[20:23], v[80:83], v[132:135], v[20:23]
    ds_read_b128 v[152:155], v7 offset:20480
    ds_read_b128 v[156:159], v7 offset:22528
    v_mfma_f32_16x16x32_bf16 v[24:27], v[80:83], v[136:139], v[24:27]
    buffer_load_dwordx4 v[72:75], v48, s[8:11], s38 offen offset:1024 sc1
    v_mfma_f32_16x16x32_bf16 v[28:31], v[80:83], v[140:143], v[28:31]
    buffer_load_dwordx4 v[76:79], v49, s[8:11], s38 offen offset:1024 sc1
    v_mfma_f32_16x16x32_bf16 v[44:47], v[84:87], v[140:143], v[44:47]
    ds_write_b128 v52, v[200:203] offset:40960
    v_mfma_f32_16x16x32_bf16 v[40:43], v[84:87], v[136:139], v[40:43]
    v_mfma_f32_16x16x32_bf16 v[36:39], v[84:87], v[132:135], v[36:39]
    v_mfma_f32_16x16x32_bf16 v[32:35], v[84:87], v[128:131], v[32:35]
    s_waitcnt vmcnt(12) lgkmcnt(1)
    v_mfma_f32_16x16x32_bf16 v[16:19], v[88:91], v[144:147], v[16:19]
    ds_read_b128 v[128:131], v4 offset:32768
    ds_read_b128 v[132:135], v4 offset:34816
    v_mfma_f32_16x16x32_bf16 v[20:23], v[88:91], v[148:151], v[20:23]
    ds_read_b128 v[136:139], v4 offset:36864
    ds_read_b128 v[140:143], v4 offset:38912
    v_mfma_f32_16x16x32_bf16 v[24:27], v[88:91], v[152:155], v[24:27]
    ds_write_b128 v52, v[204:207] offset:41984
    v_mfma_f32_16x16x32_bf16 v[28:31], v[88:91], v[156:159], v[28:31]
    v_mov_b32 v1, 5
    ds_write_b32 v63, v1 offset:96
    v_mfma_f32_16x16x32_bf16 v[44:47], v[92:95], v[156:159], v[44:47]
    ds_read_b128 v[56:59], v62 offset:96
    v_mfma_f32_16x16x32_bf16 v[40:43], v[92:95], v[152:155], v[40:43]
    buffer_load_dwordx4 v[80:83], v48, s[8:11], s38 offen offset:2048 sc1
    v_mfma_f32_16x16x32_bf16 v[36:39], v[92:95], v[148:151], v[36:39]
    buffer_load_dwordx4 v[84:87], v49, s[8:11], s38 offen offset:2048 sc1
    v_mfma_f32_16x16x32_bf16 v[32:35], v[92:95], v[144:147], v[32:35]
    s_waitcnt vmcnt(12) lgkmcnt(0)
    v_mfma_f32_16x16x32_bf16 v[16:19], v[96:99], v[128:131], v[16:19]
    ds_read_b128 v[144:147], v5 offset:32768
    ds_read_b128 v[148:151], v5 offset:34816
    v_mfma_f32_16x16x32_bf16 v[20:23], v[96:99], v[132:135], v[20:23]
    ds_read_b128 v[152:155], v5 offset:36864
    ds_read_b128 v[156:159], v5 offset:38912
    v_mfma_f32_16x16x32_bf16 v[24:27], v[96:99], v[136:139], v[24:27]
    buffer_load_dwordx4 v[88:91], v48, s[8:11], s38 offen offset:3072 sc1
    buffer_load_dwordx4 v[92:95], v49, s[8:11], s38 offen offset:3072 sc1
    s_add_u32 s38, s38, 32768
    s_and_b32 s38, s38, 0x3ffff
    s_or_b32 s38, s38, s30
    v_mfma_f32_16x16x32_bf16 v[28:31], v[96:99], v[140:143], v[28:31]
    v_min3_u32 v56, v56, v57, v58
    v_mfma_f32_16x16x32_bf16 v[44:47], v[100:103], v[140:143], v[44:47]
    v_min_u32 v56, v56, v59
    v_mfma_f32_16x16x32_bf16 v[40:43], v[100:103], v[136:139], v[40:43]
    v_cmp_gt_u32 vcc, 4, v56
    v_mfma_f32_16x16x32_bf16 v[36:39], v[100:103], v[132:135], v[36:39]
    s_cbranch_vccnz C2_p5
    C2_p5_r:
    v_mfma_f32_16x16x32_bf16 v[32:35], v[100:103], v[128:131], v[32:35]
    ds_write_b128 v53, v[224:227] offset:0
    s_waitcnt vmcnt(12) lgkmcnt(1)
    v_mfma_f32_16x16x32_bf16 v[16:19], v[104:107], v[144:147], v[16:19]
    ds_read_b128 v[128:131], v6 offset:32768
    ds_read_b128 v[132:135], v6 offset:34816
    v_mfma_f32_16x16x32_bf16 v[20:23], v[104:107], v[148:151], v[20:23]
    ds_read_b128 v[136:139], v6 offset:36864
    ds_read_b128 v[140:143], v6 offset:38912
    v_mfma_f32_16x16x32_bf16 v[24:27], v[104:107], v[152:155], v[24:27]
    s_cmp_gt_u32 s37, 7
    s_cbranch_scc0 C2_h7
    C2_h7_r:
    buffer_load_dwordx4 v[96:99], v48, s[8:11], s38 offen offset:0 sc1
    v_mfma_f32_16x16x32_bf16 v[28:31], v[104:107], v[156:159], v[28:31]
    buffer_load_dwordx4 v[100:103], v49, s[8:11], s38 offen offset:0 sc1
    v_mfma_f32_16x16x32_bf16 v[44:47], v[108:111], v[156:159], v[44:47]
    ds_write_b128 v53, v[228:231] offset:1024
    v_mfma_f32_16x16x32_bf16 v[40:43], v[108:111], v[152:155], v[40:43]
    v_mfma_f32_16x16x32_bf16 v[36:39], v[108:111], v[148:151], v[36:39]
    v_mfma_f32_16x16x32_bf16 v[32:35], v[108:111], v[144:147], v[32:35]
    s_waitcnt vmcnt(12) lgkmcnt(1)
    v_mfma_f32_16x16x32_bf16 v[16:19], v[112:115], v[128:131], v[16:19]
    ds_read_b128 v[144:147], v7 offset:32768
    ds_read_b128 v[148:151], v7 offset:34816
    v_mfma_f32_16x16x32_bf16 v[20:23], v[112:115], v[132:135], v[20:23]
    ds_read_b128 v[152:155], v7 offset:36864
    ds_read_b128 v[156:159], v7 offset:38912
    v_mfma_f32_16x16x32_bf16 v[24:27], v[112:115], v[136:139], v[24:27]
    buffer_load_dwordx4 v[104:107], v48, s[8:11], s38 offen offset:1024 sc1
    v_mfma_f32_16x16x32_bf16 v[28:31], v[112:115], v[140:143], v[28:31]
    buffer_load_dwordx4 v[108:111], v49, s[8:11], s38 offen offset:1024 sc1
    v_mfma_f32_16x16x32_bf16 v[44:47], v[116:119], v[140:143], v[44:47]
    ds_write_b128 v53, v[232:235] offset:8192
    v_mfma_f32_16x16x32_bf16 v[40:43], v[116:119], v[136:139], v[40:43]
    v_mfma_f32_16x16x32_bf16 v[36:39], v[116:119], v[132:135], v[36:39]
    v_mfma_f32_16x16x32_bf16 v[32:35], v[116:119], v[128:131], v[32:35]
    s_waitcnt vmcnt(12) lgkmcnt(1)
    v_mfma_f32_16x16x32_bf16 v[16:19], v[120:123], v[144:147], v[16:19]
    ds_read_b128 v[128:131], v8 offset:0
    ds_read_b128 v[132:135], v8 offset:2048
    v_mfma_f32_16x16x32_bf16 v[20:23], v[120:123], v[148:151], v[20:23]
    ds_read_b128 v[136:139], v8 offset:4096
    ds_read_b128 v[140:143], v8 offset:6144
    v_mfma_f32_16x16x32_bf16 v[24:27], v[120:123], v[152:155], v[24:27]
    ds_write_b128 v53, v[236:239] offset:9216
    v_mfma_f32_16x16x32_bf16 v[28:31], v[120:123], v[156:159], v[28:31]
    v_mov_b32 v1, 6
    ds_write_b32 v63, v1 offset:96
    v_mfma_f32_16x16x32_bf16 v[44:47], v[124:127], v[156:159], v[44:47]
    ds_read_b128 v[56:59], v62 offset:96
    v_mfma_f32_16x16x32_bf16 v[40:43], v[124:127], v[152:155], v[40:43]
    buffer_load_dwordx4 v[112:115], v48, s[8:11], s38 offen offset:2048 sc1
    v_mfma_f32_16x16x32_bf16 v[36:39], v[124:127], v[148:151], v[36:39]
    buffer_load_dwordx4 v[116:119], v49, s[8:11], s38 offen offset:2048 sc1
    v_mfma_f32_16x16x32_bf16 v[32:35], v[124:127], v[144:147], v[32:35]
    s_waitcnt vmcnt(12) lgkmcnt(0)
    v_mfma_f32_16x16x32_bf16 v[16:19], v[64:67], v[128:131], v[16:19]
    ds_read_b128 v[144:147], v9 offset:0
    ds_read_b128 v[148:151], v9 offset:2048
    v_mfma_f32_16x16x32_bf16 v[20:23], v[64:67], v[132:135], v[20:23]
    ds_read_b128 v[152:155], v9 offset:4096
    ds_read_b128 v[156:159], v9 offset:6144
    v_mfma_f32_16x16x32_bf16 v[24:27], v[64:67], v[136:139], v[24:27]
    buffer_load_dwordx4 v[120:123], v48, s[8:11], s38 offen offset:3072 sc1
    buffer_load_dwordx4 v[124:127], v49, s[8:11], s38 offen offset:3072 sc1
    s_add_u32 s38, s38, 32768
    s_and_b32 s38, s38, 0x3ffff
    s_or_b32 s38, s38, s31
    v_mfma_f32_16x16x32_bf16 v[28:31], v[64:67], v[140:143], v[28:31]
    v_min3_u32 v56, v56, v57, v58
    v_mfma_f32_16x16x32_bf16 v[44:47], v[68:71], v[140:143], v[44:47]
    v_min_u32 v56, v56, v59
    v_mfma_f32_16x16x32_bf16 v[40:43], v[68:71], v[136:139], v[40:43]
    v_cmp_gt_u32 vcc, 5, v56
    v_mfma_f32_16x16x32_bf16 v[36:39], v[68:71], v[132:135], v[36:39]
    s_cbranch_vccnz C2_p6
    C2_p6_r:
    v_mfma_f32_16x16x32_bf16 v[32:35], v[68:71], v[128:131], v[32:35]
    ds_write_b128 v53, v[208:211] offset:16384
    s_waitcnt vmcnt(12) lgkmcnt(1)
    v_mfma_f32_16x16x32_bf16 v[16:19], v[72:75], v[144:147], v[16:19]
    ds_read_b128 v[128:131], v10 offset:0
    ds_read_b128 v[132:135], v10 offset:2048
    v_mfma_f32_16x16x32_bf16 v[20:23], v[72:75], v[148:151], v[20:23]
    ds_read_b128 v[136:139], v10 offset:4096
    ds_read_b128 v[140:143], v10 offset:6144
    v_mfma_f32_16x16x32_bf16 v[24:27], v[72:75], v[152:155], v[24:27]
    s_cmp_gt_u32 s37, 8
    s_cbranch_scc0 C2_h8
    C2_h8_r:
    buffer_load_dwordx4 v[64:67], v48, s[8:11], s38 offen offset:0 sc1
    v_mfma_f32_16x16x32_bf16 v[28:31], v[72:75], v[156:159], v[28:31]
    buffer_load_dwordx4 v[68:71], v49, s[8:11], s38 offen offset:0 sc1
    v_mfma_f32_16x16x32_bf16 v[44:47], v[76:79], v[156:159], v[44:47]
    ds_write_b128 v53, v[212:215] offset:17408
    v_mfma_f32_16x16x32_bf16 v[40:43], v[76:79], v[152:155], v[40:43]
    v_mfma_f32_16x16x32_bf16 v[36:39], v[76:79], v[148:151], v[36:39]
    v_mfma_f32_16x16x32_bf16 v[32:35], v[76:79], v[144:147], v[32:35]
    s_waitcnt vmcnt(12) lgkmcnt(1)
    v_mfma_f32_16x16x32_bf16 v[16:19], v[80:83], v[128:131], v[16:19]
    ds_read_b128 v[144:147], v11 offset:0
    ds_read_b128 v[148:151], v11 offset:2048
    v_mfma_f32_16x16x32_bf16 v[20:23], v[80:83], v[132:135], v[20:23]
    ds_read_b128 v[152:155], v11 offset:4096
    ds_read_b128 v[156:159], v11 offset:6144
    v_mfma_f32_16x16x32_bf16 v[24:27], v[80:83], v[136:139], v[24:27]
    buffer_load_dwordx4 v[72:75], v48, s[8:11], s38 offen offset:1024 sc1
    v_mfma_f32_16x16x32_bf16 v[28:31], v[80:83], v[140:143], v[28:31]
    buffer_load_dwordx4 v[76:79], v49, s[8:11], s38 offen offset:1024 sc1
    v_mfma_f32_16x16x32_bf16 v[44:47], v[84:87], v[140:143], v[44:47]
    ds_write_b128 v53, v[216:219] offset:24576
    v_mfma_f32_16x16x32_bf16 v[40:43], v[84:87], v[136:139], v[40:43]
    v_mfma_f32_16x16x32_bf16 v[36:39], v[84:87], v[132:135], v[36:39]
    v_mfma_f32_16x16x32_bf16 v[32:35], v[84:87], v[128:131], v[32:35]
    s_waitcnt vmcnt(12) lgkmcnt(1)
    v_mfma_f32_16x16x32_bf16 v[16:19], v[88:91], v[144:147], v[16:19]
    ds_read_b128 v[128:131], v8 offset:16384
    ds_read_b128 v[132:135], v8 offset:18432
    v_mfma_f32_16x16x32_bf16 v[20:23], v[88:91], v[148:151], v[20:23]
    ds_read_b128 v[136:139], v8 offset:20480
    ds_read_b128 v[140:143], v8 offset:22528
    v_mfma_f32_16x16x32_bf16 v[24:27], v[88:91], v[152:155], v[24:27]
    ds_write_b128 v53, v[220:223] offset:25600
    v_mfma_f32_16x16x32_bf16 v[28:31], v[88:91], v[156:159], v[28:31]
    v_mov_b32 v1, 7
    ds_write_b32 v63, v1 offset:96
    v_mfma_f32_16x16x32_bf16 v[44:47], v[92:95], v[156:159], v[44:47]
    ds_read_b128 v[56:59], v62 offset:96
    v_mfma_f32_16x16x32_bf16 v[40:43], v[92:95], v[152:155], v[40:43]
    buffer_load_dwordx4 v[80:83], v48, s[8:11], s38 offen offset:2048 sc1
    v_mfma_f32_16x16x32_bf16 v[36:39], v[92:95], v[148:151], v[36:39]
    buffer_load_dwordx4 v[84:87], v49, s[8:11], s38 offen offset:2048 sc1
    v_mfma_f32_16x16x32_bf16 v[32:35], v[92:95], v[144:147], v[32:35]
    s_waitcnt vmcnt(12) lgkmcnt(0)
    v_mfma_f32_16x16x32_bf16 v[16:19], v[96:99], v[128:131], v[16:19]
    ds_read_b128 v[144:147], v9 offset:16384
    ds_read_b128 v[148:151], v9 offset:18432
    v_mfma_f32_16x16x32_bf16 v[20:23], v[96:99], v[132:135], v[20:23]
    ds_read_b128 v[152:155], v9 offset:20480
    ds_read_b128 v[156:159], v9 offset:22528
    v_mfma_f32_16x16x32_bf16 v[24:27], v[96:99], v[136:139], v[24:27]
    buffer_load_dwordx4 v[88:91], v48, s[8:11], s38 offen offset:3072 sc1
    v_mfma_f32_16x16x32_bf16 v[28:31], v[96:99], v[140:143], v[28:31]
    buffer_load_dwordx4 v[92:95], v49, s[8:11], s38 offen offset:3072 sc1
    s_add_u32 s38, s38, 32768
    s_and_b32 s38, s38, 0x3ffff
    s_or_b32 s38, s38, s31
    v_mfma_f32_16x16x32_bf16 v[44:47], v[100:103], v[140:143], v[44:47]
    v_min3_u32 v56, v56, v57, v58
    v_mfma_f32_16x16x32_bf16 v[40:43], v[100:103], v[136:139], v[40:43]
    v_min_u32 v56, v56, v59
    v_mfma_f32_16x16x32_bf16 v[36:39], v[100:103], v[132:135], v[36:39]
    v_cmp_gt_u32 vcc, 6, v56
    v_mfma_f32_16x16x32_bf16 v[32:35], v[100:103], v[128:131], v[32:35]
    s_cbranch_vccnz C2_p7
    C2_p7_r:
    s_waitcnt vmcnt(12) lgkmcnt(0)
    v_mfma_f32_16x16x32_bf16 v[16:19], v[104:107], v[144:147], v[16:19]
    ds_read_b128 v[128:131], v10 offset:16384
    ds_read_b128 v[132:135], v10 offset:18432
    v_mfma_f32_16x16x32_bf16 v[20:23], v[104:107], v[148:151], v[20:23]
    ds_read_b128 v[136:139], v10 offset:20480
    ds_read_b128 v[140:143], v10 offset:22528
    v_mfma_f32_16x16x32_bf16 v[24:27], v[104:107], v[152:155], v[24:27]
    s_cmp_gt_u32 s37, 9
    s_cbranch_scc0 C2_h9
    C2_h9_r:
    buffer_load_dwordx4 v[96:99], v48, s[8:11], s38 offen offset:0 sc1
    v_mfma_f32_16x16x32_bf16 v[28:31], v[104:107], v[156:159], v[28:31]
    buffer_load_dwordx4 v[100:103], v49, s[8:11], s38 offen offset:0 sc1
    v_mfma_f32_16x16x32_bf16 v[44:47], v[108:111], v[156:159], v[44:47]
    v_mfma_f32_16x16x32_bf16 v[40:43], v[108:111], v[152:155], v[40:43]
    v_mfma_f32_16x16x32_bf16 v[36:39], v[108:111], v[148:151], v[36:39]
    v_mfma_f32_16x16x32_bf16 v[32:35], v[108:111], v[144:147], v[32:35]
    s_waitcnt vmcnt(12) lgkmcnt(0)
    v_mfma_f32_16x16x32_bf16 v[16:19], v[112:115], v[128:131], v[16:19]
    ds_read_b128 v[144:147], v11 offset:16384
    ds_read_b128 v[148:151], v11 offset:18432
    v_mfma_f32_16x16x32_bf16 v[20:23], v[112:115], v[132:135], v[20:23]
    ds_read_b128 v[152:155], v11 offset:20480
    ds_read_b128 v[156:159], v11 offset:22528
    v_mfma_f32_16x16x32_bf16 v[24:27], v[112:115], v[136:139], v[24:27]
    buffer_load_dwordx4 v[104:107], v48, s[8:11], s38 offen offset:1024 sc1
    v_mfma_f32_16x16x32_bf16 v[28:31], v[112:115], v[140:143], v[28:31]
    buffer_load_dwordx4 v[108:111], v49, s[8:11], s38 offen offset:1024 sc1
    v_mfma_f32_16x16x32_bf16 v[44:47], v[116:119], v[140:143], v[44:47]
    v_mfma_f32_16x16x32_bf16 v[40:43], v[116:119], v[136:139], v[40:43]
    v_mfma_f32_16x16x32_bf16 v[36:39], v[116:119], v[132:135], v[36:39]
    v_mfma_f32_16x16x32_bf16 v[32:35], v[116:119], v[128:131], v[32:35]
    s_waitcnt vmcnt(12) lgkmcnt(0)
    v_mfma_f32_16x16x32_bf16 v[16:19], v[120:123], v[144:147], v[16:19]
    ds_read_b128 v[128:131], v8 offset:32768
    ds_read_b128 v[132:135], v8 offset:34816
    v_mfma_f32_16x16x32_bf16 v[20:23], v[120:123], v[148:151], v[20:23]
    ds_read_b128 v[136:139], v8 offset:36864
    ds_read_b128 v[140:143], v8 offset:38912
    v_mfma_f32_16x16x32_bf16 v[24:27], v[120:123], v[152:155], v[24:27]
    v_mov_b32 v1, 8
    ds_write_b32 v63, v1 offset:96
    v_mfma_f32_16x16x32_bf16 v[28:31], v[120:123], v[156:159], v[28:31]
    ds_read_b128 v[56:59], v62 offset:96
    v_mfma_f32_16x16x32_bf16 v[44:47], v[124:127], v[156:159], v[44:47]
    buffer_load_dwordx4 v[112:115], v48, s[8:11], s38 offen offset:2048 sc1
    v_mfma_f32_16x16x32_bf16 v[40:43], v[124:127], v[152:155], v[40:43]
    buffer_load_dwordx4 v[116:119], v49, s[8:11], s38 offen offset:2048 sc1
    v_mfma_f32_16x16x32_bf16 v[36:39], v[124:127], v[148:151], v[36:39]
    v_mfma_f32_16x16x32_bf16 v[32:35], v[124:127], v[144:147], v[32:35]
    s_waitcnt vmcnt(12) lgkmcnt(0)
    v_mfma_f32_16x16x32_bf16 v[16:19], v[64:67], v[128:131], v[16:19]
    ds_read_b128 v[144:147], v9 offset:32768
    ds_read_b128 v[148:151], v9 offset:34816
    v_mfma_f32_16x16x32_bf16 v[20:23], v[64:67], v[132:135], v[20:23]
    ds_read_b128 v[152:155], v9 offset:36864
    ds_read_b128 v[156:159], v9 offset:38912
    v_mfma_f32_16x16x32_bf16 v[24:27], v[64:67], v[136:139], v[24:27]
    buffer_load_dwordx4 v[120:123], v48, s[8:11], s38 offen offset:3072 sc1
    v_mfma_f32_16x16x32_bf16 v[28:31], v[64:67], v[140:143], v[28:31]
    buffer_load_dwordx4 v[124:127], v49, s[8:11], s38 offen offset:3072 sc1
    s_add_u32 s38, s38, 32768
    s_and_b32 s38, s38, 0x3ffff
    s_or_b32 s38, s38, s31
    v_mfma_f32_16x16x32_bf16 v[44:47], v[68:71], v[140:143], v[44:47]
    v_min3_u32 v56, v56, v57, v58
    v_mfma_f32_16x16x32_bf16 v[40:43], v[68:71], v[136:139], v[40:43]
    v_min_u32 v56, v56, v59
    v_mfma_f32_16x16x32_bf16 v[36:39], v[68:71], v[132:135], v[36:39]
    v_cmp_gt_u32 vcc, 7, v56
    v_mfma_f32_16x16x32_bf16 v[32:35], v[68:71], v[128:131], v[32:35]
    s_cbranch_vccnz C2_p8
    C2_p8_r:
    s_waitcnt vmcnt(12) lgkmcnt(0)
    v_mfma_f32_16x16x32_bf16 v[16:19], v[72:75], v[144:147], v[16:19]
    ds_read_b128 v[128:131], v10 offset:32768
    ds_read_b128 v[132:135], v10 offset:34816
    v_mfma_f32_16x16x32_bf16 v[20:23], v[72:75], v[148:151], v[20:23]
    ds_read_b128 v[136:139], v10 offset:36864
    ds_read_b128 v[140:143], v10 offset:38912
    v_mfma_f32_16x16x32_bf16 v[24:27], v[72:75], v[152:155], v[24:27]
    s_cmp_gt_u32 s37, 10
    s_cbranch_scc0 C2_h10
    C2_h10_r:
    buffer_load_dwordx4 v[64:67], v48, s[8:11], s38 offen offset:0 sc1
    v_mfma_f32_16x16x32_bf16 v[28:31], v[72:75], v[156:159], v[28:31]
    buffer_load_dwordx4 v[68:71], v49, s[8:11], s38 offen offset:0 sc1
    v_mfma_f32_16x16x32_bf16 v[44:47], v[76:79], v[156:159], v[44:47]
    v_mfma_f32_16x16x32_bf16 v[40:43], v[76:79], v[152:155], v[40:43]
    v_mfma_f32_16x16x32_bf16 v[36:39], v[76:79], v[148:151], v[36:39]
    v_mfma_f32_16x16x32_bf16 v[32:35], v[76:79], v[144:147], v[32:35]
    s_waitcnt vmcnt(12) lgkmcnt(0)
    v_mfma_f32_16x16x32_bf16 v[16:19], v[80:83], v[128:131], v[16:19]
    ds_read_b128 v[144:147], v11 offset:32768
    ds_read_b128 v[148:151], v11 offset:34816
    v_mfma_f32_16x16x32_bf16 v[20:23], v[80:83], v[132:135], v[20:23]
    ds_read_b128 v[152:155], v11 offset:36864
    ds_read_b128 v[156:159], v11 offset:38912
    v_mfma_f32_16x16x32_bf16 v[24:27], v[80:83], v[136:139], v[24:27]
    buffer_load_dwordx4 v[72:75], v48, s[8:11], s38 offen offset:1024 sc1
    v_mfma_f32_16x16x32_bf16 v[28:31], v[80:83], v[140:143], v[28:31]
    buffer_load_dwordx4 v[76:79], v49, s[8:11], s38 offen offset:1024 sc1
    v_mfma_f32_16x16x32_bf16 v[44:47], v[84:87], v[140:143], v[44:47]
    v_mfma_f32_16x16x32_bf16 v[40:43], v[84:87], v[136:139], v[40:43]
    v_mfma_f32_16x16x32_bf16 v[36:39], v[84:87], v[132:135], v[36:39]
    v_mfma_f32_16x16x32_bf16 v[32:35], v[84:87], v[128:131], v[32:35]
    s_waitcnt vmcnt(12) lgkmcnt(0)
    v_mfma_f32_16x16x32_bf16 v[16:19], v[88:91], v[144:147], v[16:19]
    ds_read_b128 v[128:131], v4 offset:0
    ds_read_b128 v[132:135], v4 offset:2048
    v_mfma_f32_16x16x32_bf16 v[20:23], v[88:91], v[148:151], v[20:23]
    ds_read_b128 v[136:139], v4 offset:4096
    ds_read_b128 v[140:143], v4 offset:6144
    v_mfma_f32_16x16x32_bf16 v[24:27], v[88:91], v[152:155], v[24:27]
    v_mov_b32 v1, 9
    ds_write_b32 v63, v1 offset:96
    v_mfma_f32_16x16x32_bf16 v[28:31], v[88:91], v[156:159], v[28:31]
    buffer_load_dwordx4 v[80:83], v48, s[8:11], s38 offen offset:2048 sc1
    v_mfma_f32_16x16x32_bf16 v[44:47], v[92:95], v[156:159], v[44:47]
    buffer_load_dwordx4 v[84:87], v49, s[8:11], s38 offen offset:2048 sc1
    v_mfma_f32_16x16x32_bf16 v[40:43], v[92:95], v[152:155], v[40:43]
    v_mfma_f32_16x16x32_bf16 v[36:39], v[92:95], v[148:151], v[36:39]
    v_mfma_f32_16x16x32_bf16 v[32:35], v[92:95], v[144:147], v[32:35]
    s_waitcnt vmcnt(12) lgkmcnt(1)
    v_mfma_f32_16x16x32_bf16 v[16:19], v[96:99], v[128:131], v[16:19]
    ds_read_b128 v[144:147], v5 offset:0
    ds_read_b128 v[148:151], v5 offset:2048
    v_mfma_f32_16x16x32_bf16 v[20:23], v[96:99], v[132:135], v[20:23]
    ds_read_b128 v[152:155], v5 offset:4096
    ds_read_b128 v[156:159], v5 offset:6144
    v_mfma_f32_16x16x32_bf16 v[24:27], v[96:99], v[136:139], v[24:27]
    buffer_load_dwordx4 v[88:91], v48, s[8:11], s38 offen offset:3072 sc1
    v_mfma_f32_16x16x32_bf16 v[28:31], v[96:99], v[140:143], v[28:31]
    buffer_load_dwordx4 v[92:95], v49, s[8:11], s38 offen offset:3072 sc1
    s_add_u32 s38, s38, 32768
    s_and_b32 s38, s38, 0x3ffff
    s_or_b32 s38, s38, s31
    v_mfma_f32_16x16x32_bf16 v[44:47], v[100:103], v[140:143], v[44:47]
    v_mfma_f32_16x16x32_bf16 v[40:43], v[100:103], v[136:139], v[40:43]
    v_mfma_f32_16x16x32_bf16 v[36:39], v[100:103], v[132:135], v[36:39]
    v_mfma_f32_16x16x32_bf16 v[32:35], v[100:103], v[128:131], v[32:35]
    s_waitcnt vmcnt(12) lgkmcnt(0)
    v_mfma_f32_16x16x32_bf16 v[16:19], v[104:107], v[144:147], v[16:19]
    ds_read_b128 v[128:131], v6 offset:0
    ds_read_b128 v[132:135], v6 offset:2048
    v_mfma_f32_16x16x32_bf16 v[20:23], v[104:107], v[148:151], v[20:23]
    ds_read_b128 v[136:139], v6 offset:4096
    ds_read_b128 v[140:143], v6 offset:6144
    v_mfma_f32_16x16x32_bf16 v[24:27], v[104:107], v[152:155], v[24:27]
    s_cmp_gt_u32 s37, 11
    s_cbranch_scc0 C2_h11
    C2_h11_r:
    buffer_load_dwordx4 v[96:99], v48, s[8:11], s38 offen offset:0 sc1
    v_mfma_f32_16x16x32_bf16 v[28:31], v[104:107], v[156:159], v[28:31]
    buffer_load_dwordx4 v[100:103], v49, s[8:11], s38 offen offset:0 sc1
    v_mfma_f32_16x16x32_bf16 v[44:47], v[108:111], v[156:159], v[44:47]
    v_mfma_f32_16x16x32_bf16 v[40:43], v[108:111], v[152:155], v[40:43]
    v_mfma_f32_16x16x32_bf16 v[36:39], v[108:111], v[148:151], v[36:39]
    v_mfma_f32_16x16x32_bf16 v[32:35], v[108:111], v[144:147], v[32:35]
    s_waitcnt vmcnt(12) lgkmcnt(0)
    v_mfma_f32_16x16x32_bf16 v[16:19], v[112:115], v[128:131], v[16:19]
    ds_read_b128 v[144:147], v7 offset:0
    ds_read_b128 v[148:151], v7 offset:2048
    v_mfma_f32_16x16x32_bf16 v[20:23], v[112:115], v[132:135], v[20:23]
    ds_read_b128 v[152:155], v7 offset:4096
    ds_read_b128 v[156:159], v7 offset:6144
    v_mfma_f32_16x16x32_bf16 v[24:27], v[112:115], v[136:139], v[24:27]
    buffer_load_dwordx4 v[104:107], v48, s[8:11], s38 offen offset:1024 sc1
    v_mfma_f32_16x16x32_bf16 v[28:31], v[112:115], v[140:143], v[28:31]
    buffer_load_dwordx4 v[108:111], v49, s[8:11], s38 offen offset:1024 sc1
    v_mfma_f32_16x16x32_bf16 v[44:47], v[116:119], v[140:143], v[44:47]
    v_mfma_f32_16x16x32_bf16 v[40:43], v[116:119], v[136:139], v[40:43]
    v_mfma_f32_16x16x32_bf16 v[36:39], v[116:119], v[132:135], v[36:39]
    v_mfma_f32_16x16x32_bf16 v[32:35], v[116:119], v[128:131], v[32:35]
    s_waitcnt vmcnt(12) lgkmcnt(0)
    v_mfma_f32_16x16x32_bf16 v[16:19], v[120:123], v[144:147], v[16:19]
    ds_read_b128 v[128:131], v4 offset:16384
    ds_read_b128 v[132:135], v4 offset:18432
    v_mfma_f32_16x16x32_bf16 v[20:23], v[120:123], v[148:151], v[20:23]
    ds_read_b128 v[136:139], v4 offset:20480
    ds_read_b128 v[140:143], v4 offset:22528
    v_mfma_f32_16x16x32_bf16 v[24:27], v[120:123], v[152:155], v[24:27]
    v_mov_b32 v1, 10
    ds_write_b32 v63, v1 offset:96
    v_mfma_f32_16x16x32_bf16 v[28:31], v[120:123], v[156:159], v[28:31]
    ds_read_b128 v[12:15], v62 offset:48
    v_mfma_f32_16x16x32_bf16 v[44:47], v[124:127], v[156:159], v[44:47]
    buffer_load_dwordx4 v[112:115], v48, s[8:11], s38 offen offset:2048 sc1
    v_mfma_f32_16x16x32_bf16 v[40:43], v[124:127], v[152:155], v[40:43]
    buffer_load_dwordx4 v[116:119], v49, s[8:11], s38 offen offset:2048 sc1
    v_mfma_f32_16x16x32_bf16 v[36:39], v[124:127], v[148:151], v[36:39]
    v_mfma_f32_16x16x32_bf16 v[32:35], v[124:127], v[144:147], v[32:35]
    s_waitcnt vmcnt(12) lgkmcnt(0)
    v_mfma_f32_16x16x32_bf16 v[16:19], v[64:67], v[128:131], v[16:19]
    ds_read_b128 v[144:147], v5 offset:16384
    ds_read_b128 v[148:151], v5 offset:18432
    v_mfma_f32_16x16x32_bf16 v[20:23], v[64:67], v[132:135], v[20:23]
    ds_read_b128 v[152:155], v5 offset:20480
    ds_read_b128 v[156:159], v5 offset:22528
    v_mfma_f32_16x16x32_bf16 v[24:27], v[64:67], v[136:139], v[24:27]
    buffer_load_dwordx4 v[120:123], v48, s[8:11], s38 offen offset:3072 sc1
    v_mfma_f32_16x16x32_bf16 v[28:31], v[64:67], v[140:143], v[28:31]
    buffer_load_dwordx4 v[124:127], v49, s[8:11], s38 offen offset:3072 sc1
    s_add_u32 s38, s38, 32768
    s_and_b32 s38, s38, 0x3ffff
    s_or_b32 s38, s38, s31
    v_mfma_f32_16x16x32_bf16 v[44:47], v[68:71], v[140:143], v[44:47]
    v_min3_u32 v12, v12, v13, v14
    v_mfma_f32_16x16x32_bf16 v[40:43], v[68:71], v[136:139], v[40:43]
    v_min_u32 v12, v12, v15
    v_mfma_f32_16x16x32_bf16 v[36:39], v[68:71], v[132:135], v[36:39]
    v_cmp_gt_u32 vcc, 12, v12
    v_mfma_f32_16x16x32_bf16 v[32:35], v[68:71], v[128:131], v[32:35]
    s_cbranch_vccnz C2_q10
    C2_q10_r:
    s_waitcnt vmcnt(12) lgkmcnt(0)
    v_mfma_f32_16x16x32_bf16 v[16:19], v[72:75], v[144:147], v[16:19]
    ds_read_b128 v[128:131], v6 offset:16384
    ds_read_b128 v[132:135], v6 offset:18432
    v_mfma_f32_16x16x32_bf16 v[20:23], v[72:75], v[148:151], v[20:23]
    ds_read_b128 v[136:139], v6 offset:20480
    ds_read_b128 v[140:143], v6 offset:22528
    v_mfma_f32_16x16x32_bf16 v[24:27], v[72:75], v[152:155], v[24:27]
    s_cmp_gt_u32 s37, 12
    s_cbranch_scc0 C2_h12
    C2_h12_r:
    buffer_load_dwordx4 v[64:67], v48, s[8:11], s38 offen offset:0 sc1
    v_mfma_f32_16x16x32_bf16 v[28:31], v[72:75], v[156:159], v[28:31]
    buffer_load_dwordx4 v[68:71], v49, s[8:11], s38 offen offset:0 sc1
    v_mfma_f32_16x16x32_bf16 v[44:47], v[76:79], v[156:159], v[44:47]
    v_mfma_f32_16x16x32_bf16 v[40:43], v[76:79], v[152:155], v[40:43]
    v_mfma_f32_16x16x32_bf16 v[36:39], v[76:79], v[148:151], v[36:39]
    v_mfma_f32_16x16x32_bf16 v[32:35], v[76:79], v[144:147], v[32:35]
    s_waitcnt vmcnt(12) lgkmcnt(0)
    v_mfma_f32_16x16x32_bf16 v[16:19], v[80:83], v[128:131], v[16:19]
    ds_read_b128 v[144:147], v7 offset:16384
    ds_read_b128 v[148:151], v7 offset:18432
    v_mfma_f32_16x16x32_bf16 v[20:23], v[80:83], v[132:135], v[20:23]
    ds_read_b128 v[152:155], v7 offset:20480
    ds_read_b128 v[156:159], v7 offset:22528
    v_mfma_f32_16x16x32_bf16 v[24:27], v[80:83], v[136:139], v[24:27]
    buffer_load_dwordx4 v[72:75], v48, s[8:11], s38 offen offset:1024 sc1
    v_mfma_f32_16x16x32_bf16 v[28:31], v[80:83], v[140:143], v[28:31]
    buffer_load_dwordx4 v[76:79], v49, s[8:11], s38 offen offset:1024 sc1
    v_mfma_f32_16x16x32_bf16 v[44:47], v[84:87], v[140:143], v[44:47]
    v_mfma_f32_16x16x32_bf16 v[40:43], v[84:87], v[136:139], v[40:43]
    v_mfma_f32_16x16x32_bf16 v[36:39], v[84:87], v[132:135], v[36:39]
    v_mfma_f32_16x16x32_bf16 v[32:35], v[84:87], v[128:131], v[32:35]
    s_waitcnt vmcnt(12) lgkmcnt(0)
    v_mfma_f32_16x16x32_bf16 v[16:19], v[88:91], v[144:147], v[16:19]
    ds_read_b128 v[128:131], v4 offset:32768
    ds_read_b128 v[132:135], v4 offset:34816
    v_mfma_f32_16x16x32_bf16 v[20:23], v[88:91], v[148:151], v[20:23]
    ds_read_b128 v[136:139], v4 offset:36864
    ds_read_b128 v[140:143], v4 offset:38912
    v_mfma_f32_16x16x32_bf16 v[24:27], v[88:91], v[152:155], v[24:27]
    v_mov_b32 v1, 11
    ds_write_b32 v63, v1 offset:96
    v_mfma_f32_16x16x32_bf16 v[28:31], v[88:91], v[156:159], v[28:31]
    ds_read_b128 v[12:15], v62 offset:48
    v_mfma_f32_16x16x32_bf16 v[44:47], v[92:95], v[156:159], v[44:47]
    buffer_load_dwordx4 v[80:83], v48, s[8:11], s38 offen offset:2048 sc1
    v_mfma_f32_16x16x32_bf16 v[40:43], v[92:95], v[152:155], v[40:43]
    buffer_load_dwordx4 v[84:87], v49, s[8:11], s38 offen offset:2048 sc1
    v_mfma_f32_16x16x32_bf16 v[36:39], v[92:95], v[148:151], v[36:39]
    v_mfma_f32_16x16x32_bf16 v[32:35], v[92:95], v[144:147], v[32:35]
    s_waitcnt vmcnt(12) lgkmcnt(0)
    v_mfma_f32_16x16x32_bf16 v[16:19], v[96:99], v[128:131], v[16:19]
    ds_read_b128 v[144:147], v5 offset:32768
    ds_read_b128 v[148:151], v5 offset:34816
    v_mfma_f32_16x16x32_bf16 v[20:23], v[96:99], v[132:135], v[20:23]
    ds_read_b128 v[152:155], v5 offset:36864
    ds_read_b128 v[156:159], v5 offset:38912
    v_mfma_f32_16x16x32_bf16 v[24:27], v[96:99], v[136:139], v[24:27]
    buffer_load_dwordx4 v[88:91], v48, s[8:11], s38 offen offset:3072 sc1
    v_mfma_f32_16x16x32_bf16 v[28:31], v[96:99], v[140:143], v[28:31]
    buffer_load_dwordx4 v[92:95], v49, s[8:11], s38 offen offset:3072 sc1
    s_add_u32 s40, s38, 32768
    s_and_b32 s40, s40, 0x3ffff
    s_or_b32 s40, s40, s31
    s_add_u32 s41, s38, 65536
    s_and_b32 s41, s41, 0x3ffff
    s_or_b32 s41, s41, s31
    s_add_u32 s42, s38, 98304
    s_and_b32 s42, s42, 0x3ffff
    s_or_b32 s42, s42, s31
    v_mfma_f32_16x16x32_bf16 v[44:47], v[100:103], v[140:143], v[44:47]
    v_min3_u32 v12, v12, v13, v14
    v_mfma_f32_16x16x32_bf16 v[40:43], v[100:103], v[136:139], v[40:43]
    v_min_u32 v12, v12, v15
    v_mfma_f32_16x16x32_bf16 v[36:39], v[100:103], v[132:135], v[36:39]
    v_cmp_gt_u32 vcc, 13, v12
    v_mfma_f32_16x16x32_bf16 v[32:35], v[100:103], v[128:131], v[32:35]
    s_cbranch_vccnz C2_q11
    C2_q11_r:
    s_waitcnt vmcnt(12) lgkmcnt(0)
    v_mfma_f32_16x16x32_bf16 v[16:19], v[104:107], v[144:147], v[16:19]
    ds_read_b128 v[128:131], v6 offset:32768
    ds_read_b128 v[132:135], v6 offset:34816
    v_mfma_f32_16x16x32_bf16 v[20:23], v[104:107], v[148:151], v[20:23]
    ds_read_b128 v[136:139], v6 offset:36864
    ds_read_b128 v[140:143], v6 offset:38912
    v_mfma_f32_16x16x32_bf16 v[24:27], v[104:107], v[152:155], v[24:27]
    s_cmp_gt_u32 s37, 13
    s_cbranch_scc0 C2_h13
    C2_h13_r:
    buffer_load_dwordx4 v[96:99], v48, s[8:11], s40 offen offset:0 sc1
    v_mfma_f32_16x16x32_bf16 v[28:31], v[104:107], v[156:159], v[28:31]
    buffer_load_dwordx4 v[100:103], v48, s[8:11], s40 offen offset:1024 sc1
    v_mfma_f32_16x16x32_bf16 v[44:47], v[108:111], v[156:159], v[44:47]
    v_mfma_f32_16x16x32_bf16 v[40:43], v[108:111], v[152:155], v[40:43]
    v_mfma_f32_16x16x32_bf16 v[36:39], v[108:111], v[148:151], v[36:39]
    v_mfma_f32_16x16x32_bf16 v[32:35], v[108:111], v[144:147], v[32:35]
    s_waitcnt vmcnt(12) lgkmcnt(0)
    v_mfma_f32_16x16x32_bf16 v[16:19], v[112:115], v[128:131], v[16:19]
    ds_read_b128 v[144:147], v7 offset:32768
    ds_read_b128 v[148:151], v7 offset:34816
    v_mfma_f32_16x16x32_bf16 v[20:23], v[112:115], v[132:135], v[20:23]
    ds_read_b128 v[152:155], v7 offset:36864
    ds_read_b128 v[156:159], v7 offset:38912
    v_mfma_f32_16x16x32_bf16 v[24:27], v[112:115], v[136:139], v[24:27]
    buffer_load_dwordx4 v[104:107], v48, s[8:11], s40 offen offset:2048 sc1
    v_mfma_f32_16x16x32_bf16 v[28:31], v[112:115], v[140:143], v[28:31]
    buffer_load_dwordx4 v[108:111], v48, s[8:11], s40 offen offset:3072 sc1
    v_mfma_f32_16x16x32_bf16 v[44:47], v[116:119], v[140:143], v[44:47]
    v_mfma_f32_16x16x32_bf16 v[40:43], v[116:119], v[136:139], v[40:43]
    v_mfma_f32_16x16x32_bf16 v[36:39], v[116:119], v[132:135], v[36:39]
    v_mfma_f32_16x16x32_bf16 v[32:35], v[116:119], v[128:131], v[32:35]
    s_waitcnt vmcnt(12) lgkmcnt(0)
    v_mfma_f32_16x16x32_bf16 v[16:19], v[120:123], v[144:147], v[16:19]
    ds_read_b128 v[128:131], v8 offset:0
    ds_read_b128 v[132:135], v8 offset:2048
    v_mfma_f32_16x16x32_bf16 v[20:23], v[120:123], v[148:151], v[20:23]
    ds_read_b128 v[136:139], v8 offset:4096
    ds_read_b128 v[140:143], v8 offset:6144
    v_mfma_f32_16x16x32_bf16 v[24:27], v[120:123], v[152:155], v[24:27]
    v_mov_b32 v1, 12
    ds_write_b32 v63, v1 offset:96
    v_mfma_f32_16x16x32_bf16 v[28:31], v[120:123], v[156:159], v[28:31]
    ds_read_b128 v[12:15], v62 offset:48
    v_mfma_f32_16x16x32_bf16 v[44:47], v[124:127], v[156:159], v[44:47]
    s_cmp_gt_u32 s37, 14
    s_cbranch_scc0 C2_h14
    C2_h14_r:
    buffer_load_dwordx4 v[112:115], v48, s[8:11], s41 offen offset:0 sc1
    v_mfma_f32_16x16x32_bf16 v[40:43], v[124:127], v[152:155], v[40:43]
    buffer_load_dwordx4 v[116:119], v48, s[8:11], s41 offen offset:1024 sc1
    v_mfma_f32_16x16x32_bf16 v[36:39], v[124:127], v[148:151], v[36:39]
    v_mfma_f32_16x16x32_bf16 v[32:35], v[124:127], v[144:147], v[32:35]
    s_waitcnt vmcnt(12) lgkmcnt(0)
    v_mfma_f32_16x16x32_bf16 v[16:19], v[64:67], v[128:131], v[16:19]
    ds_read_b128 v[144:147], v9 offset:0
    ds_read_b128 v[148:151], v9 offset:2048
    v_mfma_f32_16x16x32_bf16 v[20:23], v[64:67], v[132:135], v[20:23]
    ds_read_b128 v[152:155], v9 offset:4096
    ds_read_b128 v[156:159], v9 offset:6144
    v_mfma_f32_16x16x32_bf16 v[24:27], v[64:67], v[136:139], v[24:27]
    buffer_load_dwordx4 v[120:123], v48, s[8:11], s41 offen offset:2048 sc1
    v_mfma_f32_16x16x32_bf16 v[28:31], v[64:67], v[140:143], v[28:31]
    buffer_load_dwordx4 v[124:127], v48, s[8:11], s41 offen offset:3072 sc1
    v_mfma_f32_16x16x32_bf16 v[44:47], v[68:71], v[140:143], v[44:47]
    v_min3_u32 v12, v12, v13, v14
    v_mfma_f32_16x16x32_bf16 v[40:43], v[68:71], v[136:139], v[40:43]
    v_min_u32 v12, v12, v15
    v_mfma_f32_16x16x32_bf16 v[36:39], v[68:71], v[132:135], v[36:39]
    v_cmp_gt_u32 vcc, 14, v12
    v_mfma_f32_16x16x32_bf16 v[32:35], v[68:71], v[128:131], v[32:35]
    s_cbranch_vccnz C2_q12
    C2_q12_r:
    s_waitcnt vmcnt(12) lgkmcnt(0)
    v_mfma_f32_16x16x32_bf16 v[16:19], v[72:75], v[144:147], v[16:19]
    ds_read_b128 v[128:131], v10 offset:0
    ds_read_b128 v[132:135], v10 offset:2048
    v_mfma_f32_16x16x32_bf16 v[20:23], v[72:75], v[148:151], v[20:23]
    ds_read_b128 v[136:139], v10 offset:4096
    ds_read_b128 v[140:143], v10 offset:6144
    v_mfma_f32_16x16x32_bf16 v[24:27], v[72:75], v[152:155], v[24:27]
    s_cmp_gt_u32 s37, 15
    s_cbranch_scc0 C2_h15
    C2_h15_r:
    buffer_load_dwordx4 v[64:67], v48, s[8:11], s42 offen offset:0 sc1
    v_mfma_f32_16x16x32_bf16 v[28:31], v[72:75], v[156:159], v[28:31]
    buffer_load_dwordx4 v[68:71], v48, s[8:11], s42 offen offset:1024 sc1
    v_mfma_f32_16x16x32_bf16 v[44:47], v[76:79], v[156:159], v[44:47]
    v_mfma_f32_16x16x32_bf16 v[40:43], v[76:79], v[152:155], v[40:43]
    v_mfma_f32_16x16x32_bf16 v[36:39], v[76:79], v[148:151], v[36:39]
    v_mfma_f32_16x16x32_bf16 v[32:35], v[76:79], v[144:147], v[32:35]
    s_waitcnt vmcnt(12) lgkmcnt(0)
    v_mfma_f32_16x16x32_bf16 v[16:19], v[80:83], v[128:131], v[16:19]
    ds_read_b128 v[144:147], v11 offset:0
    ds_read_b128 v[148:151], v11 offset:2048
    v_mfma_f32_16x16x32_bf16 v[20:23], v[80:83], v[132:135], v[20:23]
    ds_read_b128 v[152:155], v11 offset:4096
    ds_read_b128 v[156:159], v11 offset:6144
    v_mfma_f32_16x16x32_bf16 v[24:27], v[80:83], v[136:139], v[24:27]
    buffer_load_dwordx4 v[72:75], v48, s[8:11], s42 offen offset:2048 sc1
    v_mfma_f32_16x16x32_bf16 v[28:31], v[80:83], v[140:143], v[28:31]
    buffer_load_dwordx4 v[76:79], v48, s[8:11], s42 offen offset:3072 sc1
    v_mfma_f32_16x16x32_bf16 v[44:47], v[84:87], v[140:143], v[44:47]
    v_mfma_f32_16x16x32_bf16 v[40:43], v[84:87], v[136:139], v[40:43]
    v_mfma_f32_16x16x32_bf16 v[36:39], v[84:87], v[132:135], v[36:39]
    v_mfma_f32_16x16x32_bf16 v[32:35], v[84:87], v[128:131], v[32:35]
    s_waitcnt vmcnt(12) lgkmcnt(0)
    v_mfma_f32_16x16x32_bf16 v[16:19], v[88:91], v[144:147], v[16:19]
    ds_read_b128 v[160:163], v8 offset:16384
    ds_read_b128 v[164:167], v8 offset:18432
    v_mfma_f32_16x16x32_bf16 v[20:23], v[88:91], v[148:151], v[20:23]
    ds_read_b128 v[168:171], v8 offset:20480
    ds_read_b128 v[172:175], v8 offset:22528
    v_mfma_f32_16x16x32_bf16 v[24:27], v[88:91], v[152:155], v[24:27]
    ds_read_b128 v[176:179], v9 offset:16384
    ds_read_b128 v[180:183], v9 offset:18432
    v_mfma_f32_16x16x32_bf16 v[28:31], v[88:91], v[156:159], v[28:31]
    ds_read_b128 v[184:187], v9 offset:20480
    ds_read_b128 v[188:191], v9 offset:22528
    v_mfma_f32_16x16x32_bf16 v[44:47], v[92:95], v[156:159], v[44:47]
    v_mov_b32 v1, 13
    ds_write_b32 v63, v1 offset:96
    v_mfma_f32_16x16x32_bf16 v[40:43], v[92:95], v[152:155], v[40:43]
    ds_read_b128 v[12:15], v62 offset:48
    v_mfma_f32_16x16x32_bf16 v[36:39], v[92:95], v[148:151], v[36:39]
    buffer_load_dwordx4 v[80:83], v49, s[8:11], s40 offen offset:0 sc1
    v_mfma_f32_16x16x32_bf16 v[32:35], v[92:95], v[144:147], v[32:35]
    buffer_load_dwordx4 v[84:87], v49, s[8:11], s40 offen offset:1024 sc1
    s_waitcnt vmcnt(12) lgkmcnt(0)
    v_mfma_f32_16x16x32_bf16 v[16:19], v[96:99], v[160:163], v[16:19]
    ds_read_b128 v[192:195], v10 offset:16384
    ds_read_b128 v[196:199], v10 offset:18432
    v_mfma_f32_16x16x32_bf16 v[20:23], v[96:99], v[164:167], v[20:23]
    ds_read_b128 v[200:203], v10 offset:20480
    ds_read_b128 v[204:207], v10 offset:22528
    v_mfma_f32_16x16x32_bf16 v[24:27], v[96:99], v[168:171], v[24:27]
    ds_read_b128 v[208:211], v11 offset:16384
    ds_read_b128 v[212:215], v11 offset:18432
    v_mfma_f32_16x16x32_bf16 v[28:31], v[96:99], v[172:175], v[28:31]
    ds_read_b128 v[216:219], v11 offset:20480
    ds_read_b128 v[220:223], v11 offset:22528
    v_mfma_f32_16x16x32_bf16 v[16:19], v[100:103], v[176:179], v[16:19]
    buffer_load_dwordx4 v[88:91], v49, s[8:11], s40 offen offset:2048 sc1
    buffer_load_dwordx4 v[92:95], v49, s[8:11], s40 offen offset:3072 sc1
    v_mfma_f32_16x16x32_bf16 v[20:23], v[100:103], v[180:183], v[20:23]
    v_min3_u32 v12, v12, v13, v14
    v_min_u32 v12, v12, v15
    v_mfma_f32_16x16x32_bf16 v[24:27], v[100:103], v[184:187], v[24:27]
    v_cmp_gt_u32 vcc, 16, v12
    v_mfma_f32_16x16x32_bf16 v[28:31], v[100:103], v[188:191], v[28:31]
    s_cbranch_vccnz C2_q13
    C2_q13_r:
    s_waitcnt vmcnt(12) lgkmcnt(0)
    v_mfma_f32_16x16x32_bf16 v[16:19], v[104:107], v[192:195], v[16:19]
    ds_read_b128 v[160:163], v8 offset:32768
    ds_read_b128 v[164:167], v8 offset:34816
    v_mfma_f32_16x16x32_bf16 v[20:23], v[104:107], v[196:199], v[20:23]
    ds_read_b128 v[168:171], v8 offset:36864
    ds_read_b128 v[172:175], v8 offset:38912
    v_mfma_f32_16x16x32_bf16 v[24:27], v[104:107], v[200:203], v[24:27]
    ds_read_b128 v[176:179], v9 offset:32768
    ds_read_b128 v[180:183], v9 offset:34816
    v_mfma_f32_16x16x32_bf16 v[28:31], v[104:107], v[204:207], v[28:31]
    ds_read_b128 v[184:187], v9 offset:36864
    ds_read_b128 v[188:191], v9 offset:38912
    v_mfma_f32_16x16x32_bf16 v[16:19], v[108:111], v[208:211], v[16:19]
    buffer_load_dwordx4 v[96:99], v49, s[8:11], s41 offen offset:0 sc1
    v_mfma_f32_16x16x32_bf16 v[20:23], v[108:111], v[212:215], v[20:23]
    buffer_load_dwordx4 v[100:103], v49, s[8:11], s41 offen offset:1024 sc1
    v_mfma_f32_16x16x32_bf16 v[24:27], v[108:111], v[216:219], v[24:27]
    v_mfma_f32_16x16x32_bf16 v[28:31], v[108:111], v[220:223], v[28:31]
    s_waitcnt vmcnt(12) lgkmcnt(0)
    v_mfma_f32_16x16x32_bf16 v[16:19], v[112:115], v[160:163], v[16:19]
    ds_read_b128 v[192:195], v10 offset:32768
    ds_read_b128 v[196:199], v10 offset:34816
    v_mfma_f32_16x16x32_bf16 v[20:23], v[112:115], v[164:167], v[20:23]
    ds_read_b128 v[200:203], v10 offset:36864
    ds_read_b128 v[204:207], v10 offset:38912
    v_mfma_f32_16x16x32_bf16 v[24:27], v[112:115], v[168:171], v[24:27]
    ds_read_b128 v[208:211], v11 offset:32768
    ds_read_b128 v[212:215], v11 offset:34816
    v_mfma_f32_16x16x32_bf16 v[28:31], v[112:115], v[172:175], v[28:31]
    ds_read_b128 v[216:219], v11 offset:36864
    ds_read_b128 v[220:223], v11 offset:38912
    v_mfma_f32_16x16x32_bf16 v[16:19], v[116:119], v[176:179], v[16:19]
    buffer_load_dwordx4 v[104:107], v49, s[8:11], s41 offen offset:2048 sc1
    v_mfma_f32_16x16x32_bf16 v[20:23], v[116:119], v[180:183], v[20:23]
    buffer_load_dwordx4 v[108:111], v49, s[8:11], s41 offen offset:3072 sc1
    v_mfma_f32_16x16x32_bf16 v[24:27], v[116:119], v[184:187], v[24:27]
    v_mfma_f32_16x16x32_bf16 v[28:31], v[116:119], v[188:191], v[28:31]
    s_waitcnt vmcnt(12) lgkmcnt(0)
    v_mfma_f32_16x16x32_bf16 v[16:19], v[120:123], v[192:195], v[16:19]
    ds_read_b128 v[160:163], v4 offset:0
    ds_read_b128 v[164:167], v4 offset:2048
    v_mfma_f32_16x16x32_bf16 v[20:23], v[120:123], v[196:199], v[20:23]
    ds_read_b128 v[168:171], v4 offset:4096
    ds_read_b128 v[172:175], v4 offset:6144
    v_mfma_f32_16x16x32_bf16 v[24:27], v[120:123], v[200:203], v[24:27]
    ds_read_b128 v[176:179], v5 offset:0
    ds_read_b128 v[180:183], v5 offset:2048
    v_mfma_f32_16x16x32_bf16 v[28:31], v[120:123], v[204:207], v[28:31]
    ds_read_b128 v[184:187], v5 offset:4096
    ds_read_b128 v[188:191], v5 offset:6144
    v_mfma_f32_16x16x32_bf16 v[16:19], v[124:127], v[208:211], v[16:19]
    buffer_load_dwordx4 v[112:115], v49, s[8:11], s42 offen offset:0 sc1
    v_mfma_f32_16x16x32_bf16 v[20:23], v[124:127], v[212:215], v[20:23]
    buffer_load_dwordx4 v[116:119], v49, s[8:11], s42 offen offset:1024 sc1
    v_mfma_f32_16x16x32_bf16 v[24:27], v[124:127], v[216:219], v[24:27]
    v_mfma_f32_16x16x32_bf16 v[28:31], v[124:127], v[220:223], v[28:31]
    s_waitcnt vmcnt(12) lgkmcnt(0)
    v_mfma_f32_16x16x32_bf16 v[16:19], v[64:67], v[160:163], v[16:19]
    ds_read_b128 v[192:195], v6 offset:0
    ds_read_b128 v[196:199], v6 offset:2048
    v_mfma_f32_16x16x32_bf16 v[20:23], v[64:67], v[164:167], v[20:23]
    ds_read_b128 v[200:203], v6 offset:4096
    ds_read_b128 v[204:207], v6 offset:6144
    v_mfma_f32_16x16x32_bf16 v[24:27], v[64:67], v[168:171], v[24:27]
    ds_read_b128 v[208:211], v7 offset:0
    ds_read_b128 v[212:215], v7 offset:2048
    v_mfma_f32_16x16x32_bf16 v[28:31], v[64:67], v[172:175], v[28:31]
    ds_read_b128 v[216:219], v7 offset:4096
    ds_read_b128 v[220:223], v7 offset:6144
    v_mfma_f32_16x16x32_bf16 v[16:19], v[68:71], v[176:179], v[16:19]
    buffer_load_dwordx4 v[120:123], v49, s[8:11], s42 offen offset:2048 sc1
    v_mfma_f32_16x16x32_bf16 v[20:23], v[68:71], v[180:183], v[20:23]
    buffer_load_dwordx4 v[124:127], v49, s[8:11], s42 offen offset:3072 sc1
    v_mfma_f32_16x16x32_bf16 v[24:27], v[68:71], v[184:187], v[24:27]
    v_mfma_f32_16x16x32_bf16 v[28:31], v[68:71], v[188:191], v[28:31]
    s_waitcnt vmcnt(12) lgkmcnt(0)
    v_mfma_f32_16x16x32_bf16 v[16:19], v[72:75], v[192:195], v[16:19]
    ds_read_b128 v[160:163], v8 offset:16384
    ds_read_b128 v[164:167], v8 offset:18432
    v_mfma_f32_16x16x32_bf16 v[20:23], v[72:75], v[196:199], v[20:23]
    ds_read_b128 v[168:171], v8 offset:20480
    ds_read_b128 v[172:175], v8 offset:22528
    v_mfma_f32_16x16x32_bf16 v[24:27], v[72:75], v[200:203], v[24:27]
    ds_read_b128 v[176:179], v9 offset:16384
    ds_read_b128 v[180:183], v9 offset:18432
    v_mfma_f32_16x16x32_bf16 v[28:31], v[72:75], v[204:207], v[28:31]
    ds_read_b128 v[184:187], v9 offset:20480
    ds_read_b128 v[188:191], v9 offset:22528
    v_mfma_f32_16x16x32_bf16 v[16:19], v[76:79], v[208:211], v[16:19]
    v_mfma_f32_16x16x32_bf16 v[20:23], v[76:79], v[212:215], v[20:23]
    v_mfma_f32_16x16x32_bf16 v[24:27], v[76:79], v[216:219], v[24:27]
    v_mfma_f32_16x16x32_bf16 v[28:31], v[76:79], v[220:223], v[28:31]
    s_waitcnt vmcnt(10) lgkmcnt(0)
    v_mfma_f32_16x16x32_bf16 v[32:35], v[80:83], v[160:163], v[32:35]
    ds_read_b128 v[192:195], v10 offset:16384
    ds_read_b128 v[196:199], v10 offset:18432
    v_mfma_f32_16x16x32_bf16 v[36:39], v[80:83], v[164:167], v[36:39]
    ds_read_b128 v[200:203], v10 offset:20480
    ds_read_b128 v[204:207], v10 offset:22528
    v_mfma_f32_16x16x32_bf16 v[40:43], v[80:83], v[168:171], v[40:43]
    ds_read_b128 v[208:211], v11 offset:16384
    ds_read_b128 v[212:215], v11 offset:18432
    v_mfma_f32_16x16x32_bf16 v[44:47], v[80:83], v[172:175], v[44:47]
    ds_read_b128 v[216:219], v11 offset:20480
    ds_read_b128 v[220:223], v11 offset:22528
    v_mfma_f32_16x16x32_bf16 v[32:35], v[84:87], v[176:179], v[32:35]
    v_mfma_f32_16x16x32_bf16 v[36:39], v[84:87], v[180:183], v[36:39]
    v_mfma_f32_16x16x32_bf16 v[40:43], v[84:87], v[184:187], v[40:43]
    v_mfma_f32_16x16x32_bf16 v[44:47], v[84:87], v[188:191], v[44:47]
    s_waitcnt vmcnt(8) lgkmcnt(0)
    v_mfma_f32_16x16x32_bf16 v[32:35], v[88:91], v[192:195], v[32:35]
    ds_read_b128 v[160:163], v8 offset:32768
    ds_read_b128 v[164:167], v8 offset:34816
    v_mfma_f32_16x16x32_bf16 v[36:39], v[88:91], v[196:199], v[36:39]
    ds_read_b128 v[168:171], v8 offset:36864
    ds_read_b128 v[172:175], v8 offset:38912
    v_mfma_f32_16x16x32_bf16 v[40:43], v[88:91], v[200:203], v[40:43]
    ds_read_b128 v[176:179], v9 offset:32768
    ds_read_b128 v[180:183], v9 offset:34816
    v_mfma_f32_16x16x32_bf16 v[44:47], v[88:91], v[204:207], v[44:47]
    ds_read_b128 v[184:187], v9 offset:36864
    ds_read_b128 v[188:191], v9 offset:38912
    v_mfma_f32_16x16x32_bf16 v[32:35], v[92:95], v[208:211], v[32:35]
    v_mov_b32 v224, v16
    v_mov_b32 v225, v20
    v_mov_b32 v226, v24
    v_mov_b32 v227, v28
    v_mfma_f32_16x16x32_bf16 v[36:39], v[92:95], v[212:215], v[36:39]
    s_mov_b32 s6, 0
    buffer_store_dwordx4 v[224:227], v50, s[76:79], s6 offen nt
    v_mfma_f32_16x16x32_bf16 v[40:43], v[92:95], v[216:219], v[40:43]
    v_mfma_f32_16x16x32_bf16 v[44:47], v[92:95], v[220:223], v[44:47]
    s_waitcnt vmcnt(7) lgkmcnt(0)
    v_mfma_f32_16x16x32_bf16 v[32:35], v[96:99], v[160:163], v[32:35]
    ds_read_b128 v[192:195], v10 offset:32768
    ds_read_b128 v[196:199], v10 offset:34816
    v_mfma_f32_16x16x32_bf16 v[36:39], v[96:99], v[164:167], v[36:39]
    ds_read_b128 v[200:203], v10 offset:36864
    ds_read_b128 v[204:207], v10 offset:38912
    v_mfma_f32_16x16x32_bf16 v[40:43], v[96:99], v[168:171], v[40:43]
    ds_read_b128 v[208:211], v11 offset:32768
    ds_read_b128 v[212:215], v11 offset:34816
    v_mfma_f32_16x16x32_bf16 v[44:47], v[96:99], v[172:175], v[44:47]
    ds_read_b128 v[216:219], v11 offset:36864
    ds_read_b128 v[220:223], v11 offset:38912
    v_mfma_f32_16x16x32_bf16 v[32:35], v[100:103], v[176:179], v[32:35]
    v_mov_b32 v228, v17
    v_mov_b32 v229, v21
    v_mov_b32 v230, v25
    v_mov_b32 v231, v29
    v_mfma_f32_16x16x32_bf16 v[36:39], v[100:103], v[180:183], v[36:39]
    s_mov_b32 s6, 65536
    buffer_store_dwordx4 v[228:231], v50, s[76:79], s6 offen nt
    v_mfma_f32_16x16x32_bf16 v[40:43], v[100:103], v[184:187], v[40:43]
    v_mfma_f32_16x16x32_bf16 v[44:47], v[100:103], v[188:191], v[44:47]
    s_waitcnt vmcnt(6) lgkmcnt(0)
    v_mfma_f32_16x16x32_bf16 v[32:35], v[104:107], v[192:195], v[32:35]
    ds_read_b128 v[160:163], v4 offset:0
    ds_read_b128 v[164:167], v4 offset:2048
    v_mfma_f32_16x16x32_bf16 v[36:39], v[104:107], v[196:199], v[36:39]
    ds_read_b128 v[168:171], v4 offset:4096
    ds_read_b128 v[172:175], v4 offset:6144
    v_mfma_f32_16x16x32_bf16 v[40:43], v[104:107], v[200:203], v[40:43]
    ds_read_b128 v[176:179], v5 offset:0
    ds_read_b128 v[180:183], v5 offset:2048
    v_mfma_f32_16x16x32_bf16 v[44:47], v[104:107], v[204:207], v[44:47]
    ds_read_b128 v[184:187], v5 offset:4096
    ds_read_b128 v[188:191], v5 offset:6144
    v_mfma_f32_16x16x32_bf16 v[32:35], v[108:111], v[208:211], v[32:35]
    v_mov_b32 v232, v18
    v_mov_b32 v233, v22
    v_mov_b32 v234, v26
    v_mov_b32 v235, v30
    v_mfma_f32_16x16x32_bf16 v[36:39], v[108:111], v[212:215], v[36:39]
    s_mov_b32 s6, 131072
    buffer_store_dwordx4 v[232:235], v50, s[76:79], s6 offen nt
    v_mfma_f32_16x16x32_bf16 v[40:43], v[108:111], v[216:219], v[40:43]
    v_mfma_f32_16x16x32_bf16 v[44:47], v[108:111], v[220:223], v[44:47]
    s_waitcnt vmcnt(5) lgkmcnt(0)
    v_mfma_f32_16x16x32_bf16 v[32:35], v[112:115], v[160:163], v[32:35]
    ds_read_b128 v[192:195], v6 offset:0
    ds_read_b128 v[196:199], v6 offset:2048
    v_mfma_f32_16x16x32_bf16 v[36:39], v[112:115], v[164:167], v[36:39]
    ds_read_b128 v[200:203], v6 offset:4096
    ds_read_b128 v[204:207], v6 offset:6144
    v_mfma_f32_16x16x32_bf16 v[40:43], v[112:115], v[168:171], v[40:43]
    ds_read_b128 v[208:211], v7 offset:0
    ds_read_b128 v[212:215], v7 offset:2048
    v_mfma_f32_16x16x32_bf16 v[44:47], v[112:115], v[172:175], v[44:47]
    ds_read_b128 v[216:219], v7 offset:4096
    ds_read_b128 v[220:223], v7 offset:6144
    v_mfma_f32_16x16x32_bf16 v[32:35], v[116:119], v[176:179], v[32:35]
    v_mov_b32 v236, v19
    v_mov_b32 v237, v23
    v_mov_b32 v238, v27
    v_mov_b32 v239, v31
    v_mfma_f32_16x16x32_bf16 v[36:39], v[116:119], v[180:183], v[36:39]
    s_mov_b32 s6, 196608
    buffer_store_dwordx4 v[236:239], v50, s[76:79], s6 offen nt
    v_mfma_f32_16x16x32_bf16 v[40:43], v[116:119], v[184:187], v[40:43]
    v_mfma_f32_16x16x32_bf16 v[44:47], v[116:119], v[188:191], v[44:47]
    s_waitcnt vmcnt(4) lgkmcnt(0)
    v_mfma_f32_16x16x32_bf16 v[32:35], v[120:123], v[192:195], v[32:35]
    v_mfma_f32_16x16x32_bf16 v[36:39], v[120:123], v[196:199], v[36:39]
    v_mfma_f32_16x16x32_bf16 v[40:43], v[120:123], v[200:203], v[40:43]
    v_mfma_f32_16x16x32_bf16 v[44:47], v[120:123], v[204:207], v[44:47]
    v_mfma_f32_16x16x32_bf16 v[32:35], v[124:127], v[208:211], v[32:35]
    v_mfma_f32_16x16x32_bf16 v[36:39], v[124:127], v[212:215], v[36:39]
    v_mfma_f32_16x16x32_bf16 v[40:43], v[124:127], v[216:219], v[40:43]
    v_mfma_f32_16x16x32_bf16 v[44:47], v[124:127], v[220:223], v[44:47]
    s_nop 7
    s_nop 2
    v_mov_b32 v80, v32
    v_mov_b32 v81, v36
    v_mov_b32 v82, v40
    v_mov_b32 v83, v44
    s_mov_b32 s6, 8192
    buffer_store_dwordx4 v[80:83], v50, s[76:79], s6 offen nt
    v_mov_b32 v84, v33
    v_mov_b32 v85, v37
    v_mov_b32 v86, v41
    v_mov_b32 v87, v45
    s_mov_b32 s6, 73728
    buffer_store_dwordx4 v[84:87], v50, s[76:79], s6 offen nt
    v_mov_b32 v88, v34
    v_mov_b32 v89, v38
    v_mov_b32 v90, v42
    v_mov_b32 v91, v46
    s_mov_b32 s6, 139264
    buffer_store_dwordx4 v[88:91], v50, s[76:79], s6 offen nt
    v_mov_b32 v92, v35
    v_mov_b32 v93, v39
    v_mov_b32 v94, v43
    v_mov_b32 v95, v47
    s_mov_b32 s6, 204800
    buffer_store_dwordx4 v[92:95], v50, s[76:79], s6 offen nt
K_fin:
K_done:
    s_endpgm
L_g0:
    s_mov_b32 s50, 0
L_g0_s:
    ds_read_b32 v1, v6 offset:64
    s_add_u32 s50, s50, 1
    s_waitcnt lgkmcnt(0)
    v_readfirstlane_b32 s7, v1
    s_cmp_gt_u32 s50, 4096
    s_cbranch_scc1 L_g0_r
    s_cmp_lt_u32 s7, 2
    s_cbranch_scc1 L_g0_s
    s_branch L_g0_r
L_cs1:
    s_add_u32 s44, s38, 512
    s_and_b32 s44, s44, 1023
    s_or_b32 s44, s44, s20
    s_add_u32 m0, s39, 65536
    s_nop 0
    buffer_load_dwordx4 v246, s[24:27], s44 offen offset:0 lds
    buffer_load_dwordx4 v247, s[24:27], s44 offen offset:1024 lds
    s_add_u32 m0, s39, 73728
    s_nop 0
    buffer_load_dwordx4 v248, s[28:31], s44 offen offset:0 lds
    buffer_load_dwordx4 v249, s[28:31], s44 offen offset:1024 lds
    s_add_u32 s44, s38, 640
    s_and_b32 s44, s44, 1023
    s_or_b32 s44, s44, s20
    s_add_u32 m0, s39, 81920
    s_nop 0
    buffer_load_dwordx4 v246, s[24:27], s44 offen offset:0 lds
    buffer_load_dwordx4 v247, s[24:27], s44 offen offset:1024 lds
    s_add_u32 m0, s39, 90112
    s_nop 0
    buffer_load_dwordx4 v248, s[28:31], s44 offen offset:0 lds
    buffer_load_dwordx4 v249, s[28:31], s44 offen offset:1024 lds
    s_branch L_cr1
L_cs4:
    v_mov_b32 v3, 6
    s_waitcnt vmcnt(0)
    ds_write_b32 v6, v3 offset:48
    s_branch L_cr0
L_g1:
    s_mov_b32 s50, 0
L_g1_s:
    ds_read_b32 v1, v6 offset:64
    s_add_u32 s50, s50, 1
    s_waitcnt lgkmcnt(0)
    v_readfirstlane_b32 s7, v1
    s_cmp_gt_u32 s50, 4096
    s_cbranch_scc1 L_g1_r
    s_cmp_lt_u32 s7, 2
    s_cbranch_scc1 L_g1_s
    s_branch L_g1_r
L_g2:
    s_mov_b32 s50, 0
L_g2_s:
    ds_read_b32 v1, v6 offset:64
    s_add_u32 s50, s50, 1
    s_waitcnt lgkmcnt(0)
    v_readfirstlane_b32 s7, v1
    s_cmp_gt_u32 s50, 4096
    s_cbranch_scc1 L_g2_r
    s_cmp_lt_u32 s7, 2
    s_cbranch_scc1 L_g2_s
    s_branch L_g2_r
L_g3:
    s_mov_b32 s50, 0
L_g3_s:
    ds_read_b32 v1, v6 offset:64
    s_add_u32 s50, s50, 1
    s_waitcnt lgkmcnt(0)
    v_readfirstlane_b32 s7, v1
    s_cmp_gt_u32 s50, 4096
    s_cbranch_scc1 L_g3_r
    s_cmp_lt_u32 s7, 2
    s_cbranch_scc1 L_g3_s
    s_branch L_g3_r
L_g4:
    s_mov_b32 s50, 0
L_g4_s:
    ds_read_b32 v1, v6 offset:64
    s_add_u32 s50, s50, 1
    s_waitcnt lgkmcnt(0)
    v_readfirstlane_b32 s7, v1
    s_cmp_gt_u32 s50, 4096
    s_cbranch_scc1 L_g4_r
    s_cmp_lt_u32 s7, 2
    s_cbranch_scc1 L_g4_s
    s_branch L_g4_r
L_g5:
    s_mov_b32 s50, 0
L_g5_s:
    ds_read_b32 v1, v6 offset:64
    s_add_u32 s50, s50, 1
    s_waitcnt lgkmcnt(0)
    v_readfirstlane_b32 s7, v1
    s_cmp_gt_u32 s50, 4096
    s_cbranch_scc1 L_g5_r
    s_cmp_lt_u32 s7, 2
    s_cbranch_scc1 L_g5_s
    s_branch L_g5_r
L_g6:
    s_mov_b32 s50, 0
L_g6_s:
    ds_read_b32 v1, v6 offset:64
    s_add_u32 s50, s50, 1
    s_waitcnt lgkmcnt(0)
    v_readfirstlane_b32 s7, v1
    s_cmp_gt_u32 s50, 4096
    s_cbranch_scc1 L_g6_r
    s_cmp_lt_u32 s7, 2
    s_cbranch_scc1 L_g6_s
    s_branch L_g6_r
C_x0:
    v_add_u32 v240, 98304, v240
    v_add_u32 v241, 98304, v241
    ds_read_b128 v[208:211], v240 offset:0
    ds_read_b128 v[212:215], v241 offset:0
    ds_read_b128 v[216:219], v240 offset:2048
    ds_read_b128 v[220:223], v241 offset:2048
    s_branch C_x0_r
C_x1:
    v_add_u32 v240, 0, v240
    v_add_u32 v241, 0, v241
    ds_read_b128 v[208:211], v240 offset:0
    ds_read_b128 v[212:215], v241 offset:0
    ds_read_b128 v[216:219], v240 offset:2048
    ds_read_b128 v[220:223], v241 offset:2048
    s_branch C_x1_r
C_x2:
    v_add_u32 v240, 32768, v240
    v_add_u32 v241, 32768, v241
    ds_read_b128 v[208:211], v240 offset:0
    ds_read_b128 v[212:215], v241 offset:0
    ds_read_b128 v[216:219], v240 offset:2048
    ds_read_b128 v[220:223], v241 offset:2048
    s_branch C_x2_r
C_x3:
    v_add_u32 v240, 65536, v240
    v_add_u32 v241, 65536, v241
    ds_read_b128 v[208:211], v240 offset:0
    ds_read_b128 v[212:215], v241 offset:0
    ds_read_b128 v[216:219], v240 offset:2048
    ds_read_b128 v[220:223], v241 offset:2048
    s_branch C_x3_r
C_x4:
    v_add_u32 v240, 98304, v240
    v_add_u32 v241, 98304, v241
    ds_read_b128 v[208:211], v240 offset:0
    ds_read_b128 v[212:215], v241 offset:0
    ds_read_b128 v[216:219], v240 offset:2048
    ds_read_b128 v[220:223], v241 offset:2048
    s_branch C_x4_r
C_non:
    s_mov_b32 s39, 0
C_non_s:
    buffer_load_dwordx2 v[54:55], off, s[16:19], 0 sc1
    s_add_u32 s39, s39, 1
    s_waitcnt vmcnt(0)
    s_cmp_gt_u32 s39, 4096
    s_cbranch_scc1 C_non_r
    v_readfirstlane_b32 s7, v54
    s_cmp_lg_u32 s7, 0
    s_cbranch_scc0 C_non_s
    s_branch C_non_r
C_x5:
    v_add_u32 v240, 0, v240
    v_add_u32 v241, 0, v241
    ds_read_b128 v[208:211], v240 offset:0
    ds_read_b128 v[212:215], v241 offset:0
    ds_read_b128 v[216:219], v240 offset:2048
    ds_read_b128 v[220:223], v241 offset:2048
    s_branch C_x5_r
C_x6:
    v_add_u32 v240, 32768, v240
    v_add_u32 v241, 32768, v241
    ds_read_b128 v[208:211], v240 offset:0
    ds_read_b128 v[212:215], v241 offset:0
    ds_read_b128 v[216:219], v240 offset:2048
    ds_read_b128 v[220:223], v241 offset:2048
    s_branch C_x6_r
C_x7:
    v_add_u32 v240, 65536, v240
    v_add_u32 v241, 65536, v241
    ds_read_b128 v[208:211], v240 offset:0
    ds_read_b128 v[212:215], v241 offset:0
    ds_read_b128 v[216:219], v240 offset:2048
    ds_read_b128 v[220:223], v241 offset:2048
    s_branch C_x7_r
C_x8:
    v_add_u32 v240, 98304, v240
    v_add_u32 v241, 98304, v241
    ds_read_b128 v[208:211], v240 offset:0
    ds_read_b128 v[212:215], v241 offset:0
    ds_read_b128 v[216:219], v240 offset:2048
    ds_read_b128 v[220:223], v241 offset:2048
    s_branch C_x8_r
C_x9:
    v_add_u32 v240, 0, v240
    v_add_u32 v241, 0, v241
    ds_read_b128 v[208:211], v240 offset:0
    ds_read_b128 v[212:215], v241 offset:0
    ds_read_b128 v[216:219], v240 offset:2048
    ds_read_b128 v[220:223], v241 offset:2048
    s_branch C_x9_r
C_x10:
    v_add_u32 v240, 32768, v240
    v_add_u32 v241, 32768, v241
    ds_read_b128 v[208:211], v240 offset:0
    ds_read_b128 v[212:215], v241 offset:0
    ds_read_b128 v[216:219], v240 offset:2048
    ds_read_b128 v[220:223], v241 offset:2048
    s_branch C_x10_r
C_x11:
    v_add_u32 v240, 65536, v240
    v_add_u32 v241, 65536, v241
    ds_read_b128 v[208:211], v240 offset:0
    ds_read_b128 v[212:215], v241 offset:0
    ds_read_b128 v[216:219], v240 offset:2048
    ds_read_b128 v[220:223], v241 offset:2048
    s_branch C_x11_r
C_x12:
    v_add_u32 v240, 98304, v240
    v_add_u32 v241, 98304, v241
    ds_read_b128 v[208:211], v240 offset:0
    ds_read_b128 v[212:215], v241 offset:0
    ds_read_b128 v[216:219], v240 offset:2048
    ds_read_b128 v[220:223], v241 offset:2048
    s_branch C_x12_r
C_x13:
    v_add_u32 v240, 0, v240
    v_add_u32 v241, 0, v241
    ds_read_b128 v[208:211], v240 offset:0
    ds_read_b128 v[212:215], v241 offset:0
    ds_read_b128 v[216:219], v240 offset:2048
    ds_read_b128 v[220:223], v241 offset:2048
    s_branch C_x13_r
C_kvp:
    s_mov_b32 s39, 0
C_kvp_s:
    buffer_load_dwordx2 v[244:245], v246, s[72:75], s21 offen sc1
    s_add_u32 s39, s39, 1
    s_waitcnt vmcnt(0)
    s_cmp_gt_u32 s39, 4096
    s_cbranch_scc1 C_kvp_r
    v_cmp_eq_u32 vcc, v244, v54
    v_cmp_eq_u32 s[54:55], v245, v55
    s_mov_b32 m0, s23
    s_and_b64 s[54:55], s[54:55], vcc
    s_cmp_eq_u64 s[54:55], -1
    s_cbranch_scc0 C_kvp_s
    s_branch C_kvp_r
C_x14:
    v_add_u32 v240, 32768, v240
    v_add_u32 v241, 32768, v241
    ds_read_b128 v[208:211], v240 offset:0
    ds_read_b128 v[212:215], v241 offset:0
    ds_read_b128 v[216:219], v240 offset:2048
    ds_read_b128 v[220:223], v241 offset:2048
    s_branch C_x14_r
C_x15:
    v_add_u32 v240, 65536, v240
    v_add_u32 v241, 65536, v241
    ds_read_b128 v[208:211], v240 offset:0
    ds_read_b128 v[212:215], v241 offset:0
    ds_read_b128 v[216:219], v240 offset:2048
    ds_read_b128 v[220:223], v241 offset:2048
    s_branch C_x15_r
C2_h1:
    s_mov_b32 s39, 0
C2_h1_s:
    buffer_load_dwordx2 v[248:249], v51, s[72:75], 0 offen sc1
    s_add_u32 s39, s39, 1
    s_waitcnt vmcnt(0)
    s_cmp_gt_u32 s39, 4096
    s_cbranch_scc1 C2_h1_r
    v_cmp_eq_u32 vcc, v248, v54
    v_cmp_eq_u32 s[54:55], v249, v55
    s_nop 0
    s_and_b64 s[54:55], s[54:55], vcc
    s_or_b32 s54, s54, 15
    s_ff0_i32_b64 s7, s[54:55]
    s_lshr_b32 s7, s7, 2
    s_max_u32 s37, s37, s7
    s_cmp_gt_u32 s37, 1
    s_cbranch_scc0 C2_h1_s
    s_branch C2_h1_r
C_crdy:
    s_mov_b32 s39, 0
C_crdy_s:
    ds_read_b128 v[12:15], v62 offset:48
    s_add_u32 s39, s39, 1
    s_waitcnt lgkmcnt(0)
    v_min3_u32 v12, v12, v13, v14
    v_min_u32 v12, v12, v15
    v_cmp_gt_u32 vcc, 6, v12
    s_cmp_gt_u32 s39, 65536
    s_cbranch_scc1 C_crdy_r
    s_cbranch_vccnz C_crdy_s
    s_branch C_crdy_r
C2_h2:
    s_mov_b32 s39, 0
C2_h2_s:
    buffer_load_dwordx2 v[248:249], v51, s[72:75], 0 offen sc1
    s_add_u32 s39, s39, 1
    s_waitcnt vmcnt(0)
    s_cmp_gt_u32 s39, 4096
    s_cbranch_scc1 C2_h2_r
    v_cmp_eq_u32 vcc, v248, v54
    v_cmp_eq_u32 s[54:55], v249, v55
    s_nop 0
    s_and_b64 s[54:55], s[54:55], vcc
    s_or_b32 s54, s54, 15
    s_ff0_i32_b64 s7, s[54:55]
    s_lshr_b32 s7, s7, 2
    s_max_u32 s37, s37, s7
    s_cmp_gt_u32 s37, 2
    s_cbranch_scc0 C2_h2_s
    s_branch C2_h2_r
C2_h3:
    s_mov_b32 s39, 0
C2_h3_s:
    buffer_load_dwordx2 v[248:249], v51, s[72:75], 0 offen sc1
    s_add_u32 s39, s39, 1
    s_waitcnt vmcnt(0)
    s_cmp_gt_u32 s39, 4096
    s_cbranch_scc1 C2_h3_r
    v_cmp_eq_u32 vcc, v248, v54
    v_cmp_eq_u32 s[54:55], v249, v55
    s_nop 0
    s_and_b64 s[54:55], s[54:55], vcc
    s_or_b32 s54, s54, 15
    s_ff0_i32_b64 s7, s[54:55]
    s_lshr_b32 s7, s7, 2
    s_max_u32 s37, s37, s7
    s_cmp_gt_u32 s37, 3
    s_cbranch_scc0 C2_h3_s
    s_branch C2_h3_r
C2_p2:
    s_mov_b32 s39, 0
C2_p2_s:
    ds_read_b128 v[56:59], v62 offset:96
    s_add_u32 s39, s39, 1
    s_waitcnt lgkmcnt(0)
    v_min3_u32 v56, v56, v57, v58
    v_min_u32 v56, v56, v59
    v_cmp_gt_u32 vcc, 1, v56
    s_cmp_gt_u32 s39, 65536
    s_cbranch_scc1 C2_p2_r
    s_cbranch_vccnz C2_p2_s
    s_branch C2_p2_r
C2_h4:
    s_mov_b32 s39, 0
C2_h4_s:
    buffer_load_dwordx2 v[248:249], v51, s[72:75], 0 offen sc1
    s_add_u32 s39, s39, 1
    s_waitcnt vmcnt(0)
    s_cmp_gt_u32 s39, 4096
    s_cbranch_scc1 C2_h4_r
    v_cmp_eq_u32 vcc, v248, v54
    v_cmp_eq_u32 s[54:55], v249, v55
    s_nop 0
    s_and_b64 s[54:55], s[54:55], vcc
    s_or_b32 s54, s54, 15
    s_ff0_i32_b64 s7, s[54:55]
    s_lshr_b32 s7, s7, 2
    s_max_u32 s37, s37, s7
    s_cmp_gt_u32 s37, 4
    s_cbranch_scc0 C2_h4_s
    s_branch C2_h4_r
C2_p3:
    s_mov_b32 s39, 0
C2_p3_s:
    ds_read_b128 v[56:59], v62 offset:96
    s_add_u32 s39, s39, 1
    s_waitcnt lgkmcnt(0)
    v_min3_u32 v56, v56, v57, v58
    v_min_u32 v56, v56, v59
    v_cmp_gt_u32 vcc, 2, v56
    s_cmp_gt_u32 s39, 65536
    s_cbranch_scc1 C2_p3_r
    s_cbranch_vccnz C2_p3_s
    s_branch C2_p3_r
C2_h5:
    s_mov_b32 s39, 0
C2_h5_s:
    buffer_load_dwordx2 v[248:249], v51, s[72:75], 0 offen sc1
    s_add_u32 s39, s39, 1
    s_waitcnt vmcnt(0)
    s_cmp_gt_u32 s39, 4096
    s_cbranch_scc1 C2_h5_r
    v_cmp_eq_u32 vcc, v248, v54
    v_cmp_eq_u32 s[54:55], v249, v55
    s_nop 0
    s_and_b64 s[54:55], s[54:55], vcc
    s_or_b32 s54, s54, 15
    s_ff0_i32_b64 s7, s[54:55]
    s_lshr_b32 s7, s7, 2
    s_max_u32 s37, s37, s7
    s_cmp_gt_u32 s37, 5
    s_cbranch_scc0 C2_h5_s
    s_branch C2_h5_r
C2_p4:
    s_mov_b32 s39, 0
C2_p4_s:
    ds_read_b128 v[56:59], v62 offset:96
    s_add_u32 s39, s39, 1
    s_waitcnt lgkmcnt(0)
    v_min3_u32 v56, v56, v57, v58
    v_min_u32 v56, v56, v59
    v_cmp_gt_u32 vcc, 3, v56
    s_cmp_gt_u32 s39, 65536
    s_cbranch_scc1 C2_p4_r
    s_cbranch_vccnz C2_p4_s
    s_branch C2_p4_r
C2_h6:
    s_mov_b32 s39, 0
C2_h6_s:
    buffer_load_dwordx2 v[248:249], v51, s[72:75], 0 offen sc1
    s_add_u32 s39, s39, 1
    s_waitcnt vmcnt(0)
    s_cmp_gt_u32 s39, 4096
    s_cbranch_scc1 C2_h6_r
    v_cmp_eq_u32 vcc, v248, v54
    v_cmp_eq_u32 s[54:55], v249, v55
    s_nop 0
    s_and_b64 s[54:55], s[54:55], vcc
    s_or_b32 s54, s54, 15
    s_ff0_i32_b64 s7, s[54:55]
    s_lshr_b32 s7, s7, 2
    s_max_u32 s37, s37, s7
    s_cmp_gt_u32 s37, 6
    s_cbranch_scc0 C2_h6_s
    s_branch C2_h6_r
C2_p5:
    s_mov_b32 s39, 0
C2_p5_s:
    ds_read_b128 v[56:59], v62 offset:96
    s_add_u32 s39, s39, 1
    s_waitcnt lgkmcnt(0)
    v_min3_u32 v56, v56, v57, v58
    v_min_u32 v56, v56, v59
    v_cmp_gt_u32 vcc, 4, v56
    s_cmp_gt_u32 s39, 65536
    s_cbranch_scc1 C2_p5_r
    s_cbranch_vccnz C2_p5_s
    s_branch C2_p5_r
C2_h7:
    s_mov_b32 s39, 0
C2_h7_s:
    buffer_load_dwordx2 v[248:249], v51, s[72:75], 0 offen sc1
    s_add_u32 s39, s39, 1
    s_waitcnt vmcnt(0)
    s_cmp_gt_u32 s39, 4096
    s_cbranch_scc1 C2_h7_r
    v_cmp_eq_u32 vcc, v248, v54
    v_cmp_eq_u32 s[54:55], v249, v55
    s_nop 0
    s_and_b64 s[54:55], s[54:55], vcc
    s_or_b32 s54, s54, 15
    s_ff0_i32_b64 s7, s[54:55]
    s_lshr_b32 s7, s7, 2
    s_max_u32 s37, s37, s7
    s_cmp_gt_u32 s37, 7
    s_cbranch_scc0 C2_h7_s
    s_branch C2_h7_r
C2_p6:
    s_mov_b32 s39, 0
C2_p6_s:
    ds_read_b128 v[56:59], v62 offset:96
    s_add_u32 s39, s39, 1
    s_waitcnt lgkmcnt(0)
    v_min3_u32 v56, v56, v57, v58
    v_min_u32 v56, v56, v59
    v_cmp_gt_u32 vcc, 5, v56
    s_cmp_gt_u32 s39, 65536
    s_cbranch_scc1 C2_p6_r
    s_cbranch_vccnz C2_p6_s
    s_branch C2_p6_r
C2_h8:
    s_mov_b32 s39, 0
C2_h8_s:
    buffer_load_dwordx2 v[248:249], v51, s[72:75], 0 offen sc1
    s_add_u32 s39, s39, 1
    s_waitcnt vmcnt(0)
    s_cmp_gt_u32 s39, 4096
    s_cbranch_scc1 C2_h8_r
    v_cmp_eq_u32 vcc, v248, v54
    v_cmp_eq_u32 s[54:55], v249, v55
    s_nop 0
    s_and_b64 s[54:55], s[54:55], vcc
    s_or_b32 s54, s54, 15
    s_ff0_i32_b64 s7, s[54:55]
    s_lshr_b32 s7, s7, 2
    s_max_u32 s37, s37, s7
    s_cmp_gt_u32 s37, 8
    s_cbranch_scc0 C2_h8_s
    s_branch C2_h8_r
C2_p7:
    s_mov_b32 s39, 0
C2_p7_s:
    ds_read_b128 v[56:59], v62 offset:96
    s_add_u32 s39, s39, 1
    s_waitcnt lgkmcnt(0)
    v_min3_u32 v56, v56, v57, v58
    v_min_u32 v56, v56, v59
    v_cmp_gt_u32 vcc, 6, v56
    s_cmp_gt_u32 s39, 65536
    s_cbranch_scc1 C2_p7_r
    s_cbranch_vccnz C2_p7_s
    s_branch C2_p7_r
C2_h9:
    s_mov_b32 s39, 0
C2_h9_s:
    buffer_load_dwordx2 v[248:249], v51, s[72:75], 0 offen sc1
    s_add_u32 s39, s39, 1
    s_waitcnt vmcnt(0)
    s_cmp_gt_u32 s39, 4096
    s_cbranch_scc1 C2_h9_r
    v_cmp_eq_u32 vcc, v248, v54
    v_cmp_eq_u32 s[54:55], v249, v55
    s_nop 0
    s_and_b64 s[54:55], s[54:55], vcc
    s_or_b32 s54, s54, 15
    s_ff0_i32_b64 s7, s[54:55]
    s_lshr_b32 s7, s7, 2
    s_max_u32 s37, s37, s7
    s_cmp_gt_u32 s37, 9
    s_cbranch_scc0 C2_h9_s
    s_branch C2_h9_r
C2_p8:
    s_mov_b32 s39, 0
C2_p8_s:
    ds_read_b128 v[56:59], v62 offset:96
    s_add_u32 s39, s39, 1
    s_waitcnt lgkmcnt(0)
    v_min3_u32 v56, v56, v57, v58
    v_min_u32 v56, v56, v59
    v_cmp_gt_u32 vcc, 7, v56
    s_cmp_gt_u32 s39, 65536
    s_cbranch_scc1 C2_p8_r
    s_cbranch_vccnz C2_p8_s
    s_branch C2_p8_r
C2_h10:
    s_mov_b32 s39, 0
C2_h10_s:
    buffer_load_dwordx2 v[248:249], v51, s[72:75], 0 offen sc1
    s_add_u32 s39, s39, 1
    s_waitcnt vmcnt(0)
    s_cmp_gt_u32 s39, 4096
    s_cbranch_scc1 C2_h10_r
    v_cmp_eq_u32 vcc, v248, v54
    v_cmp_eq_u32 s[54:55], v249, v55
    s_nop 0
    s_and_b64 s[54:55], s[54:55], vcc
    s_or_b32 s54, s54, 15
    s_ff0_i32_b64 s7, s[54:55]
    s_lshr_b32 s7, s7, 2
    s_max_u32 s37, s37, s7
    s_cmp_gt_u32 s37, 10
    s_cbranch_scc0 C2_h10_s
    s_branch C2_h10_r
C2_h11:
    s_mov_b32 s39, 0
C2_h11_s:
    buffer_load_dwordx2 v[248:249], v51, s[72:75], 0 offen sc1
    s_add_u32 s39, s39, 1
    s_waitcnt vmcnt(0)
    s_cmp_gt_u32 s39, 4096
    s_cbranch_scc1 C2_h11_r
    v_cmp_eq_u32 vcc, v248, v54
    v_cmp_eq_u32 s[54:55], v249, v55
    s_nop 0
    s_and_b64 s[54:55], s[54:55], vcc
    s_or_b32 s54, s54, 15
    s_ff0_i32_b64 s7, s[54:55]
    s_lshr_b32 s7, s7, 2
    s_max_u32 s37, s37, s7
    s_cmp_gt_u32 s37, 11
    s_cbranch_scc0 C2_h11_s
    s_branch C2_h11_r
C2_q10:
    s_mov_b32 s39, 0
C2_q10_s:
    ds_read_b128 v[12:15], v62 offset:48
    s_add_u32 s39, s39, 1
    s_waitcnt lgkmcnt(0)
    v_min3_u32 v12, v12, v13, v14
    v_min_u32 v12, v12, v15
    v_cmp_gt_u32 vcc, 12, v12
    s_cmp_gt_u32 s39, 65536
    s_cbranch_scc1 C2_q10_r
    s_cbranch_vccnz C2_q10_s
    s_branch C2_q10_r
C2_h12:
    s_mov_b32 s39, 0
C2_h12_s:
    buffer_load_dwordx2 v[248:249], v51, s[72:75], 0 offen sc1
    s_add_u32 s39, s39, 1
    s_waitcnt vmcnt(0)
    s_cmp_gt_u32 s39, 4096
    s_cbranch_scc1 C2_h12_r
    v_cmp_eq_u32 vcc, v248, v54
    v_cmp_eq_u32 s[54:55], v249, v55
    s_nop 0
    s_and_b64 s[54:55], s[54:55], vcc
    s_or_b32 s54, s54, 15
    s_ff0_i32_b64 s7, s[54:55]
    s_lshr_b32 s7, s7, 2
    s_max_u32 s37, s37, s7
    s_cmp_gt_u32 s37, 12
    s_cbranch_scc0 C2_h12_s
    s_branch C2_h12_r
C2_q11:
    s_mov_b32 s39, 0
C2_q11_s:
    ds_read_b128 v[12:15], v62 offset:48
    s_add_u32 s39, s39, 1
    s_waitcnt lgkmcnt(0)
    v_min3_u32 v12, v12, v13, v14
    v_min_u32 v12, v12, v15
    v_cmp_gt_u32 vcc, 13, v12
    s_cmp_gt_u32 s39, 65536
    s_cbranch_scc1 C2_q11_r
    s_cbranch_vccnz C2_q11_s
    s_branch C2_q11_r
C2_h13:
    s_mov_b32 s39, 0
C2_h13_s:
    buffer_load_dwordx2 v[248:249], v51, s[72:75], 0 offen sc1
    s_add_u32 s39, s39, 1
    s_waitcnt vmcnt(0)
    s_cmp_gt_u32 s39, 4096
    s_cbranch_scc1 C2_h13_r
    v_cmp_eq_u32 vcc, v248, v54
    v_cmp_eq_u32 s[54:55], v249, v55
    s_nop 0
    s_and_b64 s[54:55], s[54:55], vcc
    s_or_b32 s54, s54, 15
    s_ff0_i32_b64 s7, s[54:55]
    s_lshr_b32 s7, s7, 2
    s_max_u32 s37, s37, s7
    s_cmp_gt_u32 s37, 13
    s_cbranch_scc0 C2_h13_s
    s_branch C2_h13_r
C2_h14:
    s_mov_b32 s39, 0
C2_h14_s:
    buffer_load_dwordx2 v[248:249], v51, s[72:75], 0 offen sc1
    s_add_u32 s39, s39, 1
    s_waitcnt vmcnt(0)
    s_cmp_gt_u32 s39, 4096
    s_cbranch_scc1 C2_h14_r
    v_cmp_eq_u32 vcc, v248, v54
    v_cmp_eq_u32 s[54:55], v249, v55
    s_nop 0
    s_and_b64 s[54:55], s[54:55], vcc
    s_or_b32 s54, s54, 15
    s_ff0_i32_b64 s7, s[54:55]
    s_lshr_b32 s7, s7, 2
    s_max_u32 s37, s37, s7
    s_cmp_gt_u32 s37, 14
    s_cbranch_scc0 C2_h14_s
    s_branch C2_h14_r
C2_q12:
    s_mov_b32 s39, 0
C2_q12_s:
    ds_read_b128 v[12:15], v62 offset:48
    s_add_u32 s39, s39, 1
    s_waitcnt lgkmcnt(0)
    v_min3_u32 v12, v12, v13, v14
    v_min_u32 v12, v12, v15
    v_cmp_gt_u32 vcc, 14, v12
    s_cmp_gt_u32 s39, 65536
    s_cbranch_scc1 C2_q12_r
    s_cbranch_vccnz C2_q12_s
    s_branch C2_q12_r
C2_h15:
    s_mov_b32 s39, 0
C2_h15_s:
    buffer_load_dwordx2 v[248:249], v51, s[72:75], 0 offen sc1
    s_add_u32 s39, s39, 1
    s_waitcnt vmcnt(0)
    s_cmp_gt_u32 s39, 4096
    s_cbranch_scc1 C2_h15_r
    v_cmp_eq_u32 vcc, v248, v54
    v_cmp_eq_u32 s[54:55], v249, v55
    s_nop 0
    s_and_b64 s[54:55], s[54:55], vcc
    s_or_b32 s54, s54, 15
    s_ff0_i32_b64 s7, s[54:55]
    s_lshr_b32 s7, s7, 2
    s_max_u32 s37, s37, s7
    s_cmp_gt_u32 s37, 15
    s_cbranch_scc0 C2_h15_s
    s_branch C2_h15_r
C2_q13:
    s_mov_b32 s39, 0
C2_q13_s:
    ds_read_b128 v[12:15], v62 offset:48
    s_add_u32 s39, s39, 1
    s_waitcnt lgkmcnt(0)
    v_min3_u32 v12, v12, v13, v14
    v_min_u32 v12, v12, v15
    v_cmp_gt_u32 vcc, 16, v12
    s_cmp_gt_u32 s39, 65536
    s_cbranch_scc1 C2_q13_r
    s_cbranch_vccnz C2_q13_s
    s_branch C2_q13_r
.section .rodata,"a"
.p2align 6
.amdhsa_kernel concat_heads__ssm_conv_h3__ssm_conv_s5__prompt_kernel
  .amdhsa_next_free_vgpr 252
  .amdhsa_next_free_sgpr 102
  .amdhsa_accum_offset 252
  .amdhsa_group_segment_fixed_size 0
  .amdhsa_kernarg_size 144
  .amdhsa_user_sgpr_count 2
  .amdhsa_user_sgpr_kernarg_segment_ptr 1
  .amdhsa_system_sgpr_workgroup_id_x 1
.end_amdhsa_kernel
```

```asm
; @launch grid=(256,1,1) block=(512,1,1) lds=163840
.amdgcn_target "amdgcn-amd-amdhsa--gfx950"
.text
.p2align 8
.globl concat_heads__ssm_conv_h3__ssm_conv_s5__prompt_kernel
.type concat_heads__ssm_conv_h3__ssm_conv_s5__prompt_kernel,@function
concat_heads__ssm_conv_h3__ssm_conv_s5__prompt_kernel:
    s_cmp_ge_u32 s2, 256
    s_cbranch_scc1 K_done
    s_load_dwordx16 s[32:47], s[0:1], 0
    s_load_dwordx16 s[48:63], s[0:1], 64
    s_load_dwordx4 s[64:67], s[0:1], 128
    s_cmp_ge_u32 s2, 64
    s_cbranch_scc1 K_cw
    s_getpc_b64 s[8:9]
    K_pc:
    v_lshlrev_b32 v4, 7, v0
    v_min_u32 v4, K_end - K_pc - 68, v4
    v_mov_b32 v5, s9
    v_add_co_u32 v4, vcc, s8, v4
    v_addc_co_u32 v5, vcc, 0, v5, vcc
    global_load_dword v251, v[4:5], off
    global_load_dword v251, v[4:5], off offset:64
    K_cw:
    v_lshrrev_b32 v1, 6, v0
    v_and_b32 v2, 63, v0
    s_and_b32 s6, s2, 3
    v_readfirstlane_b32 s5, v1
    s_lshl_b32 s6, s6, 2
    s_lshr_b32 s7, s2, 3
    s_and_b32 s3, s7, 3
    s_add_u32 s3, s3, s6
    s_and_b32 s6, s2, 4
    s_lshl_b32 s6, s6, 1
    s_lshr_b32 s4, s7, 2
    s_add_u32 s4, s4, s6
    s_cmp_ge_u32 s5, 4
    s_cbranch_scc1 K_other
    v_and_b32 v12, 15, v2
    v_lshrrev_b32 v13, 4, v2
    s_lshr_b32 s7, s2, 3
    s_and_b32 s76, s7, 15
    s_lshr_b32 s7, s7, 4
    s_and_b32 s77, s2, 7
    s_lshl_b32 s77, s77, 1
    s_add_u32 s77, s77, s7
    s_lshl_b32 s7, s76, 2
    s_add_u32 s7, s7, s5
    s_lshl_b32 s7, s7, 16
    s_lshl_b32 s6, s77, 7
    s_add_u32 s7, s7, s6
    v_lshlrev_b32 v10, 14, v13
    v_lshl_add_u32 v10, v12, 3, v10
    v_add_u32 v10, s7, v10
    v_subrev_u32 v11, 0x1800, v10
    v_bfrev_b32 v9, 1
    v_cmp_gt_i32 vcc, 0, v11
    s_lshl_b32 s7, s77, 9
    v_lshlrev_b32 v15, 5, v12
    v_cndmask_b32 v11, v11, v9, vcc
    v_add_u32 v9, s7, v15
    s_mov_b32 s72, 4096
    s_mov_b32 s73, 8192
    s_mov_b32 s74, 12288
    s_lshl_b32 s6, s4, 2
    s_add_u32 s6, s6, s5
    s_lshl_b32 s6, s6, 4
    v_and_b32 v14, 3, v12
    v_and_b32 v1, 1, v13
    v_lshl_add_u32 v14, v1, 3, v14
    v_lshrrev_b32 v1, 1, v13
    v_lshl_add_u32 v14, v1, 2, v14
    v_add_u32 v14, s6, v14
    v_lshlrev_b32 v44, 1, v14
    s_lshl_b32 s6, s4, 7
    v_lshlrev_b32 v1, 3, v12
    v_add_u32 v1, s6, v1
    s_movk_i32 s22, 2048
    s_mov_b32 s23, 0x00020000
    s_mov_b64 s[26:27], s[22:23]
    s_mov_b64 s[30:31], s[22:23]
    s_mov_b32 s10, 4194304
    s_mov_b32 s11, s23
    s_mov_b64 s[14:15], s[10:11]
    s_movk_i32 s70, 8192
    s_mov_b32 s71, s23
    s_waitcnt lgkmcnt(0)
    s_mov_b64 s[20:21], s[58:59]
    s_mov_b64 s[24:25], s[46:47]
    s_mov_b64 s[28:29], s[48:49]
    buffer_load_ushort v45, v44, s[20:23], 0 offen
    buffer_load_ushort v46, v44, s[24:27], 0 offen
    buffer_load_ushort v47, v44, s[28:31], 0 offen
    s_mov_b64 s[8:9], s[34:35]
    buffer_load_dwordx2 v[146:147], v10, s[8:11], 0 offen offset:0 nt
    buffer_load_dwordx2 v[148:149], v10, s[8:11], 0 offen offset:2048 nt
    buffer_load_dwordx2 v[150:151], v10, s[8:11], s72 offen offset:0 nt
    buffer_load_dwordx2 v[152:153], v10, s[8:11], s72 offen offset:2048 nt
    buffer_load_dwordx2 v[154:155], v10, s[8:11], s73 offen offset:0 nt
    buffer_load_dwordx2 v[156:157], v10, s[8:11], s73 offen offset:2048 nt
    buffer_load_dwordx2 v[158:159], v10, s[8:11], s74 offen offset:0 nt
    buffer_load_dwordx2 v[160:161], v10, s[8:11], s74 offen offset:2048 nt
    buffer_load_dwordx2 v[140:141], v11, s[8:11], 0 offen offset:0 nt
    buffer_load_dwordx2 v[142:143], v11, s[8:11], 0 offen offset:2048 nt
    buffer_load_dwordx2 v[144:145], v11, s[8:11], s72 offen offset:0 nt
    s_mov_b64 s[68:69], s[38:39]
    buffer_load_dwordx4 v[128:131], v9, s[68:71], 0 offen
    buffer_load_dwordx4 v[132:135], v9, s[68:71], 0 offen offset:16
    s_mov_b64 s[12:13], s[36:37]
    buffer_load_dwordx2 v[162:163], v10, s[12:15], 0 offen offset:0 nt
    buffer_load_dwordx2 v[164:165], v10, s[12:15], 0 offen offset:2048 nt
    buffer_load_dwordx2 v[166:167], v10, s[12:15], s72 offen offset:0 nt
    buffer_load_dwordx2 v[168:169], v10, s[12:15], s72 offen offset:2048 nt
    buffer_load_dwordx2 v[170:171], v10, s[12:15], s73 offen offset:0 nt
    buffer_load_dwordx2 v[172:173], v10, s[12:15], s73 offen offset:2048 nt
    buffer_load_dwordx2 v[174:175], v10, s[12:15], s74 offen offset:0 nt
    buffer_load_dwordx2 v[176:177], v10, s[12:15], s74 offen offset:2048 nt
    s_barrier
    s_mov_b32 s80, s60
    s_mov_b32 s81, s61
    s_mov_b32 s82, 2048
    s_mov_b32 s83, 0x00020000
    buffer_load_dwordx2 v[242:243], v1, s[80:83], 0 offen
    s_lshl_b32 s7, s5, 2
    v_add_u32 v15, s7, v13
    v_sub_u32 v15, 15, v15
    v_xor_b32 v15, v15, v12
    v_lshlrev_b32 v15, 4, v15
    v_lshl_add_u32 v15, v12, 10, v15
    v_add_u32 v15, 147456, v15
    v_lshrrev_b32 v3, 1, v12
    v_xor_b32 v3, v3, v13
    v_lshlrev_b32 v3, 4, v3
    v_lshl_add_u32 v4, v12, 7, v3
    v_xor_b32 v6, 64, v4
    v_add_u32 v5, 0x10000, v4
    v_add_u32 v7, 0x10000, v6
    s_lshl_b32 s6, s5, 12
    s_add_u32 s6, s6, 16384
    v_add_u32 v8, s6, v4
    v_add_u32 v9, s6, v5
    v_add_u32 v10, s6, v6
    v_add_u32 v11, s6, v7
    s_mov_b32 s16, s64
    s_mov_b32 s17, s65
    s_mov_b32 s18, 256
    s_mov_b32 s19, 0x00020000
    s_or_b32 s6, s2, s5
    s_cmp_eq_u32 s6, 0
    s_cbranch_scc0 C_nonce_w
    s_memrealtime s[6:7]
    v_mov_b32 v1, 0
    s_waitcnt lgkmcnt(0)
    s_or_b32 s6, s6, 1
    v_mov_b32 v48, s6
    v_mov_b32 v49, s7
    s_mov_b64 exec, 1
    buffer_store_dwordx2 v[48:49], v1, s[16:19], 0 offen sc1
    s_mov_b64 exec, -1
C_nonce_w:
    s_add_u32 s8, s66, 8388608
    s_addc_u32 s9, s67, 0
    s_mov_b32 s10, 8388608
    s_mov_b32 s11, 0x00020000
    s_add_u32 s12, s66, 16777216
    s_addc_u32 s13, s67, 0
    s_mov_b32 s14, 262144
    s_mov_b32 s15, 0x00020000
    s_mov_b32 s68, s66
    s_mov_b32 s69, s67
    s_mov_b32 s70, 4194304
    s_mov_b32 s71, 0x00020000
    s_add_u32 s72, s66, 17825792
    s_addc_u32 s73, s67, 0
    s_mov_b32 s74, 393216
    s_mov_b32 s75, 0x00020000
    s_mov_b32 s76, s62
    s_mov_b32 s77, s63
    s_mov_b32 s78, 16777216
    s_mov_b32 s79, 0x00020000
    s_mov_b32 s24, s54
    s_mov_b32 s25, s55
    s_mov_b32 s26, 2097152
    s_mov_b32 s27, 0x00020000
    s_mov_b32 s80, s56
    s_mov_b32 s81, s57
    s_mov_b32 s82, 2097152
    s_mov_b32 s83, 0x00020000
    s_and_b32 s34, s2, 3
    s_lshl_b32 s34, s34, 2
    s_and_b32 s35, s2, 4
    s_lshl_b32 s35, s35, 1
    s_add_u32 s34, s34, s35
    s_add_u32 s35, s3, s4
    s_and_b32 s35, s35, 1
    s_lshl_b32 s35, s35, 1
    s_add_u32 s34, s34, s35
    s_and_b32 s34, s34, 15
    s_sub_u32 s34, s4, s34
    s_and_b32 s34, s34, 15
    s_lshl_b32 s6, s5, 12
    v_add_u32 v240, s6, v4
    v_xor_b32 v241, 64, v240
    v_mov_b32 v62, 147328
    s_lshr_b32 s7, s2, 3
    s_and_b32 s32, s7, 15
    s_lshr_b32 s7, s7, 4
    s_and_b32 s33, s2, 7
    s_lshl_b32 s33, s33, 1
    s_add_u32 s33, s33, s7
    s_mov_b32 s36, 16384
    s_mov_b32 s37, 32768
    s_mov_b32 s38, 49152
    s_lshl_b32 s6, s5, 2
    v_xor_b32 v1, s6, v12
    v_lshlrev_b32 v1, 4, v1
    v_lshl_add_u32 v1, v13, 8, v1
    s_lshl_b32 s6, s5, 12
    s_add_u32 s6, s6, 147456
    v_add_u32 v244, s6, v1
    v_xor_b32 v245, 16, v244
    v_xor_b32 v246, 32, v244
    v_xor_b32 v247, 48, v244
    s_lshl_b32 s6, s33, 2
    s_add_u32 s6, s6, s5
    s_lshl_b32 s6, s6, 16
    s_lshl_b32 s7, s32, 8
    s_sub_u32 s7, 3840, s7
    s_add_u32 s6, s6, s7
    v_lshlrev_b32 v1, 12, v13
    v_lshl_add_u32 v1, v12, 4, v1
    v_add_u32 v248, s6, v1
    s_lshl_b32 s6, s33, 2
    s_add_u32 s7, s6, s5
    s_lshl_b32 s7, s7, 4
    s_add_u32 s7, s7, s32
    s_lshl_b32 s20, s7, 3
    s_lshr_b32 s7, s32, 2
    s_add_u32 s7, s7, s6
    s_lshl_b32 s21, s7, 7
    s_lshl_b32 s7, s33, 4
    s_add_u32 s7, s7, s32
    s_lshl_b32 s7, s7, 2
    s_add_u32 s7, s7, s5
    s_lshl_b32 s22, s7, 12
    s_lshl_b32 s23, s5, 14
    s_add_u32 s23, s23, 106624
    s_lshl_b32 s6, s3, 14
    v_lshlrev_b32 v1, 4, v14
    v_add_u32 v60, s6, v1
    v_lshrrev_b32 v1, 2, v12
    v_lshlrev_b32 v1, 14, v1
    v_sub_u32 v1, v60, v1
    v_subrev_u32 v56, 0x4000, v1
    v_subrev_u32 v57, 0x14000, v1
    v_subrev_u32 v58, 0x24000, v1
    v_subrev_u32 v59, 0x34000, v1
    v_cmp_gt_i32 s[40:41], 0, v56
    v_cmp_gt_i32 s[42:43], 0, v57
    v_cmp_gt_i32 s[44:45], 0, v58
    v_cmp_gt_i32 s[46:47], 0, v59
    s_lshl_b32 s6, s3, 4
    s_add_u32 s6, s6, s4
    s_lshl_b32 s6, s6, 15
    s_lshl_b32 s7, s5, 10
    s_add_u32 s6, s6, s7
    v_lshlrev_b32 v1, 4, v2
    v_add_u32 v61, s6, v1
    s_lshl_b32 s7, s5, 2
    v_add_u32 v63, s7, v62
    s_mov_b32 s48, 0xaaaaaaaa
    s_mov_b32 s49, 0xaaaaaaaa
    s_mov_b32 s50, 0xcccccccc
    s_mov_b32 s51, 0xcccccccc
    s_mov_b32 s52, 0x000f000f
    s_mov_b32 s53, 0x000f000f
    v_mov_b32 v64, 0
    v_mov_b32 v65, 0
    v_mov_b32 v66, 0
    v_mov_b32 v67, 0
    v_mov_b32 v68, 0
    v_mov_b32 v69, 0
    v_mov_b32 v70, 0
    v_mov_b32 v71, 0
    v_mov_b32 v72, 0
    v_mov_b32 v73, 0
    v_mov_b32 v74, 0
    v_mov_b32 v75, 0
    v_mov_b32 v76, 0
    v_mov_b32 v77, 0
    v_mov_b32 v78, 0
    v_mov_b32 v79, 0
    v_mov_b32 v80, 0
    v_mov_b32 v81, 0
    v_mov_b32 v82, 0
    v_mov_b32 v83, 0
    v_mov_b32 v84, 0
    v_mov_b32 v85, 0
    v_mov_b32 v86, 0
    v_mov_b32 v87, 0
    v_mov_b32 v88, 0
    v_mov_b32 v89, 0
    v_mov_b32 v90, 0
    v_mov_b32 v91, 0
    v_mov_b32 v92, 0
    v_mov_b32 v93, 0
    v_mov_b32 v94, 0
    v_mov_b32 v95, 0
    v_mov_b32 v96, 0
    v_mov_b32 v97, 0
    v_mov_b32 v98, 0
    v_mov_b32 v99, 0
    v_mov_b32 v100, 0
    v_mov_b32 v101, 0
    v_mov_b32 v102, 0
    v_mov_b32 v103, 0
    v_mov_b32 v104, 0
    v_mov_b32 v105, 0
    v_mov_b32 v106, 0
    v_mov_b32 v107, 0
    v_mov_b32 v108, 0
    v_mov_b32 v109, 0
    v_mov_b32 v110, 0
    v_mov_b32 v111, 0
    v_mov_b32 v112, 0
    v_mov_b32 v113, 0
    v_mov_b32 v114, 0
    v_mov_b32 v115, 0
    v_mov_b32 v116, 0
    v_mov_b32 v117, 0
    v_mov_b32 v118, 0
    v_mov_b32 v119, 0
    v_mov_b32 v120, 0
    v_mov_b32 v121, 0
    v_mov_b32 v122, 0
    v_mov_b32 v123, 0
    v_mov_b32 v124, 0
    v_mov_b32 v125, 0
    v_mov_b32 v126, 0
    v_mov_b32 v127, 0
    s_waitcnt vmcnt(22)
    v_lshlrev_b32 v45, 16, v45
    v_lshlrev_b32 v46, 16, v46
    v_lshlrev_b32 v47, 16, v47
    v_mul_f32 v45, 0x3fb8aa3b, v45
    v_exp_f32 v45, v45
    s_nop 0
    v_cvt_pk_bf16_f32 v45, v45, v45
    v_lshlrev_b32 v45, 16, v45
    v_mul_f32 v52, v45, v46
    v_mul_f32 v53, v45, v47
    v_mul_f32 v52, 0x3fb8aa3b, v52
    v_exp_f32 v48, v52
    v_mul_f32 v53, 0.15915494, v53
    v_fract_f32 v53, v53
    v_cos_f32 v50, v53
    v_sin_f32 v51, v53
    s_nop 0
    v_mul_f32 v44, v48, v50
    v_mul_f32 v45, v48, v51
    v_add_f32 v48, -1.0, v44
    v_mul_f32 v49, v46, v46
    v_fmac_f32 v49, v47, v47
    v_rcp_f32 v49, v49
    v_mul_f32 v50, v48, v46
    v_fmac_f32 v50, v45, v47
    v_mul_f32 v51, v45, v46
    v_fma_f32 v51, -v48, v47, v51
    v_add_f32 v49, v49, v49
    v_mul_f32 v46, v50, v49
    v_mul_f32 v47, v51, v49
    v_lshlrev_b32 v54, 3, v12
    v_cvt_f32_u32 v54, v54
    v_lshrrev_b32 v55, 2, v12
    v_lshlrev_b32 v55, 7, v55
    v_cvt_f32_u32 v55, v55
    v_mov_b32_dpp v16, v44 quad_perm:[0,0,0,0] row_mask:0xf bank_mask:0xf
    v_mov_b32_dpp v20, v45 quad_perm:[0,0,0,0] row_mask:0xf bank_mask:0xf
    v_mov_b32_dpp v24, v46 quad_perm:[0,0,0,0] row_mask:0xf bank_mask:0xf
    v_mov_b32_dpp v28, v47 quad_perm:[0,0,0,0] row_mask:0xf bank_mask:0xf
    v_mov_b32_dpp v17, v44 quad_perm:[1,1,1,1] row_mask:0xf bank_mask:0xf
    v_mov_b32_dpp v21, v45 quad_perm:[1,1,1,1] row_mask:0xf bank_mask:0xf
    v_mov_b32_dpp v25, v46 quad_perm:[1,1,1,1] row_mask:0xf bank_mask:0xf
    v_mov_b32_dpp v29, v47 quad_perm:[1,1,1,1] row_mask:0xf bank_mask:0xf
    v_mov_b32_dpp v18, v44 quad_perm:[2,2,2,2] row_mask:0xf bank_mask:0xf
    v_mov_b32_dpp v22, v45 quad_perm:[2,2,2,2] row_mask:0xf bank_mask:0xf
    v_mov_b32_dpp v26, v46 quad_perm:[2,2,2,2] row_mask:0xf bank_mask:0xf
    v_mov_b32_dpp v30, v47 quad_perm:[2,2,2,2] row_mask:0xf bank_mask:0xf
    v_mov_b32_dpp v19, v44 quad_perm:[3,3,3,3] row_mask:0xf bank_mask:0xf
    v_mov_b32_dpp v23, v45 quad_perm:[3,3,3,3] row_mask:0xf bank_mask:0xf
    v_mov_b32_dpp v27, v46 quad_perm:[3,3,3,3] row_mask:0xf bank_mask:0xf
    v_mov_b32_dpp v31, v47 quad_perm:[3,3,3,3] row_mask:0xf bank_mask:0xf
    v_mul_f32_dpp v48, v52, v54 quad_perm:[0,0,0,0] row_mask:0xf bank_mask:0xf
    v_mul_f32_dpp v49, v53, v54 quad_perm:[0,0,0,0] row_mask:0xf bank_mask:0xf
    v_exp_f32 v48, v48
    v_fract_f32 v49, v49
    v_cos_f32 v50, v49
    v_sin_f32 v51, v49
    s_nop 0
    v_mul_f32 v32, v48, v50
    v_mul_f32 v36, v48, v51
    v_mul_f32_dpp v48, v52, v54 quad_perm:[1,1,1,1] row_mask:0xf bank_mask:0xf
    v_mul_f32_dpp v49, v53, v54 quad_perm:[1,1,1,1] row_mask:0xf bank_mask:0xf
    v_exp_f32 v48, v48
    v_fract_f32 v49, v49
    v_cos_f32 v50, v49
    v_sin_f32 v51, v49
    s_nop 0
    v_mul_f32 v33, v48, v50
    v_mul_f32 v37, v48, v51
    v_mul_f32_dpp v48, v52, v54 quad_perm:[2,2,2,2] row_mask:0xf bank_mask:0xf
    v_mul_f32_dpp v49, v53, v54 quad_perm:[2,2,2,2] row_mask:0xf bank_mask:0xf
    v_exp_f32 v48, v48
    v_fract_f32 v49, v49
    v_cos_f32 v50, v49
    v_sin_f32 v51, v49
    s_nop 0
    v_mul_f32 v34, v48, v50
    v_mul_f32 v38, v48, v51
    v_mul_f32_dpp v48, v52, v54 quad_perm:[3,3,3,3] row_mask:0xf bank_mask:0xf
    v_mul_f32_dpp v49, v53, v54 quad_perm:[3,3,3,3] row_mask:0xf bank_mask:0xf
    v_exp_f32 v48, v48
    v_fract_f32 v49, v49
    v_cos_f32 v50, v49
    v_sin_f32 v51, v49
    s_nop 0
    v_mul_f32 v35, v48, v50
    v_mul_f32 v39, v48, v51
    v_mul_f32 v48, v52, v55
    v_mul_f32 v49, v53, v55
    v_exp_f32 v48, v48
    v_fract_f32 v49, v49
    v_cos_f32 v50, v49
    v_sin_f32 v51, v49
    s_nop 0
    v_mul_f32 v40, v48, v50
    v_mul_f32 v41, v48, v51
    v_mul_f32 v48, 0x44000000, v52
    v_mul_f32 v49, 0x44000000, v53
    v_exp_f32 v48, v48
    v_fract_f32 v49, v49
    v_cos_f32 v50, v49
    v_sin_f32 v51, v49
    s_nop 0
    v_mul_f32 v42, v48, v50
    v_mul_f32 v43, v48, v51
    s_waitcnt vmcnt(9)
    v_lshlrev_b32 v136, 16, v128
    v_and_b32 v137, 0xffff0000, v128
    v_lshlrev_b32 v138, 16, v129
    v_and_b32 v139, 0xffff0000, v129
    v_lshlrev_b32 v178, 16, v140
    v_lshlrev_b32 v179, 16, v142
    v_lshlrev_b32 v180, 16, v144
    v_lshlrev_b32 v181, 16, v146
    v_lshlrev_b32 v182, 16, v148
    v_lshlrev_b32 v183, 16, v150
    v_lshlrev_b32 v184, 16, v152
    v_lshlrev_b32 v185, 16, v154
    v_lshlrev_b32 v186, 16, v156
    v_lshlrev_b32 v187, 16, v158
    v_lshlrev_b32 v188, 16, v160
    v_mul_f32 v190, v136, v181
    v_mul_f32 v191, v136, v182
    v_mul_f32 v192, v136, v183
    v_mul_f32 v193, v136, v184
    v_mul_f32 v194, v136, v185
    v_mul_f32 v195, v136, v186
    v_mul_f32 v196, v136, v187
    v_mul_f32 v197, v136, v188
    v_fmac_f32 v190, v137, v180
    v_fmac_f32 v191, v137, v181
    v_fmac_f32 v192, v137, v182
    v_fmac_f32 v193, v137, v183
    v_fmac_f32 v194, v137, v184
    v_fmac_f32 v195, v137, v185
    v_fmac_f32 v196, v137, v186
    v_fmac_f32 v197, v137, v187
    v_fmac_f32 v190, v138, v179
    v_fmac_f32 v191, v138, v180
    v_fmac_f32 v192, v138, v181
    v_fmac_f32 v193, v138, v182
    v_fmac_f32 v194, v138, v183
    v_fmac_f32 v195, v138, v184
    v_fmac_f32 v196, v138, v185
    v_fmac_f32 v197, v138, v186
    v_fmac_f32 v190, v139, v178
    v_fmac_f32 v191, v139, v179
    v_fmac_f32 v192, v139, v180
    v_fmac_f32 v193, v139, v181
    v_fmac_f32 v194, v139, v182
    v_fmac_f32 v195, v139, v183
    v_fmac_f32 v196, v139, v184
    v_fmac_f32 v197, v139, v185
    v_lshlrev_b32 v136, 16, v130
    v_and_b32 v137, 0xffff0000, v130
    v_lshlrev_b32 v138, 16, v131
    v_and_b32 v139, 0xffff0000, v131
    v_and_b32 v178, 0xffff0000, v140
    v_and_b32 v179, 0xffff0000, v142
    v_and_b32 v180, 0xffff0000, v144
    v_and_b32 v181, 0xffff0000, v146
    v_and_b32 v182, 0xffff0000, v148
    v_and_b32 v183, 0xffff0000, v150
    v_and_b32 v184, 0xffff0000, v152
    v_and_b32 v185, 0xffff0000, v154
    v_and_b32 v186, 0xffff0000, v156
    v_and_b32 v187, 0xffff0000, v158
    v_and_b32 v188, 0xffff0000, v160
    v_mul_f32 v198, v136, v181
    v_mul_f32 v199, v136, v182
    v_mul_f32 v200, v136, v183
    v_mul_f32 v201, v136, v184
    v_mul_f32 v202, v136, v185
    v_mul_f32 v203, v136, v186
    v_mul_f32 v204, v136, v187
    v_mul_f32 v205, v136, v188
    v_fmac_f32 v198, v137, v180
    v_fmac_f32 v199, v137, v181
    v_fmac_f32 v200, v137, v182
    v_fmac_f32 v201, v137, v183
    v_fmac_f32 v202, v137, v184
    v_fmac_f32 v203, v137, v185
    v_fmac_f32 v204, v137, v186
    v_fmac_f32 v205, v137, v187
    v_fmac_f32 v198, v138, v179
    v_fmac_f32 v199, v138, v180
    v_fmac_f32 v200, v138, v181
    v_fmac_f32 v201, v138, v182
    v_fmac_f32 v202, v138, v183
    v_fmac_f32 v203, v138, v184
    v_fmac_f32 v204, v138, v185
    v_fmac_f32 v205, v138, v186
    v_fmac_f32 v198, v139, v178
    v_fmac_f32 v199, v139, v179
    v_fmac_f32 v200, v139, v180
    v_fmac_f32 v201, v139, v181
    v_fmac_f32 v202, v139, v182
    v_fmac_f32 v203, v139, v183
    v_fmac_f32 v204, v139, v184
    v_fmac_f32 v205, v139, v185
    v_lshlrev_b32 v136, 16, v132
    v_and_b32 v137, 0xffff0000, v132
    v_lshlrev_b32 v138, 16, v133
    v_and_b32 v139, 0xffff0000, v133
    v_lshlrev_b32 v178, 16, v141
    v_lshlrev_b32 v179, 16, v143
    v_lshlrev_b32 v180, 16, v145
    v_lshlrev_b32 v181, 16, v147
    v_lshlrev_b32 v182, 16, v149
    v_lshlrev_b32 v183, 16, v151
    v_lshlrev_b32 v184, 16, v153
    v_lshlrev_b32 v185, 16, v155
    v_lshlrev_b32 v186, 16, v157
    v_lshlrev_b32 v187, 16, v159
    v_lshlrev_b32 v188, 16, v161
    v_mul_f32 v206, v136, v181
    v_mul_f32 v207, v136, v182
    v_mul_f32 v208, v136, v183
    v_mul_f32 v209, v136, v184
    v_mul_f32 v210, v136, v185
    v_mul_f32 v211, v136, v186
    v_mul_f32 v212, v136, v187
    v_mul_f32 v213, v136, v188
    v_fmac_f32 v206, v137, v180
    v_fmac_f32 v207, v137, v181
    v_fmac_f32 v208, v137, v182
    v_fmac_f32 v209, v137, v183
    v_fmac_f32 v210, v137, v184
    v_fmac_f32 v211, v137, v185
    v_fmac_f32 v212, v137, v186
    v_fmac_f32 v213, v137, v187
    v_fmac_f32 v206, v138, v179
    v_fmac_f32 v207, v138, v180
    v_fmac_f32 v208, v138, v181
    v_fmac_f32 v209, v138, v182
    v_fmac_f32 v210, v138, v183
    v_fmac_f32 v211, v138, v184
    v_fmac_f32 v212, v138, v185
    v_fmac_f32 v213, v138, v186
    v_fmac_f32 v206, v139, v178
    v_fmac_f32 v207, v139, v179
    v_fmac_f32 v208, v139, v180
    v_fmac_f32 v209, v139, v181
    v_fmac_f32 v210, v139, v182
    v_fmac_f32 v211, v139, v183
    v_fmac_f32 v212, v139, v184
    v_fmac_f32 v213, v139, v185
    v_lshlrev_b32 v136, 16, v134
    v_and_b32 v137, 0xffff0000, v134
    v_lshlrev_b32 v138, 16, v135
    v_and_b32 v139, 0xffff0000, v135
    v_and_b32 v178, 0xffff0000, v141
    v_and_b32 v179, 0xffff0000, v143
    v_and_b32 v180, 0xffff0000, v145
    v_and_b32 v181, 0xffff0000, v147
    v_and_b32 v182, 0xffff0000, v149
    v_and_b32 v183, 0xffff0000, v151
    v_and_b32 v184, 0xffff0000, v153
    v_and_b32 v185, 0xffff0000, v155
    v_and_b32 v186, 0xffff0000, v157
    v_and_b32 v187, 0xffff0000, v159
    v_and_b32 v188, 0xffff0000, v161
    v_mul_f32 v214, v136, v181
    v_mul_f32 v215, v136, v182
    v_mul_f32 v216, v136, v183
    v_mul_f32 v217, v136, v184
    v_mul_f32 v218, v136, v185
    v_mul_f32 v219, v136, v186
    v_mul_f32 v220, v136, v187
    v_mul_f32 v221, v136, v188
    v_fmac_f32 v214, v137, v180
    v_fmac_f32 v215, v137, v181
    v_fmac_f32 v216, v137, v182
    v_fmac_f32 v217, v137, v183
    v_fmac_f32 v218, v137, v184
    v_fmac_f32 v219, v137, v185
    v_fmac_f32 v220, v137, v186
    v_fmac_f32 v221, v137, v187
    v_fmac_f32 v214, v138, v179
    v_fmac_f32 v215, v138, v180
    v_fmac_f32 v216, v138, v181
    v_fmac_f32 v217, v138, v182
    v_fmac_f32 v218, v138, v183
    v_fmac_f32 v219, v138, v184
    v_fmac_f32 v220, v138, v185
    v_fmac_f32 v221, v138, v186
    v_fmac_f32 v214, v139, v178
    v_fmac_f32 v215, v139, v179
    v_fmac_f32 v216, v139, v180
    v_fmac_f32 v217, v139, v181
    v_fmac_f32 v218, v139, v182
    v_fmac_f32 v219, v139, v183
    v_fmac_f32 v220, v139, v184
    v_fmac_f32 v221, v139, v185
    s_waitcnt vmcnt(1)
    v_lshlrev_b32 v178, 16, v162
    v_lshlrev_b32 v179, 16, v164
    v_lshlrev_b32 v180, 16, v166
    v_lshlrev_b32 v181, 16, v168
    v_lshlrev_b32 v182, 16, v170
    v_lshlrev_b32 v183, 16, v172
    v_lshlrev_b32 v184, 16, v174
    v_lshlrev_b32 v185, 16, v176
    v_mul_f32 v190, v190, v178
    v_mul_f32 v191, v191, v179
    v_mul_f32 v192, v192, v180
    v_mul_f32 v193, v193, v181
    v_mul_f32 v194, v194, v182
    v_mul_f32 v195, v195, v183
    v_mul_f32 v196, v196, v184
    v_mul_f32 v197, v197, v185
    v_cvt_pk_bf16_f32 v224, v197, v196
    v_cvt_pk_bf16_f32 v225, v195, v194
    v_cvt_pk_bf16_f32 v226, v193, v192
    v_cvt_pk_bf16_f32 v227, v191, v190
    ds_write_b128 v15, v[224:227] offset:0
    v_and_b32 v178, 0xffff0000, v162
    v_and_b32 v179, 0xffff0000, v164
    v_and_b32 v180, 0xffff0000, v166
    v_and_b32 v181, 0xffff0000, v168
    v_and_b32 v182, 0xffff0000, v170
    v_and_b32 v183, 0xffff0000, v172
    v_and_b32 v184, 0xffff0000, v174
    v_and_b32 v185, 0xffff0000, v176
    v_mul_f32 v198, v198, v178
    v_mul_f32 v199, v199, v179
    v_mul_f32 v200, v200, v180
    v_mul_f32 v201, v201, v181
    v_mul_f32 v202, v202, v182
    v_mul_f32 v203, v203, v183
    v_mul_f32 v204, v204, v184
    v_mul_f32 v205, v205, v185
    v_cvt_pk_bf16_f32 v228, v205, v204
    v_cvt_pk_bf16_f32 v229, v203, v202
    v_cvt_pk_bf16_f32 v230, v201, v200
    v_cvt_pk_bf16_f32 v231, v199, v198
    ds_write_b128 v15, v[228:231] offset:256
    v_lshlrev_b32 v178, 16, v163
    v_lshlrev_b32 v179, 16, v165
    v_lshlrev_b32 v180, 16, v167
    v_lshlrev_b32 v181, 16, v169
    v_lshlrev_b32 v182, 16, v171
    v_lshlrev_b32 v183, 16, v173
    v_lshlrev_b32 v184, 16, v175
    v_lshlrev_b32 v185, 16, v177
    v_mul_f32 v206, v206, v178
    v_mul_f32 v207, v207, v179
    v_mul_f32 v208, v208, v180
    v_mul_f32 v209, v209, v181
    v_mul_f32 v210, v210, v182
    v_mul_f32 v211, v211, v183
    v_mul_f32 v212, v212, v184
    v_mul_f32 v213, v213, v185
    v_cvt_pk_bf16_f32 v232, v213, v212
    v_cvt_pk_bf16_f32 v233, v211, v210
    v_cvt_pk_bf16_f32 v234, v209, v208
    v_cvt_pk_bf16_f32 v235, v207, v206
    ds_write_b128 v15, v[232:235] offset:512
    v_and_b32 v178, 0xffff0000, v163
    v_and_b32 v179, 0xffff0000, v165
    v_and_b32 v180, 0xffff0000, v167
    v_and_b32 v181, 0xffff0000, v169
    v_and_b32 v182, 0xffff0000, v171
    v_and_b32 v183, 0xffff0000, v173
    v_and_b32 v184, 0xffff0000, v175
    v_and_b32 v185, 0xffff0000, v177
    v_mul_f32 v214, v214, v178
    v_mul_f32 v215, v215, v179
    v_mul_f32 v216, v216, v180
    v_mul_f32 v217, v217, v181
    v_mul_f32 v218, v218, v182
    v_mul_f32 v219, v219, v183
    v_mul_f32 v220, v220, v184
    v_mul_f32 v221, v221, v185
    v_cvt_pk_bf16_f32 v236, v221, v220
    v_cvt_pk_bf16_f32 v237, v219, v218
    v_cvt_pk_bf16_f32 v238, v217, v216
    v_cvt_pk_bf16_f32 v239, v215, v214
    ds_write_b128 v15, v[236:239] offset:768
    s_waitcnt lgkmcnt(0)
    s_barrier
    ds_read_b128 v[160:163], v9 offset:32768
    ds_read_b128 v[164:167], v9 offset:34816
    ds_read_b128 v[128:131], v5 offset:32768
    ds_read_b128 v[132:135], v5 offset:34816
    ds_read_b128 v[136:139], v5 offset:36864
    ds_read_b128 v[140:143], v5 offset:38912
    ds_read_b128 v[144:147], v5 offset:40960
    ds_read_b128 v[148:151], v5 offset:43008
    ds_read_b128 v[152:155], v5 offset:45056
    ds_read_b128 v[156:159], v5 offset:47104
    s_setprio 3
    ds_read_b128 v[224:227], v244 offset:0
    ds_read_b128 v[228:231], v245 offset:1024
    ds_read_b128 v[232:235], v246 offset:2048
    ds_read_b128 v[236:239], v247 offset:3072
    s_cmp_eq_u32 s34, 0
    s_waitcnt lgkmcnt(0)
    s_cbranch_scc1 C_x0
C_x0_r:
    buffer_store_dwordx4 v[224:227], v248, s[68:71], 0 offen sc1
    buffer_store_dwordx4 v[228:231], v248, s[68:71], s36 offen sc1
    buffer_store_dwordx4 v[232:235], v248, s[68:71], s37 offen sc1
    buffer_store_dwordx4 v[236:239], v248, s[68:71], s38 offen sc1
    buffer_load_dwordx2 v[54:55], off, s[16:19], 0 sc1
    v_lshlrev_b32 v246, 3, v12
    v_lshlrev_b32 v247, 4, v2
    v_mfma_f32_16x16x32_bf16 v[64:67], v[160:163], v[128:131], v[64:67]
    ds_read_b128 v[200:203], v11 offset:32768
    v_mfma_f32_16x16x32_bf16 v[68:71], v[164:167], v[128:131], v[68:71]
    ds_read_b128 v[204:207], v11 offset:34816
    v_mfma_f32_16x16x32_bf16 v[76:79], v[164:167], v[132:135], v[76:79]
    ds_read_b128 v[168:171], v7 offset:32768
    v_mfma_f32_16x16x32_bf16 v[72:75], v[160:163], v[132:135], v[72:75]
    ds_read_b128 v[172:175], v7 offset:34816
    v_mfma_f32_16x16x32_bf16 v[80:83], v[160:163], v[136:139], v[80:83]
    ds_read_b128 v[176:179], v7 offset:36864
    v_mfma_f32_16x16x32_bf16 v[84:87], v[164:167], v[136:139], v[84:87]
    ds_read_b128 v[180:183], v7 offset:38912
    v_mfma_f32_16x16x32_bf16 v[92:95], v[164:167], v[140:143], v[92:95]
    ds_read_b128 v[184:187], v7 offset:40960
    v_mfma_f32_16x16x32_bf16 v[88:91], v[160:163], v[140:143], v[88:91]
    ds_read_b128 v[188:191], v7 offset:43008
    v_mfma_f32_16x16x32_bf16 v[96:99], v[160:163], v[144:147], v[96:99]
    ds_read_b128 v[192:195], v7 offset:45056
    v_mfma_f32_16x16x32_bf16 v[100:103], v[164:167], v[144:147], v[100:103]
    ds_read_b128 v[196:199], v7 offset:47104
    v_mfma_f32_16x16x32_bf16 v[108:111], v[164:167], v[148:151], v[108:111]
    v_mfma_f32_16x16x32_bf16 v[104:107], v[160:163], v[148:151], v[104:107]
    v_mfma_f32_16x16x32_bf16 v[112:115], v[160:163], v[152:155], v[112:115]
    v_mfma_f32_16x16x32_bf16 v[116:119], v[164:167], v[152:155], v[116:119]
    v_mfma_f32_16x16x32_bf16 v[124:127], v[164:167], v[156:159], v[124:127]
    v_mfma_f32_16x16x32_bf16 v[120:123], v[160:163], v[156:159], v[120:123]
    s_waitcnt lgkmcnt(0)
    s_barrier
    v_mfma_f32_16x16x32_bf16 v[64:67], v[200:203], v[168:171], v[64:67]
    ds_read_b128 v[160:163], v8 offset:0
    v_mfma_f32_16x16x32_bf16 v[68:71], v[204:207], v[168:171], v[68:71]
    ds_read_b128 v[164:167], v8 offset:2048
    v_mfma_f32_16x16x32_bf16 v[76:79], v[204:207], v[172:175], v[76:79]
    ds_read_b128 v[128:131], v4 offset:0
    v_mfma_f32_16x16x32_bf16 v[72:75], v[200:203], v[172:175], v[72:75]
    ds_read_b128 v[132:135], v4 offset:2048
    v_mfma_f32_16x16x32_bf16 v[80:83], v[200:203], v[176:179], v[80:83]
    ds_read_b128 v[136:139], v4 offset:4096
    v_mfma_f32_16x16x32_bf16 v[84:87], v[204:207], v[176:179], v[84:87]
    ds_read_b128 v[140:143], v4 offset:6144
    v_mfma_f32_16x16x32_bf16 v[92:95], v[204:207], v[180:183], v[92:95]
    ds_read_b128 v[144:147], v4 offset:8192
    v_mfma_f32_16x16x32_bf16 v[88:91], v[200:203], v[180:183], v[88:91]
    ds_read_b128 v[148:151], v4 offset:10240
    v_mfma_f32_16x16x32_bf16 v[96:99], v[200:203], v[184:187], v[96:99]
    ds_read_b128 v[152:155], v4 offset:12288
    v_mfma_f32_16x16x32_bf16 v[100:103], v[204:207], v[184:187], v[100:103]
    ds_read_b128 v[156:159], v4 offset:14336
    v_mfma_f32_16x16x32_bf16 v[108:111], v[204:207], v[188:191], v[108:111]
    v_mfma_f32_16x16x32_bf16 v[104:107], v[200:203], v[188:191], v[104:107]
    v_mfma_f32_16x16x32_bf16 v[112:115], v[200:203], v[192:195], v[112:115]
    v_mfma_f32_16x16x32_bf16 v[116:119], v[204:207], v[192:195], v[116:119]
    v_mfma_f32_16x16x32_bf16 v[124:127], v[204:207], v[196:199], v[124:127]
    v_mfma_f32_16x16x32_bf16 v[120:123], v[200:203], v[196:199], v[120:123]
    s_cmp_eq_u32 s34, 1
    s_waitcnt lgkmcnt(0)
    s_cbranch_scc1 C_x1
C_x1_r:
    v_mfma_f32_16x16x32_bf16 v[64:67], v[160:163], v[128:131], v[64:67]
    ds_read_b128 v[200:203], v10 offset:0
    v_mfma_f32_16x16x32_bf16 v[68:71], v[164:167], v[128:131], v[68:71]
    ds_read_b128 v[204:207], v10 offset:2048
    v_mfma_f32_16x16x32_bf16 v[76:79], v[164:167], v[132:135], v[76:79]
    ds_read_b128 v[168:171], v6 offset:0
    v_mfma_f32_16x16x32_bf16 v[72:75], v[160:163], v[132:135], v[72:75]
    ds_read_b128 v[172:175], v6 offset:2048
    v_mfma_f32_16x16x32_bf16 v[80:83], v[160:163], v[136:139], v[80:83]
    ds_read_b128 v[176:179], v6 offset:4096
    v_mfma_f32_16x16x32_bf16 v[84:87], v[164:167], v[136:139], v[84:87]
    ds_read_b128 v[180:183], v6 offset:6144
    v_mfma_f32_16x16x32_bf16 v[92:95], v[164:167], v[140:143], v[92:95]
    ds_read_b128 v[184:187], v6 offset:8192
    v_mfma_f32_16x16x32_bf16 v[88:91], v[160:163], v[140:143], v[88:91]
    ds_read_b128 v[188:191], v6 offset:10240
    v_mfma_f32_16x16x32_bf16 v[96:99], v[160:163], v[144:147], v[96:99]
    ds_read_b128 v[192:195], v6 offset:12288
    v_mfma_f32_16x16x32_bf16 v[100:103], v[164:167], v[144:147], v[100:103]
    ds_read_b128 v[196:199], v6 offset:14336
    v_mfma_f32_16x16x32_bf16 v[108:111], v[164:167], v[148:151], v[108:111]
    v_mfma_f32_16x16x32_bf16 v[104:107], v[160:163], v[148:151], v[104:107]
    v_mfma_f32_16x16x32_bf16 v[112:115], v[160:163], v[152:155], v[112:115]
    v_mfma_f32_16x16x32_bf16 v[116:119], v[164:167], v[152:155], v[116:119]
    v_mfma_f32_16x16x32_bf16 v[124:127], v[164:167], v[156:159], v[124:127]
    v_mfma_f32_16x16x32_bf16 v[120:123], v[160:163], v[156:159], v[120:123]
    s_waitcnt lgkmcnt(0)
    s_barrier
    v_mfma_f32_16x16x32_bf16 v[64:67], v[200:203], v[168:171], v[64:67]
    ds_read_b128 v[160:163], v8 offset:32768
    v_mfma_f32_16x16x32_bf16 v[68:71], v[204:207], v[168:171], v[68:71]
    ds_read_b128 v[164:167], v8 offset:34816
    v_mfma_f32_16x16x32_bf16 v[76:79], v[204:207], v[172:175], v[76:79]
    ds_read_b128 v[128:131], v4 offset:32768
    v_mfma_f32_16x16x32_bf16 v[72:75], v[200:203], v[172:175], v[72:75]
    ds_read_b128 v[132:135], v4 offset:34816
    v_mfma_f32_16x16x32_bf16 v[80:83], v[200:203], v[176:179], v[80:83]
    ds_read_b128 v[136:139], v4 offset:36864
    v_mfma_f32_16x16x32_bf16 v[84:87], v[204:207], v[176:179], v[84:87]
    ds_read_b128 v[140:143], v4 offset:38912
    v_mfma_f32_16x16x32_bf16 v[92:95], v[204:207], v[180:183], v[92:95]
    ds_read_b128 v[144:147], v4 offset:40960
    v_mfma_f32_16x16x32_bf16 v[88:91], v[200:203], v[180:183], v[88:91]
    ds_read_b128 v[148:151], v4 offset:43008
    v_mfma_f32_16x16x32_bf16 v[96:99], v[200:203], v[184:187], v[96:99]
    ds_read_b128 v[152:155], v4 offset:45056
    v_mfma_f32_16x16x32_bf16 v[100:103], v[204:207], v[184:187], v[100:103]
    ds_read_b128 v[156:159], v4 offset:47104
    v_mfma_f32_16x16x32_bf16 v[108:111], v[204:207], v[188:191], v[108:111]
    v_mfma_f32_16x16x32_bf16 v[104:107], v[200:203], v[188:191], v[104:107]
    v_mfma_f32_16x16x32_bf16 v[112:115], v[200:203], v[192:195], v[112:115]
    v_mfma_f32_16x16x32_bf16 v[116:119], v[204:207], v[192:195], v[116:119]
    v_mfma_f32_16x16x32_bf16 v[124:127], v[204:207], v[196:199], v[124:127]
    v_mfma_f32_16x16x32_bf16 v[120:123], v[200:203], v[196:199], v[120:123]
    s_cmp_eq_u32 s34, 2
    s_waitcnt lgkmcnt(0)
    s_cbranch_scc1 C_x2
C_x2_r:
    v_mfma_f32_16x16x32_bf16 v[64:67], v[160:163], v[128:131], v[64:67]
    ds_read_b128 v[200:203], v10 offset:32768
    v_mfma_f32_16x16x32_bf16 v[68:71], v[164:167], v[128:131], v[68:71]
    ds_read_b128 v[204:207], v10 offset:34816
    v_mfma_f32_16x16x32_bf16 v[76:79], v[164:167], v[132:135], v[76:79]
    ds_read_b128 v[168:171], v6 offset:32768
    v_mfma_f32_16x16x32_bf16 v[72:75], v[160:163], v[132:135], v[72:75]
    ds_read_b128 v[172:175], v6 offset:34816
    v_mfma_f32_16x16x32_bf16 v[80:83], v[160:163], v[136:139], v[80:83]
    ds_read_b128 v[176:179], v6 offset:36864
    v_mfma_f32_16x16x32_bf16 v[84:87], v[164:167], v[136:139], v[84:87]
    ds_read_b128 v[180:183], v6 offset:38912
    v_mfma_f32_16x16x32_bf16 v[92:95], v[164:167], v[140:143], v[92:95]
    ds_read_b128 v[184:187], v6 offset:40960
    v_mfma_f32_16x16x32_bf16 v[88:91], v[160:163], v[140:143], v[88:91]
    ds_read_b128 v[188:191], v6 offset:43008
    v_mfma_f32_16x16x32_bf16 v[96:99], v[160:163], v[144:147], v[96:99]
    ds_read_b128 v[192:195], v6 offset:45056
    v_mfma_f32_16x16x32_bf16 v[100:103], v[164:167], v[144:147], v[100:103]
    ds_read_b128 v[196:199], v6 offset:47104
    v_mfma_f32_16x16x32_bf16 v[108:111], v[164:167], v[148:151], v[108:111]
    v_mfma_f32_16x16x32_bf16 v[104:107], v[160:163], v[148:151], v[104:107]
    v_mfma_f32_16x16x32_bf16 v[112:115], v[160:163], v[152:155], v[112:115]
    v_mfma_f32_16x16x32_bf16 v[116:119], v[164:167], v[152:155], v[116:119]
    v_mfma_f32_16x16x32_bf16 v[124:127], v[164:167], v[156:159], v[124:127]
    v_mfma_f32_16x16x32_bf16 v[120:123], v[160:163], v[156:159], v[120:123]
    s_waitcnt lgkmcnt(0)
    s_barrier
    v_mfma_f32_16x16x32_bf16 v[64:67], v[200:203], v[168:171], v[64:67]
    ds_read_b128 v[160:163], v9 offset:0
    v_mfma_f32_16x16x32_bf16 v[68:71], v[204:207], v[168:171], v[68:71]
    ds_read_b128 v[164:167], v9 offset:2048
    v_mfma_f32_16x16x32_bf16 v[76:79], v[204:207], v[172:175], v[76:79]
    ds_read_b128 v[128:131], v5 offset:0
    v_mfma_f32_16x16x32_bf16 v[72:75], v[200:203], v[172:175], v[72:75]
    ds_read_b128 v[132:135], v5 offset:2048
    v_mfma_f32_16x16x32_bf16 v[80:83], v[200:203], v[176:179], v[80:83]
    ds_read_b128 v[136:139], v5 offset:4096
    v_mfma_f32_16x16x32_bf16 v[84:87], v[204:207], v[176:179], v[84:87]
    ds_read_b128 v[140:143], v5 offset:6144
    v_mfma_f32_16x16x32_bf16 v[92:95], v[204:207], v[180:183], v[92:95]
    ds_read_b128 v[144:147], v5 offset:8192
    v_mfma_f32_16x16x32_bf16 v[88:91], v[200:203], v[180:183], v[88:91]
    ds_read_b128 v[148:151], v5 offset:10240
    v_mfma_f32_16x16x32_bf16 v[96:99], v[200:203], v[184:187], v[96:99]
    ds_read_b128 v[152:155], v5 offset:12288
    v_mfma_f32_16x16x32_bf16 v[100:103], v[204:207], v[184:187], v[100:103]
    ds_read_b128 v[156:159], v5 offset:14336
    v_mfma_f32_16x16x32_bf16 v[108:111], v[204:207], v[188:191], v[108:111]
    v_mfma_f32_16x16x32_bf16 v[104:107], v[200:203], v[188:191], v[104:107]
    v_mfma_f32_16x16x32_bf16 v[112:115], v[200:203], v[192:195], v[112:115]
    v_mfma_f32_16x16x32_bf16 v[116:119], v[204:207], v[192:195], v[116:119]
    v_mfma_f32_16x16x32_bf16 v[124:127], v[204:207], v[196:199], v[124:127]
    v_mfma_f32_16x16x32_bf16 v[120:123], v[200:203], v[196:199], v[120:123]
    s_cmp_eq_u32 s34, 3
    s_waitcnt lgkmcnt(0)
    s_cbranch_scc1 C_x3
C_x3_r:
    v_mfma_f32_16x16x32_bf16 v[64:67], v[160:163], v[128:131], v[64:67]
    ds_read_b128 v[200:203], v11 offset:0
    v_mfma_f32_16x16x32_bf16 v[68:71], v[164:167], v[128:131], v[68:71]
    ds_read_b128 v[204:207], v11 offset:2048
    v_mfma_f32_16x16x32_bf16 v[76:79], v[164:167], v[132:135], v[76:79]
    ds_read_b128 v[168:171], v7 offset:0
    v_mfma_f32_16x16x32_bf16 v[72:75], v[160:163], v[132:135], v[72:75]
    ds_read_b128 v[172:175], v7 offset:2048
    v_mfma_f32_16x16x32_bf16 v[80:83], v[160:163], v[136:139], v[80:83]
    ds_read_b128 v[176:179], v7 offset:4096
    v_mfma_f32_16x16x32_bf16 v[84:87], v[164:167], v[136:139], v[84:87]
    ds_read_b128 v[180:183], v7 offset:6144
    v_mfma_f32_16x16x32_bf16 v[92:95], v[164:167], v[140:143], v[92:95]
    ds_read_b128 v[184:187], v7 offset:8192
    v_mfma_f32_16x16x32_bf16 v[88:91], v[160:163], v[140:143], v[88:91]
    ds_read_b128 v[188:191], v7 offset:10240
    v_mfma_f32_16x16x32_bf16 v[96:99], v[160:163], v[144:147], v[96:99]
    ds_read_b128 v[192:195], v7 offset:12288
    v_mfma_f32_16x16x32_bf16 v[100:103], v[164:167], v[144:147], v[100:103]
    ds_read_b128 v[196:199], v7 offset:14336
    v_mfma_f32_16x16x32_bf16 v[108:111], v[164:167], v[148:151], v[108:111]
    v_mfma_f32_16x16x32_bf16 v[104:107], v[160:163], v[148:151], v[104:107]
    v_mfma_f32_16x16x32_bf16 v[112:115], v[160:163], v[152:155], v[112:115]
    v_mfma_f32_16x16x32_bf16 v[116:119], v[164:167], v[152:155], v[116:119]
    v_mfma_f32_16x16x32_bf16 v[124:127], v[164:167], v[156:159], v[124:127]
    v_mfma_f32_16x16x32_bf16 v[120:123], v[160:163], v[156:159], v[120:123]
    s_waitcnt lgkmcnt(0)
    s_barrier
    v_mfma_f32_16x16x32_bf16 v[64:67], v[200:203], v[168:171], v[64:67]
    ds_read_b128 v[160:163], v9 offset:32768
    v_mfma_f32_16x16x32_bf16 v[68:71], v[204:207], v[168:171], v[68:71]
    ds_read_b128 v[164:167], v9 offset:34816
    v_mfma_f32_16x16x32_bf16 v[76:79], v[204:207], v[172:175], v[76:79]
    ds_read_b128 v[128:131], v5 offset:32768
    v_mfma_f32_16x16x32_bf16 v[72:75], v[200:203], v[172:175], v[72:75]
    ds_read_b128 v[132:135], v5 offset:34816
    v_mfma_f32_16x16x32_bf16 v[80:83], v[200:203], v[176:179], v[80:83]
    ds_read_b128 v[136:139], v5 offset:36864
    v_mfma_f32_16x16x32_bf16 v[84:87], v[204:207], v[176:179], v[84:87]
    ds_read_b128 v[140:143], v5 offset:38912
    v_mfma_f32_16x16x32_bf16 v[92:95], v[204:207], v[180:183], v[92:95]
    ds_read_b128 v[144:147], v5 offset:40960
    v_mfma_f32_16x16x32_bf16 v[88:91], v[200:203], v[180:183], v[88:91]
    ds_read_b128 v[148:151], v5 offset:43008
    v_mfma_f32_16x16x32_bf16 v[96:99], v[200:203], v[184:187], v[96:99]
    ds_read_b128 v[152:155], v5 offset:45056
    v_mfma_f32_16x16x32_bf16 v[100:103], v[204:207], v[184:187], v[100:103]
    ds_read_b128 v[156:159], v5 offset:47104
    v_mfma_f32_16x16x32_bf16 v[108:111], v[204:207], v[188:191], v[108:111]
    v_mfma_f32_16x16x32_bf16 v[104:107], v[200:203], v[188:191], v[104:107]
    v_mfma_f32_16x16x32_bf16 v[112:115], v[200:203], v[192:195], v[112:115]
    v_mfma_f32_16x16x32_bf16 v[116:119], v[204:207], v[192:195], v[116:119]
    v_mfma_f32_16x16x32_bf16 v[124:127], v[204:207], v[196:199], v[124:127]
    v_mfma_f32_16x16x32_bf16 v[120:123], v[200:203], v[196:199], v[120:123]
    s_cmp_eq_u32 s34, 4
    s_waitcnt lgkmcnt(0)
    s_cbranch_scc1 C_x4
C_x4_r:
    v_mfma_f32_16x16x32_bf16 v[64:67], v[160:163], v[128:131], v[64:67]
    ds_read_b128 v[200:203], v11 offset:32768
    v_mfma_f32_16x16x32_bf16 v[68:71], v[164:167], v[128:131], v[68:71]
    ds_read_b128 v[204:207], v11 offset:34816
    v_mfma_f32_16x16x32_bf16 v[76:79], v[164:167], v[132:135], v[76:79]
    ds_read_b128 v[168:171], v7 offset:32768
    v_mfma_f32_16x16x32_bf16 v[72:75], v[160:163], v[132:135], v[72:75]
    ds_read_b128 v[172:175], v7 offset:34816
    v_mfma_f32_16x16x32_bf16 v[80:83], v[160:163], v[136:139], v[80:83]
    ds_read_b128 v[176:179], v7 offset:36864
    v_mfma_f32_16x16x32_bf16 v[84:87], v[164:167], v[136:139], v[84:87]
    ds_read_b128 v[180:183], v7 offset:38912
    v_mfma_f32_16x16x32_bf16 v[92:95], v[164:167], v[140:143], v[92:95]
    ds_read_b128 v[184:187], v7 offset:40960
    v_mfma_f32_16x16x32_bf16 v[88:91], v[160:163], v[140:143], v[88:91]
    ds_read_b128 v[188:191], v7 offset:43008
    v_mfma_f32_16x16x32_bf16 v[96:99], v[160:163], v[144:147], v[96:99]
    ds_read_b128 v[192:195], v7 offset:45056
    v_mfma_f32_16x16x32_bf16 v[100:103], v[164:167], v[144:147], v[100:103]
    ds_read_b128 v[196:199], v7 offset:47104
    v_mfma_f32_16x16x32_bf16 v[108:111], v[164:167], v[148:151], v[108:111]
    v_mfma_f32_16x16x32_bf16 v[104:107], v[160:163], v[148:151], v[104:107]
    v_mfma_f32_16x16x32_bf16 v[112:115], v[160:163], v[152:155], v[112:115]
    v_mfma_f32_16x16x32_bf16 v[116:119], v[164:167], v[152:155], v[116:119]
    v_mfma_f32_16x16x32_bf16 v[124:127], v[164:167], v[156:159], v[124:127]
    v_mfma_f32_16x16x32_bf16 v[120:123], v[160:163], v[156:159], v[120:123]
    s_waitcnt vmcnt(0)
    v_readfirstlane_b32 s7, v54
    s_cmp_lg_u32 s7, 0
    s_cbranch_scc0 C_non
C_non_r:
    s_mov_b64 exec, 1
    buffer_store_dwordx2 v[54:55], off, s[72:75], s20 sc1
    ds_write_b64 v62, v[54:55]
    s_mov_b64 exec, -1
    s_waitcnt lgkmcnt(0)
    s_barrier
    v_mfma_f32_16x16x32_bf16 v[64:67], v[200:203], v[168:171], v[64:67]
    ds_read_b128 v[160:163], v8 offset:0
    v_mfma_f32_16x16x32_bf16 v[68:71], v[204:207], v[168:171], v[68:71]
    ds_read_b128 v[164:167], v8 offset:2048
    v_mfma_f32_16x16x32_bf16 v[76:79], v[204:207], v[172:175], v[76:79]
    ds_read_b128 v[128:131], v4 offset:0
    v_mfma_f32_16x16x32_bf16 v[72:75], v[200:203], v[172:175], v[72:75]
    ds_read_b128 v[132:135], v4 offset:2048
    v_mfma_f32_16x16x32_bf16 v[80:83], v[200:203], v[176:179], v[80:83]
    ds_read_b128 v[136:139], v4 offset:4096
    v_mfma_f32_16x16x32_bf16 v[84:87], v[204:207], v[176:179], v[84:87]
    ds_read_b128 v[140:143], v4 offset:6144
    v_mfma_f32_16x16x32_bf16 v[92:95], v[204:207], v[180:183], v[92:95]
    ds_read_b128 v[144:147], v4 offset:8192
    v_mfma_f32_16x16x32_bf16 v[88:91], v[200:203], v[180:183], v[88:91]
    ds_read_b128 v[148:151], v4 offset:10240
    v_mfma_f32_16x16x32_bf16 v[96:99], v[200:203], v[184:187], v[96:99]
    ds_read_b128 v[152:155], v4 offset:12288
    v_mfma_f32_16x16x32_bf16 v[100:103], v[204:207], v[184:187], v[100:103]
    ds_read_b128 v[156:159], v4 offset:14336
    v_mfma_f32_16x16x32_bf16 v[108:111], v[204:207], v[188:191], v[108:111]
    v_mfma_f32_16x16x32_bf16 v[104:107], v[200:203], v[188:191], v[104:107]
    v_mfma_f32_16x16x32_bf16 v[112:115], v[200:203], v[192:195], v[112:115]
    v_mfma_f32_16x16x32_bf16 v[116:119], v[204:207], v[192:195], v[116:119]
    v_mfma_f32_16x16x32_bf16 v[124:127], v[204:207], v[196:199], v[124:127]
    v_mfma_f32_16x16x32_bf16 v[120:123], v[200:203], v[196:199], v[120:123]
    s_cmp_eq_u32 s34, 5
    s_waitcnt lgkmcnt(0)
    s_cbranch_scc1 C_x5
C_x5_r:
    v_mfma_f32_16x16x32_bf16 v[64:67], v[160:163], v[128:131], v[64:67]
    ds_read_b128 v[200:203], v10 offset:0
    v_mfma_f32_16x16x32_bf16 v[68:71], v[164:167], v[128:131], v[68:71]
    ds_read_b128 v[204:207], v10 offset:2048
    v_mfma_f32_16x16x32_bf16 v[76:79], v[164:167], v[132:135], v[76:79]
    ds_read_b128 v[168:171], v6 offset:0
    v_mfma_f32_16x16x32_bf16 v[72:75], v[160:163], v[132:135], v[72:75]
    ds_read_b128 v[172:175], v6 offset:2048
    v_mfma_f32_16x16x32_bf16 v[80:83], v[160:163], v[136:139], v[80:83]
    ds_read_b128 v[176:179], v6 offset:4096
    v_mfma_f32_16x16x32_bf16 v[84:87], v[164:167], v[136:139], v[84:87]
    ds_read_b128 v[180:183], v6 offset:6144
    v_mfma_f32_16x16x32_bf16 v[92:95], v[164:167], v[140:143], v[92:95]
    ds_read_b128 v[184:187], v6 offset:8192
    v_mfma_f32_16x16x32_bf16 v[88:91], v[160:163], v[140:143], v[88:91]
    ds_read_b128 v[188:191], v6 offset:10240
    v_mfma_f32_16x16x32_bf16 v[96:99], v[160:163], v[144:147], v[96:99]
    ds_read_b128 v[192:195], v6 offset:12288
    v_mfma_f32_16x16x32_bf16 v[100:103], v[164:167], v[144:147], v[100:103]
    ds_read_b128 v[196:199], v6 offset:14336
    v_mfma_f32_16x16x32_bf16 v[108:111], v[164:167], v[148:151], v[108:111]
    v_mfma_f32_16x16x32_bf16 v[104:107], v[160:163], v[148:151], v[104:107]
    v_mfma_f32_16x16x32_bf16 v[112:115], v[160:163], v[152:155], v[112:115]
    v_mfma_f32_16x16x32_bf16 v[116:119], v[164:167], v[152:155], v[116:119]
    v_mfma_f32_16x16x32_bf16 v[124:127], v[164:167], v[156:159], v[124:127]
    v_mfma_f32_16x16x32_bf16 v[120:123], v[160:163], v[156:159], v[120:123]
    s_waitcnt lgkmcnt(0)
    s_barrier
    v_mfma_f32_16x16x32_bf16 v[64:67], v[200:203], v[168:171], v[64:67]
    ds_read_b128 v[160:163], v8 offset:32768
    v_mfma_f32_16x16x32_bf16 v[68:71], v[204:207], v[168:171], v[68:71]
    ds_read_b128 v[164:167], v8 offset:34816
    v_mfma_f32_16x16x32_bf16 v[76:79], v[204:207], v[172:175], v[76:79]
    ds_read_b128 v[128:131], v4 offset:32768
    v_mfma_f32_16x16x32_bf16 v[72:75], v[200:203], v[172:175], v[72:75]
    ds_read_b128 v[132:135], v4 offset:34816
    v_mfma_f32_16x16x32_bf16 v[80:83], v[200:203], v[176:179], v[80:83]
    ds_read_b128 v[136:139], v4 offset:36864
    v_mfma_f32_16x16x32_bf16 v[84:87], v[204:207], v[176:179], v[84:87]
    ds_read_b128 v[140:143], v4 offset:38912
    v_mfma_f32_16x16x32_bf16 v[92:95], v[204:207], v[180:183], v[92:95]
    ds_read_b128 v[144:147], v4 offset:40960
    v_mfma_f32_16x16x32_bf16 v[88:91], v[200:203], v[180:183], v[88:91]
    ds_read_b128 v[148:151], v4 offset:43008
    v_mfma_f32_16x16x32_bf16 v[96:99], v[200:203], v[184:187], v[96:99]
    ds_read_b128 v[152:155], v4 offset:45056
    v_mfma_f32_16x16x32_bf16 v[100:103], v[204:207], v[184:187], v[100:103]
    ds_read_b128 v[156:159], v4 offset:47104
    v_mfma_f32_16x16x32_bf16 v[108:111], v[204:207], v[188:191], v[108:111]
    v_mfma_f32_16x16x32_bf16 v[104:107], v[200:203], v[188:191], v[104:107]
    v_mfma_f32_16x16x32_bf16 v[112:115], v[200:203], v[192:195], v[112:115]
    v_mfma_f32_16x16x32_bf16 v[116:119], v[204:207], v[192:195], v[116:119]
    v_mfma_f32_16x16x32_bf16 v[124:127], v[204:207], v[196:199], v[124:127]
    v_mfma_f32_16x16x32_bf16 v[120:123], v[200:203], v[196:199], v[120:123]
    s_cmp_eq_u32 s34, 6
    s_waitcnt lgkmcnt(0)
    s_cbranch_scc1 C_x6
C_x6_r:
    v_mfma_f32_16x16x32_bf16 v[64:67], v[160:163], v[128:131], v[64:67]
    ds_read_b128 v[200:203], v10 offset:32768
    v_mfma_f32_16x16x32_bf16 v[68:71], v[164:167], v[128:131], v[68:71]
    ds_read_b128 v[204:207], v10 offset:34816
    v_mfma_f32_16x16x32_bf16 v[76:79], v[164:167], v[132:135], v[76:79]
    ds_read_b128 v[168:171], v6 offset:32768
    v_mfma_f32_16x16x32_bf16 v[72:75], v[160:163], v[132:135], v[72:75]
    ds_read_b128 v[172:175], v6 offset:34816
    v_mfma_f32_16x16x32_bf16 v[80:83], v[160:163], v[136:139], v[80:83]
    ds_read_b128 v[176:179], v6 offset:36864
    v_mfma_f32_16x16x32_bf16 v[84:87], v[164:167], v[136:139], v[84:87]
    ds_read_b128 v[180:183], v6 offset:38912
    v_mfma_f32_16x16x32_bf16 v[92:95], v[164:167], v[140:143], v[92:95]
    ds_read_b128 v[184:187], v6 offset:40960
    v_mfma_f32_16x16x32_bf16 v[88:91], v[160:163], v[140:143], v[88:91]
    ds_read_b128 v[188:191], v6 offset:43008
    v_mfma_f32_16x16x32_bf16 v[96:99], v[160:163], v[144:147], v[96:99]
    ds_read_b128 v[192:195], v6 offset:45056
    v_mfma_f32_16x16x32_bf16 v[100:103], v[164:167], v[144:147], v[100:103]
    ds_read_b128 v[196:199], v6 offset:47104
    v_mfma_f32_16x16x32_bf16 v[108:111], v[164:167], v[148:151], v[108:111]
    v_mfma_f32_16x16x32_bf16 v[104:107], v[160:163], v[148:151], v[104:107]
    v_mfma_f32_16x16x32_bf16 v[112:115], v[160:163], v[152:155], v[112:115]
    v_mfma_f32_16x16x32_bf16 v[116:119], v[164:167], v[152:155], v[116:119]
    v_mfma_f32_16x16x32_bf16 v[124:127], v[164:167], v[156:159], v[124:127]
    v_mfma_f32_16x16x32_bf16 v[120:123], v[160:163], v[156:159], v[120:123]
    s_waitcnt lgkmcnt(0)
    s_barrier
    v_mfma_f32_16x16x32_bf16 v[64:67], v[200:203], v[168:171], v[64:67]
    ds_read_b128 v[160:163], v9 offset:0
    v_mfma_f32_16x16x32_bf16 v[68:71], v[204:207], v[168:171], v[68:71]
    ds_read_b128 v[164:167], v9 offset:2048
    v_mfma_f32_16x16x32_bf16 v[76:79], v[204:207], v[172:175], v[76:79]
    ds_read_b128 v[128:131], v5 offset:0
    v_mfma_f32_16x16x32_bf16 v[72:75], v[200:203], v[172:175], v[72:75]
    ds_read_b128 v[132:135], v5 offset:2048
    v_mfma_f32_16x16x32_bf16 v[80:83], v[200:203], v[176:179], v[80:83]
    ds_read_b128 v[136:139], v5 offset:4096
    v_mfma_f32_16x16x32_bf16 v[84:87], v[204:207], v[176:179], v[84:87]
    ds_read_b128 v[140:143], v5 offset:6144
    v_mfma_f32_16x16x32_bf16 v[92:95], v[204:207], v[180:183], v[92:95]
    ds_read_b128 v[144:147], v5 offset:8192
    v_mfma_f32_16x16x32_bf16 v[88:91], v[200:203], v[180:183], v[88:91]
    ds_read_b128 v[148:151], v5 offset:10240
    v_mfma_f32_16x16x32_bf16 v[96:99], v[200:203], v[184:187], v[96:99]
    ds_read_b128 v[152:155], v5 offset:12288
    v_mfma_f32_16x16x32_bf16 v[100:103], v[204:207], v[184:187], v[100:103]
    ds_read_b128 v[156:159], v5 offset:14336
    v_mfma_f32_16x16x32_bf16 v[108:111], v[204:207], v[188:191], v[108:111]
    v_mfma_f32_16x16x32_bf16 v[104:107], v[200:203], v[188:191], v[104:107]
    v_mfma_f32_16x16x32_bf16 v[112:115], v[200:203], v[192:195], v[112:115]
    v_mfma_f32_16x16x32_bf16 v[116:119], v[204:207], v[192:195], v[116:119]
    v_mfma_f32_16x16x32_bf16 v[124:127], v[204:207], v[196:199], v[124:127]
    v_mfma_f32_16x16x32_bf16 v[120:123], v[200:203], v[196:199], v[120:123]
    s_cmp_eq_u32 s34, 7
    s_waitcnt lgkmcnt(0)
    s_cbranch_scc1 C_x7
C_x7_r:
    v_mfma_f32_16x16x32_bf16 v[64:67], v[160:163], v[128:131], v[64:67]
    ds_read_b128 v[200:203], v11 offset:0
    v_mfma_f32_16x16x32_bf16 v[68:71], v[164:167], v[128:131], v[68:71]
    ds_read_b128 v[204:207], v11 offset:2048
    v_mfma_f32_16x16x32_bf16 v[76:79], v[164:167], v[132:135], v[76:79]
    ds_read_b128 v[168:171], v7 offset:0
    v_mfma_f32_16x16x32_bf16 v[72:75], v[160:163], v[132:135], v[72:75]
    ds_read_b128 v[172:175], v7 offset:2048
    v_mfma_f32_16x16x32_bf16 v[80:83], v[160:163], v[136:139], v[80:83]
    ds_read_b128 v[176:179], v7 offset:4096
    v_mfma_f32_16x16x32_bf16 v[84:87], v[164:167], v[136:139], v[84:87]
    ds_read_b128 v[180:183], v7 offset:6144
    v_mfma_f32_16x16x32_bf16 v[92:95], v[164:167], v[140:143], v[92:95]
    ds_read_b128 v[184:187], v7 offset:8192
    v_mfma_f32_16x16x32_bf16 v[88:91], v[160:163], v[140:143], v[88:91]
    ds_read_b128 v[188:191], v7 offset:10240
    v_mfma_f32_16x16x32_bf16 v[96:99], v[160:163], v[144:147], v[96:99]
    ds_read_b128 v[192:195], v7 offset:12288
    v_mfma_f32_16x16x32_bf16 v[100:103], v[164:167], v[144:147], v[100:103]
    ds_read_b128 v[196:199], v7 offset:14336
    v_mfma_f32_16x16x32_bf16 v[108:111], v[164:167], v[148:151], v[108:111]
    v_mfma_f32_16x16x32_bf16 v[104:107], v[160:163], v[148:151], v[104:107]
    v_mfma_f32_16x16x32_bf16 v[112:115], v[160:163], v[152:155], v[112:115]
    v_mfma_f32_16x16x32_bf16 v[116:119], v[164:167], v[152:155], v[116:119]
    v_mfma_f32_16x16x32_bf16 v[124:127], v[164:167], v[156:159], v[124:127]
    v_mfma_f32_16x16x32_bf16 v[120:123], v[160:163], v[156:159], v[120:123]
    s_waitcnt lgkmcnt(0)
    s_barrier
    v_mfma_f32_16x16x32_bf16 v[64:67], v[200:203], v[168:171], v[64:67]
    ds_read_b128 v[160:163], v9 offset:32768
    v_mfma_f32_16x16x32_bf16 v[68:71], v[204:207], v[168:171], v[68:71]
    ds_read_b128 v[164:167], v9 offset:34816
    v_mfma_f32_16x16x32_bf16 v[76:79], v[204:207], v[172:175], v[76:79]
    ds_read_b128 v[128:131], v5 offset:32768
    v_mfma_f32_16x16x32_bf16 v[72:75], v[200:203], v[172:175], v[72:75]
    ds_read_b128 v[132:135], v5 offset:34816
    v_mfma_f32_16x16x32_bf16 v[80:83], v[200:203], v[176:179], v[80:83]
    ds_read_b128 v[136:139], v5 offset:36864
    v_mfma_f32_16x16x32_bf16 v[84:87], v[204:207], v[176:179], v[84:87]
    ds_read_b128 v[140:143], v5 offset:38912
    v_mfma_f32_16x16x32_bf16 v[92:95], v[204:207], v[180:183], v[92:95]
    ds_read_b128 v[144:147], v5 offset:40960
    v_mfma_f32_16x16x32_bf16 v[88:91], v[200:203], v[180:183], v[88:91]
    ds_read_b128 v[148:151], v5 offset:43008
    v_mfma_f32_16x16x32_bf16 v[96:99], v[200:203], v[184:187], v[96:99]
    ds_read_b128 v[152:155], v5 offset:45056
    v_mfma_f32_16x16x32_bf16 v[100:103], v[204:207], v[184:187], v[100:103]
    ds_read_b128 v[156:159], v5 offset:47104
    v_mfma_f32_16x16x32_bf16 v[108:111], v[204:207], v[188:191], v[108:111]
    v_mfma_f32_16x16x32_bf16 v[104:107], v[200:203], v[188:191], v[104:107]
    v_mfma_f32_16x16x32_bf16 v[112:115], v[200:203], v[192:195], v[112:115]
    v_mfma_f32_16x16x32_bf16 v[116:119], v[204:207], v[192:195], v[116:119]
    v_mfma_f32_16x16x32_bf16 v[124:127], v[204:207], v[196:199], v[124:127]
    v_mfma_f32_16x16x32_bf16 v[120:123], v[200:203], v[196:199], v[120:123]
    s_cmp_eq_u32 s34, 8
    s_waitcnt lgkmcnt(0)
    s_cbranch_scc1 C_x8
C_x8_r:
    v_mfma_f32_16x16x32_bf16 v[64:67], v[160:163], v[128:131], v[64:67]
    ds_read_b128 v[200:203], v11 offset:32768
    v_mfma_f32_16x16x32_bf16 v[68:71], v[164:167], v[128:131], v[68:71]
    ds_read_b128 v[204:207], v11 offset:34816
    v_mfma_f32_16x16x32_bf16 v[76:79], v[164:167], v[132:135], v[76:79]
    ds_read_b128 v[168:171], v7 offset:32768
    v_mfma_f32_16x16x32_bf16 v[72:75], v[160:163], v[132:135], v[72:75]
    ds_read_b128 v[172:175], v7 offset:34816
    v_mfma_f32_16x16x32_bf16 v[80:83], v[160:163], v[136:139], v[80:83]
    ds_read_b128 v[176:179], v7 offset:36864
    v_mfma_f32_16x16x32_bf16 v[84:87], v[164:167], v[136:139], v[84:87]
    ds_read_b128 v[180:183], v7 offset:38912
    v_mfma_f32_16x16x32_bf16 v[92:95], v[164:167], v[140:143], v[92:95]
    ds_read_b128 v[184:187], v7 offset:40960
    v_mfma_f32_16x16x32_bf16 v[88:91], v[160:163], v[140:143], v[88:91]
    ds_read_b128 v[188:191], v7 offset:43008
    v_mfma_f32_16x16x32_bf16 v[96:99], v[160:163], v[144:147], v[96:99]
    ds_read_b128 v[192:195], v7 offset:45056
    v_mfma_f32_16x16x32_bf16 v[100:103], v[164:167], v[144:147], v[100:103]
    ds_read_b128 v[196:199], v7 offset:47104
    v_mfma_f32_16x16x32_bf16 v[108:111], v[164:167], v[148:151], v[108:111]
    v_mfma_f32_16x16x32_bf16 v[104:107], v[160:163], v[148:151], v[104:107]
    v_mfma_f32_16x16x32_bf16 v[112:115], v[160:163], v[152:155], v[112:115]
    v_mfma_f32_16x16x32_bf16 v[116:119], v[164:167], v[152:155], v[116:119]
    v_mfma_f32_16x16x32_bf16 v[124:127], v[164:167], v[156:159], v[124:127]
    v_mfma_f32_16x16x32_bf16 v[120:123], v[160:163], v[156:159], v[120:123]
    s_waitcnt lgkmcnt(0)
    s_barrier
    v_mfma_f32_16x16x32_bf16 v[64:67], v[200:203], v[168:171], v[64:67]
    ds_read_b128 v[160:163], v8 offset:0
    v_mfma_f32_16x16x32_bf16 v[68:71], v[204:207], v[168:171], v[68:71]
    ds_read_b128 v[164:167], v8 offset:2048
    v_mfma_f32_16x16x32_bf16 v[76:79], v[204:207], v[172:175], v[76:79]
    ds_read_b128 v[128:131], v4 offset:0
    v_mfma_f32_16x16x32_bf16 v[72:75], v[200:203], v[172:175], v[72:75]
    ds_read_b128 v[132:135], v4 offset:2048
    v_mfma_f32_16x16x32_bf16 v[80:83], v[200:203], v[176:179], v[80:83]
    ds_read_b128 v[136:139], v4 offset:4096
    v_mfma_f32_16x16x32_bf16 v[84:87], v[204:207], v[176:179], v[84:87]
    ds_read_b128 v[140:143], v4 offset:6144
    v_mfma_f32_16x16x32_bf16 v[92:95], v[204:207], v[180:183], v[92:95]
    ds_read_b128 v[144:147], v4 offset:8192
    v_mfma_f32_16x16x32_bf16 v[88:91], v[200:203], v[180:183], v[88:91]
    ds_read_b128 v[148:151], v4 offset:10240
    v_mfma_f32_16x16x32_bf16 v[96:99], v[200:203], v[184:187], v[96:99]
    ds_read_b128 v[152:155], v4 offset:12288
    v_mfma_f32_16x16x32_bf16 v[100:103], v[204:207], v[184:187], v[100:103]
    ds_read_b128 v[156:159], v4 offset:14336
    v_mfma_f32_16x16x32_bf16 v[108:111], v[204:207], v[188:191], v[108:111]
    v_mfma_f32_16x16x32_bf16 v[104:107], v[200:203], v[188:191], v[104:107]
    v_mfma_f32_16x16x32_bf16 v[112:115], v[200:203], v[192:195], v[112:115]
    v_mfma_f32_16x16x32_bf16 v[116:119], v[204:207], v[192:195], v[116:119]
    v_mfma_f32_16x16x32_bf16 v[124:127], v[204:207], v[196:199], v[124:127]
    v_mfma_f32_16x16x32_bf16 v[120:123], v[200:203], v[196:199], v[120:123]
    s_cmp_eq_u32 s34, 9
    s_waitcnt lgkmcnt(0)
    s_cbranch_scc1 C_x9
C_x9_r:
    v_mfma_f32_16x16x32_bf16 v[64:67], v[160:163], v[128:131], v[64:67]
    ds_read_b128 v[200:203], v10 offset:0
    v_mfma_f32_16x16x32_bf16 v[68:71], v[164:167], v[128:131], v[68:71]
    ds_read_b128 v[204:207], v10 offset:2048
    v_mfma_f32_16x16x32_bf16 v[76:79], v[164:167], v[132:135], v[76:79]
    ds_read_b128 v[168:171], v6 offset:0
    v_mfma_f32_16x16x32_bf16 v[72:75], v[160:163], v[132:135], v[72:75]
    ds_read_b128 v[172:175], v6 offset:2048
    v_mfma_f32_16x16x32_bf16 v[80:83], v[160:163], v[136:139], v[80:83]
    ds_read_b128 v[176:179], v6 offset:4096
    v_mfma_f32_16x16x32_bf16 v[84:87], v[164:167], v[136:139], v[84:87]
    ds_read_b128 v[180:183], v6 offset:6144
    v_mfma_f32_16x16x32_bf16 v[92:95], v[164:167], v[140:143], v[92:95]
    ds_read_b128 v[184:187], v6 offset:8192
    v_mfma_f32_16x16x32_bf16 v[88:91], v[160:163], v[140:143], v[88:91]
    ds_read_b128 v[188:191], v6 offset:10240
    v_mfma_f32_16x16x32_bf16 v[96:99], v[160:163], v[144:147], v[96:99]
    ds_read_b128 v[192:195], v6 offset:12288
    v_mfma_f32_16x16x32_bf16 v[100:103], v[164:167], v[144:147], v[100:103]
    ds_read_b128 v[196:199], v6 offset:14336
    v_mfma_f32_16x16x32_bf16 v[108:111], v[164:167], v[148:151], v[108:111]
    v_mfma_f32_16x16x32_bf16 v[104:107], v[160:163], v[148:151], v[104:107]
    v_mfma_f32_16x16x32_bf16 v[112:115], v[160:163], v[152:155], v[112:115]
    v_mfma_f32_16x16x32_bf16 v[116:119], v[164:167], v[152:155], v[116:119]
    v_mfma_f32_16x16x32_bf16 v[124:127], v[164:167], v[156:159], v[124:127]
    v_mfma_f32_16x16x32_bf16 v[120:123], v[160:163], v[156:159], v[120:123]
    s_waitcnt lgkmcnt(0)
    s_barrier
    v_mfma_f32_16x16x32_bf16 v[64:67], v[200:203], v[168:171], v[64:67]
    ds_read_b128 v[160:163], v8 offset:32768
    v_mfma_f32_16x16x32_bf16 v[68:71], v[204:207], v[168:171], v[68:71]
    ds_read_b128 v[164:167], v8 offset:34816
    v_mfma_f32_16x16x32_bf16 v[76:79], v[204:207], v[172:175], v[76:79]
    ds_read_b128 v[128:131], v4 offset:32768
    v_mfma_f32_16x16x32_bf16 v[72:75], v[200:203], v[172:175], v[72:75]
    ds_read_b128 v[132:135], v4 offset:34816
    v_mfma_f32_16x16x32_bf16 v[80:83], v[200:203], v[176:179], v[80:83]
    ds_read_b128 v[136:139], v4 offset:36864
    v_mfma_f32_16x16x32_bf16 v[84:87], v[204:207], v[176:179], v[84:87]
    ds_read_b128 v[140:143], v4 offset:38912
    v_mfma_f32_16x16x32_bf16 v[92:95], v[204:207], v[180:183], v[92:95]
    ds_read_b128 v[144:147], v4 offset:40960
    v_mfma_f32_16x16x32_bf16 v[88:91], v[200:203], v[180:183], v[88:91]
    ds_read_b128 v[148:151], v4 offset:43008
    v_mfma_f32_16x16x32_bf16 v[96:99], v[200:203], v[184:187], v[96:99]
    ds_read_b128 v[152:155], v4 offset:45056
    v_mfma_f32_16x16x32_bf16 v[100:103], v[204:207], v[184:187], v[100:103]
    ds_read_b128 v[156:159], v4 offset:47104
    v_mfma_f32_16x16x32_bf16 v[108:111], v[204:207], v[188:191], v[108:111]
    v_mfma_f32_16x16x32_bf16 v[104:107], v[200:203], v[188:191], v[104:107]
    v_mfma_f32_16x16x32_bf16 v[112:115], v[200:203], v[192:195], v[112:115]
    v_mfma_f32_16x16x32_bf16 v[116:119], v[204:207], v[192:195], v[116:119]
    v_mfma_f32_16x16x32_bf16 v[124:127], v[204:207], v[196:199], v[124:127]
    v_mfma_f32_16x16x32_bf16 v[120:123], v[200:203], v[196:199], v[120:123]
    s_cmp_eq_u32 s34, 10
    s_waitcnt lgkmcnt(0)
    s_cbranch_scc1 C_x10
C_x10_r:
    v_mfma_f32_16x16x32_bf16 v[64:67], v[160:163], v[128:131], v[64:67]
    ds_read_b128 v[200:203], v10 offset:32768
    v_mfma_f32_16x16x32_bf16 v[68:71], v[164:167], v[128:131], v[68:71]
    ds_read_b128 v[204:207], v10 offset:34816
    v_mfma_f32_16x16x32_bf16 v[76:79], v[164:167], v[132:135], v[76:79]
    ds_read_b128 v[168:171], v6 offset:32768
    v_mfma_f32_16x16x32_bf16 v[72:75], v[160:163], v[132:135], v[72:75]
    ds_read_b128 v[172:175], v6 offset:34816
    v_mfma_f32_16x16x32_bf16 v[80:83], v[160:163], v[136:139], v[80:83]
    ds_read_b128 v[176:179], v6 offset:36864
    v_mfma_f32_16x16x32_bf16 v[84:87], v[164:167], v[136:139], v[84:87]
    ds_read_b128 v[180:183], v6 offset:38912
    v_mfma_f32_16x16x32_bf16 v[92:95], v[164:167], v[140:143], v[92:95]
    ds_read_b128 v[184:187], v6 offset:40960
    v_mfma_f32_16x16x32_bf16 v[88:91], v[160:163], v[140:143], v[88:91]
    ds_read_b128 v[188:191], v6 offset:43008
    v_mfma_f32_16x16x32_bf16 v[96:99], v[160:163], v[144:147], v[96:99]
    ds_read_b128 v[192:195], v6 offset:45056
    v_mfma_f32_16x16x32_bf16 v[100:103], v[164:167], v[144:147], v[100:103]
    ds_read_b128 v[196:199], v6 offset:47104
    v_mfma_f32_16x16x32_bf16 v[108:111], v[164:167], v[148:151], v[108:111]
    v_mfma_f32_16x16x32_bf16 v[104:107], v[160:163], v[148:151], v[104:107]
    v_mfma_f32_16x16x32_bf16 v[112:115], v[160:163], v[152:155], v[112:115]
    v_mfma_f32_16x16x32_bf16 v[116:119], v[164:167], v[152:155], v[116:119]
    v_mfma_f32_16x16x32_bf16 v[124:127], v[164:167], v[156:159], v[124:127]
    v_mfma_f32_16x16x32_bf16 v[120:123], v[160:163], v[156:159], v[120:123]
    buffer_load_dwordx2 v[244:245], v246, s[72:75], s21 offen sc1
    s_waitcnt lgkmcnt(0)
    s_barrier
    v_mfma_f32_16x16x32_bf16 v[64:67], v[200:203], v[168:171], v[64:67]
    ds_read_b128 v[160:163], v9 offset:0
    v_mfma_f32_16x16x32_bf16 v[68:71], v[204:207], v[168:171], v[68:71]
    ds_read_b128 v[164:167], v9 offset:2048
    v_mfma_f32_16x16x32_bf16 v[76:79], v[204:207], v[172:175], v[76:79]
    ds_read_b128 v[128:131], v5 offset:0
    v_mfma_f32_16x16x32_bf16 v[72:75], v[200:203], v[172:175], v[72:75]
    ds_read_b128 v[132:135], v5 offset:2048
    v_mfma_f32_16x16x32_bf16 v[80:83], v[200:203], v[176:179], v[80:83]
    ds_read_b128 v[136:139], v5 offset:4096
    v_mfma_f32_16x16x32_bf16 v[84:87], v[204:207], v[176:179], v[84:87]
    ds_read_b128 v[140:143], v5 offset:6144
    v_mfma_f32_16x16x32_bf16 v[92:95], v[204:207], v[180:183], v[92:95]
    ds_read_b128 v[144:147], v5 offset:8192
    v_mfma_f32_16x16x32_bf16 v[88:91], v[200:203], v[180:183], v[88:91]
    ds_read_b128 v[148:151], v5 offset:10240
    v_mfma_f32_16x16x32_bf16 v[96:99], v[200:203], v[184:187], v[96:99]
    ds_read_b128 v[152:155], v5 offset:12288
    v_mfma_f32_16x16x32_bf16 v[100:103], v[204:207], v[184:187], v[100:103]
    ds_read_b128 v[156:159], v5 offset:14336
    v_mfma_f32_16x16x32_bf16 v[108:111], v[204:207], v[188:191], v[108:111]
    v_mfma_f32_16x16x32_bf16 v[104:107], v[200:203], v[188:191], v[104:107]
    v_mfma_f32_16x16x32_bf16 v[112:115], v[200:203], v[192:195], v[112:115]
    v_mfma_f32_16x16x32_bf16 v[116:119], v[204:207], v[192:195], v[116:119]
    v_mfma_f32_16x16x32_bf16 v[124:127], v[204:207], v[196:199], v[124:127]
    v_mfma_f32_16x16x32_bf16 v[120:123], v[200:203], v[196:199], v[120:123]
    s_cmp_eq_u32 s34, 11
    s_waitcnt lgkmcnt(0)
    s_cbranch_scc1 C_x11
C_x11_r:
    v_mfma_f32_16x16x32_bf16 v[64:67], v[160:163], v[128:131], v[64:67]
    ds_read_b128 v[200:203], v11 offset:0
    v_mfma_f32_16x16x32_bf16 v[68:71], v[164:167], v[128:131], v[68:71]
    ds_read_b128 v[204:207], v11 offset:2048
    v_mfma_f32_16x16x32_bf16 v[76:79], v[164:167], v[132:135], v[76:79]
    ds_read_b128 v[168:171], v7 offset:0
    v_mfma_f32_16x16x32_bf16 v[72:75], v[160:163], v[132:135], v[72:75]
    ds_read_b128 v[172:175], v7 offset:2048
    v_mfma_f32_16x16x32_bf16 v[80:83], v[160:163], v[136:139], v[80:83]
    ds_read_b128 v[176:179], v7 offset:4096
    v_mfma_f32_16x16x32_bf16 v[84:87], v[164:167], v[136:139], v[84:87]
    ds_read_b128 v[180:183], v7 offset:6144
    v_mfma_f32_16x16x32_bf16 v[92:95], v[164:167], v[140:143], v[92:95]
    ds_read_b128 v[184:187], v7 offset:8192
    v_mfma_f32_16x16x32_bf16 v[88:91], v[160:163], v[140:143], v[88:91]
    ds_read_b128 v[188:191], v7 offset:10240
    v_mfma_f32_16x16x32_bf16 v[96:99], v[160:163], v[144:147], v[96:99]
    ds_read_b128 v[192:195], v7 offset:12288
    v_mfma_f32_16x16x32_bf16 v[100:103], v[164:167], v[144:147], v[100:103]
    ds_read_b128 v[196:199], v7 offset:14336
    v_mfma_f32_16x16x32_bf16 v[108:111], v[164:167], v[148:151], v[108:111]
    v_mfma_f32_16x16x32_bf16 v[104:107], v[160:163], v[148:151], v[104:107]
    v_mfma_f32_16x16x32_bf16 v[112:115], v[160:163], v[152:155], v[112:115]
    v_mfma_f32_16x16x32_bf16 v[116:119], v[164:167], v[152:155], v[116:119]
    v_mfma_f32_16x16x32_bf16 v[124:127], v[164:167], v[156:159], v[124:127]
    v_mfma_f32_16x16x32_bf16 v[120:123], v[160:163], v[156:159], v[120:123]
    s_waitcnt lgkmcnt(0)
    s_barrier
    v_mfma_f32_16x16x32_bf16 v[64:67], v[200:203], v[168:171], v[64:67]
    ds_read_b128 v[160:163], v9 offset:32768
    v_mfma_f32_16x16x32_bf16 v[68:71], v[204:207], v[168:171], v[68:71]
    ds_read_b128 v[164:167], v9 offset:34816
    v_mfma_f32_16x16x32_bf16 v[76:79], v[204:207], v[172:175], v[76:79]
    ds_read_b128 v[128:131], v5 offset:32768
    v_mfma_f32_16x16x32_bf16 v[72:75], v[200:203], v[172:175], v[72:75]
    ds_read_b128 v[132:135], v5 offset:34816
    v_mfma_f32_16x16x32_bf16 v[80:83], v[200:203], v[176:179], v[80:83]
    ds_read_b128 v[136:139], v5 offset:36864
    v_mfma_f32_16x16x32_bf16 v[84:87], v[204:207], v[176:179], v[84:87]
    ds_read_b128 v[140:143], v5 offset:38912
    v_mfma_f32_16x16x32_bf16 v[92:95], v[204:207], v[180:183], v[92:95]
    ds_read_b128 v[144:147], v5 offset:40960
    v_mfma_f32_16x16x32_bf16 v[88:91], v[200:203], v[180:183], v[88:91]
    ds_read_b128 v[148:151], v5 offset:43008
    v_mfma_f32_16x16x32_bf16 v[96:99], v[200:203], v[184:187], v[96:99]
    ds_read_b128 v[152:155], v5 offset:45056
    v_mfma_f32_16x16x32_bf16 v[100:103], v[204:207], v[184:187], v[100:103]
    ds_read_b128 v[156:159], v5 offset:47104
    v_mfma_f32_16x16x32_bf16 v[108:111], v[204:207], v[188:191], v[108:111]
    v_mfma_f32_16x16x32_bf16 v[104:107], v[200:203], v[188:191], v[104:107]
    v_mfma_f32_16x16x32_bf16 v[112:115], v[200:203], v[192:195], v[112:115]
    v_mfma_f32_16x16x32_bf16 v[116:119], v[204:207], v[192:195], v[116:119]
    v_mfma_f32_16x16x32_bf16 v[124:127], v[204:207], v[196:199], v[124:127]
    v_mfma_f32_16x16x32_bf16 v[120:123], v[200:203], v[196:199], v[120:123]
    s_cmp_eq_u32 s34, 12
    s_waitcnt lgkmcnt(0)
    s_cbranch_scc1 C_x12
C_x12_r:
    v_mfma_f32_16x16x32_bf16 v[64:67], v[160:163], v[128:131], v[64:67]
    ds_read_b128 v[200:203], v11 offset:32768
    v_mfma_f32_16x16x32_bf16 v[68:71], v[164:167], v[128:131], v[68:71]
    ds_read_b128 v[204:207], v11 offset:34816
    v_mfma_f32_16x16x32_bf16 v[76:79], v[164:167], v[132:135], v[76:79]
    ds_read_b128 v[168:171], v7 offset:32768
    v_mfma_f32_16x16x32_bf16 v[72:75], v[160:163], v[132:135], v[72:75]
    ds_read_b128 v[172:175], v7 offset:34816
    v_mfma_f32_16x16x32_bf16 v[80:83], v[160:163], v[136:139], v[80:83]
    ds_read_b128 v[176:179], v7 offset:36864
    v_mfma_f32_16x16x32_bf16 v[84:87], v[164:167], v[136:139], v[84:87]
    ds_read_b128 v[180:183], v7 offset:38912
    v_mfma_f32_16x16x32_bf16 v[92:95], v[164:167], v[140:143], v[92:95]
    ds_read_b128 v[184:187], v7 offset:40960
    v_mfma_f32_16x16x32_bf16 v[88:91], v[160:163], v[140:143], v[88:91]
    ds_read_b128 v[188:191], v7 offset:43008
    v_mfma_f32_16x16x32_bf16 v[96:99], v[160:163], v[144:147], v[96:99]
    ds_read_b128 v[192:195], v7 offset:45056
    v_mfma_f32_16x16x32_bf16 v[100:103], v[164:167], v[144:147], v[100:103]
    ds_read_b128 v[196:199], v7 offset:47104
    v_mfma_f32_16x16x32_bf16 v[108:111], v[164:167], v[148:151], v[108:111]
    v_mfma_f32_16x16x32_bf16 v[104:107], v[160:163], v[148:151], v[104:107]
    v_mfma_f32_16x16x32_bf16 v[112:115], v[160:163], v[152:155], v[112:115]
    v_mfma_f32_16x16x32_bf16 v[116:119], v[164:167], v[152:155], v[116:119]
    v_mfma_f32_16x16x32_bf16 v[124:127], v[164:167], v[156:159], v[124:127]
    v_mfma_f32_16x16x32_bf16 v[120:123], v[160:163], v[156:159], v[120:123]
    s_waitcnt lgkmcnt(0)
    s_barrier
    v_mfma_f32_16x16x32_bf16 v[64:67], v[200:203], v[168:171], v[64:67]
    ds_read_b128 v[160:163], v8 offset:0
    v_mfma_f32_16x16x32_bf16 v[68:71], v[204:207], v[168:171], v[68:71]
    ds_read_b128 v[164:167], v8 offset:2048
    v_mfma_f32_16x16x32_bf16 v[76:79], v[204:207], v[172:175], v[76:79]
    ds_read_b128 v[128:131], v4 offset:0
    v_mfma_f32_16x16x32_bf16 v[72:75], v[200:203], v[172:175], v[72:75]
    ds_read_b128 v[132:135], v4 offset:2048
    v_mfma_f32_16x16x32_bf16 v[80:83], v[200:203], v[176:179], v[80:83]
    ds_read_b128 v[136:139], v4 offset:4096
    v_mfma_f32_16x16x32_bf16 v[84:87], v[204:207], v[176:179], v[84:87]
    ds_read_b128 v[140:143], v4 offset:6144
    v_mfma_f32_16x16x32_bf16 v[92:95], v[204:207], v[180:183], v[92:95]
    ds_read_b128 v[144:147], v4 offset:8192
    v_mfma_f32_16x16x32_bf16 v[88:91], v[200:203], v[180:183], v[88:91]
    ds_read_b128 v[148:151], v4 offset:10240
    v_mfma_f32_16x16x32_bf16 v[96:99], v[200:203], v[184:187], v[96:99]
    ds_read_b128 v[152:155], v4 offset:12288
    v_mfma_f32_16x16x32_bf16 v[100:103], v[204:207], v[184:187], v[100:103]
    ds_read_b128 v[156:159], v4 offset:14336
    v_mfma_f32_16x16x32_bf16 v[108:111], v[204:207], v[188:191], v[108:111]
    v_mfma_f32_16x16x32_bf16 v[104:107], v[200:203], v[188:191], v[104:107]
    v_mfma_f32_16x16x32_bf16 v[112:115], v[200:203], v[192:195], v[112:115]
    v_mfma_f32_16x16x32_bf16 v[116:119], v[204:207], v[192:195], v[116:119]
    v_mfma_f32_16x16x32_bf16 v[124:127], v[204:207], v[196:199], v[124:127]
    v_mfma_f32_16x16x32_bf16 v[120:123], v[200:203], v[196:199], v[120:123]
    s_cmp_eq_u32 s34, 13
    s_waitcnt lgkmcnt(0)
    s_cbranch_scc1 C_x13
C_x13_r:
    s_waitcnt vmcnt(0)
    v_cmp_eq_u32 vcc, v244, v54
    v_cmp_eq_u32 s[54:55], v245, v55
    s_mov_b32 m0, s23
    s_and_b64 s[54:55], s[54:55], vcc
    s_cmp_eq_u64 s[54:55], -1
    s_cbranch_scc0 C_kvp
C_kvp_r:
    buffer_load_dwordx4 v247, s[68:71], s22 offen offset:0 sc1 lds
    buffer_load_dwordx4 v247, s[68:71], s22 offen offset:1024 sc1 lds
    buffer_load_dwordx4 v247, s[68:71], s22 offen offset:2048 sc1 lds
    buffer_load_dwordx4 v247, s[68:71], s22 offen offset:3072 sc1 lds
    v_mfma_f32_16x16x32_bf16 v[64:67], v[160:163], v[128:131], v[64:67]
    ds_read_b128 v[200:203], v10 offset:0
    v_mfma_f32_16x16x32_bf16 v[68:71], v[164:167], v[128:131], v[68:71]
    ds_read_b128 v[204:207], v10 offset:2048
    v_mfma_f32_16x16x32_bf16 v[76:79], v[164:167], v[132:135], v[76:79]
    ds_read_b128 v[168:171], v6 offset:0
    v_mfma_f32_16x16x32_bf16 v[72:75], v[160:163], v[132:135], v[72:75]
    ds_read_b128 v[172:175], v6 offset:2048
    v_mfma_f32_16x16x32_bf16 v[80:83], v[160:163], v[136:139], v[80:83]
    ds_read_b128 v[176:179], v6 offset:4096
    v_mfma_f32_16x16x32_bf16 v[84:87], v[164:167], v[136:139], v[84:87]
    ds_read_b128 v[180:183], v6 offset:6144
    v_mfma_f32_16x16x32_bf16 v[92:95], v[164:167], v[140:143], v[92:95]
    ds_read_b128 v[184:187], v6 offset:8192
    v_mfma_f32_16x16x32_bf16 v[88:91], v[160:163], v[140:143], v[88:91]
    ds_read_b128 v[188:191], v6 offset:10240
    v_mfma_f32_16x16x32_bf16 v[96:99], v[160:163], v[144:147], v[96:99]
    ds_read_b128 v[192:195], v6 offset:12288
    v_mfma_f32_16x16x32_bf16 v[100:103], v[164:167], v[144:147], v[100:103]
    ds_read_b128 v[196:199], v6 offset:14336
    v_mfma_f32_16x16x32_bf16 v[108:111], v[164:167], v[148:151], v[108:111]
    v_mfma_f32_16x16x32_bf16 v[104:107], v[160:163], v[148:151], v[104:107]
    v_mfma_f32_16x16x32_bf16 v[112:115], v[160:163], v[152:155], v[112:115]
    v_mfma_f32_16x16x32_bf16 v[116:119], v[164:167], v[152:155], v[116:119]
    v_mfma_f32_16x16x32_bf16 v[124:127], v[164:167], v[156:159], v[124:127]
    v_mfma_f32_16x16x32_bf16 v[120:123], v[160:163], v[156:159], v[120:123]
    s_waitcnt lgkmcnt(0)
    s_barrier
    v_mfma_f32_16x16x32_bf16 v[64:67], v[200:203], v[168:171], v[64:67]
    ds_read_b128 v[160:163], v8 offset:32768
    v_mfma_f32_16x16x32_bf16 v[68:71], v[204:207], v[168:171], v[68:71]
    ds_read_b128 v[164:167], v8 offset:34816
    v_mfma_f32_16x16x32_bf16 v[76:79], v[204:207], v[172:175], v[76:79]
    ds_read_b128 v[128:131], v4 offset:32768
    v_mfma_f32_16x16x32_bf16 v[72:75], v[200:203], v[172:175], v[72:75]
    ds_read_b128 v[132:135], v4 offset:34816
    v_mfma_f32_16x16x32_bf16 v[80:83], v[200:203], v[176:179], v[80:83]
    ds_read_b128 v[136:139], v4 offset:36864
    v_mfma_f32_16x16x32_bf16 v[84:87], v[204:207], v[176:179], v[84:87]
    ds_read_b128 v[140:143], v4 offset:38912
    v_mfma_f32_16x16x32_bf16 v[92:95], v[204:207], v[180:183], v[92:95]
    ds_read_b128 v[144:147], v4 offset:40960
    v_mfma_f32_16x16x32_bf16 v[88:91], v[200:203], v[180:183], v[88:91]
    ds_read_b128 v[148:151], v4 offset:43008
    v_mfma_f32_16x16x32_bf16 v[96:99], v[200:203], v[184:187], v[96:99]
    ds_read_b128 v[152:155], v4 offset:45056
    v_mfma_f32_16x16x32_bf16 v[100:103], v[204:207], v[184:187], v[100:103]
    ds_read_b128 v[156:159], v4 offset:47104
    v_mfma_f32_16x16x32_bf16 v[108:111], v[204:207], v[188:191], v[108:111]
    v_mfma_f32_16x16x32_bf16 v[104:107], v[200:203], v[188:191], v[104:107]
    v_mfma_f32_16x16x32_bf16 v[112:115], v[200:203], v[192:195], v[112:115]
    v_mfma_f32_16x16x32_bf16 v[116:119], v[204:207], v[192:195], v[116:119]
    v_mfma_f32_16x16x32_bf16 v[124:127], v[204:207], v[196:199], v[124:127]
    v_mfma_f32_16x16x32_bf16 v[120:123], v[200:203], v[196:199], v[120:123]
    s_cmp_eq_u32 s34, 14
    s_waitcnt lgkmcnt(0)
    s_cbranch_scc1 C_x14
C_x14_r:
    v_mfma_f32_16x16x32_bf16 v[64:67], v[160:163], v[128:131], v[64:67]
    ds_read_b128 v[200:203], v10 offset:32768
    v_mfma_f32_16x16x32_bf16 v[68:71], v[164:167], v[128:131], v[68:71]
    ds_read_b128 v[204:207], v10 offset:34816
    v_mfma_f32_16x16x32_bf16 v[76:79], v[164:167], v[132:135], v[76:79]
    ds_read_b128 v[168:171], v6 offset:32768
    v_mfma_f32_16x16x32_bf16 v[72:75], v[160:163], v[132:135], v[72:75]
    ds_read_b128 v[172:175], v6 offset:34816
    v_mfma_f32_16x16x32_bf16 v[80:83], v[160:163], v[136:139], v[80:83]
    ds_read_b128 v[176:179], v6 offset:36864
    v_mfma_f32_16x16x32_bf16 v[84:87], v[164:167], v[136:139], v[84:87]
    ds_read_b128 v[180:183], v6 offset:38912
    v_mfma_f32_16x16x32_bf16 v[92:95], v[164:167], v[140:143], v[92:95]
    ds_read_b128 v[184:187], v6 offset:40960
    v_mfma_f32_16x16x32_bf16 v[88:91], v[160:163], v[140:143], v[88:91]
    ds_read_b128 v[188:191], v6 offset:43008
    v_mfma_f32_16x16x32_bf16 v[96:99], v[160:163], v[144:147], v[96:99]
    ds_read_b128 v[192:195], v6 offset:45056
    v_mfma_f32_16x16x32_bf16 v[100:103], v[164:167], v[144:147], v[100:103]
    ds_read_b128 v[196:199], v6 offset:47104
    v_mfma_f32_16x16x32_bf16 v[108:111], v[164:167], v[148:151], v[108:111]
    v_mfma_f32_16x16x32_bf16 v[104:107], v[160:163], v[148:151], v[104:107]
    v_mfma_f32_16x16x32_bf16 v[112:115], v[160:163], v[152:155], v[112:115]
    v_mfma_f32_16x16x32_bf16 v[116:119], v[164:167], v[152:155], v[116:119]
    v_mfma_f32_16x16x32_bf16 v[124:127], v[164:167], v[156:159], v[124:127]
    v_mfma_f32_16x16x32_bf16 v[120:123], v[160:163], v[156:159], v[120:123]
    s_waitcnt lgkmcnt(0)
    s_barrier
    v_mfma_f32_16x16x32_bf16 v[64:67], v[200:203], v[168:171], v[64:67]
    ds_read_b128 v[160:163], v9 offset:0
    v_mfma_f32_16x16x32_bf16 v[68:71], v[204:207], v[168:171], v[68:71]
    ds_read_b128 v[164:167], v9 offset:2048
    v_mfma_f32_16x16x32_bf16 v[76:79], v[204:207], v[172:175], v[76:79]
    ds_read_b128 v[128:131], v5 offset:0
    v_mfma_f32_16x16x32_bf16 v[72:75], v[200:203], v[172:175], v[72:75]
    ds_read_b128 v[132:135], v5 offset:2048
    v_mfma_f32_16x16x32_bf16 v[80:83], v[200:203], v[176:179], v[80:83]
    ds_read_b128 v[136:139], v5 offset:4096
    v_mfma_f32_16x16x32_bf16 v[84:87], v[204:207], v[176:179], v[84:87]
    ds_read_b128 v[140:143], v5 offset:6144
    v_mfma_f32_16x16x32_bf16 v[92:95], v[204:207], v[180:183], v[92:95]
    ds_read_b128 v[144:147], v5 offset:8192
    v_mfma_f32_16x16x32_bf16 v[88:91], v[200:203], v[180:183], v[88:91]
    ds_read_b128 v[148:151], v5 offset:10240
    v_mfma_f32_16x16x32_bf16 v[96:99], v[200:203], v[184:187], v[96:99]
    ds_read_b128 v[152:155], v5 offset:12288
    v_mfma_f32_16x16x32_bf16 v[100:103], v[204:207], v[184:187], v[100:103]
    ds_read_b128 v[156:159], v5 offset:14336
    v_mfma_f32_16x16x32_bf16 v[108:111], v[204:207], v[188:191], v[108:111]
    v_mfma_f32_16x16x32_bf16 v[104:107], v[200:203], v[188:191], v[104:107]
    v_mfma_f32_16x16x32_bf16 v[112:115], v[200:203], v[192:195], v[112:115]
    v_mfma_f32_16x16x32_bf16 v[116:119], v[204:207], v[192:195], v[116:119]
    v_mfma_f32_16x16x32_bf16 v[124:127], v[204:207], v[196:199], v[124:127]
    v_mfma_f32_16x16x32_bf16 v[120:123], v[200:203], v[196:199], v[120:123]
    s_cmp_eq_u32 s34, 15
    s_waitcnt lgkmcnt(0)
    s_cbranch_scc1 C_x15
C_x15_r:
    v_mfma_f32_16x16x32_bf16 v[64:67], v[160:163], v[128:131], v[64:67]
    ds_read_b128 v[200:203], v11 offset:0
    v_mfma_f32_16x16x32_bf16 v[68:71], v[164:167], v[128:131], v[68:71]
    ds_read_b128 v[204:207], v11 offset:2048
    v_mfma_f32_16x16x32_bf16 v[76:79], v[164:167], v[132:135], v[76:79]
    ds_read_b128 v[168:171], v7 offset:0
    v_mfma_f32_16x16x32_bf16 v[72:75], v[160:163], v[132:135], v[72:75]
    ds_read_b128 v[172:175], v7 offset:2048
    v_mfma_f32_16x16x32_bf16 v[80:83], v[160:163], v[136:139], v[80:83]
    ds_read_b128 v[176:179], v7 offset:4096
    v_mfma_f32_16x16x32_bf16 v[84:87], v[164:167], v[136:139], v[84:87]
    ds_read_b128 v[180:183], v7 offset:6144
    v_mfma_f32_16x16x32_bf16 v[92:95], v[164:167], v[140:143], v[92:95]
    ds_read_b128 v[184:187], v7 offset:8192
    v_mfma_f32_16x16x32_bf16 v[88:91], v[160:163], v[140:143], v[88:91]
    ds_read_b128 v[188:191], v7 offset:10240
    v_mfma_f32_16x16x32_bf16 v[96:99], v[160:163], v[144:147], v[96:99]
    ds_read_b128 v[192:195], v7 offset:12288
    v_mfma_f32_16x16x32_bf16 v[100:103], v[164:167], v[144:147], v[100:103]
    ds_read_b128 v[196:199], v7 offset:14336
    v_mfma_f32_16x16x32_bf16 v[108:111], v[164:167], v[148:151], v[108:111]
    v_mfma_f32_16x16x32_bf16 v[104:107], v[160:163], v[148:151], v[104:107]
    v_mfma_f32_16x16x32_bf16 v[112:115], v[160:163], v[152:155], v[112:115]
    v_mfma_f32_16x16x32_bf16 v[116:119], v[164:167], v[152:155], v[116:119]
    v_mfma_f32_16x16x32_bf16 v[124:127], v[164:167], v[156:159], v[124:127]
    v_mfma_f32_16x16x32_bf16 v[120:123], v[160:163], v[156:159], v[120:123]
    s_waitcnt vmcnt(0)
    s_waitcnt lgkmcnt(0)
    v_mov_b32 v3, 1
    v_mov_b32 v15, 2
    ds_write_b32 v63, v3 offset:64
    ds_write_b32 v63, v54 offset:16
    v_mfma_f32_16x16x32_bf16 v[64:67], v[200:203], v[168:171], v[64:67]
    v_mfma_f32_16x16x32_bf16 v[68:71], v[204:207], v[168:171], v[68:71]
    v_mfma_f32_16x16x32_bf16 v[76:79], v[204:207], v[172:175], v[76:79]
    v_mfma_f32_16x16x32_bf16 v[72:75], v[200:203], v[172:175], v[72:75]
    v_mfma_f32_16x16x32_bf16 v[80:83], v[200:203], v[176:179], v[80:83]
    v_mfma_f32_16x16x32_bf16 v[84:87], v[204:207], v[176:179], v[84:87]
    v_mfma_f32_16x16x32_bf16 v[92:95], v[204:207], v[180:183], v[92:95]
    v_mfma_f32_16x16x32_bf16 v[88:91], v[200:203], v[180:183], v[88:91]
    v_mfma_f32_16x16x32_bf16 v[96:99], v[200:203], v[184:187], v[96:99]
    v_mfma_f32_16x16x32_bf16 v[100:103], v[204:207], v[184:187], v[100:103]
    v_mfma_f32_16x16x32_bf16 v[108:111], v[204:207], v[188:191], v[108:111]
    v_mfma_f32_16x16x32_bf16 v[104:107], v[200:203], v[188:191], v[104:107]
    v_mfma_f32_16x16x32_bf16 v[112:115], v[200:203], v[192:195], v[112:115]
    v_mfma_f32_16x16x32_bf16 v[116:119], v[204:207], v[192:195], v[116:119]
    v_mfma_f32_16x16x32_bf16 v[124:127], v[204:207], v[196:199], v[124:127]
    v_mfma_f32_16x16x32_bf16 v[120:123], v[200:203], v[196:199], v[120:123]
    s_nop 3
    v_pk_fma_f32 v[136:137], v[16:17], v[64:65], v[72:73]
    v_pk_fma_f32 v[140:141], v[16:17], v[68:69], v[76:77]
    v_pk_fma_f32 v[138:139], v[18:19], v[66:67], v[74:75]
    v_pk_fma_f32 v[142:143], v[18:19], v[70:71], v[78:79]
    v_pk_fma_f32 v[136:137], v[20:21], v[68:69], v[136:137] neg_lo:[1,0,0] neg_hi:[1,0,0]
    v_pk_fma_f32 v[140:141], v[20:21], v[64:65], v[140:141]
    v_pk_fma_f32 v[138:139], v[22:23], v[70:71], v[138:139] neg_lo:[1,0,0] neg_hi:[1,0,0]
    v_pk_fma_f32 v[142:143], v[22:23], v[66:67], v[142:143]
    v_pk_fma_f32 v[128:129], v[16:17], v[136:137], v[80:81]
    v_pk_fma_f32 v[132:133], v[16:17], v[140:141], v[84:85]
    v_pk_fma_f32 v[130:131], v[18:19], v[138:139], v[82:83]
    v_pk_fma_f32 v[134:135], v[18:19], v[142:143], v[86:87]
    v_pk_fma_f32 v[128:129], v[20:21], v[140:141], v[128:129] neg_lo:[1,0,0] neg_hi:[1,0,0]
    v_pk_fma_f32 v[132:133], v[20:21], v[136:137], v[132:133]
    v_pk_fma_f32 v[130:131], v[22:23], v[142:143], v[130:131] neg_lo:[1,0,0] neg_hi:[1,0,0]
    v_pk_fma_f32 v[134:135], v[22:23], v[138:139], v[134:135]
    v_pk_fma_f32 v[136:137], v[16:17], v[128:129], v[88:89]
    v_pk_fma_f32 v[140:141], v[16:17], v[132:133], v[92:93]
    v_pk_fma_f32 v[138:139], v[18:19], v[130:131], v[90:91]
    v_pk_fma_f32 v[142:143], v[18:19], v[134:135], v[94:95]
    v_pk_fma_f32 v[136:137], v[20:21], v[132:133], v[136:137] neg_lo:[1,0,0] neg_hi:[1,0,0]
    v_pk_fma_f32 v[140:141], v[20:21], v[128:129], v[140:141]
    v_pk_fma_f32 v[138:139], v[22:23], v[134:135], v[138:139] neg_lo:[1,0,0] neg_hi:[1,0,0]
    v_pk_fma_f32 v[142:143], v[22:23], v[130:131], v[142:143]
    v_pk_fma_f32 v[128:129], v[16:17], v[136:137], v[96:97]
    v_pk_fma_f32 v[132:133], v[16:17], v[140:141], v[100:101]
    v_pk_fma_f32 v[130:131], v[18:19], v[138:139], v[98:99]
    v_pk_fma_f32 v[134:135], v[18:19], v[142:143], v[102:103]
    v_pk_fma_f32 v[128:129], v[20:21], v[140:141], v[128:129] neg_lo:[1,0,0] neg_hi:[1,0,0]
    v_pk_fma_f32 v[132:133], v[20:21], v[136:137], v[132:133]
    v_pk_fma_f32 v[130:131], v[22:23], v[142:143], v[130:131] neg_lo:[1,0,0] neg_hi:[1,0,0]
    v_pk_fma_f32 v[134:135], v[22:23], v[138:139], v[134:135]
    v_pk_fma_f32 v[136:137], v[16:17], v[128:129], v[104:105]
    v_pk_fma_f32 v[140:141], v[16:17], v[132:133], v[108:109]
    v_pk_fma_f32 v[138:139], v[18:19], v[130:131], v[106:107]
    v_pk_fma_f32 v[142:143], v[18:19], v[134:135], v[110:111]
    v_pk_fma_f32 v[136:137], v[20:21], v[132:133], v[136:137] neg_lo:[1,0,0] neg_hi:[1,0,0]
    v_pk_fma_f32 v[140:141], v[20:21], v[128:129], v[140:141]
    v_pk_fma_f32 v[138:139], v[22:23], v[134:135], v[138:139] neg_lo:[1,0,0] neg_hi:[1,0,0]
    v_pk_fma_f32 v[142:143], v[22:23], v[130:131], v[142:143]
    v_pk_fma_f32 v[128:129], v[16:17], v[136:137], v[112:113]
    v_pk_fma_f32 v[132:133], v[16:17], v[140:141], v[116:117]
    v_pk_fma_f32 v[130:131], v[18:19], v[138:139], v[114:115]
    v_pk_fma_f32 v[134:135], v[18:19], v[142:143], v[118:119]
    v_pk_fma_f32 v[128:129], v[20:21], v[140:141], v[128:129] neg_lo:[1,0,0] neg_hi:[1,0,0]
    v_pk_fma_f32 v[132:133], v[20:21], v[136:137], v[132:133]
    v_pk_fma_f32 v[130:131], v[22:23], v[142:143], v[130:131] neg_lo:[1,0,0] neg_hi:[1,0,0]
    v_pk_fma_f32 v[134:135], v[22:23], v[138:139], v[134:135]
    v_pk_fma_f32 v[136:137], v[16:17], v[128:129], v[120:121]
    v_pk_fma_f32 v[140:141], v[16:17], v[132:133], v[124:125]
    v_pk_fma_f32 v[138:139], v[18:19], v[130:131], v[122:123]
    v_pk_fma_f32 v[142:143], v[18:19], v[134:135], v[126:127]
    v_pk_fma_f32 v[136:137], v[20:21], v[132:133], v[136:137] neg_lo:[1,0,0] neg_hi:[1,0,0]
    v_pk_fma_f32 v[140:141], v[20:21], v[128:129], v[140:141]
    v_pk_fma_f32 v[138:139], v[22:23], v[134:135], v[138:139] neg_lo:[1,0,0] neg_hi:[1,0,0]
    v_pk_fma_f32 v[142:143], v[22:23], v[130:131], v[142:143]
    v_mul_f32_dpp v144, v32, v136 row_mirror row_mask:0xf bank_mask:0xf
    v_mul_f32_dpp v148, v32, v140 row_mirror row_mask:0xf bank_mask:0xf
    v_mul_f32_dpp v145, v33, v137 row_mirror row_mask:0xf bank_mask:0xf
    v_mul_f32_dpp v149, v33, v141 row_mirror row_mask:0xf bank_mask:0xf
    v_mul_f32_dpp v146, v34, v138 row_mirror row_mask:0xf bank_mask:0xf
    v_mul_f32_dpp v150, v34, v142 row_mirror row_mask:0xf bank_mask:0xf
    v_mul_f32_dpp v147, v35, v139 row_mirror row_mask:0xf bank_mask:0xf
    v_mul_f32_dpp v151, v35, v143 row_mirror row_mask:0xf bank_mask:0xf
    v_fmac_f32_dpp v144, -v36, v140 row_mirror row_mask:0xf bank_mask:0xf
    v_fmac_f32_dpp v148, v36, v136 row_mirror row_mask:0xf bank_mask:0xf
    v_fmac_f32_dpp v145, -v37, v141 row_mirror row_mask:0xf bank_mask:0xf
    v_fmac_f32_dpp v149, v37, v137 row_mirror row_mask:0xf bank_mask:0xf
    v_fmac_f32_dpp v146, -v38, v142 row_mirror row_mask:0xf bank_mask:0xf
    v_fmac_f32_dpp v150, v38, v138 row_mirror row_mask:0xf bank_mask:0xf
    v_fmac_f32_dpp v147, -v39, v143 row_mirror row_mask:0xf bank_mask:0xf
    v_fmac_f32_dpp v151, v39, v139 row_mirror row_mask:0xf bank_mask:0xf
    v_add_f32_dpp v144, v144, v144 quad_perm:[1,0,3,2] row_mask:0xf bank_mask:0xf
    v_add_f32_dpp v148, v148, v148 quad_perm:[1,0,3,2] row_mask:0xf bank_mask:0xf
    v_add_f32_dpp v145, v145, v145 quad_perm:[1,0,3,2] row_mask:0xf bank_mask:0xf
    v_add_f32_dpp v149, v149, v149 quad_perm:[1,0,3,2] row_mask:0xf bank_mask:0xf
    v_add_f32_dpp v146, v146, v146 quad_perm:[1,0,3,2] row_mask:0xf bank_mask:0xf
    v_add_f32_dpp v150, v150, v150 quad_perm:[1,0,3,2] row_mask:0xf bank_mask:0xf
    v_add_f32_dpp v147, v147, v147 quad_perm:[1,0,3,2] row_mask:0xf bank_mask:0xf
    v_add_f32_dpp v151, v151, v151 quad_perm:[1,0,3,2] row_mask:0xf bank_mask:0xf
    v_cndmask_b32 v44, v144, v145, s[48:49]
    v_cndmask_b32 v45, v146, v147, s[48:49]
    v_cndmask_b32 v46, v148, v149, s[48:49]
    v_cndmask_b32 v47, v150, v151, s[48:49]
    s_nop 0
    v_add_f32_dpp v44, v44, v44 quad_perm:[2,3,0,1] row_mask:0xf bank_mask:0xf
    v_add_f32_dpp v45, v45, v45 quad_perm:[2,3,0,1] row_mask:0xf bank_mask:0xf
    v_add_f32_dpp v46, v46, v46 quad_perm:[2,3,0,1] row_mask:0xf bank_mask:0xf
    v_add_f32_dpp v47, v47, v47 quad_perm:[2,3,0,1] row_mask:0xf bank_mask:0xf
    v_cndmask_b32 v52, v44, v45, s[50:51]
    v_cndmask_b32 v53, v46, v47, s[50:51]
    s_nop 0
    v_add_f32_dpp v52, v52, v52 row_ror:4 row_mask:0xf bank_mask:0xf
    v_add_f32_dpp v53, v53, v53 row_ror:4 row_mask:0xf bank_mask:0xf
    s_nop 0
    v_add_f32_dpp v52, v52, v52 row_ror:8 row_mask:0xf bank_mask:0xf
    v_add_f32_dpp v53, v53, v53 row_ror:8 row_mask:0xf bank_mask:0xf
    s_mov_b64 exec, s[52:53]
    buffer_store_dwordx4 v[52:55], v60, s[12:15], 0 offen sc1
    s_mov_b64 exec, -1
    ds_write_b32 v63, v15 offset:64
    s_and_b32 s7, s3, 0
    s_add_u32 s7, s7, s4
    s_and_b32 s36, s7, 15
    v_lshrrev_b32 v1, 3, v2
    v_and_b32 v44, 7, v2
    v_xor_b32 v44, v44, v13
    v_lshlrev_b32 v44, 4, v44
    v_lshl_add_u32 v44, v1, 13, v44
    s_lshl_b32 s7, s4, 6
    s_add_u32 s7, s7, s5
    s_lshl_b32 s7, s7, 11
    v_add_u32 v244, s7, v44
    v_xor_b32 v245, 64, v244
    v_add_u32 v245, 64512, v245
    v_xor_b32 v246, 32, v244
    v_xor_b32 v247, 32, v245
    s_lshl_b32 s20, s36, 7
    s_and_b32 s22, s20, 1024
    s_xor_b32 s23, s22, 1024
    s_lshl_b32 s21, s5, 11
    s_add_u32 s7, s20, 768
    s_and_b32 s7, s7, 1023
    s_or_b32 s7, s7, s22
    buffer_load_dwordx4 v[160:163], v244, s[24:27], s7 offen offset:0
    buffer_load_dwordx4 v[164:167], v245, s[24:27], s7 offen offset:1024
    buffer_load_dwordx4 v[168:171], v246, s[80:83], s7 offen offset:0
    buffer_load_dwordx4 v[172:175], v247, s[80:83], s7 offen offset:1024
    s_add_u32 s7, s20, 896
    s_and_b32 s7, s7, 1023
    s_or_b32 s7, s7, s22
    buffer_load_dwordx4 v[176:179], v244, s[24:27], s7 offen offset:0
    buffer_load_dwordx4 v[180:183], v245, s[24:27], s7 offen offset:1024
    buffer_load_dwordx4 v[184:187], v246, s[80:83], s7 offen offset:0
    buffer_load_dwordx4 v[188:191], v247, s[80:83], s7 offen offset:1024
    s_add_u32 s7, s20, 1024
    s_and_b32 s7, s7, 1023
    s_or_b32 s7, s7, s23
    buffer_load_dwordx4 v[192:195], v244, s[24:27], s7 offen offset:0
    buffer_load_dwordx4 v[196:199], v245, s[24:27], s7 offen offset:1024
    buffer_load_dwordx4 v[200:203], v246, s[80:83], s7 offen offset:0
    buffer_load_dwordx4 v[204:207], v247, s[80:83], s7 offen offset:1024
    s_add_u32 s7, s20, 1152
    s_and_b32 s7, s7, 1023
    s_or_b32 s7, s7, s23
    buffer_load_dwordx4 v[224:227], v244, s[24:27], s7 offen offset:0
    buffer_load_dwordx4 v[228:231], v245, s[24:27], s7 offen offset:1024
    buffer_load_dwordx4 v[232:235], v246, s[80:83], s7 offen offset:0
    buffer_load_dwordx4 v[236:239], v247, s[80:83], s7 offen offset:1024
    v_mov_b32_dpp v128, v136 row_shr:1 row_mask:0xf bank_mask:0xf bound_ctrl:0
    v_mov_b32_dpp v129, v137 row_shr:1 row_mask:0xf bank_mask:0xf bound_ctrl:0
    v_mov_b32_dpp v130, v138 row_shr:1 row_mask:0xf bank_mask:0xf bound_ctrl:0
    v_mov_b32_dpp v131, v139 row_shr:1 row_mask:0xf bank_mask:0xf bound_ctrl:0
    v_mov_b32_dpp v132, v140 row_shr:1 row_mask:0xf bank_mask:0xf bound_ctrl:0
    v_mov_b32_dpp v133, v141 row_shr:1 row_mask:0xf bank_mask:0xf bound_ctrl:0
    v_mov_b32_dpp v134, v142 row_shr:1 row_mask:0xf bank_mask:0xf bound_ctrl:0
    v_mov_b32_dpp v135, v143 row_shr:1 row_mask:0xf bank_mask:0xf bound_ctrl:0
    s_nop 0
    v_mov_b32_dpp v144, v128 row_shr:1 row_mask:0xf bank_mask:0xf bound_ctrl:0
    v_mov_b32_dpp v145, v129 row_shr:1 row_mask:0xf bank_mask:0xf bound_ctrl:0
    v_mov_b32_dpp v146, v130 row_shr:1 row_mask:0xf bank_mask:0xf bound_ctrl:0
    v_mov_b32_dpp v147, v131 row_shr:1 row_mask:0xf bank_mask:0xf bound_ctrl:0
    v_mov_b32_dpp v148, v132 row_shr:1 row_mask:0xf bank_mask:0xf bound_ctrl:0
    v_mov_b32_dpp v149, v133 row_shr:1 row_mask:0xf bank_mask:0xf bound_ctrl:0
    v_mov_b32_dpp v150, v134 row_shr:1 row_mask:0xf bank_mask:0xf bound_ctrl:0
    v_mov_b32_dpp v151, v135 row_shr:1 row_mask:0xf bank_mask:0xf bound_ctrl:0
    v_fmac_f32_dpp v128, v32, v144 row_newbcast:1 row_mask:0xf bank_mask:0xf
    v_fmac_f32_dpp v129, v33, v145 row_newbcast:1 row_mask:0xf bank_mask:0xf
    v_fmac_f32_dpp v130, v34, v146 row_newbcast:1 row_mask:0xf bank_mask:0xf
    v_fmac_f32_dpp v131, v35, v147 row_newbcast:1 row_mask:0xf bank_mask:0xf
    v_fmac_f32_dpp v132, v32, v148 row_newbcast:1 row_mask:0xf bank_mask:0xf
    v_fmac_f32_dpp v133, v33, v149 row_newbcast:1 row_mask:0xf bank_mask:0xf
    v_fmac_f32_dpp v134, v34, v150 row_newbcast:1 row_mask:0xf bank_mask:0xf
    v_fmac_f32_dpp v135, v35, v151 row_newbcast:1 row_mask:0xf bank_mask:0xf
    v_fmac_f32_dpp v128, -v36, v148 row_newbcast:1 row_mask:0xf bank_mask:0xf
    v_fmac_f32_dpp v129, -v37, v149 row_newbcast:1 row_mask:0xf bank_mask:0xf
    v_fmac_f32_dpp v130, -v38, v150 row_newbcast:1 row_mask:0xf bank_mask:0xf
    v_fmac_f32_dpp v131, -v39, v151 row_newbcast:1 row_mask:0xf bank_mask:0xf
    v_fmac_f32_dpp v132, v36, v144 row_newbcast:1 row_mask:0xf bank_mask:0xf
    v_fmac_f32_dpp v133, v37, v145 row_newbcast:1 row_mask:0xf bank_mask:0xf
    v_fmac_f32_dpp v134, v38, v146 row_newbcast:1 row_mask:0xf bank_mask:0xf
    v_fmac_f32_dpp v135, v39, v147 row_newbcast:1 row_mask:0xf bank_mask:0xf
    v_mov_b32_dpp v144, v128 row_shr:2 row_mask:0xf bank_mask:0xf bound_ctrl:0
    v_mov_b32_dpp v145, v129 row_shr:2 row_mask:0xf bank_mask:0xf bound_ctrl:0
    v_mov_b32_dpp v146, v130 row_shr:2 row_mask:0xf bank_mask:0xf bound_ctrl:0
    v_mov_b32_dpp v147, v131 row_shr:2 row_mask:0xf bank_mask:0xf bound_ctrl:0
    v_mov_b32_dpp v148, v132 row_shr:2 row_mask:0xf bank_mask:0xf bound_ctrl:0
    v_mov_b32_dpp v149, v133 row_shr:2 row_mask:0xf bank_mask:0xf bound_ctrl:0
    v_mov_b32_dpp v150, v134 row_shr:2 row_mask:0xf bank_mask:0xf bound_ctrl:0
    v_mov_b32_dpp v151, v135 row_shr:2 row_mask:0xf bank_mask:0xf bound_ctrl:0
    v_fmac_f32_dpp v128, v32, v144 row_newbcast:2 row_mask:0xf bank_mask:0xf
    v_fmac_f32_dpp v129, v33, v145 row_newbcast:2 row_mask:0xf bank_mask:0xf
    v_fmac_f32_dpp v130, v34, v146 row_newbcast:2 row_mask:0xf bank_mask:0xf
    v_fmac_f32_dpp v131, v35, v147 row_newbcast:2 row_mask:0xf bank_mask:0xf
    v_fmac_f32_dpp v132, v32, v148 row_newbcast:2 row_mask:0xf bank_mask:0xf
    v_fmac_f32_dpp v133, v33, v149 row_newbcast:2 row_mask:0xf bank_mask:0xf
    v_fmac_f32_dpp v134, v34, v150 row_newbcast:2 row_mask:0xf bank_mask:0xf
    v_fmac_f32_dpp v135, v35, v151 row_newbcast:2 row_mask:0xf bank_mask:0xf
    v_fmac_f32_dpp v128, -v36, v148 row_newbcast:2 row_mask:0xf bank_mask:0xf
    v_fmac_f32_dpp v129, -v37, v149 row_newbcast:2 row_mask:0xf bank_mask:0xf
    v_fmac_f32_dpp v130, -v38, v150 row_newbcast:2 row_mask:0xf bank_mask:0xf
    v_fmac_f32_dpp v131, -v39, v151 row_newbcast:2 row_mask:0xf bank_mask:0xf
    v_fmac_f32_dpp v132, v36, v144 row_newbcast:2 row_mask:0xf bank_mask:0xf
    v_fmac_f32_dpp v133, v37, v145 row_newbcast:2 row_mask:0xf bank_mask:0xf
    v_fmac_f32_dpp v134, v38, v146 row_newbcast:2 row_mask:0xf bank_mask:0xf
    v_fmac_f32_dpp v135, v39, v147 row_newbcast:2 row_mask:0xf bank_mask:0xf
    v_mov_b32_dpp v144, v128 row_shr:4 row_mask:0xf bank_mask:0xf bound_ctrl:0
    v_mov_b32_dpp v145, v129 row_shr:4 row_mask:0xf bank_mask:0xf bound_ctrl:0
    v_mov_b32_dpp v146, v130 row_shr:4 row_mask:0xf bank_mask:0xf bound_ctrl:0
    v_mov_b32_dpp v147, v131 row_shr:4 row_mask:0xf bank_mask:0xf bound_ctrl:0
    v_mov_b32_dpp v148, v132 row_shr:4 row_mask:0xf bank_mask:0xf bound_ctrl:0
    v_mov_b32_dpp v149, v133 row_shr:4 row_mask:0xf bank_mask:0xf bound_ctrl:0
    v_mov_b32_dpp v150, v134 row_shr:4 row_mask:0xf bank_mask:0xf bound_ctrl:0
    v_mov_b32_dpp v151, v135 row_shr:4 row_mask:0xf bank_mask:0xf bound_ctrl:0
    v_fmac_f32_dpp v128, v32, v144 row_newbcast:4 row_mask:0xf bank_mask:0xf
    v_fmac_f32_dpp v129, v33, v145 row_newbcast:4 row_mask:0xf bank_mask:0xf
    v_fmac_f32_dpp v130, v34, v146 row_newbcast:4 row_mask:0xf bank_mask:0xf
    v_fmac_f32_dpp v131, v35, v147 row_newbcast:4 row_mask:0xf bank_mask:0xf
    v_fmac_f32_dpp v132, v32, v148 row_newbcast:4 row_mask:0xf bank_mask:0xf
    v_fmac_f32_dpp v133, v33, v149 row_newbcast:4 row_mask:0xf bank_mask:0xf
    v_fmac_f32_dpp v134, v34, v150 row_newbcast:4 row_mask:0xf bank_mask:0xf
    v_fmac_f32_dpp v135, v35, v151 row_newbcast:4 row_mask:0xf bank_mask:0xf
    v_fmac_f32_dpp v128, -v36, v148 row_newbcast:4 row_mask:0xf bank_mask:0xf
    v_fmac_f32_dpp v129, -v37, v149 row_newbcast:4 row_mask:0xf bank_mask:0xf
    v_fmac_f32_dpp v130, -v38, v150 row_newbcast:4 row_mask:0xf bank_mask:0xf
    v_fmac_f32_dpp v131, -v39, v151 row_newbcast:4 row_mask:0xf bank_mask:0xf
    v_fmac_f32_dpp v132, v36, v144 row_newbcast:4 row_mask:0xf bank_mask:0xf
    v_fmac_f32_dpp v133, v37, v145 row_newbcast:4 row_mask:0xf bank_mask:0xf
    v_fmac_f32_dpp v134, v38, v146 row_newbcast:4 row_mask:0xf bank_mask:0xf
    v_fmac_f32_dpp v135, v39, v147 row_newbcast:4 row_mask:0xf bank_mask:0xf
    v_mov_b32_dpp v144, v128 row_shr:8 row_mask:0xf bank_mask:0xf bound_ctrl:0
    v_mov_b32_dpp v145, v129 row_shr:8 row_mask:0xf bank_mask:0xf bound_ctrl:0
    v_mov_b32_dpp v146, v130 row_shr:8 row_mask:0xf bank_mask:0xf bound_ctrl:0
    v_mov_b32_dpp v147, v131 row_shr:8 row_mask:0xf bank_mask:0xf bound_ctrl:0
    v_mov_b32_dpp v148, v132 row_shr:8 row_mask:0xf bank_mask:0xf bound_ctrl:0
    v_mov_b32_dpp v149, v133 row_shr:8 row_mask:0xf bank_mask:0xf bound_ctrl:0
    v_mov_b32_dpp v150, v134 row_shr:8 row_mask:0xf bank_mask:0xf bound_ctrl:0
    v_mov_b32_dpp v151, v135 row_shr:8 row_mask:0xf bank_mask:0xf bound_ctrl:0
    v_fmac_f32_dpp v128, v32, v144 row_newbcast:8 row_mask:0xf bank_mask:0xf
    v_fmac_f32_dpp v129, v33, v145 row_newbcast:8 row_mask:0xf bank_mask:0xf
    v_fmac_f32_dpp v130, v34, v146 row_newbcast:8 row_mask:0xf bank_mask:0xf
    v_fmac_f32_dpp v131, v35, v147 row_newbcast:8 row_mask:0xf bank_mask:0xf
    v_fmac_f32_dpp v132, v32, v148 row_newbcast:8 row_mask:0xf bank_mask:0xf
    v_fmac_f32_dpp v133, v33, v149 row_newbcast:8 row_mask:0xf bank_mask:0xf
    v_fmac_f32_dpp v134, v34, v150 row_newbcast:8 row_mask:0xf bank_mask:0xf
    v_fmac_f32_dpp v135, v35, v151 row_newbcast:8 row_mask:0xf bank_mask:0xf
    v_fmac_f32_dpp v128, -v36, v148 row_newbcast:8 row_mask:0xf bank_mask:0xf
    v_fmac_f32_dpp v129, -v37, v149 row_newbcast:8 row_mask:0xf bank_mask:0xf
    v_fmac_f32_dpp v130, -v38, v150 row_newbcast:8 row_mask:0xf bank_mask:0xf
    v_fmac_f32_dpp v131, -v39, v151 row_newbcast:8 row_mask:0xf bank_mask:0xf
    v_fmac_f32_dpp v132, v36, v144 row_newbcast:8 row_mask:0xf bank_mask:0xf
    v_fmac_f32_dpp v133, v37, v145 row_newbcast:8 row_mask:0xf bank_mask:0xf
    v_fmac_f32_dpp v134, v38, v146 row_newbcast:8 row_mask:0xf bank_mask:0xf
    v_fmac_f32_dpp v135, v39, v147 row_newbcast:8 row_mask:0xf bank_mask:0xf
    v_mul_f32 v152, v24, v128
    v_mul_f32 v153, v25, v129
    v_mul_f32 v156, -v24, v132
    v_mul_f32 v157, -v25, v133
    v_mul_f32 v154, v26, v130
    v_mul_f32 v155, v27, v131
    v_mul_f32 v158, -v26, v134
    v_mul_f32 v159, -v27, v135
    v_fma_f32 v152, -v28, v132, v152
    v_fma_f32 v153, -v29, v133, v153
    v_fma_f32 v156, -v28, v128, v156
    v_fma_f32 v157, -v29, v129, v157
    v_fma_f32 v154, -v30, v134, v154
    v_fma_f32 v155, -v31, v135, v155
    v_fma_f32 v158, -v30, v130, v158
    v_fma_f32 v159, -v31, v131, v159
    v_mul_f32 v136, v24, v32
    v_mul_f32 v137, v25, v33
    v_mul_f32 v140, v24, v36
    v_mul_f32 v141, v25, v37
    v_mul_f32 v138, v26, v34
    v_mul_f32 v139, v27, v35
    v_mul_f32 v142, v26, v38
    v_mul_f32 v143, v27, v39
    v_fma_f32 v136, -v28, v36, v136
    v_fma_f32 v137, -v29, v37, v137
    v_fmac_f32 v140, v28, v32
    v_fmac_f32 v141, v29, v33
    v_fma_f32 v138, -v30, v38, v138
    v_fma_f32 v139, -v31, v39, v139
    v_fmac_f32 v142, v30, v34
    v_fmac_f32 v143, v31, v35
    v_mul_f32 v48, v24, v64
    v_mul_f32 v49, v25, v65
    v_mul_f32 v50, v26, v66
    v_mul_f32 v51, v27, v67
    v_fma_f32 v48, -v28, v68, v48
    v_fma_f32 v49, -v29, v69, v49
    v_fma_f32 v50, -v30, v70, v50
    v_fma_f32 v51, -v31, v71, v51
    v_mul_f32 v68, -v24, v68
    v_mul_f32 v69, -v25, v69
    v_mul_f32 v70, -v26, v70
    v_mul_f32 v71, -v27, v71
    v_fma_f32 v68, -v28, v64, v68
    v_fma_f32 v69, -v29, v65, v69
    v_fma_f32 v70, -v30, v66, v70
    v_fma_f32 v71, -v31, v67, v71
    v_mul_f32 v64, v24, v72
    v_mul_f32 v65, v25, v73
    v_mul_f32 v66, v26, v74
    v_mul_f32 v67, v27, v75
    v_fma_f32 v64, -v28, v76, v64
    v_fma_f32 v65, -v29, v77, v65
    v_fma_f32 v66, -v30, v78, v66
    v_fma_f32 v67, -v31, v79, v67
    v_mul_f32 v76, -v24, v76
    v_mul_f32 v77, -v25, v77
    v_mul_f32 v78, -v26, v78
    v_mul_f32 v79, -v27, v79
    v_fma_f32 v76, -v28, v72, v76
    v_fma_f32 v77, -v29, v73, v77
    v_fma_f32 v78, -v30, v74, v78
    v_fma_f32 v79, -v31, v75, v79
    v_mul_f32 v72, v24, v80
    v_mul_f32 v73, v25, v81
    v_mul_f32 v74, v26, v82
    v_mul_f32 v75, v27, v83
    v_fma_f32 v72, -v28, v84, v72
    v_fma_f32 v73, -v29, v85, v73
    v_fma_f32 v74, -v30, v86, v74
    v_fma_f32 v75, -v31, v87, v75
    v_mul_f32 v84, -v24, v84
    v_mul_f32 v85, -v25, v85
    v_mul_f32 v86, -v26, v86
    v_mul_f32 v87, -v27, v87
    v_fma_f32 v84, -v28, v80, v84
    v_fma_f32 v85, -v29, v81, v85
    v_fma_f32 v86, -v30, v82, v86
    v_fma_f32 v87, -v31, v83, v87
    v_mul_f32 v80, v24, v88
    v_mul_f32 v81, v25, v89
    v_mul_f32 v82, v26, v90
    v_mul_f32 v83, v27, v91
    v_fma_f32 v80, -v28, v92, v80
    v_fma_f32 v81, -v29, v93, v81
    v_fma_f32 v82, -v30, v94, v82
    v_fma_f32 v83, -v31, v95, v83
    v_mul_f32 v92, -v24, v92
    v_mul_f32 v93, -v25, v93
    v_mul_f32 v94, -v26, v94
    v_mul_f32 v95, -v27, v95
    v_fma_f32 v92, -v28, v88, v92
    v_fma_f32 v93, -v29, v89, v93
    v_fma_f32 v94, -v30, v90, v94
    v_fma_f32 v95, -v31, v91, v95
    v_mul_f32 v88, v24, v96
    v_mul_f32 v89, v25, v97
    v_mul_f32 v90, v26, v98
    v_mul_f32 v91, v27, v99
    v_fma_f32 v88, -v28, v100, v88
    v_fma_f32 v89, -v29, v101, v89
    v_fma_f32 v90, -v30, v102, v90
    v_fma_f32 v91, -v31, v103, v91
    v_mul_f32 v100, -v24, v100
    v_mul_f32 v101, -v25, v101
    v_mul_f32 v102, -v26, v102
    v_mul_f32 v103, -v27, v103
    v_fma_f32 v100, -v28, v96, v100
    v_fma_f32 v101, -v29, v97, v101
    v_fma_f32 v102, -v30, v98, v102
    v_fma_f32 v103, -v31, v99, v103
    v_mul_f32 v96, v24, v104
    v_mul_f32 v97, v25, v105
    v_mul_f32 v98, v26, v106
    v_mul_f32 v99, v27, v107
    v_fma_f32 v96, -v28, v108, v96
    v_fma_f32 v97, -v29, v109, v97
    v_fma_f32 v98, -v30, v110, v98
    v_fma_f32 v99, -v31, v111, v99
    v_mul_f32 v108, -v24, v108
    v_mul_f32 v109, -v25, v109
    v_mul_f32 v110, -v26, v110
    v_mul_f32 v111, -v27, v111
    v_fma_f32 v108, -v28, v104, v108
    v_fma_f32 v109, -v29, v105, v109
    v_fma_f32 v110, -v30, v106, v110
    v_fma_f32 v111, -v31, v107, v111
    v_mul_f32 v104, v24, v112
    v_mul_f32 v105, v25, v113
    v_mul_f32 v106, v26, v114
    v_mul_f32 v107, v27, v115
    v_fma_f32 v104, -v28, v116, v104
    v_fma_f32 v105, -v29, v117, v105
    v_fma_f32 v106, -v30, v118, v106
    v_fma_f32 v107, -v31, v119, v107
    v_mul_f32 v116, -v24, v116
    v_mul_f32 v117, -v25, v117
    v_mul_f32 v118, -v26, v118
    v_mul_f32 v119, -v27, v119
    v_fma_f32 v116, -v28, v112, v116
    v_fma_f32 v117, -v29, v113, v117
    v_fma_f32 v118, -v30, v114, v118
    v_fma_f32 v119, -v31, v115, v119
    v_mul_f32 v112, v24, v120
    v_mul_f32 v113, v25, v121
    v_mul_f32 v114, v26, v122
    v_mul_f32 v115, v27, v123
    v_fma_f32 v112, -v28, v124, v112
    v_fma_f32 v113, -v29, v125, v113
    v_fma_f32 v114, -v30, v126, v114
    v_fma_f32 v115, -v31, v127, v115
    v_mul_f32 v124, -v24, v124
    v_mul_f32 v125, -v25, v125
    v_mul_f32 v126, -v26, v126
    v_mul_f32 v127, -v27, v127
    v_fma_f32 v124, -v28, v120, v124
    v_fma_f32 v125, -v29, v121, v125
    v_fma_f32 v126, -v30, v122, v126
    v_fma_f32 v127, -v31, v123, v127
    buffer_load_dwordx4 v[24:27], v56, s[12:15], 0 offen sc1
    buffer_load_dwordx4 v[28:31], v57, s[12:15], 0 offen sc1
    buffer_load_dwordx4 v[32:35], v58, s[12:15], 0 offen sc1
    buffer_load_dwordx4 v[36:39], v59, s[12:15], 0 offen sc1
    s_mov_b32 s39, 0
C_chk:
    s_waitcnt vmcnt(0)
    v_cmp_eq_u32 vcc, v26, v54
    v_cmp_eq_u32 s[54:55], v27, v55
    s_and_b64 s[54:55], s[54:55], vcc
    s_or_b64 s[56:57], s[54:55], s[40:41]
    v_cmp_eq_u32 vcc, v30, v54
    v_cmp_eq_u32 s[54:55], v31, v55
    s_and_b64 s[54:55], s[54:55], vcc
    s_or_b64 s[58:59], s[54:55], s[42:43]
    v_cmp_eq_u32 vcc, v34, v54
    v_cmp_eq_u32 s[54:55], v35, v55
    s_and_b64 s[54:55], s[54:55], vcc
    s_or_b64 s[60:61], s[54:55], s[44:45]
    v_cmp_eq_u32 vcc, v38, v54
    v_cmp_eq_u32 s[54:55], v39, v55
    s_and_b64 s[54:55], s[54:55], vcc
    s_or_b64 s[62:63], s[54:55], s[46:47]
    s_and_b64 s[56:57], s[56:57], s[58:59]
    s_and_b64 s[60:61], s[60:61], s[62:63]
    s_and_b64 s[56:57], s[56:57], s[60:61]
    s_cmp_eq_u64 s[56:57], -1
    s_cbranch_scc1 C_ok
    s_add_u32 s39, s39, 1
    s_cmp_gt_u32 s39, 4096
    s_cbranch_scc1 C_ok
    buffer_load_dwordx4 v[24:27], v56, s[12:15], 0 offen sc1
    buffer_load_dwordx4 v[28:31], v57, s[12:15], 0 offen sc1
    buffer_load_dwordx4 v[32:35], v58, s[12:15], 0 offen sc1
    buffer_load_dwordx4 v[36:39], v59, s[12:15], 0 offen sc1
    s_branch C_chk
C_ok:
    ds_write_b32 v63, v3 offset:64
    v_fma_f32 v32, v36, v42, v32
    v_fma_f32 v33, v36, v43, v33
    v_fma_f32 v32, -v37, v43, v32
    v_fmac_f32 v33, v37, v42
    v_fma_f32 v28, v32, v42, v28
    v_fma_f32 v29, v32, v43, v29
    v_fma_f32 v28, -v33, v43, v28
    v_fmac_f32 v29, v33, v42
    v_fma_f32 v24, v28, v42, v24
    v_fma_f32 v25, v28, v43, v25
    v_fma_f32 v24, -v29, v43, v24
    v_fmac_f32 v25, v29, v42
    v_mul_f32 v44, v24, v40
    v_mul_f32 v45, v24, v41
    v_fma_f32 v44, -v25, v41, v44
    v_fmac_f32 v45, v25, v40
    s_nop 0
    v_add_f32_dpp v44, v44, v44 row_ror:4 row_mask:0xf bank_mask:0xf
    v_add_f32_dpp v45, v45, v45 row_ror:4 row_mask:0xf bank_mask:0xf
    s_nop 0
    v_add_f32_dpp v44, v44, v44 row_ror:8 row_mask:0xf bank_mask:0xf
    v_add_f32_dpp v45, v45, v45 row_ror:8 row_mask:0xf bank_mask:0xf
    s_nop 0
    v_mov_b32_dpp v144, v44 quad_perm:[0,0,0,0] row_mask:0xf bank_mask:0xf
    v_mov_b32_dpp v148, v45 quad_perm:[0,0,0,0] row_mask:0xf bank_mask:0xf
    v_mov_b32_dpp v145, v44 quad_perm:[1,1,1,1] row_mask:0xf bank_mask:0xf
    v_mov_b32_dpp v149, v45 quad_perm:[1,1,1,1] row_mask:0xf bank_mask:0xf
    v_mov_b32_dpp v146, v44 quad_perm:[2,2,2,2] row_mask:0xf bank_mask:0xf
    v_mov_b32_dpp v150, v45 quad_perm:[2,2,2,2] row_mask:0xf bank_mask:0xf
    v_mov_b32_dpp v147, v44 quad_perm:[3,3,3,3] row_mask:0xf bank_mask:0xf
    v_mov_b32_dpp v151, v45 quad_perm:[3,3,3,3] row_mask:0xf bank_mask:0xf
    v_pk_fma_f32 v[152:153], v[136:137], v[144:145], v[152:153]
    v_pk_fma_f32 v[156:157], v[136:137], v[148:149], v[156:157] neg_lo:[1,0,0] neg_hi:[1,0,0]
    v_pk_fma_f32 v[154:155], v[138:139], v[146:147], v[154:155]
    v_pk_fma_f32 v[158:159], v[138:139], v[150:151], v[158:159] neg_lo:[1,0,0] neg_hi:[1,0,0]
    v_pk_fma_f32 v[152:153], v[140:141], v[148:149], v[152:153] neg_lo:[1,0,0] neg_hi:[1,0,0]
    v_pk_fma_f32 v[156:157], v[140:141], v[144:145], v[156:157] neg_lo:[1,0,0] neg_hi:[1,0,0]
    v_pk_fma_f32 v[154:155], v[142:143], v[150:151], v[154:155] neg_lo:[1,0,0] neg_hi:[1,0,0]
    v_pk_fma_f32 v[158:159], v[142:143], v[146:147], v[158:159] neg_lo:[1,0,0] neg_hi:[1,0,0]
    v_pk_fma_f32 v[48:49], v[16:17], v[152:153], v[48:49]
    v_pk_fma_f32 v[68:69], v[16:17], v[156:157], v[68:69]
    v_pk_fma_f32 v[50:51], v[18:19], v[154:155], v[50:51]
    v_pk_fma_f32 v[70:71], v[18:19], v[158:159], v[70:71]
    v_pk_fma_f32 v[48:49], v[20:21], v[156:157], v[48:49]
    v_pk_fma_f32 v[68:69], v[20:21], v[152:153], v[68:69] neg_lo:[1,0,0] neg_hi:[1,0,0]
    v_pk_fma_f32 v[50:51], v[22:23], v[158:159], v[50:51]
    v_pk_fma_f32 v[70:71], v[22:23], v[154:155], v[70:71] neg_lo:[1,0,0] neg_hi:[1,0,0]
    v_cvt_pk_bf16_f32 v128, v48, v49
    v_cvt_pk_bf16_f32 v130, v68, v69
    v_cvt_pk_bf16_f32 v129, v50, v51
    v_cvt_pk_bf16_f32 v131, v70, v71
    v_pk_fma_f32 v[64:65], v[16:17], v[48:49], v[64:65]
    v_pk_fma_f32 v[76:77], v[16:17], v[68:69], v[76:77]
    v_pk_fma_f32 v[66:67], v[18:19], v[50:51], v[66:67]
    v_pk_fma_f32 v[78:79], v[18:19], v[70:71], v[78:79]
    v_pk_fma_f32 v[64:65], v[20:21], v[68:69], v[64:65]
    v_pk_fma_f32 v[76:77], v[20:21], v[48:49], v[76:77] neg_lo:[1,0,0] neg_hi:[1,0,0]
    v_pk_fma_f32 v[66:67], v[22:23], v[70:71], v[66:67]
    v_pk_fma_f32 v[78:79], v[22:23], v[50:51], v[78:79] neg_lo:[1,0,0] neg_hi:[1,0,0]
    v_permlane32_swap_b32 v128, v130
    v_permlane32_swap_b32 v129, v131
    s_mov_b32 s6, 0
    buffer_store_dwordx4 v[128:131], v61, s[8:11], s6 offen sc1
    v_cvt_pk_bf16_f32 v132, v64, v65
    v_cvt_pk_bf16_f32 v134, v76, v77
    v_cvt_pk_bf16_f32 v133, v66, v67
    v_cvt_pk_bf16_f32 v135, v78, v79
    v_pk_fma_f32 v[72:73], v[16:17], v[64:65], v[72:73]
    v_pk_fma_f32 v[84:85], v[16:17], v[76:77], v[84:85]
    v_pk_fma_f32 v[74:75], v[18:19], v[66:67], v[74:75]
    v_pk_fma_f32 v[86:87], v[18:19], v[78:79], v[86:87]
    v_pk_fma_f32 v[72:73], v[20:21], v[76:77], v[72:73]
    v_pk_fma_f32 v[84:85], v[20:21], v[64:65], v[84:85] neg_lo:[1,0,0] neg_hi:[1,0,0]
    v_pk_fma_f32 v[74:75], v[22:23], v[78:79], v[74:75]
    v_pk_fma_f32 v[86:87], v[22:23], v[66:67], v[86:87] neg_lo:[1,0,0] neg_hi:[1,0,0]
    v_permlane32_swap_b32 v132, v134
    v_permlane32_swap_b32 v133, v135
    s_mov_b32 s6, 4096
    buffer_store_dwordx4 v[132:135], v61, s[8:11], s6 offen sc1
    v_cvt_pk_bf16_f32 v136, v72, v73
    v_cvt_pk_bf16_f32 v138, v84, v85
    v_cvt_pk_bf16_f32 v137, v74, v75
    v_cvt_pk_bf16_f32 v139, v86, v87
    v_pk_fma_f32 v[80:81], v[16:17], v[72:73], v[80:81]
    v_pk_fma_f32 v[92:93], v[16:17], v[84:85], v[92:93]
    v_pk_fma_f32 v[82:83], v[18:19], v[74:75], v[82:83]
    v_pk_fma_f32 v[94:95], v[18:19], v[86:87], v[94:95]
    v_pk_fma_f32 v[80:81], v[20:21], v[84:85], v[80:81]
    v_pk_fma_f32 v[92:93], v[20:21], v[72:73], v[92:93] neg_lo:[1,0,0] neg_hi:[1,0,0]
    v_pk_fma_f32 v[82:83], v[22:23], v[86:87], v[82:83]
    v_pk_fma_f32 v[94:95], v[22:23], v[74:75], v[94:95] neg_lo:[1,0,0] neg_hi:[1,0,0]
    v_permlane32_swap_b32 v136, v138
    v_permlane32_swap_b32 v137, v139
    s_mov_b32 s6, 8192
    buffer_store_dwordx4 v[136:139], v61, s[8:11], s6 offen sc1
    v_cvt_pk_bf16_f32 v140, v80, v81
    v_cvt_pk_bf16_f32 v142, v92, v93
    v_cvt_pk_bf16_f32 v141, v82, v83
    v_cvt_pk_bf16_f32 v143, v94, v95
    v_pk_fma_f32 v[88:89], v[16:17], v[80:81], v[88:89]
    v_pk_fma_f32 v[100:101], v[16:17], v[92:93], v[100:101]
    v_pk_fma_f32 v[90:91], v[18:19], v[82:83], v[90:91]
    v_pk_fma_f32 v[102:103], v[18:19], v[94:95], v[102:103]
    v_pk_fma_f32 v[88:89], v[20:21], v[92:93], v[88:89]
    v_pk_fma_f32 v[100:101], v[20:21], v[80:81], v[100:101] neg_lo:[1,0,0] neg_hi:[1,0,0]
    v_pk_fma_f32 v[90:91], v[22:23], v[94:95], v[90:91]
    v_pk_fma_f32 v[102:103], v[22:23], v[82:83], v[102:103] neg_lo:[1,0,0] neg_hi:[1,0,0]
    v_permlane32_swap_b32 v140, v142
    v_permlane32_swap_b32 v141, v143
    s_mov_b32 s6, 12288
    buffer_store_dwordx4 v[140:143], v61, s[8:11], s6 offen sc1
    v_cvt_pk_bf16_f32 v144, v88, v89
    v_cvt_pk_bf16_f32 v146, v100, v101
    v_cvt_pk_bf16_f32 v145, v90, v91
    v_cvt_pk_bf16_f32 v147, v102, v103
    v_pk_fma_f32 v[96:97], v[16:17], v[88:89], v[96:97]
    v_pk_fma_f32 v[108:109], v[16:17], v[100:101], v[108:109]
    v_pk_fma_f32 v[98:99], v[18:19], v[90:91], v[98:99]
    v_pk_fma_f32 v[110:111], v[18:19], v[102:103], v[110:111]
    v_pk_fma_f32 v[96:97], v[20:21], v[100:101], v[96:97]
    v_pk_fma_f32 v[108:109], v[20:21], v[88:89], v[108:109] neg_lo:[1,0,0] neg_hi:[1,0,0]
    v_pk_fma_f32 v[98:99], v[22:23], v[102:103], v[98:99]
    v_pk_fma_f32 v[110:111], v[22:23], v[90:91], v[110:111] neg_lo:[1,0,0] neg_hi:[1,0,0]
    v_permlane32_swap_b32 v144, v146
    v_permlane32_swap_b32 v145, v147
    s_mov_b32 s6, 16384
    buffer_store_dwordx4 v[144:147], v61, s[8:11], s6 offen sc1
    v_cvt_pk_bf16_f32 v148, v96, v97
    v_cvt_pk_bf16_f32 v150, v108, v109
    v_cvt_pk_bf16_f32 v149, v98, v99
    v_cvt_pk_bf16_f32 v151, v110, v111
    v_pk_fma_f32 v[104:105], v[16:17], v[96:97], v[104:105]
    v_pk_fma_f32 v[116:117], v[16:17], v[108:109], v[116:117]
    v_pk_fma_f32 v[106:107], v[18:19], v[98:99], v[106:107]
    v_pk_fma_f32 v[118:119], v[18:19], v[110:111], v[118:119]
    v_pk_fma_f32 v[104:105], v[20:21], v[108:109], v[104:105]
    v_pk_fma_f32 v[116:117], v[20:21], v[96:97], v[116:117] neg_lo:[1,0,0] neg_hi:[1,0,0]
    v_pk_fma_f32 v[106:107], v[22:23], v[110:111], v[106:107]
    v_pk_fma_f32 v[118:119], v[22:23], v[98:99], v[118:119] neg_lo:[1,0,0] neg_hi:[1,0,0]
    v_permlane32_swap_b32 v148, v150
    v_permlane32_swap_b32 v149, v151
    s_mov_b32 s6, 20480
    buffer_store_dwordx4 v[148:151], v61, s[8:11], s6 offen sc1
    v_cvt_pk_bf16_f32 v152, v104, v105
    v_cvt_pk_bf16_f32 v154, v116, v117
    v_cvt_pk_bf16_f32 v153, v106, v107
    v_cvt_pk_bf16_f32 v155, v118, v119
    v_pk_fma_f32 v[112:113], v[16:17], v[104:105], v[112:113]
    v_pk_fma_f32 v[124:125], v[16:17], v[116:117], v[124:125]
    v_pk_fma_f32 v[114:115], v[18:19], v[106:107], v[114:115]
    v_pk_fma_f32 v[126:127], v[18:19], v[118:119], v[126:127]
    v_pk_fma_f32 v[112:113], v[20:21], v[116:117], v[112:113]
    v_pk_fma_f32 v[124:125], v[20:21], v[104:105], v[124:125] neg_lo:[1,0,0] neg_hi:[1,0,0]
    v_pk_fma_f32 v[114:115], v[22:23], v[118:119], v[114:115]
    v_pk_fma_f32 v[126:127], v[22:23], v[106:107], v[126:127] neg_lo:[1,0,0] neg_hi:[1,0,0]
    v_permlane32_swap_b32 v152, v154
    v_permlane32_swap_b32 v153, v155
    s_mov_b32 s6, 24576
    buffer_store_dwordx4 v[152:155], v61, s[8:11], s6 offen sc1
    v_cvt_pk_bf16_f32 v156, v112, v113
    v_cvt_pk_bf16_f32 v158, v124, v125
    v_cvt_pk_bf16_f32 v157, v114, v115
    v_cvt_pk_bf16_f32 v159, v126, v127
    s_nop 0
    v_permlane32_swap_b32 v156, v158
    v_permlane32_swap_b32 v157, v159
    s_mov_b32 s6, 28672
    buffer_store_dwordx4 v[156:159], v61, s[8:11], s6 offen sc1
    ds_write_b32 v63, v15 offset:64
    v_lshlrev_b32 v1, 4, v2
    v_add_u32 v52, s21, v1
    v_add_u32 v53, 0xc000, v52
    v_lshrrev_b32 v1, 1, v13
    v_lshl_add_u32 v8, v1, 13, v4
    v_xor_b32 v9, 32, v8
    v_xor_b32 v10, 64, v8
    v_xor_b32 v11, 96, v8
    s_lshl_b32 s6, s3, 6
    s_add_u32 s6, s6, s5
    s_lshl_b32 s6, s6, 13
    v_lshlrev_b32 v1, 4, v2
    v_add_u32 v48, s6, v1
    v_add_u32 v49, 4096, v48
    s_lshl_b32 s6, s6, 1
    s_lshl_b32 s7, s4, 8
    s_add_u32 s6, s6, s7
    s_add_u32 s6, s6, 4096
    v_lshlrev_b32 v50, 18, v13
    v_lshl_add_u32 v50, v12, 4, v50
    v_add_u32 v50, s6, v50
    v_lshlrev_b32 v1, 1, v13
    v_sub_u32 v1, v12, v1
    v_cmp_eq_u32 s[40:41], 0, v1
    v_cmp_eq_u32 s[42:43], 1, v1
    v_cmp_eq_u32 s[44:45], 8, v1
    v_cmp_eq_u32 s[46:47], 9, v1
    v_and_b32 v56, 0xffff, v242
    v_and_b32 v57, 0xffff0000, v242
    v_and_b32 v58, 0xffff, v243
    v_and_b32 v59, 0xffff0000, v243
    s_lshl_b32 s7, s3, 13
    s_add_u32 s7, s7, 131072
    v_lshrrev_b32 v1, 2, v2
    v_xor_b32 v3, s36, v1
    v_add_u32 v1, s36, v1
    v_and_b32 v1, 7, v1
    v_and_b32 v3, 8, v3
    v_or_b32 v1, v1, v3
    v_lshlrev_b32 v1, 9, v1
    v_add_u32 v51, s7, v1
    s_lshl_b32 s6, s4, 9
    s_add_u32 s6, s6, s7
    v_lshl_add_u32 v3, v12, 3, s6
    s_lshl_b32 s38, s36, 15
    s_and_b32 s30, s38, 0x40000
    s_xor_b32 s31, s30, 0x40000
    s_xor_b32 s35, s38, 0x40000
    s_lshl_b32 s6, s3, 19
    s_lshl_b32 s7, s5, 13
    s_add_u32 s6, s6, s7
    v_lshlrev_b32 v1, 7, v2
    v_add_u32 v60, s6, v1
    s_mov_b32 s34, 1
    s_mov_b32 s37, 0
    v_cndmask_b32 v64, 0, v56, s[40:41]
    v_mov_b32 v65, 0
    v_cndmask_b32 v66, 0, v56, s[42:43]
    v_mov_b32 v67, 0
    v_cndmask_b32 v68, 0, v56, s[44:45]
    v_mov_b32 v69, 0
    v_cndmask_b32 v70, 0, v56, s[46:47]
    v_mov_b32 v71, 0
    v_cndmask_b32 v72, 0, v57, s[40:41]
    v_mov_b32 v73, 0
    v_cndmask_b32 v74, 0, v57, s[42:43]
    v_mov_b32 v75, 0
    v_cndmask_b32 v76, 0, v57, s[44:45]
    v_mov_b32 v77, 0
    v_cndmask_b32 v78, 0, v57, s[46:47]
    v_mov_b32 v79, 0
    v_mov_b32 v80, 0
    v_cndmask_b32 v81, 0, v58, s[40:41]
    v_mov_b32 v82, 0
    v_cndmask_b32 v83, 0, v58, s[42:43]
    v_mov_b32 v84, 0
    v_cndmask_b32 v85, 0, v58, s[44:45]
    v_mov_b32 v86, 0
    v_cndmask_b32 v87, 0, v58, s[46:47]
    v_mov_b32 v88, 0
    v_cndmask_b32 v89, 0, v59, s[40:41]
    v_mov_b32 v90, 0
    v_cndmask_b32 v91, 0, v59, s[42:43]
    v_mov_b32 v92, 0
    v_cndmask_b32 v93, 0, v59, s[44:45]
    v_mov_b32 v94, 0
    v_cndmask_b32 v95, 0, v59, s[46:47]
    v_add_u32 v4, 0xc000, v8
    v_add_u32 v5, 0xc000, v9
    v_add_u32 v6, 0xc000, v10
    v_add_u32 v7, 0xc000, v11
    v_mfma_f32_16x16x32_bf16 v[16:19], v[208:211], v[64:67], 0
    v_mfma_f32_16x16x32_bf16 v[20:23], v[208:211], v[72:75], 0
    v_mfma_f32_16x16x32_bf16 v[24:27], v[208:211], v[80:83], 0
    v_mfma_f32_16x16x32_bf16 v[28:31], v[208:211], v[88:91], 0
    v_mfma_f32_16x16x32_bf16 v[32:35], v[216:219], v[64:67], 0
    v_mfma_f32_16x16x32_bf16 v[36:39], v[216:219], v[72:75], 0
    v_mfma_f32_16x16x32_bf16 v[40:43], v[216:219], v[80:83], 0
    v_mfma_f32_16x16x32_bf16 v[44:47], v[216:219], v[88:91], 0
    v_mfma_f32_16x16x32_bf16 v[16:19], v[212:215], v[68:71], v[16:19]
    v_mfma_f32_16x16x32_bf16 v[20:23], v[212:215], v[76:79], v[20:23]
    v_mfma_f32_16x16x32_bf16 v[24:27], v[212:215], v[84:87], v[24:27]
    v_mfma_f32_16x16x32_bf16 v[28:31], v[212:215], v[92:95], v[28:31]
    v_mfma_f32_16x16x32_bf16 v[32:35], v[220:223], v[68:71], v[32:35]
    v_mfma_f32_16x16x32_bf16 v[36:39], v[220:223], v[76:79], v[36:39]
    v_mfma_f32_16x16x32_bf16 v[40:43], v[220:223], v[84:87], v[40:43]
    v_mfma_f32_16x16x32_bf16 v[44:47], v[220:223], v[92:95], v[44:47]
    buffer_load_dwordx2 v[240:241], v51, s[72:75], 0 offen sc1
    s_waitcnt vmcnt(1)
    ds_write_b32 v63, v54 offset:32
    ds_read_b128 v[56:59], v62 offset:32
    s_waitcnt lgkmcnt(0)
    v_xor_b32 v56, v56, v54
    v_xor_b32 v57, v57, v54
    v_xor_b32 v58, v58, v54
    v_xor_b32 v59, v59, v54
    v_or3_b32 v56, v56, v57, v58
    v_or_b32 v56, v56, v59
    v_cmp_ne_u32 vcc, 0, v56
    s_mov_b32 s39, 0
    s_cbranch_vccnz C_nofl
    s_mov_b64 exec, 65535
    buffer_store_dwordx2 v[54:55], v3, s[72:75], 0 offen sc1
    s_mov_b64 exec, -1
    s_branch C_own
C_nofl:
    ds_read_b128 v[56:59], v62 offset:32
    s_waitcnt lgkmcnt(0)
    v_xor_b32 v56, v56, v54
    v_xor_b32 v57, v57, v54
    v_xor_b32 v58, v58, v54
    v_xor_b32 v59, v59, v54
    v_or3_b32 v56, v56, v57, v58
    v_or_b32 v56, v56, v59
    v_cmp_ne_u32 vcc, 0, v56
    s_add_u32 s39, s39, 1
    s_cmp_gt_u32 s39, 16384
    s_cbranch_scc1 C_own
    s_cbranch_vccnz C_nofl
C_own:
    ds_read_b128 v[12:15], v62 offset:48
    buffer_load_dwordx4 v[64:67], v48, s[8:11], s38 offen offset:0 sc1
    buffer_load_dwordx4 v[68:71], v49, s[8:11], s38 offen offset:0 sc1
    buffer_load_dwordx4 v[72:75], v48, s[8:11], s38 offen offset:1024 sc1
    buffer_load_dwordx4 v[76:79], v49, s[8:11], s38 offen offset:1024 sc1
    buffer_load_dwordx4 v[80:83], v48, s[8:11], s38 offen offset:2048 sc1
    buffer_load_dwordx4 v[84:87], v49, s[8:11], s38 offen offset:2048 sc1
    buffer_load_dwordx4 v[88:91], v48, s[8:11], s38 offen offset:3072 sc1
    buffer_load_dwordx4 v[92:95], v49, s[8:11], s38 offen offset:3072 sc1
    s_add_u32 s38, s38, 32768
    s_and_b32 s38, s38, 0x3ffff
    s_or_b32 s38, s38, s30
    s_add_u32 s7, s20, 1280
    s_and_b32 s7, s7, 1023
    s_or_b32 s7, s7, s23
    buffer_load_dwordx4 v[208:211], v244, s[24:27], s7 offen offset:0
    buffer_load_dwordx4 v[212:215], v245, s[24:27], s7 offen offset:1024
    buffer_load_dwordx4 v[216:219], v246, s[80:83], s7 offen offset:0
    buffer_load_dwordx4 v[220:223], v247, s[80:83], s7 offen offset:1024
    s_waitcnt vmcnt(12)
    v_cmp_eq_u32 vcc, v240, v54
    v_cmp_eq_u32 s[54:55], v241, v55
    s_nop 0
    s_and_b64 s[54:55], s[54:55], vcc
    s_or_b32 s54, s54, 15
    s_ff0_i32_b64 s7, s[54:55]
    s_lshr_b32 s7, s7, 2
    s_max_u32 s37, s37, s7
    s_cmp_gt_u32 s37, 1
    s_cbranch_scc0 C2_h1
    C2_h1_r:
    buffer_load_dwordx4 v[96:99], v48, s[8:11], s38 offen offset:0 sc1
    buffer_load_dwordx4 v[100:103], v49, s[8:11], s38 offen offset:0 sc1
    buffer_load_dwordx4 v[104:107], v48, s[8:11], s38 offen offset:1024 sc1
    buffer_load_dwordx4 v[108:111], v49, s[8:11], s38 offen offset:1024 sc1
    buffer_load_dwordx4 v[112:115], v48, s[8:11], s38 offen offset:2048 sc1
    buffer_load_dwordx4 v[116:119], v49, s[8:11], s38 offen offset:2048 sc1
    s_waitcnt lgkmcnt(0)
    v_min3_u32 v12, v12, v13, v14
    v_min_u32 v12, v12, v15
    v_cmp_gt_u32 vcc, 6, v12
    s_cbranch_vccnz C_crdy
    C_crdy_r:
    s_setprio 3
    ds_read_b128 v[128:131], v8 offset:0
    ds_read_b128 v[132:135], v8 offset:2048
    ds_read_b128 v[136:139], v8 offset:4096
    ds_read_b128 v[140:143], v8 offset:6144
    s_waitcnt vmcnt(16) lgkmcnt(0)
    v_mfma_f32_16x16x32_bf16 v[16:19], v[64:67], v[128:131], v[16:19]
    ds_read_b128 v[144:147], v9 offset:0
    ds_read_b128 v[148:151], v9 offset:2048
    v_mfma_f32_16x16x32_bf16 v[20:23], v[64:67], v[132:135], v[20:23]
    ds_read_b128 v[152:155], v9 offset:4096
    ds_read_b128 v[156:159], v9 offset:6144
    v_mfma_f32_16x16x32_bf16 v[24:27], v[64:67], v[136:139], v[24:27]
    buffer_load_dwordx2 v[244:245], v51, s[72:75], 0 offen sc1
    v_mfma_f32_16x16x32_bf16 v[28:31], v[64:67], v[140:143], v[28:31]
    buffer_load_dwordx4 v[120:123], v48, s[8:11], s38 offen offset:3072 sc1
    v_mfma_f32_16x16x32_bf16 v[44:47], v[68:71], v[140:143], v[44:47]
    buffer_load_dwordx4 v[124:127], v49, s[8:11], s38 offen offset:3072 sc1
    s_add_u32 s38, s38, 32768
    s_and_b32 s38, s38, 0x3ffff
    s_or_b32 s38, s38, s30
    v_mfma_f32_16x16x32_bf16 v[40:43], v[68:71], v[136:139], v[40:43]
    v_mfma_f32_16x16x32_bf16 v[36:39], v[68:71], v[132:135], v[36:39]
    v_mfma_f32_16x16x32_bf16 v[32:35], v[68:71], v[128:131], v[32:35]
    s_waitcnt vmcnt(17) lgkmcnt(0)
    v_mfma_f32_16x16x32_bf16 v[16:19], v[72:75], v[144:147], v[16:19]
    ds_read_b128 v[128:131], v10 offset:0
    ds_read_b128 v[132:135], v10 offset:2048
    v_mfma_f32_16x16x32_bf16 v[20:23], v[72:75], v[148:151], v[20:23]
    ds_read_b128 v[136:139], v10 offset:4096
    ds_read_b128 v[140:143], v10 offset:6144
    v_mfma_f32_16x16x32_bf16 v[24:27], v[72:75], v[152:155], v[24:27]
    s_cmp_gt_u32 s37, 2
    s_cbranch_scc0 C2_h2
    C2_h2_r:
    buffer_load_dwordx4 v[64:67], v48, s[8:11], s38 offen offset:0 sc1
    v_mfma_f32_16x16x32_bf16 v[28:31], v[72:75], v[156:159], v[28:31]
    buffer_load_dwordx4 v[68:71], v49, s[8:11], s38 offen offset:0 sc1
    v_mfma_f32_16x16x32_bf16 v[44:47], v[76:79], v[156:159], v[44:47]
    v_mfma_f32_16x16x32_bf16 v[40:43], v[76:79], v[152:155], v[40:43]
    v_mfma_f32_16x16x32_bf16 v[36:39], v[76:79], v[148:151], v[36:39]
    v_mfma_f32_16x16x32_bf16 v[32:35], v[76:79], v[144:147], v[32:35]
    s_waitcnt vmcnt(17) lgkmcnt(0)
    v_mfma_f32_16x16x32_bf16 v[16:19], v[80:83], v[128:131], v[16:19]
    ds_read_b128 v[144:147], v11 offset:0
    ds_read_b128 v[148:151], v11 offset:2048
    v_mfma_f32_16x16x32_bf16 v[20:23], v[80:83], v[132:135], v[20:23]
    ds_read_b128 v[152:155], v11 offset:4096
    ds_read_b128 v[156:159], v11 offset:6144
    v_mfma_f32_16x16x32_bf16 v[24:27], v[80:83], v[136:139], v[24:27]
    buffer_load_dwordx4 v[72:75], v48, s[8:11], s38 offen offset:1024 sc1
    v_mfma_f32_16x16x32_bf16 v[28:31], v[80:83], v[140:143], v[28:31]
    buffer_load_dwordx4 v[76:79], v49, s[8:11], s38 offen offset:1024 sc1
    v_mfma_f32_16x16x32_bf16 v[44:47], v[84:87], v[140:143], v[44:47]
    v_mfma_f32_16x16x32_bf16 v[40:43], v[84:87], v[136:139], v[40:43]
    v_mfma_f32_16x16x32_bf16 v[36:39], v[84:87], v[132:135], v[36:39]
    v_mfma_f32_16x16x32_bf16 v[32:35], v[84:87], v[128:131], v[32:35]
    s_waitcnt vmcnt(17) lgkmcnt(0)
    v_mfma_f32_16x16x32_bf16 v[16:19], v[88:91], v[144:147], v[16:19]
    ds_read_b128 v[128:131], v8 offset:16384
    ds_read_b128 v[132:135], v8 offset:18432
    v_mfma_f32_16x16x32_bf16 v[20:23], v[88:91], v[148:151], v[20:23]
    ds_read_b128 v[136:139], v8 offset:20480
    ds_read_b128 v[140:143], v8 offset:22528
    v_mfma_f32_16x16x32_bf16 v[24:27], v[88:91], v[152:155], v[24:27]
    v_mov_b32 v1, 1
    ds_write_b32 v63, v1 offset:96
    v_mfma_f32_16x16x32_bf16 v[28:31], v[88:91], v[156:159], v[28:31]
    buffer_load_dwordx4 v[80:83], v48, s[8:11], s38 offen offset:2048 sc1
    v_mfma_f32_16x16x32_bf16 v[44:47], v[92:95], v[156:159], v[44:47]
    buffer_load_dwordx4 v[84:87], v49, s[8:11], s38 offen offset:2048 sc1
    v_mfma_f32_16x16x32_bf16 v[40:43], v[92:95], v[152:155], v[40:43]
    v_mfma_f32_16x16x32_bf16 v[36:39], v[92:95], v[148:151], v[36:39]
    v_mfma_f32_16x16x32_bf16 v[32:35], v[92:95], v[144:147], v[32:35]
    s_waitcnt vmcnt(13) lgkmcnt(1)
    v_mfma_f32_16x16x32_bf16 v[16:19], v[96:99], v[128:131], v[16:19]
    ds_read_b128 v[144:147], v9 offset:16384
    ds_read_b128 v[148:151], v9 offset:18432
    v_mfma_f32_16x16x32_bf16 v[20:23], v[96:99], v[132:135], v[20:23]
    ds_read_b128 v[152:155], v9 offset:20480
    ds_read_b128 v[156:159], v9 offset:22528
    v_mfma_f32_16x16x32_bf16 v[24:27], v[96:99], v[136:139], v[24:27]
    buffer_load_dwordx2 v[240:241], v51, s[72:75], 0 offen sc1
    v_mfma_f32_16x16x32_bf16 v[28:31], v[96:99], v[140:143], v[28:31]
    buffer_load_dwordx4 v[88:91], v48, s[8:11], s38 offen offset:3072 sc1
    v_mfma_f32_16x16x32_bf16 v[44:47], v[100:103], v[140:143], v[44:47]
    buffer_load_dwordx4 v[92:95], v49, s[8:11], s38 offen offset:3072 sc1
    s_add_u32 s38, s38, 32768
    s_and_b32 s38, s38, 0x3ffff
    s_or_b32 s38, s38, s30
    v_mfma_f32_16x16x32_bf16 v[40:43], v[100:103], v[136:139], v[40:43]
    v_mfma_f32_16x16x32_bf16 v[36:39], v[100:103], v[132:135], v[36:39]
    v_mfma_f32_16x16x32_bf16 v[32:35], v[100:103], v[128:131], v[32:35]
    s_waitcnt vmcnt(14) lgkmcnt(0)
    v_mfma_f32_16x16x32_bf16 v[16:19], v[104:107], v[144:147], v[16:19]
    ds_read_b128 v[128:131], v10 offset:16384
    ds_read_b128 v[132:135], v10 offset:18432
    v_mfma_f32_16x16x32_bf16 v[20:23], v[104:107], v[148:151], v[20:23]
    ds_read_b128 v[136:139], v10 offset:20480
    ds_read_b128 v[140:143], v10 offset:22528
    v_mfma_f32_16x16x32_bf16 v[24:27], v[104:107], v[152:155], v[24:27]
    s_cmp_gt_u32 s37, 3
    s_cbranch_scc0 C2_h3
    C2_h3_r:
    buffer_load_dwordx4 v[96:99], v48, s[8:11], s38 offen offset:0 sc1
    v_mfma_f32_16x16x32_bf16 v[28:31], v[104:107], v[156:159], v[28:31]
    buffer_load_dwordx4 v[100:103], v49, s[8:11], s38 offen offset:0 sc1
    v_mfma_f32_16x16x32_bf16 v[44:47], v[108:111], v[156:159], v[44:47]
    v_mfma_f32_16x16x32_bf16 v[40:43], v[108:111], v[152:155], v[40:43]
    v_mfma_f32_16x16x32_bf16 v[36:39], v[108:111], v[148:151], v[36:39]
    v_mfma_f32_16x16x32_bf16 v[32:35], v[108:111], v[144:147], v[32:35]
    s_waitcnt vmcnt(14) lgkmcnt(0)
    v_mfma_f32_16x16x32_bf16 v[16:19], v[112:115], v[128:131], v[16:19]
    ds_read_b128 v[144:147], v11 offset:16384
    ds_read_b128 v[148:151], v11 offset:18432
    v_mfma_f32_16x16x32_bf16 v[20:23], v[112:115], v[132:135], v[20:23]
    ds_read_b128 v[152:155], v11 offset:20480
    ds_read_b128 v[156:159], v11 offset:22528
    v_mfma_f32_16x16x32_bf16 v[24:27], v[112:115], v[136:139], v[24:27]
    buffer_load_dwordx4 v[104:107], v48, s[8:11], s38 offen offset:1024 sc1
    v_mfma_f32_16x16x32_bf16 v[28:31], v[112:115], v[140:143], v[28:31]
    buffer_load_dwordx4 v[108:111], v49, s[8:11], s38 offen offset:1024 sc1
    v_mfma_f32_16x16x32_bf16 v[44:47], v[116:119], v[140:143], v[44:47]
    v_mfma_f32_16x16x32_bf16 v[40:43], v[116:119], v[136:139], v[40:43]
    v_mfma_f32_16x16x32_bf16 v[36:39], v[116:119], v[132:135], v[36:39]
    v_mfma_f32_16x16x32_bf16 v[32:35], v[116:119], v[128:131], v[32:35]
    s_waitcnt vmcnt(13) lgkmcnt(0)
    v_mfma_f32_16x16x32_bf16 v[16:19], v[120:123], v[144:147], v[16:19]
    ds_read_b128 v[128:131], v8 offset:32768
    ds_read_b128 v[132:135], v8 offset:34816
    v_mfma_f32_16x16x32_bf16 v[20:23], v[120:123], v[148:151], v[20:23]
    ds_read_b128 v[136:139], v8 offset:36864
    ds_read_b128 v[140:143], v8 offset:38912
    v_mfma_f32_16x16x32_bf16 v[24:27], v[120:123], v[152:155], v[24:27]
    v_mov_b32 v1, 2
    ds_write_b32 v63, v1 offset:96
    v_mfma_f32_16x16x32_bf16 v[28:31], v[120:123], v[156:159], v[28:31]
    ds_read_b128 v[56:59], v62 offset:96
    v_mfma_f32_16x16x32_bf16 v[44:47], v[124:127], v[156:159], v[44:47]
    buffer_load_dwordx4 v[112:115], v48, s[8:11], s38 offen offset:2048 sc1
    v_mfma_f32_16x16x32_bf16 v[40:43], v[124:127], v[152:155], v[40:43]
    buffer_load_dwordx4 v[116:119], v49, s[8:11], s38 offen offset:2048 sc1
    v_mfma_f32_16x16x32_bf16 v[36:39], v[124:127], v[148:151], v[36:39]
    v_mfma_f32_16x16x32_bf16 v[32:35], v[124:127], v[144:147], v[32:35]
    s_waitcnt vmcnt(13) lgkmcnt(0)
    v_mfma_f32_16x16x32_bf16 v[16:19], v[64:67], v[128:131], v[16:19]
    ds_read_b128 v[144:147], v9 offset:32768
    ds_read_b128 v[148:151], v9 offset:34816
    v_mfma_f32_16x16x32_bf16 v[20:23], v[64:67], v[132:135], v[20:23]
    ds_read_b128 v[152:155], v9 offset:36864
    ds_read_b128 v[156:159], v9 offset:38912
    v_mfma_f32_16x16x32_bf16 v[24:27], v[64:67], v[136:139], v[24:27]
    buffer_load_dwordx2 v[242:243], v51, s[72:75], 0 offen sc1
    v_cmp_eq_u32 vcc, v244, v54
    v_cmp_eq_u32 s[54:55], v245, v55
    s_nop 0
    s_and_b64 s[54:55], s[54:55], vcc
    s_or_b32 s54, s54, 15
    s_ff0_i32_b64 s7, s[54:55]
    s_lshr_b32 s7, s7, 2
    s_max_u32 s37, s37, s7
    v_mfma_f32_16x16x32_bf16 v[28:31], v[64:67], v[140:143], v[28:31]
    buffer_load_dwordx4 v[120:123], v48, s[8:11], s38 offen offset:3072 sc1
    buffer_load_dwordx4 v[124:127], v49, s[8:11], s38 offen offset:3072 sc1
    s_add_u32 s38, s38, 32768
    s_and_b32 s38, s38, 0x3ffff
    s_or_b32 s38, s38, s30
    v_mfma_f32_16x16x32_bf16 v[44:47], v[68:71], v[140:143], v[44:47]
    v_min3_u32 v56, v56, v57, v58
    v_min_u32 v56, v56, v59
    v_mfma_f32_16x16x32_bf16 v[40:43], v[68:71], v[136:139], v[40:43]
    v_cmp_gt_u32 vcc, 1, v56
    v_mfma_f32_16x16x32_bf16 v[36:39], v[68:71], v[132:135], v[36:39]
    s_cbranch_vccnz C2_p2
    C2_p2_r:
    v_mfma_f32_16x16x32_bf16 v[32:35], v[68:71], v[128:131], v[32:35]
    ds_write_b128 v52, v[160:163] offset:0
    s_waitcnt vmcnt(14) lgkmcnt(1)
    v_mfma_f32_16x16x32_bf16 v[16:19], v[72:75], v[144:147], v[16:19]
    ds_read_b128 v[128:131], v10 offset:32768
    ds_read_b128 v[132:135], v10 offset:34816
    v_mfma_f32_16x16x32_bf16 v[20:23], v[72:75], v[148:151], v[20:23]
    ds_read_b128 v[136:139], v10 offset:36864
    ds_read_b128 v[140:143], v10 offset:38912
    v_mfma_f32_16x16x32_bf16 v[24:27], v[72:75], v[152:155], v[24:27]
    s_cmp_gt_u32 s37, 4
    s_cbranch_scc0 C2_h4
    C2_h4_r:
    buffer_load_dwordx4 v[64:67], v48, s[8:11], s38 offen offset:0 sc1
    v_mfma_f32_16x16x32_bf16 v[28:31], v[72:75], v[156:159], v[28:31]
    buffer_load_dwordx4 v[68:71], v49, s[8:11], s38 offen offset:0 sc1
    v_mfma_f32_16x16x32_bf16 v[44:47], v[76:79], v[156:159], v[44:47]
    ds_write_b128 v52, v[164:167] offset:1024
    v_mfma_f32_16x16x32_bf16 v[40:43], v[76:79], v[152:155], v[40:43]
    v_mfma_f32_16x16x32_bf16 v[36:39], v[76:79], v[148:151], v[36:39]
    v_mfma_f32_16x16x32_bf16 v[32:35], v[76:79], v[144:147], v[32:35]
    s_waitcnt vmcnt(14) lgkmcnt(1)
    v_mfma_f32_16x16x32_bf16 v[16:19], v[80:83], v[128:131], v[16:19]
    ds_read_b128 v[144:147], v11 offset:32768
    ds_read_b128 v[148:151], v11 offset:34816
    v_mfma_f32_16x16x32_bf16 v[20:23], v[80:83], v[132:135], v[20:23]
    ds_read_b128 v[152:155], v11 offset:36864
    ds_read_b128 v[156:159], v11 offset:38912
    v_mfma_f32_16x16x32_bf16 v[24:27], v[80:83], v[136:139], v[24:27]
    buffer_load_dwordx4 v[72:75], v48, s[8:11], s38 offen offset:1024 sc1
    v_mfma_f32_16x16x32_bf16 v[28:31], v[80:83], v[140:143], v[28:31]
    buffer_load_dwordx4 v[76:79], v49, s[8:11], s38 offen offset:1024 sc1
    v_mfma_f32_16x16x32_bf16 v[44:47], v[84:87], v[140:143], v[44:47]
    ds_write_b128 v52, v[168:171] offset:8192
    v_mfma_f32_16x16x32_bf16 v[40:43], v[84:87], v[136:139], v[40:43]
    v_mfma_f32_16x16x32_bf16 v[36:39], v[84:87], v[132:135], v[36:39]
    v_mfma_f32_16x16x32_bf16 v[32:35], v[84:87], v[128:131], v[32:35]
    s_waitcnt vmcnt(13) lgkmcnt(1)
    v_mfma_f32_16x16x32_bf16 v[16:19], v[88:91], v[144:147], v[16:19]
    ds_read_b128 v[128:131], v4 offset:0
    ds_read_b128 v[132:135], v4 offset:2048
    v_mfma_f32_16x16x32_bf16 v[20:23], v[88:91], v[148:151], v[20:23]
    ds_read_b128 v[136:139], v4 offset:4096
    ds_read_b128 v[140:143], v4 offset:6144
    v_mfma_f32_16x16x32_bf16 v[24:27], v[88:91], v[152:155], v[24:27]
    ds_write_b128 v52, v[172:175] offset:9216
    v_mfma_f32_16x16x32_bf16 v[28:31], v[88:91], v[156:159], v[28:31]
    v_mov_b32 v1, 3
    ds_write_b32 v63, v1 offset:96
    v_mfma_f32_16x16x32_bf16 v[44:47], v[92:95], v[156:159], v[44:47]
    ds_read_b128 v[56:59], v62 offset:96
    v_mfma_f32_16x16x32_bf16 v[40:43], v[92:95], v[152:155], v[40:43]
    buffer_load_dwordx4 v[80:83], v48, s[8:11], s38 offen offset:2048 sc1
    v_mfma_f32_16x16x32_bf16 v[36:39], v[92:95], v[148:151], v[36:39]
    buffer_load_dwordx4 v[84:87], v49, s[8:11], s38 offen offset:2048 sc1
    v_mfma_f32_16x16x32_bf16 v[32:35], v[92:95], v[144:147], v[32:35]
    s_waitcnt vmcnt(13) lgkmcnt(0)
    v_mfma_f32_16x16x32_bf16 v[16:19], v[96:99], v[128:131], v[16:19]
    ds_read_b128 v[144:147], v5 offset:0
    ds_read_b128 v[148:151], v5 offset:2048
    v_mfma_f32_16x16x32_bf16 v[20:23], v[96:99], v[132:135], v[20:23]
    ds_read_b128 v[152:155], v5 offset:4096
    ds_read_b128 v[156:159], v5 offset:6144
    v_mfma_f32_16x16x32_bf16 v[24:27], v[96:99], v[136:139], v[24:27]
    v_cmp_eq_u32 vcc, v240, v54
    v_cmp_eq_u32 s[54:55], v241, v55
    s_nop 0
    s_and_b64 s[54:55], s[54:55], vcc
    s_or_b32 s54, s54, 15
    s_ff0_i32_b64 s7, s[54:55]
    s_lshr_b32 s7, s7, 2
    s_max_u32 s37, s37, s7
    buffer_load_dwordx4 v[88:91], v48, s[8:11], s38 offen offset:3072 sc1
    v_mfma_f32_16x16x32_bf16 v[28:31], v[96:99], v[140:143], v[28:31]
    buffer_load_dwordx4 v[92:95], v49, s[8:11], s38 offen offset:3072 sc1
    s_add_u32 s38, s38, 32768
    s_and_b32 s38, s38, 0x3ffff
    s_or_b32 s38, s38, s30
    v_min3_u32 v56, v56, v57, v58
    v_mfma_f32_16x16x32_bf16 v[44:47], v[100:103], v[140:143], v[44:47]
    v_min_u32 v56, v56, v59
    v_mfma_f32_16x16x32_bf16 v[40:43], v[100:103], v[136:139], v[40:43]
    v_cmp_gt_u32 vcc, 2, v56
    v_mfma_f32_16x16x32_bf16 v[36:39], v[100:103], v[132:135], v[36:39]
    s_cbranch_vccnz C2_p3
    C2_p3_r:
    v_mfma_f32_16x16x32_bf16 v[32:35], v[100:103], v[128:131], v[32:35]
    ds_write_b128 v52, v[176:179] offset:16384
    s_waitcnt vmcnt(13) lgkmcnt(1)
    v_mfma_f32_16x16x32_bf16 v[16:19], v[104:107], v[144:147], v[16:19]
    ds_read_b128 v[128:131], v6 offset:0
    ds_read_b128 v[132:135], v6 offset:2048
    v_mfma_f32_16x16x32_bf16 v[20:23], v[104:107], v[148:151], v[20:23]
    ds_read_b128 v[136:139], v6 offset:4096
    ds_read_b128 v[140:143], v6 offset:6144
    v_mfma_f32_16x16x32_bf16 v[24:27], v[104:107], v[152:155], v[24:27]
    s_cmp_gt_u32 s37, 5
    s_cbranch_scc0 C2_h5
    C2_h5_r:
    buffer_load_dwordx4 v[96:99], v48, s[8:11], s38 offen offset:0 sc1
    v_mfma_f32_16x16x32_bf16 v[28:31], v[104:107], v[156:159], v[28:31]
    buffer_load_dwordx4 v[100:103], v49, s[8:11], s38 offen offset:0 sc1
    v_mfma_f32_16x16x32_bf16 v[44:47], v[108:111], v[156:159], v[44:47]
    ds_write_b128 v52, v[180:183] offset:17408
    v_mfma_f32_16x16x32_bf16 v[40:43], v[108:111], v[152:155], v[40:43]
    v_mfma_f32_16x16x32_bf16 v[36:39], v[108:111], v[148:151], v[36:39]
    v_mfma_f32_16x16x32_bf16 v[32:35], v[108:111], v[144:147], v[32:35]
    s_waitcnt vmcnt(13) lgkmcnt(1)
    v_mfma_f32_16x16x32_bf16 v[16:19], v[112:115], v[128:131], v[16:19]
    ds_read_b128 v[144:147], v7 offset:0
    ds_read_b128 v[148:151], v7 offset:2048
    v_mfma_f32_16x16x32_bf16 v[20:23], v[112:115], v[132:135], v[20:23]
    ds_read_b128 v[152:155], v7 offset:4096
    ds_read_b128 v[156:159], v7 offset:6144
    v_mfma_f32_16x16x32_bf16 v[24:27], v[112:115], v[136:139], v[24:27]
    buffer_load_dwordx4 v[104:107], v48, s[8:11], s38 offen offset:1024 sc1
    v_mfma_f32_16x16x32_bf16 v[28:31], v[112:115], v[140:143], v[28:31]
    buffer_load_dwordx4 v[108:111], v49, s[8:11], s38 offen offset:1024 sc1
    v_mfma_f32_16x16x32_bf16 v[44:47], v[116:119], v[140:143], v[44:47]
    ds_write_b128 v52, v[184:187] offset:24576
    v_mfma_f32_16x16x32_bf16 v[40:43], v[116:119], v[136:139], v[40:43]
    v_mfma_f32_16x16x32_bf16 v[36:39], v[116:119], v[132:135], v[36:39]
    v_mfma_f32_16x16x32_bf16 v[32:35], v[116:119], v[128:131], v[32:35]
    s_waitcnt vmcnt(12) lgkmcnt(1)
    v_mfma_f32_16x16x32_bf16 v[16:19], v[120:123], v[144:147], v[16:19]
    ds_read_b128 v[128:131], v4 offset:16384
    ds_read_b128 v[132:135], v4 offset:18432
    v_mfma_f32_16x16x32_bf16 v[20:23], v[120:123], v[148:151], v[20:23]
    ds_read_b128 v[136:139], v4 offset:20480
    ds_read_b128 v[140:143], v4 offset:22528
    v_mfma_f32_16x16x32_bf16 v[24:27], v[120:123], v[152:155], v[24:27]
    ds_write_b128 v52, v[188:191] offset:25600
    v_mfma_f32_16x16x32_bf16 v[28:31], v[120:123], v[156:159], v[28:31]
    v_mov_b32 v1, 4
    ds_write_b32 v63, v1 offset:96
    v_mfma_f32_16x16x32_bf16 v[44:47], v[124:127], v[156:159], v[44:47]
    ds_read_b128 v[56:59], v62 offset:96
    v_mfma_f32_16x16x32_bf16 v[40:43], v[124:127], v[152:155], v[40:43]
    buffer_load_dwordx4 v[112:115], v48, s[8:11], s38 offen offset:2048 sc1
    v_mfma_f32_16x16x32_bf16 v[36:39], v[124:127], v[148:151], v[36:39]
    buffer_load_dwordx4 v[116:119], v49, s[8:11], s38 offen offset:2048 sc1
    v_mfma_f32_16x16x32_bf16 v[32:35], v[124:127], v[144:147], v[32:35]
    s_waitcnt vmcnt(12) lgkmcnt(0)
    v_mfma_f32_16x16x32_bf16 v[16:19], v[64:67], v[128:131], v[16:19]
    ds_read_b128 v[144:147], v5 offset:16384
    ds_read_b128 v[148:151], v5 offset:18432
    v_mfma_f32_16x16x32_bf16 v[20:23], v[64:67], v[132:135], v[20:23]
    ds_read_b128 v[152:155], v5 offset:20480
    ds_read_b128 v[156:159], v5 offset:22528
    v_mfma_f32_16x16x32_bf16 v[24:27], v[64:67], v[136:139], v[24:27]
    v_cmp_eq_u32 vcc, v242, v54
    v_cmp_eq_u32 s[54:55], v243, v55
    s_nop 0
    s_and_b64 s[54:55], s[54:55], vcc
    s_or_b32 s54, s54, 15
    s_ff0_i32_b64 s7, s[54:55]
    s_lshr_b32 s7, s7, 2
    s_max_u32 s37, s37, s7
    buffer_load_dwordx4 v[120:123], v48, s[8:11], s38 offen offset:3072 sc1
    v_mfma_f32_16x16x32_bf16 v[28:31], v[64:67], v[140:143], v[28:31]
    buffer_load_dwordx4 v[124:127], v49, s[8:11], s38 offen offset:3072 sc1
    s_add_u32 s38, s38, 32768
    s_and_b32 s38, s38, 0x3ffff
    s_or_b32 s38, s38, s30
    v_min3_u32 v56, v56, v57, v58
    v_mfma_f32_16x16x32_bf16 v[44:47], v[68:71], v[140:143], v[44:47]
    v_min_u32 v56, v56, v59
    v_mfma_f32_16x16x32_bf16 v[40:43], v[68:71], v[136:139], v[40:43]
    v_cmp_gt_u32 vcc, 3, v56
    v_mfma_f32_16x16x32_bf16 v[36:39], v[68:71], v[132:135], v[36:39]
    s_cbranch_vccnz C2_p4
    C2_p4_r:
    v_mfma_f32_16x16x32_bf16 v[32:35], v[68:71], v[128:131], v[32:35]
    ds_write_b128 v52, v[192:195] offset:32768
    s_waitcnt vmcnt(12) lgkmcnt(1)
    v_mfma_f32_16x16x32_bf16 v[16:19], v[72:75], v[144:147], v[16:19]
    ds_read_b128 v[128:131], v6 offset:16384
    ds_read_b128 v[132:135], v6 offset:18432
    v_mfma_f32_16x16x32_bf16 v[20:23], v[72:75], v[148:151], v[20:23]
    ds_read_b128 v[136:139], v6 offset:20480
    ds_read_b128 v[140:143], v6 offset:22528
    v_mfma_f32_16x16x32_bf16 v[24:27], v[72:75], v[152:155], v[24:27]
    s_cmp_gt_u32 s37, 6
    s_cbranch_scc0 C2_h6
    C2_h6_r:
    buffer_load_dwordx4 v[64:67], v48, s[8:11], s38 offen offset:0 sc1
    v_mfma_f32_16x16x32_bf16 v[28:31], v[72:75], v[156:159], v[28:31]
    buffer_load_dwordx4 v[68:71], v49, s[8:11], s38 offen offset:0 sc1
    v_mfma_f32_16x16x32_bf16 v[44:47], v[76:79], v[156:159], v[44:47]
    ds_write_b128 v52, v[196:199] offset:33792
    v_mfma_f32_16x16x32_bf16 v[40:43], v[76:79], v[152:155], v[40:43]
    v_mfma_f32_16x16x32_bf16 v[36:39], v[76:79], v[148:151], v[36:39]
    v_mfma_f32_16x16x32_bf16 v[32:35], v[76:79], v[144:147], v[32:35]
    s_waitcnt vmcnt(12) lgkmcnt(1)
    v_mfma_f32_16x16x32_bf16 v[16:19], v[80:83], v[128:131], v[16:19]
    ds_read_b128 v[144:147], v7 offset:16384
    ds_read_b128 v[148:151], v7 offset:18432
    v_mfma_f32_16x16x32_bf16 v[20:23], v[80:83], v[132:135], v[20:23]
    ds_read_b128 v[152:155], v7 offset:20480
    ds_read_b128 v[156:159], v7 offset:22528
    v_mfma_f32_16x16x32_bf16 v[24:27], v[80:83], v[136:139], v[24:27]
    buffer_load_dwordx4 v[72:75], v48, s[8:11], s38 offen offset:1024 sc1
    v_mfma_f32_16x16x32_bf16 v[28:31], v[80:83], v[140:143], v[28:31]
    buffer_load_dwordx4 v[76:79], v49, s[8:11], s38 offen offset:1024 sc1
    v_mfma_f32_16x16x32_bf16 v[44:47], v[84:87], v[140:143], v[44:47]
    ds_write_b128 v52, v[200:203] offset:40960
    v_mfma_f32_16x16x32_bf16 v[40:43], v[84:87], v[136:139], v[40:43]
    v_mfma_f32_16x16x32_bf16 v[36:39], v[84:87], v[132:135], v[36:39]
    v_mfma_f32_16x16x32_bf16 v[32:35], v[84:87], v[128:131], v[32:35]
    s_waitcnt vmcnt(12) lgkmcnt(1)
    v_mfma_f32_16x16x32_bf16 v[16:19], v[88:91], v[144:147], v[16:19]
    ds_read_b128 v[128:131], v4 offset:32768
    ds_read_b128 v[132:135], v4 offset:34816
    v_mfma_f32_16x16x32_bf16 v[20:23], v[88:91], v[148:151], v[20:23]
    ds_read_b128 v[136:139], v4 offset:36864
    ds_read_b128 v[140:143], v4 offset:38912
    v_mfma_f32_16x16x32_bf16 v[24:27], v[88:91], v[152:155], v[24:27]
    ds_write_b128 v52, v[204:207] offset:41984
    v_mfma_f32_16x16x32_bf16 v[28:31], v[88:91], v[156:159], v[28:31]
    v_mov_b32 v1, 5
    ds_write_b32 v63, v1 offset:96
    v_mfma_f32_16x16x32_bf16 v[44:47], v[92:95], v[156:159], v[44:47]
    ds_read_b128 v[56:59], v62 offset:96
    v_mfma_f32_16x16x32_bf16 v[40:43], v[92:95], v[152:155], v[40:43]
    buffer_load_dwordx4 v[80:83], v48, s[8:11], s38 offen offset:2048 sc1
    v_mfma_f32_16x16x32_bf16 v[36:39], v[92:95], v[148:151], v[36:39]
    buffer_load_dwordx4 v[84:87], v49, s[8:11], s38 offen offset:2048 sc1
    v_mfma_f32_16x16x32_bf16 v[32:35], v[92:95], v[144:147], v[32:35]
    s_waitcnt vmcnt(12) lgkmcnt(0)
    v_mfma_f32_16x16x32_bf16 v[16:19], v[96:99], v[128:131], v[16:19]
    ds_read_b128 v[144:147], v5 offset:32768
    ds_read_b128 v[148:151], v5 offset:34816
    v_mfma_f32_16x16x32_bf16 v[20:23], v[96:99], v[132:135], v[20:23]
    ds_read_b128 v[152:155], v5 offset:36864
    ds_read_b128 v[156:159], v5 offset:38912
    v_mfma_f32_16x16x32_bf16 v[24:27], v[96:99], v[136:139], v[24:27]
    buffer_load_dwordx4 v[88:91], v48, s[8:11], s38 offen offset:3072 sc1
    buffer_load_dwordx4 v[92:95], v49, s[8:11], s38 offen offset:3072 sc1
    s_add_u32 s38, s38, 32768
    s_and_b32 s38, s38, 0x3ffff
    s_or_b32 s38, s38, s30
    v_mfma_f32_16x16x32_bf16 v[28:31], v[96:99], v[140:143], v[28:31]
    v_min3_u32 v56, v56, v57, v58
    v_mfma_f32_16x16x32_bf16 v[44:47], v[100:103], v[140:143], v[44:47]
    v_min_u32 v56, v56, v59
    v_mfma_f32_16x16x32_bf16 v[40:43], v[100:103], v[136:139], v[40:43]
    v_cmp_gt_u32 vcc, 4, v56
    v_mfma_f32_16x16x32_bf16 v[36:39], v[100:103], v[132:135], v[36:39]
    s_cbranch_vccnz C2_p5
    C2_p5_r:
    v_mfma_f32_16x16x32_bf16 v[32:35], v[100:103], v[128:131], v[32:35]
    ds_write_b128 v53, v[224:227] offset:0
    s_waitcnt vmcnt(12) lgkmcnt(1)
    v_mfma_f32_16x16x32_bf16 v[16:19], v[104:107], v[144:147], v[16:19]
    ds_read_b128 v[128:131], v6 offset:32768
    ds_read_b128 v[132:135], v6 offset:34816
    v_mfma_f32_16x16x32_bf16 v[20:23], v[104:107], v[148:151], v[20:23]
    ds_read_b128 v[136:139], v6 offset:36864
    ds_read_b128 v[140:143], v6 offset:38912
    v_mfma_f32_16x16x32_bf16 v[24:27], v[104:107], v[152:155], v[24:27]
    s_cmp_gt_u32 s37, 7
    s_cbranch_scc0 C2_h7
    C2_h7_r:
    buffer_load_dwordx4 v[96:99], v48, s[8:11], s38 offen offset:0 sc1
    v_mfma_f32_16x16x32_bf16 v[28:31], v[104:107], v[156:159], v[28:31]
    buffer_load_dwordx4 v[100:103], v49, s[8:11], s38 offen offset:0 sc1
    v_mfma_f32_16x16x32_bf16 v[44:47], v[108:111], v[156:159], v[44:47]
    ds_write_b128 v53, v[228:231] offset:1024
    v_mfma_f32_16x16x32_bf16 v[40:43], v[108:111], v[152:155], v[40:43]
    v_mfma_f32_16x16x32_bf16 v[36:39], v[108:111], v[148:151], v[36:39]
    v_mfma_f32_16x16x32_bf16 v[32:35], v[108:111], v[144:147], v[32:35]
    s_waitcnt vmcnt(12) lgkmcnt(1)
    v_mfma_f32_16x16x32_bf16 v[16:19], v[112:115], v[128:131], v[16:19]
    ds_read_b128 v[144:147], v7 offset:32768
    ds_read_b128 v[148:151], v7 offset:34816
    v_mfma_f32_16x16x32_bf16 v[20:23], v[112:115], v[132:135], v[20:23]
    ds_read_b128 v[152:155], v7 offset:36864
    ds_read_b128 v[156:159], v7 offset:38912
    v_mfma_f32_16x16x32_bf16 v[24:27], v[112:115], v[136:139], v[24:27]
    buffer_load_dwordx4 v[104:107], v48, s[8:11], s38 offen offset:1024 sc1
    v_mfma_f32_16x16x32_bf16 v[28:31], v[112:115], v[140:143], v[28:31]
    buffer_load_dwordx4 v[108:111], v49, s[8:11], s38 offen offset:1024 sc1
    v_mfma_f32_16x16x32_bf16 v[44:47], v[116:119], v[140:143], v[44:47]
    ds_write_b128 v53, v[232:235] offset:8192
    v_mfma_f32_16x16x32_bf16 v[40:43], v[116:119], v[136:139], v[40:43]
    v_mfma_f32_16x16x32_bf16 v[36:39], v[116:119], v[132:135], v[36:39]
    v_mfma_f32_16x16x32_bf16 v[32:35], v[116:119], v[128:131], v[32:35]
    s_waitcnt vmcnt(12) lgkmcnt(1)
    v_mfma_f32_16x16x32_bf16 v[16:19], v[120:123], v[144:147], v[16:19]
    ds_read_b128 v[128:131], v8 offset:0
    ds_read_b128 v[132:135], v8 offset:2048
    v_mfma_f32_16x16x32_bf16 v[20:23], v[120:123], v[148:151], v[20:23]
    ds_read_b128 v[136:139], v8 offset:4096
    ds_read_b128 v[140:143], v8 offset:6144
    v_mfma_f32_16x16x32_bf16 v[24:27], v[120:123], v[152:155], v[24:27]
    ds_write_b128 v53, v[236:239] offset:9216
    v_mfma_f32_16x16x32_bf16 v[28:31], v[120:123], v[156:159], v[28:31]
    v_mov_b32 v1, 6
    ds_write_b32 v63, v1 offset:96
    v_mfma_f32_16x16x32_bf16 v[44:47], v[124:127], v[156:159], v[44:47]
    ds_read_b128 v[56:59], v62 offset:96
    v_mfma_f32_16x16x32_bf16 v[40:43], v[124:127], v[152:155], v[40:43]
    buffer_load_dwordx4 v[112:115], v48, s[8:11], s38 offen offset:2048 sc1
    v_mfma_f32_16x16x32_bf16 v[36:39], v[124:127], v[148:151], v[36:39]
    buffer_load_dwordx4 v[116:119], v49, s[8:11], s38 offen offset:2048 sc1
    v_mfma_f32_16x16x32_bf16 v[32:35], v[124:127], v[144:147], v[32:35]
    s_waitcnt vmcnt(12) lgkmcnt(0)
    v_mfma_f32_16x16x32_bf16 v[16:19], v[64:67], v[128:131], v[16:19]
    ds_read_b128 v[144:147], v9 offset:0
    ds_read_b128 v[148:151], v9 offset:2048
    v_mfma_f32_16x16x32_bf16 v[20:23], v[64:67], v[132:135], v[20:23]
    ds_read_b128 v[152:155], v9 offset:4096
    ds_read_b128 v[156:159], v9 offset:6144
    v_mfma_f32_16x16x32_bf16 v[24:27], v[64:67], v[136:139], v[24:27]
    buffer_load_dwordx4 v[120:123], v48, s[8:11], s38 offen offset:3072 sc1
    buffer_load_dwordx4 v[124:127], v49, s[8:11], s38 offen offset:3072 sc1
    s_add_u32 s38, s38, 32768
    s_and_b32 s38, s38, 0x3ffff
    s_or_b32 s38, s38, s31
    v_mfma_f32_16x16x32_bf16 v[28:31], v[64:67], v[140:143], v[28:31]
    v_min3_u32 v56, v56, v57, v58
    v_mfma_f32_16x16x32_bf16 v[44:47], v[68:71], v[140:143], v[44:47]
    v_min_u32 v56, v56, v59
    v_mfma_f32_16x16x32_bf16 v[40:43], v[68:71], v[136:139], v[40:43]
    v_cmp_gt_u32 vcc, 5, v56
    v_mfma_f32_16x16x32_bf16 v[36:39], v[68:71], v[132:135], v[36:39]
    s_cbranch_vccnz C2_p6
    C2_p6_r:
    v_mfma_f32_16x16x32_bf16 v[32:35], v[68:71], v[128:131], v[32:35]
    ds_write_b128 v53, v[208:211] offset:16384
    s_waitcnt vmcnt(12) lgkmcnt(1)
    v_mfma_f32_16x16x32_bf16 v[16:19], v[72:75], v[144:147], v[16:19]
    ds_read_b128 v[128:131], v10 offset:0
    ds_read_b128 v[132:135], v10 offset:2048
    v_mfma_f32_16x16x32_bf16 v[20:23], v[72:75], v[148:151], v[20:23]
    ds_read_b128 v[136:139], v10 offset:4096
    ds_read_b128 v[140:143], v10 offset:6144
    v_mfma_f32_16x16x32_bf16 v[24:27], v[72:75], v[152:155], v[24:27]
    s_cmp_gt_u32 s37, 8
    s_cbranch_scc0 C2_h8
    C2_h8_r:
    buffer_load_dwordx4 v[64:67], v48, s[8:11], s38 offen offset:0 sc1
    v_mfma_f32_16x16x32_bf16 v[28:31], v[72:75], v[156:159], v[28:31]
    buffer_load_dwordx4 v[68:71], v49, s[8:11], s38 offen offset:0 sc1
    v_mfma_f32_16x16x32_bf16 v[44:47], v[76:79], v[156:159], v[44:47]
    ds_write_b128 v53, v[212:215] offset:17408
    v_mfma_f32_16x16x32_bf16 v[40:43], v[76:79], v[152:155], v[40:43]
    v_mfma_f32_16x16x32_bf16 v[36:39], v[76:79], v[148:151], v[36:39]
    v_mfma_f32_16x16x32_bf16 v[32:35], v[76:79], v[144:147], v[32:35]
    s_waitcnt vmcnt(12) lgkmcnt(1)
    v_mfma_f32_16x16x32_bf16 v[16:19], v[80:83], v[128:131], v[16:19]
    ds_read_b128 v[144:147], v11 offset:0
    ds_read_b128 v[148:151], v11 offset:2048
    v_mfma_f32_16x16x32_bf16 v[20:23], v[80:83], v[132:135], v[20:23]
    ds_read_b128 v[152:155], v11 offset:4096
    ds_read_b128 v[156:159], v11 offset:6144
    v_mfma_f32_16x16x32_bf16 v[24:27], v[80:83], v[136:139], v[24:27]
    buffer_load_dwordx4 v[72:75], v48, s[8:11], s38 offen offset:1024 sc1
    v_mfma_f32_16x16x32_bf16 v[28:31], v[80:83], v[140:143], v[28:31]
    buffer_load_dwordx4 v[76:79], v49, s[8:11], s38 offen offset:1024 sc1
    v_mfma_f32_16x16x32_bf16 v[44:47], v[84:87], v[140:143], v[44:47]
    ds_write_b128 v53, v[216:219] offset:24576
    v_mfma_f32_16x16x32_bf16 v[40:43], v[84:87], v[136:139], v[40:43]
    v_mfma_f32_16x16x32_bf16 v[36:39], v[84:87], v[132:135], v[36:39]
    v_mfma_f32_16x16x32_bf16 v[32:35], v[84:87], v[128:131], v[32:35]
    s_waitcnt vmcnt(12) lgkmcnt(1)
    v_mfma_f32_16x16x32_bf16 v[16:19], v[88:91], v[144:147], v[16:19]
    ds_read_b128 v[128:131], v8 offset:16384
    ds_read_b128 v[132:135], v8 offset:18432
    v_mfma_f32_16x16x32_bf16 v[20:23], v[88:91], v[148:151], v[20:23]
    ds_read_b128 v[136:139], v8 offset:20480
    ds_read_b128 v[140:143], v8 offset:22528
    v_mfma_f32_16x16x32_bf16 v[24:27], v[88:91], v[152:155], v[24:27]
    ds_write_b128 v53, v[220:223] offset:25600
    v_mfma_f32_16x16x32_bf16 v[28:31], v[88:91], v[156:159], v[28:31]
    v_mov_b32 v1, 7
    ds_write_b32 v63, v1 offset:96
    v_mfma_f32_16x16x32_bf16 v[44:47], v[92:95], v[156:159], v[44:47]
    ds_read_b128 v[56:59], v62 offset:96
    v_mfma_f32_16x16x32_bf16 v[40:43], v[92:95], v[152:155], v[40:43]
    buffer_load_dwordx4 v[80:83], v48, s[8:11], s38 offen offset:2048 sc1
    v_mfma_f32_16x16x32_bf16 v[36:39], v[92:95], v[148:151], v[36:39]
    buffer_load_dwordx4 v[84:87], v49, s[8:11], s38 offen offset:2048 sc1
    v_mfma_f32_16x16x32_bf16 v[32:35], v[92:95], v[144:147], v[32:35]
    s_waitcnt vmcnt(12) lgkmcnt(0)
    v_mfma_f32_16x16x32_bf16 v[16:19], v[96:99], v[128:131], v[16:19]
    ds_read_b128 v[144:147], v9 offset:16384
    ds_read_b128 v[148:151], v9 offset:18432
    v_mfma_f32_16x16x32_bf16 v[20:23], v[96:99], v[132:135], v[20:23]
    ds_read_b128 v[152:155], v9 offset:20480
    ds_read_b128 v[156:159], v9 offset:22528
    v_mfma_f32_16x16x32_bf16 v[24:27], v[96:99], v[136:139], v[24:27]
    buffer_load_dwordx4 v[88:91], v48, s[8:11], s38 offen offset:3072 sc1
    v_mfma_f32_16x16x32_bf16 v[28:31], v[96:99], v[140:143], v[28:31]
    buffer_load_dwordx4 v[92:95], v49, s[8:11], s38 offen offset:3072 sc1
    s_add_u32 s38, s38, 32768
    s_and_b32 s38, s38, 0x3ffff
    s_or_b32 s38, s38, s31
    v_mfma_f32_16x16x32_bf16 v[44:47], v[100:103], v[140:143], v[44:47]
    v_min3_u32 v56, v56, v57, v58
    v_mfma_f32_16x16x32_bf16 v[40:43], v[100:103], v[136:139], v[40:43]
    v_min_u32 v56, v56, v59
    v_mfma_f32_16x16x32_bf16 v[36:39], v[100:103], v[132:135], v[36:39]
    v_cmp_gt_u32 vcc, 6, v56
    v_mfma_f32_16x16x32_bf16 v[32:35], v[100:103], v[128:131], v[32:35]
    s_cbranch_vccnz C2_p7
    C2_p7_r:
    s_waitcnt vmcnt(12) lgkmcnt(0)
    v_mfma_f32_16x16x32_bf16 v[16:19], v[104:107], v[144:147], v[16:19]
    ds_read_b128 v[128:131], v10 offset:16384
    ds_read_b128 v[132:135], v10 offset:18432
    v_mfma_f32_16x16x32_bf16 v[20:23], v[104:107], v[148:151], v[20:23]
    ds_read_b128 v[136:139], v10 offset:20480
    ds_read_b128 v[140:143], v10 offset:22528
    v_mfma_f32_16x16x32_bf16 v[24:27], v[104:107], v[152:155], v[24:27]
    s_cmp_gt_u32 s37, 9
    s_cbranch_scc0 C2_h9
    C2_h9_r:
    buffer_load_dwordx4 v[96:99], v48, s[8:11], s38 offen offset:0 sc1
    v_mfma_f32_16x16x32_bf16 v[28:31], v[104:107], v[156:159], v[28:31]
    buffer_load_dwordx4 v[100:103], v49, s[8:11], s38 offen offset:0 sc1
    v_mfma_f32_16x16x32_bf16 v[44:47], v[108:111], v[156:159], v[44:47]
    v_mfma_f32_16x16x32_bf16 v[40:43], v[108:111], v[152:155], v[40:43]
    v_mfma_f32_16x16x32_bf16 v[36:39], v[108:111], v[148:151], v[36:39]
    v_mfma_f32_16x16x32_bf16 v[32:35], v[108:111], v[144:147], v[32:35]
    s_waitcnt vmcnt(12) lgkmcnt(0)
    v_mfma_f32_16x16x32_bf16 v[16:19], v[112:115], v[128:131], v[16:19]
    ds_read_b128 v[144:147], v11 offset:16384
    ds_read_b128 v[148:151], v11 offset:18432
    v_mfma_f32_16x16x32_bf16 v[20:23], v[112:115], v[132:135], v[20:23]
    ds_read_b128 v[152:155], v11 offset:20480
    ds_read_b128 v[156:159], v11 offset:22528
    v_mfma_f32_16x16x32_bf16 v[24:27], v[112:115], v[136:139], v[24:27]
    buffer_load_dwordx4 v[104:107], v48, s[8:11], s38 offen offset:1024 sc1
    v_mfma_f32_16x16x32_bf16 v[28:31], v[112:115], v[140:143], v[28:31]
    buffer_load_dwordx4 v[108:111], v49, s[8:11], s38 offen offset:1024 sc1
    v_mfma_f32_16x16x32_bf16 v[44:47], v[116:119], v[140:143], v[44:47]
    v_mfma_f32_16x16x32_bf16 v[40:43], v[116:119], v[136:139], v[40:43]
    v_mfma_f32_16x16x32_bf16 v[36:39], v[116:119], v[132:135], v[36:39]
    v_mfma_f32_16x16x32_bf16 v[32:35], v[116:119], v[128:131], v[32:35]
    s_waitcnt vmcnt(12) lgkmcnt(0)
    v_mfma_f32_16x16x32_bf16 v[16:19], v[120:123], v[144:147], v[16:19]
    ds_read_b128 v[128:131], v8 offset:32768
    ds_read_b128 v[132:135], v8 offset:34816
    v_mfma_f32_16x16x32_bf16 v[20:23], v[120:123], v[148:151], v[20:23]
    ds_read_b128 v[136:139], v8 offset:36864
    ds_read_b128 v[140:143], v8 offset:38912
    v_mfma_f32_16x16x32_bf16 v[24:27], v[120:123], v[152:155], v[24:27]
    v_mov_b32 v1, 8
    ds_write_b32 v63, v1 offset:96
    v_mfma_f32_16x16x32_bf16 v[28:31], v[120:123], v[156:159], v[28:31]
    ds_read_b128 v[56:59], v62 offset:96
    v_mfma_f32_16x16x32_bf16 v[44:47], v[124:127], v[156:159], v[44:47]
    buffer_load_dwordx4 v[112:115], v48, s[8:11], s38 offen offset:2048 sc1
    v_mfma_f32_16x16x32_bf16 v[40:43], v[124:127], v[152:155], v[40:43]
    buffer_load_dwordx4 v[116:119], v49, s[8:11], s38 offen offset:2048 sc1
    v_mfma_f32_16x16x32_bf16 v[36:39], v[124:127], v[148:151], v[36:39]
    v_mfma_f32_16x16x32_bf16 v[32:35], v[124:127], v[144:147], v[32:35]
    s_waitcnt vmcnt(12) lgkmcnt(0)
    v_mfma_f32_16x16x32_bf16 v[16:19], v[64:67], v[128:131], v[16:19]
    ds_read_b128 v[144:147], v9 offset:32768
    ds_read_b128 v[148:151], v9 offset:34816
    v_mfma_f32_16x16x32_bf16 v[20:23], v[64:67], v[132:135], v[20:23]
    ds_read_b128 v[152:155], v9 offset:36864
    ds_read_b128 v[156:159], v9 offset:38912
    v_mfma_f32_16x16x32_bf16 v[24:27], v[64:67], v[136:139], v[24:27]
    buffer_load_dwordx4 v[120:123], v48, s[8:11], s38 offen offset:3072 sc1
    v_mfma_f32_16x16x32_bf16 v[28:31], v[64:67], v[140:143], v[28:31]
    buffer_load_dwordx4 v[124:127], v49, s[8:11], s38 offen offset:3072 sc1
    s_add_u32 s38, s38, 32768
    s_and_b32 s38, s38, 0x3ffff
    s_or_b32 s38, s38, s31
    v_mfma_f32_16x16x32_bf16 v[44:47], v[68:71], v[140:143], v[44:47]
    v_min3_u32 v56, v56, v57, v58
    v_mfma_f32_16x16x32_bf16 v[40:43], v[68:71], v[136:139], v[40:43]
    v_min_u32 v56, v56, v59
    v_mfma_f32_16x16x32_bf16 v[36:39], v[68:71], v[132:135], v[36:39]
    v_cmp_gt_u32 vcc, 7, v56
    v_mfma_f32_16x16x32_bf16 v[32:35], v[68:71], v[128:131], v[32:35]
    s_cbranch_vccnz C2_p8
    C2_p8_r:
    s_waitcnt vmcnt(12) lgkmcnt(0)
    v_mfma_f32_16x16x32_bf16 v[16:19], v[72:75], v[144:147], v[16:19]
    ds_read_b128 v[128:131], v10 offset:32768
    ds_read_b128 v[132:135], v10 offset:34816
    v_mfma_f32_16x16x32_bf16 v[20:23], v[72:75], v[148:151], v[20:23]
    ds_read_b128 v[136:139], v10 offset:36864
    ds_read_b128 v[140:143], v10 offset:38912
    v_mfma_f32_16x16x32_bf16 v[24:27], v[72:75], v[152:155], v[24:27]
    s_cmp_gt_u32 s37, 10
    s_cbranch_scc0 C2_h10
    C2_h10_r:
    buffer_load_dwordx4 v[64:67], v48, s[8:11], s38 offen offset:0 sc1
    v_mfma_f32_16x16x32_bf16 v[28:31], v[72:75], v[156:159], v[28:31]
    buffer_load_dwordx4 v[68:71], v49, s[8:11], s38 offen offset:0 sc1
    v_mfma_f32_16x16x32_bf16 v[44:47], v[76:79], v[156:159], v[44:47]
    v_mfma_f32_16x16x32_bf16 v[40:43], v[76:79], v[152:155], v[40:43]
    v_mfma_f32_16x16x32_bf16 v[36:39], v[76:79], v[148:151], v[36:39]
    v_mfma_f32_16x16x32_bf16 v[32:35], v[76:79], v[144:147], v[32:35]
    s_waitcnt vmcnt(12) lgkmcnt(0)
    v_mfma_f32_16x16x32_bf16 v[16:19], v[80:83], v[128:131], v[16:19]
    ds_read_b128 v[144:147], v11 offset:32768
    ds_read_b128 v[148:151], v11 offset:34816
    v_mfma_f32_16x16x32_bf16 v[20:23], v[80:83], v[132:135], v[20:23]
    ds_read_b128 v[152:155], v11 offset:36864
    ds_read_b128 v[156:159], v11 offset:38912
    v_mfma_f32_16x16x32_bf16 v[24:27], v[80:83], v[136:139], v[24:27]
    buffer_load_dwordx4 v[72:75], v48, s[8:11], s38 offen offset:1024 sc1
    v_mfma_f32_16x16x32_bf16 v[28:31], v[80:83], v[140:143], v[28:31]
    buffer_load_dwordx4 v[76:79], v49, s[8:11], s38 offen offset:1024 sc1
    v_mfma_f32_16x16x32_bf16 v[44:47], v[84:87], v[140:143], v[44:47]
    v_mfma_f32_16x16x32_bf16 v[40:43], v[84:87], v[136:139], v[40:43]
    v_mfma_f32_16x16x32_bf16 v[36:39], v[84:87], v[132:135], v[36:39]
    v_mfma_f32_16x16x32_bf16 v[32:35], v[84:87], v[128:131], v[32:35]
    s_waitcnt vmcnt(12) lgkmcnt(0)
    v_mfma_f32_16x16x32_bf16 v[16:19], v[88:91], v[144:147], v[16:19]
    ds_read_b128 v[128:131], v4 offset:0
    ds_read_b128 v[132:135], v4 offset:2048
    v_mfma_f32_16x16x32_bf16 v[20:23], v[88:91], v[148:151], v[20:23]
    ds_read_b128 v[136:139], v4 offset:4096
    ds_read_b128 v[140:143], v4 offset:6144
    v_mfma_f32_16x16x32_bf16 v[24:27], v[88:91], v[152:155], v[24:27]
    v_mov_b32 v1, 9
    ds_write_b32 v63, v1 offset:96
    v_mfma_f32_16x16x32_bf16 v[28:31], v[88:91], v[156:159], v[28:31]
    buffer_load_dwordx4 v[80:83], v48, s[8:11], s38 offen offset:2048 sc1
    v_mfma_f32_16x16x32_bf16 v[44:47], v[92:95], v[156:159], v[44:47]
    buffer_load_dwordx4 v[84:87], v49, s[8:11], s38 offen offset:2048 sc1
    v_mfma_f32_16x16x32_bf16 v[40:43], v[92:95], v[152:155], v[40:43]
    v_mfma_f32_16x16x32_bf16 v[36:39], v[92:95], v[148:151], v[36:39]
    v_mfma_f32_16x16x32_bf16 v[32:35], v[92:95], v[144:147], v[32:35]
    s_waitcnt vmcnt(12) lgkmcnt(1)
    v_mfma_f32_16x16x32_bf16 v[16:19], v[96:99], v[128:131], v[16:19]
    ds_read_b128 v[144:147], v5 offset:0
    ds_read_b128 v[148:151], v5 offset:2048
    v_mfma_f32_16x16x32_bf16 v[20:23], v[96:99], v[132:135], v[20:23]
    ds_read_b128 v[152:155], v5 offset:4096
    ds_read_b128 v[156:159], v5 offset:6144
    v_mfma_f32_16x16x32_bf16 v[24:27], v[96:99], v[136:139], v[24:27]
    buffer_load_dwordx4 v[88:91], v48, s[8:11], s38 offen offset:3072 sc1
    v_mfma_f32_16x16x32_bf16 v[28:31], v[96:99], v[140:143], v[28:31]
    buffer_load_dwordx4 v[92:95], v49, s[8:11], s38 offen offset:3072 sc1
    s_add_u32 s38, s38, 32768
    s_and_b32 s38, s38, 0x3ffff
    s_or_b32 s38, s38, s31
    v_mfma_f32_16x16x32_bf16 v[44:47], v[100:103], v[140:143], v[44:47]
    v_mfma_f32_16x16x32_bf16 v[40:43], v[100:103], v[136:139], v[40:43]
    v_mfma_f32_16x16x32_bf16 v[36:39], v[100:103], v[132:135], v[36:39]
    v_mfma_f32_16x16x32_bf16 v[32:35], v[100:103], v[128:131], v[32:35]
    s_waitcnt vmcnt(12) lgkmcnt(0)
    v_mfma_f32_16x16x32_bf16 v[16:19], v[104:107], v[144:147], v[16:19]
    ds_read_b128 v[128:131], v6 offset:0
    ds_read_b128 v[132:135], v6 offset:2048
    v_mfma_f32_16x16x32_bf16 v[20:23], v[104:107], v[148:151], v[20:23]
    ds_read_b128 v[136:139], v6 offset:4096
    ds_read_b128 v[140:143], v6 offset:6144
    v_mfma_f32_16x16x32_bf16 v[24:27], v[104:107], v[152:155], v[24:27]
    s_cmp_gt_u32 s37, 11
    s_cbranch_scc0 C2_h11
    C2_h11_r:
    buffer_load_dwordx4 v[96:99], v48, s[8:11], s38 offen offset:0 sc1
    v_mfma_f32_16x16x32_bf16 v[28:31], v[104:107], v[156:159], v[28:31]
    buffer_load_dwordx4 v[100:103], v49, s[8:11], s38 offen offset:0 sc1
    v_mfma_f32_16x16x32_bf16 v[44:47], v[108:111], v[156:159], v[44:47]
    v_mfma_f32_16x16x32_bf16 v[40:43], v[108:111], v[152:155], v[40:43]
    v_mfma_f32_16x16x32_bf16 v[36:39], v[108:111], v[148:151], v[36:39]
    v_mfma_f32_16x16x32_bf16 v[32:35], v[108:111], v[144:147], v[32:35]
    s_waitcnt vmcnt(12) lgkmcnt(0)
    v_mfma_f32_16x16x32_bf16 v[16:19], v[112:115], v[128:131], v[16:19]
    ds_read_b128 v[144:147], v7 offset:0
    ds_read_b128 v[148:151], v7 offset:2048
    v_mfma_f32_16x16x32_bf16 v[20:23], v[112:115], v[132:135], v[20:23]
    ds_read_b128 v[152:155], v7 offset:4096
    ds_read_b128 v[156:159], v7 offset:6144
    v_mfma_f32_16x16x32_bf16 v[24:27], v[112:115], v[136:139], v[24:27]
    buffer_load_dwordx4 v[104:107], v48, s[8:11], s38 offen offset:1024 sc1
    v_mfma_f32_16x16x32_bf16 v[28:31], v[112:115], v[140:143], v[28:31]
    buffer_load_dwordx4 v[108:111], v49, s[8:11], s38 offen offset:1024 sc1
    v_mfma_f32_16x16x32_bf16 v[44:47], v[116:119], v[140:143], v[44:47]
    v_mfma_f32_16x16x32_bf16 v[40:43], v[116:119], v[136:139], v[40:43]
    v_mfma_f32_16x16x32_bf16 v[36:39], v[116:119], v[132:135], v[36:39]
    v_mfma_f32_16x16x32_bf16 v[32:35], v[116:119], v[128:131], v[32:35]
    s_waitcnt vmcnt(12) lgkmcnt(0)
    v_mfma_f32_16x16x32_bf16 v[16:19], v[120:123], v[144:147], v[16:19]
    ds_read_b128 v[128:131], v4 offset:16384
    ds_read_b128 v[132:135], v4 offset:18432
    v_mfma_f32_16x16x32_bf16 v[20:23], v[120:123], v[148:151], v[20:23]
    ds_read_b128 v[136:139], v4 offset:20480
    ds_read_b128 v[140:143], v4 offset:22528
    v_mfma_f32_16x16x32_bf16 v[24:27], v[120:123], v[152:155], v[24:27]
    v_mov_b32 v1, 10
    ds_write_b32 v63, v1 offset:96
    v_mfma_f32_16x16x32_bf16 v[28:31], v[120:123], v[156:159], v[28:31]
    ds_read_b128 v[12:15], v62 offset:48
    v_mfma_f32_16x16x32_bf16 v[44:47], v[124:127], v[156:159], v[44:47]
    buffer_load_dwordx4 v[112:115], v48, s[8:11], s38 offen offset:2048 sc1
    v_mfma_f32_16x16x32_bf16 v[40:43], v[124:127], v[152:155], v[40:43]
    buffer_load_dwordx4 v[116:119], v49, s[8:11], s38 offen offset:2048 sc1
    v_mfma_f32_16x16x32_bf16 v[36:39], v[124:127], v[148:151], v[36:39]
    v_mfma_f32_16x16x32_bf16 v[32:35], v[124:127], v[144:147], v[32:35]
    s_waitcnt vmcnt(12) lgkmcnt(0)
    v_mfma_f32_16x16x32_bf16 v[16:19], v[64:67], v[128:131], v[16:19]
    ds_read_b128 v[144:147], v5 offset:16384
    ds_read_b128 v[148:151], v5 offset:18432
    v_mfma_f32_16x16x32_bf16 v[20:23], v[64:67], v[132:135], v[20:23]
    ds_read_b128 v[152:155], v5 offset:20480
    ds_read_b128 v[156:159], v5 offset:22528
    v_mfma_f32_16x16x32_bf16 v[24:27], v[64:67], v[136:139], v[24:27]
    buffer_load_dwordx4 v[120:123], v48, s[8:11], s38 offen offset:3072 sc1
    v_mfma_f32_16x16x32_bf16 v[28:31], v[64:67], v[140:143], v[28:31]
    buffer_load_dwordx4 v[124:127], v49, s[8:11], s38 offen offset:3072 sc1
    s_add_u32 s38, s38, 32768
    s_and_b32 s38, s38, 0x3ffff
    s_or_b32 s38, s38, s31
    v_mfma_f32_16x16x32_bf16 v[44:47], v[68:71], v[140:143], v[44:47]
    v_min3_u32 v12, v12, v13, v14
    v_mfma_f32_16x16x32_bf16 v[40:43], v[68:71], v[136:139], v[40:43]
    v_min_u32 v12, v12, v15
    v_mfma_f32_16x16x32_bf16 v[36:39], v[68:71], v[132:135], v[36:39]
    v_cmp_gt_u32 vcc, 12, v12
    v_mfma_f32_16x16x32_bf16 v[32:35], v[68:71], v[128:131], v[32:35]
    s_cbranch_vccnz C2_q10
    C2_q10_r:
    s_waitcnt vmcnt(12) lgkmcnt(0)
    v_mfma_f32_16x16x32_bf16 v[16:19], v[72:75], v[144:147], v[16:19]
    ds_read_b128 v[128:131], v6 offset:16384
    ds_read_b128 v[132:135], v6 offset:18432
    v_mfma_f32_16x16x32_bf16 v[20:23], v[72:75], v[148:151], v[20:23]
    ds_read_b128 v[136:139], v6 offset:20480
    ds_read_b128 v[140:143], v6 offset:22528
    v_mfma_f32_16x16x32_bf16 v[24:27], v[72:75], v[152:155], v[24:27]
    s_cmp_gt_u32 s37, 12
    s_cbranch_scc0 C2_h12
    C2_h12_r:
    buffer_load_dwordx4 v[64:67], v48, s[8:11], s38 offen offset:0 sc1
    v_mfma_f32_16x16x32_bf16 v[28:31], v[72:75], v[156:159], v[28:31]
    buffer_load_dwordx4 v[68:71], v49, s[8:11], s38 offen offset:0 sc1
    v_mfma_f32_16x16x32_bf16 v[44:47], v[76:79], v[156:159], v[44:47]
    v_mfma_f32_16x16x32_bf16 v[40:43], v[76:79], v[152:155], v[40:43]
    v_mfma_f32_16x16x32_bf16 v[36:39], v[76:79], v[148:151], v[36:39]
    v_mfma_f32_16x16x32_bf16 v[32:35], v[76:79], v[144:147], v[32:35]
    s_waitcnt vmcnt(12) lgkmcnt(0)
    v_mfma_f32_16x16x32_bf16 v[16:19], v[80:83], v[128:131], v[16:19]
    ds_read_b128 v[144:147], v7 offset:16384
    ds_read_b128 v[148:151], v7 offset:18432
    v_mfma_f32_16x16x32_bf16 v[20:23], v[80:83], v[132:135], v[20:23]
    ds_read_b128 v[152:155], v7 offset:20480
    ds_read_b128 v[156:159], v7 offset:22528
    v_mfma_f32_16x16x32_bf16 v[24:27], v[80:83], v[136:139], v[24:27]
    buffer_load_dwordx4 v[72:75], v48, s[8:11], s38 offen offset:1024 sc1
    v_mfma_f32_16x16x32_bf16 v[28:31], v[80:83], v[140:143], v[28:31]
    buffer_load_dwordx4 v[76:79], v49, s[8:11], s38 offen offset:1024 sc1
    v_mfma_f32_16x16x32_bf16 v[44:47], v[84:87], v[140:143], v[44:47]
    v_mfma_f32_16x16x32_bf16 v[40:43], v[84:87], v[136:139], v[40:43]
    v_mfma_f32_16x16x32_bf16 v[36:39], v[84:87], v[132:135], v[36:39]
    v_mfma_f32_16x16x32_bf16 v[32:35], v[84:87], v[128:131], v[32:35]
    s_waitcnt vmcnt(12) lgkmcnt(0)
    v_mfma_f32_16x16x32_bf16 v[16:19], v[88:91], v[144:147], v[16:19]
    ds_read_b128 v[128:131], v4 offset:32768
    ds_read_b128 v[132:135], v4 offset:34816
    v_mfma_f32_16x16x32_bf16 v[20:23], v[88:91], v[148:151], v[20:23]
    ds_read_b128 v[136:139], v4 offset:36864
    ds_read_b128 v[140:143], v4 offset:38912
    v_mfma_f32_16x16x32_bf16 v[24:27], v[88:91], v[152:155], v[24:27]
    v_mov_b32 v1, 11
    ds_write_b32 v63, v1 offset:96
    v_mfma_f32_16x16x32_bf16 v[28:31], v[88:91], v[156:159], v[28:31]
    ds_read_b128 v[12:15], v62 offset:48
    v_mfma_f32_16x16x32_bf16 v[44:47], v[92:95], v[156:159], v[44:47]
    buffer_load_dwordx4 v[80:83], v48, s[8:11], s38 offen offset:2048 sc1
    v_mfma_f32_16x16x32_bf16 v[40:43], v[92:95], v[152:155], v[40:43]
    buffer_load_dwordx4 v[84:87], v49, s[8:11], s38 offen offset:2048 sc1
    v_mfma_f32_16x16x32_bf16 v[36:39], v[92:95], v[148:151], v[36:39]
    v_mfma_f32_16x16x32_bf16 v[32:35], v[92:95], v[144:147], v[32:35]
    s_waitcnt vmcnt(12) lgkmcnt(0)
    v_mfma_f32_16x16x32_bf16 v[16:19], v[96:99], v[128:131], v[16:19]
    ds_read_b128 v[144:147], v5 offset:32768
    ds_read_b128 v[148:151], v5 offset:34816
    v_mfma_f32_16x16x32_bf16 v[20:23], v[96:99], v[132:135], v[20:23]
    ds_read_b128 v[152:155], v5 offset:36864
    ds_read_b128 v[156:159], v5 offset:38912
    v_mfma_f32_16x16x32_bf16 v[24:27], v[96:99], v[136:139], v[24:27]
    buffer_load_dwordx4 v[88:91], v48, s[8:11], s38 offen offset:3072 sc1
    v_mfma_f32_16x16x32_bf16 v[28:31], v[96:99], v[140:143], v[28:31]
    buffer_load_dwordx4 v[92:95], v49, s[8:11], s38 offen offset:3072 sc1
    s_add_u32 s40, s38, 32768
    s_and_b32 s40, s40, 0x3ffff
    s_or_b32 s40, s40, s31
    s_add_u32 s41, s38, 65536
    s_and_b32 s41, s41, 0x3ffff
    s_or_b32 s41, s41, s31
    s_add_u32 s42, s38, 98304
    s_and_b32 s42, s42, 0x3ffff
    s_or_b32 s42, s42, s31
    v_mfma_f32_16x16x32_bf16 v[44:47], v[100:103], v[140:143], v[44:47]
    v_min3_u32 v12, v12, v13, v14
    v_mfma_f32_16x16x32_bf16 v[40:43], v[100:103], v[136:139], v[40:43]
    v_min_u32 v12, v12, v15
    v_mfma_f32_16x16x32_bf16 v[36:39], v[100:103], v[132:135], v[36:39]
    v_cmp_gt_u32 vcc, 13, v12
    v_mfma_f32_16x16x32_bf16 v[32:35], v[100:103], v[128:131], v[32:35]
    s_cbranch_vccnz C2_q11
    C2_q11_r:
    s_waitcnt vmcnt(12) lgkmcnt(0)
    v_mfma_f32_16x16x32_bf16 v[16:19], v[104:107], v[144:147], v[16:19]
    ds_read_b128 v[128:131], v6 offset:32768
    ds_read_b128 v[132:135], v6 offset:34816
    v_mfma_f32_16x16x32_bf16 v[20:23], v[104:107], v[148:151], v[20:23]
    ds_read_b128 v[136:139], v6 offset:36864
    ds_read_b128 v[140:143], v6 offset:38912
    v_mfma_f32_16x16x32_bf16 v[24:27], v[104:107], v[152:155], v[24:27]
    s_cmp_gt_u32 s37, 13
    s_cbranch_scc0 C2_h13
    C2_h13_r:
    buffer_load_dwordx4 v[96:99], v48, s[8:11], s40 offen offset:0 sc1
    v_mfma_f32_16x16x32_bf16 v[28:31], v[104:107], v[156:159], v[28:31]
    buffer_load_dwordx4 v[100:103], v48, s[8:11], s40 offen offset:1024 sc1
    v_mfma_f32_16x16x32_bf16 v[44:47], v[108:111], v[156:159], v[44:47]
    v_mfma_f32_16x16x32_bf16 v[40:43], v[108:111], v[152:155], v[40:43]
    v_mfma_f32_16x16x32_bf16 v[36:39], v[108:111], v[148:151], v[36:39]
    v_mfma_f32_16x16x32_bf16 v[32:35], v[108:111], v[144:147], v[32:35]
    s_waitcnt vmcnt(12) lgkmcnt(0)
    v_mfma_f32_16x16x32_bf16 v[16:19], v[112:115], v[128:131], v[16:19]
    ds_read_b128 v[144:147], v7 offset:32768
    ds_read_b128 v[148:151], v7 offset:34816
    v_mfma_f32_16x16x32_bf16 v[20:23], v[112:115], v[132:135], v[20:23]
    ds_read_b128 v[152:155], v7 offset:36864
    ds_read_b128 v[156:159], v7 offset:38912
    v_mfma_f32_16x16x32_bf16 v[24:27], v[112:115], v[136:139], v[24:27]
    buffer_load_dwordx4 v[104:107], v48, s[8:11], s40 offen offset:2048 sc1
    v_mfma_f32_16x16x32_bf16 v[28:31], v[112:115], v[140:143], v[28:31]
    buffer_load_dwordx4 v[108:111], v48, s[8:11], s40 offen offset:3072 sc1
    v_mfma_f32_16x16x32_bf16 v[44:47], v[116:119], v[140:143], v[44:47]
    v_mfma_f32_16x16x32_bf16 v[40:43], v[116:119], v[136:139], v[40:43]
    v_mfma_f32_16x16x32_bf16 v[36:39], v[116:119], v[132:135], v[36:39]
    v_mfma_f32_16x16x32_bf16 v[32:35], v[116:119], v[128:131], v[32:35]
    s_waitcnt vmcnt(12) lgkmcnt(0)
    v_mfma_f32_16x16x32_bf16 v[16:19], v[120:123], v[144:147], v[16:19]
    ds_read_b128 v[128:131], v8 offset:0
    ds_read_b128 v[132:135], v8 offset:2048
    v_mfma_f32_16x16x32_bf16 v[20:23], v[120:123], v[148:151], v[20:23]
    ds_read_b128 v[136:139], v8 offset:4096
    ds_read_b128 v[140:143], v8 offset:6144
    v_mfma_f32_16x16x32_bf16 v[24:27], v[120:123], v[152:155], v[24:27]
    v_mov_b32 v1, 12
    ds_write_b32 v63, v1 offset:96
    v_mfma_f32_16x16x32_bf16 v[28:31], v[120:123], v[156:159], v[28:31]
    ds_read_b128 v[12:15], v62 offset:48
    v_mfma_f32_16x16x32_bf16 v[44:47], v[124:127], v[156:159], v[44:47]
    s_cmp_gt_u32 s37, 14
    s_cbranch_scc0 C2_h14
    C2_h14_r:
    buffer_load_dwordx4 v[112:115], v48, s[8:11], s41 offen offset:0 sc1
    v_mfma_f32_16x16x32_bf16 v[40:43], v[124:127], v[152:155], v[40:43]
    buffer_load_dwordx4 v[116:119], v48, s[8:11], s41 offen offset:1024 sc1
    v_mfma_f32_16x16x32_bf16 v[36:39], v[124:127], v[148:151], v[36:39]
    v_mfma_f32_16x16x32_bf16 v[32:35], v[124:127], v[144:147], v[32:35]
    s_waitcnt vmcnt(12) lgkmcnt(0)
    v_mfma_f32_16x16x32_bf16 v[16:19], v[64:67], v[128:131], v[16:19]
    ds_read_b128 v[144:147], v9 offset:0
    ds_read_b128 v[148:151], v9 offset:2048
    v_mfma_f32_16x16x32_bf16 v[20:23], v[64:67], v[132:135], v[20:23]
    ds_read_b128 v[152:155], v9 offset:4096
    ds_read_b128 v[156:159], v9 offset:6144
    v_mfma_f32_16x16x32_bf16 v[24:27], v[64:67], v[136:139], v[24:27]
    buffer_load_dwordx4 v[120:123], v48, s[8:11], s41 offen offset:2048 sc1
    v_mfma_f32_16x16x32_bf16 v[28:31], v[64:67], v[140:143], v[28:31]
    buffer_load_dwordx4 v[124:127], v48, s[8:11], s41 offen offset:3072 sc1
    v_mfma_f32_16x16x32_bf16 v[44:47], v[68:71], v[140:143], v[44:47]
    v_min3_u32 v12, v12, v13, v14
    v_mfma_f32_16x16x32_bf16 v[40:43], v[68:71], v[136:139], v[40:43]
    v_min_u32 v12, v12, v15
    v_mfma_f32_16x16x32_bf16 v[36:39], v[68:71], v[132:135], v[36:39]
    v_cmp_gt_u32 vcc, 14, v12
    v_mfma_f32_16x16x32_bf16 v[32:35], v[68:71], v[128:131], v[32:35]
    s_cbranch_vccnz C2_q12
    C2_q12_r:
    s_waitcnt vmcnt(12) lgkmcnt(0)
    v_mfma_f32_16x16x32_bf16 v[16:19], v[72:75], v[144:147], v[16:19]
    ds_read_b128 v[128:131], v10 offset:0
    ds_read_b128 v[132:135], v10 offset:2048
    v_mfma_f32_16x16x32_bf16 v[20:23], v[72:75], v[148:151], v[20:23]
    ds_read_b128 v[136:139], v10 offset:4096
    ds_read_b128 v[140:143], v10 offset:6144
    v_mfma_f32_16x16x32_bf16 v[24:27], v[72:75], v[152:155], v[24:27]
    s_cmp_gt_u32 s37, 15
    s_cbranch_scc0 C2_h15
    C2_h15_r:
    buffer_load_dwordx4 v[64:67], v48, s[8:11], s42 offen offset:0 sc1
    v_mfma_f32_16x16x32_bf16 v[28:31], v[72:75], v[156:159], v[28:31]
    buffer_load_dwordx4 v[68:71], v48, s[8:11], s42 offen offset:1024 sc1
    v_mfma_f32_16x16x32_bf16 v[44:47], v[76:79], v[156:159], v[44:47]
    v_mfma_f32_16x16x32_bf16 v[40:43], v[76:79], v[152:155], v[40:43]
    v_mfma_f32_16x16x32_bf16 v[36:39], v[76:79], v[148:151], v[36:39]
    v_mfma_f32_16x16x32_bf16 v[32:35], v[76:79], v[144:147], v[32:35]
    s_waitcnt vmcnt(12) lgkmcnt(0)
    v_mfma_f32_16x16x32_bf16 v[16:19], v[80:83], v[128:131], v[16:19]
    ds_read_b128 v[144:147], v11 offset:0
    ds_read_b128 v[148:151], v11 offset:2048
    v_mfma_f32_16x16x32_bf16 v[20:23], v[80:83], v[132:135], v[20:23]
    ds_read_b128 v[152:155], v11 offset:4096
    ds_read_b128 v[156:159], v11 offset:6144
    v_mfma_f32_16x16x32_bf16 v[24:27], v[80:83], v[136:139], v[24:27]
    buffer_load_dwordx4 v[72:75], v48, s[8:11], s42 offen offset:2048 sc1
    v_mfma_f32_16x16x32_bf16 v[28:31], v[80:83], v[140:143], v[28:31]
    buffer_load_dwordx4 v[76:79], v48, s[8:11], s42 offen offset:3072 sc1
    v_mfma_f32_16x16x32_bf16 v[44:47], v[84:87], v[140:143], v[44:47]
    v_mfma_f32_16x16x32_bf16 v[40:43], v[84:87], v[136:139], v[40:43]
    v_mfma_f32_16x16x32_bf16 v[36:39], v[84:87], v[132:135], v[36:39]
    v_mfma_f32_16x16x32_bf16 v[32:35], v[84:87], v[128:131], v[32:35]
    s_waitcnt vmcnt(12) lgkmcnt(0)
    v_mfma_f32_16x16x32_bf16 v[16:19], v[88:91], v[144:147], v[16:19]
    ds_read_b128 v[160:163], v8 offset:16384
    ds_read_b128 v[164:167], v8 offset:18432
    v_mfma_f32_16x16x32_bf16 v[20:23], v[88:91], v[148:151], v[20:23]
    ds_read_b128 v[168:171], v8 offset:20480
    ds_read_b128 v[172:175], v8 offset:22528
    v_mfma_f32_16x16x32_bf16 v[24:27], v[88:91], v[152:155], v[24:27]
    ds_read_b128 v[176:179], v9 offset:16384
    ds_read_b128 v[180:183], v9 offset:18432
    v_mfma_f32_16x16x32_bf16 v[28:31], v[88:91], v[156:159], v[28:31]
    ds_read_b128 v[184:187], v9 offset:20480
    ds_read_b128 v[188:191], v9 offset:22528
    v_mfma_f32_16x16x32_bf16 v[44:47], v[92:95], v[156:159], v[44:47]
    v_mov_b32 v1, 13
    ds_write_b32 v63, v1 offset:96
    v_mfma_f32_16x16x32_bf16 v[40:43], v[92:95], v[152:155], v[40:43]
    ds_read_b128 v[12:15], v62 offset:48
    v_mfma_f32_16x16x32_bf16 v[36:39], v[92:95], v[148:151], v[36:39]
    buffer_load_dwordx4 v[80:83], v49, s[8:11], s40 offen offset:0 sc1
    v_mfma_f32_16x16x32_bf16 v[32:35], v[92:95], v[144:147], v[32:35]
    buffer_load_dwordx4 v[84:87], v49, s[8:11], s40 offen offset:1024 sc1
    s_waitcnt vmcnt(12) lgkmcnt(0)
    v_mfma_f32_16x16x32_bf16 v[16:19], v[96:99], v[160:163], v[16:19]
    ds_read_b128 v[192:195], v10 offset:16384
    ds_read_b128 v[196:199], v10 offset:18432
    v_mfma_f32_16x16x32_bf16 v[20:23], v[96:99], v[164:167], v[20:23]
    ds_read_b128 v[200:203], v10 offset:20480
    ds_read_b128 v[204:207], v10 offset:22528
    v_mfma_f32_16x16x32_bf16 v[24:27], v[96:99], v[168:171], v[24:27]
    ds_read_b128 v[208:211], v11 offset:16384
    ds_read_b128 v[212:215], v11 offset:18432
    v_mfma_f32_16x16x32_bf16 v[28:31], v[96:99], v[172:175], v[28:31]
    ds_read_b128 v[216:219], v11 offset:20480
    ds_read_b128 v[220:223], v11 offset:22528
    v_mfma_f32_16x16x32_bf16 v[16:19], v[100:103], v[176:179], v[16:19]
    buffer_load_dwordx4 v[88:91], v49, s[8:11], s40 offen offset:2048 sc1
    buffer_load_dwordx4 v[92:95], v49, s[8:11], s40 offen offset:3072 sc1
    v_mfma_f32_16x16x32_bf16 v[20:23], v[100:103], v[180:183], v[20:23]
    v_min3_u32 v12, v12, v13, v14
    v_min_u32 v12, v12, v15
    v_mfma_f32_16x16x32_bf16 v[24:27], v[100:103], v[184:187], v[24:27]
    v_cmp_gt_u32 vcc, 16, v12
    v_mfma_f32_16x16x32_bf16 v[28:31], v[100:103], v[188:191], v[28:31]
    s_cbranch_vccnz C2_q13
    C2_q13_r:
    s_waitcnt vmcnt(12) lgkmcnt(0)
    v_mfma_f32_16x16x32_bf16 v[16:19], v[104:107], v[192:195], v[16:19]
    ds_read_b128 v[160:163], v8 offset:32768
    ds_read_b128 v[164:167], v8 offset:34816
    v_mfma_f32_16x16x32_bf16 v[20:23], v[104:107], v[196:199], v[20:23]
    ds_read_b128 v[168:171], v8 offset:36864
    ds_read_b128 v[172:175], v8 offset:38912
    v_mfma_f32_16x16x32_bf16 v[24:27], v[104:107], v[200:203], v[24:27]
    ds_read_b128 v[176:179], v9 offset:32768
    ds_read_b128 v[180:183], v9 offset:34816
    v_mfma_f32_16x16x32_bf16 v[28:31], v[104:107], v[204:207], v[28:31]
    ds_read_b128 v[184:187], v9 offset:36864
    ds_read_b128 v[188:191], v9 offset:38912
    v_mfma_f32_16x16x32_bf16 v[16:19], v[108:111], v[208:211], v[16:19]
    buffer_load_dwordx4 v[96:99], v49, s[8:11], s41 offen offset:0 sc1
    v_mfma_f32_16x16x32_bf16 v[20:23], v[108:111], v[212:215], v[20:23]
    buffer_load_dwordx4 v[100:103], v49, s[8:11], s41 offen offset:1024 sc1
    v_mfma_f32_16x16x32_bf16 v[24:27], v[108:111], v[216:219], v[24:27]
    v_mfma_f32_16x16x32_bf16 v[28:31], v[108:111], v[220:223], v[28:31]
    s_waitcnt vmcnt(12) lgkmcnt(0)
    v_mfma_f32_16x16x32_bf16 v[16:19], v[112:115], v[160:163], v[16:19]
    ds_read_b128 v[192:195], v10 offset:32768
    ds_read_b128 v[196:199], v10 offset:34816
    v_mfma_f32_16x16x32_bf16 v[20:23], v[112:115], v[164:167], v[20:23]
    ds_read_b128 v[200:203], v10 offset:36864
    ds_read_b128 v[204:207], v10 offset:38912
    v_mfma_f32_16x16x32_bf16 v[24:27], v[112:115], v[168:171], v[24:27]
    ds_read_b128 v[208:211], v11 offset:32768
    ds_read_b128 v[212:215], v11 offset:34816
    v_mfma_f32_16x16x32_bf16 v[28:31], v[112:115], v[172:175], v[28:31]
    ds_read_b128 v[216:219], v11 offset:36864
    ds_read_b128 v[220:223], v11 offset:38912
    v_mfma_f32_16x16x32_bf16 v[16:19], v[116:119], v[176:179], v[16:19]
    buffer_load_dwordx4 v[104:107], v49, s[8:11], s41 offen offset:2048 sc1
    v_mfma_f32_16x16x32_bf16 v[20:23], v[116:119], v[180:183], v[20:23]
    buffer_load_dwordx4 v[108:111], v49, s[8:11], s41 offen offset:3072 sc1
    v_mfma_f32_16x16x32_bf16 v[24:27], v[116:119], v[184:187], v[24:27]
    v_mfma_f32_16x16x32_bf16 v[28:31], v[116:119], v[188:191], v[28:31]
    s_waitcnt vmcnt(12) lgkmcnt(0)
    v_mfma_f32_16x16x32_bf16 v[16:19], v[120:123], v[192:195], v[16:19]
    ds_read_b128 v[160:163], v4 offset:0
    ds_read_b128 v[164:167], v4 offset:2048
    v_mfma_f32_16x16x32_bf16 v[20:23], v[120:123], v[196:199], v[20:23]
    ds_read_b128 v[168:171], v4 offset:4096
    ds_read_b128 v[172:175], v4 offset:6144
    v_mfma_f32_16x16x32_bf16 v[24:27], v[120:123], v[200:203], v[24:27]
    ds_read_b128 v[176:179], v5 offset:0
    ds_read_b128 v[180:183], v5 offset:2048
    v_mfma_f32_16x16x32_bf16 v[28:31], v[120:123], v[204:207], v[28:31]
    ds_read_b128 v[184:187], v5 offset:4096
    ds_read_b128 v[188:191], v5 offset:6144
    v_mfma_f32_16x16x32_bf16 v[16:19], v[124:127], v[208:211], v[16:19]
    buffer_load_dwordx4 v[112:115], v49, s[8:11], s42 offen offset:0 sc1
    v_mfma_f32_16x16x32_bf16 v[20:23], v[124:127], v[212:215], v[20:23]
    buffer_load_dwordx4 v[116:119], v49, s[8:11], s42 offen offset:1024 sc1
    v_mfma_f32_16x16x32_bf16 v[24:27], v[124:127], v[216:219], v[24:27]
    v_mfma_f32_16x16x32_bf16 v[28:31], v[124:127], v[220:223], v[28:31]
    s_waitcnt vmcnt(12) lgkmcnt(0)
    v_mfma_f32_16x16x32_bf16 v[16:19], v[64:67], v[160:163], v[16:19]
    ds_read_b128 v[192:195], v6 offset:0
    ds_read_b128 v[196:199], v6 offset:2048
    v_mfma_f32_16x16x32_bf16 v[20:23], v[64:67], v[164:167], v[20:23]
    ds_read_b128 v[200:203], v6 offset:4096
    ds_read_b128 v[204:207], v6 offset:6144
    v_mfma_f32_16x16x32_bf16 v[24:27], v[64:67], v[168:171], v[24:27]
    ds_read_b128 v[208:211], v7 offset:0
    ds_read_b128 v[212:215], v7 offset:2048
    v_mfma_f32_16x16x32_bf16 v[28:31], v[64:67], v[172:175], v[28:31]
    ds_read_b128 v[216:219], v7 offset:4096
    ds_read_b128 v[220:223], v7 offset:6144
    v_mfma_f32_16x16x32_bf16 v[16:19], v[68:71], v[176:179], v[16:19]
    buffer_load_dwordx4 v[120:123], v49, s[8:11], s42 offen offset:2048 sc1
    v_mfma_f32_16x16x32_bf16 v[20:23], v[68:71], v[180:183], v[20:23]
    buffer_load_dwordx4 v[124:127], v49, s[8:11], s42 offen offset:3072 sc1
    v_mfma_f32_16x16x32_bf16 v[24:27], v[68:71], v[184:187], v[24:27]
    v_mfma_f32_16x16x32_bf16 v[28:31], v[68:71], v[188:191], v[28:31]
    s_waitcnt vmcnt(12) lgkmcnt(0)
    v_mfma_f32_16x16x32_bf16 v[16:19], v[72:75], v[192:195], v[16:19]
    ds_read_b128 v[160:163], v8 offset:16384
    ds_read_b128 v[164:167], v8 offset:18432
    v_mfma_f32_16x16x32_bf16 v[20:23], v[72:75], v[196:199], v[20:23]
    ds_read_b128 v[168:171], v8 offset:20480
    ds_read_b128 v[172:175], v8 offset:22528
    v_mfma_f32_16x16x32_bf16 v[24:27], v[72:75], v[200:203], v[24:27]
    ds_read_b128 v[176:179], v9 offset:16384
    ds_read_b128 v[180:183], v9 offset:18432
    v_mfma_f32_16x16x32_bf16 v[28:31], v[72:75], v[204:207], v[28:31]
    ds_read_b128 v[184:187], v9 offset:20480
    ds_read_b128 v[188:191], v9 offset:22528
    v_mfma_f32_16x16x32_bf16 v[16:19], v[76:79], v[208:211], v[16:19]
    v_mfma_f32_16x16x32_bf16 v[20:23], v[76:79], v[212:215], v[20:23]
    v_mfma_f32_16x16x32_bf16 v[24:27], v[76:79], v[216:219], v[24:27]
    v_mfma_f32_16x16x32_bf16 v[28:31], v[76:79], v[220:223], v[28:31]
    s_waitcnt vmcnt(10) lgkmcnt(0)
    v_mfma_f32_16x16x32_bf16 v[32:35], v[80:83], v[160:163], v[32:35]
    ds_read_b128 v[192:195], v10 offset:16384
    ds_read_b128 v[196:199], v10 offset:18432
    v_mfma_f32_16x16x32_bf16 v[36:39], v[80:83], v[164:167], v[36:39]
    ds_read_b128 v[200:203], v10 offset:20480
    ds_read_b128 v[204:207], v10 offset:22528
    v_mfma_f32_16x16x32_bf16 v[40:43], v[80:83], v[168:171], v[40:43]
    ds_read_b128 v[208:211], v11 offset:16384
    ds_read_b128 v[212:215], v11 offset:18432
    v_mfma_f32_16x16x32_bf16 v[44:47], v[80:83], v[172:175], v[44:47]
    ds_read_b128 v[216:219], v11 offset:20480
    ds_read_b128 v[220:223], v11 offset:22528
    v_mfma_f32_16x16x32_bf16 v[32:35], v[84:87], v[176:179], v[32:35]
    v_mfma_f32_16x16x32_bf16 v[36:39], v[84:87], v[180:183], v[36:39]
    v_mfma_f32_16x16x32_bf16 v[40:43], v[84:87], v[184:187], v[40:43]
    v_mfma_f32_16x16x32_bf16 v[44:47], v[84:87], v[188:191], v[44:47]
    s_waitcnt vmcnt(8) lgkmcnt(0)
    v_mfma_f32_16x16x32_bf16 v[32:35], v[88:91], v[192:195], v[32:35]
    ds_read_b128 v[160:163], v8 offset:32768
    ds_read_b128 v[164:167], v8 offset:34816
    v_mfma_f32_16x16x32_bf16 v[36:39], v[88:91], v[196:199], v[36:39]
    ds_read_b128 v[168:171], v8 offset:36864
    ds_read_b128 v[172:175], v8 offset:38912
    v_mfma_f32_16x16x32_bf16 v[40:43], v[88:91], v[200:203], v[40:43]
    ds_read_b128 v[176:179], v9 offset:32768
    ds_read_b128 v[180:183], v9 offset:34816
    v_mfma_f32_16x16x32_bf16 v[44:47], v[88:91], v[204:207], v[44:47]
    ds_read_b128 v[184:187], v9 offset:36864
    ds_read_b128 v[188:191], v9 offset:38912
    v_mfma_f32_16x16x32_bf16 v[32:35], v[92:95], v[208:211], v[32:35]
    v_mov_b32 v224, v16
    v_mov_b32 v225, v20
    v_mov_b32 v226, v24
    v_mov_b32 v227, v28
    v_mfma_f32_16x16x32_bf16 v[36:39], v[92:95], v[212:215], v[36:39]
    s_mov_b32 s6, 0
    buffer_store_dwordx4 v[224:227], v50, s[76:79], s6 offen nt
    v_mfma_f32_16x16x32_bf16 v[40:43], v[92:95], v[216:219], v[40:43]
    v_mfma_f32_16x16x32_bf16 v[44:47], v[92:95], v[220:223], v[44:47]
    s_waitcnt vmcnt(7) lgkmcnt(0)
    v_mfma_f32_16x16x32_bf16 v[32:35], v[96:99], v[160:163], v[32:35]
    ds_read_b128 v[192:195], v10 offset:32768
    ds_read_b128 v[196:199], v10 offset:34816
    v_mfma_f32_16x16x32_bf16 v[36:39], v[96:99], v[164:167], v[36:39]
    ds_read_b128 v[200:203], v10 offset:36864
    ds_read_b128 v[204:207], v10 offset:38912
    v_mfma_f32_16x16x32_bf16 v[40:43], v[96:99], v[168:171], v[40:43]
    ds_read_b128 v[208:211], v11 offset:32768
    ds_read_b128 v[212:215], v11 offset:34816
    v_mfma_f32_16x16x32_bf16 v[44:47], v[96:99], v[172:175], v[44:47]
    ds_read_b128 v[216:219], v11 offset:36864
    ds_read_b128 v[220:223], v11 offset:38912
    v_mfma_f32_16x16x32_bf16 v[32:35], v[100:103], v[176:179], v[32:35]
    v_mov_b32 v228, v17
    v_mov_b32 v229, v21
    v_mov_b32 v230, v25
    v_mov_b32 v231, v29
    v_mfma_f32_16x16x32_bf16 v[36:39], v[100:103], v[180:183], v[36:39]
    s_mov_b32 s6, 65536
    buffer_store_dwordx4 v[228:231], v50, s[76:79], s6 offen nt
    v_mfma_f32_16x16x32_bf16 v[40:43], v[100:103], v[184:187], v[40:43]
    v_mfma_f32_16x16x32_bf16 v[44:47], v[100:103], v[188:191], v[44:47]
    s_waitcnt vmcnt(6) lgkmcnt(0)
    v_mfma_f32_16x16x32_bf16 v[32:35], v[104:107], v[192:195], v[32:35]
    ds_read_b128 v[160:163], v4 offset:0
    ds_read_b128 v[164:167], v4 offset:2048
    v_mfma_f32_16x16x32_bf16 v[36:39], v[104:107], v[196:199], v[36:39]
    ds_read_b128 v[168:171], v4 offset:4096
    ds_read_b128 v[172:175], v4 offset:6144
    v_mfma_f32_16x16x32_bf16 v[40:43], v[104:107], v[200:203], v[40:43]
    ds_read_b128 v[176:179], v5 offset:0
    ds_read_b128 v[180:183], v5 offset:2048
    v_mfma_f32_16x16x32_bf16 v[44:47], v[104:107], v[204:207], v[44:47]
    ds_read_b128 v[184:187], v5 offset:4096
    ds_read_b128 v[188:191], v5 offset:6144
    v_mfma_f32_16x16x32_bf16 v[32:35], v[108:111], v[208:211], v[32:35]
    v_mov_b32 v232, v18
    v_mov_b32 v233, v22
    v_mov_b32 v234, v26
    v_mov_b32 v235, v30
    v_mfma_f32_16x16x32_bf16 v[36:39], v[108:111], v[212:215], v[36:39]
    s_mov_b32 s6, 131072
    buffer_store_dwordx4 v[232:235], v50, s[76:79], s6 offen nt
    v_mfma_f32_16x16x32_bf16 v[40:43], v[108:111], v[216:219], v[40:43]
    v_mfma_f32_16x16x32_bf16 v[44:47], v[108:111], v[220:223], v[44:47]
    s_waitcnt vmcnt(5) lgkmcnt(0)
    v_mfma_f32_16x16x32_bf16 v[32:35], v[112:115], v[160:163], v[32:35]
    ds_read_b128 v[192:195], v6 offset:0
    ds_read_b128 v[196:199], v6 offset:2048
    v_mfma_f32_16x16x32_bf16 v[36:39], v[112:115], v[164:167], v[36:39]
    ds_read_b128 v[200:203], v6 offset:4096
    ds_read_b128 v[204:207], v6 offset:6144
    v_mfma_f32_16x16x32_bf16 v[40:43], v[112:115], v[168:171], v[40:43]
    ds_read_b128 v[208:211], v7 offset:0
    ds_read_b128 v[212:215], v7 offset:2048
    v_mfma_f32_16x16x32_bf16 v[44:47], v[112:115], v[172:175], v[44:47]
    ds_read_b128 v[216:219], v7 offset:4096
    ds_read_b128 v[220:223], v7 offset:6144
    v_mfma_f32_16x16x32_bf16 v[32:35], v[116:119], v[176:179], v[32:35]
    v_mov_b32 v236, v19
    v_mov_b32 v237, v23
    v_mov_b32 v238, v27
    v_mov_b32 v239, v31
    v_mfma_f32_16x16x32_bf16 v[36:39], v[116:119], v[180:183], v[36:39]
    s_mov_b32 s6, 196608
    buffer_store_dwordx4 v[236:239], v50, s[76:79], s6 offen nt
    v_mfma_f32_16x16x32_bf16 v[40:43], v[116:119], v[184:187], v[40:43]
    v_mfma_f32_16x16x32_bf16 v[44:47], v[116:119], v[188:191], v[44:47]
    s_waitcnt vmcnt(4) lgkmcnt(0)
    v_mfma_f32_16x16x32_bf16 v[32:35], v[120:123], v[192:195], v[32:35]
    v_mfma_f32_16x16x32_bf16 v[36:39], v[120:123], v[196:199], v[36:39]
    v_mfma_f32_16x16x32_bf16 v[40:43], v[120:123], v[200:203], v[40:43]
    v_mfma_f32_16x16x32_bf16 v[44:47], v[120:123], v[204:207], v[44:47]
    v_mfma_f32_16x16x32_bf16 v[32:35], v[124:127], v[208:211], v[32:35]
    v_mfma_f32_16x16x32_bf16 v[36:39], v[124:127], v[212:215], v[36:39]
    v_mfma_f32_16x16x32_bf16 v[40:43], v[124:127], v[216:219], v[40:43]
    v_mfma_f32_16x16x32_bf16 v[44:47], v[124:127], v[220:223], v[44:47]
    s_nop 7
    s_nop 2
    v_mov_b32 v80, v32
    v_mov_b32 v81, v36
    v_mov_b32 v82, v40
    v_mov_b32 v83, v44
    s_mov_b32 s6, 8192
    buffer_store_dwordx4 v[80:83], v50, s[76:79], s6 offen nt
    v_mov_b32 v84, v33
    v_mov_b32 v85, v37
    v_mov_b32 v86, v41
    v_mov_b32 v87, v45
    s_mov_b32 s6, 73728
    buffer_store_dwordx4 v[84:87], v50, s[76:79], s6 offen nt
    v_mov_b32 v88, v34
    v_mov_b32 v89, v38
    v_mov_b32 v90, v42
    v_mov_b32 v91, v46
    s_mov_b32 s6, 139264
    buffer_store_dwordx4 v[88:91], v50, s[76:79], s6 offen nt
    v_mov_b32 v92, v35
    v_mov_b32 v93, v39
    v_mov_b32 v94, v43
    v_mov_b32 v95, v47
    s_mov_b32 s6, 204800
    buffer_store_dwordx4 v[92:95], v50, s[76:79], s6 offen nt
    s_endpgm
K_other:
    s_sub_u32 s6, s5, 4
    v_lshrrev_b32 v12, 3, v2
    v_and_b32 v13, 7, v2
    v_lshrrev_b32 v14, 4, v2
    v_xor_b32 v13, v13, v14
    v_lshlrev_b32 v13, 4, v13
    v_lshrrev_b32 v14, 5, v2
    v_and_b32 v15, 3, v12
    v_lshl_add_u32 v15, v14, 3, v15
    v_lshl_add_u32 v14, v12, 14, v13
    v_lshl_add_u32 v15, v15, 11, v13
    s_lshl_b32 s7, s3, 6
    s_add_u32 s7, s7, s6
    s_lshl_b32 s7, s7, 12
    v_add_u32 v4, s7, v14
    v_xor_b32 v5, 64, v4
    v_add_u32 v5, 0x1fc00, v5
    s_lshl_b32 s7, s4, 2
    s_add_u32 s7, s7, s6
    s_lshl_b32 s7, s7, 15
    v_add_u32 v8, s7, v15
    v_xor_b32 v9, 64, v8
    v_add_u32 v9, 0x1c00, v9
    s_and_b32 s30, s2, 3
    s_lshl_b32 s30, s30, 2
    s_and_b32 s31, s2, 4
    s_lshl_b32 s31, s31, 1
    s_add_u32 s30, s30, s31
    s_add_u32 s31, s3, s4
    s_and_b32 s31, s31, 1
    s_lshl_b32 s31, s31, 1
    s_add_u32 s30, s30, s31
    s_and_b32 s30, s30, 15
    s_lshl_b32 s100, s30, 7
    s_lshl_b32 s101, s6, 12
    s_waitcnt lgkmcnt(0)
    s_mov_b32 s8, s44
    s_mov_b32 s9, s45
    s_mov_b32 s10, 4194304
    s_mov_b32 s11, 0x00020000
    s_mov_b32 s12, s50
    s_mov_b32 s13, s51
    s_mov_b32 s14, 2097152
    s_mov_b32 s15, 0x00020000
    s_mov_b32 s16, s52
    s_mov_b32 s17, s53
    s_mov_b32 s18, 2097152
    s_mov_b32 s19, 0x00020000
    s_mov_b32 s58, s32
    s_mov_b32 s59, s33
    s_lshr_b32 s7, s2, 3
    s_and_b32 s32, s7, 15
    s_lshr_b32 s7, s7, 4
    s_and_b32 s33, s2, 7
    s_lshl_b32 s33, s33, 1
    s_add_u32 s33, s33, s7
    s_lshl_b32 s34, s33, 4
    s_add_u32 s34, s34, s32
    s_lshl_b32 s34, s34, 2
    s_add_u32 s34, s34, s6
    s_lshl_b32 s35, s34, 12
    s_lshr_b32 s7, s34, 1
    s_lshl_b32 s7, s7, 2
    s_load_dword s37, s[42:43], s7
    v_and_b32 v12, 15, v2
    v_lshrrev_b32 v13, 4, v2
    s_mov_b32 s68, s40
    s_mov_b32 s69, s41
    s_mov_b32 s70, 4194304
    s_mov_b32 s71, 0x00020000
    s_add_u32 s76, s66, 17825792
    s_addc_u32 s77, s67, 0
    s_mov_b32 s78, 393216
    s_mov_b32 s79, 0x00020000
    s_mov_b32 s24, s54
    s_mov_b32 s25, s55
    s_mov_b32 s26, 2097152
    s_mov_b32 s27, 0x00020000
    s_mov_b32 s28, s56
    s_mov_b32 s29, s57
    s_mov_b32 s30, 2097152
    s_mov_b32 s31, 0x00020000
    s_mov_b32 s40, s58
    s_mov_b32 s41, s59
    s_mov_b32 s42, 4194304
    s_mov_b32 s43, 0x00020000
    s_cmp_lt_u32 s6, 2
    s_cselect_b32 s52, s54, s56
    s_cselect_b32 s53, s55, s57
    s_mov_b32 s54, 2097152
    s_mov_b32 s55, 0x00020000
    s_waitcnt lgkmcnt(0)
    s_lshl_b32 s45, s6, 14
    v_lshlrev_b32 v16, 4, v13
    v_lshl_add_u32 v16, v12, 1, v16
    v_and_b32 v1, 1, v12
    v_mov_b32 v3, 98308
    v_mov_b32 v14, 102466
    v_cmp_eq_u32 vcc, 1, v1
    s_and_b32 s7, s34, 1
    s_lshl_b32 s7, s7, 4
    v_cndmask_b32 v3, v3, v14, vcc
    v_add3_u32 v16, v16, v3, s45
    v_add_u32 v17, 1024, v16
    v_add_u32 v18, 2048, v16
    v_add_u32 v19, 3072, v16
    s_add_u32 s47, s45, 107104
    v_lshlrev_b32 v1, 4, v13
    v_lshlrev_b32 v3, 5, v12
    v_sub_u32 v1, v1, v3
    v_add_u32 v20, s47, v1
    s_lshr_b32 s37, s37, s7
    s_and_b32 s37, s37, 0xffff
    v_lshlrev_b32 v1, 3, v13
    v_add_u32 v1, v1, v12
    v_sub_u32 v1, 15, v1
    v_and_b32 v3, 1, v1
    v_lshlrev_b32 v3, 4, v3
    v_lshlrev_b32 v3, v3, s37
    v_lshrrev_b32 v1, 1, v1
    v_cmp_eq_u32 vcc, 0, v1
    s_nop 1
    v_cndmask_b32 v24, 0, v3, vcc
    v_cmp_eq_u32 vcc, 1, v1
    s_nop 1
    v_cndmask_b32 v25, 0, v3, vcc
    v_cmp_eq_u32 vcc, 2, v1
    s_nop 1
    v_cndmask_b32 v26, 0, v3, vcc
    v_cmp_eq_u32 vcc, 3, v1
    s_nop 1
    v_cndmask_b32 v27, 0, v3, vcc
    s_add_u32 s7, s45, 106496
    v_lshlrev_b32 v1, 3, v2
    v_add_u32 v21, s7, v1
    v_lshlrev_b32 v10, 4, v2
    v_mov_b32 v7, 147328
    s_lshl_b32 s7, s6, 2
    v_add_u32 v6, s7, v7
    v_mov_b32 v1, 0
    ds_write_b32 v6, v1 offset:48
    ds_write_b32 v6, v1 offset:96
    v_mov_b32 v1, 2
    ds_write_b32 v6, v1 offset:64
    v_lshrrev_b32 v1, 3, v2
    v_and_b32 v3, 7, v2
    v_xor_b32 v3, v3, v13
    v_lshlrev_b32 v3, 4, v3
    v_lshl_add_u32 v3, v1, 13, v3
    s_lshl_b32 s7, s4, 6
    s_add_u32 s7, s7, s6
    s_lshl_b32 s7, s7, 11
    v_add_u32 v246, s7, v3
    v_xor_b32 v247, 64, v246
    v_add_u32 v247, 64512, v247
    v_xor_b32 v248, 32, v246
    v_xor_b32 v249, 32, v247
    s_lshl_b32 s38, s4, 7
    v_lshlrev_b32 v3, 11, v13
    v_lshl_add_u32 v3, v12, 3, v3
    s_lshl_b32 s7, s32, 2
    s_add_u32 s7, s7, s6
    s_lshl_b32 s7, s7, 9
    s_add_u32 s7, s7, s33
    s_lshl_b32 s7, s7, 7
    v_add_u32 v31, s7, v3
    s_lshr_b32 s46, s2, 3
    s_and_b32 s46, s46, 7
    s_lshr_b32 s46, s2, 4
    s_and_b32 s46, s46, 7
    s_add_u32 s7, s3, s4
    s_and_b32 s7, s7, 1
    s_cmp_eq_u32 s7, 0
    s_cselect_b32 s46, s46, 99
    s_lshl_b32 s39, s6, 11
    s_and_b32 s7, s3, 0
    s_lshl_b32 s7, s7, 7
    s_add_u32 s38, s38, s7
    s_and_b32 s20, s38, 1024
    s_xor_b32 s21, s20, 1024
    s_and_b32 s7, s3, 3
    s_lshl_b32 s7, s7, 1
    s_and_b32 s47, s6, 1
    s_add_u32 s7, s7, s47
    s_lshl_b32 s7, s7, 7
    s_or_b32 s7, s7, s21
    s_lshl_b32 s47, s4, 17
    s_add_u32 s7, s7, s47
    v_lshlrev_b32 v11, 11, v2
    v_add_u32 v11, s7, v11
    s_and_b32 s7, s3, 14
    s_and_b32 s47, s6, 1
    s_add_u32 s7, s7, s47
    s_add_u32 s7, s7, s4
    s_and_b32 s7, s7, 15
    s_lshl_b32 s7, s7, 7
    s_lshl_b32 s47, s4, 17
    s_add_u32 s7, s7, s47
    v_lshlrev_b32 v30, 11, v2
    v_add_u32 v30, s7, v30
    s_barrier
    s_add_u32 m0, s101, 98304
    s_nop 0
    buffer_load_dwordx4 v4, s[8:11], s100 offen lds
    buffer_load_dwordx4 v5, s[8:11], s100 offen offset:1024 lds
    buffer_load_dwordx4 v4, s[8:11], s100 offen offset:2048 lds
    buffer_load_dwordx4 v5, s[8:11], s100 offen offset:3072 lds
    s_add_u32 m0, s101, 114688
    s_nop 0
    buffer_load_dwordx4 v8, s[12:15], s100 offen lds
    buffer_load_dwordx4 v9, s[12:15], s100 offen offset:1024 lds
    s_add_u32 m0, s101, 116736
    s_nop 0
    buffer_load_dwordx4 v8, s[16:19], s100 offen lds
    buffer_load_dwordx4 v9, s[16:19], s100 offen offset:1024 lds
    s_add_u32 s100, s100, 128
    s_and_b32 s100, s100, 2047
    s_add_u32 m0, s101, 0
    s_nop 0
    buffer_load_dwordx4 v4, s[8:11], s100 offen lds
    buffer_load_dwordx4 v5, s[8:11], s100 offen offset:1024 lds
    buffer_load_dwordx4 v4, s[8:11], s100 offen offset:2048 lds
    buffer_load_dwordx4 v5, s[8:11], s100 offen offset:3072 lds
    s_add_u32 m0, s101, 16384
    s_nop 0
    buffer_load_dwordx4 v8, s[12:15], s100 offen lds
    buffer_load_dwordx4 v9, s[12:15], s100 offen offset:1024 lds
    s_add_u32 m0, s101, 18432
    s_nop 0
    buffer_load_dwordx4 v8, s[16:19], s100 offen lds
    buffer_load_dwordx4 v9, s[16:19], s100 offen offset:1024 lds
    s_add_u32 s100, s100, 128
    s_and_b32 s100, s100, 2047
    s_add_u32 m0, s101, 32768
    s_nop 0
    buffer_load_dwordx4 v4, s[8:11], s100 offen lds
    buffer_load_dwordx4 v5, s[8:11], s100 offen offset:1024 lds
    buffer_load_dwordx4 v4, s[8:11], s100 offen offset:2048 lds
    buffer_load_dwordx4 v5, s[8:11], s100 offen offset:3072 lds
    s_add_u32 m0, s101, 49152
    s_nop 0
    buffer_load_dwordx4 v8, s[12:15], s100 offen lds
    buffer_load_dwordx4 v9, s[12:15], s100 offen offset:1024 lds
    s_add_u32 m0, s101, 51200
    s_nop 0
    buffer_load_dwordx4 v8, s[16:19], s100 offen lds
    buffer_load_dwordx4 v9, s[16:19], s100 offen offset:1024 lds
    s_add_u32 s100, s100, 128
    s_and_b32 s100, s100, 2047
    s_waitcnt vmcnt(16)
    s_barrier
    s_add_u32 m0, s101, 65536
    s_nop 0
    buffer_load_dwordx4 v4, s[8:11], s100 offen lds
    buffer_load_dwordx4 v5, s[8:11], s100 offen offset:1024 lds
    buffer_load_dwordx4 v4, s[8:11], s100 offen offset:2048 lds
    buffer_load_dwordx4 v5, s[8:11], s100 offen offset:3072 lds
    s_add_u32 m0, s101, 81920
    s_nop 0
    buffer_load_dwordx4 v8, s[12:15], s100 offen lds
    buffer_load_dwordx4 v9, s[12:15], s100 offen offset:1024 lds
    s_add_u32 m0, s101, 83968
    s_nop 0
    buffer_load_dwordx4 v8, s[16:19], s100 offen lds
    buffer_load_dwordx4 v9, s[16:19], s100 offen offset:1024 lds
    s_add_u32 s100, s100, 128
    s_and_b32 s100, s100, 2047
    buffer_load_dwordx4 v[112:115], v10, s[68:71], s35 offen offset:0 nt
    buffer_load_dwordx4 v[116:119], v10, s[68:71], s35 offen offset:1024 nt
    buffer_load_dwordx4 v[120:123], v10, s[68:71], s35 offen offset:2048 nt
    buffer_load_dwordx4 v[124:127], v10, s[68:71], s35 offen offset:3072 nt
    s_waitcnt vmcnt(20) lgkmcnt(0)
    s_barrier
    s_add_u32 m0, s101, 98304
    s_nop 0
    buffer_load_dwordx4 v4, s[8:11], s100 offen lds
    buffer_load_dwordx4 v5, s[8:11], s100 offen offset:1024 lds
    buffer_load_dwordx4 v4, s[8:11], s100 offen offset:2048 lds
    buffer_load_dwordx4 v5, s[8:11], s100 offen offset:3072 lds
    s_waitcnt vmcnt(16)
    s_barrier
    s_add_u32 m0, s101, 114688
    s_nop 0
    buffer_load_dwordx4 v8, s[12:15], s100 offen lds
    buffer_load_dwordx4 v9, s[12:15], s100 offen offset:1024 lds
    s_add_u32 m0, s101, 116736
    s_nop 0
    buffer_load_dwordx4 v8, s[16:19], s100 offen lds
    buffer_load_dwordx4 v9, s[16:19], s100 offen offset:1024 lds
    s_add_u32 s100, s100, 128
    s_and_b32 s100, s100, 2047
    s_add_u32 m0, s101, 0
    s_nop 0
    buffer_load_dwordx4 v4, s[8:11], s100 offen lds
    buffer_load_dwordx4 v5, s[8:11], s100 offen offset:1024 lds
    buffer_load_dwordx4 v4, s[8:11], s100 offen offset:2048 lds
    buffer_load_dwordx4 v5, s[8:11], s100 offen offset:3072 lds
    s_waitcnt vmcnt(16)
    s_barrier
    s_add_u32 m0, s101, 16384
    s_nop 0
    buffer_load_dwordx4 v8, s[12:15], s100 offen lds
    buffer_load_dwordx4 v9, s[12:15], s100 offen offset:1024 lds
    s_add_u32 m0, s101, 18432
    s_nop 0
    buffer_load_dwordx4 v8, s[16:19], s100 offen lds
    buffer_load_dwordx4 v9, s[16:19], s100 offen offset:1024 lds
    s_add_u32 s100, s100, 128
    s_and_b32 s100, s100, 2047
    s_cmp_eq_u32 s46, 0
    s_cbranch_scc0 L_t0
    buffer_load_dword v240, v30, s[52:55], 0 offen
    buffer_load_dword v241, v30, s[52:55], 0 offen offset:64
    L_t0:
    s_add_u32 m0, s101, 32768
    s_nop 0
    buffer_load_dwordx4 v4, s[8:11], s100 offen lds
    buffer_load_dwordx4 v5, s[8:11], s100 offen offset:1024 lds
    buffer_load_dwordx4 v4, s[8:11], s100 offen offset:2048 lds
    buffer_load_dwordx4 v5, s[8:11], s100 offen offset:3072 lds
    s_waitcnt vmcnt(12)
    s_barrier
    s_add_u32 m0, s101, 49152
    s_nop 0
    buffer_load_dwordx4 v8, s[12:15], s100 offen lds
    buffer_load_dwordx4 v9, s[12:15], s100 offen offset:1024 lds
    s_add_u32 m0, s101, 51200
    s_nop 0
    buffer_load_dwordx4 v8, s[16:19], s100 offen lds
    buffer_load_dwordx4 v9, s[16:19], s100 offen offset:1024 lds
    s_add_u32 s100, s100, 128
    s_and_b32 s100, s100, 2047
    s_cmp_eq_u32 s46, 1
    s_cbranch_scc0 L_t1
    buffer_load_dword v240, v30, s[52:55], 0 offen
    buffer_load_dword v241, v30, s[52:55], 0 offen offset:64
    L_t1:
    s_add_u32 m0, s101, 65536
    s_nop 0
    buffer_load_dwordx4 v4, s[8:11], s100 offen lds
    buffer_load_dwordx4 v5, s[8:11], s100 offen offset:1024 lds
    buffer_load_dwordx4 v4, s[8:11], s100 offen offset:2048 lds
    buffer_load_dwordx4 v5, s[8:11], s100 offen offset:3072 lds
    s_waitcnt vmcnt(12)
    s_barrier
    s_add_u32 m0, s101, 81920
    s_nop 0
    buffer_load_dwordx4 v8, s[12:15], s100 offen lds
    buffer_load_dwordx4 v9, s[12:15], s100 offen offset:1024 lds
    s_add_u32 m0, s101, 83968
    s_nop 0
    buffer_load_dwordx4 v8, s[16:19], s100 offen lds
    buffer_load_dwordx4 v9, s[16:19], s100 offen offset:1024 lds
    s_add_u32 s100, s100, 128
    s_and_b32 s100, s100, 2047
    s_cmp_eq_u32 s46, 2
    s_cbranch_scc0 L_t2
    buffer_load_dword v240, v30, s[52:55], 0 offen
    buffer_load_dword v241, v30, s[52:55], 0 offen offset:64
    L_t2:
    s_add_u32 m0, s101, 98304
    s_nop 0
    buffer_load_dwordx4 v4, s[8:11], s100 offen lds
    buffer_load_dwordx4 v5, s[8:11], s100 offen offset:1024 lds
    buffer_load_dwordx4 v4, s[8:11], s100 offen offset:2048 lds
    buffer_load_dwordx4 v5, s[8:11], s100 offen offset:3072 lds
    v_mov_b32 v1, 147328
    ds_read_b64 v[28:29], v1
    s_waitcnt vmcnt(12)
    s_barrier
    s_add_u32 m0, s101, 114688
    s_nop 0
    buffer_load_dwordx4 v8, s[12:15], s100 offen lds
    buffer_load_dwordx4 v9, s[12:15], s100 offen offset:1024 lds
    s_add_u32 m0, s101, 116736
    s_nop 0
    buffer_load_dwordx4 v8, s[16:19], s100 offen lds
    buffer_load_dwordx4 v9, s[16:19], s100 offen offset:1024 lds
    s_add_u32 s100, s100, 128
    s_and_b32 s100, s100, 2047
    s_cmp_eq_u32 s46, 3
    s_cbranch_scc0 L_t3
    buffer_load_dword v240, v30, s[52:55], 0 offen
    buffer_load_dword v241, v30, s[52:55], 0 offen offset:64
    L_t3:
    s_add_u32 m0, s101, 0
    s_nop 0
    buffer_load_dwordx4 v4, s[8:11], s100 offen lds
    buffer_load_dwordx4 v5, s[8:11], s100 offen offset:1024 lds
    buffer_load_dwordx4 v4, s[8:11], s100 offen offset:2048 lds
    buffer_load_dwordx4 v5, s[8:11], s100 offen offset:3072 lds
    s_waitcnt vmcnt(12)
    s_barrier
    s_add_u32 m0, s101, 16384
    s_nop 0
    buffer_load_dwordx4 v8, s[12:15], s100 offen lds
    buffer_load_dwordx4 v9, s[12:15], s100 offen offset:1024 lds
    s_add_u32 m0, s101, 18432
    s_nop 0
    buffer_load_dwordx4 v8, s[16:19], s100 offen lds
    buffer_load_dwordx4 v9, s[16:19], s100 offen offset:1024 lds
    s_add_u32 s100, s100, 128
    s_and_b32 s100, s100, 2047
    s_cmp_eq_u32 s46, 4
    s_cbranch_scc0 L_t4
    buffer_load_dword v240, v30, s[52:55], 0 offen
    buffer_load_dword v241, v30, s[52:55], 0 offen offset:64
    L_t4:
    s_add_u32 m0, s101, 32768
    s_nop 0
    buffer_load_dwordx4 v4, s[8:11], s100 offen lds
    buffer_load_dwordx4 v5, s[8:11], s100 offen offset:1024 lds
    buffer_load_dwordx4 v4, s[8:11], s100 offen offset:2048 lds
    buffer_load_dwordx4 v5, s[8:11], s100 offen offset:3072 lds
    s_waitcnt vmcnt(12)
    s_barrier
    s_add_u32 m0, s101, 49152
    s_nop 0
    buffer_load_dwordx4 v8, s[12:15], s100 offen lds
    buffer_load_dwordx4 v9, s[12:15], s100 offen offset:1024 lds
    s_add_u32 m0, s101, 51200
    s_nop 0
    buffer_load_dwordx4 v8, s[16:19], s100 offen lds
    buffer_load_dwordx4 v9, s[16:19], s100 offen offset:1024 lds
    s_add_u32 s100, s100, 128
    s_and_b32 s100, s100, 2047
    s_cmp_eq_u32 s46, 5
    s_cbranch_scc0 L_t5
    buffer_load_dword v240, v30, s[52:55], 0 offen
    buffer_load_dword v241, v30, s[52:55], 0 offen offset:64
    L_t5:
    s_add_u32 m0, s101, 65536
    s_nop 0
    buffer_load_dwordx4 v4, s[8:11], s100 offen lds
    buffer_load_dwordx4 v5, s[8:11], s100 offen offset:1024 lds
    buffer_load_dwordx4 v4, s[8:11], s100 offen offset:2048 lds
    buffer_load_dwordx4 v5, s[8:11], s100 offen offset:3072 lds
    v_mov_b32 v32, 0
    v_mov_b32 v33, 0
    v_mov_b32 v34, 0
    v_mov_b32 v35, 0
    s_add_u32 s47, s45, 110720
    v_add_u32 v1, s47, v10
    v_and_b32 v3, 16, v10
    v_and_b32 v15, 32, v10
    v_mul_u32_u24 v15, 130, v15
    v_add3_u32 v3, v3, v15, s45
    v_add_u32 v3, 98304, v3
    v_cmp_gt_u32 vcc, 32, v2
    s_add_u32 s47, s45, 98336
    v_add_u32 v15, s47, v10
    v_cndmask_b32 v1, v3, v1, vcc
    v_mov_b32 v64, 0
    s_waitcnt vmcnt(60)
    v_mov_b32_dpp v68, v115 wave_ror:1 row_mask:0xf bank_mask:0xf
    v_mov_b32_dpp v72, v119 wave_ror:1 row_mask:0xf bank_mask:0xf
    v_mov_b32_dpp v76, v123 wave_ror:1 row_mask:0xf bank_mask:0xf
    v_mov_b32_dpp v64, v115 wave_shr:1 row_mask:0xf bank_mask:0xf
    v_mov_b32_dpp v68, v119 wave_shr:1 row_mask:0xf bank_mask:0xf
    v_mov_b32_dpp v72, v123 wave_shr:1 row_mask:0xf bank_mask:0xf
    v_mov_b32_dpp v76, v127 wave_shr:1 row_mask:0xf bank_mask:0xf
    v_alignbit_b32 v64, v112, v64, 16
    v_alignbit_b32 v65, v113, v112, 16
    v_alignbit_b32 v66, v114, v113, 16
    v_alignbit_b32 v67, v115, v114, 16
    v_alignbit_b32 v68, v116, v68, 16
    v_alignbit_b32 v69, v117, v116, 16
    v_alignbit_b32 v70, v118, v117, 16
    v_alignbit_b32 v71, v119, v118, 16
    v_alignbit_b32 v72, v120, v72, 16
    v_alignbit_b32 v73, v121, v120, 16
    v_alignbit_b32 v74, v122, v121, 16
    v_alignbit_b32 v75, v123, v122, 16
    v_alignbit_b32 v76, v124, v76, 16
    v_alignbit_b32 v77, v125, v124, 16
    v_alignbit_b32 v78, v126, v125, 16
    v_alignbit_b32 v79, v127, v126, 16
    s_waitcnt vmcnt(12)
    s_barrier
    s_add_u32 m0, s101, 81920
    s_nop 0
    buffer_load_dwordx4 v8, s[12:15], s100 offen lds
    buffer_load_dwordx4 v9, s[12:15], s100 offen offset:1024 lds
    s_add_u32 m0, s101, 83968
    s_nop 0
    buffer_load_dwordx4 v8, s[16:19], s100 offen lds
    buffer_load_dwordx4 v9, s[16:19], s100 offen offset:1024 lds
    s_add_u32 s100, s100, 128
    s_and_b32 s100, s100, 2047
    s_cmp_eq_u32 s46, 6
    s_cbranch_scc0 L_t6
    buffer_load_dword v240, v30, s[52:55], 0 offen
    buffer_load_dword v241, v30, s[52:55], 0 offen offset:64
    L_t6:
    s_add_u32 m0, s101, 98304
    s_nop 0
    buffer_load_dwordx4 v4, s[8:11], s100 offen lds
    buffer_load_dwordx4 v5, s[8:11], s100 offen offset:1024 lds
    buffer_load_dwordx4 v4, s[8:11], s100 offen offset:2048 lds
    buffer_load_dwordx4 v5, s[8:11], s100 offen offset:3072 lds
    s_waitcnt vmcnt(12)
    s_barrier
    s_add_u32 m0, s101, 114688
    s_nop 0
    buffer_load_dwordx4 v8, s[12:15], s100 offen lds
    buffer_load_dwordx4 v9, s[12:15], s100 offen offset:1024 lds
    s_add_u32 m0, s101, 116736
    s_nop 0
    buffer_load_dwordx4 v8, s[16:19], s100 offen lds
    buffer_load_dwordx4 v9, s[16:19], s100 offen offset:1024 lds
    s_add_u32 s100, s100, 128
    s_and_b32 s100, s100, 2047
    s_cmp_eq_u32 s46, 7
    s_cbranch_scc0 L_t7
    buffer_load_dword v240, v30, s[52:55], 0 offen
    buffer_load_dword v241, v30, s[52:55], 0 offen offset:64
    L_t7:
    s_add_u32 m0, s101, 0
    s_nop 0
    buffer_load_dwordx4 v4, s[8:11], s100 offen lds
    buffer_load_dwordx4 v5, s[8:11], s100 offen offset:1024 lds
    buffer_load_dwordx4 v4, s[8:11], s100 offen offset:2048 lds
    buffer_load_dwordx4 v5, s[8:11], s100 offen offset:3072 lds
    s_waitcnt vmcnt(12)
    s_barrier
    s_add_u32 m0, s101, 16384
    s_nop 0
    buffer_load_dwordx4 v8, s[12:15], s100 offen lds
    buffer_load_dwordx4 v9, s[12:15], s100 offen offset:1024 lds
    s_add_u32 m0, s101, 18432
    s_nop 0
    buffer_load_dwordx4 v8, s[16:19], s100 offen lds
    buffer_load_dwordx4 v9, s[16:19], s100 offen offset:1024 lds
    s_add_u32 s100, s100, 128
    s_and_b32 s100, s100, 2047
    s_add_u32 m0, s101, 32768
    s_nop 0
    buffer_load_dwordx4 v4, s[8:11], s100 offen lds
    buffer_load_dwordx4 v5, s[8:11], s100 offen offset:1024 lds
    buffer_load_dwordx4 v4, s[8:11], s100 offen offset:2048 lds
    buffer_load_dwordx4 v5, s[8:11], s100 offen offset:3072 lds
    s_waitcnt vmcnt(12)
    s_barrier
    s_add_u32 m0, s101, 49152
    s_nop 0
    buffer_load_dwordx4 v8, s[12:15], s100 offen lds
    buffer_load_dwordx4 v9, s[12:15], s100 offen offset:1024 lds
    s_add_u32 m0, s101, 51200
    s_nop 0
    buffer_load_dwordx4 v8, s[16:19], s100 offen lds
    buffer_load_dwordx4 v9, s[16:19], s100 offen offset:1024 lds
    s_add_u32 s100, s100, 128
    s_and_b32 s100, s100, 2047
    s_add_u32 m0, s101, 65536
    s_nop 0
    buffer_load_dwordx4 v4, s[8:11], s100 offen lds
    buffer_load_dwordx4 v5, s[8:11], s100 offen offset:1024 lds
    buffer_load_dwordx4 v4, s[8:11], s100 offen offset:2048 lds
    buffer_load_dwordx4 v5, s[8:11], s100 offen offset:3072 lds
    s_waitcnt vmcnt(12)
    s_barrier
    s_add_u32 m0, s101, 81920
    s_nop 0
    buffer_load_dwordx4 v8, s[12:15], s100 offen lds
    buffer_load_dwordx4 v9, s[12:15], s100 offen offset:1024 lds
    s_add_u32 m0, s101, 83968
    s_nop 0
    buffer_load_dwordx4 v8, s[16:19], s100 offen lds
    buffer_load_dwordx4 v9, s[16:19], s100 offen offset:1024 lds
    s_add_u32 s100, s100, 128
    s_and_b32 s100, s100, 2047
    s_mov_b32 s36, 0
    buffer_load_dwordx2 v[192:193], v31, s[40:43], s36 offen nt
    s_mov_b32 s36, 8192
    buffer_load_dwordx2 v[194:195], v31, s[40:43], s36 offen nt
    s_mov_b32 s36, 16384
    buffer_load_dwordx2 v[196:197], v31, s[40:43], s36 offen nt
    s_mov_b32 s36, 24576
    buffer_load_dwordx2 v[198:199], v31, s[40:43], s36 offen nt
    s_mov_b32 s36, 32768
    buffer_load_dwordx2 v[200:201], v31, s[40:43], s36 offen nt
    s_mov_b32 s36, 40960
    buffer_load_dwordx2 v[202:203], v31, s[40:43], s36 offen nt
    s_mov_b32 s36, 49152
    buffer_load_dwordx2 v[204:205], v31, s[40:43], s36 offen nt
    s_mov_b32 s36, 57344
    buffer_load_dwordx2 v[206:207], v31, s[40:43], s36 offen nt
    s_waitcnt vmcnt(16)
    s_barrier
    s_add_u32 s44, s38, 0
    s_and_b32 s44, s44, 1023
    s_or_b32 s44, s44, s20
    s_add_u32 m0, s39, 0
    s_nop 0
    buffer_load_dwordx4 v246, s[24:27], s44 offen offset:0 lds
    buffer_load_dwordx4 v247, s[24:27], s44 offen offset:1024 lds
    s_add_u32 m0, s39, 8192
    s_nop 0
    buffer_load_dwordx4 v248, s[28:31], s44 offen offset:0 lds
    buffer_load_dwordx4 v249, s[28:31], s44 offen offset:1024 lds
    s_add_u32 s44, s38, 128
    s_and_b32 s44, s44, 1023
    s_or_b32 s44, s44, s20
    s_add_u32 m0, s39, 16384
    s_nop 0
    buffer_load_dwordx4 v246, s[24:27], s44 offen offset:0 lds
    buffer_load_dwordx4 v247, s[24:27], s44 offen offset:1024 lds
    s_add_u32 m0, s39, 24576
    s_nop 0
    buffer_load_dwordx4 v248, s[28:31], s44 offen offset:0 lds
    buffer_load_dwordx4 v249, s[28:31], s44 offen offset:1024 lds
    s_waitcnt vmcnt(16)
    s_barrier
    ds_write_b128 v1, v[32:35]
    ds_write_b128 v15, v[112:115] offset:4160
    ds_write_b128 v15, v[64:67] offset:0
    ds_write_b128 v15, v[116:119] offset:5184
    ds_write_b128 v15, v[68:71] offset:1024
    ds_write_b128 v15, v[120:123] offset:6208
    ds_write_b128 v15, v[72:75] offset:2048
    ds_write_b128 v15, v[124:127] offset:7232
    ds_write_b128 v15, v[76:79] offset:3072
    s_mov_b32 s51, 0
L_g1d:
    ds_read_b128 v[242:245], v7 offset:16
    s_add_u32 s51, s51, 1
    s_waitcnt lgkmcnt(0)
    v_xor_b32 v242, v242, v28
    v_xor_b32 v243, v243, v28
    v_xor_b32 v244, v244, v28
    v_xor_b32 v245, v245, v28
    v_or3_b32 v242, v242, v243, v244
    v_or_b32 v242, v242, v245
    s_cmp_gt_u32 s51, 16384
    s_cbranch_scc1 L_g1d_ok
    v_cmp_ne_u32 vcc, 0, v242
    s_cbranch_vccnz L_g1d
L_g1d_ok:
    ds_read_b128 v[96:99], v20 offset:3584
    ds_read2_b32 v[64:65], v16 offset0:0 offset1:1
    ds_read2_b32 v[66:67], v16 offset0:2 offset1:3
    ds_read_b128 v[100:103], v20 offset:3072
    ds_read2_b32 v[68:69], v16 offset0:128 offset1:129
    ds_read2_b32 v[70:71], v16 offset0:130 offset1:131
    ds_read_b128 v[104:107], v20 offset:2560
    ds_read2_b32 v[72:73], v17 offset0:0 offset1:1
    ds_read2_b32 v[74:75], v17 offset0:2 offset1:3
    ds_read_b128 v[108:111], v20 offset:2048
    ds_read2_b32 v[76:77], v17 offset0:128 offset1:129
    ds_read2_b32 v[78:79], v17 offset0:130 offset1:131
    ds_read_b128 v[112:115], v20 offset:1536
    ds_read2_b32 v[80:81], v18 offset0:0 offset1:1
    ds_read2_b32 v[82:83], v18 offset0:2 offset1:3
    ds_read_b128 v[116:119], v20 offset:1024
    ds_read2_b32 v[84:85], v18 offset0:128 offset1:129
    ds_read2_b32 v[86:87], v18 offset0:130 offset1:131
    ds_read_b128 v[120:123], v20 offset:512
    ds_read2_b32 v[88:89], v19 offset0:0 offset1:1
    ds_read2_b32 v[90:91], v19 offset0:2 offset1:3
    ds_read_b128 v[124:127], v20 offset:0
    ds_read2_b32 v[92:93], v19 offset0:128 offset1:129
    ds_read2_b32 v[94:95], v19 offset0:130 offset1:131
    s_add_u32 s44, s38, 256
    s_and_b32 s44, s44, 1023
    s_or_b32 s44, s44, s20
    s_add_u32 m0, s39, 32768
    s_nop 0
    buffer_load_dwordx4 v246, s[24:27], s44 offen offset:0 lds
    buffer_load_dwordx4 v247, s[24:27], s44 offen offset:1024 lds
    s_add_u32 m0, s39, 40960
    s_nop 0
    buffer_load_dwordx4 v248, s[28:31], s44 offen offset:0 lds
    buffer_load_dwordx4 v249, s[28:31], s44 offen offset:1024 lds
    s_add_u32 s44, s38, 384
    s_and_b32 s44, s44, 1023
    s_or_b32 s44, s44, s20
    s_add_u32 m0, s39, 49152
    s_nop 0
    buffer_load_dwordx4 v246, s[24:27], s44 offen offset:0 lds
    buffer_load_dwordx4 v247, s[24:27], s44 offen offset:1024 lds
    s_add_u32 m0, s39, 57344
    s_nop 0
    buffer_load_dwordx4 v248, s[28:31], s44 offen offset:0 lds
    buffer_load_dwordx4 v249, s[28:31], s44 offen offset:1024 lds
    ds_read_b32 v1, v6 offset:64
    s_waitcnt lgkmcnt(0)
    v_cmp_gt_u32 vcc, 2, v1
    s_cbranch_vccnz L_g0
    L_g0_r:
    s_waitcnt lgkmcnt(0)
    v_mfma_f32_16x16x32_bf16 v[32:35], v[24:27], v[96:99], 0
    v_mfma_f32_16x16x32_bf16 v[36:39], v[24:27], v[100:103], 0
    v_mfma_f32_16x16x32_bf16 v[40:43], v[24:27], v[104:107], 0
    v_mfma_f32_16x16x32_bf16 v[44:47], v[24:27], v[108:111], 0
    v_mfma_f32_16x16x32_bf16 v[48:51], v[24:27], v[112:115], 0
    v_mfma_f32_16x16x32_bf16 v[52:55], v[24:27], v[116:119], 0
    v_mfma_f32_16x16x32_bf16 v[56:59], v[24:27], v[120:123], 0
    v_mfma_f32_16x16x32_bf16 v[60:63], v[24:27], v[124:127], 0
    s_mov_b32 s51, 0
L_conv:
    s_cmp_eq_u32 s51, 2
    s_cbranch_scc1 L_cs4
L_cr0:
    s_waitcnt lgkmcnt(0)
    v_mfma_f32_16x16x32_bf16 v[60:63], v[64:67], v[124:127], v[60:63]
    ds_read_b128 v[160:163], v20 offset:3648
    v_mfma_f32_16x16x32_bf16 v[56:59], v[64:67], v[120:123], v[56:59]
    ds_read2_b32 v[128:129], v16 offset0:16 offset1:17
    v_mfma_f32_16x16x32_bf16 v[52:55], v[64:67], v[116:119], v[52:55]
    ds_read2_b32 v[130:131], v16 offset0:18 offset1:19
    v_mfma_f32_16x16x32_bf16 v[48:51], v[64:67], v[112:115], v[48:51]
    ds_read_b128 v[164:167], v20 offset:3136
    v_mfma_f32_16x16x32_bf16 v[60:63], v[68:71], v[120:123], v[60:63]
    ds_read_b32 v1, v6 offset:64
    v_mfma_f32_16x16x32_bf16 v[56:59], v[68:71], v[116:119], v[56:59]
    ds_read2_b32 v[132:133], v16 offset0:144 offset1:145
    v_mfma_f32_16x16x32_bf16 v[52:55], v[68:71], v[112:115], v[52:55]
    ds_read2_b32 v[134:135], v16 offset0:146 offset1:147
    v_mfma_f32_16x16x32_bf16 v[44:47], v[64:67], v[108:111], v[44:47]
    ds_read_b128 v[168:171], v20 offset:2624
    v_mfma_f32_16x16x32_bf16 v[60:63], v[72:75], v[116:119], v[60:63]
    ds_read2_b32 v[136:137], v17 offset0:16 offset1:17
    v_mfma_f32_16x16x32_bf16 v[56:59], v[72:75], v[112:115], v[56:59]
    ds_read2_b32 v[138:139], v17 offset0:18 offset1:19
    v_mfma_f32_16x16x32_bf16 v[48:51], v[68:71], v[108:111], v[48:51]
    s_waitcnt lgkmcnt(5)
    v_cmp_gt_u32 vcc, 2, v1
    v_mfma_f32_16x16x32_bf16 v[52:55], v[72:75], v[108:111], v[52:55]
    ds_read_b128 v[172:175], v20 offset:2112
    s_cbranch_vccnz L_g1
    L_g1_r:
    v_mfma_f32_16x16x32_bf16 v[60:63], v[76:79], v[112:115], v[60:63]
    ds_read2_b32 v[140:141], v17 offset0:144 offset1:145
    v_mfma_f32_16x16x32_bf16 v[56:59], v[76:79], v[108:111], v[56:59]
    ds_read2_b32 v[142:143], v17 offset0:146 offset1:147
    v_mfma_f32_16x16x32_bf16 v[40:43], v[64:67], v[104:107], v[40:43]
    ds_read_b128 v[176:179], v20 offset:1600
    v_mfma_f32_16x16x32_bf16 v[44:47], v[68:71], v[104:107], v[44:47]
    ds_read2_b32 v[144:145], v18 offset0:16 offset1:17
    v_mfma_f32_16x16x32_bf16 v[60:63], v[80:83], v[108:111], v[60:63]
    ds_read_b32 v1, v6 offset:64
    v_mfma_f32_16x16x32_bf16 v[48:51], v[72:75], v[104:107], v[48:51]
    ds_read2_b32 v[146:147], v18 offset0:18 offset1:19
    v_mfma_f32_16x16x32_bf16 v[52:55], v[76:79], v[104:107], v[52:55]
    ds_read_b128 v[180:183], v20 offset:1088
    v_mfma_f32_16x16x32_bf16 v[56:59], v[80:83], v[104:107], v[56:59]
    ds_read2_b32 v[148:149], v18 offset0:144 offset1:145
    v_mfma_f32_16x16x32_bf16 v[60:63], v[84:87], v[104:107], v[60:63]
    ds_read2_b32 v[150:151], v18 offset0:146 offset1:147
    v_mfma_f32_16x16x32_bf16 v[36:39], v[64:67], v[100:103], v[36:39]
    ds_read_b128 v[184:187], v20 offset:576
    v_mfma_f32_16x16x32_bf16 v[40:43], v[68:71], v[100:103], v[40:43]
    s_waitcnt lgkmcnt(5)
    v_cmp_gt_u32 vcc, 2, v1
    v_mfma_f32_16x16x32_bf16 v[44:47], v[72:75], v[100:103], v[44:47]
    ds_read2_b32 v[152:153], v19 offset0:16 offset1:17
    s_cbranch_vccnz L_g2
    L_g2_r:
    v_mfma_f32_16x16x32_bf16 v[48:51], v[76:79], v[100:103], v[48:51]
    ds_read2_b32 v[154:155], v19 offset0:18 offset1:19
    v_mfma_f32_16x16x32_bf16 v[52:55], v[80:83], v[100:103], v[52:55]
    ds_read_b128 v[188:191], v20 offset:64
    v_mfma_f32_16x16x32_bf16 v[56:59], v[84:87], v[100:103], v[56:59]
    ds_read2_b32 v[156:157], v19 offset0:144 offset1:145
    v_mfma_f32_16x16x32_bf16 v[60:63], v[88:91], v[100:103], v[60:63]
    ds_read2_b32 v[158:159], v19 offset0:146 offset1:147
    v_mfma_f32_16x16x32_bf16 v[32:35], v[64:67], v[96:99], v[32:35]
    ds_read_b32 v1, v6 offset:64
    v_mfma_f32_16x16x32_bf16 v[36:39], v[68:71], v[96:99], v[36:39]
    v_mfma_f32_16x16x32_bf16 v[40:43], v[72:75], v[96:99], v[40:43]
    v_mfma_f32_16x16x32_bf16 v[44:47], v[76:79], v[96:99], v[44:47]
    v_mfma_f32_16x16x32_bf16 v[48:51], v[80:83], v[96:99], v[48:51]
    v_mfma_f32_16x16x32_bf16 v[52:55], v[84:87], v[96:99], v[52:55]
    v_mfma_f32_16x16x32_bf16 v[56:59], v[88:91], v[96:99], v[56:59]
    s_waitcnt lgkmcnt(0)
    v_cmp_gt_u32 vcc, 2, v1
    v_mfma_f32_16x16x32_bf16 v[60:63], v[92:95], v[96:99], v[60:63]
    s_cbranch_vccnz L_g3
    L_g3_r:
    s_cmp_eq_u32 s51, 0
    s_cbranch_scc1 L_cs1
L_cr1:
    s_waitcnt lgkmcnt(0)
    v_mfma_f32_16x16x32_bf16 v[60:63], v[128:131], v[188:191], v[60:63]
    ds_read_b128 v[96:99], v20 offset:3712
    v_mfma_f32_16x16x32_bf16 v[56:59], v[128:131], v[184:187], v[56:59]
    ds_read2_b32 v[64:65], v16 offset0:32 offset1:33
    v_mfma_f32_16x16x32_bf16 v[52:55], v[128:131], v[180:183], v[52:55]
    ds_read2_b32 v[66:67], v16 offset0:34 offset1:35
    v_mfma_f32_16x16x32_bf16 v[48:51], v[128:131], v[176:179], v[48:51]
    ds_read_b128 v[100:103], v20 offset:3200
    v_mfma_f32_16x16x32_bf16 v[60:63], v[132:135], v[184:187], v[60:63]
    ds_read_b32 v1, v6 offset:64
    v_mfma_f32_16x16x32_bf16 v[56:59], v[132:135], v[180:183], v[56:59]
    ds_read2_b32 v[68:69], v16 offset0:160 offset1:161
    v_mfma_f32_16x16x32_bf16 v[52:55], v[132:135], v[176:179], v[52:55]
    ds_read2_b32 v[70:71], v16 offset0:162 offset1:163
    v_mfma_f32_16x16x32_bf16 v[44:47], v[128:131], v[172:175], v[44:47]
    ds_read_b128 v[104:107], v20 offset:2688
    v_mfma_f32_16x16x32_bf16 v[60:63], v[136:139], v[180:183], v[60:63]
    ds_read2_b32 v[72:73], v17 offset0:32 offset1:33
    v_mfma_f32_16x16x32_bf16 v[56:59], v[136:139], v[176:179], v[56:59]
    ds_read2_b32 v[74:75], v17 offset0:34 offset1:35
    v_mfma_f32_16x16x32_bf16 v[48:51], v[132:135], v[172:175], v[48:51]
    s_waitcnt lgkmcnt(5)
    v_cmp_gt_u32 vcc, 2, v1
    v_mfma_f32_16x16x32_bf16 v[52:55], v[136:139], v[172:175], v[52:55]
    ds_read_b128 v[108:111], v20 offset:2176
    s_cbranch_vccnz L_g4
    L_g4_r:
    v_mfma_f32_16x16x32_bf16 v[60:63], v[140:143], v[176:179], v[60:63]
    ds_read2_b32 v[76:77], v17 offset0:160 offset1:161
    v_mfma_f32_16x16x32_bf16 v[56:59], v[140:143], v[172:175], v[56:59]
    ds_read2_b32 v[78:79], v17 offset0:162 offset1:163
    v_mfma_f32_16x16x32_bf16 v[40:43], v[128:131], v[168:171], v[40:43]
    ds_read_b128 v[112:115], v20 offset:1664
    v_mfma_f32_16x16x32_bf16 v[44:47], v[132:135], v[168:171], v[44:47]
    ds_read2_b32 v[80:81], v18 offset0:32 offset1:33
    v_mfma_f32_16x16x32_bf16 v[60:63], v[144:147], v[172:175], v[60:63]
    ds_read_b32 v1, v6 offset:64
    v_mfma_f32_16x16x32_bf16 v[48:51], v[136:139], v[168:171], v[48:51]
    ds_read2_b32 v[82:83], v18 offset0:34 offset1:35
    v_mfma_f32_16x16x32_bf16 v[52:55], v[140:143], v[168:171], v[52:55]
    ds_read_b128 v[116:119], v20 offset:1152
    v_mfma_f32_16x16x32_bf16 v[56:59], v[144:147], v[168:171], v[56:59]
    ds_read2_b32 v[84:85], v18 offset0:160 offset1:161
    v_mfma_f32_16x16x32_bf16 v[60:63], v[148:151], v[168:171], v[60:63]
    ds_read2_b32 v[86:87], v18 offset0:162 offset1:163
    v_mfma_f32_16x16x32_bf16 v[36:39], v[128:131], v[164:167], v[36:39]
    ds_read_b128 v[120:123], v20 offset:640
    v_mfma_f32_16x16x32_bf16 v[40:43], v[132:135], v[164:167], v[40:43]
    s_waitcnt lgkmcnt(5)
    v_cmp_gt_u32 vcc, 2, v1
    v_mfma_f32_16x16x32_bf16 v[44:47], v[136:139], v[164:167], v[44:47]
    ds_read2_b32 v[88:89], v19 offset0:32 offset1:33
    s_cbranch_vccnz L_g5
    L_g5_r:
    v_mfma_f32_16x16x32_bf16 v[48:51], v[140:143], v[164:167], v[48:51]
    ds_read2_b32 v[90:91], v19 offset0:34 offset1:35
    v_mfma_f32_16x16x32_bf16 v[52:55], v[144:147], v[164:167], v[52:55]
    ds_read_b128 v[124:127], v20 offset:128
    v_mfma_f32_16x16x32_bf16 v[56:59], v[148:151], v[164:167], v[56:59]
    ds_read2_b32 v[92:93], v19 offset0:160 offset1:161
    v_mfma_f32_16x16x32_bf16 v[60:63], v[152:155], v[164:167], v[60:63]
    ds_read2_b32 v[94:95], v19 offset0:162 offset1:163
    v_mfma_f32_16x16x32_bf16 v[32:35], v[128:131], v[160:163], v[32:35]
    ds_read_b32 v1, v6 offset:64
    v_mfma_f32_16x16x32_bf16 v[36:39], v[132:135], v[160:163], v[36:39]
    v_add_u32 v16, 128, v16
    v_mfma_f32_16x16x32_bf16 v[40:43], v[136:139], v[160:163], v[40:43]
    v_add_u32 v17, 128, v17
    v_mfma_f32_16x16x32_bf16 v[44:47], v[140:143], v[160:163], v[44:47]
    v_add_u32 v18, 128, v18
    v_mfma_f32_16x16x32_bf16 v[48:51], v[144:147], v[160:163], v[48:51]
    v_add_u32 v19, 128, v19
    v_mfma_f32_16x16x32_bf16 v[52:55], v[148:151], v[160:163], v[52:55]
    v_add_u32 v20, 128, v20
    v_mfma_f32_16x16x32_bf16 v[56:59], v[152:155], v[160:163], v[56:59]
    s_waitcnt lgkmcnt(0)
    v_cmp_gt_u32 vcc, 2, v1
    v_mfma_f32_16x16x32_bf16 v[60:63], v[156:159], v[160:163], v[60:63]
    s_cbranch_vccnz L_g6
    L_g6_r:
    s_add_u32 s51, s51, 1
    s_cmp_lt_u32 s51, 4
    s_cbranch_scc1 L_conv
    s_waitcnt lgkmcnt(0)
    s_nop 6
    v_cvt_pk_bf16_f32 v32, v32, v33
    v_cvt_pk_bf16_f32 v33, v34, v35
    ds_write_b64 v21, v[32:33] offset:0
    v_cvt_pk_bf16_f32 v34, v36, v37
    v_cvt_pk_bf16_f32 v35, v38, v39
    ds_write_b64 v21, v[34:35] offset:512
    v_cvt_pk_bf16_f32 v36, v40, v41
    v_cvt_pk_bf16_f32 v37, v42, v43
    ds_write_b64 v21, v[36:37] offset:1024
    v_cvt_pk_bf16_f32 v38, v44, v45
    v_cvt_pk_bf16_f32 v39, v46, v47
    ds_write_b64 v21, v[38:39] offset:1536
    v_cvt_pk_bf16_f32 v40, v48, v49
    v_cvt_pk_bf16_f32 v41, v50, v51
    ds_write_b64 v21, v[40:41] offset:2048
    v_cvt_pk_bf16_f32 v42, v52, v53
    v_cvt_pk_bf16_f32 v43, v54, v55
    ds_write_b64 v21, v[42:43] offset:2560
    v_cvt_pk_bf16_f32 v44, v56, v57
    v_cvt_pk_bf16_f32 v45, v58, v59
    ds_write_b64 v21, v[44:45] offset:3072
    v_cvt_pk_bf16_f32 v46, v60, v61
    v_cvt_pk_bf16_f32 v47, v62, v63
    ds_write_b64 v21, v[46:47] offset:3584
    ds_write_b32 v6, v28 offset:80
    s_add_u32 s8, s66, 4194304
    s_addc_u32 s9, s67, 0
    s_mov_b32 s10, 4194304
    s_mov_b32 s11, 0x00020000
    s_mov_b32 s12, s62
    s_mov_b32 s13, s63
    s_mov_b32 s14, 16777216
    s_mov_b32 s15, 0x00020000
    s_lshr_b32 s7, s32, 2
    s_lshl_b32 s7, s7, 4
    s_add_u32 s7, s7, s33
    s_lshl_b32 s7, s7, 11
    s_add_u32 s7, s7, 262144
    v_lshlrev_b32 v1, 7, v12
    v_add_u32 v16, s7, v1
    v_xor_b32 v1, v12, v13
    v_lshlrev_b32 v1, 4, v1
    v_lshl_add_u32 v3, v13, 14, v1
    s_lshl_b32 s47, s32, 2
    s_add_u32 s47, s47, s6
    s_lshl_b32 s7, s33, 10
    s_add_u32 s7, s7, s47
    s_lshl_b32 s7, s7, 8
    v_add_u32 v17, s7, v3
    v_xor_b32 v18, 64, v17
    v_add_u32 v18, 64512, v18
    v_xor_b32 v19, 128, v17
    v_add_u32 v19, 129024, v19
    v_xor_b32 v20, 192, v17
    v_add_u32 v20, 193536, v20
    s_add_u32 s35, s45, 98304
    v_lshl_add_u32 v1, v12, 8, v1
    v_add_u32 v24, s35, v1
    v_xor_b32 v25, 64, v24
    v_xor_b32 v26, 128, v24
    v_xor_b32 v27, 192, v24
    s_lshl_b32 s47, s47, 10
    s_add_u32 s47, s47, s33
    s_lshl_b32 s47, s47, 8
    v_lshlrev_b32 v1, 13, v13
    v_lshl_add_u32 v1, v12, 4, v1
    v_add_u32 v21, s47, v1
    v_bfe_u32 v1, v2, 2, 2
    v_lshlrev_b32 v1, 14, v1
    v_and_b32 v3, 3, v2
    v_lshl_add_u32 v1, v3, 7, v1
    v_lshl_add_u32 v1, v13, 4, v1
    s_lshl_b32 s7, s6, 10
    s_add_u32 s7, s7, 106496
    v_add_u32 v4, s7, v1
    s_lshl_b32 s7, s34, 12
    v_add_u32 v5, s7, v10
    s_lshr_b32 s47, s34, 2
    s_lshl_b32 s7, s6, 8
    s_add_u32 s7, s7, s47
    s_lshl_b32 s7, s7, 7
    s_add_u32 s7, s7, 262144
    v_lshl_add_u32 v8, v12, 3, s7
    v_add_u32 v9, s39, v10
    v_add_u32 v11, 0xc000, v9
    s_mov_b32 s51, 0
L_zd:
    ds_read_b128 v[44:47], v7 offset:80
    s_add_u32 s51, s51, 1
    s_waitcnt lgkmcnt(0)
    v_xor_b32 v44, v44, v28
    v_xor_b32 v45, v45, v28
    v_xor_b32 v46, v46, v28
    v_xor_b32 v47, v47, v28
    v_or3_b32 v44, v44, v45, v46
    v_or_b32 v44, v44, v47
    s_cmp_gt_u32 s51, 16384
    s_cbranch_scc1 L_zd_ok
    v_cmp_ne_u32 vcc, 0, v44
    s_cbranch_vccnz L_zd
L_zd_ok:
    ds_read_b64_tr_b16 v[44:45], v4 offset:0
    ds_read_b64_tr_b16 v[46:47], v4 offset:8
    ds_read_b64_tr_b16 v[48:49], v4 offset:64
    ds_read_b64_tr_b16 v[50:51], v4 offset:72
    ds_read_b64_tr_b16 v[52:53], v4 offset:512
    ds_read_b64_tr_b16 v[54:55], v4 offset:520
    ds_read_b64_tr_b16 v[56:57], v4 offset:576
    ds_read_b64_tr_b16 v[58:59], v4 offset:584
    s_waitcnt lgkmcnt(0)
    buffer_store_dwordx4 v[44:47], v5, s[8:11], 0 offen offset:0 sc1
    buffer_store_dwordx4 v[48:51], v5, s[8:11], 0 offen offset:1024 sc1
    buffer_store_dwordx4 v[52:55], v5, s[8:11], 0 offen offset:2048 sc1
    buffer_store_dwordx4 v[56:59], v5, s[8:11], 0 offen offset:3072 sc1
    s_waitcnt vmcnt(23)
    s_add_u32 s44, s38, 1408
    s_and_b32 s44, s44, 1023
    s_or_b32 s44, s44, s21
    buffer_load_dwordx4 v[208:211], v246, s[24:27], s44 offen offset:0
    s_waitcnt vmcnt(23)
    buffer_load_dwordx4 v[212:215], v247, s[24:27], s44 offen offset:1024
    s_waitcnt vmcnt(23)
    buffer_load_dwordx4 v[216:219], v248, s[28:31], s44 offen offset:0
    s_waitcnt vmcnt(23)
    buffer_load_dwordx4 v[220:223], v249, s[28:31], s44 offen offset:1024
    s_waitcnt vmcnt(23)
    s_add_u32 s44, s38, 1536
    s_and_b32 s44, s44, 1023
    s_or_b32 s44, s44, s21
    buffer_load_dwordx4 v[224:227], v246, s[24:27], s44 offen offset:0
    s_waitcnt vmcnt(23)
    buffer_load_dwordx4 v[228:231], v247, s[24:27], s44 offen offset:1024
    s_waitcnt vmcnt(23)
    buffer_load_dwordx4 v[232:235], v248, s[28:31], s44 offen offset:0
    s_waitcnt vmcnt(23)
    buffer_load_dwordx4 v[236:239], v249, s[28:31], s44 offen offset:1024
    s_waitcnt vmcnt(8)
    s_mov_b64 exec, 0xffff
    buffer_store_dwordx2 v[28:29], v8, s[76:79], 0 offen sc1
    s_mov_b64 exec, -1
    s_mov_b32 s51, 0
L_p1:
    ds_read_b128 v[32:35], v7 offset:96
    s_add_u32 s51, s51, 1
    s_waitcnt lgkmcnt(0)
    v_min3_u32 v32, v32, v33, v34
    v_min_u32 v32, v32, v35
    s_cmp_gt_u32 s51, 65536
    s_cbranch_scc1 L_p1_ok
    v_cmp_gt_u32 vcc, 1, v32
    s_cbranch_vccnz L_p1
L_p1_ok:
    s_waitcnt vmcnt(23)
    s_add_u32 s44, s38, 1664
    s_and_b32 s44, s44, 1023
    s_or_b32 s44, s44, s21
    buffer_load_dwordx4 v[64:67], v246, s[24:27], s44 offen offset:0
    s_waitcnt vmcnt(23)
    buffer_load_dwordx4 v[68:71], v247, s[24:27], s44 offen offset:1024
    s_waitcnt vmcnt(23)
    buffer_load_dwordx4 v[72:75], v248, s[28:31], s44 offen offset:0
    s_waitcnt vmcnt(23)
    buffer_load_dwordx4 v[76:79], v249, s[28:31], s44 offen offset:1024
    s_mov_b32 s51, 0
L_p2:
    ds_read_b128 v[32:35], v7 offset:96
    s_add_u32 s51, s51, 1
    s_waitcnt lgkmcnt(0)
    v_min3_u32 v32, v32, v33, v34
    v_min_u32 v32, v32, v35
    s_cmp_gt_u32 s51, 65536
    s_cbranch_scc1 L_p2_ok
    v_cmp_gt_u32 vcc, 2, v32
    s_cbranch_vccnz L_p2
L_p2_ok:
    s_waitcnt vmcnt(23)
    s_add_u32 s44, s38, 1792
    s_and_b32 s44, s44, 1023
    s_or_b32 s44, s44, s21
    buffer_load_dwordx4 v[80:83], v246, s[24:27], s44 offen offset:0
    s_waitcnt vmcnt(23)
    buffer_load_dwordx4 v[84:87], v247, s[24:27], s44 offen offset:1024
    s_waitcnt vmcnt(23)
    buffer_load_dwordx4 v[88:91], v248, s[28:31], s44 offen offset:0
    s_waitcnt vmcnt(23)
    buffer_load_dwordx4 v[92:95], v249, s[28:31], s44 offen offset:1024
    s_mov_b32 s51, 0
L_p3:
    ds_read_b128 v[32:35], v7 offset:96
    s_add_u32 s51, s51, 1
    s_waitcnt lgkmcnt(0)
    v_min3_u32 v32, v32, v33, v34
    v_min_u32 v32, v32, v35
    s_cmp_gt_u32 s51, 65536
    s_cbranch_scc1 L_p3_ok
    v_cmp_gt_u32 vcc, 3, v32
    s_cbranch_vccnz L_p3
L_p3_ok:
    s_waitcnt vmcnt(23)
    s_add_u32 s44, s38, 1920
    s_and_b32 s44, s44, 1023
    s_or_b32 s44, s44, s21
    buffer_load_dwordx4 v[96:99], v246, s[24:27], s44 offen offset:0
    s_waitcnt vmcnt(23)
    buffer_load_dwordx4 v[100:103], v247, s[24:27], s44 offen offset:1024
    s_waitcnt vmcnt(23)
    buffer_load_dwordx4 v[104:107], v248, s[28:31], s44 offen offset:0
    s_waitcnt vmcnt(23)
    buffer_load_dwordx4 v[108:111], v249, s[28:31], s44 offen offset:1024
    s_mov_b32 s51, 0
L_p6:
    ds_read_b128 v[32:35], v7 offset:96
    s_add_u32 s51, s51, 1
    s_waitcnt lgkmcnt(0)
    v_min3_u32 v32, v32, v33, v34
    v_min_u32 v32, v32, v35
    s_cmp_gt_u32 s51, 65536
    s_cbranch_scc1 L_p6_ok
    v_cmp_gt_u32 vcc, 6, v32
    s_cbranch_vccnz L_p6
L_p6_ok:
    v_mov_b32 v3, 12
    s_waitcnt vmcnt(17)
    ds_write_b128 v11, v[208:211] offset:32768
    ds_write_b128 v11, v[212:215] offset:33792
    ds_write_b128 v11, v[216:219] offset:40960
    ds_write_b128 v11, v[220:223] offset:41984
    ds_write_b32 v6, v3 offset:48
    buffer_load_dwordx2 v[22:23], v16, s[76:79], 0 offen sc1
    s_mov_b32 s51, 0
L_p7:
    ds_read_b128 v[32:35], v7 offset:96
    s_add_u32 s51, s51, 1
    s_waitcnt lgkmcnt(0)
    v_min3_u32 v32, v32, v33, v34
    v_min_u32 v32, v32, v35
    s_cmp_gt_u32 s51, 65536
    s_cbranch_scc1 L_p7_ok
    v_cmp_gt_u32 vcc, 7, v32
    s_cbranch_vccnz L_p7
L_p7_ok:
    v_mov_b32 v3, 13
    s_waitcnt vmcnt(14)
    ds_write_b128 v9, v[224:227] offset:0
    ds_write_b128 v9, v[228:231] offset:1024
    ds_write_b128 v9, v[232:235] offset:8192
    ds_write_b128 v9, v[236:239] offset:9216
    ds_write_b32 v6, v3 offset:48
    s_mov_b32 s51, 0
L_p8:
    ds_read_b128 v[32:35], v7 offset:96
    s_add_u32 s51, s51, 1
    s_waitcnt lgkmcnt(0)
    v_min3_u32 v32, v32, v33, v34
    v_min_u32 v32, v32, v35
    s_cmp_gt_u32 s51, 65536
    s_cbranch_scc1 L_p8_ok
    v_cmp_gt_u32 vcc, 8, v32
    s_cbranch_vccnz L_p8
L_p8_ok:
    v_mov_b32 v3, 14
    s_waitcnt vmcnt(9)
    ds_write_b128 v9, v[64:67] offset:16384
    ds_write_b128 v9, v[68:71] offset:17408
    ds_write_b128 v9, v[72:75] offset:24576
    ds_write_b128 v9, v[76:79] offset:25600
    ds_write_b32 v6, v3 offset:48
    s_waitcnt vmcnt(0)
    v_cmp_eq_u32 vcc, v22, v28
    v_cmp_eq_u32 s[48:49], v23, v29
    s_mov_b32 m0, s35
    s_and_b64 s[48:49], s[48:49], vcc
    s_cmp_eq_u64 s[48:49], -1
    s_cbranch_scc1 L_zspin_go
    s_mov_b32 s51, 0
L_zspin:
    buffer_load_dwordx2 v[22:23], v16, s[76:79], 0 offen sc1
    s_add_u32 s51, s51, 1
    s_waitcnt vmcnt(0)
    v_cmp_eq_u32 vcc, v22, v28
    v_cmp_eq_u32 s[48:49], v23, v29
    s_cmp_gt_u32 s51, 4096
    s_cbranch_scc1 L_zspin_go
    s_and_b64 s[48:49], s[48:49], vcc
    s_cmp_eq_u64 s[48:49], -1
    s_cbranch_scc0 L_zspin
L_zspin_go:
    buffer_load_dwordx4 v17, s[8:11], 0 offen offset:0 sc1 lds
    buffer_load_dwordx4 v18, s[8:11], 0 offen offset:1024 sc1 lds
    buffer_load_dwordx4 v19, s[8:11], 0 offen offset:2048 sc1 lds
    buffer_load_dwordx4 v20, s[8:11], 0 offen offset:3072 sc1 lds
    s_mov_b32 s51, 0
L_p9:
    ds_read_b128 v[32:35], v7 offset:96
    s_add_u32 s51, s51, 1
    s_waitcnt lgkmcnt(0)
    v_min3_u32 v32, v32, v33, v34
    v_min_u32 v32, v32, v35
    s_cmp_gt_u32 s51, 65536
    s_cbranch_scc1 L_p9_ok
    v_cmp_gt_u32 vcc, 9, v32
    s_cbranch_vccnz L_p9
L_p9_ok:
    v_mov_b32 v3, 15
    s_waitcnt vmcnt(9)
    ds_write_b128 v9, v[80:83] offset:32768
    ds_write_b128 v9, v[84:87] offset:33792
    ds_write_b128 v9, v[88:91] offset:40960
    ds_write_b128 v9, v[92:95] offset:41984
    ds_write_b32 v6, v3 offset:48
    s_mov_b32 s51, 0
L_p10:
    ds_read_b128 v[32:35], v7 offset:96
    s_add_u32 s51, s51, 1
    s_waitcnt lgkmcnt(0)
    v_min3_u32 v32, v32, v33, v34
    v_min_u32 v32, v32, v35
    s_cmp_gt_u32 s51, 65536
    s_cbranch_scc1 L_p10_ok
    v_cmp_gt_u32 vcc, 10, v32
    s_cbranch_vccnz L_p10
L_p10_ok:
    v_mov_b32 v3, 16
    s_waitcnt vmcnt(5)
    ds_write_b128 v11, v[96:99] offset:0
    ds_write_b128 v11, v[100:103] offset:1024
    ds_write_b128 v11, v[104:107] offset:8192
    ds_write_b128 v11, v[108:111] offset:9216
    ds_write_b32 v6, v3 offset:48
    s_waitcnt vmcnt(0) lgkmcnt(0)
    ds_read_b128 v[44:47], v24
    ds_read_b128 v[48:51], v25
    ds_read_b128 v[52:55], v26
    ds_read_b128 v[56:59], v27
    s_waitcnt lgkmcnt(3)
    v_lshlrev_b32 v1, 16, v44
    v_lshlrev_b32 v36, 16, v192
    v_mul_f32 v36, v36, v1
    v_and_b32 v1, 0xffff0000, v44
    v_and_b32 v37, 0xffff0000, v192
    v_mul_f32 v37, v37, v1
    v_lshlrev_b32 v1, 16, v45
    v_lshlrev_b32 v38, 16, v193
    v_mul_f32 v38, v38, v1
    v_and_b32 v1, 0xffff0000, v45
    v_and_b32 v39, 0xffff0000, v193
    v_mul_f32 v39, v39, v1
    s_mov_b32 s7, 0
    buffer_store_dwordx4 v[36:39], v21, s[12:15], s7 offen nt
    v_lshlrev_b32 v1, 16, v46
    v_lshlrev_b32 v40, 16, v200
    v_mul_f32 v40, v40, v1
    v_and_b32 v1, 0xffff0000, v46
    v_and_b32 v41, 0xffff0000, v200
    v_mul_f32 v41, v41, v1
    v_lshlrev_b32 v1, 16, v47
    v_lshlrev_b32 v42, 16, v201
    v_mul_f32 v42, v42, v1
    v_and_b32 v1, 0xffff0000, v47
    v_and_b32 v43, 0xffff0000, v201
    v_mul_f32 v43, v43, v1
    s_mov_b32 s7, 131072
    buffer_store_dwordx4 v[40:43], v21, s[12:15], s7 offen nt
    s_waitcnt lgkmcnt(2)
    v_lshlrev_b32 v1, 16, v48
    v_lshlrev_b32 v36, 16, v194
    v_mul_f32 v36, v36, v1
    v_and_b32 v1, 0xffff0000, v48
    v_and_b32 v37, 0xffff0000, v194
    v_mul_f32 v37, v37, v1
    v_lshlrev_b32 v1, 16, v49
    v_lshlrev_b32 v38, 16, v195
    v_mul_f32 v38, v38, v1
    v_and_b32 v1, 0xffff0000, v49
    v_and_b32 v39, 0xffff0000, v195
    v_mul_f32 v39, v39, v1
    s_mov_b32 s7, 32768
    buffer_store_dwordx4 v[36:39], v21, s[12:15], s7 offen nt
    v_lshlrev_b32 v1, 16, v50
    v_lshlrev_b32 v40, 16, v202
    v_mul_f32 v40, v40, v1
    v_and_b32 v1, 0xffff0000, v50
    v_and_b32 v41, 0xffff0000, v202
    v_mul_f32 v41, v41, v1
    v_lshlrev_b32 v1, 16, v51
    v_lshlrev_b32 v42, 16, v203
    v_mul_f32 v42, v42, v1
    v_and_b32 v1, 0xffff0000, v51
    v_and_b32 v43, 0xffff0000, v203
    v_mul_f32 v43, v43, v1
    s_mov_b32 s7, 163840
    buffer_store_dwordx4 v[40:43], v21, s[12:15], s7 offen nt
    s_waitcnt lgkmcnt(1)
    v_lshlrev_b32 v1, 16, v52
    v_lshlrev_b32 v36, 16, v196
    v_mul_f32 v36, v36, v1
    v_and_b32 v1, 0xffff0000, v52
    v_and_b32 v37, 0xffff0000, v196
    v_mul_f32 v37, v37, v1
    v_lshlrev_b32 v1, 16, v53
    v_lshlrev_b32 v38, 16, v197
    v_mul_f32 v38, v38, v1
    v_and_b32 v1, 0xffff0000, v53
    v_and_b32 v39, 0xffff0000, v197
    v_mul_f32 v39, v39, v1
    s_mov_b32 s7, 65536
    buffer_store_dwordx4 v[36:39], v21, s[12:15], s7 offen nt
    v_lshlrev_b32 v1, 16, v54
    v_lshlrev_b32 v40, 16, v204
    v_mul_f32 v40, v40, v1
    v_and_b32 v1, 0xffff0000, v54
    v_and_b32 v41, 0xffff0000, v204
    v_mul_f32 v41, v41, v1
    v_lshlrev_b32 v1, 16, v55
    v_lshlrev_b32 v42, 16, v205
    v_mul_f32 v42, v42, v1
    v_and_b32 v1, 0xffff0000, v55
    v_and_b32 v43, 0xffff0000, v205
    v_mul_f32 v43, v43, v1
    s_mov_b32 s7, 196608
    buffer_store_dwordx4 v[40:43], v21, s[12:15], s7 offen nt
    s_waitcnt lgkmcnt(0)
    v_lshlrev_b32 v1, 16, v56
    v_lshlrev_b32 v36, 16, v198
    v_mul_f32 v36, v36, v1
    v_and_b32 v1, 0xffff0000, v56
    v_and_b32 v37, 0xffff0000, v198
    v_mul_f32 v37, v37, v1
    v_lshlrev_b32 v1, 16, v57
    v_lshlrev_b32 v38, 16, v199
    v_mul_f32 v38, v38, v1
    v_and_b32 v1, 0xffff0000, v57
    v_and_b32 v39, 0xffff0000, v199
    v_mul_f32 v39, v39, v1
    s_mov_b32 s7, 98304
    buffer_store_dwordx4 v[36:39], v21, s[12:15], s7 offen nt
    v_lshlrev_b32 v1, 16, v58
    v_lshlrev_b32 v40, 16, v206
    v_mul_f32 v40, v40, v1
    v_and_b32 v1, 0xffff0000, v58
    v_and_b32 v41, 0xffff0000, v206
    v_mul_f32 v41, v41, v1
    v_lshlrev_b32 v1, 16, v59
    v_lshlrev_b32 v42, 16, v207
    v_mul_f32 v42, v42, v1
    v_and_b32 v1, 0xffff0000, v59
    v_and_b32 v43, 0xffff0000, v207
    v_mul_f32 v43, v43, v1
    s_mov_b32 s7, 229376
    buffer_store_dwordx4 v[40:43], v21, s[12:15], s7 offen nt
K_fin:
K_done:
    s_endpgm
L_g0:
    s_mov_b32 s50, 0
L_g0_s:
    ds_read_b32 v1, v6 offset:64
    s_add_u32 s50, s50, 1
    s_waitcnt lgkmcnt(0)
    v_readfirstlane_b32 s7, v1
    s_cmp_gt_u32 s50, 4096
    s_cbranch_scc1 L_g0_r
    s_cmp_lt_u32 s7, 2
    s_cbranch_scc1 L_g0_s
    s_branch L_g0_r
L_cs1:
    s_add_u32 s44, s38, 512
    s_and_b32 s44, s44, 1023
    s_or_b32 s44, s44, s20
    s_add_u32 m0, s39, 65536
    s_nop 0
    buffer_load_dwordx4 v246, s[24:27], s44 offen offset:0 lds
    buffer_load_dwordx4 v247, s[24:27], s44 offen offset:1024 lds
    s_add_u32 m0, s39, 73728
    s_nop 0
    buffer_load_dwordx4 v248, s[28:31], s44 offen offset:0 lds
    buffer_load_dwordx4 v249, s[28:31], s44 offen offset:1024 lds
    s_add_u32 s44, s38, 640
    s_and_b32 s44, s44, 1023
    s_or_b32 s44, s44, s20
    s_add_u32 m0, s39, 81920
    s_nop 0
    buffer_load_dwordx4 v246, s[24:27], s44 offen offset:0 lds
    buffer_load_dwordx4 v247, s[24:27], s44 offen offset:1024 lds
    s_add_u32 m0, s39, 90112
    s_nop 0
    buffer_load_dwordx4 v248, s[28:31], s44 offen offset:0 lds
    buffer_load_dwordx4 v249, s[28:31], s44 offen offset:1024 lds
    s_branch L_cr1
L_cs4:
    v_mov_b32 v3, 6
    s_waitcnt vmcnt(0)
    ds_write_b32 v6, v3 offset:48
    s_branch L_cr0
L_g1:
    s_mov_b32 s50, 0
L_g1_s:
    ds_read_b32 v1, v6 offset:64
    s_add_u32 s50, s50, 1
    s_waitcnt lgkmcnt(0)
    v_readfirstlane_b32 s7, v1
    s_cmp_gt_u32 s50, 4096
    s_cbranch_scc1 L_g1_r
    s_cmp_lt_u32 s7, 2
    s_cbranch_scc1 L_g1_s
    s_branch L_g1_r
L_g2:
    s_mov_b32 s50, 0
L_g2_s:
    ds_read_b32 v1, v6 offset:64
    s_add_u32 s50, s50, 1
    s_waitcnt lgkmcnt(0)
    v_readfirstlane_b32 s7, v1
    s_cmp_gt_u32 s50, 4096
    s_cbranch_scc1 L_g2_r
    s_cmp_lt_u32 s7, 2
    s_cbranch_scc1 L_g2_s
    s_branch L_g2_r
L_g3:
    s_mov_b32 s50, 0
L_g3_s:
    ds_read_b32 v1, v6 offset:64
    s_add_u32 s50, s50, 1
    s_waitcnt lgkmcnt(0)
    v_readfirstlane_b32 s7, v1
    s_cmp_gt_u32 s50, 4096
    s_cbranch_scc1 L_g3_r
    s_cmp_lt_u32 s7, 2
    s_cbranch_scc1 L_g3_s
    s_branch L_g3_r
L_g4:
    s_mov_b32 s50, 0
L_g4_s:
    ds_read_b32 v1, v6 offset:64
    s_add_u32 s50, s50, 1
    s_waitcnt lgkmcnt(0)
    v_readfirstlane_b32 s7, v1
    s_cmp_gt_u32 s50, 4096
    s_cbranch_scc1 L_g4_r
    s_cmp_lt_u32 s7, 2
    s_cbranch_scc1 L_g4_s
    s_branch L_g4_r
L_g5:
    s_mov_b32 s50, 0
L_g5_s:
    ds_read_b32 v1, v6 offset:64
    s_add_u32 s50, s50, 1
    s_waitcnt lgkmcnt(0)
    v_readfirstlane_b32 s7, v1
    s_cmp_gt_u32 s50, 4096
    s_cbranch_scc1 L_g5_r
    s_cmp_lt_u32 s7, 2
    s_cbranch_scc1 L_g5_s
    s_branch L_g5_r
L_g6:
    s_mov_b32 s50, 0
L_g6_s:
    ds_read_b32 v1, v6 offset:64
    s_add_u32 s50, s50, 1
    s_waitcnt lgkmcnt(0)
    v_readfirstlane_b32 s7, v1
    s_cmp_gt_u32 s50, 4096
    s_cbranch_scc1 L_g6_r
    s_cmp_lt_u32 s7, 2
    s_cbranch_scc1 L_g6_s
    s_branch L_g6_r
C_x0:
    v_add_u32 v240, 98304, v240
    v_add_u32 v241, 98304, v241
    ds_read_b128 v[208:211], v240 offset:0
    ds_read_b128 v[212:215], v241 offset:0
    ds_read_b128 v[216:219], v240 offset:2048
    ds_read_b128 v[220:223], v241 offset:2048
    s_branch C_x0_r
C_x1:
    v_add_u32 v240, 0, v240
    v_add_u32 v241, 0, v241
    ds_read_b128 v[208:211], v240 offset:0
    ds_read_b128 v[212:215], v241 offset:0
    ds_read_b128 v[216:219], v240 offset:2048
    ds_read_b128 v[220:223], v241 offset:2048
    s_branch C_x1_r
C_x2:
    v_add_u32 v240, 32768, v240
    v_add_u32 v241, 32768, v241
    ds_read_b128 v[208:211], v240 offset:0
    ds_read_b128 v[212:215], v241 offset:0
    ds_read_b128 v[216:219], v240 offset:2048
    ds_read_b128 v[220:223], v241 offset:2048
    s_branch C_x2_r
C_x3:
    v_add_u32 v240, 65536, v240
    v_add_u32 v241, 65536, v241
    ds_read_b128 v[208:211], v240 offset:0
    ds_read_b128 v[212:215], v241 offset:0
    ds_read_b128 v[216:219], v240 offset:2048
    ds_read_b128 v[220:223], v241 offset:2048
    s_branch C_x3_r
C_x4:
    v_add_u32 v240, 98304, v240
    v_add_u32 v241, 98304, v241
    ds_read_b128 v[208:211], v240 offset:0
    ds_read_b128 v[212:215], v241 offset:0
    ds_read_b128 v[216:219], v240 offset:2048
    ds_read_b128 v[220:223], v241 offset:2048
    s_branch C_x4_r
C_non:
    s_mov_b32 s39, 0
C_non_s:
    buffer_load_dwordx2 v[54:55], off, s[16:19], 0 sc1
    s_add_u32 s39, s39, 1
    s_waitcnt vmcnt(0)
    s_cmp_gt_u32 s39, 4096
    s_cbranch_scc1 C_non_r
    v_readfirstlane_b32 s7, v54
    s_cmp_lg_u32 s7, 0
    s_cbranch_scc0 C_non_s
    s_branch C_non_r
C_x5:
    v_add_u32 v240, 0, v240
    v_add_u32 v241, 0, v241
    ds_read_b128 v[208:211], v240 offset:0
    ds_read_b128 v[212:215], v241 offset:0
    ds_read_b128 v[216:219], v240 offset:2048
    ds_read_b128 v[220:223], v241 offset:2048
    s_branch C_x5_r
C_x6:
    v_add_u32 v240, 32768, v240
    v_add_u32 v241, 32768, v241
    ds_read_b128 v[208:211], v240 offset:0
    ds_read_b128 v[212:215], v241 offset:0
    ds_read_b128 v[216:219], v240 offset:2048
    ds_read_b128 v[220:223], v241 offset:2048
    s_branch C_x6_r
C_x7:
    v_add_u32 v240, 65536, v240
    v_add_u32 v241, 65536, v241
    ds_read_b128 v[208:211], v240 offset:0
    ds_read_b128 v[212:215], v241 offset:0
    ds_read_b128 v[216:219], v240 offset:2048
    ds_read_b128 v[220:223], v241 offset:2048
    s_branch C_x7_r
C_x8:
    v_add_u32 v240, 98304, v240
    v_add_u32 v241, 98304, v241
    ds_read_b128 v[208:211], v240 offset:0
    ds_read_b128 v[212:215], v241 offset:0
    ds_read_b128 v[216:219], v240 offset:2048
    ds_read_b128 v[220:223], v241 offset:2048
    s_branch C_x8_r
C_x9:
    v_add_u32 v240, 0, v240
    v_add_u32 v241, 0, v241
    ds_read_b128 v[208:211], v240 offset:0
    ds_read_b128 v[212:215], v241 offset:0
    ds_read_b128 v[216:219], v240 offset:2048
    ds_read_b128 v[220:223], v241 offset:2048
    s_branch C_x9_r
C_x10:
    v_add_u32 v240, 32768, v240
    v_add_u32 v241, 32768, v241
    ds_read_b128 v[208:211], v240 offset:0
    ds_read_b128 v[212:215], v241 offset:0
    ds_read_b128 v[216:219], v240 offset:2048
    ds_read_b128 v[220:223], v241 offset:2048
    s_branch C_x10_r
C_x11:
    v_add_u32 v240, 65536, v240
    v_add_u32 v241, 65536, v241
    ds_read_b128 v[208:211], v240 offset:0
    ds_read_b128 v[212:215], v241 offset:0
    ds_read_b128 v[216:219], v240 offset:2048
    ds_read_b128 v[220:223], v241 offset:2048
    s_branch C_x11_r
C_x12:
    v_add_u32 v240, 98304, v240
    v_add_u32 v241, 98304, v241
    ds_read_b128 v[208:211], v240 offset:0
    ds_read_b128 v[212:215], v241 offset:0
    ds_read_b128 v[216:219], v240 offset:2048
    ds_read_b128 v[220:223], v241 offset:2048
    s_branch C_x12_r
C_x13:
    v_add_u32 v240, 0, v240
    v_add_u32 v241, 0, v241
    ds_read_b128 v[208:211], v240 offset:0
    ds_read_b128 v[212:215], v241 offset:0
    ds_read_b128 v[216:219], v240 offset:2048
    ds_read_b128 v[220:223], v241 offset:2048
    s_branch C_x13_r
C_kvp:
    s_mov_b32 s39, 0
C_kvp_s:
    buffer_load_dwordx2 v[244:245], v246, s[72:75], s21 offen sc1
    s_add_u32 s39, s39, 1
    s_waitcnt vmcnt(0)
    s_cmp_gt_u32 s39, 4096
    s_cbranch_scc1 C_kvp_r
    v_cmp_eq_u32 vcc, v244, v54
    v_cmp_eq_u32 s[54:55], v245, v55
    s_mov_b32 m0, s23
    s_and_b64 s[54:55], s[54:55], vcc
    s_cmp_eq_u64 s[54:55], -1
    s_cbranch_scc0 C_kvp_s
    s_branch C_kvp_r
C_x14:
    v_add_u32 v240, 32768, v240
    v_add_u32 v241, 32768, v241
    ds_read_b128 v[208:211], v240 offset:0
    ds_read_b128 v[212:215], v241 offset:0
    ds_read_b128 v[216:219], v240 offset:2048
    ds_read_b128 v[220:223], v241 offset:2048
    s_branch C_x14_r
C_x15:
    v_add_u32 v240, 65536, v240
    v_add_u32 v241, 65536, v241
    ds_read_b128 v[208:211], v240 offset:0
    ds_read_b128 v[212:215], v241 offset:0
    ds_read_b128 v[216:219], v240 offset:2048
    ds_read_b128 v[220:223], v241 offset:2048
    s_branch C_x15_r
C2_h1:
    s_mov_b32 s39, 0
C2_h1_s:
    buffer_load_dwordx2 v[248:249], v51, s[72:75], 0 offen sc1
    s_add_u32 s39, s39, 1
    s_waitcnt vmcnt(0)
    s_cmp_gt_u32 s39, 4096
    s_cbranch_scc1 C2_h1_r
    v_cmp_eq_u32 vcc, v248, v54
    v_cmp_eq_u32 s[54:55], v249, v55
    s_nop 0
    s_and_b64 s[54:55], s[54:55], vcc
    s_or_b32 s54, s54, 15
    s_ff0_i32_b64 s7, s[54:55]
    s_lshr_b32 s7, s7, 2
    s_max_u32 s37, s37, s7
    s_cmp_gt_u32 s37, 1
    s_cbranch_scc0 C2_h1_s
    s_branch C2_h1_r
C_crdy:
    s_mov_b32 s39, 0
C_crdy_s:
    ds_read_b128 v[12:15], v62 offset:48
    s_add_u32 s39, s39, 1
    s_waitcnt lgkmcnt(0)
    v_min3_u32 v12, v12, v13, v14
    v_min_u32 v12, v12, v15
    v_cmp_gt_u32 vcc, 6, v12
    s_cmp_gt_u32 s39, 65536
    s_cbranch_scc1 C_crdy_r
    s_cbranch_vccnz C_crdy_s
    s_branch C_crdy_r
C2_h2:
    s_mov_b32 s39, 0
C2_h2_s:
    buffer_load_dwordx2 v[248:249], v51, s[72:75], 0 offen sc1
    s_add_u32 s39, s39, 1
    s_waitcnt vmcnt(0)
    s_cmp_gt_u32 s39, 4096
    s_cbranch_scc1 C2_h2_r
    v_cmp_eq_u32 vcc, v248, v54
    v_cmp_eq_u32 s[54:55], v249, v55
    s_nop 0
    s_and_b64 s[54:55], s[54:55], vcc
    s_or_b32 s54, s54, 15
    s_ff0_i32_b64 s7, s[54:55]
    s_lshr_b32 s7, s7, 2
    s_max_u32 s37, s37, s7
    s_cmp_gt_u32 s37, 2
    s_cbranch_scc0 C2_h2_s
    s_branch C2_h2_r
C2_h3:
    s_mov_b32 s39, 0
C2_h3_s:
    buffer_load_dwordx2 v[248:249], v51, s[72:75], 0 offen sc1
    s_add_u32 s39, s39, 1
    s_waitcnt vmcnt(0)
    s_cmp_gt_u32 s39, 4096
    s_cbranch_scc1 C2_h3_r
    v_cmp_eq_u32 vcc, v248, v54
    v_cmp_eq_u32 s[54:55], v249, v55
    s_nop 0
    s_and_b64 s[54:55], s[54:55], vcc
    s_or_b32 s54, s54, 15
    s_ff0_i32_b64 s7, s[54:55]
    s_lshr_b32 s7, s7, 2
    s_max_u32 s37, s37, s7
    s_cmp_gt_u32 s37, 3
    s_cbranch_scc0 C2_h3_s
    s_branch C2_h3_r
C2_p2:
    s_mov_b32 s39, 0
C2_p2_s:
    ds_read_b128 v[56:59], v62 offset:96
    s_add_u32 s39, s39, 1
    s_waitcnt lgkmcnt(0)
    v_min3_u32 v56, v56, v57, v58
    v_min_u32 v56, v56, v59
    v_cmp_gt_u32 vcc, 1, v56
    s_cmp_gt_u32 s39, 65536
    s_cbranch_scc1 C2_p2_r
    s_cbranch_vccnz C2_p2_s
    s_branch C2_p2_r
C2_h4:
    s_mov_b32 s39, 0
C2_h4_s:
    buffer_load_dwordx2 v[248:249], v51, s[72:75], 0 offen sc1
    s_add_u32 s39, s39, 1
    s_waitcnt vmcnt(0)
    s_cmp_gt_u32 s39, 4096
    s_cbranch_scc1 C2_h4_r
    v_cmp_eq_u32 vcc, v248, v54
    v_cmp_eq_u32 s[54:55], v249, v55
    s_nop 0
    s_and_b64 s[54:55], s[54:55], vcc
    s_or_b32 s54, s54, 15
    s_ff0_i32_b64 s7, s[54:55]
    s_lshr_b32 s7, s7, 2
    s_max_u32 s37, s37, s7
    s_cmp_gt_u32 s37, 4
    s_cbranch_scc0 C2_h4_s
    s_branch C2_h4_r
C2_p3:
    s_mov_b32 s39, 0
C2_p3_s:
    ds_read_b128 v[56:59], v62 offset:96
    s_add_u32 s39, s39, 1
    s_waitcnt lgkmcnt(0)
    v_min3_u32 v56, v56, v57, v58
    v_min_u32 v56, v56, v59
    v_cmp_gt_u32 vcc, 2, v56
    s_cmp_gt_u32 s39, 65536
    s_cbranch_scc1 C2_p3_r
    s_cbranch_vccnz C2_p3_s
    s_branch C2_p3_r
C2_h5:
    s_mov_b32 s39, 0
C2_h5_s:
    buffer_load_dwordx2 v[248:249], v51, s[72:75], 0 offen sc1
    s_add_u32 s39, s39, 1
    s_waitcnt vmcnt(0)
    s_cmp_gt_u32 s39, 4096
    s_cbranch_scc1 C2_h5_r
    v_cmp_eq_u32 vcc, v248, v54
    v_cmp_eq_u32 s[54:55], v249, v55
    s_nop 0
    s_and_b64 s[54:55], s[54:55], vcc
    s_or_b32 s54, s54, 15
    s_ff0_i32_b64 s7, s[54:55]
    s_lshr_b32 s7, s7, 2
    s_max_u32 s37, s37, s7
    s_cmp_gt_u32 s37, 5
    s_cbranch_scc0 C2_h5_s
    s_branch C2_h5_r
C2_p4:
    s_mov_b32 s39, 0
C2_p4_s:
    ds_read_b128 v[56:59], v62 offset:96
    s_add_u32 s39, s39, 1
    s_waitcnt lgkmcnt(0)
    v_min3_u32 v56, v56, v57, v58
    v_min_u32 v56, v56, v59
    v_cmp_gt_u32 vcc, 3, v56
    s_cmp_gt_u32 s39, 65536
    s_cbranch_scc1 C2_p4_r
    s_cbranch_vccnz C2_p4_s
    s_branch C2_p4_r
C2_h6:
    s_mov_b32 s39, 0
C2_h6_s:
    buffer_load_dwordx2 v[248:249], v51, s[72:75], 0 offen sc1
    s_add_u32 s39, s39, 1
    s_waitcnt vmcnt(0)
    s_cmp_gt_u32 s39, 4096
    s_cbranch_scc1 C2_h6_r
    v_cmp_eq_u32 vcc, v248, v54
    v_cmp_eq_u32 s[54:55], v249, v55
    s_nop 0
    s_and_b64 s[54:55], s[54:55], vcc
    s_or_b32 s54, s54, 15
    s_ff0_i32_b64 s7, s[54:55]
    s_lshr_b32 s7, s7, 2
    s_max_u32 s37, s37, s7
    s_cmp_gt_u32 s37, 6
    s_cbranch_scc0 C2_h6_s
    s_branch C2_h6_r
C2_p5:
    s_mov_b32 s39, 0
C2_p5_s:
    ds_read_b128 v[56:59], v62 offset:96
    s_add_u32 s39, s39, 1
    s_waitcnt lgkmcnt(0)
    v_min3_u32 v56, v56, v57, v58
    v_min_u32 v56, v56, v59
    v_cmp_gt_u32 vcc, 4, v56
    s_cmp_gt_u32 s39, 65536
    s_cbranch_scc1 C2_p5_r
    s_cbranch_vccnz C2_p5_s
    s_branch C2_p5_r
C2_h7:
    s_mov_b32 s39, 0
C2_h7_s:
    buffer_load_dwordx2 v[248:249], v51, s[72:75], 0 offen sc1
    s_add_u32 s39, s39, 1
    s_waitcnt vmcnt(0)
    s_cmp_gt_u32 s39, 4096
    s_cbranch_scc1 C2_h7_r
    v_cmp_eq_u32 vcc, v248, v54
    v_cmp_eq_u32 s[54:55], v249, v55
    s_nop 0
    s_and_b64 s[54:55], s[54:55], vcc
    s_or_b32 s54, s54, 15
    s_ff0_i32_b64 s7, s[54:55]
    s_lshr_b32 s7, s7, 2
    s_max_u32 s37, s37, s7
    s_cmp_gt_u32 s37, 7
    s_cbranch_scc0 C2_h7_s
    s_branch C2_h7_r
C2_p6:
    s_mov_b32 s39, 0
C2_p6_s:
    ds_read_b128 v[56:59], v62 offset:96
    s_add_u32 s39, s39, 1
    s_waitcnt lgkmcnt(0)
    v_min3_u32 v56, v56, v57, v58
    v_min_u32 v56, v56, v59
    v_cmp_gt_u32 vcc, 5, v56
    s_cmp_gt_u32 s39, 65536
    s_cbranch_scc1 C2_p6_r
    s_cbranch_vccnz C2_p6_s
    s_branch C2_p6_r
C2_h8:
    s_mov_b32 s39, 0
C2_h8_s:
    buffer_load_dwordx2 v[248:249], v51, s[72:75], 0 offen sc1
    s_add_u32 s39, s39, 1
    s_waitcnt vmcnt(0)
    s_cmp_gt_u32 s39, 4096
    s_cbranch_scc1 C2_h8_r
    v_cmp_eq_u32 vcc, v248, v54
    v_cmp_eq_u32 s[54:55], v249, v55
    s_nop 0
    s_and_b64 s[54:55], s[54:55], vcc
    s_or_b32 s54, s54, 15
    s_ff0_i32_b64 s7, s[54:55]
    s_lshr_b32 s7, s7, 2
    s_max_u32 s37, s37, s7
    s_cmp_gt_u32 s37, 8
    s_cbranch_scc0 C2_h8_s
    s_branch C2_h8_r
C2_p7:
    s_mov_b32 s39, 0
C2_p7_s:
    ds_read_b128 v[56:59], v62 offset:96
    s_add_u32 s39, s39, 1
    s_waitcnt lgkmcnt(0)
    v_min3_u32 v56, v56, v57, v58
    v_min_u32 v56, v56, v59
    v_cmp_gt_u32 vcc, 6, v56
    s_cmp_gt_u32 s39, 65536
    s_cbranch_scc1 C2_p7_r
    s_cbranch_vccnz C2_p7_s
    s_branch C2_p7_r
C2_h9:
    s_mov_b32 s39, 0
C2_h9_s:
    buffer_load_dwordx2 v[248:249], v51, s[72:75], 0 offen sc1
    s_add_u32 s39, s39, 1
    s_waitcnt vmcnt(0)
    s_cmp_gt_u32 s39, 4096
    s_cbranch_scc1 C2_h9_r
    v_cmp_eq_u32 vcc, v248, v54
    v_cmp_eq_u32 s[54:55], v249, v55
    s_nop 0
    s_and_b64 s[54:55], s[54:55], vcc
    s_or_b32 s54, s54, 15
    s_ff0_i32_b64 s7, s[54:55]
    s_lshr_b32 s7, s7, 2
    s_max_u32 s37, s37, s7
    s_cmp_gt_u32 s37, 9
    s_cbranch_scc0 C2_h9_s
    s_branch C2_h9_r
C2_p8:
    s_mov_b32 s39, 0
C2_p8_s:
    ds_read_b128 v[56:59], v62 offset:96
    s_add_u32 s39, s39, 1
    s_waitcnt lgkmcnt(0)
    v_min3_u32 v56, v56, v57, v58
    v_min_u32 v56, v56, v59
    v_cmp_gt_u32 vcc, 7, v56
    s_cmp_gt_u32 s39, 65536
    s_cbranch_scc1 C2_p8_r
    s_cbranch_vccnz C2_p8_s
    s_branch C2_p8_r
C2_h10:
    s_mov_b32 s39, 0
C2_h10_s:
    buffer_load_dwordx2 v[248:249], v51, s[72:75], 0 offen sc1
    s_add_u32 s39, s39, 1
    s_waitcnt vmcnt(0)
    s_cmp_gt_u32 s39, 4096
    s_cbranch_scc1 C2_h10_r
    v_cmp_eq_u32 vcc, v248, v54
    v_cmp_eq_u32 s[54:55], v249, v55
    s_nop 0
    s_and_b64 s[54:55], s[54:55], vcc
    s_or_b32 s54, s54, 15
    s_ff0_i32_b64 s7, s[54:55]
    s_lshr_b32 s7, s7, 2
    s_max_u32 s37, s37, s7
    s_cmp_gt_u32 s37, 10
    s_cbranch_scc0 C2_h10_s
    s_branch C2_h10_r
C2_h11:
    s_mov_b32 s39, 0
C2_h11_s:
    buffer_load_dwordx2 v[248:249], v51, s[72:75], 0 offen sc1
    s_add_u32 s39, s39, 1
    s_waitcnt vmcnt(0)
    s_cmp_gt_u32 s39, 4096
    s_cbranch_scc1 C2_h11_r
    v_cmp_eq_u32 vcc, v248, v54
    v_cmp_eq_u32 s[54:55], v249, v55
    s_nop 0
    s_and_b64 s[54:55], s[54:55], vcc
    s_or_b32 s54, s54, 15
    s_ff0_i32_b64 s7, s[54:55]
    s_lshr_b32 s7, s7, 2
    s_max_u32 s37, s37, s7
    s_cmp_gt_u32 s37, 11
    s_cbranch_scc0 C2_h11_s
    s_branch C2_h11_r
C2_q10:
    s_mov_b32 s39, 0
C2_q10_s:
    ds_read_b128 v[12:15], v62 offset:48
    s_add_u32 s39, s39, 1
    s_waitcnt lgkmcnt(0)
    v_min3_u32 v12, v12, v13, v14
    v_min_u32 v12, v12, v15
    v_cmp_gt_u32 vcc, 12, v12
    s_cmp_gt_u32 s39, 65536
    s_cbranch_scc1 C2_q10_r
    s_cbranch_vccnz C2_q10_s
    s_branch C2_q10_r
C2_h12:
    s_mov_b32 s39, 0
C2_h12_s:
    buffer_load_dwordx2 v[248:249], v51, s[72:75], 0 offen sc1
    s_add_u32 s39, s39, 1
    s_waitcnt vmcnt(0)
    s_cmp_gt_u32 s39, 4096
    s_cbranch_scc1 C2_h12_r
    v_cmp_eq_u32 vcc, v248, v54
    v_cmp_eq_u32 s[54:55], v249, v55
    s_nop 0
    s_and_b64 s[54:55], s[54:55], vcc
    s_or_b32 s54, s54, 15
    s_ff0_i32_b64 s7, s[54:55]
    s_lshr_b32 s7, s7, 2
    s_max_u32 s37, s37, s7
    s_cmp_gt_u32 s37, 12
    s_cbranch_scc0 C2_h12_s
    s_branch C2_h12_r
C2_q11:
    s_mov_b32 s39, 0
C2_q11_s:
    ds_read_b128 v[12:15], v62 offset:48
    s_add_u32 s39, s39, 1
    s_waitcnt lgkmcnt(0)
    v_min3_u32 v12, v12, v13, v14
    v_min_u32 v12, v12, v15
    v_cmp_gt_u32 vcc, 13, v12
    s_cmp_gt_u32 s39, 65536
    s_cbranch_scc1 C2_q11_r
    s_cbranch_vccnz C2_q11_s
    s_branch C2_q11_r
C2_h13:
    s_mov_b32 s39, 0
C2_h13_s:
    buffer_load_dwordx2 v[248:249], v51, s[72:75], 0 offen sc1
    s_add_u32 s39, s39, 1
    s_waitcnt vmcnt(0)
    s_cmp_gt_u32 s39, 4096
    s_cbranch_scc1 C2_h13_r
    v_cmp_eq_u32 vcc, v248, v54
    v_cmp_eq_u32 s[54:55], v249, v55
    s_nop 0
    s_and_b64 s[54:55], s[54:55], vcc
    s_or_b32 s54, s54, 15
    s_ff0_i32_b64 s7, s[54:55]
    s_lshr_b32 s7, s7, 2
    s_max_u32 s37, s37, s7
    s_cmp_gt_u32 s37, 13
    s_cbranch_scc0 C2_h13_s
    s_branch C2_h13_r
C2_h14:
    s_mov_b32 s39, 0
C2_h14_s:
    buffer_load_dwordx2 v[248:249], v51, s[72:75], 0 offen sc1
    s_add_u32 s39, s39, 1
    s_waitcnt vmcnt(0)
    s_cmp_gt_u32 s39, 4096
    s_cbranch_scc1 C2_h14_r
    v_cmp_eq_u32 vcc, v248, v54
    v_cmp_eq_u32 s[54:55], v249, v55
    s_nop 0
    s_and_b64 s[54:55], s[54:55], vcc
    s_or_b32 s54, s54, 15
    s_ff0_i32_b64 s7, s[54:55]
    s_lshr_b32 s7, s7, 2
    s_max_u32 s37, s37, s7
    s_cmp_gt_u32 s37, 14
    s_cbranch_scc0 C2_h14_s
    s_branch C2_h14_r
C2_q12:
    s_mov_b32 s39, 0
C2_q12_s:
    ds_read_b128 v[12:15], v62 offset:48
    s_add_u32 s39, s39, 1
    s_waitcnt lgkmcnt(0)
    v_min3_u32 v12, v12, v13, v14
    v_min_u32 v12, v12, v15
    v_cmp_gt_u32 vcc, 14, v12
    s_cmp_gt_u32 s39, 65536
    s_cbranch_scc1 C2_q12_r
    s_cbranch_vccnz C2_q12_s
    s_branch C2_q12_r
C2_h15:
    s_mov_b32 s39, 0
C2_h15_s:
    buffer_load_dwordx2 v[248:249], v51, s[72:75], 0 offen sc1
    s_add_u32 s39, s39, 1
    s_waitcnt vmcnt(0)
    s_cmp_gt_u32 s39, 4096
    s_cbranch_scc1 C2_h15_r
    v_cmp_eq_u32 vcc, v248, v54
    v_cmp_eq_u32 s[54:55], v249, v55
    s_nop 0
    s_and_b64 s[54:55], s[54:55], vcc
    s_or_b32 s54, s54, 15
    s_ff0_i32_b64 s7, s[54:55]
    s_lshr_b32 s7, s7, 2
    s_max_u32 s37, s37, s7
    s_cmp_gt_u32 s37, 15
    s_cbranch_scc0 C2_h15_s
    s_branch C2_h15_r
C2_q13:
    s_mov_b32 s39, 0
C2_q13_s:
    ds_read_b128 v[12:15], v62 offset:48
    s_add_u32 s39, s39, 1
    s_waitcnt lgkmcnt(0)
    v_min3_u32 v12, v12, v13, v14
    v_min_u32 v12, v12, v15
    v_cmp_gt_u32 vcc, 16, v12
    s_cmp_gt_u32 s39, 65536
    s_cbranch_scc1 C2_q13_r
    s_cbranch_vccnz C2_q13_s
    s_branch C2_q13_r
K_end:
.section .rodata,"a"
.p2align 6
.amdhsa_kernel concat_heads__ssm_conv_h3__ssm_conv_s5__prompt_kernel
  .amdhsa_next_free_vgpr 252
  .amdhsa_next_free_sgpr 102
  .amdhsa_accum_offset 252
  .amdhsa_group_segment_fixed_size 0
  .amdhsa_kernarg_size 144
  .amdhsa_user_sgpr_count 2
  .amdhsa_user_sgpr_kernarg_segment_ptr 1
  .amdhsa_system_sgpr_workgroup_id_x 1
.end_amdhsa_kernel
```

```asm
; @launch grid=(256,1,1) block=(512,1,1) lds=163840
.amdgcn_target "amdgcn-amd-amdhsa--gfx950"
.text
.p2align 8
.globl concat_heads__ssm_conv_h3__ssm_conv_s5__prompt_kernel
.type concat_heads__ssm_conv_h3__ssm_conv_s5__prompt_kernel,@function
concat_heads__ssm_conv_h3__ssm_conv_s5__prompt_kernel:
    s_cmp_ge_u32 s2, 256
    s_cbranch_scc1 K_done
    s_load_dwordx16 s[32:47], s[0:1], 0
    s_load_dwordx16 s[48:63], s[0:1], 64
    s_load_dwordx4 s[64:67], s[0:1], 128
    s_cmp_ge_u32 s2, 64
    s_cbranch_scc1 K_cw
    s_getpc_b64 s[8:9]
    K_pc:
    v_lshlrev_b32 v4, 7, v0
    v_min_u32 v4, K_end - K_pc - 68, v4
    v_mov_b32 v5, s9
    v_add_co_u32 v4, vcc, s8, v4
    v_addc_co_u32 v5, vcc, 0, v5, vcc
    global_load_dword v251, v[4:5], off
    global_load_dword v251, v[4:5], off offset:64
    K_cw:
    v_lshrrev_b32 v1, 6, v0
    v_and_b32 v2, 63, v0
    s_and_b32 s6, s2, 3
    v_readfirstlane_b32 s5, v1
    s_lshl_b32 s6, s6, 2
    s_lshr_b32 s7, s2, 3
    s_and_b32 s3, s7, 3
    s_add_u32 s3, s3, s6
    s_and_b32 s6, s2, 4
    s_lshl_b32 s6, s6, 1
    s_lshr_b32 s4, s7, 2
    s_add_u32 s4, s4, s6
    s_cmp_ge_u32 s5, 4
    s_cbranch_scc1 K_other
    v_and_b32 v12, 15, v2
    v_lshrrev_b32 v13, 4, v2
    s_lshr_b32 s7, s2, 3
    s_and_b32 s76, s7, 15
    s_lshr_b32 s7, s7, 4
    s_and_b32 s77, s2, 7
    s_lshl_b32 s77, s77, 1
    s_add_u32 s77, s77, s7
    s_lshl_b32 s7, s76, 2
    s_add_u32 s7, s7, s5
    s_lshl_b32 s7, s7, 16
    s_lshl_b32 s6, s77, 7
    s_add_u32 s7, s7, s6
    v_lshlrev_b32 v10, 14, v13
    v_lshl_add_u32 v10, v12, 3, v10
    v_add_u32 v10, s7, v10
    v_subrev_u32 v11, 0x1800, v10
    v_bfrev_b32 v9, 1
    v_cmp_gt_i32 vcc, 0, v11
    s_lshl_b32 s7, s77, 9
    v_lshlrev_b32 v15, 5, v12
    v_cndmask_b32 v11, v11, v9, vcc
    v_add_u32 v9, s7, v15
    s_mov_b32 s72, 4096
    s_mov_b32 s73, 8192
    s_mov_b32 s74, 12288
    s_lshl_b32 s6, s4, 2
    s_add_u32 s6, s6, s5
    s_lshl_b32 s6, s6, 4
    v_and_b32 v14, 3, v12
    v_and_b32 v1, 1, v13
    v_lshl_add_u32 v14, v1, 3, v14
    v_lshrrev_b32 v1, 1, v13
    v_lshl_add_u32 v14, v1, 2, v14
    v_add_u32 v14, s6, v14
    v_lshlrev_b32 v44, 1, v14
    s_lshl_b32 s6, s4, 7
    v_lshlrev_b32 v1, 3, v12
    v_add_u32 v1, s6, v1
    s_movk_i32 s22, 2048
    s_mov_b32 s23, 0x00020000
    s_mov_b64 s[26:27], s[22:23]
    s_mov_b64 s[30:31], s[22:23]
    s_mov_b32 s10, 4194304
    s_mov_b32 s11, s23
    s_mov_b64 s[14:15], s[10:11]
    s_movk_i32 s70, 8192
    s_mov_b32 s71, s23
    s_waitcnt lgkmcnt(0)
    s_mov_b64 s[20:21], s[58:59]
    s_mov_b64 s[24:25], s[46:47]
    s_mov_b64 s[28:29], s[48:49]
    buffer_load_ushort v45, v44, s[20:23], 0 offen
    buffer_load_ushort v46, v44, s[24:27], 0 offen
    buffer_load_ushort v47, v44, s[28:31], 0 offen
    s_mov_b64 s[8:9], s[34:35]
    buffer_load_dwordx2 v[146:147], v10, s[8:11], 0 offen offset:0 nt
    buffer_load_dwordx2 v[148:149], v10, s[8:11], 0 offen offset:2048 nt
    buffer_load_dwordx2 v[150:151], v10, s[8:11], s72 offen offset:0 nt
    buffer_load_dwordx2 v[152:153], v10, s[8:11], s72 offen offset:2048 nt
    buffer_load_dwordx2 v[154:155], v10, s[8:11], s73 offen offset:0 nt
    buffer_load_dwordx2 v[156:157], v10, s[8:11], s73 offen offset:2048 nt
    buffer_load_dwordx2 v[158:159], v10, s[8:11], s74 offen offset:0 nt
    buffer_load_dwordx2 v[160:161], v10, s[8:11], s74 offen offset:2048 nt
    buffer_load_dwordx2 v[140:141], v11, s[8:11], 0 offen offset:0 nt
    buffer_load_dwordx2 v[142:143], v11, s[8:11], 0 offen offset:2048 nt
    buffer_load_dwordx2 v[144:145], v11, s[8:11], s72 offen offset:0 nt
    s_mov_b64 s[68:69], s[38:39]
    buffer_load_dwordx4 v[128:131], v9, s[68:71], 0 offen
    buffer_load_dwordx4 v[132:135], v9, s[68:71], 0 offen offset:16
    s_mov_b64 s[12:13], s[36:37]
    buffer_load_dwordx2 v[162:163], v10, s[12:15], 0 offen offset:0 nt
    buffer_load_dwordx2 v[164:165], v10, s[12:15], 0 offen offset:2048 nt
    buffer_load_dwordx2 v[166:167], v10, s[12:15], s72 offen offset:0 nt
    buffer_load_dwordx2 v[168:169], v10, s[12:15], s72 offen offset:2048 nt
    buffer_load_dwordx2 v[170:171], v10, s[12:15], s73 offen offset:0 nt
    buffer_load_dwordx2 v[172:173], v10, s[12:15], s73 offen offset:2048 nt
    buffer_load_dwordx2 v[174:175], v10, s[12:15], s74 offen offset:0 nt
    buffer_load_dwordx2 v[176:177], v10, s[12:15], s74 offen offset:2048 nt
    s_barrier
    s_mov_b32 s80, s60
    s_mov_b32 s81, s61
    s_mov_b32 s82, 2048
    s_mov_b32 s83, 0x00020000
    buffer_load_dwordx2 v[242:243], v1, s[80:83], 0 offen
    s_lshl_b32 s7, s5, 2
    v_add_u32 v15, s7, v13
    v_sub_u32 v15, 15, v15
    v_xor_b32 v15, v15, v12
    v_lshlrev_b32 v15, 4, v15
    v_lshl_add_u32 v15, v12, 10, v15
    v_add_u32 v15, 147456, v15
    v_lshrrev_b32 v3, 1, v12
    v_xor_b32 v3, v3, v13
    v_lshlrev_b32 v3, 4, v3
    v_lshl_add_u32 v4, v12, 7, v3
    v_xor_b32 v6, 64, v4
    v_add_u32 v5, 0x10000, v4
    v_add_u32 v7, 0x10000, v6
    s_lshl_b32 s6, s5, 12
    s_add_u32 s6, s6, 16384
    v_add_u32 v8, s6, v4
    v_add_u32 v9, s6, v5
    v_add_u32 v10, s6, v6
    v_add_u32 v11, s6, v7
    s_mov_b32 s16, s64
    s_mov_b32 s17, s65
    s_mov_b32 s18, 256
    s_mov_b32 s19, 0x00020000
    s_or_b32 s6, s2, s5
    s_cmp_eq_u32 s6, 0
    s_cbranch_scc0 C_nonce_w
    s_memrealtime s[6:7]
    v_mov_b32 v1, 0
    s_waitcnt lgkmcnt(0)
    s_or_b32 s6, s6, 1
    v_mov_b32 v48, s6
    v_mov_b32 v49, s7
    s_mov_b64 exec, 1
    buffer_store_dwordx2 v[48:49], v1, s[16:19], 0 offen sc1
    s_mov_b64 exec, -1
C_nonce_w:
    s_add_u32 s8, s66, 8388608
    s_addc_u32 s9, s67, 0
    s_mov_b32 s10, 8388608
    s_mov_b32 s11, 0x00020000
    s_add_u32 s12, s66, 16777216
    s_addc_u32 s13, s67, 0
    s_mov_b32 s14, 262144
    s_mov_b32 s15, 0x00020000
    s_mov_b32 s68, s66
    s_mov_b32 s69, s67
    s_mov_b32 s70, 4194304
    s_mov_b32 s71, 0x00020000
    s_add_u32 s72, s66, 17825792
    s_addc_u32 s73, s67, 0
    s_mov_b32 s74, 393216
    s_mov_b32 s75, 0x00020000
    s_mov_b32 s76, s62
    s_mov_b32 s77, s63
    s_mov_b32 s78, 16777216
    s_mov_b32 s79, 0x00020000
    s_mov_b32 s24, s54
    s_mov_b32 s25, s55
    s_mov_b32 s26, 2097152
    s_mov_b32 s27, 0x00020000
    s_mov_b32 s80, s56
    s_mov_b32 s81, s57
    s_mov_b32 s82, 2097152
    s_mov_b32 s83, 0x00020000
    s_and_b32 s34, s2, 3
    s_lshl_b32 s34, s34, 2
    s_and_b32 s35, s2, 4
    s_lshl_b32 s35, s35, 1
    s_add_u32 s34, s34, s35
    s_add_u32 s35, s3, s4
    s_and_b32 s35, s35, 1
    s_lshl_b32 s35, s35, 1
    s_add_u32 s34, s34, s35
    s_and_b32 s34, s34, 15
    s_sub_u32 s34, s4, s34
    s_and_b32 s34, s34, 15
    s_lshl_b32 s6, s5, 12
    v_add_u32 v240, s6, v4
    v_xor_b32 v241, 64, v240
    v_mov_b32 v62, 147328
    s_lshr_b32 s7, s2, 3
    s_and_b32 s32, s7, 15
    s_lshr_b32 s7, s7, 4
    s_and_b32 s33, s2, 7
    s_lshl_b32 s33, s33, 1
    s_add_u32 s33, s33, s7
    s_mov_b32 s36, 16384
    s_mov_b32 s37, 32768
    s_mov_b32 s38, 49152
    s_lshl_b32 s6, s5, 2
    v_xor_b32 v1, s6, v12
    v_lshlrev_b32 v1, 4, v1
    v_lshl_add_u32 v1, v13, 8, v1
    s_lshl_b32 s6, s5, 12
    s_add_u32 s6, s6, 147456
    v_add_u32 v244, s6, v1
    v_xor_b32 v245, 16, v244
    v_xor_b32 v246, 32, v244
    v_xor_b32 v247, 48, v244
    s_lshl_b32 s6, s33, 2
    s_add_u32 s6, s6, s5
    s_lshl_b32 s6, s6, 16
    s_lshl_b32 s7, s32, 8
    s_sub_u32 s7, 3840, s7
    s_add_u32 s6, s6, s7
    v_lshlrev_b32 v1, 12, v13
    v_lshl_add_u32 v1, v12, 4, v1
    v_add_u32 v248, s6, v1
    s_lshl_b32 s6, s33, 2
    s_add_u32 s7, s6, s5
    s_lshl_b32 s7, s7, 4
    s_add_u32 s7, s7, s32
    s_lshl_b32 s20, s7, 3
    s_lshr_b32 s7, s32, 2
    s_add_u32 s7, s7, s6
    s_lshl_b32 s21, s7, 7
    s_lshl_b32 s7, s33, 4
    s_add_u32 s7, s7, s32
    s_lshl_b32 s7, s7, 2
    s_add_u32 s7, s7, s5
    s_lshl_b32 s22, s7, 12
    s_lshl_b32 s23, s5, 14
    s_add_u32 s23, s23, 106624
    s_lshl_b32 s6, s3, 14
    v_lshlrev_b32 v1, 4, v14
    v_add_u32 v60, s6, v1
    v_lshrrev_b32 v1, 2, v12
    v_lshlrev_b32 v1, 14, v1
    v_sub_u32 v1, v60, v1
    v_subrev_u32 v56, 0x4000, v1
    v_subrev_u32 v57, 0x14000, v1
    v_subrev_u32 v58, 0x24000, v1
    v_subrev_u32 v59, 0x34000, v1
    v_cmp_gt_i32 s[40:41], 0, v56
    v_cmp_gt_i32 s[42:43], 0, v57
    v_cmp_gt_i32 s[44:45], 0, v58
    v_cmp_gt_i32 s[46:47], 0, v59
    s_lshl_b32 s6, s3, 4
    s_add_u32 s6, s6, s4
    s_lshl_b32 s6, s6, 15
    s_lshl_b32 s7, s5, 10
    s_add_u32 s6, s6, s7
    v_lshlrev_b32 v1, 4, v2
    v_add_u32 v61, s6, v1
    s_lshl_b32 s7, s5, 2
    v_add_u32 v63, s7, v62
    s_mov_b32 s48, 0xaaaaaaaa
    s_mov_b32 s49, 0xaaaaaaaa
    s_mov_b32 s50, 0xcccccccc
    s_mov_b32 s51, 0xcccccccc
    s_mov_b32 s52, 0x000f000f
    s_mov_b32 s53, 0x000f000f
    v_mov_b32 v64, 0
    v_mov_b32 v65, 0
    v_mov_b32 v66, 0
    v_mov_b32 v67, 0
    v_mov_b32 v68, 0
    v_mov_b32 v69, 0
    v_mov_b32 v70, 0
    v_mov_b32 v71, 0
    v_mov_b32 v72, 0
    v_mov_b32 v73, 0
    v_mov_b32 v74, 0
    v_mov_b32 v75, 0
    v_mov_b32 v76, 0
    v_mov_b32 v77, 0
    v_mov_b32 v78, 0
    v_mov_b32 v79, 0
    v_mov_b32 v80, 0
    v_mov_b32 v81, 0
    v_mov_b32 v82, 0
    v_mov_b32 v83, 0
    v_mov_b32 v84, 0
    v_mov_b32 v85, 0
    v_mov_b32 v86, 0
    v_mov_b32 v87, 0
    v_mov_b32 v88, 0
    v_mov_b32 v89, 0
    v_mov_b32 v90, 0
    v_mov_b32 v91, 0
    v_mov_b32 v92, 0
    v_mov_b32 v93, 0
    v_mov_b32 v94, 0
    v_mov_b32 v95, 0
    v_mov_b32 v96, 0
    v_mov_b32 v97, 0
    v_mov_b32 v98, 0
    v_mov_b32 v99, 0
    v_mov_b32 v100, 0
    v_mov_b32 v101, 0
    v_mov_b32 v102, 0
    v_mov_b32 v103, 0
    v_mov_b32 v104, 0
    v_mov_b32 v105, 0
    v_mov_b32 v106, 0
    v_mov_b32 v107, 0
    v_mov_b32 v108, 0
    v_mov_b32 v109, 0
    v_mov_b32 v110, 0
    v_mov_b32 v111, 0
    v_mov_b32 v112, 0
    v_mov_b32 v113, 0
    v_mov_b32 v114, 0
    v_mov_b32 v115, 0
    v_mov_b32 v116, 0
    v_mov_b32 v117, 0
    v_mov_b32 v118, 0
    v_mov_b32 v119, 0
    v_mov_b32 v120, 0
    v_mov_b32 v121, 0
    v_mov_b32 v122, 0
    v_mov_b32 v123, 0
    v_mov_b32 v124, 0
    v_mov_b32 v125, 0
    v_mov_b32 v126, 0
    v_mov_b32 v127, 0
    s_waitcnt vmcnt(22)
    v_lshlrev_b32 v45, 16, v45
    v_lshlrev_b32 v46, 16, v46
    v_lshlrev_b32 v47, 16, v47
    v_mul_f32 v45, 0x3fb8aa3b, v45
    v_exp_f32 v45, v45
    s_nop 0
    v_cvt_pk_bf16_f32 v45, v45, v45
    v_lshlrev_b32 v45, 16, v45
    v_mul_f32 v52, v45, v46
    v_mul_f32 v53, v45, v47
    v_mul_f32 v52, 0x3fb8aa3b, v52
    v_exp_f32 v48, v52
    v_mul_f32 v53, 0.15915494, v53
    v_fract_f32 v53, v53
    v_cos_f32 v50, v53
    v_sin_f32 v51, v53
    s_nop 0
    v_mul_f32 v44, v48, v50
    v_mul_f32 v45, v48, v51
    v_add_f32 v48, -1.0, v44
    v_mul_f32 v49, v46, v46
    v_fmac_f32 v49, v47, v47
    v_rcp_f32 v49, v49
    v_mul_f32 v50, v48, v46
    v_fmac_f32 v50, v45, v47
    v_mul_f32 v51, v45, v46
    v_fma_f32 v51, -v48, v47, v51
    v_add_f32 v49, v49, v49
    v_mul_f32 v46, v50, v49
    v_mul_f32 v47, v51, v49
    v_lshlrev_b32 v54, 3, v12
    v_cvt_f32_u32 v54, v54
    v_lshrrev_b32 v55, 2, v12
    v_lshlrev_b32 v55, 7, v55
    v_cvt_f32_u32 v55, v55
    v_mov_b32_dpp v16, v44 quad_perm:[0,0,0,0] row_mask:0xf bank_mask:0xf
    v_mov_b32_dpp v20, v45 quad_perm:[0,0,0,0] row_mask:0xf bank_mask:0xf
    v_mov_b32_dpp v24, v46 quad_perm:[0,0,0,0] row_mask:0xf bank_mask:0xf
    v_mov_b32_dpp v28, v47 quad_perm:[0,0,0,0] row_mask:0xf bank_mask:0xf
    v_mov_b32_dpp v17, v44 quad_perm:[1,1,1,1] row_mask:0xf bank_mask:0xf
    v_mov_b32_dpp v21, v45 quad_perm:[1,1,1,1] row_mask:0xf bank_mask:0xf
    v_mov_b32_dpp v25, v46 quad_perm:[1,1,1,1] row_mask:0xf bank_mask:0xf
    v_mov_b32_dpp v29, v47 quad_perm:[1,1,1,1] row_mask:0xf bank_mask:0xf
    v_mov_b32_dpp v18, v44 quad_perm:[2,2,2,2] row_mask:0xf bank_mask:0xf
    v_mov_b32_dpp v22, v45 quad_perm:[2,2,2,2] row_mask:0xf bank_mask:0xf
    v_mov_b32_dpp v26, v46 quad_perm:[2,2,2,2] row_mask:0xf bank_mask:0xf
    v_mov_b32_dpp v30, v47 quad_perm:[2,2,2,2] row_mask:0xf bank_mask:0xf
    v_mov_b32_dpp v19, v44 quad_perm:[3,3,3,3] row_mask:0xf bank_mask:0xf
    v_mov_b32_dpp v23, v45 quad_perm:[3,3,3,3] row_mask:0xf bank_mask:0xf
    v_mov_b32_dpp v27, v46 quad_perm:[3,3,3,3] row_mask:0xf bank_mask:0xf
    v_mov_b32_dpp v31, v47 quad_perm:[3,3,3,3] row_mask:0xf bank_mask:0xf
    v_mul_f32_dpp v48, v52, v54 quad_perm:[0,0,0,0] row_mask:0xf bank_mask:0xf
    v_mul_f32_dpp v49, v53, v54 quad_perm:[0,0,0,0] row_mask:0xf bank_mask:0xf
    v_exp_f32 v48, v48
    v_fract_f32 v49, v49
    v_cos_f32 v50, v49
    v_sin_f32 v51, v49
    s_nop 0
    v_mul_f32 v32, v48, v50
    v_mul_f32 v36, v48, v51
    v_mul_f32_dpp v48, v52, v54 quad_perm:[1,1,1,1] row_mask:0xf bank_mask:0xf
    v_mul_f32_dpp v49, v53, v54 quad_perm:[1,1,1,1] row_mask:0xf bank_mask:0xf
    v_exp_f32 v48, v48
    v_fract_f32 v49, v49
    v_cos_f32 v50, v49
    v_sin_f32 v51, v49
    s_nop 0
    v_mul_f32 v33, v48, v50
    v_mul_f32 v37, v48, v51
    v_mul_f32_dpp v48, v52, v54 quad_perm:[2,2,2,2] row_mask:0xf bank_mask:0xf
    v_mul_f32_dpp v49, v53, v54 quad_perm:[2,2,2,2] row_mask:0xf bank_mask:0xf
    v_exp_f32 v48, v48
    v_fract_f32 v49, v49
    v_cos_f32 v50, v49
    v_sin_f32 v51, v49
    s_nop 0
    v_mul_f32 v34, v48, v50
    v_mul_f32 v38, v48, v51
    v_mul_f32_dpp v48, v52, v54 quad_perm:[3,3,3,3] row_mask:0xf bank_mask:0xf
    v_mul_f32_dpp v49, v53, v54 quad_perm:[3,3,3,3] row_mask:0xf bank_mask:0xf
    v_exp_f32 v48, v48
    v_fract_f32 v49, v49
    v_cos_f32 v50, v49
    v_sin_f32 v51, v49
    s_nop 0
    v_mul_f32 v35, v48, v50
    v_mul_f32 v39, v48, v51
    v_mul_f32 v48, v52, v55
    v_mul_f32 v49, v53, v55
    v_exp_f32 v48, v48
    v_fract_f32 v49, v49
    v_cos_f32 v50, v49
    v_sin_f32 v51, v49
    s_nop 0
    v_mul_f32 v40, v48, v50
    v_mul_f32 v41, v48, v51
    v_mul_f32 v48, 0x44000000, v52
    v_mul_f32 v49, 0x44000000, v53
    v_exp_f32 v48, v48
    v_fract_f32 v49, v49
    v_cos_f32 v50, v49
    v_sin_f32 v51, v49
    s_nop 0
    v_mul_f32 v42, v48, v50
    v_mul_f32 v43, v48, v51
    s_waitcnt vmcnt(9)
    v_lshlrev_b32 v136, 16, v128
    v_and_b32 v137, 0xffff0000, v128
    v_lshlrev_b32 v138, 16, v129
    v_and_b32 v139, 0xffff0000, v129
    v_lshlrev_b32 v178, 16, v140
    v_lshlrev_b32 v179, 16, v142
    v_lshlrev_b32 v180, 16, v144
    v_lshlrev_b32 v181, 16, v146
    v_lshlrev_b32 v182, 16, v148
    v_lshlrev_b32 v183, 16, v150
    v_lshlrev_b32 v184, 16, v152
    v_lshlrev_b32 v185, 16, v154
    v_lshlrev_b32 v186, 16, v156
    v_lshlrev_b32 v187, 16, v158
    v_lshlrev_b32 v188, 16, v160
    v_mul_f32 v190, v136, v181
    v_mul_f32 v191, v136, v182
    v_mul_f32 v192, v136, v183
    v_mul_f32 v193, v136, v184
    v_mul_f32 v194, v136, v185
    v_mul_f32 v195, v136, v186
    v_mul_f32 v196, v136, v187
    v_mul_f32 v197, v136, v188
    v_fmac_f32 v190, v137, v180
    v_fmac_f32 v191, v137, v181
    v_fmac_f32 v192, v137, v182
    v_fmac_f32 v193, v137, v183
    v_fmac_f32 v194, v137, v184
    v_fmac_f32 v195, v137, v185
    v_fmac_f32 v196, v137, v186
    v_fmac_f32 v197, v137, v187
    v_fmac_f32 v190, v138, v179
    v_fmac_f32 v191, v138, v180
    v_fmac_f32 v192, v138, v181
    v_fmac_f32 v193, v138, v182
    v_fmac_f32 v194, v138, v183
    v_fmac_f32 v195, v138, v184
    v_fmac_f32 v196, v138, v185
    v_fmac_f32 v197, v138, v186
    v_fmac_f32 v190, v139, v178
    v_fmac_f32 v191, v139, v179
    v_fmac_f32 v192, v139, v180
    v_fmac_f32 v193, v139, v181
    v_fmac_f32 v194, v139, v182
    v_fmac_f32 v195, v139, v183
    v_fmac_f32 v196, v139, v184
    v_fmac_f32 v197, v139, v185
    v_lshlrev_b32 v136, 16, v130
    v_and_b32 v137, 0xffff0000, v130
    v_lshlrev_b32 v138, 16, v131
    v_and_b32 v139, 0xffff0000, v131
    v_and_b32 v178, 0xffff0000, v140
    v_and_b32 v179, 0xffff0000, v142
    v_and_b32 v180, 0xffff0000, v144
    v_and_b32 v181, 0xffff0000, v146
    v_and_b32 v182, 0xffff0000, v148
    v_and_b32 v183, 0xffff0000, v150
    v_and_b32 v184, 0xffff0000, v152
    v_and_b32 v185, 0xffff0000, v154
    v_and_b32 v186, 0xffff0000, v156
    v_and_b32 v187, 0xffff0000, v158
    v_and_b32 v188, 0xffff0000, v160
    v_mul_f32 v198, v136, v181
    v_mul_f32 v199, v136, v182
    v_mul_f32 v200, v136, v183
    v_mul_f32 v201, v136, v184
    v_mul_f32 v202, v136, v185
    v_mul_f32 v203, v136, v186
    v_mul_f32 v204, v136, v187
    v_mul_f32 v205, v136, v188
    v_fmac_f32 v198, v137, v180
    v_fmac_f32 v199, v137, v181
    v_fmac_f32 v200, v137, v182
    v_fmac_f32 v201, v137, v183
    v_fmac_f32 v202, v137, v184
    v_fmac_f32 v203, v137, v185
    v_fmac_f32 v204, v137, v186
    v_fmac_f32 v205, v137, v187
    v_fmac_f32 v198, v138, v179
    v_fmac_f32 v199, v138, v180
    v_fmac_f32 v200, v138, v181
    v_fmac_f32 v201, v138, v182
    v_fmac_f32 v202, v138, v183
    v_fmac_f32 v203, v138, v184
    v_fmac_f32 v204, v138, v185
    v_fmac_f32 v205, v138, v186
    v_fmac_f32 v198, v139, v178
    v_fmac_f32 v199, v139, v179
    v_fmac_f32 v200, v139, v180
    v_fmac_f32 v201, v139, v181
    v_fmac_f32 v202, v139, v182
    v_fmac_f32 v203, v139, v183
    v_fmac_f32 v204, v139, v184
    v_fmac_f32 v205, v139, v185
    v_lshlrev_b32 v136, 16, v132
    v_and_b32 v137, 0xffff0000, v132
    v_lshlrev_b32 v138, 16, v133
    v_and_b32 v139, 0xffff0000, v133
    v_lshlrev_b32 v178, 16, v141
    v_lshlrev_b32 v179, 16, v143
    v_lshlrev_b32 v180, 16, v145
    v_lshlrev_b32 v181, 16, v147
    v_lshlrev_b32 v182, 16, v149
    v_lshlrev_b32 v183, 16, v151
    v_lshlrev_b32 v184, 16, v153
    v_lshlrev_b32 v185, 16, v155
    v_lshlrev_b32 v186, 16, v157
    v_lshlrev_b32 v187, 16, v159
    v_lshlrev_b32 v188, 16, v161
    v_mul_f32 v206, v136, v181
    v_mul_f32 v207, v136, v182
    v_mul_f32 v208, v136, v183
    v_mul_f32 v209, v136, v184
    v_mul_f32 v210, v136, v185
    v_mul_f32 v211, v136, v186
    v_mul_f32 v212, v136, v187
    v_mul_f32 v213, v136, v188
    v_fmac_f32 v206, v137, v180
    v_fmac_f32 v207, v137, v181
    v_fmac_f32 v208, v137, v182
    v_fmac_f32 v209, v137, v183
    v_fmac_f32 v210, v137, v184
    v_fmac_f32 v211, v137, v185
    v_fmac_f32 v212, v137, v186
    v_fmac_f32 v213, v137, v187
    v_fmac_f32 v206, v138, v179
    v_fmac_f32 v207, v138, v180
    v_fmac_f32 v208, v138, v181
    v_fmac_f32 v209, v138, v182
    v_fmac_f32 v210, v138, v183
    v_fmac_f32 v211, v138, v184
    v_fmac_f32 v212, v138, v185
    v_fmac_f32 v213, v138, v186
    v_fmac_f32 v206, v139, v178
    v_fmac_f32 v207, v139, v179
    v_fmac_f32 v208, v139, v180
    v_fmac_f32 v209, v139, v181
    v_fmac_f32 v210, v139, v182
    v_fmac_f32 v211, v139, v183
    v_fmac_f32 v212, v139, v184
    v_fmac_f32 v213, v139, v185
    v_lshlrev_b32 v136, 16, v134
    v_and_b32 v137, 0xffff0000, v134
    v_lshlrev_b32 v138, 16, v135
    v_and_b32 v139, 0xffff0000, v135
    v_and_b32 v178, 0xffff0000, v141
    v_and_b32 v179, 0xffff0000, v143
    v_and_b32 v180, 0xffff0000, v145
    v_and_b32 v181, 0xffff0000, v147
    v_and_b32 v182, 0xffff0000, v149
    v_and_b32 v183, 0xffff0000, v151
    v_and_b32 v184, 0xffff0000, v153
    v_and_b32 v185, 0xffff0000, v155
    v_and_b32 v186, 0xffff0000, v157
    v_and_b32 v187, 0xffff0000, v159
    v_and_b32 v188, 0xffff0000, v161
    v_mul_f32 v214, v136, v181
    v_mul_f32 v215, v136, v182
    v_mul_f32 v216, v136, v183
    v_mul_f32 v217, v136, v184
    v_mul_f32 v218, v136, v185
    v_mul_f32 v219, v136, v186
    v_mul_f32 v220, v136, v187
    v_mul_f32 v221, v136, v188
    v_fmac_f32 v214, v137, v180
    v_fmac_f32 v215, v137, v181
    v_fmac_f32 v216, v137, v182
    v_fmac_f32 v217, v137, v183
    v_fmac_f32 v218, v137, v184
    v_fmac_f32 v219, v137, v185
    v_fmac_f32 v220, v137, v186
    v_fmac_f32 v221, v137, v187
    v_fmac_f32 v214, v138, v179
    v_fmac_f32 v215, v138, v180
    v_fmac_f32 v216, v138, v181
    v_fmac_f32 v217, v138, v182
    v_fmac_f32 v218, v138, v183
    v_fmac_f32 v219, v138, v184
    v_fmac_f32 v220, v138, v185
    v_fmac_f32 v221, v138, v186
    v_fmac_f32 v214, v139, v178
    v_fmac_f32 v215, v139, v179
    v_fmac_f32 v216, v139, v180
    v_fmac_f32 v217, v139, v181
    v_fmac_f32 v218, v139, v182
    v_fmac_f32 v219, v139, v183
    v_fmac_f32 v220, v139, v184
    v_fmac_f32 v221, v139, v185
    s_waitcnt vmcnt(1)
    v_lshlrev_b32 v178, 16, v162
    v_lshlrev_b32 v179, 16, v164
    v_lshlrev_b32 v180, 16, v166
    v_lshlrev_b32 v181, 16, v168
    v_lshlrev_b32 v182, 16, v170
    v_lshlrev_b32 v183, 16, v172
    v_lshlrev_b32 v184, 16, v174
    v_lshlrev_b32 v185, 16, v176
    v_mul_f32 v190, v190, v178
    v_mul_f32 v191, v191, v179
    v_mul_f32 v192, v192, v180
    v_mul_f32 v193, v193, v181
    v_mul_f32 v194, v194, v182
    v_mul_f32 v195, v195, v183
    v_mul_f32 v196, v196, v184
    v_mul_f32 v197, v197, v185
    v_cvt_pk_bf16_f32 v224, v197, v196
    v_cvt_pk_bf16_f32 v225, v195, v194
    v_cvt_pk_bf16_f32 v226, v193, v192
    v_cvt_pk_bf16_f32 v227, v191, v190
    ds_write_b128 v15, v[224:227] offset:0
    v_and_b32 v178, 0xffff0000, v162
    v_and_b32 v179, 0xffff0000, v164
    v_and_b32 v180, 0xffff0000, v166
    v_and_b32 v181, 0xffff0000, v168
    v_and_b32 v182, 0xffff0000, v170
    v_and_b32 v183, 0xffff0000, v172
    v_and_b32 v184, 0xffff0000, v174
    v_and_b32 v185, 0xffff0000, v176
    v_mul_f32 v198, v198, v178
    v_mul_f32 v199, v199, v179
    v_mul_f32 v200, v200, v180
    v_mul_f32 v201, v201, v181
    v_mul_f32 v202, v202, v182
    v_mul_f32 v203, v203, v183
    v_mul_f32 v204, v204, v184
    v_mul_f32 v205, v205, v185
    v_cvt_pk_bf16_f32 v228, v205, v204
    v_cvt_pk_bf16_f32 v229, v203, v202
    v_cvt_pk_bf16_f32 v230, v201, v200
    v_cvt_pk_bf16_f32 v231, v199, v198
    ds_write_b128 v15, v[228:231] offset:256
    v_lshlrev_b32 v178, 16, v163
    v_lshlrev_b32 v179, 16, v165
    v_lshlrev_b32 v180, 16, v167
    v_lshlrev_b32 v181, 16, v169
    v_lshlrev_b32 v182, 16, v171
    v_lshlrev_b32 v183, 16, v173
    v_lshlrev_b32 v184, 16, v175
    v_lshlrev_b32 v185, 16, v177
    v_mul_f32 v206, v206, v178
    v_mul_f32 v207, v207, v179
    v_mul_f32 v208, v208, v180
    v_mul_f32 v209, v209, v181
    v_mul_f32 v210, v210, v182
    v_mul_f32 v211, v211, v183
    v_mul_f32 v212, v212, v184
    v_mul_f32 v213, v213, v185
    v_cvt_pk_bf16_f32 v232, v213, v212
    v_cvt_pk_bf16_f32 v233, v211, v210
    v_cvt_pk_bf16_f32 v234, v209, v208
    v_cvt_pk_bf16_f32 v235, v207, v206
    ds_write_b128 v15, v[232:235] offset:512
    v_and_b32 v178, 0xffff0000, v163
    v_and_b32 v179, 0xffff0000, v165
    v_and_b32 v180, 0xffff0000, v167
    v_and_b32 v181, 0xffff0000, v169
    v_and_b32 v182, 0xffff0000, v171
    v_and_b32 v183, 0xffff0000, v173
    v_and_b32 v184, 0xffff0000, v175
    v_and_b32 v185, 0xffff0000, v177
    v_mul_f32 v214, v214, v178
    v_mul_f32 v215, v215, v179
    v_mul_f32 v216, v216, v180
    v_mul_f32 v217, v217, v181
    v_mul_f32 v218, v218, v182
    v_mul_f32 v219, v219, v183
    v_mul_f32 v220, v220, v184
    v_mul_f32 v221, v221, v185
    v_cvt_pk_bf16_f32 v236, v221, v220
    v_cvt_pk_bf16_f32 v237, v219, v218
    v_cvt_pk_bf16_f32 v238, v217, v216
    v_cvt_pk_bf16_f32 v239, v215, v214
    ds_write_b128 v15, v[236:239] offset:768
    s_waitcnt lgkmcnt(0)
    s_barrier
    ds_read_b128 v[160:163], v9 offset:32768
    ds_read_b128 v[164:167], v9 offset:34816
    ds_read_b128 v[128:131], v5 offset:32768
    ds_read_b128 v[132:135], v5 offset:34816
    ds_read_b128 v[136:139], v5 offset:36864
    ds_read_b128 v[140:143], v5 offset:38912
    ds_read_b128 v[144:147], v5 offset:40960
    ds_read_b128 v[148:151], v5 offset:43008
    ds_read_b128 v[152:155], v5 offset:45056
    ds_read_b128 v[156:159], v5 offset:47104
    s_setprio 3
    ds_read_b128 v[224:227], v244 offset:0
    ds_read_b128 v[228:231], v245 offset:1024
    ds_read_b128 v[232:235], v246 offset:2048
    ds_read_b128 v[236:239], v247 offset:3072
    s_cmp_eq_u32 s34, 0
    s_waitcnt lgkmcnt(0)
    s_cbranch_scc1 C_x0
C_x0_r:
    buffer_store_dwordx4 v[224:227], v248, s[68:71], 0 offen sc1
    buffer_store_dwordx4 v[228:231], v248, s[68:71], s36 offen sc1
    buffer_store_dwordx4 v[232:235], v248, s[68:71], s37 offen sc1
    buffer_store_dwordx4 v[236:239], v248, s[68:71], s38 offen sc1
    buffer_load_dwordx2 v[54:55], off, s[16:19], 0 sc1
    v_lshlrev_b32 v246, 3, v12
    v_lshlrev_b32 v247, 4, v2
    v_mfma_f32_16x16x32_bf16 v[64:67], v[160:163], v[128:131], v[64:67]
    ds_read_b128 v[200:203], v11 offset:32768
    v_mfma_f32_16x16x32_bf16 v[68:71], v[164:167], v[128:131], v[68:71]
    ds_read_b128 v[204:207], v11 offset:34816
    v_mfma_f32_16x16x32_bf16 v[76:79], v[164:167], v[132:135], v[76:79]
    ds_read_b128 v[168:171], v7 offset:32768
    v_mfma_f32_16x16x32_bf16 v[72:75], v[160:163], v[132:135], v[72:75]
    ds_read_b128 v[172:175], v7 offset:34816
    v_mfma_f32_16x16x32_bf16 v[80:83], v[160:163], v[136:139], v[80:83]
    ds_read_b128 v[176:179], v7 offset:36864
    v_mfma_f32_16x16x32_bf16 v[84:87], v[164:167], v[136:139], v[84:87]
    ds_read_b128 v[180:183], v7 offset:38912
    v_mfma_f32_16x16x32_bf16 v[92:95], v[164:167], v[140:143], v[92:95]
    ds_read_b128 v[184:187], v7 offset:40960
    v_mfma_f32_16x16x32_bf16 v[88:91], v[160:163], v[140:143], v[88:91]
    ds_read_b128 v[188:191], v7 offset:43008
    v_mfma_f32_16x16x32_bf16 v[96:99], v[160:163], v[144:147], v[96:99]
    ds_read_b128 v[192:195], v7 offset:45056
    v_mfma_f32_16x16x32_bf16 v[100:103], v[164:167], v[144:147], v[100:103]
    ds_read_b128 v[196:199], v7 offset:47104
    v_mfma_f32_16x16x32_bf16 v[108:111], v[164:167], v[148:151], v[108:111]
    v_mfma_f32_16x16x32_bf16 v[104:107], v[160:163], v[148:151], v[104:107]
    v_mfma_f32_16x16x32_bf16 v[112:115], v[160:163], v[152:155], v[112:115]
    v_mfma_f32_16x16x32_bf16 v[116:119], v[164:167], v[152:155], v[116:119]
    v_mfma_f32_16x16x32_bf16 v[124:127], v[164:167], v[156:159], v[124:127]
    v_mfma_f32_16x16x32_bf16 v[120:123], v[160:163], v[156:159], v[120:123]
    s_waitcnt lgkmcnt(0)
    s_barrier
    v_mfma_f32_16x16x32_bf16 v[64:67], v[200:203], v[168:171], v[64:67]
    ds_read_b128 v[160:163], v8 offset:0
    v_mfma_f32_16x16x32_bf16 v[68:71], v[204:207], v[168:171], v[68:71]
    ds_read_b128 v[164:167], v8 offset:2048
    v_mfma_f32_16x16x32_bf16 v[76:79], v[204:207], v[172:175], v[76:79]
    ds_read_b128 v[128:131], v4 offset:0
    v_mfma_f32_16x16x32_bf16 v[72:75], v[200:203], v[172:175], v[72:75]
    ds_read_b128 v[132:135], v4 offset:2048
    v_mfma_f32_16x16x32_bf16 v[80:83], v[200:203], v[176:179], v[80:83]
    ds_read_b128 v[136:139], v4 offset:4096
    v_mfma_f32_16x16x32_bf16 v[84:87], v[204:207], v[176:179], v[84:87]
    ds_read_b128 v[140:143], v4 offset:6144
    v_mfma_f32_16x16x32_bf16 v[92:95], v[204:207], v[180:183], v[92:95]
    ds_read_b128 v[144:147], v4 offset:8192
    v_mfma_f32_16x16x32_bf16 v[88:91], v[200:203], v[180:183], v[88:91]
    ds_read_b128 v[148:151], v4 offset:10240
    v_mfma_f32_16x16x32_bf16 v[96:99], v[200:203], v[184:187], v[96:99]
    ds_read_b128 v[152:155], v4 offset:12288
    v_mfma_f32_16x16x32_bf16 v[100:103], v[204:207], v[184:187], v[100:103]
    ds_read_b128 v[156:159], v4 offset:14336
    v_mfma_f32_16x16x32_bf16 v[108:111], v[204:207], v[188:191], v[108:111]
    v_mfma_f32_16x16x32_bf16 v[104:107], v[200:203], v[188:191], v[104:107]
    v_mfma_f32_16x16x32_bf16 v[112:115], v[200:203], v[192:195], v[112:115]
    v_mfma_f32_16x16x32_bf16 v[116:119], v[204:207], v[192:195], v[116:119]
    v_mfma_f32_16x16x32_bf16 v[124:127], v[204:207], v[196:199], v[124:127]
    v_mfma_f32_16x16x32_bf16 v[120:123], v[200:203], v[196:199], v[120:123]
    s_cmp_eq_u32 s34, 1
    s_waitcnt lgkmcnt(0)
    s_cbranch_scc1 C_x1
C_x1_r:
    v_mfma_f32_16x16x32_bf16 v[64:67], v[160:163], v[128:131], v[64:67]
    ds_read_b128 v[200:203], v10 offset:0
    v_mfma_f32_16x16x32_bf16 v[68:71], v[164:167], v[128:131], v[68:71]
    ds_read_b128 v[204:207], v10 offset:2048
    v_mfma_f32_16x16x32_bf16 v[76:79], v[164:167], v[132:135], v[76:79]
    ds_read_b128 v[168:171], v6 offset:0
    v_mfma_f32_16x16x32_bf16 v[72:75], v[160:163], v[132:135], v[72:75]
    ds_read_b128 v[172:175], v6 offset:2048
    v_mfma_f32_16x16x32_bf16 v[80:83], v[160:163], v[136:139], v[80:83]
    ds_read_b128 v[176:179], v6 offset:4096
    v_mfma_f32_16x16x32_bf16 v[84:87], v[164:167], v[136:139], v[84:87]
    ds_read_b128 v[180:183], v6 offset:6144
    v_mfma_f32_16x16x32_bf16 v[92:95], v[164:167], v[140:143], v[92:95]
    ds_read_b128 v[184:187], v6 offset:8192
    v_mfma_f32_16x16x32_bf16 v[88:91], v[160:163], v[140:143], v[88:91]
    ds_read_b128 v[188:191], v6 offset:10240
    v_mfma_f32_16x16x32_bf16 v[96:99], v[160:163], v[144:147], v[96:99]
    ds_read_b128 v[192:195], v6 offset:12288
    v_mfma_f32_16x16x32_bf16 v[100:103], v[164:167], v[144:147], v[100:103]
    ds_read_b128 v[196:199], v6 offset:14336
    v_mfma_f32_16x16x32_bf16 v[108:111], v[164:167], v[148:151], v[108:111]
    v_mfma_f32_16x16x32_bf16 v[104:107], v[160:163], v[148:151], v[104:107]
    v_mfma_f32_16x16x32_bf16 v[112:115], v[160:163], v[152:155], v[112:115]
    v_mfma_f32_16x16x32_bf16 v[116:119], v[164:167], v[152:155], v[116:119]
    v_mfma_f32_16x16x32_bf16 v[124:127], v[164:167], v[156:159], v[124:127]
    v_mfma_f32_16x16x32_bf16 v[120:123], v[160:163], v[156:159], v[120:123]
    s_waitcnt lgkmcnt(0)
    s_barrier
    v_mfma_f32_16x16x32_bf16 v[64:67], v[200:203], v[168:171], v[64:67]
    ds_read_b128 v[160:163], v8 offset:32768
    v_mfma_f32_16x16x32_bf16 v[68:71], v[204:207], v[168:171], v[68:71]
    ds_read_b128 v[164:167], v8 offset:34816
    v_mfma_f32_16x16x32_bf16 v[76:79], v[204:207], v[172:175], v[76:79]
    ds_read_b128 v[128:131], v4 offset:32768
    v_mfma_f32_16x16x32_bf16 v[72:75], v[200:203], v[172:175], v[72:75]
    ds_read_b128 v[132:135], v4 offset:34816
    v_mfma_f32_16x16x32_bf16 v[80:83], v[200:203], v[176:179], v[80:83]
    ds_read_b128 v[136:139], v4 offset:36864
    v_mfma_f32_16x16x32_bf16 v[84:87], v[204:207], v[176:179], v[84:87]
    ds_read_b128 v[140:143], v4 offset:38912
    v_mfma_f32_16x16x32_bf16 v[92:95], v[204:207], v[180:183], v[92:95]
    ds_read_b128 v[144:147], v4 offset:40960
    v_mfma_f32_16x16x32_bf16 v[88:91], v[200:203], v[180:183], v[88:91]
    ds_read_b128 v[148:151], v4 offset:43008
    v_mfma_f32_16x16x32_bf16 v[96:99], v[200:203], v[184:187], v[96:99]
    ds_read_b128 v[152:155], v4 offset:45056
    v_mfma_f32_16x16x32_bf16 v[100:103], v[204:207], v[184:187], v[100:103]
    ds_read_b128 v[156:159], v4 offset:47104
    v_mfma_f32_16x16x32_bf16 v[108:111], v[204:207], v[188:191], v[108:111]
    v_mfma_f32_16x16x32_bf16 v[104:107], v[200:203], v[188:191], v[104:107]
    v_mfma_f32_16x16x32_bf16 v[112:115], v[200:203], v[192:195], v[112:115]
    v_mfma_f32_16x16x32_bf16 v[116:119], v[204:207], v[192:195], v[116:119]
    v_mfma_f32_16x16x32_bf16 v[124:127], v[204:207], v[196:199], v[124:127]
    v_mfma_f32_16x16x32_bf16 v[120:123], v[200:203], v[196:199], v[120:123]
    s_cmp_eq_u32 s34, 2
    s_waitcnt lgkmcnt(0)
    s_cbranch_scc1 C_x2
C_x2_r:
    v_mfma_f32_16x16x32_bf16 v[64:67], v[160:163], v[128:131], v[64:67]
    ds_read_b128 v[200:203], v10 offset:32768
    v_mfma_f32_16x16x32_bf16 v[68:71], v[164:167], v[128:131], v[68:71]
    ds_read_b128 v[204:207], v10 offset:34816
    v_mfma_f32_16x16x32_bf16 v[76:79], v[164:167], v[132:135], v[76:79]
    ds_read_b128 v[168:171], v6 offset:32768
    v_mfma_f32_16x16x32_bf16 v[72:75], v[160:163], v[132:135], v[72:75]
    ds_read_b128 v[172:175], v6 offset:34816
    v_mfma_f32_16x16x32_bf16 v[80:83], v[160:163], v[136:139], v[80:83]
    ds_read_b128 v[176:179], v6 offset:36864
    v_mfma_f32_16x16x32_bf16 v[84:87], v[164:167], v[136:139], v[84:87]
    ds_read_b128 v[180:183], v6 offset:38912
    v_mfma_f32_16x16x32_bf16 v[92:95], v[164:167], v[140:143], v[92:95]
    ds_read_b128 v[184:187], v6 offset:40960
    v_mfma_f32_16x16x32_bf16 v[88:91], v[160:163], v[140:143], v[88:91]
    ds_read_b128 v[188:191], v6 offset:43008
    v_mfma_f32_16x16x32_bf16 v[96:99], v[160:163], v[144:147], v[96:99]
    ds_read_b128 v[192:195], v6 offset:45056
    v_mfma_f32_16x16x32_bf16 v[100:103], v[164:167], v[144:147], v[100:103]
    ds_read_b128 v[196:199], v6 offset:47104
    v_mfma_f32_16x16x32_bf16 v[108:111], v[164:167], v[148:151], v[108:111]
    v_mfma_f32_16x16x32_bf16 v[104:107], v[160:163], v[148:151], v[104:107]
    v_mfma_f32_16x16x32_bf16 v[112:115], v[160:163], v[152:155], v[112:115]
    v_mfma_f32_16x16x32_bf16 v[116:119], v[164:167], v[152:155], v[116:119]
    v_mfma_f32_16x16x32_bf16 v[124:127], v[164:167], v[156:159], v[124:127]
    v_mfma_f32_16x16x32_bf16 v[120:123], v[160:163], v[156:159], v[120:123]
    s_waitcnt lgkmcnt(0)
    s_barrier
    v_mfma_f32_16x16x32_bf16 v[64:67], v[200:203], v[168:171], v[64:67]
    ds_read_b128 v[160:163], v9 offset:0
    v_mfma_f32_16x16x32_bf16 v[68:71], v[204:207], v[168:171], v[68:71]
    ds_read_b128 v[164:167], v9 offset:2048
    v_mfma_f32_16x16x32_bf16 v[76:79], v[204:207], v[172:175], v[76:79]
    ds_read_b128 v[128:131], v5 offset:0
    v_mfma_f32_16x16x32_bf16 v[72:75], v[200:203], v[172:175], v[72:75]
    ds_read_b128 v[132:135], v5 offset:2048
    v_mfma_f32_16x16x32_bf16 v[80:83], v[200:203], v[176:179], v[80:83]
    ds_read_b128 v[136:139], v5 offset:4096
    v_mfma_f32_16x16x32_bf16 v[84:87], v[204:207], v[176:179], v[84:87]
    ds_read_b128 v[140:143], v5 offset:6144
    v_mfma_f32_16x16x32_bf16 v[92:95], v[204:207], v[180:183], v[92:95]
    ds_read_b128 v[144:147], v5 offset:8192
    v_mfma_f32_16x16x32_bf16 v[88:91], v[200:203], v[180:183], v[88:91]
    ds_read_b128 v[148:151], v5 offset:10240
    v_mfma_f32_16x16x32_bf16 v[96:99], v[200:203], v[184:187], v[96:99]
    ds_read_b128 v[152:155], v5 offset:12288
    v_mfma_f32_16x16x32_bf16 v[100:103], v[204:207], v[184:187], v[100:103]
    ds_read_b128 v[156:159], v5 offset:14336
    v_mfma_f32_16x16x32_bf16 v[108:111], v[204:207], v[188:191], v[108:111]
    v_mfma_f32_16x16x32_bf16 v[104:107], v[200:203], v[188:191], v[104:107]
    v_mfma_f32_16x16x32_bf16 v[112:115], v[200:203], v[192:195], v[112:115]
    v_mfma_f32_16x16x32_bf16 v[116:119], v[204:207], v[192:195], v[116:119]
    v_mfma_f32_16x16x32_bf16 v[124:127], v[204:207], v[196:199], v[124:127]
    v_mfma_f32_16x16x32_bf16 v[120:123], v[200:203], v[196:199], v[120:123]
    s_cmp_eq_u32 s34, 3
    s_waitcnt lgkmcnt(0)
    s_cbranch_scc1 C_x3
C_x3_r:
    v_mfma_f32_16x16x32_bf16 v[64:67], v[160:163], v[128:131], v[64:67]
    ds_read_b128 v[200:203], v11 offset:0
    v_mfma_f32_16x16x32_bf16 v[68:71], v[164:167], v[128:131], v[68:71]
    ds_read_b128 v[204:207], v11 offset:2048
    v_mfma_f32_16x16x32_bf16 v[76:79], v[164:167], v[132:135], v[76:79]
    ds_read_b128 v[168:171], v7 offset:0
    v_mfma_f32_16x16x32_bf16 v[72:75], v[160:163], v[132:135], v[72:75]
    ds_read_b128 v[172:175], v7 offset:2048
    v_mfma_f32_16x16x32_bf16 v[80:83], v[160:163], v[136:139], v[80:83]
    ds_read_b128 v[176:179], v7 offset:4096
    v_mfma_f32_16x16x32_bf16 v[84:87], v[164:167], v[136:139], v[84:87]
    ds_read_b128 v[180:183], v7 offset:6144
    v_mfma_f32_16x16x32_bf16 v[92:95], v[164:167], v[140:143], v[92:95]
    ds_read_b128 v[184:187], v7 offset:8192
    v_mfma_f32_16x16x32_bf16 v[88:91], v[160:163], v[140:143], v[88:91]
    ds_read_b128 v[188:191], v7 offset:10240
    v_mfma_f32_16x16x32_bf16 v[96:99], v[160:163], v[144:147], v[96:99]
    ds_read_b128 v[192:195], v7 offset:12288
    v_mfma_f32_16x16x32_bf16 v[100:103], v[164:167], v[144:147], v[100:103]
    ds_read_b128 v[196:199], v7 offset:14336
    v_mfma_f32_16x16x32_bf16 v[108:111], v[164:167], v[148:151], v[108:111]
    v_mfma_f32_16x16x32_bf16 v[104:107], v[160:163], v[148:151], v[104:107]
    v_mfma_f32_16x16x32_bf16 v[112:115], v[160:163], v[152:155], v[112:115]
    v_mfma_f32_16x16x32_bf16 v[116:119], v[164:167], v[152:155], v[116:119]
    v_mfma_f32_16x16x32_bf16 v[124:127], v[164:167], v[156:159], v[124:127]
    v_mfma_f32_16x16x32_bf16 v[120:123], v[160:163], v[156:159], v[120:123]
    s_waitcnt lgkmcnt(0)
    s_barrier
    v_mfma_f32_16x16x32_bf16 v[64:67], v[200:203], v[168:171], v[64:67]
    ds_read_b128 v[160:163], v9 offset:32768
    v_mfma_f32_16x16x32_bf16 v[68:71], v[204:207], v[168:171], v[68:71]
    ds_read_b128 v[164:167], v9 offset:34816
    v_mfma_f32_16x16x32_bf16 v[76:79], v[204:207], v[172:175], v[76:79]
    ds_read_b128 v[128:131], v5 offset:32768
    v_mfma_f32_16x16x32_bf16 v[72:75], v[200:203], v[172:175], v[72:75]
    ds_read_b128 v[132:135], v5 offset:34816
    v_mfma_f32_16x16x32_bf16 v[80:83], v[200:203], v[176:179], v[80:83]
    ds_read_b128 v[136:139], v5 offset:36864
    v_mfma_f32_16x16x32_bf16 v[84:87], v[204:207], v[176:179], v[84:87]
    ds_read_b128 v[140:143], v5 offset:38912
    v_mfma_f32_16x16x32_bf16 v[92:95], v[204:207], v[180:183], v[92:95]
    ds_read_b128 v[144:147], v5 offset:40960
    v_mfma_f32_16x16x32_bf16 v[88:91], v[200:203], v[180:183], v[88:91]
    ds_read_b128 v[148:151], v5 offset:43008
    v_mfma_f32_16x16x32_bf16 v[96:99], v[200:203], v[184:187], v[96:99]
    ds_read_b128 v[152:155], v5 offset:45056
    v_mfma_f32_16x16x32_bf16 v[100:103], v[204:207], v[184:187], v[100:103]
    ds_read_b128 v[156:159], v5 offset:47104
    v_mfma_f32_16x16x32_bf16 v[108:111], v[204:207], v[188:191], v[108:111]
    v_mfma_f32_16x16x32_bf16 v[104:107], v[200:203], v[188:191], v[104:107]
    v_mfma_f32_16x16x32_bf16 v[112:115], v[200:203], v[192:195], v[112:115]
    v_mfma_f32_16x16x32_bf16 v[116:119], v[204:207], v[192:195], v[116:119]
    v_mfma_f32_16x16x32_bf16 v[124:127], v[204:207], v[196:199], v[124:127]
    v_mfma_f32_16x16x32_bf16 v[120:123], v[200:203], v[196:199], v[120:123]
    s_cmp_eq_u32 s34, 4
    s_waitcnt lgkmcnt(0)
    s_cbranch_scc1 C_x4
C_x4_r:
    v_mfma_f32_16x16x32_bf16 v[64:67], v[160:163], v[128:131], v[64:67]
    ds_read_b128 v[200:203], v11 offset:32768
    v_mfma_f32_16x16x32_bf16 v[68:71], v[164:167], v[128:131], v[68:71]
    ds_read_b128 v[204:207], v11 offset:34816
    v_mfma_f32_16x16x32_bf16 v[76:79], v[164:167], v[132:135], v[76:79]
    ds_read_b128 v[168:171], v7 offset:32768
    v_mfma_f32_16x16x32_bf16 v[72:75], v[160:163], v[132:135], v[72:75]
    ds_read_b128 v[172:175], v7 offset:34816
    v_mfma_f32_16x16x32_bf16 v[80:83], v[160:163], v[136:139], v[80:83]
    ds_read_b128 v[176:179], v7 offset:36864
    v_mfma_f32_16x16x32_bf16 v[84:87], v[164:167], v[136:139], v[84:87]
    ds_read_b128 v[180:183], v7 offset:38912
    v_mfma_f32_16x16x32_bf16 v[92:95], v[164:167], v[140:143], v[92:95]
    ds_read_b128 v[184:187], v7 offset:40960
    v_mfma_f32_16x16x32_bf16 v[88:91], v[160:163], v[140:143], v[88:91]
    ds_read_b128 v[188:191], v7 offset:43008
    v_mfma_f32_16x16x32_bf16 v[96:99], v[160:163], v[144:147], v[96:99]
    ds_read_b128 v[192:195], v7 offset:45056
    v_mfma_f32_16x16x32_bf16 v[100:103], v[164:167], v[144:147], v[100:103]
    ds_read_b128 v[196:199], v7 offset:47104
    v_mfma_f32_16x16x32_bf16 v[108:111], v[164:167], v[148:151], v[108:111]
    v_mfma_f32_16x16x32_bf16 v[104:107], v[160:163], v[148:151], v[104:107]
    v_mfma_f32_16x16x32_bf16 v[112:115], v[160:163], v[152:155], v[112:115]
    v_mfma_f32_16x16x32_bf16 v[116:119], v[164:167], v[152:155], v[116:119]
    v_mfma_f32_16x16x32_bf16 v[124:127], v[164:167], v[156:159], v[124:127]
    v_mfma_f32_16x16x32_bf16 v[120:123], v[160:163], v[156:159], v[120:123]
    s_waitcnt vmcnt(0)
    v_readfirstlane_b32 s7, v54
    s_cmp_lg_u32 s7, 0
    s_cbranch_scc0 C_non
C_non_r:
    s_mov_b64 exec, 1
    buffer_store_dwordx2 v[54:55], off, s[72:75], s20 sc1
    ds_write_b64 v62, v[54:55]
    s_mov_b64 exec, -1
    s_waitcnt lgkmcnt(0)
    s_barrier
    v_mfma_f32_16x16x32_bf16 v[64:67], v[200:203], v[168:171], v[64:67]
    ds_read_b128 v[160:163], v8 offset:0
    v_mfma_f32_16x16x32_bf16 v[68:71], v[204:207], v[168:171], v[68:71]
    ds_read_b128 v[164:167], v8 offset:2048
    v_mfma_f32_16x16x32_bf16 v[76:79], v[204:207], v[172:175], v[76:79]
    ds_read_b128 v[128:131], v4 offset:0
    v_mfma_f32_16x16x32_bf16 v[72:75], v[200:203], v[172:175], v[72:75]
    ds_read_b128 v[132:135], v4 offset:2048
    v_mfma_f32_16x16x32_bf16 v[80:83], v[200:203], v[176:179], v[80:83]
    ds_read_b128 v[136:139], v4 offset:4096
    v_mfma_f32_16x16x32_bf16 v[84:87], v[204:207], v[176:179], v[84:87]
    ds_read_b128 v[140:143], v4 offset:6144
    v_mfma_f32_16x16x32_bf16 v[92:95], v[204:207], v[180:183], v[92:95]
    ds_read_b128 v[144:147], v4 offset:8192
    v_mfma_f32_16x16x32_bf16 v[88:91], v[200:203], v[180:183], v[88:91]
    ds_read_b128 v[148:151], v4 offset:10240
    v_mfma_f32_16x16x32_bf16 v[96:99], v[200:203], v[184:187], v[96:99]
    ds_read_b128 v[152:155], v4 offset:12288
    v_mfma_f32_16x16x32_bf16 v[100:103], v[204:207], v[184:187], v[100:103]
    ds_read_b128 v[156:159], v4 offset:14336
    v_mfma_f32_16x16x32_bf16 v[108:111], v[204:207], v[188:191], v[108:111]
    v_mfma_f32_16x16x32_bf16 v[104:107], v[200:203], v[188:191], v[104:107]
    v_mfma_f32_16x16x32_bf16 v[112:115], v[200:203], v[192:195], v[112:115]
    v_mfma_f32_16x16x32_bf16 v[116:119], v[204:207], v[192:195], v[116:119]
    v_mfma_f32_16x16x32_bf16 v[124:127], v[204:207], v[196:199], v[124:127]
    v_mfma_f32_16x16x32_bf16 v[120:123], v[200:203], v[196:199], v[120:123]
    s_cmp_eq_u32 s34, 5
    s_waitcnt lgkmcnt(0)
    s_cbranch_scc1 C_x5
C_x5_r:
    v_mfma_f32_16x16x32_bf16 v[64:67], v[160:163], v[128:131], v[64:67]
    ds_read_b128 v[200:203], v10 offset:0
    v_mfma_f32_16x16x32_bf16 v[68:71], v[164:167], v[128:131], v[68:71]
    ds_read_b128 v[204:207], v10 offset:2048
    v_mfma_f32_16x16x32_bf16 v[76:79], v[164:167], v[132:135], v[76:79]
    ds_read_b128 v[168:171], v6 offset:0
    v_mfma_f32_16x16x32_bf16 v[72:75], v[160:163], v[132:135], v[72:75]
    ds_read_b128 v[172:175], v6 offset:2048
    v_mfma_f32_16x16x32_bf16 v[80:83], v[160:163], v[136:139], v[80:83]
    ds_read_b128 v[176:179], v6 offset:4096
    v_mfma_f32_16x16x32_bf16 v[84:87], v[164:167], v[136:139], v[84:87]
    ds_read_b128 v[180:183], v6 offset:6144
    v_mfma_f32_16x16x32_bf16 v[92:95], v[164:167], v[140:143], v[92:95]
    ds_read_b128 v[184:187], v6 offset:8192
    v_mfma_f32_16x16x32_bf16 v[88:91], v[160:163], v[140:143], v[88:91]
    ds_read_b128 v[188:191], v6 offset:10240
    v_mfma_f32_16x16x32_bf16 v[96:99], v[160:163], v[144:147], v[96:99]
    ds_read_b128 v[192:195], v6 offset:12288
    v_mfma_f32_16x16x32_bf16 v[100:103], v[164:167], v[144:147], v[100:103]
    ds_read_b128 v[196:199], v6 offset:14336
    v_mfma_f32_16x16x32_bf16 v[108:111], v[164:167], v[148:151], v[108:111]
    v_mfma_f32_16x16x32_bf16 v[104:107], v[160:163], v[148:151], v[104:107]
    v_mfma_f32_16x16x32_bf16 v[112:115], v[160:163], v[152:155], v[112:115]
    v_mfma_f32_16x16x32_bf16 v[116:119], v[164:167], v[152:155], v[116:119]
    v_mfma_f32_16x16x32_bf16 v[124:127], v[164:167], v[156:159], v[124:127]
    v_mfma_f32_16x16x32_bf16 v[120:123], v[160:163], v[156:159], v[120:123]
    s_waitcnt lgkmcnt(0)
    s_barrier
    v_mfma_f32_16x16x32_bf16 v[64:67], v[200:203], v[168:171], v[64:67]
    ds_read_b128 v[160:163], v8 offset:32768
    v_mfma_f32_16x16x32_bf16 v[68:71], v[204:207], v[168:171], v[68:71]
    ds_read_b128 v[164:167], v8 offset:34816
    v_mfma_f32_16x16x32_bf16 v[76:79], v[204:207], v[172:175], v[76:79]
    ds_read_b128 v[128:131], v4 offset:32768
    v_mfma_f32_16x16x32_bf16 v[72:75], v[200:203], v[172:175], v[72:75]
    ds_read_b128 v[132:135], v4 offset:34816
    v_mfma_f32_16x16x32_bf16 v[80:83], v[200:203], v[176:179], v[80:83]
    ds_read_b128 v[136:139], v4 offset:36864
    v_mfma_f32_16x16x32_bf16 v[84:87], v[204:207], v[176:179], v[84:87]
    ds_read_b128 v[140:143], v4 offset:38912
    v_mfma_f32_16x16x32_bf16 v[92:95], v[204:207], v[180:183], v[92:95]
    ds_read_b128 v[144:147], v4 offset:40960
    v_mfma_f32_16x16x32_bf16 v[88:91], v[200:203], v[180:183], v[88:91]
    ds_read_b128 v[148:151], v4 offset:43008
    v_mfma_f32_16x16x32_bf16 v[96:99], v[200:203], v[184:187], v[96:99]
    ds_read_b128 v[152:155], v4 offset:45056
    v_mfma_f32_16x16x32_bf16 v[100:103], v[204:207], v[184:187], v[100:103]
    ds_read_b128 v[156:159], v4 offset:47104
    v_mfma_f32_16x16x32_bf16 v[108:111], v[204:207], v[188:191], v[108:111]
    v_mfma_f32_16x16x32_bf16 v[104:107], v[200:203], v[188:191], v[104:107]
    v_mfma_f32_16x16x32_bf16 v[112:115], v[200:203], v[192:195], v[112:115]
    v_mfma_f32_16x16x32_bf16 v[116:119], v[204:207], v[192:195], v[116:119]
    v_mfma_f32_16x16x32_bf16 v[124:127], v[204:207], v[196:199], v[124:127]
    v_mfma_f32_16x16x32_bf16 v[120:123], v[200:203], v[196:199], v[120:123]
    s_cmp_eq_u32 s34, 6
    s_waitcnt lgkmcnt(0)
    s_cbranch_scc1 C_x6
C_x6_r:
    v_mfma_f32_16x16x32_bf16 v[64:67], v[160:163], v[128:131], v[64:67]
    ds_read_b128 v[200:203], v10 offset:32768
    v_mfma_f32_16x16x32_bf16 v[68:71], v[164:167], v[128:131], v[68:71]
    ds_read_b128 v[204:207], v10 offset:34816
    v_mfma_f32_16x16x32_bf16 v[76:79], v[164:167], v[132:135], v[76:79]
    ds_read_b128 v[168:171], v6 offset:32768
    v_mfma_f32_16x16x32_bf16 v[72:75], v[160:163], v[132:135], v[72:75]
    ds_read_b128 v[172:175], v6 offset:34816
    v_mfma_f32_16x16x32_bf16 v[80:83], v[160:163], v[136:139], v[80:83]
    ds_read_b128 v[176:179], v6 offset:36864
    v_mfma_f32_16x16x32_bf16 v[84:87], v[164:167], v[136:139], v[84:87]
    ds_read_b128 v[180:183], v6 offset:38912
    v_mfma_f32_16x16x32_bf16 v[92:95], v[164:167], v[140:143], v[92:95]
    ds_read_b128 v[184:187], v6 offset:40960
    v_mfma_f32_16x16x32_bf16 v[88:91], v[160:163], v[140:143], v[88:91]
    ds_read_b128 v[188:191], v6 offset:43008
    v_mfma_f32_16x16x32_bf16 v[96:99], v[160:163], v[144:147], v[96:99]
    ds_read_b128 v[192:195], v6 offset:45056
    v_mfma_f32_16x16x32_bf16 v[100:103], v[164:167], v[144:147], v[100:103]
    ds_read_b128 v[196:199], v6 offset:47104
    v_mfma_f32_16x16x32_bf16 v[108:111], v[164:167], v[148:151], v[108:111]
    v_mfma_f32_16x16x32_bf16 v[104:107], v[160:163], v[148:151], v[104:107]
    v_mfma_f32_16x16x32_bf16 v[112:115], v[160:163], v[152:155], v[112:115]
    v_mfma_f32_16x16x32_bf16 v[116:119], v[164:167], v[152:155], v[116:119]
    v_mfma_f32_16x16x32_bf16 v[124:127], v[164:167], v[156:159], v[124:127]
    v_mfma_f32_16x16x32_bf16 v[120:123], v[160:163], v[156:159], v[120:123]
    s_waitcnt lgkmcnt(0)
    s_barrier
    v_mfma_f32_16x16x32_bf16 v[64:67], v[200:203], v[168:171], v[64:67]
    ds_read_b128 v[160:163], v9 offset:0
    v_mfma_f32_16x16x32_bf16 v[68:71], v[204:207], v[168:171], v[68:71]
    ds_read_b128 v[164:167], v9 offset:2048
    v_mfma_f32_16x16x32_bf16 v[76:79], v[204:207], v[172:175], v[76:79]
    ds_read_b128 v[128:131], v5 offset:0
    v_mfma_f32_16x16x32_bf16 v[72:75], v[200:203], v[172:175], v[72:75]
    ds_read_b128 v[132:135], v5 offset:2048
    v_mfma_f32_16x16x32_bf16 v[80:83], v[200:203], v[176:179], v[80:83]
    ds_read_b128 v[136:139], v5 offset:4096
    v_mfma_f32_16x16x32_bf16 v[84:87], v[204:207], v[176:179], v[84:87]
    ds_read_b128 v[140:143], v5 offset:6144
    v_mfma_f32_16x16x32_bf16 v[92:95], v[204:207], v[180:183], v[92:95]
    ds_read_b128 v[144:147], v5 offset:8192
    v_mfma_f32_16x16x32_bf16 v[88:91], v[200:203], v[180:183], v[88:91]
    ds_read_b128 v[148:151], v5 offset:10240
    v_mfma_f32_16x16x32_bf16 v[96:99], v[200:203], v[184:187], v[96:99]
    ds_read_b128 v[152:155], v5 offset:12288
    v_mfma_f32_16x16x32_bf16 v[100:103], v[204:207], v[184:187], v[100:103]
    ds_read_b128 v[156:159], v5 offset:14336
    v_mfma_f32_16x16x32_bf16 v[108:111], v[204:207], v[188:191], v[108:111]
    v_mfma_f32_16x16x32_bf16 v[104:107], v[200:203], v[188:191], v[104:107]
    v_mfma_f32_16x16x32_bf16 v[112:115], v[200:203], v[192:195], v[112:115]
    v_mfma_f32_16x16x32_bf16 v[116:119], v[204:207], v[192:195], v[116:119]
    v_mfma_f32_16x16x32_bf16 v[124:127], v[204:207], v[196:199], v[124:127]
    v_mfma_f32_16x16x32_bf16 v[120:123], v[200:203], v[196:199], v[120:123]
    s_cmp_eq_u32 s34, 7
    s_waitcnt lgkmcnt(0)
    s_cbranch_scc1 C_x7
C_x7_r:
    v_mfma_f32_16x16x32_bf16 v[64:67], v[160:163], v[128:131], v[64:67]
    ds_read_b128 v[200:203], v11 offset:0
    v_mfma_f32_16x16x32_bf16 v[68:71], v[164:167], v[128:131], v[68:71]
    ds_read_b128 v[204:207], v11 offset:2048
    v_mfma_f32_16x16x32_bf16 v[76:79], v[164:167], v[132:135], v[76:79]
    ds_read_b128 v[168:171], v7 offset:0
    v_mfma_f32_16x16x32_bf16 v[72:75], v[160:163], v[132:135], v[72:75]
    ds_read_b128 v[172:175], v7 offset:2048
    v_mfma_f32_16x16x32_bf16 v[80:83], v[160:163], v[136:139], v[80:83]
    ds_read_b128 v[176:179], v7 offset:4096
    v_mfma_f32_16x16x32_bf16 v[84:87], v[164:167], v[136:139], v[84:87]
    ds_read_b128 v[180:183], v7 offset:6144
    v_mfma_f32_16x16x32_bf16 v[92:95], v[164:167], v[140:143], v[92:95]
    ds_read_b128 v[184:187], v7 offset:8192
    v_mfma_f32_16x16x32_bf16 v[88:91], v[160:163], v[140:143], v[88:91]
    ds_read_b128 v[188:191], v7 offset:10240
    v_mfma_f32_16x16x32_bf16 v[96:99], v[160:163], v[144:147], v[96:99]
    ds_read_b128 v[192:195], v7 offset:12288
    v_mfma_f32_16x16x32_bf16 v[100:103], v[164:167], v[144:147], v[100:103]
    ds_read_b128 v[196:199], v7 offset:14336
    v_mfma_f32_16x16x32_bf16 v[108:111], v[164:167], v[148:151], v[108:111]
    v_mfma_f32_16x16x32_bf16 v[104:107], v[160:163], v[148:151], v[104:107]
    v_mfma_f32_16x16x32_bf16 v[112:115], v[160:163], v[152:155], v[112:115]
    v_mfma_f32_16x16x32_bf16 v[116:119], v[164:167], v[152:155], v[116:119]
    v_mfma_f32_16x16x32_bf16 v[124:127], v[164:167], v[156:159], v[124:127]
    v_mfma_f32_16x16x32_bf16 v[120:123], v[160:163], v[156:159], v[120:123]
    s_waitcnt lgkmcnt(0)
    s_barrier
    v_mfma_f32_16x16x32_bf16 v[64:67], v[200:203], v[168:171], v[64:67]
    ds_read_b128 v[160:163], v9 offset:32768
    v_mfma_f32_16x16x32_bf16 v[68:71], v[204:207], v[168:171], v[68:71]
    ds_read_b128 v[164:167], v9 offset:34816
    v_mfma_f32_16x16x32_bf16 v[76:79], v[204:207], v[172:175], v[76:79]
    ds_read_b128 v[128:131], v5 offset:32768
    v_mfma_f32_16x16x32_bf16 v[72:75], v[200:203], v[172:175], v[72:75]
    ds_read_b128 v[132:135], v5 offset:34816
    v_mfma_f32_16x16x32_bf16 v[80:83], v[200:203], v[176:179], v[80:83]
    ds_read_b128 v[136:139], v5 offset:36864
    v_mfma_f32_16x16x32_bf16 v[84:87], v[204:207], v[176:179], v[84:87]
    ds_read_b128 v[140:143], v5 offset:38912
    v_mfma_f32_16x16x32_bf16 v[92:95], v[204:207], v[180:183], v[92:95]
    ds_read_b128 v[144:147], v5 offset:40960
    v_mfma_f32_16x16x32_bf16 v[88:91], v[200:203], v[180:183], v[88:91]
    ds_read_b128 v[148:151], v5 offset:43008
    v_mfma_f32_16x16x32_bf16 v[96:99], v[200:203], v[184:187], v[96:99]
    ds_read_b128 v[152:155], v5 offset:45056
    v_mfma_f32_16x16x32_bf16 v[100:103], v[204:207], v[184:187], v[100:103]
    ds_read_b128 v[156:159], v5 offset:47104
    v_mfma_f32_16x16x32_bf16 v[108:111], v[204:207], v[188:191], v[108:111]
    v_mfma_f32_16x16x32_bf16 v[104:107], v[200:203], v[188:191], v[104:107]
    v_mfma_f32_16x16x32_bf16 v[112:115], v[200:203], v[192:195], v[112:115]
    v_mfma_f32_16x16x32_bf16 v[116:119], v[204:207], v[192:195], v[116:119]
    v_mfma_f32_16x16x32_bf16 v[124:127], v[204:207], v[196:199], v[124:127]
    v_mfma_f32_16x16x32_bf16 v[120:123], v[200:203], v[196:199], v[120:123]
    s_cmp_eq_u32 s34, 8
    s_waitcnt lgkmcnt(0)
    s_cbranch_scc1 C_x8
C_x8_r:
    v_mfma_f32_16x16x32_bf16 v[64:67], v[160:163], v[128:131], v[64:67]
    ds_read_b128 v[200:203], v11 offset:32768
    v_mfma_f32_16x16x32_bf16 v[68:71], v[164:167], v[128:131], v[68:71]
    ds_read_b128 v[204:207], v11 offset:34816
    v_mfma_f32_16x16x32_bf16 v[76:79], v[164:167], v[132:135], v[76:79]
    ds_read_b128 v[168:171], v7 offset:32768
    v_mfma_f32_16x16x32_bf16 v[72:75], v[160:163], v[132:135], v[72:75]
    ds_read_b128 v[172:175], v7 offset:34816
    v_mfma_f32_16x16x32_bf16 v[80:83], v[160:163], v[136:139], v[80:83]
    ds_read_b128 v[176:179], v7 offset:36864
    v_mfma_f32_16x16x32_bf16 v[84:87], v[164:167], v[136:139], v[84:87]
    ds_read_b128 v[180:183], v7 offset:38912
    v_mfma_f32_16x16x32_bf16 v[92:95], v[164:167], v[140:143], v[92:95]
    ds_read_b128 v[184:187], v7 offset:40960
    v_mfma_f32_16x16x32_bf16 v[88:91], v[160:163], v[140:143], v[88:91]
    ds_read_b128 v[188:191], v7 offset:43008
    v_mfma_f32_16x16x32_bf16 v[96:99], v[160:163], v[144:147], v[96:99]
    ds_read_b128 v[192:195], v7 offset:45056
    v_mfma_f32_16x16x32_bf16 v[100:103], v[164:167], v[144:147], v[100:103]
    ds_read_b128 v[196:199], v7 offset:47104
    v_mfma_f32_16x16x32_bf16 v[108:111], v[164:167], v[148:151], v[108:111]
    v_mfma_f32_16x16x32_bf16 v[104:107], v[160:163], v[148:151], v[104:107]
    v_mfma_f32_16x16x32_bf16 v[112:115], v[160:163], v[152:155], v[112:115]
    v_mfma_f32_16x16x32_bf16 v[116:119], v[164:167], v[152:155], v[116:119]
    v_mfma_f32_16x16x32_bf16 v[124:127], v[164:167], v[156:159], v[124:127]
    v_mfma_f32_16x16x32_bf16 v[120:123], v[160:163], v[156:159], v[120:123]
    s_waitcnt lgkmcnt(0)
    s_barrier
    v_mfma_f32_16x16x32_bf16 v[64:67], v[200:203], v[168:171], v[64:67]
    ds_read_b128 v[160:163], v8 offset:0
    v_mfma_f32_16x16x32_bf16 v[68:71], v[204:207], v[168:171], v[68:71]
    ds_read_b128 v[164:167], v8 offset:2048
    v_mfma_f32_16x16x32_bf16 v[76:79], v[204:207], v[172:175], v[76:79]
    ds_read_b128 v[128:131], v4 offset:0
    v_mfma_f32_16x16x32_bf16 v[72:75], v[200:203], v[172:175], v[72:75]
    ds_read_b128 v[132:135], v4 offset:2048
    v_mfma_f32_16x16x32_bf16 v[80:83], v[200:203], v[176:179], v[80:83]
    ds_read_b128 v[136:139], v4 offset:4096
    v_mfma_f32_16x16x32_bf16 v[84:87], v[204:207], v[176:179], v[84:87]
    ds_read_b128 v[140:143], v4 offset:6144
    v_mfma_f32_16x16x32_bf16 v[92:95], v[204:207], v[180:183], v[92:95]
    ds_read_b128 v[144:147], v4 offset:8192
    v_mfma_f32_16x16x32_bf16 v[88:91], v[200:203], v[180:183], v[88:91]
    ds_read_b128 v[148:151], v4 offset:10240
    v_mfma_f32_16x16x32_bf16 v[96:99], v[200:203], v[184:187], v[96:99]
    ds_read_b128 v[152:155], v4 offset:12288
    v_mfma_f32_16x16x32_bf16 v[100:103], v[204:207], v[184:187], v[100:103]
    ds_read_b128 v[156:159], v4 offset:14336
    v_mfma_f32_16x16x32_bf16 v[108:111], v[204:207], v[188:191], v[108:111]
    v_mfma_f32_16x16x32_bf16 v[104:107], v[200:203], v[188:191], v[104:107]
    v_mfma_f32_16x16x32_bf16 v[112:115], v[200:203], v[192:195], v[112:115]
    v_mfma_f32_16x16x32_bf16 v[116:119], v[204:207], v[192:195], v[116:119]
    v_mfma_f32_16x16x32_bf16 v[124:127], v[204:207], v[196:199], v[124:127]
    v_mfma_f32_16x16x32_bf16 v[120:123], v[200:203], v[196:199], v[120:123]
    s_cmp_eq_u32 s34, 9
    s_waitcnt lgkmcnt(0)
    s_cbranch_scc1 C_x9
C_x9_r:
    v_mfma_f32_16x16x32_bf16 v[64:67], v[160:163], v[128:131], v[64:67]
    ds_read_b128 v[200:203], v10 offset:0
    v_mfma_f32_16x16x32_bf16 v[68:71], v[164:167], v[128:131], v[68:71]
    ds_read_b128 v[204:207], v10 offset:2048
    v_mfma_f32_16x16x32_bf16 v[76:79], v[164:167], v[132:135], v[76:79]
    ds_read_b128 v[168:171], v6 offset:0
    v_mfma_f32_16x16x32_bf16 v[72:75], v[160:163], v[132:135], v[72:75]
    ds_read_b128 v[172:175], v6 offset:2048
    v_mfma_f32_16x16x32_bf16 v[80:83], v[160:163], v[136:139], v[80:83]
    ds_read_b128 v[176:179], v6 offset:4096
    v_mfma_f32_16x16x32_bf16 v[84:87], v[164:167], v[136:139], v[84:87]
    ds_read_b128 v[180:183], v6 offset:6144
    v_mfma_f32_16x16x32_bf16 v[92:95], v[164:167], v[140:143], v[92:95]
    ds_read_b128 v[184:187], v6 offset:8192
    v_mfma_f32_16x16x32_bf16 v[88:91], v[160:163], v[140:143], v[88:91]
    ds_read_b128 v[188:191], v6 offset:10240
    v_mfma_f32_16x16x32_bf16 v[96:99], v[160:163], v[144:147], v[96:99]
    ds_read_b128 v[192:195], v6 offset:12288
    v_mfma_f32_16x16x32_bf16 v[100:103], v[164:167], v[144:147], v[100:103]
    ds_read_b128 v[196:199], v6 offset:14336
    v_mfma_f32_16x16x32_bf16 v[108:111], v[164:167], v[148:151], v[108:111]
    v_mfma_f32_16x16x32_bf16 v[104:107], v[160:163], v[148:151], v[104:107]
    v_mfma_f32_16x16x32_bf16 v[112:115], v[160:163], v[152:155], v[112:115]
    v_mfma_f32_16x16x32_bf16 v[116:119], v[164:167], v[152:155], v[116:119]
    v_mfma_f32_16x16x32_bf16 v[124:127], v[164:167], v[156:159], v[124:127]
    v_mfma_f32_16x16x32_bf16 v[120:123], v[160:163], v[156:159], v[120:123]
    s_waitcnt lgkmcnt(0)
    s_barrier
    v_mfma_f32_16x16x32_bf16 v[64:67], v[200:203], v[168:171], v[64:67]
    ds_read_b128 v[160:163], v8 offset:32768
    v_mfma_f32_16x16x32_bf16 v[68:71], v[204:207], v[168:171], v[68:71]
    ds_read_b128 v[164:167], v8 offset:34816
    v_mfma_f32_16x16x32_bf16 v[76:79], v[204:207], v[172:175], v[76:79]
    ds_read_b128 v[128:131], v4 offset:32768
    v_mfma_f32_16x16x32_bf16 v[72:75], v[200:203], v[172:175], v[72:75]
    ds_read_b128 v[132:135], v4 offset:34816
    v_mfma_f32_16x16x32_bf16 v[80:83], v[200:203], v[176:179], v[80:83]
    ds_read_b128 v[136:139], v4 offset:36864
    v_mfma_f32_16x16x32_bf16 v[84:87], v[204:207], v[176:179], v[84:87]
    ds_read_b128 v[140:143], v4 offset:38912
    v_mfma_f32_16x16x32_bf16 v[92:95], v[204:207], v[180:183], v[92:95]
    ds_read_b128 v[144:147], v4 offset:40960
    v_mfma_f32_16x16x32_bf16 v[88:91], v[200:203], v[180:183], v[88:91]
    ds_read_b128 v[148:151], v4 offset:43008
    v_mfma_f32_16x16x32_bf16 v[96:99], v[200:203], v[184:187], v[96:99]
    ds_read_b128 v[152:155], v4 offset:45056
    v_mfma_f32_16x16x32_bf16 v[100:103], v[204:207], v[184:187], v[100:103]
    ds_read_b128 v[156:159], v4 offset:47104
    v_mfma_f32_16x16x32_bf16 v[108:111], v[204:207], v[188:191], v[108:111]
    v_mfma_f32_16x16x32_bf16 v[104:107], v[200:203], v[188:191], v[104:107]
    v_mfma_f32_16x16x32_bf16 v[112:115], v[200:203], v[192:195], v[112:115]
    v_mfma_f32_16x16x32_bf16 v[116:119], v[204:207], v[192:195], v[116:119]
    v_mfma_f32_16x16x32_bf16 v[124:127], v[204:207], v[196:199], v[124:127]
    v_mfma_f32_16x16x32_bf16 v[120:123], v[200:203], v[196:199], v[120:123]
    s_cmp_eq_u32 s34, 10
    s_waitcnt lgkmcnt(0)
    s_cbranch_scc1 C_x10
C_x10_r:
    v_mfma_f32_16x16x32_bf16 v[64:67], v[160:163], v[128:131], v[64:67]
    ds_read_b128 v[200:203], v10 offset:32768
    v_mfma_f32_16x16x32_bf16 v[68:71], v[164:167], v[128:131], v[68:71]
    ds_read_b128 v[204:207], v10 offset:34816
    v_mfma_f32_16x16x32_bf16 v[76:79], v[164:167], v[132:135], v[76:79]
    ds_read_b128 v[168:171], v6 offset:32768
    v_mfma_f32_16x16x32_bf16 v[72:75], v[160:163], v[132:135], v[72:75]
    ds_read_b128 v[172:175], v6 offset:34816
    v_mfma_f32_16x16x32_bf16 v[80:83], v[160:163], v[136:139], v[80:83]
    ds_read_b128 v[176:179], v6 offset:36864
    v_mfma_f32_16x16x32_bf16 v[84:87], v[164:167], v[136:139], v[84:87]
    ds_read_b128 v[180:183], v6 offset:38912
    v_mfma_f32_16x16x32_bf16 v[92:95], v[164:167], v[140:143], v[92:95]
    ds_read_b128 v[184:187], v6 offset:40960
    v_mfma_f32_16x16x32_bf16 v[88:91], v[160:163], v[140:143], v[88:91]
    ds_read_b128 v[188:191], v6 offset:43008
    v_mfma_f32_16x16x32_bf16 v[96:99], v[160:163], v[144:147], v[96:99]
    ds_read_b128 v[192:195], v6 offset:45056
    v_mfma_f32_16x16x32_bf16 v[100:103], v[164:167], v[144:147], v[100:103]
    ds_read_b128 v[196:199], v6 offset:47104
    v_mfma_f32_16x16x32_bf16 v[108:111], v[164:167], v[148:151], v[108:111]
    v_mfma_f32_16x16x32_bf16 v[104:107], v[160:163], v[148:151], v[104:107]
    v_mfma_f32_16x16x32_bf16 v[112:115], v[160:163], v[152:155], v[112:115]
    v_mfma_f32_16x16x32_bf16 v[116:119], v[164:167], v[152:155], v[116:119]
    v_mfma_f32_16x16x32_bf16 v[124:127], v[164:167], v[156:159], v[124:127]
    v_mfma_f32_16x16x32_bf16 v[120:123], v[160:163], v[156:159], v[120:123]
    buffer_load_dwordx2 v[244:245], v246, s[72:75], s21 offen sc1
    s_waitcnt lgkmcnt(0)
    s_barrier
    v_mfma_f32_16x16x32_bf16 v[64:67], v[200:203], v[168:171], v[64:67]
    ds_read_b128 v[160:163], v9 offset:0
    v_mfma_f32_16x16x32_bf16 v[68:71], v[204:207], v[168:171], v[68:71]
    ds_read_b128 v[164:167], v9 offset:2048
    v_mfma_f32_16x16x32_bf16 v[76:79], v[204:207], v[172:175], v[76:79]
    ds_read_b128 v[128:131], v5 offset:0
    v_mfma_f32_16x16x32_bf16 v[72:75], v[200:203], v[172:175], v[72:75]
    ds_read_b128 v[132:135], v5 offset:2048
    v_mfma_f32_16x16x32_bf16 v[80:83], v[200:203], v[176:179], v[80:83]
    ds_read_b128 v[136:139], v5 offset:4096
    v_mfma_f32_16x16x32_bf16 v[84:87], v[204:207], v[176:179], v[84:87]
    ds_read_b128 v[140:143], v5 offset:6144
    v_mfma_f32_16x16x32_bf16 v[92:95], v[204:207], v[180:183], v[92:95]
    ds_read_b128 v[144:147], v5 offset:8192
    v_mfma_f32_16x16x32_bf16 v[88:91], v[200:203], v[180:183], v[88:91]
    ds_read_b128 v[148:151], v5 offset:10240
    v_mfma_f32_16x16x32_bf16 v[96:99], v[200:203], v[184:187], v[96:99]
    ds_read_b128 v[152:155], v5 offset:12288
    v_mfma_f32_16x16x32_bf16 v[100:103], v[204:207], v[184:187], v[100:103]
    ds_read_b128 v[156:159], v5 offset:14336
    v_mfma_f32_16x16x32_bf16 v[108:111], v[204:207], v[188:191], v[108:111]
    v_mfma_f32_16x16x32_bf16 v[104:107], v[200:203], v[188:191], v[104:107]
    v_mfma_f32_16x16x32_bf16 v[112:115], v[200:203], v[192:195], v[112:115]
    v_mfma_f32_16x16x32_bf16 v[116:119], v[204:207], v[192:195], v[116:119]
    v_mfma_f32_16x16x32_bf16 v[124:127], v[204:207], v[196:199], v[124:127]
    v_mfma_f32_16x16x32_bf16 v[120:123], v[200:203], v[196:199], v[120:123]
    s_cmp_eq_u32 s34, 11
    s_waitcnt lgkmcnt(0)
    s_cbranch_scc1 C_x11
C_x11_r:
    v_mfma_f32_16x16x32_bf16 v[64:67], v[160:163], v[128:131], v[64:67]
    ds_read_b128 v[200:203], v11 offset:0
    v_mfma_f32_16x16x32_bf16 v[68:71], v[164:167], v[128:131], v[68:71]
    ds_read_b128 v[204:207], v11 offset:2048
    v_mfma_f32_16x16x32_bf16 v[76:79], v[164:167], v[132:135], v[76:79]
    ds_read_b128 v[168:171], v7 offset:0
    v_mfma_f32_16x16x32_bf16 v[72:75], v[160:163], v[132:135], v[72:75]
    ds_read_b128 v[172:175], v7 offset:2048
    v_mfma_f32_16x16x32_bf16 v[80:83], v[160:163], v[136:139], v[80:83]
    ds_read_b128 v[176:179], v7 offset:4096
    v_mfma_f32_16x16x32_bf16 v[84:87], v[164:167], v[136:139], v[84:87]
    ds_read_b128 v[180:183], v7 offset:6144
    v_mfma_f32_16x16x32_bf16 v[92:95], v[164:167], v[140:143], v[92:95]
    ds_read_b128 v[184:187], v7 offset:8192
    v_mfma_f32_16x16x32_bf16 v[88:91], v[160:163], v[140:143], v[88:91]
    ds_read_b128 v[188:191], v7 offset:10240
    v_mfma_f32_16x16x32_bf16 v[96:99], v[160:163], v[144:147], v[96:99]
    ds_read_b128 v[192:195], v7 offset:12288
    v_mfma_f32_16x16x32_bf16 v[100:103], v[164:167], v[144:147], v[100:103]
    ds_read_b128 v[196:199], v7 offset:14336
    v_mfma_f32_16x16x32_bf16 v[108:111], v[164:167], v[148:151], v[108:111]
    v_mfma_f32_16x16x32_bf16 v[104:107], v[160:163], v[148:151], v[104:107]
    v_mfma_f32_16x16x32_bf16 v[112:115], v[160:163], v[152:155], v[112:115]
    v_mfma_f32_16x16x32_bf16 v[116:119], v[164:167], v[152:155], v[116:119]
    v_mfma_f32_16x16x32_bf16 v[124:127], v[164:167], v[156:159], v[124:127]
    v_mfma_f32_16x16x32_bf16 v[120:123], v[160:163], v[156:159], v[120:123]
    s_waitcnt lgkmcnt(0)
    s_barrier
    v_mfma_f32_16x16x32_bf16 v[64:67], v[200:203], v[168:171], v[64:67]
    ds_read_b128 v[160:163], v9 offset:32768
    v_mfma_f32_16x16x32_bf16 v[68:71], v[204:207], v[168:171], v[68:71]
    ds_read_b128 v[164:167], v9 offset:34816
    v_mfma_f32_16x16x32_bf16 v[76:79], v[204:207], v[172:175], v[76:79]
    ds_read_b128 v[128:131], v5 offset:32768
    v_mfma_f32_16x16x32_bf16 v[72:75], v[200:203], v[172:175], v[72:75]
    ds_read_b128 v[132:135], v5 offset:34816
    v_mfma_f32_16x16x32_bf16 v[80:83], v[200:203], v[176:179], v[80:83]
    ds_read_b128 v[136:139], v5 offset:36864
    v_mfma_f32_16x16x32_bf16 v[84:87], v[204:207], v[176:179], v[84:87]
    ds_read_b128 v[140:143], v5 offset:38912
    v_mfma_f32_16x16x32_bf16 v[92:95], v[204:207], v[180:183], v[92:95]
    ds_read_b128 v[144:147], v5 offset:40960
    v_mfma_f32_16x16x32_bf16 v[88:91], v[200:203], v[180:183], v[88:91]
    ds_read_b128 v[148:151], v5 offset:43008
    v_mfma_f32_16x16x32_bf16 v[96:99], v[200:203], v[184:187], v[96:99]
    ds_read_b128 v[152:155], v5 offset:45056
    v_mfma_f32_16x16x32_bf16 v[100:103], v[204:207], v[184:187], v[100:103]
    ds_read_b128 v[156:159], v5 offset:47104
    v_mfma_f32_16x16x32_bf16 v[108:111], v[204:207], v[188:191], v[108:111]
    v_mfma_f32_16x16x32_bf16 v[104:107], v[200:203], v[188:191], v[104:107]
    v_mfma_f32_16x16x32_bf16 v[112:115], v[200:203], v[192:195], v[112:115]
    v_mfma_f32_16x16x32_bf16 v[116:119], v[204:207], v[192:195], v[116:119]
    v_mfma_f32_16x16x32_bf16 v[124:127], v[204:207], v[196:199], v[124:127]
    v_mfma_f32_16x16x32_bf16 v[120:123], v[200:203], v[196:199], v[120:123]
    s_cmp_eq_u32 s34, 12
    s_waitcnt lgkmcnt(0)
    s_cbranch_scc1 C_x12
C_x12_r:
    v_mfma_f32_16x16x32_bf16 v[64:67], v[160:163], v[128:131], v[64:67]
    ds_read_b128 v[200:203], v11 offset:32768
    v_mfma_f32_16x16x32_bf16 v[68:71], v[164:167], v[128:131], v[68:71]
    ds_read_b128 v[204:207], v11 offset:34816
    v_mfma_f32_16x16x32_bf16 v[76:79], v[164:167], v[132:135], v[76:79]
    ds_read_b128 v[168:171], v7 offset:32768
    v_mfma_f32_16x16x32_bf16 v[72:75], v[160:163], v[132:135], v[72:75]
    ds_read_b128 v[172:175], v7 offset:34816
    v_mfma_f32_16x16x32_bf16 v[80:83], v[160:163], v[136:139], v[80:83]
    ds_read_b128 v[176:179], v7 offset:36864
    v_mfma_f32_16x16x32_bf16 v[84:87], v[164:167], v[136:139], v[84:87]
    ds_read_b128 v[180:183], v7 offset:38912
    v_mfma_f32_16x16x32_bf16 v[92:95], v[164:167], v[140:143], v[92:95]
    ds_read_b128 v[184:187], v7 offset:40960
    v_mfma_f32_16x16x32_bf16 v[88:91], v[160:163], v[140:143], v[88:91]
    ds_read_b128 v[188:191], v7 offset:43008
    v_mfma_f32_16x16x32_bf16 v[96:99], v[160:163], v[144:147], v[96:99]
    ds_read_b128 v[192:195], v7 offset:45056
    v_mfma_f32_16x16x32_bf16 v[100:103], v[164:167], v[144:147], v[100:103]
    ds_read_b128 v[196:199], v7 offset:47104
    v_mfma_f32_16x16x32_bf16 v[108:111], v[164:167], v[148:151], v[108:111]
    v_mfma_f32_16x16x32_bf16 v[104:107], v[160:163], v[148:151], v[104:107]
    v_mfma_f32_16x16x32_bf16 v[112:115], v[160:163], v[152:155], v[112:115]
    v_mfma_f32_16x16x32_bf16 v[116:119], v[164:167], v[152:155], v[116:119]
    v_mfma_f32_16x16x32_bf16 v[124:127], v[164:167], v[156:159], v[124:127]
    v_mfma_f32_16x16x32_bf16 v[120:123], v[160:163], v[156:159], v[120:123]
    s_waitcnt lgkmcnt(0)
    s_barrier
    v_mfma_f32_16x16x32_bf16 v[64:67], v[200:203], v[168:171], v[64:67]
    ds_read_b128 v[160:163], v8 offset:0
    v_mfma_f32_16x16x32_bf16 v[68:71], v[204:207], v[168:171], v[68:71]
    ds_read_b128 v[164:167], v8 offset:2048
    v_mfma_f32_16x16x32_bf16 v[76:79], v[204:207], v[172:175], v[76:79]
    ds_read_b128 v[128:131], v4 offset:0
    v_mfma_f32_16x16x32_bf16 v[72:75], v[200:203], v[172:175], v[72:75]
    ds_read_b128 v[132:135], v4 offset:2048
    v_mfma_f32_16x16x32_bf16 v[80:83], v[200:203], v[176:179], v[80:83]
    ds_read_b128 v[136:139], v4 offset:4096
    v_mfma_f32_16x16x32_bf16 v[84:87], v[204:207], v[176:179], v[84:87]
    ds_read_b128 v[140:143], v4 offset:6144
    v_mfma_f32_16x16x32_bf16 v[92:95], v[204:207], v[180:183], v[92:95]
    ds_read_b128 v[144:147], v4 offset:8192
    v_mfma_f32_16x16x32_bf16 v[88:91], v[200:203], v[180:183], v[88:91]
    ds_read_b128 v[148:151], v4 offset:10240
    v_mfma_f32_16x16x32_bf16 v[96:99], v[200:203], v[184:187], v[96:99]
    ds_read_b128 v[152:155], v4 offset:12288
    v_mfma_f32_16x16x32_bf16 v[100:103], v[204:207], v[184:187], v[100:103]
    ds_read_b128 v[156:159], v4 offset:14336
    v_mfma_f32_16x16x32_bf16 v[108:111], v[204:207], v[188:191], v[108:111]
    v_mfma_f32_16x16x32_bf16 v[104:107], v[200:203], v[188:191], v[104:107]
    v_mfma_f32_16x16x32_bf16 v[112:115], v[200:203], v[192:195], v[112:115]
    v_mfma_f32_16x16x32_bf16 v[116:119], v[204:207], v[192:195], v[116:119]
    v_mfma_f32_16x16x32_bf16 v[124:127], v[204:207], v[196:199], v[124:127]
    v_mfma_f32_16x16x32_bf16 v[120:123], v[200:203], v[196:199], v[120:123]
    s_cmp_eq_u32 s34, 13
    s_waitcnt lgkmcnt(0)
    s_cbranch_scc1 C_x13
C_x13_r:
    s_waitcnt vmcnt(0)
    v_cmp_eq_u32 vcc, v244, v54
    v_cmp_eq_u32 s[54:55], v245, v55
    s_mov_b32 m0, s23
    s_and_b64 s[54:55], s[54:55], vcc
    s_cmp_eq_u64 s[54:55], -1
    s_cbranch_scc0 C_kvp
C_kvp_r:
    buffer_load_dwordx4 v247, s[68:71], s22 offen offset:0 sc1 lds
    buffer_load_dwordx4 v247, s[68:71], s22 offen offset:1024 sc1 lds
    buffer_load_dwordx4 v247, s[68:71], s22 offen offset:2048 sc1 lds
    buffer_load_dwordx4 v247, s[68:71], s22 offen offset:3072 sc1 lds
    v_mfma_f32_16x16x32_bf16 v[64:67], v[160:163], v[128:131], v[64:67]
    ds_read_b128 v[200:203], v10 offset:0
    v_mfma_f32_16x16x32_bf16 v[68:71], v[164:167], v[128:131], v[68:71]
    ds_read_b128 v[204:207], v10 offset:2048
    v_mfma_f32_16x16x32_bf16 v[76:79], v[164:167], v[132:135], v[76:79]
    ds_read_b128 v[168:171], v6 offset:0
    v_mfma_f32_16x16x32_bf16 v[72:75], v[160:163], v[132:135], v[72:75]
    ds_read_b128 v[172:175], v6 offset:2048
    v_mfma_f32_16x16x32_bf16 v[80:83], v[160:163], v[136:139], v[80:83]
    ds_read_b128 v[176:179], v6 offset:4096
    v_mfma_f32_16x16x32_bf16 v[84:87], v[164:167], v[136:139], v[84:87]
    ds_read_b128 v[180:183], v6 offset:6144
    v_mfma_f32_16x16x32_bf16 v[92:95], v[164:167], v[140:143], v[92:95]
    ds_read_b128 v[184:187], v6 offset:8192
    v_mfma_f32_16x16x32_bf16 v[88:91], v[160:163], v[140:143], v[88:91]
    ds_read_b128 v[188:191], v6 offset:10240
    v_mfma_f32_16x16x32_bf16 v[96:99], v[160:163], v[144:147], v[96:99]
    ds_read_b128 v[192:195], v6 offset:12288
    v_mfma_f32_16x16x32_bf16 v[100:103], v[164:167], v[144:147], v[100:103]
    ds_read_b128 v[196:199], v6 offset:14336
    v_mfma_f32_16x16x32_bf16 v[108:111], v[164:167], v[148:151], v[108:111]
    v_mfma_f32_16x16x32_bf16 v[104:107], v[160:163], v[148:151], v[104:107]
    v_mfma_f32_16x16x32_bf16 v[112:115], v[160:163], v[152:155], v[112:115]
    v_mfma_f32_16x16x32_bf16 v[116:119], v[164:167], v[152:155], v[116:119]
    v_mfma_f32_16x16x32_bf16 v[124:127], v[164:167], v[156:159], v[124:127]
    v_mfma_f32_16x16x32_bf16 v[120:123], v[160:163], v[156:159], v[120:123]
    s_waitcnt lgkmcnt(0)
    s_barrier
    v_mfma_f32_16x16x32_bf16 v[64:67], v[200:203], v[168:171], v[64:67]
    ds_read_b128 v[160:163], v8 offset:32768
    v_mfma_f32_16x16x32_bf16 v[68:71], v[204:207], v[168:171], v[68:71]
    ds_read_b128 v[164:167], v8 offset:34816
    v_mfma_f32_16x16x32_bf16 v[76:79], v[204:207], v[172:175], v[76:79]
    ds_read_b128 v[128:131], v4 offset:32768
    v_mfma_f32_16x16x32_bf16 v[72:75], v[200:203], v[172:175], v[72:75]
    ds_read_b128 v[132:135], v4 offset:34816
    v_mfma_f32_16x16x32_bf16 v[80:83], v[200:203], v[176:179], v[80:83]
    ds_read_b128 v[136:139], v4 offset:36864
    v_mfma_f32_16x16x32_bf16 v[84:87], v[204:207], v[176:179], v[84:87]
    ds_read_b128 v[140:143], v4 offset:38912
    v_mfma_f32_16x16x32_bf16 v[92:95], v[204:207], v[180:183], v[92:95]
    ds_read_b128 v[144:147], v4 offset:40960
    v_mfma_f32_16x16x32_bf16 v[88:91], v[200:203], v[180:183], v[88:91]
    ds_read_b128 v[148:151], v4 offset:43008
    v_mfma_f32_16x16x32_bf16 v[96:99], v[200:203], v[184:187], v[96:99]
    ds_read_b128 v[152:155], v4 offset:45056
    v_mfma_f32_16x16x32_bf16 v[100:103], v[204:207], v[184:187], v[100:103]
    ds_read_b128 v[156:159], v4 offset:47104
    v_mfma_f32_16x16x32_bf16 v[108:111], v[204:207], v[188:191], v[108:111]
    v_mfma_f32_16x16x32_bf16 v[104:107], v[200:203], v[188:191], v[104:107]
    v_mfma_f32_16x16x32_bf16 v[112:115], v[200:203], v[192:195], v[112:115]
    v_mfma_f32_16x16x32_bf16 v[116:119], v[204:207], v[192:195], v[116:119]
    v_mfma_f32_16x16x32_bf16 v[124:127], v[204:207], v[196:199], v[124:127]
    v_mfma_f32_16x16x32_bf16 v[120:123], v[200:203], v[196:199], v[120:123]
    s_cmp_eq_u32 s34, 14
    s_waitcnt lgkmcnt(0)
    s_cbranch_scc1 C_x14
C_x14_r:
    v_mfma_f32_16x16x32_bf16 v[64:67], v[160:163], v[128:131], v[64:67]
    ds_read_b128 v[200:203], v10 offset:32768
    v_mfma_f32_16x16x32_bf16 v[68:71], v[164:167], v[128:131], v[68:71]
    ds_read_b128 v[204:207], v10 offset:34816
    v_mfma_f32_16x16x32_bf16 v[76:79], v[164:167], v[132:135], v[76:79]
    ds_read_b128 v[168:171], v6 offset:32768
    v_mfma_f32_16x16x32_bf16 v[72:75], v[160:163], v[132:135], v[72:75]
    ds_read_b128 v[172:175], v6 offset:34816
    v_mfma_f32_16x16x32_bf16 v[80:83], v[160:163], v[136:139], v[80:83]
    ds_read_b128 v[176:179], v6 offset:36864
    v_mfma_f32_16x16x32_bf16 v[84:87], v[164:167], v[136:139], v[84:87]
    ds_read_b128 v[180:183], v6 offset:38912
    v_mfma_f32_16x16x32_bf16 v[92:95], v[164:167], v[140:143], v[92:95]
    ds_read_b128 v[184:187], v6 offset:40960
    v_mfma_f32_16x16x32_bf16 v[88:91], v[160:163], v[140:143], v[88:91]
    ds_read_b128 v[188:191], v6 offset:43008
    v_mfma_f32_16x16x32_bf16 v[96:99], v[160:163], v[144:147], v[96:99]
    ds_read_b128 v[192:195], v6 offset:45056
    v_mfma_f32_16x16x32_bf16 v[100:103], v[164:167], v[144:147], v[100:103]
    ds_read_b128 v[196:199], v6 offset:47104
    v_mfma_f32_16x16x32_bf16 v[108:111], v[164:167], v[148:151], v[108:111]
    v_mfma_f32_16x16x32_bf16 v[104:107], v[160:163], v[148:151], v[104:107]
    v_mfma_f32_16x16x32_bf16 v[112:115], v[160:163], v[152:155], v[112:115]
    v_mfma_f32_16x16x32_bf16 v[116:119], v[164:167], v[152:155], v[116:119]
    v_mfma_f32_16x16x32_bf16 v[124:127], v[164:167], v[156:159], v[124:127]
    v_mfma_f32_16x16x32_bf16 v[120:123], v[160:163], v[156:159], v[120:123]
    s_waitcnt lgkmcnt(0)
    s_barrier
    v_mfma_f32_16x16x32_bf16 v[64:67], v[200:203], v[168:171], v[64:67]
    ds_read_b128 v[160:163], v9 offset:0
    v_mfma_f32_16x16x32_bf16 v[68:71], v[204:207], v[168:171], v[68:71]
    ds_read_b128 v[164:167], v9 offset:2048
    v_mfma_f32_16x16x32_bf16 v[76:79], v[204:207], v[172:175], v[76:79]
    ds_read_b128 v[128:131], v5 offset:0
    v_mfma_f32_16x16x32_bf16 v[72:75], v[200:203], v[172:175], v[72:75]
    ds_read_b128 v[132:135], v5 offset:2048
    v_mfma_f32_16x16x32_bf16 v[80:83], v[200:203], v[176:179], v[80:83]
    ds_read_b128 v[136:139], v5 offset:4096
    v_mfma_f32_16x16x32_bf16 v[84:87], v[204:207], v[176:179], v[84:87]
    ds_read_b128 v[140:143], v5 offset:6144
    v_mfma_f32_16x16x32_bf16 v[92:95], v[204:207], v[180:183], v[92:95]
    ds_read_b128 v[144:147], v5 offset:8192
    v_mfma_f32_16x16x32_bf16 v[88:91], v[200:203], v[180:183], v[88:91]
    ds_read_b128 v[148:151], v5 offset:10240
    v_mfma_f32_16x16x32_bf16 v[96:99], v[200:203], v[184:187], v[96:99]
    ds_read_b128 v[152:155], v5 offset:12288
    v_mfma_f32_16x16x32_bf16 v[100:103], v[204:207], v[184:187], v[100:103]
    ds_read_b128 v[156:159], v5 offset:14336
    v_mfma_f32_16x16x32_bf16 v[108:111], v[204:207], v[188:191], v[108:111]
    v_mfma_f32_16x16x32_bf16 v[104:107], v[200:203], v[188:191], v[104:107]
    v_mfma_f32_16x16x32_bf16 v[112:115], v[200:203], v[192:195], v[112:115]
    v_mfma_f32_16x16x32_bf16 v[116:119], v[204:207], v[192:195], v[116:119]
    v_mfma_f32_16x16x32_bf16 v[124:127], v[204:207], v[196:199], v[124:127]
    v_mfma_f32_16x16x32_bf16 v[120:123], v[200:203], v[196:199], v[120:123]
    s_cmp_eq_u32 s34, 15
    s_waitcnt lgkmcnt(0)
    s_cbranch_scc1 C_x15
C_x15_r:
    v_mfma_f32_16x16x32_bf16 v[64:67], v[160:163], v[128:131], v[64:67]
    ds_read_b128 v[200:203], v11 offset:0
    v_mfma_f32_16x16x32_bf16 v[68:71], v[164:167], v[128:131], v[68:71]
    ds_read_b128 v[204:207], v11 offset:2048
    v_mfma_f32_16x16x32_bf16 v[76:79], v[164:167], v[132:135], v[76:79]
    ds_read_b128 v[168:171], v7 offset:0
    v_mfma_f32_16x16x32_bf16 v[72:75], v[160:163], v[132:135], v[72:75]
    ds_read_b128 v[172:175], v7 offset:2048
    v_mfma_f32_16x16x32_bf16 v[80:83], v[160:163], v[136:139], v[80:83]
    ds_read_b128 v[176:179], v7 offset:4096
    v_mfma_f32_16x16x32_bf16 v[84:87], v[164:167], v[136:139], v[84:87]
    ds_read_b128 v[180:183], v7 offset:6144
    v_mfma_f32_16x16x32_bf16 v[92:95], v[164:167], v[140:143], v[92:95]
    ds_read_b128 v[184:187], v7 offset:8192
    v_mfma_f32_16x16x32_bf16 v[88:91], v[160:163], v[140:143], v[88:91]
    ds_read_b128 v[188:191], v7 offset:10240
    v_mfma_f32_16x16x32_bf16 v[96:99], v[160:163], v[144:147], v[96:99]
    ds_read_b128 v[192:195], v7 offset:12288
    v_mfma_f32_16x16x32_bf16 v[100:103], v[164:167], v[144:147], v[100:103]
    ds_read_b128 v[196:199], v7 offset:14336
    v_mfma_f32_16x16x32_bf16 v[108:111], v[164:167], v[148:151], v[108:111]
    v_mfma_f32_16x16x32_bf16 v[104:107], v[160:163], v[148:151], v[104:107]
    v_mfma_f32_16x16x32_bf16 v[112:115], v[160:163], v[152:155], v[112:115]
    v_mfma_f32_16x16x32_bf16 v[116:119], v[164:167], v[152:155], v[116:119]
    v_mfma_f32_16x16x32_bf16 v[124:127], v[164:167], v[156:159], v[124:127]
    v_mfma_f32_16x16x32_bf16 v[120:123], v[160:163], v[156:159], v[120:123]
    s_waitcnt vmcnt(0)
    s_waitcnt lgkmcnt(0)
    v_mov_b32 v3, 1
    v_mov_b32 v15, 2
    ds_write_b32 v63, v3 offset:64
    ds_write_b32 v63, v54 offset:16
    v_mfma_f32_16x16x32_bf16 v[64:67], v[200:203], v[168:171], v[64:67]
    v_mfma_f32_16x16x32_bf16 v[68:71], v[204:207], v[168:171], v[68:71]
    v_mfma_f32_16x16x32_bf16 v[76:79], v[204:207], v[172:175], v[76:79]
    v_mfma_f32_16x16x32_bf16 v[72:75], v[200:203], v[172:175], v[72:75]
    v_mfma_f32_16x16x32_bf16 v[80:83], v[200:203], v[176:179], v[80:83]
    v_mfma_f32_16x16x32_bf16 v[84:87], v[204:207], v[176:179], v[84:87]
    v_mfma_f32_16x16x32_bf16 v[92:95], v[204:207], v[180:183], v[92:95]
    v_mfma_f32_16x16x32_bf16 v[88:91], v[200:203], v[180:183], v[88:91]
    v_mfma_f32_16x16x32_bf16 v[96:99], v[200:203], v[184:187], v[96:99]
    v_mfma_f32_16x16x32_bf16 v[100:103], v[204:207], v[184:187], v[100:103]
    v_mfma_f32_16x16x32_bf16 v[108:111], v[204:207], v[188:191], v[108:111]
    v_mfma_f32_16x16x32_bf16 v[104:107], v[200:203], v[188:191], v[104:107]
    v_mfma_f32_16x16x32_bf16 v[112:115], v[200:203], v[192:195], v[112:115]
    v_mfma_f32_16x16x32_bf16 v[116:119], v[204:207], v[192:195], v[116:119]
    v_mfma_f32_16x16x32_bf16 v[124:127], v[204:207], v[196:199], v[124:127]
    v_mfma_f32_16x16x32_bf16 v[120:123], v[200:203], v[196:199], v[120:123]
    s_nop 3
    v_pk_fma_f32 v[136:137], v[16:17], v[64:65], v[72:73]
    v_pk_fma_f32 v[140:141], v[16:17], v[68:69], v[76:77]
    v_pk_fma_f32 v[138:139], v[18:19], v[66:67], v[74:75]
    v_pk_fma_f32 v[142:143], v[18:19], v[70:71], v[78:79]
    v_pk_fma_f32 v[136:137], v[20:21], v[68:69], v[136:137] neg_lo:[1,0,0] neg_hi:[1,0,0]
    v_pk_fma_f32 v[140:141], v[20:21], v[64:65], v[140:141]
    v_pk_fma_f32 v[138:139], v[22:23], v[70:71], v[138:139] neg_lo:[1,0,0] neg_hi:[1,0,0]
    v_pk_fma_f32 v[142:143], v[22:23], v[66:67], v[142:143]
    v_pk_fma_f32 v[128:129], v[16:17], v[136:137], v[80:81]
    v_pk_fma_f32 v[132:133], v[16:17], v[140:141], v[84:85]
    v_pk_fma_f32 v[130:131], v[18:19], v[138:139], v[82:83]
    v_pk_fma_f32 v[134:135], v[18:19], v[142:143], v[86:87]
    v_pk_fma_f32 v[128:129], v[20:21], v[140:141], v[128:129] neg_lo:[1,0,0] neg_hi:[1,0,0]
    v_pk_fma_f32 v[132:133], v[20:21], v[136:137], v[132:133]
    v_pk_fma_f32 v[130:131], v[22:23], v[142:143], v[130:131] neg_lo:[1,0,0] neg_hi:[1,0,0]
    v_pk_fma_f32 v[134:135], v[22:23], v[138:139], v[134:135]
    v_pk_fma_f32 v[136:137], v[16:17], v[128:129], v[88:89]
    v_pk_fma_f32 v[140:141], v[16:17], v[132:133], v[92:93]
    v_pk_fma_f32 v[138:139], v[18:19], v[130:131], v[90:91]
    v_pk_fma_f32 v[142:143], v[18:19], v[134:135], v[94:95]
    v_pk_fma_f32 v[136:137], v[20:21], v[132:133], v[136:137] neg_lo:[1,0,0] neg_hi:[1,0,0]
    v_pk_fma_f32 v[140:141], v[20:21], v[128:129], v[140:141]
    v_pk_fma_f32 v[138:139], v[22:23], v[134:135], v[138:139] neg_lo:[1,0,0] neg_hi:[1,0,0]
    v_pk_fma_f32 v[142:143], v[22:23], v[130:131], v[142:143]
    v_pk_fma_f32 v[128:129], v[16:17], v[136:137], v[96:97]
    v_pk_fma_f32 v[132:133], v[16:17], v[140:141], v[100:101]
    v_pk_fma_f32 v[130:131], v[18:19], v[138:139], v[98:99]
    v_pk_fma_f32 v[134:135], v[18:19], v[142:143], v[102:103]
    v_pk_fma_f32 v[128:129], v[20:21], v[140:141], v[128:129] neg_lo:[1,0,0] neg_hi:[1,0,0]
    v_pk_fma_f32 v[132:133], v[20:21], v[136:137], v[132:133]
    v_pk_fma_f32 v[130:131], v[22:23], v[142:143], v[130:131] neg_lo:[1,0,0] neg_hi:[1,0,0]
    v_pk_fma_f32 v[134:135], v[22:23], v[138:139], v[134:135]
    v_pk_fma_f32 v[136:137], v[16:17], v[128:129], v[104:105]
    v_pk_fma_f32 v[140:141], v[16:17], v[132:133], v[108:109]
    v_pk_fma_f32 v[138:139], v[18:19], v[130:131], v[106:107]
    v_pk_fma_f32 v[142:143], v[18:19], v[134:135], v[110:111]
    v_pk_fma_f32 v[136:137], v[20:21], v[132:133], v[136:137] neg_lo:[1,0,0] neg_hi:[1,0,0]
    v_pk_fma_f32 v[140:141], v[20:21], v[128:129], v[140:141]
    v_pk_fma_f32 v[138:139], v[22:23], v[134:135], v[138:139] neg_lo:[1,0,0] neg_hi:[1,0,0]
    v_pk_fma_f32 v[142:143], v[22:23], v[130:131], v[142:143]
    v_pk_fma_f32 v[128:129], v[16:17], v[136:137], v[112:113]
    v_pk_fma_f32 v[132:133], v[16:17], v[140:141], v[116:117]
    v_pk_fma_f32 v[130:131], v[18:19], v[138:139], v[114:115]
    v_pk_fma_f32 v[134:135], v[18:19], v[142:143], v[118:119]
    v_pk_fma_f32 v[128:129], v[20:21], v[140:141], v[128:129] neg_lo:[1,0,0] neg_hi:[1,0,0]
    v_pk_fma_f32 v[132:133], v[20:21], v[136:137], v[132:133]
    v_pk_fma_f32 v[130:131], v[22:23], v[142:143], v[130:131] neg_lo:[1,0,0] neg_hi:[1,0,0]
    v_pk_fma_f32 v[134:135], v[22:23], v[138:139], v[134:135]
    v_pk_fma_f32 v[136:137], v[16:17], v[128:129], v[120:121]
    v_pk_fma_f32 v[140:141], v[16:17], v[132:133], v[124:125]
    v_pk_fma_f32 v[138:139], v[18:19], v[130:131], v[122:123]
    v_pk_fma_f32 v[142:143], v[18:19], v[134:135], v[126:127]
    v_pk_fma_f32 v[136:137], v[20:21], v[132:133], v[136:137] neg_lo:[1,0,0] neg_hi:[1,0,0]
    v_pk_fma_f32 v[140:141], v[20:21], v[128:129], v[140:141]
    v_pk_fma_f32 v[138:139], v[22:23], v[134:135], v[138:139] neg_lo:[1,0,0] neg_hi:[1,0,0]
    v_pk_fma_f32 v[142:143], v[22:23], v[130:131], v[142:143]
    v_mul_f32_dpp v144, v32, v136 row_mirror row_mask:0xf bank_mask:0xf
    v_mul_f32_dpp v148, v32, v140 row_mirror row_mask:0xf bank_mask:0xf
    v_mul_f32_dpp v145, v33, v137 row_mirror row_mask:0xf bank_mask:0xf
    v_mul_f32_dpp v149, v33, v141 row_mirror row_mask:0xf bank_mask:0xf
    v_mul_f32_dpp v146, v34, v138 row_mirror row_mask:0xf bank_mask:0xf
    v_mul_f32_dpp v150, v34, v142 row_mirror row_mask:0xf bank_mask:0xf
    v_mul_f32_dpp v147, v35, v139 row_mirror row_mask:0xf bank_mask:0xf
    v_mul_f32_dpp v151, v35, v143 row_mirror row_mask:0xf bank_mask:0xf
    v_fmac_f32_dpp v144, -v36, v140 row_mirror row_mask:0xf bank_mask:0xf
    v_fmac_f32_dpp v148, v36, v136 row_mirror row_mask:0xf bank_mask:0xf
    v_fmac_f32_dpp v145, -v37, v141 row_mirror row_mask:0xf bank_mask:0xf
    v_fmac_f32_dpp v149, v37, v137 row_mirror row_mask:0xf bank_mask:0xf
    v_fmac_f32_dpp v146, -v38, v142 row_mirror row_mask:0xf bank_mask:0xf
    v_fmac_f32_dpp v150, v38, v138 row_mirror row_mask:0xf bank_mask:0xf
    v_fmac_f32_dpp v147, -v39, v143 row_mirror row_mask:0xf bank_mask:0xf
    v_fmac_f32_dpp v151, v39, v139 row_mirror row_mask:0xf bank_mask:0xf
    v_add_f32_dpp v144, v144, v144 quad_perm:[1,0,3,2] row_mask:0xf bank_mask:0xf
    v_add_f32_dpp v148, v148, v148 quad_perm:[1,0,3,2] row_mask:0xf bank_mask:0xf
    v_add_f32_dpp v145, v145, v145 quad_perm:[1,0,3,2] row_mask:0xf bank_mask:0xf
    v_add_f32_dpp v149, v149, v149 quad_perm:[1,0,3,2] row_mask:0xf bank_mask:0xf
    v_add_f32_dpp v146, v146, v146 quad_perm:[1,0,3,2] row_mask:0xf bank_mask:0xf
    v_add_f32_dpp v150, v150, v150 quad_perm:[1,0,3,2] row_mask:0xf bank_mask:0xf
    v_add_f32_dpp v147, v147, v147 quad_perm:[1,0,3,2] row_mask:0xf bank_mask:0xf
    v_add_f32_dpp v151, v151, v151 quad_perm:[1,0,3,2] row_mask:0xf bank_mask:0xf
    v_cndmask_b32 v44, v144, v145, s[48:49]
    v_cndmask_b32 v45, v146, v147, s[48:49]
    v_cndmask_b32 v46, v148, v149, s[48:49]
    v_cndmask_b32 v47, v150, v151, s[48:49]
    s_nop 0
    v_add_f32_dpp v44, v44, v44 quad_perm:[2,3,0,1] row_mask:0xf bank_mask:0xf
    v_add_f32_dpp v45, v45, v45 quad_perm:[2,3,0,1] row_mask:0xf bank_mask:0xf
    v_add_f32_dpp v46, v46, v46 quad_perm:[2,3,0,1] row_mask:0xf bank_mask:0xf
    v_add_f32_dpp v47, v47, v47 quad_perm:[2,3,0,1] row_mask:0xf bank_mask:0xf
    v_cndmask_b32 v52, v44, v45, s[50:51]
    v_cndmask_b32 v53, v46, v47, s[50:51]
    s_nop 0
    v_add_f32_dpp v52, v52, v52 row_ror:4 row_mask:0xf bank_mask:0xf
    v_add_f32_dpp v53, v53, v53 row_ror:4 row_mask:0xf bank_mask:0xf
    s_nop 0
    v_add_f32_dpp v52, v52, v52 row_ror:8 row_mask:0xf bank_mask:0xf
    v_add_f32_dpp v53, v53, v53 row_ror:8 row_mask:0xf bank_mask:0xf
    s_mov_b64 exec, s[52:53]
    buffer_store_dwordx4 v[52:55], v60, s[12:15], 0 offen sc1
    s_mov_b64 exec, -1
    ds_write_b32 v63, v15 offset:64
    s_and_b32 s7, s3, 0
    s_add_u32 s7, s7, s4
    s_and_b32 s36, s7, 15
    v_lshrrev_b32 v1, 3, v2
    v_and_b32 v44, 7, v2
    v_xor_b32 v44, v44, v13
    v_lshlrev_b32 v44, 4, v44
    v_lshl_add_u32 v44, v1, 13, v44
    s_lshl_b32 s7, s4, 6
    s_add_u32 s7, s7, s5
    s_lshl_b32 s7, s7, 11
    v_add_u32 v244, s7, v44
    v_xor_b32 v245, 64, v244
    v_add_u32 v245, 64512, v245
    v_xor_b32 v246, 32, v244
    v_xor_b32 v247, 32, v245
    s_lshl_b32 s20, s36, 7
    s_and_b32 s22, s20, 1024
    s_xor_b32 s23, s22, 1024
    s_lshl_b32 s21, s5, 11
    s_add_u32 s7, s20, 768
    s_and_b32 s7, s7, 1023
    s_or_b32 s7, s7, s22
    buffer_load_dwordx4 v[160:163], v244, s[24:27], s7 offen offset:0
    buffer_load_dwordx4 v[164:167], v245, s[24:27], s7 offen offset:1024
    buffer_load_dwordx4 v[168:171], v246, s[80:83], s7 offen offset:0
    buffer_load_dwordx4 v[172:175], v247, s[80:83], s7 offen offset:1024
    s_add_u32 s7, s20, 896
    s_and_b32 s7, s7, 1023
    s_or_b32 s7, s7, s22
    buffer_load_dwordx4 v[176:179], v244, s[24:27], s7 offen offset:0
    buffer_load_dwordx4 v[180:183], v245, s[24:27], s7 offen offset:1024
    buffer_load_dwordx4 v[184:187], v246, s[80:83], s7 offen offset:0
    buffer_load_dwordx4 v[188:191], v247, s[80:83], s7 offen offset:1024
    s_add_u32 s7, s20, 1024
    s_and_b32 s7, s7, 1023
    s_or_b32 s7, s7, s23
    buffer_load_dwordx4 v[192:195], v244, s[24:27], s7 offen offset:0
    buffer_load_dwordx4 v[196:199], v245, s[24:27], s7 offen offset:1024
    buffer_load_dwordx4 v[200:203], v246, s[80:83], s7 offen offset:0
    buffer_load_dwordx4 v[204:207], v247, s[80:83], s7 offen offset:1024
    s_add_u32 s7, s20, 1152
    s_and_b32 s7, s7, 1023
    s_or_b32 s7, s7, s23
    buffer_load_dwordx4 v[224:227], v244, s[24:27], s7 offen offset:0
    buffer_load_dwordx4 v[228:231], v245, s[24:27], s7 offen offset:1024
    buffer_load_dwordx4 v[232:235], v246, s[80:83], s7 offen offset:0
    buffer_load_dwordx4 v[236:239], v247, s[80:83], s7 offen offset:1024
    v_mov_b32_dpp v128, v136 row_shr:1 row_mask:0xf bank_mask:0xf bound_ctrl:0
    v_mov_b32_dpp v129, v137 row_shr:1 row_mask:0xf bank_mask:0xf bound_ctrl:0
    v_mov_b32_dpp v130, v138 row_shr:1 row_mask:0xf bank_mask:0xf bound_ctrl:0
    v_mov_b32_dpp v131, v139 row_shr:1 row_mask:0xf bank_mask:0xf bound_ctrl:0
    v_mov_b32_dpp v132, v140 row_shr:1 row_mask:0xf bank_mask:0xf bound_ctrl:0
    v_mov_b32_dpp v133, v141 row_shr:1 row_mask:0xf bank_mask:0xf bound_ctrl:0
    v_mov_b32_dpp v134, v142 row_shr:1 row_mask:0xf bank_mask:0xf bound_ctrl:0
    v_mov_b32_dpp v135, v143 row_shr:1 row_mask:0xf bank_mask:0xf bound_ctrl:0
    s_nop 0
    v_mov_b32_dpp v144, v128 row_shr:1 row_mask:0xf bank_mask:0xf bound_ctrl:0
    v_mov_b32_dpp v145, v129 row_shr:1 row_mask:0xf bank_mask:0xf bound_ctrl:0
    v_mov_b32_dpp v146, v130 row_shr:1 row_mask:0xf bank_mask:0xf bound_ctrl:0
    v_mov_b32_dpp v147, v131 row_shr:1 row_mask:0xf bank_mask:0xf bound_ctrl:0
    v_mov_b32_dpp v148, v132 row_shr:1 row_mask:0xf bank_mask:0xf bound_ctrl:0
    v_mov_b32_dpp v149, v133 row_shr:1 row_mask:0xf bank_mask:0xf bound_ctrl:0
    v_mov_b32_dpp v150, v134 row_shr:1 row_mask:0xf bank_mask:0xf bound_ctrl:0
    v_mov_b32_dpp v151, v135 row_shr:1 row_mask:0xf bank_mask:0xf bound_ctrl:0
    v_fmac_f32_dpp v128, v32, v144 row_newbcast:1 row_mask:0xf bank_mask:0xf
    v_fmac_f32_dpp v129, v33, v145 row_newbcast:1 row_mask:0xf bank_mask:0xf
    v_fmac_f32_dpp v130, v34, v146 row_newbcast:1 row_mask:0xf bank_mask:0xf
    v_fmac_f32_dpp v131, v35, v147 row_newbcast:1 row_mask:0xf bank_mask:0xf
    v_fmac_f32_dpp v132, v32, v148 row_newbcast:1 row_mask:0xf bank_mask:0xf
    v_fmac_f32_dpp v133, v33, v149 row_newbcast:1 row_mask:0xf bank_mask:0xf
    v_fmac_f32_dpp v134, v34, v150 row_newbcast:1 row_mask:0xf bank_mask:0xf
    v_fmac_f32_dpp v135, v35, v151 row_newbcast:1 row_mask:0xf bank_mask:0xf
    v_fmac_f32_dpp v128, -v36, v148 row_newbcast:1 row_mask:0xf bank_mask:0xf
    v_fmac_f32_dpp v129, -v37, v149 row_newbcast:1 row_mask:0xf bank_mask:0xf
    v_fmac_f32_dpp v130, -v38, v150 row_newbcast:1 row_mask:0xf bank_mask:0xf
    v_fmac_f32_dpp v131, -v39, v151 row_newbcast:1 row_mask:0xf bank_mask:0xf
    v_fmac_f32_dpp v132, v36, v144 row_newbcast:1 row_mask:0xf bank_mask:0xf
    v_fmac_f32_dpp v133, v37, v145 row_newbcast:1 row_mask:0xf bank_mask:0xf
    v_fmac_f32_dpp v134, v38, v146 row_newbcast:1 row_mask:0xf bank_mask:0xf
    v_fmac_f32_dpp v135, v39, v147 row_newbcast:1 row_mask:0xf bank_mask:0xf
    v_mov_b32_dpp v144, v128 row_shr:2 row_mask:0xf bank_mask:0xf bound_ctrl:0
    v_mov_b32_dpp v145, v129 row_shr:2 row_mask:0xf bank_mask:0xf bound_ctrl:0
    v_mov_b32_dpp v146, v130 row_shr:2 row_mask:0xf bank_mask:0xf bound_ctrl:0
    v_mov_b32_dpp v147, v131 row_shr:2 row_mask:0xf bank_mask:0xf bound_ctrl:0
    v_mov_b32_dpp v148, v132 row_shr:2 row_mask:0xf bank_mask:0xf bound_ctrl:0
    v_mov_b32_dpp v149, v133 row_shr:2 row_mask:0xf bank_mask:0xf bound_ctrl:0
    v_mov_b32_dpp v150, v134 row_shr:2 row_mask:0xf bank_mask:0xf bound_ctrl:0
    v_mov_b32_dpp v151, v135 row_shr:2 row_mask:0xf bank_mask:0xf bound_ctrl:0
    v_fmac_f32_dpp v128, v32, v144 row_newbcast:2 row_mask:0xf bank_mask:0xf
    v_fmac_f32_dpp v129, v33, v145 row_newbcast:2 row_mask:0xf bank_mask:0xf
    v_fmac_f32_dpp v130, v34, v146 row_newbcast:2 row_mask:0xf bank_mask:0xf
    v_fmac_f32_dpp v131, v35, v147 row_newbcast:2 row_mask:0xf bank_mask:0xf
    v_fmac_f32_dpp v132, v32, v148 row_newbcast:2 row_mask:0xf bank_mask:0xf
    v_fmac_f32_dpp v133, v33, v149 row_newbcast:2 row_mask:0xf bank_mask:0xf
    v_fmac_f32_dpp v134, v34, v150 row_newbcast:2 row_mask:0xf bank_mask:0xf
    v_fmac_f32_dpp v135, v35, v151 row_newbcast:2 row_mask:0xf bank_mask:0xf
    v_fmac_f32_dpp v128, -v36, v148 row_newbcast:2 row_mask:0xf bank_mask:0xf
    v_fmac_f32_dpp v129, -v37, v149 row_newbcast:2 row_mask:0xf bank_mask:0xf
    v_fmac_f32_dpp v130, -v38, v150 row_newbcast:2 row_mask:0xf bank_mask:0xf
    v_fmac_f32_dpp v131, -v39, v151 row_newbcast:2 row_mask:0xf bank_mask:0xf
    v_fmac_f32_dpp v132, v36, v144 row_newbcast:2 row_mask:0xf bank_mask:0xf
    v_fmac_f32_dpp v133, v37, v145 row_newbcast:2 row_mask:0xf bank_mask:0xf
    v_fmac_f32_dpp v134, v38, v146 row_newbcast:2 row_mask:0xf bank_mask:0xf
    v_fmac_f32_dpp v135, v39, v147 row_newbcast:2 row_mask:0xf bank_mask:0xf
    v_mov_b32_dpp v144, v128 row_shr:4 row_mask:0xf bank_mask:0xf bound_ctrl:0
    v_mov_b32_dpp v145, v129 row_shr:4 row_mask:0xf bank_mask:0xf bound_ctrl:0
    v_mov_b32_dpp v146, v130 row_shr:4 row_mask:0xf bank_mask:0xf bound_ctrl:0
    v_mov_b32_dpp v147, v131 row_shr:4 row_mask:0xf bank_mask:0xf bound_ctrl:0
    v_mov_b32_dpp v148, v132 row_shr:4 row_mask:0xf bank_mask:0xf bound_ctrl:0
    v_mov_b32_dpp v149, v133 row_shr:4 row_mask:0xf bank_mask:0xf bound_ctrl:0
    v_mov_b32_dpp v150, v134 row_shr:4 row_mask:0xf bank_mask:0xf bound_ctrl:0
    v_mov_b32_dpp v151, v135 row_shr:4 row_mask:0xf bank_mask:0xf bound_ctrl:0
    v_fmac_f32_dpp v128, v32, v144 row_newbcast:4 row_mask:0xf bank_mask:0xf
    v_fmac_f32_dpp v129, v33, v145 row_newbcast:4 row_mask:0xf bank_mask:0xf
    v_fmac_f32_dpp v130, v34, v146 row_newbcast:4 row_mask:0xf bank_mask:0xf
    v_fmac_f32_dpp v131, v35, v147 row_newbcast:4 row_mask:0xf bank_mask:0xf
    v_fmac_f32_dpp v132, v32, v148 row_newbcast:4 row_mask:0xf bank_mask:0xf
    v_fmac_f32_dpp v133, v33, v149 row_newbcast:4 row_mask:0xf bank_mask:0xf
    v_fmac_f32_dpp v134, v34, v150 row_newbcast:4 row_mask:0xf bank_mask:0xf
    v_fmac_f32_dpp v135, v35, v151 row_newbcast:4 row_mask:0xf bank_mask:0xf
    v_fmac_f32_dpp v128, -v36, v148 row_newbcast:4 row_mask:0xf bank_mask:0xf
    v_fmac_f32_dpp v129, -v37, v149 row_newbcast:4 row_mask:0xf bank_mask:0xf
    v_fmac_f32_dpp v130, -v38, v150 row_newbcast:4 row_mask:0xf bank_mask:0xf
    v_fmac_f32_dpp v131, -v39, v151 row_newbcast:4 row_mask:0xf bank_mask:0xf
    v_fmac_f32_dpp v132, v36, v144 row_newbcast:4 row_mask:0xf bank_mask:0xf
    v_fmac_f32_dpp v133, v37, v145 row_newbcast:4 row_mask:0xf bank_mask:0xf
    v_fmac_f32_dpp v134, v38, v146 row_newbcast:4 row_mask:0xf bank_mask:0xf
    v_fmac_f32_dpp v135, v39, v147 row_newbcast:4 row_mask:0xf bank_mask:0xf
    v_mov_b32_dpp v144, v128 row_shr:8 row_mask:0xf bank_mask:0xf bound_ctrl:0
    v_mov_b32_dpp v145, v129 row_shr:8 row_mask:0xf bank_mask:0xf bound_ctrl:0
    v_mov_b32_dpp v146, v130 row_shr:8 row_mask:0xf bank_mask:0xf bound_ctrl:0
    v_mov_b32_dpp v147, v131 row_shr:8 row_mask:0xf bank_mask:0xf bound_ctrl:0
    v_mov_b32_dpp v148, v132 row_shr:8 row_mask:0xf bank_mask:0xf bound_ctrl:0
    v_mov_b32_dpp v149, v133 row_shr:8 row_mask:0xf bank_mask:0xf bound_ctrl:0
    v_mov_b32_dpp v150, v134 row_shr:8 row_mask:0xf bank_mask:0xf bound_ctrl:0
    v_mov_b32_dpp v151, v135 row_shr:8 row_mask:0xf bank_mask:0xf bound_ctrl:0
    v_fmac_f32_dpp v128, v32, v144 row_newbcast:8 row_mask:0xf bank_mask:0xf
    v_fmac_f32_dpp v129, v33, v145 row_newbcast:8 row_mask:0xf bank_mask:0xf
    v_fmac_f32_dpp v130, v34, v146 row_newbcast:8 row_mask:0xf bank_mask:0xf
    v_fmac_f32_dpp v131, v35, v147 row_newbcast:8 row_mask:0xf bank_mask:0xf
    v_fmac_f32_dpp v132, v32, v148 row_newbcast:8 row_mask:0xf bank_mask:0xf
    v_fmac_f32_dpp v133, v33, v149 row_newbcast:8 row_mask:0xf bank_mask:0xf
    v_fmac_f32_dpp v134, v34, v150 row_newbcast:8 row_mask:0xf bank_mask:0xf
    v_fmac_f32_dpp v135, v35, v151 row_newbcast:8 row_mask:0xf bank_mask:0xf
    v_fmac_f32_dpp v128, -v36, v148 row_newbcast:8 row_mask:0xf bank_mask:0xf
    v_fmac_f32_dpp v129, -v37, v149 row_newbcast:8 row_mask:0xf bank_mask:0xf
    v_fmac_f32_dpp v130, -v38, v150 row_newbcast:8 row_mask:0xf bank_mask:0xf
    v_fmac_f32_dpp v131, -v39, v151 row_newbcast:8 row_mask:0xf bank_mask:0xf
    v_fmac_f32_dpp v132, v36, v144 row_newbcast:8 row_mask:0xf bank_mask:0xf
    v_fmac_f32_dpp v133, v37, v145 row_newbcast:8 row_mask:0xf bank_mask:0xf
    v_fmac_f32_dpp v134, v38, v146 row_newbcast:8 row_mask:0xf bank_mask:0xf
    v_fmac_f32_dpp v135, v39, v147 row_newbcast:8 row_mask:0xf bank_mask:0xf
    v_mul_f32 v152, v24, v128
    v_mul_f32 v153, v25, v129
    v_mul_f32 v156, -v24, v132
    v_mul_f32 v157, -v25, v133
    v_mul_f32 v154, v26, v130
    v_mul_f32 v155, v27, v131
    v_mul_f32 v158, -v26, v134
    v_mul_f32 v159, -v27, v135
    v_fma_f32 v152, -v28, v132, v152
    v_fma_f32 v153, -v29, v133, v153
    v_fma_f32 v156, -v28, v128, v156
    v_fma_f32 v157, -v29, v129, v157
    v_fma_f32 v154, -v30, v134, v154
    v_fma_f32 v155, -v31, v135, v155
    v_fma_f32 v158, -v30, v130, v158
    v_fma_f32 v159, -v31, v131, v159
    v_mul_f32 v136, v24, v32
    v_mul_f32 v137, v25, v33
    v_mul_f32 v140, v24, v36
    v_mul_f32 v141, v25, v37
    v_mul_f32 v138, v26, v34
    v_mul_f32 v139, v27, v35
    v_mul_f32 v142, v26, v38
    v_mul_f32 v143, v27, v39
    v_fma_f32 v136, -v28, v36, v136
    v_fma_f32 v137, -v29, v37, v137
    v_fmac_f32 v140, v28, v32
    v_fmac_f32 v141, v29, v33
    v_fma_f32 v138, -v30, v38, v138
    v_fma_f32 v139, -v31, v39, v139
    v_fmac_f32 v142, v30, v34
    v_fmac_f32 v143, v31, v35
    v_mul_f32 v48, v24, v64
    v_mul_f32 v49, v25, v65
    v_mul_f32 v50, v26, v66
    v_mul_f32 v51, v27, v67
    v_fma_f32 v48, -v28, v68, v48
    v_fma_f32 v49, -v29, v69, v49
    v_fma_f32 v50, -v30, v70, v50
    v_fma_f32 v51, -v31, v71, v51
    v_mul_f32 v68, -v24, v68
    v_mul_f32 v69, -v25, v69
    v_mul_f32 v70, -v26, v70
    v_mul_f32 v71, -v27, v71
    v_fma_f32 v68, -v28, v64, v68
    v_fma_f32 v69, -v29, v65, v69
    v_fma_f32 v70, -v30, v66, v70
    v_fma_f32 v71, -v31, v67, v71
    v_mul_f32 v64, v24, v72
    v_mul_f32 v65, v25, v73
    v_mul_f32 v66, v26, v74
    v_mul_f32 v67, v27, v75
    v_fma_f32 v64, -v28, v76, v64
    v_fma_f32 v65, -v29, v77, v65
    v_fma_f32 v66, -v30, v78, v66
    v_fma_f32 v67, -v31, v79, v67
    v_mul_f32 v76, -v24, v76
    v_mul_f32 v77, -v25, v77
    v_mul_f32 v78, -v26, v78
    v_mul_f32 v79, -v27, v79
    v_fma_f32 v76, -v28, v72, v76
    v_fma_f32 v77, -v29, v73, v77
    v_fma_f32 v78, -v30, v74, v78
    v_fma_f32 v79, -v31, v75, v79
    v_mul_f32 v72, v24, v80
    v_mul_f32 v73, v25, v81
    v_mul_f32 v74, v26, v82
    v_mul_f32 v75, v27, v83
    v_fma_f32 v72, -v28, v84, v72
    v_fma_f32 v73, -v29, v85, v73
    v_fma_f32 v74, -v30, v86, v74
    v_fma_f32 v75, -v31, v87, v75
    v_mul_f32 v84, -v24, v84
    v_mul_f32 v85, -v25, v85
    v_mul_f32 v86, -v26, v86
    v_mul_f32 v87, -v27, v87
    v_fma_f32 v84, -v28, v80, v84
    v_fma_f32 v85, -v29, v81, v85
    v_fma_f32 v86, -v30, v82, v86
    v_fma_f32 v87, -v31, v83, v87
    v_mul_f32 v80, v24, v88
    v_mul_f32 v81, v25, v89
    v_mul_f32 v82, v26, v90
    v_mul_f32 v83, v27, v91
    v_fma_f32 v80, -v28, v92, v80
    v_fma_f32 v81, -v29, v93, v81
    v_fma_f32 v82, -v30, v94, v82
    v_fma_f32 v83, -v31, v95, v83
    v_mul_f32 v92, -v24, v92
    v_mul_f32 v93, -v25, v93
    v_mul_f32 v94, -v26, v94
    v_mul_f32 v95, -v27, v95
    v_fma_f32 v92, -v28, v88, v92
    v_fma_f32 v93, -v29, v89, v93
    v_fma_f32 v94, -v30, v90, v94
    v_fma_f32 v95, -v31, v91, v95
    v_mul_f32 v88, v24, v96
    v_mul_f32 v89, v25, v97
    v_mul_f32 v90, v26, v98
    v_mul_f32 v91, v27, v99
    v_fma_f32 v88, -v28, v100, v88
    v_fma_f32 v89, -v29, v101, v89
    v_fma_f32 v90, -v30, v102, v90
    v_fma_f32 v91, -v31, v103, v91
    v_mul_f32 v100, -v24, v100
    v_mul_f32 v101, -v25, v101
    v_mul_f32 v102, -v26, v102
    v_mul_f32 v103, -v27, v103
    v_fma_f32 v100, -v28, v96, v100
    v_fma_f32 v101, -v29, v97, v101
    v_fma_f32 v102, -v30, v98, v102
    v_fma_f32 v103, -v31, v99, v103
    v_mul_f32 v96, v24, v104
    v_mul_f32 v97, v25, v105
    v_mul_f32 v98, v26, v106
    v_mul_f32 v99, v27, v107
    v_fma_f32 v96, -v28, v108, v96
    v_fma_f32 v97, -v29, v109, v97
    v_fma_f32 v98, -v30, v110, v98
    v_fma_f32 v99, -v31, v111, v99
    v_mul_f32 v108, -v24, v108
    v_mul_f32 v109, -v25, v109
    v_mul_f32 v110, -v26, v110
    v_mul_f32 v111, -v27, v111
    v_fma_f32 v108, -v28, v104, v108
    v_fma_f32 v109, -v29, v105, v109
    v_fma_f32 v110, -v30, v106, v110
    v_fma_f32 v111, -v31, v107, v111
    v_mul_f32 v104, v24, v112
    v_mul_f32 v105, v25, v113
    v_mul_f32 v106, v26, v114
    v_mul_f32 v107, v27, v115
    v_fma_f32 v104, -v28, v116, v104
    v_fma_f32 v105, -v29, v117, v105
    v_fma_f32 v106, -v30, v118, v106
    v_fma_f32 v107, -v31, v119, v107
    v_mul_f32 v116, -v24, v116
    v_mul_f32 v117, -v25, v117
    v_mul_f32 v118, -v26, v118
    v_mul_f32 v119, -v27, v119
    v_fma_f32 v116, -v28, v112, v116
    v_fma_f32 v117, -v29, v113, v117
    v_fma_f32 v118, -v30, v114, v118
    v_fma_f32 v119, -v31, v115, v119
    v_mul_f32 v112, v24, v120
    v_mul_f32 v113, v25, v121
    v_mul_f32 v114, v26, v122
    v_mul_f32 v115, v27, v123
    v_fma_f32 v112, -v28, v124, v112
    v_fma_f32 v113, -v29, v125, v113
    v_fma_f32 v114, -v30, v126, v114
    v_fma_f32 v115, -v31, v127, v115
    v_mul_f32 v124, -v24, v124
    v_mul_f32 v125, -v25, v125
    v_mul_f32 v126, -v26, v126
    v_mul_f32 v127, -v27, v127
    v_fma_f32 v124, -v28, v120, v124
    v_fma_f32 v125, -v29, v121, v125
    v_fma_f32 v126, -v30, v122, v126
    v_fma_f32 v127, -v31, v123, v127
    buffer_load_dwordx4 v[24:27], v56, s[12:15], 0 offen sc1
    buffer_load_dwordx4 v[28:31], v57, s[12:15], 0 offen sc1
    buffer_load_dwordx4 v[32:35], v58, s[12:15], 0 offen sc1
    buffer_load_dwordx4 v[36:39], v59, s[12:15], 0 offen sc1
    s_mov_b32 s39, 0
C_chk:
    s_waitcnt vmcnt(0)
    v_cmp_eq_u32 vcc, v26, v54
    v_cmp_eq_u32 s[54:55], v27, v55
    s_and_b64 s[54:55], s[54:55], vcc
    s_or_b64 s[56:57], s[54:55], s[40:41]
    v_cmp_eq_u32 vcc, v30, v54
    v_cmp_eq_u32 s[54:55], v31, v55
    s_and_b64 s[54:55], s[54:55], vcc
    s_or_b64 s[58:59], s[54:55], s[42:43]
    v_cmp_eq_u32 vcc, v34, v54
    v_cmp_eq_u32 s[54:55], v35, v55
    s_and_b64 s[54:55], s[54:55], vcc
    s_or_b64 s[60:61], s[54:55], s[44:45]
    v_cmp_eq_u32 vcc, v38, v54
    v_cmp_eq_u32 s[54:55], v39, v55
    s_and_b64 s[54:55], s[54:55], vcc
    s_or_b64 s[62:63], s[54:55], s[46:47]
    s_and_b64 s[56:57], s[56:57], s[58:59]
    s_and_b64 s[60:61], s[60:61], s[62:63]
    s_and_b64 s[56:57], s[56:57], s[60:61]
    s_cmp_eq_u64 s[56:57], -1
    s_cbranch_scc1 C_ok
    s_add_u32 s39, s39, 1
    s_cmp_gt_u32 s39, 4096
    s_cbranch_scc1 C_ok
    buffer_load_dwordx4 v[24:27], v56, s[12:15], 0 offen sc1
    buffer_load_dwordx4 v[28:31], v57, s[12:15], 0 offen sc1
    buffer_load_dwordx4 v[32:35], v58, s[12:15], 0 offen sc1
    buffer_load_dwordx4 v[36:39], v59, s[12:15], 0 offen sc1
    s_branch C_chk
C_ok:
    ds_write_b32 v63, v3 offset:64
    v_fma_f32 v32, v36, v42, v32
    v_fma_f32 v33, v36, v43, v33
    v_fma_f32 v32, -v37, v43, v32
    v_fmac_f32 v33, v37, v42
    v_fma_f32 v28, v32, v42, v28
    v_fma_f32 v29, v32, v43, v29
    v_fma_f32 v28, -v33, v43, v28
    v_fmac_f32 v29, v33, v42
    v_fma_f32 v24, v28, v42, v24
    v_fma_f32 v25, v28, v43, v25
    v_fma_f32 v24, -v29, v43, v24
    v_fmac_f32 v25, v29, v42
    v_mul_f32 v44, v24, v40
    v_mul_f32 v45, v24, v41
    v_fma_f32 v44, -v25, v41, v44
    v_fmac_f32 v45, v25, v40
    s_nop 0
    v_add_f32_dpp v44, v44, v44 row_ror:4 row_mask:0xf bank_mask:0xf
    v_add_f32_dpp v45, v45, v45 row_ror:4 row_mask:0xf bank_mask:0xf
    s_nop 0
    v_add_f32_dpp v44, v44, v44 row_ror:8 row_mask:0xf bank_mask:0xf
    v_add_f32_dpp v45, v45, v45 row_ror:8 row_mask:0xf bank_mask:0xf
    s_nop 0
    v_mov_b32_dpp v144, v44 quad_perm:[0,0,0,0] row_mask:0xf bank_mask:0xf
    v_mov_b32_dpp v148, v45 quad_perm:[0,0,0,0] row_mask:0xf bank_mask:0xf
    v_mov_b32_dpp v145, v44 quad_perm:[1,1,1,1] row_mask:0xf bank_mask:0xf
    v_mov_b32_dpp v149, v45 quad_perm:[1,1,1,1] row_mask:0xf bank_mask:0xf
    v_mov_b32_dpp v146, v44 quad_perm:[2,2,2,2] row_mask:0xf bank_mask:0xf
    v_mov_b32_dpp v150, v45 quad_perm:[2,2,2,2] row_mask:0xf bank_mask:0xf
    v_mov_b32_dpp v147, v44 quad_perm:[3,3,3,3] row_mask:0xf bank_mask:0xf
    v_mov_b32_dpp v151, v45 quad_perm:[3,3,3,3] row_mask:0xf bank_mask:0xf
    v_pk_fma_f32 v[152:153], v[136:137], v[144:145], v[152:153]
    v_pk_fma_f32 v[156:157], v[136:137], v[148:149], v[156:157] neg_lo:[1,0,0] neg_hi:[1,0,0]
    v_pk_fma_f32 v[154:155], v[138:139], v[146:147], v[154:155]
    v_pk_fma_f32 v[158:159], v[138:139], v[150:151], v[158:159] neg_lo:[1,0,0] neg_hi:[1,0,0]
    v_pk_fma_f32 v[152:153], v[140:141], v[148:149], v[152:153] neg_lo:[1,0,0] neg_hi:[1,0,0]
    v_pk_fma_f32 v[156:157], v[140:141], v[144:145], v[156:157] neg_lo:[1,0,0] neg_hi:[1,0,0]
    v_pk_fma_f32 v[154:155], v[142:143], v[150:151], v[154:155] neg_lo:[1,0,0] neg_hi:[1,0,0]
    v_pk_fma_f32 v[158:159], v[142:143], v[146:147], v[158:159] neg_lo:[1,0,0] neg_hi:[1,0,0]
    v_pk_fma_f32 v[48:49], v[16:17], v[152:153], v[48:49]
    v_pk_fma_f32 v[68:69], v[16:17], v[156:157], v[68:69]
    v_pk_fma_f32 v[50:51], v[18:19], v[154:155], v[50:51]
    v_pk_fma_f32 v[70:71], v[18:19], v[158:159], v[70:71]
    v_pk_fma_f32 v[48:49], v[20:21], v[156:157], v[48:49]
    v_pk_fma_f32 v[68:69], v[20:21], v[152:153], v[68:69] neg_lo:[1,0,0] neg_hi:[1,0,0]
    v_pk_fma_f32 v[50:51], v[22:23], v[158:159], v[50:51]
    v_pk_fma_f32 v[70:71], v[22:23], v[154:155], v[70:71] neg_lo:[1,0,0] neg_hi:[1,0,0]
    v_cvt_pk_bf16_f32 v128, v48, v49
    v_cvt_pk_bf16_f32 v130, v68, v69
    v_cvt_pk_bf16_f32 v129, v50, v51
    v_cvt_pk_bf16_f32 v131, v70, v71
    v_pk_fma_f32 v[64:65], v[16:17], v[48:49], v[64:65]
    v_pk_fma_f32 v[76:77], v[16:17], v[68:69], v[76:77]
    v_pk_fma_f32 v[66:67], v[18:19], v[50:51], v[66:67]
    v_pk_fma_f32 v[78:79], v[18:19], v[70:71], v[78:79]
    v_pk_fma_f32 v[64:65], v[20:21], v[68:69], v[64:65]
    v_pk_fma_f32 v[76:77], v[20:21], v[48:49], v[76:77] neg_lo:[1,0,0] neg_hi:[1,0,0]
    v_pk_fma_f32 v[66:67], v[22:23], v[70:71], v[66:67]
    v_pk_fma_f32 v[78:79], v[22:23], v[50:51], v[78:79] neg_lo:[1,0,0] neg_hi:[1,0,0]
    v_permlane32_swap_b32 v128, v130
    v_permlane32_swap_b32 v129, v131
    s_mov_b32 s6, 0
    buffer_store_dwordx4 v[128:131], v61, s[8:11], s6 offen sc1
    v_cvt_pk_bf16_f32 v132, v64, v65
    v_cvt_pk_bf16_f32 v134, v76, v77
    v_cvt_pk_bf16_f32 v133, v66, v67
    v_cvt_pk_bf16_f32 v135, v78, v79
    v_pk_fma_f32 v[72:73], v[16:17], v[64:65], v[72:73]
    v_pk_fma_f32 v[84:85], v[16:17], v[76:77], v[84:85]
    v_pk_fma_f32 v[74:75], v[18:19], v[66:67], v[74:75]
    v_pk_fma_f32 v[86:87], v[18:19], v[78:79], v[86:87]
    v_pk_fma_f32 v[72:73], v[20:21], v[76:77], v[72:73]
    v_pk_fma_f32 v[84:85], v[20:21], v[64:65], v[84:85] neg_lo:[1,0,0] neg_hi:[1,0,0]
    v_pk_fma_f32 v[74:75], v[22:23], v[78:79], v[74:75]
    v_pk_fma_f32 v[86:87], v[22:23], v[66:67], v[86:87] neg_lo:[1,0,0] neg_hi:[1,0,0]
    v_permlane32_swap_b32 v132, v134
    v_permlane32_swap_b32 v133, v135
    s_mov_b32 s6, 4096
    buffer_store_dwordx4 v[132:135], v61, s[8:11], s6 offen sc1
    v_cvt_pk_bf16_f32 v136, v72, v73
    v_cvt_pk_bf16_f32 v138, v84, v85
    v_cvt_pk_bf16_f32 v137, v74, v75
    v_cvt_pk_bf16_f32 v139, v86, v87
    v_pk_fma_f32 v[80:81], v[16:17], v[72:73], v[80:81]
    v_pk_fma_f32 v[92:93], v[16:17], v[84:85], v[92:93]
    v_pk_fma_f32 v[82:83], v[18:19], v[74:75], v[82:83]
    v_pk_fma_f32 v[94:95], v[18:19], v[86:87], v[94:95]
    v_pk_fma_f32 v[80:81], v[20:21], v[84:85], v[80:81]
    v_pk_fma_f32 v[92:93], v[20:21], v[72:73], v[92:93] neg_lo:[1,0,0] neg_hi:[1,0,0]
    v_pk_fma_f32 v[82:83], v[22:23], v[86:87], v[82:83]
    v_pk_fma_f32 v[94:95], v[22:23], v[74:75], v[94:95] neg_lo:[1,0,0] neg_hi:[1,0,0]
    v_permlane32_swap_b32 v136, v138
    v_permlane32_swap_b32 v137, v139
    s_mov_b32 s6, 8192
    buffer_store_dwordx4 v[136:139], v61, s[8:11], s6 offen sc1
    v_cvt_pk_bf16_f32 v140, v80, v81
    v_cvt_pk_bf16_f32 v142, v92, v93
    v_cvt_pk_bf16_f32 v141, v82, v83
    v_cvt_pk_bf16_f32 v143, v94, v95
    v_pk_fma_f32 v[88:89], v[16:17], v[80:81], v[88:89]
    v_pk_fma_f32 v[100:101], v[16:17], v[92:93], v[100:101]
    v_pk_fma_f32 v[90:91], v[18:19], v[82:83], v[90:91]
    v_pk_fma_f32 v[102:103], v[18:19], v[94:95], v[102:103]
    v_pk_fma_f32 v[88:89], v[20:21], v[92:93], v[88:89]
    v_pk_fma_f32 v[100:101], v[20:21], v[80:81], v[100:101] neg_lo:[1,0,0] neg_hi:[1,0,0]
    v_pk_fma_f32 v[90:91], v[22:23], v[94:95], v[90:91]
    v_pk_fma_f32 v[102:103], v[22:23], v[82:83], v[102:103] neg_lo:[1,0,0] neg_hi:[1,0,0]
    v_permlane32_swap_b32 v140, v142
    v_permlane32_swap_b32 v141, v143
    s_mov_b32 s6, 12288
    buffer_store_dwordx4 v[140:143], v61, s[8:11], s6 offen sc1
    v_cvt_pk_bf16_f32 v144, v88, v89
    v_cvt_pk_bf16_f32 v146, v100, v101
    v_cvt_pk_bf16_f32 v145, v90, v91
    v_cvt_pk_bf16_f32 v147, v102, v103
    v_pk_fma_f32 v[96:97], v[16:17], v[88:89], v[96:97]
    v_pk_fma_f32 v[108:109], v[16:17], v[100:101], v[108:109]
    v_pk_fma_f32 v[98:99], v[18:19], v[90:91], v[98:99]
    v_pk_fma_f32 v[110:111], v[18:19], v[102:103], v[110:111]
    v_pk_fma_f32 v[96:97], v[20:21], v[100:101], v[96:97]
    v_pk_fma_f32 v[108:109], v[20:21], v[88:89], v[108:109] neg_lo:[1,0,0] neg_hi:[1,0,0]
    v_pk_fma_f32 v[98:99], v[22:23], v[102:103], v[98:99]
    v_pk_fma_f32 v[110:111], v[22:23], v[90:91], v[110:111] neg_lo:[1,0,0] neg_hi:[1,0,0]
    v_permlane32_swap_b32 v144, v146
    v_permlane32_swap_b32 v145, v147
    s_mov_b32 s6, 16384
    buffer_store_dwordx4 v[144:147], v61, s[8:11], s6 offen sc1
    v_cvt_pk_bf16_f32 v148, v96, v97
    v_cvt_pk_bf16_f32 v150, v108, v109
    v_cvt_pk_bf16_f32 v149, v98, v99
    v_cvt_pk_bf16_f32 v151, v110, v111
    v_pk_fma_f32 v[104:105], v[16:17], v[96:97], v[104:105]
    v_pk_fma_f32 v[116:117], v[16:17], v[108:109], v[116:117]
    v_pk_fma_f32 v[106:107], v[18:19], v[98:99], v[106:107]
    v_pk_fma_f32 v[118:119], v[18:19], v[110:111], v[118:119]
    v_pk_fma_f32 v[104:105], v[20:21], v[108:109], v[104:105]
    v_pk_fma_f32 v[116:117], v[20:21], v[96:97], v[116:117] neg_lo:[1,0,0] neg_hi:[1,0,0]
    v_pk_fma_f32 v[106:107], v[22:23], v[110:111], v[106:107]
    v_pk_fma_f32 v[118:119], v[22:23], v[98:99], v[118:119] neg_lo:[1,0,0] neg_hi:[1,0,0]
    v_permlane32_swap_b32 v148, v150
    v_permlane32_swap_b32 v149, v151
    s_mov_b32 s6, 20480
    buffer_store_dwordx4 v[148:151], v61, s[8:11], s6 offen sc1
    v_cvt_pk_bf16_f32 v152, v104, v105
    v_cvt_pk_bf16_f32 v154, v116, v117
    v_cvt_pk_bf16_f32 v153, v106, v107
    v_cvt_pk_bf16_f32 v155, v118, v119
    v_pk_fma_f32 v[112:113], v[16:17], v[104:105], v[112:113]
    v_pk_fma_f32 v[124:125], v[16:17], v[116:117], v[124:125]
    v_pk_fma_f32 v[114:115], v[18:19], v[106:107], v[114:115]
    v_pk_fma_f32 v[126:127], v[18:19], v[118:119], v[126:127]
    v_pk_fma_f32 v[112:113], v[20:21], v[116:117], v[112:113]
    v_pk_fma_f32 v[124:125], v[20:21], v[104:105], v[124:125] neg_lo:[1,0,0] neg_hi:[1,0,0]
    v_pk_fma_f32 v[114:115], v[22:23], v[118:119], v[114:115]
    v_pk_fma_f32 v[126:127], v[22:23], v[106:107], v[126:127] neg_lo:[1,0,0] neg_hi:[1,0,0]
    v_permlane32_swap_b32 v152, v154
    v_permlane32_swap_b32 v153, v155
    s_mov_b32 s6, 24576
    buffer_store_dwordx4 v[152:155], v61, s[8:11], s6 offen sc1
    v_cvt_pk_bf16_f32 v156, v112, v113
    v_cvt_pk_bf16_f32 v158, v124, v125
    v_cvt_pk_bf16_f32 v157, v114, v115
    v_cvt_pk_bf16_f32 v159, v126, v127
    s_nop 0
    v_permlane32_swap_b32 v156, v158
    v_permlane32_swap_b32 v157, v159
    s_mov_b32 s6, 28672
    buffer_store_dwordx4 v[156:159], v61, s[8:11], s6 offen sc1
    ds_write_b32 v63, v15 offset:64
    v_lshlrev_b32 v1, 4, v2
    v_add_u32 v52, s21, v1
    v_add_u32 v53, 0xc000, v52
    v_lshrrev_b32 v1, 1, v13
    v_lshl_add_u32 v8, v1, 13, v4
    v_xor_b32 v9, 32, v8
    v_xor_b32 v10, 64, v8
    v_xor_b32 v11, 96, v8
    s_lshl_b32 s6, s3, 6
    s_add_u32 s6, s6, s5
    s_lshl_b32 s6, s6, 13
    v_lshlrev_b32 v1, 4, v2
    v_add_u32 v48, s6, v1
    v_add_u32 v49, 4096, v48
    s_lshl_b32 s6, s6, 1
    s_lshl_b32 s7, s4, 8
    s_add_u32 s6, s6, s7
    s_add_u32 s6, s6, 4096
    v_lshlrev_b32 v50, 18, v13
    v_lshl_add_u32 v50, v12, 4, v50
    v_add_u32 v50, s6, v50
    v_lshlrev_b32 v1, 1, v13
    v_sub_u32 v1, v12, v1
    v_cmp_eq_u32 s[40:41], 0, v1
    v_cmp_eq_u32 s[42:43], 1, v1
    v_cmp_eq_u32 s[44:45], 8, v1
    v_cmp_eq_u32 s[46:47], 9, v1
    v_and_b32 v56, 0xffff, v242
    v_and_b32 v57, 0xffff0000, v242
    v_and_b32 v58, 0xffff, v243
    v_and_b32 v59, 0xffff0000, v243
    s_lshl_b32 s7, s3, 13
    s_add_u32 s7, s7, 131072
    v_lshrrev_b32 v1, 2, v2
    v_xor_b32 v3, s36, v1
    v_add_u32 v1, s36, v1
    v_and_b32 v1, 7, v1
    v_and_b32 v3, 8, v3
    v_or_b32 v1, v1, v3
    v_lshlrev_b32 v1, 9, v1
    v_add_u32 v51, s7, v1
    s_lshl_b32 s6, s4, 9
    s_add_u32 s6, s6, s7
    v_lshl_add_u32 v3, v12, 3, s6
    s_lshl_b32 s38, s36, 15
    s_and_b32 s30, s38, 0x40000
    s_xor_b32 s31, s30, 0x40000
    s_xor_b32 s35, s38, 0x40000
    s_lshl_b32 s6, s3, 19
    s_lshl_b32 s7, s5, 13
    s_add_u32 s6, s6, s7
    v_lshlrev_b32 v1, 7, v2
    v_add_u32 v60, s6, v1
    s_mov_b32 s34, 1
    s_mov_b32 s37, 0
    v_cndmask_b32 v64, 0, v56, s[40:41]
    v_mov_b32 v65, 0
    v_cndmask_b32 v66, 0, v56, s[42:43]
    v_mov_b32 v67, 0
    v_cndmask_b32 v68, 0, v56, s[44:45]
    v_mov_b32 v69, 0
    v_cndmask_b32 v70, 0, v56, s[46:47]
    v_mov_b32 v71, 0
    v_cndmask_b32 v72, 0, v57, s[40:41]
    v_mov_b32 v73, 0
    v_cndmask_b32 v74, 0, v57, s[42:43]
    v_mov_b32 v75, 0
    v_cndmask_b32 v76, 0, v57, s[44:45]
    v_mov_b32 v77, 0
    v_cndmask_b32 v78, 0, v57, s[46:47]
    v_mov_b32 v79, 0
    v_mov_b32 v80, 0
    v_cndmask_b32 v81, 0, v58, s[40:41]
    v_mov_b32 v82, 0
    v_cndmask_b32 v83, 0, v58, s[42:43]
    v_mov_b32 v84, 0
    v_cndmask_b32 v85, 0, v58, s[44:45]
    v_mov_b32 v86, 0
    v_cndmask_b32 v87, 0, v58, s[46:47]
    v_mov_b32 v88, 0
    v_cndmask_b32 v89, 0, v59, s[40:41]
    v_mov_b32 v90, 0
    v_cndmask_b32 v91, 0, v59, s[42:43]
    v_mov_b32 v92, 0
    v_cndmask_b32 v93, 0, v59, s[44:45]
    v_mov_b32 v94, 0
    v_cndmask_b32 v95, 0, v59, s[46:47]
    v_add_u32 v4, 0xc000, v8
    v_add_u32 v5, 0xc000, v9
    v_add_u32 v6, 0xc000, v10
    v_add_u32 v7, 0xc000, v11
    v_mfma_f32_16x16x32_bf16 v[16:19], v[208:211], v[64:67], 0
    v_mfma_f32_16x16x32_bf16 v[20:23], v[208:211], v[72:75], 0
    v_mfma_f32_16x16x32_bf16 v[24:27], v[208:211], v[80:83], 0
    v_mfma_f32_16x16x32_bf16 v[28:31], v[208:211], v[88:91], 0
    v_mfma_f32_16x16x32_bf16 v[32:35], v[216:219], v[64:67], 0
    v_mfma_f32_16x16x32_bf16 v[36:39], v[216:219], v[72:75], 0
    v_mfma_f32_16x16x32_bf16 v[40:43], v[216:219], v[80:83], 0
    v_mfma_f32_16x16x32_bf16 v[44:47], v[216:219], v[88:91], 0
    v_mfma_f32_16x16x32_bf16 v[16:19], v[212:215], v[68:71], v[16:19]
    v_mfma_f32_16x16x32_bf16 v[20:23], v[212:215], v[76:79], v[20:23]
    v_mfma_f32_16x16x32_bf16 v[24:27], v[212:215], v[84:87], v[24:27]
    v_mfma_f32_16x16x32_bf16 v[28:31], v[212:215], v[92:95], v[28:31]
    v_mfma_f32_16x16x32_bf16 v[32:35], v[220:223], v[68:71], v[32:35]
    v_mfma_f32_16x16x32_bf16 v[36:39], v[220:223], v[76:79], v[36:39]
    v_mfma_f32_16x16x32_bf16 v[40:43], v[220:223], v[84:87], v[40:43]
    v_mfma_f32_16x16x32_bf16 v[44:47], v[220:223], v[92:95], v[44:47]
    buffer_load_dwordx2 v[240:241], v51, s[72:75], 0 offen sc1
    s_waitcnt vmcnt(1)
    ds_write_b32 v63, v54 offset:32
    ds_read_b128 v[56:59], v62 offset:32
    s_waitcnt lgkmcnt(0)
    v_xor_b32 v56, v56, v54
    v_xor_b32 v57, v57, v54
    v_xor_b32 v58, v58, v54
    v_xor_b32 v59, v59, v54
    v_or3_b32 v56, v56, v57, v58
    v_or_b32 v56, v56, v59
    v_cmp_ne_u32 vcc, 0, v56
    s_mov_b32 s39, 0
    s_cbranch_vccnz C_nofl
    s_mov_b64 exec, 65535
    buffer_store_dwordx2 v[54:55], v3, s[72:75], 0 offen sc1
    s_mov_b64 exec, -1
    s_branch C_own
C_nofl:
    ds_read_b128 v[56:59], v62 offset:32
    s_waitcnt lgkmcnt(0)
    v_xor_b32 v56, v56, v54
    v_xor_b32 v57, v57, v54
    v_xor_b32 v58, v58, v54
    v_xor_b32 v59, v59, v54
    v_or3_b32 v56, v56, v57, v58
    v_or_b32 v56, v56, v59
    v_cmp_ne_u32 vcc, 0, v56
    s_add_u32 s39, s39, 1
    s_cmp_gt_u32 s39, 16384
    s_cbranch_scc1 C_own
    s_cbranch_vccnz C_nofl
C_own:
    ds_read_b128 v[12:15], v62 offset:48
    buffer_load_dwordx4 v[64:67], v48, s[8:11], s38 offen offset:0 sc1
    buffer_load_dwordx4 v[68:71], v49, s[8:11], s38 offen offset:0 sc1
    buffer_load_dwordx4 v[72:75], v48, s[8:11], s38 offen offset:1024 sc1
    buffer_load_dwordx4 v[76:79], v49, s[8:11], s38 offen offset:1024 sc1
    buffer_load_dwordx4 v[80:83], v48, s[8:11], s38 offen offset:2048 sc1
    buffer_load_dwordx4 v[84:87], v49, s[8:11], s38 offen offset:2048 sc1
    buffer_load_dwordx4 v[88:91], v48, s[8:11], s38 offen offset:3072 sc1
    buffer_load_dwordx4 v[92:95], v49, s[8:11], s38 offen offset:3072 sc1
    s_add_u32 s38, s38, 32768
    s_and_b32 s38, s38, 0x3ffff
    s_or_b32 s38, s38, s30
    s_add_u32 s7, s20, 1280
    s_and_b32 s7, s7, 1023
    s_or_b32 s7, s7, s23
    buffer_load_dwordx4 v[208:211], v244, s[24:27], s7 offen offset:0
    buffer_load_dwordx4 v[212:215], v245, s[24:27], s7 offen offset:1024
    buffer_load_dwordx4 v[216:219], v246, s[80:83], s7 offen offset:0
    buffer_load_dwordx4 v[220:223], v247, s[80:83], s7 offen offset:1024
    s_waitcnt vmcnt(12)
    v_cmp_eq_u32 vcc, v240, v54
    v_cmp_eq_u32 s[54:55], v241, v55
    s_nop 0
    s_and_b64 s[54:55], s[54:55], vcc
    s_or_b32 s54, s54, 15
    s_ff0_i32_b64 s7, s[54:55]
    s_lshr_b32 s7, s7, 2
    s_max_u32 s37, s37, s7
    s_cmp_gt_u32 s37, 1
    s_cbranch_scc0 C2_h1
    C2_h1_r:
    buffer_load_dwordx4 v[96:99], v48, s[8:11], s38 offen offset:0 sc1
    buffer_load_dwordx4 v[100:103], v49, s[8:11], s38 offen offset:0 sc1
    buffer_load_dwordx4 v[104:107], v48, s[8:11], s38 offen offset:1024 sc1
    buffer_load_dwordx4 v[108:111], v49, s[8:11], s38 offen offset:1024 sc1
    buffer_load_dwordx4 v[112:115], v48, s[8:11], s38 offen offset:2048 sc1
    buffer_load_dwordx4 v[116:119], v49, s[8:11], s38 offen offset:2048 sc1
    s_waitcnt lgkmcnt(0)
    v_min3_u32 v12, v12, v13, v14
    v_min_u32 v12, v12, v15
    v_cmp_gt_u32 vcc, 6, v12
    s_cbranch_vccnz C_crdy
    C_crdy_r:
    s_setprio 3
    ds_read_b128 v[128:131], v8 offset:0
    ds_read_b128 v[132:135], v8 offset:2048
    ds_read_b128 v[136:139], v8 offset:4096
    ds_read_b128 v[140:143], v8 offset:6144
    s_waitcnt vmcnt(16) lgkmcnt(0)
    v_mfma_f32_16x16x32_bf16 v[16:19], v[64:67], v[128:131], v[16:19]
    ds_read_b128 v[144:147], v9 offset:0
    ds_read_b128 v[148:151], v9 offset:2048
    v_mfma_f32_16x16x32_bf16 v[20:23], v[64:67], v[132:135], v[20:23]
    ds_read_b128 v[152:155], v9 offset:4096
    ds_read_b128 v[156:159], v9 offset:6144
    v_mfma_f32_16x16x32_bf16 v[24:27], v[64:67], v[136:139], v[24:27]
    buffer_load_dwordx2 v[244:245], v51, s[72:75], 0 offen sc1
    v_mfma_f32_16x16x32_bf16 v[28:31], v[64:67], v[140:143], v[28:31]
    buffer_load_dwordx4 v[120:123], v48, s[8:11], s38 offen offset:3072 sc1
    v_mfma_f32_16x16x32_bf16 v[44:47], v[68:71], v[140:143], v[44:47]
    buffer_load_dwordx4 v[124:127], v49, s[8:11], s38 offen offset:3072 sc1
    s_add_u32 s38, s38, 32768
    s_and_b32 s38, s38, 0x3ffff
    s_or_b32 s38, s38, s30
    v_mfma_f32_16x16x32_bf16 v[40:43], v[68:71], v[136:139], v[40:43]
    v_mfma_f32_16x16x32_bf16 v[36:39], v[68:71], v[132:135], v[36:39]
    v_mfma_f32_16x16x32_bf16 v[32:35], v[68:71], v[128:131], v[32:35]
    s_waitcnt vmcnt(17) lgkmcnt(0)
    v_mfma_f32_16x16x32_bf16 v[16:19], v[72:75], v[144:147], v[16:19]
    ds_read_b128 v[128:131], v10 offset:0
    ds_read_b128 v[132:135], v10 offset:2048
    v_mfma_f32_16x16x32_bf16 v[20:23], v[72:75], v[148:151], v[20:23]
    ds_read_b128 v[136:139], v10 offset:4096
    ds_read_b128 v[140:143], v10 offset:6144
    v_mfma_f32_16x16x32_bf16 v[24:27], v[72:75], v[152:155], v[24:27]
    s_cmp_gt_u32 s37, 2
    s_cbranch_scc0 C2_h2
    C2_h2_r:
    buffer_load_dwordx4 v[64:67], v48, s[8:11], s38 offen offset:0 sc1
    v_mfma_f32_16x16x32_bf16 v[28:31], v[72:75], v[156:159], v[28:31]
    buffer_load_dwordx4 v[68:71], v49, s[8:11], s38 offen offset:0 sc1
    v_mfma_f32_16x16x32_bf16 v[44:47], v[76:79], v[156:159], v[44:47]
    v_mfma_f32_16x16x32_bf16 v[40:43], v[76:79], v[152:155], v[40:43]
    v_mfma_f32_16x16x32_bf16 v[36:39], v[76:79], v[148:151], v[36:39]
    v_mfma_f32_16x16x32_bf16 v[32:35], v[76:79], v[144:147], v[32:35]
    s_waitcnt vmcnt(17) lgkmcnt(0)
    v_mfma_f32_16x16x32_bf16 v[16:19], v[80:83], v[128:131], v[16:19]
    ds_read_b128 v[144:147], v11 offset:0
    ds_read_b128 v[148:151], v11 offset:2048
    v_mfma_f32_16x16x32_bf16 v[20:23], v[80:83], v[132:135], v[20:23]
    ds_read_b128 v[152:155], v11 offset:4096
    ds_read_b128 v[156:159], v11 offset:6144
    v_mfma_f32_16x16x32_bf16 v[24:27], v[80:83], v[136:139], v[24:27]
    buffer_load_dwordx4 v[72:75], v48, s[8:11], s38 offen offset:1024 sc1
    v_mfma_f32_16x16x32_bf16 v[28:31], v[80:83], v[140:143], v[28:31]
    buffer_load_dwordx4 v[76:79], v49, s[8:11], s38 offen offset:1024 sc1
    v_mfma_f32_16x16x32_bf16 v[44:47], v[84:87], v[140:143], v[44:47]
    v_mfma_f32_16x16x32_bf16 v[40:43], v[84:87], v[136:139], v[40:43]
    v_mfma_f32_16x16x32_bf16 v[36:39], v[84:87], v[132:135], v[36:39]
    v_mfma_f32_16x16x32_bf16 v[32:35], v[84:87], v[128:131], v[32:35]
    s_waitcnt vmcnt(17) lgkmcnt(0)
    v_mfma_f32_16x16x32_bf16 v[16:19], v[88:91], v[144:147], v[16:19]
    ds_read_b128 v[128:131], v8 offset:16384
    ds_read_b128 v[132:135], v8 offset:18432
    v_mfma_f32_16x16x32_bf16 v[20:23], v[88:91], v[148:151], v[20:23]
    ds_read_b128 v[136:139], v8 offset:20480
    ds_read_b128 v[140:143], v8 offset:22528
    v_mfma_f32_16x16x32_bf16 v[24:27], v[88:91], v[152:155], v[24:27]
    v_mov_b32 v1, 1
    ds_write_b32 v63, v1 offset:96
    v_mfma_f32_16x16x32_bf16 v[28:31], v[88:91], v[156:159], v[28:31]
    buffer_load_dwordx4 v[80:83], v48, s[8:11], s38 offen offset:2048 sc1
    v_mfma_f32_16x16x32_bf16 v[44:47], v[92:95], v[156:159], v[44:47]
    buffer_load_dwordx4 v[84:87], v49, s[8:11], s38 offen offset:2048 sc1
    v_mfma_f32_16x16x32_bf16 v[40:43], v[92:95], v[152:155], v[40:43]
    v_mfma_f32_16x16x32_bf16 v[36:39], v[92:95], v[148:151], v[36:39]
    v_mfma_f32_16x16x32_bf16 v[32:35], v[92:95], v[144:147], v[32:35]
    s_waitcnt vmcnt(13) lgkmcnt(1)
    v_mfma_f32_16x16x32_bf16 v[16:19], v[96:99], v[128:131], v[16:19]
    ds_read_b128 v[144:147], v9 offset:16384
    ds_read_b128 v[148:151], v9 offset:18432
    v_mfma_f32_16x16x32_bf16 v[20:23], v[96:99], v[132:135], v[20:23]
    ds_read_b128 v[152:155], v9 offset:20480
    ds_read_b128 v[156:159], v9 offset:22528
    v_mfma_f32_16x16x32_bf16 v[24:27], v[96:99], v[136:139], v[24:27]
    buffer_load_dwordx2 v[240:241], v51, s[72:75], 0 offen sc1
    v_mfma_f32_16x16x32_bf16 v[28:31], v[96:99], v[140:143], v[28:31]
    buffer_load_dwordx4 v[88:91], v48, s[8:11], s38 offen offset:3072 sc1
    v_mfma_f32_16x16x32_bf16 v[44:47], v[100:103], v[140:143], v[44:47]
    buffer_load_dwordx4 v[92:95], v49, s[8:11], s38 offen offset:3072 sc1
    s_add_u32 s38, s38, 32768
    s_and_b32 s38, s38, 0x3ffff
    s_or_b32 s38, s38, s30
    v_mfma_f32_16x16x32_bf16 v[40:43], v[100:103], v[136:139], v[40:43]
    v_mfma_f32_16x16x32_bf16 v[36:39], v[100:103], v[132:135], v[36:39]
    v_mfma_f32_16x16x32_bf16 v[32:35], v[100:103], v[128:131], v[32:35]
    s_waitcnt vmcnt(14) lgkmcnt(0)
    v_mfma_f32_16x16x32_bf16 v[16:19], v[104:107], v[144:147], v[16:19]
    ds_read_b128 v[128:131], v10 offset:16384
    ds_read_b128 v[132:135], v10 offset:18432
    v_mfma_f32_16x16x32_bf16 v[20:23], v[104:107], v[148:151], v[20:23]
    ds_read_b128 v[136:139], v10 offset:20480
    ds_read_b128 v[140:143], v10 offset:22528
    v_mfma_f32_16x16x32_bf16 v[24:27], v[104:107], v[152:155], v[24:27]
    s_cmp_gt_u32 s37, 3
    s_cbranch_scc0 C2_h3
    C2_h3_r:
    buffer_load_dwordx4 v[96:99], v48, s[8:11], s38 offen offset:0 sc1
    v_mfma_f32_16x16x32_bf16 v[28:31], v[104:107], v[156:159], v[28:31]
    buffer_load_dwordx4 v[100:103], v49, s[8:11], s38 offen offset:0 sc1
    v_mfma_f32_16x16x32_bf16 v[44:47], v[108:111], v[156:159], v[44:47]
    v_mfma_f32_16x16x32_bf16 v[40:43], v[108:111], v[152:155], v[40:43]
    v_mfma_f32_16x16x32_bf16 v[36:39], v[108:111], v[148:151], v[36:39]
    v_mfma_f32_16x16x32_bf16 v[32:35], v[108:111], v[144:147], v[32:35]
    s_waitcnt vmcnt(14) lgkmcnt(0)
    v_mfma_f32_16x16x32_bf16 v[16:19], v[112:115], v[128:131], v[16:19]
    ds_read_b128 v[144:147], v11 offset:16384
    ds_read_b128 v[148:151], v11 offset:18432
    v_mfma_f32_16x16x32_bf16 v[20:23], v[112:115], v[132:135], v[20:23]
    ds_read_b128 v[152:155], v11 offset:20480
    ds_read_b128 v[156:159], v11 offset:22528
    v_mfma_f32_16x16x32_bf16 v[24:27], v[112:115], v[136:139], v[24:27]
    buffer_load_dwordx4 v[104:107], v48, s[8:11], s38 offen offset:1024 sc1
    v_mfma_f32_16x16x32_bf16 v[28:31], v[112:115], v[140:143], v[28:31]
    buffer_load_dwordx4 v[108:111], v49, s[8:11], s38 offen offset:1024 sc1
    v_mfma_f32_16x16x32_bf16 v[44:47], v[116:119], v[140:143], v[44:47]
    v_mfma_f32_16x16x32_bf16 v[40:43], v[116:119], v[136:139], v[40:43]
    v_mfma_f32_16x16x32_bf16 v[36:39], v[116:119], v[132:135], v[36:39]
    v_mfma_f32_16x16x32_bf16 v[32:35], v[116:119], v[128:131], v[32:35]
    s_waitcnt vmcnt(13) lgkmcnt(0)
    v_mfma_f32_16x16x32_bf16 v[16:19], v[120:123], v[144:147], v[16:19]
    ds_read_b128 v[128:131], v8 offset:32768
    ds_read_b128 v[132:135], v8 offset:34816
    v_mfma_f32_16x16x32_bf16 v[20:23], v[120:123], v[148:151], v[20:23]
    ds_read_b128 v[136:139], v8 offset:36864
    ds_read_b128 v[140:143], v8 offset:38912
    v_mfma_f32_16x16x32_bf16 v[24:27], v[120:123], v[152:155], v[24:27]
    v_mov_b32 v1, 2
    ds_write_b32 v63, v1 offset:96
    v_mfma_f32_16x16x32_bf16 v[28:31], v[120:123], v[156:159], v[28:31]
    ds_read_b128 v[56:59], v62 offset:96
    v_mfma_f32_16x16x32_bf16 v[44:47], v[124:127], v[156:159], v[44:47]
    buffer_load_dwordx4 v[112:115], v48, s[8:11], s38 offen offset:2048 sc1
    v_mfma_f32_16x16x32_bf16 v[40:43], v[124:127], v[152:155], v[40:43]
    buffer_load_dwordx4 v[116:119], v49, s[8:11], s38 offen offset:2048 sc1
    v_mfma_f32_16x16x32_bf16 v[36:39], v[124:127], v[148:151], v[36:39]
    v_mfma_f32_16x16x32_bf16 v[32:35], v[124:127], v[144:147], v[32:35]
    s_waitcnt vmcnt(13) lgkmcnt(0)
    v_mfma_f32_16x16x32_bf16 v[16:19], v[64:67], v[128:131], v[16:19]
    ds_read_b128 v[144:147], v9 offset:32768
    ds_read_b128 v[148:151], v9 offset:34816
    v_mfma_f32_16x16x32_bf16 v[20:23], v[64:67], v[132:135], v[20:23]
    ds_read_b128 v[152:155], v9 offset:36864
    ds_read_b128 v[156:159], v9 offset:38912
    v_mfma_f32_16x16x32_bf16 v[24:27], v[64:67], v[136:139], v[24:27]
    buffer_load_dwordx2 v[242:243], v51, s[72:75], 0 offen sc1
    v_cmp_eq_u32 vcc, v244, v54
    v_cmp_eq_u32 s[54:55], v245, v55
    s_nop 0
    s_and_b64 s[54:55], s[54:55], vcc
    s_or_b32 s54, s54, 15
    s_ff0_i32_b64 s7, s[54:55]
    s_lshr_b32 s7, s7, 2
    s_max_u32 s37, s37, s7
    v_mfma_f32_16x16x32_bf16 v[28:31], v[64:67], v[140:143], v[28:31]
    buffer_load_dwordx4 v[120:123], v48, s[8:11], s38 offen offset:3072 sc1
    buffer_load_dwordx4 v[124:127], v49, s[8:11], s38 offen offset:3072 sc1
    s_add_u32 s38, s38, 32768
    s_and_b32 s38, s38, 0x3ffff
    s_or_b32 s38, s38, s30
    v_mfma_f32_16x16x32_bf16 v[44:47], v[68:71], v[140:143], v[44:47]
    v_min3_u32 v56, v56, v57, v58
    v_min_u32 v56, v56, v59
    v_mfma_f32_16x16x32_bf16 v[40:43], v[68:71], v[136:139], v[40:43]
    v_cmp_gt_u32 vcc, 1, v56
    v_mfma_f32_16x16x32_bf16 v[36:39], v[68:71], v[132:135], v[36:39]
    s_cbranch_vccnz C2_p2
    C2_p2_r:
    v_mfma_f32_16x16x32_bf16 v[32:35], v[68:71], v[128:131], v[32:35]
    ds_write_b128 v52, v[160:163] offset:0
    s_waitcnt vmcnt(14) lgkmcnt(1)
    v_mfma_f32_16x16x32_bf16 v[16:19], v[72:75], v[144:147], v[16:19]
    ds_read_b128 v[128:131], v10 offset:32768
    ds_read_b128 v[132:135], v10 offset:34816
    v_mfma_f32_16x16x32_bf16 v[20:23], v[72:75], v[148:151], v[20:23]
    ds_read_b128 v[136:139], v10 offset:36864
    ds_read_b128 v[140:143], v10 offset:38912
    v_mfma_f32_16x16x32_bf16 v[24:27], v[72:75], v[152:155], v[24:27]
    s_cmp_gt_u32 s37, 4
    s_cbranch_scc0 C2_h4
    C2_h4_r:
    buffer_load_dwordx4 v[64:67], v48, s[8:11], s38 offen offset:0 sc1
    v_mfma_f32_16x16x32_bf16 v[28:31], v[72:75], v[156:159], v[28:31]
    buffer_load_dwordx4 v[68:71], v49, s[8:11], s38 offen offset:0 sc1
    v_mfma_f32_16x16x32_bf16 v[44:47], v[76:79], v[156:159], v[44:47]
    ds_write_b128 v52, v[164:167] offset:1024
    v_mfma_f32_16x16x32_bf16 v[40:43], v[76:79], v[152:155], v[40:43]
    v_mfma_f32_16x16x32_bf16 v[36:39], v[76:79], v[148:151], v[36:39]
    v_mfma_f32_16x16x32_bf16 v[32:35], v[76:79], v[144:147], v[32:35]
    s_waitcnt vmcnt(14) lgkmcnt(1)
    v_mfma_f32_16x16x32_bf16 v[16:19], v[80:83], v[128:131], v[16:19]
    ds_read_b128 v[144:147], v11 offset:32768
    ds_read_b128 v[148:151], v11 offset:34816
    v_mfma_f32_16x16x32_bf16 v[20:23], v[80:83], v[132:135], v[20:23]
    ds_read_b128 v[152:155], v11 offset:36864
    ds_read_b128 v[156:159], v11 offset:38912
    v_mfma_f32_16x16x32_bf16 v[24:27], v[80:83], v[136:139], v[24:27]
    buffer_load_dwordx4 v[72:75], v48, s[8:11], s38 offen offset:1024 sc1
    v_mfma_f32_16x16x32_bf16 v[28:31], v[80:83], v[140:143], v[28:31]
    buffer_load_dwordx4 v[76:79], v49, s[8:11], s38 offen offset:1024 sc1
    v_mfma_f32_16x16x32_bf16 v[44:47], v[84:87], v[140:143], v[44:47]
    ds_write_b128 v52, v[168:171] offset:8192
    v_mfma_f32_16x16x32_bf16 v[40:43], v[84:87], v[136:139], v[40:43]
    v_mfma_f32_16x16x32_bf16 v[36:39], v[84:87], v[132:135], v[36:39]
    v_mfma_f32_16x16x32_bf16 v[32:35], v[84:87], v[128:131], v[32:35]
    s_waitcnt vmcnt(13) lgkmcnt(1)
    v_mfma_f32_16x16x32_bf16 v[16:19], v[88:91], v[144:147], v[16:19]
    ds_read_b128 v[128:131], v4 offset:0
    ds_read_b128 v[132:135], v4 offset:2048
    v_mfma_f32_16x16x32_bf16 v[20:23], v[88:91], v[148:151], v[20:23]
    ds_read_b128 v[136:139], v4 offset:4096
    ds_read_b128 v[140:143], v4 offset:6144
    v_mfma_f32_16x16x32_bf16 v[24:27], v[88:91], v[152:155], v[24:27]
    ds_write_b128 v52, v[172:175] offset:9216
    v_mfma_f32_16x16x32_bf16 v[28:31], v[88:91], v[156:159], v[28:31]
    v_mov_b32 v1, 3
    ds_write_b32 v63, v1 offset:96
    v_mfma_f32_16x16x32_bf16 v[44:47], v[92:95], v[156:159], v[44:47]
    ds_read_b128 v[56:59], v62 offset:96
    v_mfma_f32_16x16x32_bf16 v[40:43], v[92:95], v[152:155], v[40:43]
    buffer_load_dwordx4 v[80:83], v48, s[8:11], s38 offen offset:2048 sc1
    v_mfma_f32_16x16x32_bf16 v[36:39], v[92:95], v[148:151], v[36:39]
    buffer_load_dwordx4 v[84:87], v49, s[8:11], s38 offen offset:2048 sc1
    v_mfma_f32_16x16x32_bf16 v[32:35], v[92:95], v[144:147], v[32:35]
    s_waitcnt vmcnt(13) lgkmcnt(0)
    v_mfma_f32_16x16x32_bf16 v[16:19], v[96:99], v[128:131], v[16:19]
    ds_read_b128 v[144:147], v5 offset:0
    ds_read_b128 v[148:151], v5 offset:2048
    v_mfma_f32_16x16x32_bf16 v[20:23], v[96:99], v[132:135], v[20:23]
    ds_read_b128 v[152:155], v5 offset:4096
    ds_read_b128 v[156:159], v5 offset:6144
    v_mfma_f32_16x16x32_bf16 v[24:27], v[96:99], v[136:139], v[24:27]
    v_cmp_eq_u32 vcc, v240, v54
    v_cmp_eq_u32 s[54:55], v241, v55
    s_nop 0
    s_and_b64 s[54:55], s[54:55], vcc
    s_or_b32 s54, s54, 15
    s_ff0_i32_b64 s7, s[54:55]
    s_lshr_b32 s7, s7, 2
    s_max_u32 s37, s37, s7
    buffer_load_dwordx4 v[88:91], v48, s[8:11], s38 offen offset:3072 sc1
    v_mfma_f32_16x16x32_bf16 v[28:31], v[96:99], v[140:143], v[28:31]
    buffer_load_dwordx4 v[92:95], v49, s[8:11], s38 offen offset:3072 sc1
    s_add_u32 s38, s38, 32768
    s_and_b32 s38, s38, 0x3ffff
    s_or_b32 s38, s38, s30
    v_min3_u32 v56, v56, v57, v58
    v_mfma_f32_16x16x32_bf16 v[44:47], v[100:103], v[140:143], v[44:47]
    v_min_u32 v56, v56, v59
    v_mfma_f32_16x16x32_bf16 v[40:43], v[100:103], v[136:139], v[40:43]
    v_cmp_gt_u32 vcc, 2, v56
    v_mfma_f32_16x16x32_bf16 v[36:39], v[100:103], v[132:135], v[36:39]
    s_cbranch_vccnz C2_p3
    C2_p3_r:
    v_mfma_f32_16x16x32_bf16 v[32:35], v[100:103], v[128:131], v[32:35]
    ds_write_b128 v52, v[176:179] offset:16384
    s_waitcnt vmcnt(13) lgkmcnt(1)
    v_mfma_f32_16x16x32_bf16 v[16:19], v[104:107], v[144:147], v[16:19]
    ds_read_b128 v[128:131], v6 offset:0
    ds_read_b128 v[132:135], v6 offset:2048
    v_mfma_f32_16x16x32_bf16 v[20:23], v[104:107], v[148:151], v[20:23]
    ds_read_b128 v[136:139], v6 offset:4096
    ds_read_b128 v[140:143], v6 offset:6144
    v_mfma_f32_16x16x32_bf16 v[24:27], v[104:107], v[152:155], v[24:27]
    s_cmp_gt_u32 s37, 5
    s_cbranch_scc0 C2_h5
    C2_h5_r:
    buffer_load_dwordx4 v[96:99], v48, s[8:11], s38 offen offset:0 sc1
    v_mfma_f32_16x16x32_bf16 v[28:31], v[104:107], v[156:159], v[28:31]
    buffer_load_dwordx4 v[100:103], v49, s[8:11], s38 offen offset:0 sc1
    v_mfma_f32_16x16x32_bf16 v[44:47], v[108:111], v[156:159], v[44:47]
    ds_write_b128 v52, v[180:183] offset:17408
    v_mfma_f32_16x16x32_bf16 v[40:43], v[108:111], v[152:155], v[40:43]
    v_mfma_f32_16x16x32_bf16 v[36:39], v[108:111], v[148:151], v[36:39]
    v_mfma_f32_16x16x32_bf16 v[32:35], v[108:111], v[144:147], v[32:35]
    s_waitcnt vmcnt(13) lgkmcnt(1)
    v_mfma_f32_16x16x32_bf16 v[16:19], v[112:115], v[128:131], v[16:19]
    ds_read_b128 v[144:147], v7 offset:0
    ds_read_b128 v[148:151], v7 offset:2048
    v_mfma_f32_16x16x32_bf16 v[20:23], v[112:115], v[132:135], v[20:23]
    ds_read_b128 v[152:155], v7 offset:4096
    ds_read_b128 v[156:159], v7 offset:6144
    v_mfma_f32_16x16x32_bf16 v[24:27], v[112:115], v[136:139], v[24:27]
    buffer_load_dwordx4 v[104:107], v48, s[8:11], s38 offen offset:1024 sc1
    v_mfma_f32_16x16x32_bf16 v[28:31], v[112:115], v[140:143], v[28:31]
    buffer_load_dwordx4 v[108:111], v49, s[8:11], s38 offen offset:1024 sc1
    v_mfma_f32_16x16x32_bf16 v[44:47], v[116:119], v[140:143], v[44:47]
    ds_write_b128 v52, v[184:187] offset:24576
    v_mfma_f32_16x16x32_bf16 v[40:43], v[116:119], v[136:139], v[40:43]
    v_mfma_f32_16x16x32_bf16 v[36:39], v[116:119], v[132:135], v[36:39]
    v_mfma_f32_16x16x32_bf16 v[32:35], v[116:119], v[128:131], v[32:35]
    s_waitcnt vmcnt(12) lgkmcnt(1)
    v_mfma_f32_16x16x32_bf16 v[16:19], v[120:123], v[144:147], v[16:19]
    ds_read_b128 v[128:131], v4 offset:16384
    ds_read_b128 v[132:135], v4 offset:18432
    v_mfma_f32_16x16x32_bf16 v[20:23], v[120:123], v[148:151], v[20:23]
    ds_read_b128 v[136:139], v4 offset:20480
    ds_read_b128 v[140:143], v4 offset:22528
    v_mfma_f32_16x16x32_bf16 v[24:27], v[120:123], v[152:155], v[24:27]
    ds_write_b128 v52, v[188:191] offset:25600
    v_mfma_f32_16x16x32_bf16 v[28:31], v[120:123], v[156:159], v[28:31]
    v_mov_b32 v1, 4
    ds_write_b32 v63, v1 offset:96
    v_mfma_f32_16x16x32_bf16 v[44:47], v[124:127], v[156:159], v[44:47]
    ds_read_b128 v[56:59], v62 offset:96
    v_mfma_f32_16x16x32_bf16 v[40:43], v[124:127], v[152:155], v[40:43]
    buffer_load_dwordx4 v[112:115], v48, s[8:11], s38 offen offset:2048 sc1
    v_mfma_f32_16x16x32_bf16 v[36:39], v[124:127], v[148:151], v[36:39]
    buffer_load_dwordx4 v[116:119], v49, s[8:11], s38 offen offset:2048 sc1
    v_mfma_f32_16x16x32_bf16 v[32:35], v[124:127], v[144:147], v[32:35]
    s_waitcnt vmcnt(12) lgkmcnt(0)
    v_mfma_f32_16x16x32_bf16 v[16:19], v[64:67], v[128:131], v[16:19]
    ds_read_b128 v[144:147], v5 offset:16384
    ds_read_b128 v[148:151], v5 offset:18432
    v_mfma_f32_16x16x32_bf16 v[20:23], v[64:67], v[132:135], v[20:23]
    ds_read_b128 v[152:155], v5 offset:20480
    ds_read_b128 v[156:159], v5 offset:22528
    v_mfma_f32_16x16x32_bf16 v[24:27], v[64:67], v[136:139], v[24:27]
    v_cmp_eq_u32 vcc, v242, v54
    v_cmp_eq_u32 s[54:55], v243, v55
    s_nop 0
    s_and_b64 s[54:55], s[54:55], vcc
    s_or_b32 s54, s54, 15
    s_ff0_i32_b64 s7, s[54:55]
    s_lshr_b32 s7, s7, 2
    s_max_u32 s37, s37, s7
    buffer_load_dwordx4 v[120:123], v48, s[8:11], s38 offen offset:3072 sc1
    v_mfma_f32_16x16x32_bf16 v[28:31], v[64:67], v[140:143], v[28:31]
    buffer_load_dwordx4 v[124:127], v49, s[8:11], s38 offen offset:3072 sc1
    s_add_u32 s38, s38, 32768
    s_and_b32 s38, s38, 0x3ffff
    s_or_b32 s38, s38, s30
    v_min3_u32 v56, v56, v57, v58
    v_mfma_f32_16x16x32_bf16 v[44:47], v[68:71], v[140:143], v[44:47]
    v_min_u32 v56, v56, v59
    v_mfma_f32_16x16x32_bf16 v[40:43], v[68:71], v[136:139], v[40:43]
    v_cmp_gt_u32 vcc, 3, v56
    v_mfma_f32_16x16x32_bf16 v[36:39], v[68:71], v[132:135], v[36:39]
    s_cbranch_vccnz C2_p4
    C2_p4_r:
    v_mfma_f32_16x16x32_bf16 v[32:35], v[68:71], v[128:131], v[32:35]
    ds_write_b128 v52, v[192:195] offset:32768
    s_waitcnt vmcnt(12) lgkmcnt(1)
    v_mfma_f32_16x16x32_bf16 v[16:19], v[72:75], v[144:147], v[16:19]
    ds_read_b128 v[128:131], v6 offset:16384
    ds_read_b128 v[132:135], v6 offset:18432
    v_mfma_f32_16x16x32_bf16 v[20:23], v[72:75], v[148:151], v[20:23]
    ds_read_b128 v[136:139], v6 offset:20480
    ds_read_b128 v[140:143], v6 offset:22528
    v_mfma_f32_16x16x32_bf16 v[24:27], v[72:75], v[152:155], v[24:27]
    s_cmp_gt_u32 s37, 6
    s_cbranch_scc0 C2_h6
    C2_h6_r:
    buffer_load_dwordx4 v[64:67], v48, s[8:11], s38 offen offset:0 sc1
    v_mfma_f32_16x16x32_bf16 v[28:31], v[72:75], v[156:159], v[28:31]
    buffer_load_dwordx4 v[68:71], v49, s[8:11], s38 offen offset:0 sc1
    v_mfma_f32_16x16x32_bf16 v[44:47], v[76:79], v[156:159], v[44:47]
    ds_write_b128 v52, v[196:199] offset:33792
    v_mfma_f32_16x16x32_bf16 v[40:43], v[76:79], v[152:155], v[40:43]
    v_mfma_f32_16x16x32_bf16 v[36:39], v[76:79], v[148:151], v[36:39]
    v_mfma_f32_16x16x32_bf16 v[32:35], v[76:79], v[144:147], v[32:35]
    s_waitcnt vmcnt(12) lgkmcnt(1)
    v_mfma_f32_16x16x32_bf16 v[16:19], v[80:83], v[128:131], v[16:19]
    ds_read_b128 v[144:147], v7 offset:16384
    ds_read_b128 v[148:151], v7 offset:18432
    v_mfma_f32_16x16x32_bf16 v[20:23], v[80:83], v[132:135], v[20:23]
    ds_read_b128 v[152:155], v7 offset:20480
    ds_read_b128 v[156:159], v7 offset:22528
    v_mfma_f32_16x16x32_bf16 v[24:27], v[80:83], v[136:139], v[24:27]
    buffer_load_dwordx4 v[72:75], v48, s[8:11], s38 offen offset:1024 sc1
    v_mfma_f32_16x16x32_bf16 v[28:31], v[80:83], v[140:143], v[28:31]
    buffer_load_dwordx4 v[76:79], v49, s[8:11], s38 offen offset:1024 sc1
    v_mfma_f32_16x16x32_bf16 v[44:47], v[84:87], v[140:143], v[44:47]
    ds_write_b128 v52, v[200:203] offset:40960
    v_mfma_f32_16x16x32_bf16 v[40:43], v[84:87], v[136:139], v[40:43]
    v_mfma_f32_16x16x32_bf16 v[36:39], v[84:87], v[132:135], v[36:39]
    v_mfma_f32_16x16x32_bf16 v[32:35], v[84:87], v[128:131], v[32:35]
    s_waitcnt vmcnt(12) lgkmcnt(1)
    v_mfma_f32_16x16x32_bf16 v[16:19], v[88:91], v[144:147], v[16:19]
    ds_read_b128 v[128:131], v4 offset:32768
    ds_read_b128 v[132:135], v4 offset:34816
    v_mfma_f32_16x16x32_bf16 v[20:23], v[88:91], v[148:151], v[20:23]
    ds_read_b128 v[136:139], v4 offset:36864
    ds_read_b128 v[140:143], v4 offset:38912
    v_mfma_f32_16x16x32_bf16 v[24:27], v[88:91], v[152:155], v[24:27]
    ds_write_b128 v52, v[204:207] offset:41984
    v_mfma_f32_16x16x32_bf16 v[28:31], v[88:91], v[156:159], v[28:31]
    v_mov_b32 v1, 5
    ds_write_b32 v63, v1 offset:96
    v_mfma_f32_16x16x32_bf16 v[44:47], v[92:95], v[156:159], v[44:47]
    ds_read_b128 v[56:59], v62 offset:96
    v_mfma_f32_16x16x32_bf16 v[40:43], v[92:95], v[152:155], v[40:43]
    buffer_load_dwordx4 v[80:83], v48, s[8:11], s38 offen offset:2048 sc1
    v_mfma_f32_16x16x32_bf16 v[36:39], v[92:95], v[148:151], v[36:39]
    buffer_load_dwordx4 v[84:87], v49, s[8:11], s38 offen offset:2048 sc1
    v_mfma_f32_16x16x32_bf16 v[32:35], v[92:95], v[144:147], v[32:35]
    s_waitcnt vmcnt(12) lgkmcnt(0)
    v_mfma_f32_16x16x32_bf16 v[16:19], v[96:99], v[128:131], v[16:19]
    ds_read_b128 v[144:147], v5 offset:32768
    ds_read_b128 v[148:151], v5 offset:34816
    v_mfma_f32_16x16x32_bf16 v[20:23], v[96:99], v[132:135], v[20:23]
    ds_read_b128 v[152:155], v5 offset:36864
    ds_read_b128 v[156:159], v5 offset:38912
    v_mfma_f32_16x16x32_bf16 v[24:27], v[96:99], v[136:139], v[24:27]
    buffer_load_dwordx4 v[88:91], v48, s[8:11], s38 offen offset:3072 sc1
    buffer_load_dwordx4 v[92:95], v49, s[8:11], s38 offen offset:3072 sc1
    s_add_u32 s38, s38, 32768
    s_and_b32 s38, s38, 0x3ffff
    s_or_b32 s38, s38, s30
    v_mfma_f32_16x16x32_bf16 v[28:31], v[96:99], v[140:143], v[28:31]
    v_min3_u32 v56, v56, v57, v58
    v_mfma_f32_16x16x32_bf16 v[44:47], v[100:103], v[140:143], v[44:47]
    v_min_u32 v56, v56, v59
    v_mfma_f32_16x16x32_bf16 v[40:43], v[100:103], v[136:139], v[40:43]
    v_cmp_gt_u32 vcc, 4, v56
    v_mfma_f32_16x16x32_bf16 v[36:39], v[100:103], v[132:135], v[36:39]
    s_cbranch_vccnz C2_p5
    C2_p5_r:
    v_mfma_f32_16x16x32_bf16 v[32:35], v[100:103], v[128:131], v[32:35]
    ds_write_b128 v53, v[224:227] offset:0
    s_waitcnt vmcnt(12) lgkmcnt(1)
    v_mfma_f32_16x16x32_bf16 v[16:19], v[104:107], v[144:147], v[16:19]
    ds_read_b128 v[128:131], v6 offset:32768
    ds_read_b128 v[132:135], v6 offset:34816
    v_mfma_f32_16x16x32_bf16 v[20:23], v[104:107], v[148:151], v[20:23]
    ds_read_b128 v[136:139], v6 offset:36864
    ds_read_b128 v[140:143], v6 offset:38912
    v_mfma_f32_16x16x32_bf16 v[24:27], v[104:107], v[152:155], v[24:27]
    s_cmp_gt_u32 s37, 7
    s_cbranch_scc0 C2_h7
    C2_h7_r:
    buffer_load_dwordx4 v[96:99], v48, s[8:11], s38 offen offset:0 sc1
    v_mfma_f32_16x16x32_bf16 v[28:31], v[104:107], v[156:159], v[28:31]
    buffer_load_dwordx4 v[100:103], v49, s[8:11], s38 offen offset:0 sc1
    v_mfma_f32_16x16x32_bf16 v[44:47], v[108:111], v[156:159], v[44:47]
    ds_write_b128 v53, v[228:231] offset:1024
    v_mfma_f32_16x16x32_bf16 v[40:43], v[108:111], v[152:155], v[40:43]
    v_mfma_f32_16x16x32_bf16 v[36:39], v[108:111], v[148:151], v[36:39]
    v_mfma_f32_16x16x32_bf16 v[32:35], v[108:111], v[144:147], v[32:35]
    s_waitcnt vmcnt(12) lgkmcnt(1)
    v_mfma_f32_16x16x32_bf16 v[16:19], v[112:115], v[128:131], v[16:19]
    ds_read_b128 v[144:147], v7 offset:32768
    ds_read_b128 v[148:151], v7 offset:34816
    v_mfma_f32_16x16x32_bf16 v[20:23], v[112:115], v[132:135], v[20:23]
    ds_read_b128 v[152:155], v7 offset:36864
    ds_read_b128 v[156:159], v7 offset:38912
    v_mfma_f32_16x16x32_bf16 v[24:27], v[112:115], v[136:139], v[24:27]
    buffer_load_dwordx4 v[104:107], v48, s[8:11], s38 offen offset:1024 sc1
    v_mfma_f32_16x16x32_bf16 v[28:31], v[112:115], v[140:143], v[28:31]
    buffer_load_dwordx4 v[108:111], v49, s[8:11], s38 offen offset:1024 sc1
    v_mfma_f32_16x16x32_bf16 v[44:47], v[116:119], v[140:143], v[44:47]
    ds_write_b128 v53, v[232:235] offset:8192
    v_mfma_f32_16x16x32_bf16 v[40:43], v[116:119], v[136:139], v[40:43]
    v_mfma_f32_16x16x32_bf16 v[36:39], v[116:119], v[132:135], v[36:39]
    v_mfma_f32_16x16x32_bf16 v[32:35], v[116:119], v[128:131], v[32:35]
    s_waitcnt vmcnt(12) lgkmcnt(1)
    v_mfma_f32_16x16x32_bf16 v[16:19], v[120:123], v[144:147], v[16:19]
    ds_read_b128 v[128:131], v8 offset:0
    ds_read_b128 v[132:135], v8 offset:2048
    v_mfma_f32_16x16x32_bf16 v[20:23], v[120:123], v[148:151], v[20:23]
    ds_read_b128 v[136:139], v8 offset:4096
    ds_read_b128 v[140:143], v8 offset:6144
    v_mfma_f32_16x16x32_bf16 v[24:27], v[120:123], v[152:155], v[24:27]
    ds_write_b128 v53, v[236:239] offset:9216
    v_mfma_f32_16x16x32_bf16 v[28:31], v[120:123], v[156:159], v[28:31]
    v_mov_b32 v1, 6
    ds_write_b32 v63, v1 offset:96
    v_mfma_f32_16x16x32_bf16 v[44:47], v[124:127], v[156:159], v[44:47]
    ds_read_b128 v[56:59], v62 offset:96
    v_mfma_f32_16x16x32_bf16 v[40:43], v[124:127], v[152:155], v[40:43]
    buffer_load_dwordx4 v[112:115], v48, s[8:11], s38 offen offset:2048 sc1
    v_mfma_f32_16x16x32_bf16 v[36:39], v[124:127], v[148:151], v[36:39]
    buffer_load_dwordx4 v[116:119], v49, s[8:11], s38 offen offset:2048 sc1
    v_mfma_f32_16x16x32_bf16 v[32:35], v[124:127], v[144:147], v[32:35]
    s_waitcnt vmcnt(12) lgkmcnt(0)
    v_mfma_f32_16x16x32_bf16 v[16:19], v[64:67], v[128:131], v[16:19]
    ds_read_b128 v[144:147], v9 offset:0
    ds_read_b128 v[148:151], v9 offset:2048
    v_mfma_f32_16x16x32_bf16 v[20:23], v[64:67], v[132:135], v[20:23]
    ds_read_b128 v[152:155], v9 offset:4096
    ds_read_b128 v[156:159], v9 offset:6144
    v_mfma_f32_16x16x32_bf16 v[24:27], v[64:67], v[136:139], v[24:27]
    buffer_load_dwordx4 v[120:123], v48, s[8:11], s38 offen offset:3072 sc1
    buffer_load_dwordx4 v[124:127], v49, s[8:11], s38 offen offset:3072 sc1
    s_add_u32 s38, s38, 32768
    s_and_b32 s38, s38, 0x3ffff
    s_or_b32 s38, s38, s31
    v_mfma_f32_16x16x32_bf16 v[28:31], v[64:67], v[140:143], v[28:31]
    v_min3_u32 v56, v56, v57, v58
    v_mfma_f32_16x16x32_bf16 v[44:47], v[68:71], v[140:143], v[44:47]
    v_min_u32 v56, v56, v59
    v_mfma_f32_16x16x32_bf16 v[40:43], v[68:71], v[136:139], v[40:43]
    v_cmp_gt_u32 vcc, 5, v56
    v_mfma_f32_16x16x32_bf16 v[36:39], v[68:71], v[132:135], v[36:39]
    s_cbranch_vccnz C2_p6
    C2_p6_r:
    v_mfma_f32_16x16x32_bf16 v[32:35], v[68:71], v[128:131], v[32:35]
    ds_write_b128 v53, v[208:211] offset:16384
    s_waitcnt vmcnt(12) lgkmcnt(1)
    v_mfma_f32_16x16x32_bf16 v[16:19], v[72:75], v[144:147], v[16:19]
    ds_read_b128 v[128:131], v10 offset:0
    ds_read_b128 v[132:135], v10 offset:2048
    v_mfma_f32_16x16x32_bf16 v[20:23], v[72:75], v[148:151], v[20:23]
    ds_read_b128 v[136:139], v10 offset:4096
    ds_read_b128 v[140:143], v10 offset:6144
    v_mfma_f32_16x16x32_bf16 v[24:27], v[72:75], v[152:155], v[24:27]
    s_cmp_gt_u32 s37, 8
    s_cbranch_scc0 C2_h8
    C2_h8_r:
    buffer_load_dwordx4 v[64:67], v48, s[8:11], s38 offen offset:0 sc1
    v_mfma_f32_16x16x32_bf16 v[28:31], v[72:75], v[156:159], v[28:31]
    buffer_load_dwordx4 v[68:71], v49, s[8:11], s38 offen offset:0 sc1
    v_mfma_f32_16x16x32_bf16 v[44:47], v[76:79], v[156:159], v[44:47]
    ds_write_b128 v53, v[212:215] offset:17408
    v_mfma_f32_16x16x32_bf16 v[40:43], v[76:79], v[152:155], v[40:43]
    v_mfma_f32_16x16x32_bf16 v[36:39], v[76:79], v[148:151], v[36:39]
    v_mfma_f32_16x16x32_bf16 v[32:35], v[76:79], v[144:147], v[32:35]
    s_waitcnt vmcnt(12) lgkmcnt(1)
    v_mfma_f32_16x16x32_bf16 v[16:19], v[80:83], v[128:131], v[16:19]
    ds_read_b128 v[144:147], v11 offset:0
    ds_read_b128 v[148:151], v11 offset:2048
    v_mfma_f32_16x16x32_bf16 v[20:23], v[80:83], v[132:135], v[20:23]
    ds_read_b128 v[152:155], v11 offset:4096
    ds_read_b128 v[156:159], v11 offset:6144
    v_mfma_f32_16x16x32_bf16 v[24:27], v[80:83], v[136:139], v[24:27]
    buffer_load_dwordx4 v[72:75], v48, s[8:11], s38 offen offset:1024 sc1
    v_mfma_f32_16x16x32_bf16 v[28:31], v[80:83], v[140:143], v[28:31]
    buffer_load_dwordx4 v[76:79], v49, s[8:11], s38 offen offset:1024 sc1
    v_mfma_f32_16x16x32_bf16 v[44:47], v[84:87], v[140:143], v[44:47]
    ds_write_b128 v53, v[216:219] offset:24576
    v_mfma_f32_16x16x32_bf16 v[40:43], v[84:87], v[136:139], v[40:43]
    v_mfma_f32_16x16x32_bf16 v[36:39], v[84:87], v[132:135], v[36:39]
    v_mfma_f32_16x16x32_bf16 v[32:35], v[84:87], v[128:131], v[32:35]
    s_waitcnt vmcnt(12) lgkmcnt(1)
    v_mfma_f32_16x16x32_bf16 v[16:19], v[88:91], v[144:147], v[16:19]
    ds_read_b128 v[128:131], v8 offset:16384
    ds_read_b128 v[132:135], v8 offset:18432
    v_mfma_f32_16x16x32_bf16 v[20:23], v[88:91], v[148:151], v[20:23]
    ds_read_b128 v[136:139], v8 offset:20480
    ds_read_b128 v[140:143], v8 offset:22528
    v_mfma_f32_16x16x32_bf16 v[24:27], v[88:91], v[152:155], v[24:27]
    ds_write_b128 v53, v[220:223] offset:25600
    v_mfma_f32_16x16x32_bf16 v[28:31], v[88:91], v[156:159], v[28:31]
    v_mov_b32 v1, 7
    ds_write_b32 v63, v1 offset:96
    v_mfma_f32_16x16x32_bf16 v[44:47], v[92:95], v[156:159], v[44:47]
    ds_read_b128 v[56:59], v62 offset:96
    v_mfma_f32_16x16x32_bf16 v[40:43], v[92:95], v[152:155], v[40:43]
    buffer_load_dwordx4 v[80:83], v48, s[8:11], s38 offen offset:2048 sc1
    v_mfma_f32_16x16x32_bf16 v[36:39], v[92:95], v[148:151], v[36:39]
    buffer_load_dwordx4 v[84:87], v49, s[8:11], s38 offen offset:2048 sc1
    v_mfma_f32_16x16x32_bf16 v[32:35], v[92:95], v[144:147], v[32:35]
    s_waitcnt vmcnt(12) lgkmcnt(0)
    v_mfma_f32_16x16x32_bf16 v[16:19], v[96:99], v[128:131], v[16:19]
    ds_read_b128 v[144:147], v9 offset:16384
    ds_read_b128 v[148:151], v9 offset:18432
    v_mfma_f32_16x16x32_bf16 v[20:23], v[96:99], v[132:135], v[20:23]
    ds_read_b128 v[152:155], v9 offset:20480
    ds_read_b128 v[156:159], v9 offset:22528
    v_mfma_f32_16x16x32_bf16 v[24:27], v[96:99], v[136:139], v[24:27]
    buffer_load_dwordx4 v[88:91], v48, s[8:11], s38 offen offset:3072 sc1
    v_mfma_f32_16x16x32_bf16 v[28:31], v[96:99], v[140:143], v[28:31]
    buffer_load_dwordx4 v[92:95], v49, s[8:11], s38 offen offset:3072 sc1
    s_add_u32 s38, s38, 32768
    s_and_b32 s38, s38, 0x3ffff
    s_or_b32 s38, s38, s31
    v_mfma_f32_16x16x32_bf16 v[44:47], v[100:103], v[140:143], v[44:47]
    v_min3_u32 v56, v56, v57, v58
    v_mfma_f32_16x16x32_bf16 v[40:43], v[100:103], v[136:139], v[40:43]
    v_min_u32 v56, v56, v59
    v_mfma_f32_16x16x32_bf16 v[36:39], v[100:103], v[132:135], v[36:39]
    v_cmp_gt_u32 vcc, 6, v56
    v_mfma_f32_16x16x32_bf16 v[32:35], v[100:103], v[128:131], v[32:35]
    s_cbranch_vccnz C2_p7
    C2_p7_r:
    s_waitcnt vmcnt(12) lgkmcnt(0)
    v_mfma_f32_16x16x32_bf16 v[16:19], v[104:107], v[144:147], v[16:19]
    ds_read_b128 v[128:131], v10 offset:16384
    ds_read_b128 v[132:135], v10 offset:18432
    v_mfma_f32_16x16x32_bf16 v[20:23], v[104:107], v[148:151], v[20:23]
    ds_read_b128 v[136:139], v10 offset:20480
    ds_read_b128 v[140:143], v10 offset:22528
    v_mfma_f32_16x16x32_bf16 v[24:27], v[104:107], v[152:155], v[24:27]
    s_cmp_gt_u32 s37, 9
    s_cbranch_scc0 C2_h9
    C2_h9_r:
    buffer_load_dwordx4 v[96:99], v48, s[8:11], s38 offen offset:0 sc1
    v_mfma_f32_16x16x32_bf16 v[28:31], v[104:107], v[156:159], v[28:31]
    buffer_load_dwordx4 v[100:103], v49, s[8:11], s38 offen offset:0 sc1
    v_mfma_f32_16x16x32_bf16 v[44:47], v[108:111], v[156:159], v[44:47]
    v_mfma_f32_16x16x32_bf16 v[40:43], v[108:111], v[152:155], v[40:43]
    v_mfma_f32_16x16x32_bf16 v[36:39], v[108:111], v[148:151], v[36:39]
    v_mfma_f32_16x16x32_bf16 v[32:35], v[108:111], v[144:147], v[32:35]
    s_waitcnt vmcnt(12) lgkmcnt(0)
    v_mfma_f32_16x16x32_bf16 v[16:19], v[112:115], v[128:131], v[16:19]
    ds_read_b128 v[144:147], v11 offset:16384
    ds_read_b128 v[148:151], v11 offset:18432
    v_mfma_f32_16x16x32_bf16 v[20:23], v[112:115], v[132:135], v[20:23]
    ds_read_b128 v[152:155], v11 offset:20480
    ds_read_b128 v[156:159], v11 offset:22528
    v_mfma_f32_16x16x32_bf16 v[24:27], v[112:115], v[136:139], v[24:27]
    buffer_load_dwordx4 v[104:107], v48, s[8:11], s38 offen offset:1024 sc1
    v_mfma_f32_16x16x32_bf16 v[28:31], v[112:115], v[140:143], v[28:31]
    buffer_load_dwordx4 v[108:111], v49, s[8:11], s38 offen offset:1024 sc1
    v_mfma_f32_16x16x32_bf16 v[44:47], v[116:119], v[140:143], v[44:47]
    v_mfma_f32_16x16x32_bf16 v[40:43], v[116:119], v[136:139], v[40:43]
    v_mfma_f32_16x16x32_bf16 v[36:39], v[116:119], v[132:135], v[36:39]
    v_mfma_f32_16x16x32_bf16 v[32:35], v[116:119], v[128:131], v[32:35]
    s_waitcnt vmcnt(12) lgkmcnt(0)
    v_mfma_f32_16x16x32_bf16 v[16:19], v[120:123], v[144:147], v[16:19]
    ds_read_b128 v[128:131], v8 offset:32768
    ds_read_b128 v[132:135], v8 offset:34816
    v_mfma_f32_16x16x32_bf16 v[20:23], v[120:123], v[148:151], v[20:23]
    ds_read_b128 v[136:139], v8 offset:36864
    ds_read_b128 v[140:143], v8 offset:38912
    v_mfma_f32_16x16x32_bf16 v[24:27], v[120:123], v[152:155], v[24:27]
    v_mov_b32 v1, 8
    ds_write_b32 v63, v1 offset:96
    v_mfma_f32_16x16x32_bf16 v[28:31], v[120:123], v[156:159], v[28:31]
    ds_read_b128 v[56:59], v62 offset:96
    v_mfma_f32_16x16x32_bf16 v[44:47], v[124:127], v[156:159], v[44:47]
    buffer_load_dwordx4 v[112:115], v48, s[8:11], s38 offen offset:2048 sc1
    v_mfma_f32_16x16x32_bf16 v[40:43], v[124:127], v[152:155], v[40:43]
    buffer_load_dwordx4 v[116:119], v49, s[8:11], s38 offen offset:2048 sc1
    v_mfma_f32_16x16x32_bf16 v[36:39], v[124:127], v[148:151], v[36:39]
    v_mfma_f32_16x16x32_bf16 v[32:35], v[124:127], v[144:147], v[32:35]
    s_waitcnt vmcnt(12) lgkmcnt(0)
    v_mfma_f32_16x16x32_bf16 v[16:19], v[64:67], v[128:131], v[16:19]
    ds_read_b128 v[144:147], v9 offset:32768
    ds_read_b128 v[148:151], v9 offset:34816
    v_mfma_f32_16x16x32_bf16 v[20:23], v[64:67], v[132:135], v[20:23]
    ds_read_b128 v[152:155], v9 offset:36864
    ds_read_b128 v[156:159], v9 offset:38912
    v_mfma_f32_16x16x32_bf16 v[24:27], v[64:67], v[136:139], v[24:27]
    buffer_load_dwordx4 v[120:123], v48, s[8:11], s38 offen offset:3072 sc1
    v_mfma_f32_16x16x32_bf16 v[28:31], v[64:67], v[140:143], v[28:31]
    buffer_load_dwordx4 v[124:127], v49, s[8:11], s38 offen offset:3072 sc1
    s_add_u32 s38, s38, 32768
    s_and_b32 s38, s38, 0x3ffff
    s_or_b32 s38, s38, s31
    v_mfma_f32_16x16x32_bf16 v[44:47], v[68:71], v[140:143], v[44:47]
    v_min3_u32 v56, v56, v57, v58
    v_mfma_f32_16x16x32_bf16 v[40:43], v[68:71], v[136:139], v[40:43]
    v_min_u32 v56, v56, v59
    v_mfma_f32_16x16x32_bf16 v[36:39], v[68:71], v[132:135], v[36:39]
    v_cmp_gt_u32 vcc, 7, v56
    v_mfma_f32_16x16x32_bf16 v[32:35], v[68:71], v[128:131], v[32:35]
    s_cbranch_vccnz C2_p8
    C2_p8_r:
    s_waitcnt vmcnt(12) lgkmcnt(0)
    v_mfma_f32_16x16x32_bf16 v[16:19], v[72:75], v[144:147], v[16:19]
    ds_read_b128 v[128:131], v10 offset:32768
    ds_read_b128 v[132:135], v10 offset:34816
    v_mfma_f32_16x16x32_bf16 v[20:23], v[72:75], v[148:151], v[20:23]
    ds_read_b128 v[136:139], v10 offset:36864
    ds_read_b128 v[140:143], v10 offset:38912
    v_mfma_f32_16x16x32_bf16 v[24:27], v[72:75], v[152:155], v[24:27]
    s_cmp_gt_u32 s37, 10
    s_cbranch_scc0 C2_h10
    C2_h10_r:
    buffer_load_dwordx4 v[64:67], v48, s[8:11], s38 offen offset:0 sc1
    v_mfma_f32_16x16x32_bf16 v[28:31], v[72:75], v[156:159], v[28:31]
    buffer_load_dwordx4 v[68:71], v49, s[8:11], s38 offen offset:0 sc1
    v_mfma_f32_16x16x32_bf16 v[44:47], v[76:79], v[156:159], v[44:47]
    v_mfma_f32_16x16x32_bf16 v[40:43], v[76:79], v[152:155], v[40:43]
    v_mfma_f32_16x16x32_bf16 v[36:39], v[76:79], v[148:151], v[36:39]
    v_mfma_f32_16x16x32_bf16 v[32:35], v[76:79], v[144:147], v[32:35]
    s_waitcnt vmcnt(12) lgkmcnt(0)
    v_mfma_f32_16x16x32_bf16 v[16:19], v[80:83], v[128:131], v[16:19]
    ds_read_b128 v[144:147], v11 offset:32768
    ds_read_b128 v[148:151], v11 offset:34816
    v_mfma_f32_16x16x32_bf16 v[20:23], v[80:83], v[132:135], v[20:23]
    ds_read_b128 v[152:155], v11 offset:36864
    ds_read_b128 v[156:159], v11 offset:38912
    v_mfma_f32_16x16x32_bf16 v[24:27], v[80:83], v[136:139], v[24:27]
    buffer_load_dwordx4 v[72:75], v48, s[8:11], s38 offen offset:1024 sc1
    v_mfma_f32_16x16x32_bf16 v[28:31], v[80:83], v[140:143], v[28:31]
    buffer_load_dwordx4 v[76:79], v49, s[8:11], s38 offen offset:1024 sc1
    v_mfma_f32_16x16x32_bf16 v[44:47], v[84:87], v[140:143], v[44:47]
    v_mfma_f32_16x16x32_bf16 v[40:43], v[84:87], v[136:139], v[40:43]
    v_mfma_f32_16x16x32_bf16 v[36:39], v[84:87], v[132:135], v[36:39]
    v_mfma_f32_16x16x32_bf16 v[32:35], v[84:87], v[128:131], v[32:35]
    s_waitcnt vmcnt(12) lgkmcnt(0)
    v_mfma_f32_16x16x32_bf16 v[16:19], v[88:91], v[144:147], v[16:19]
    ds_read_b128 v[128:131], v4 offset:0
    ds_read_b128 v[132:135], v4 offset:2048
    v_mfma_f32_16x16x32_bf16 v[20:23], v[88:91], v[148:151], v[20:23]
    ds_read_b128 v[136:139], v4 offset:4096
    ds_read_b128 v[140:143], v4 offset:6144
    v_mfma_f32_16x16x32_bf16 v[24:27], v[88:91], v[152:155], v[24:27]
    v_mov_b32 v1, 9
    ds_write_b32 v63, v1 offset:96
    v_mfma_f32_16x16x32_bf16 v[28:31], v[88:91], v[156:159], v[28:31]
    buffer_load_dwordx4 v[80:83], v48, s[8:11], s38 offen offset:2048 sc1
    v_mfma_f32_16x16x32_bf16 v[44:47], v[92:95], v[156:159], v[44:47]
    buffer_load_dwordx4 v[84:87], v49, s[8:11], s38 offen offset:2048 sc1
    v_mfma_f32_16x16x32_bf16 v[40:43], v[92:95], v[152:155], v[40:43]
    v_mfma_f32_16x16x32_bf16 v[36:39], v[92:95], v[148:151], v[36:39]
    v_mfma_f32_16x16x32_bf16 v[32:35], v[92:95], v[144:147], v[32:35]
    s_waitcnt vmcnt(12) lgkmcnt(1)
    v_mfma_f32_16x16x32_bf16 v[16:19], v[96:99], v[128:131], v[16:19]
    ds_read_b128 v[144:147], v5 offset:0
    ds_read_b128 v[148:151], v5 offset:2048
    v_mfma_f32_16x16x32_bf16 v[20:23], v[96:99], v[132:135], v[20:23]
    ds_read_b128 v[152:155], v5 offset:4096
    ds_read_b128 v[156:159], v5 offset:6144
    v_mfma_f32_16x16x32_bf16 v[24:27], v[96:99], v[136:139], v[24:27]
    buffer_load_dwordx4 v[88:91], v48, s[8:11], s38 offen offset:3072 sc1
    v_mfma_f32_16x16x32_bf16 v[28:31], v[96:99], v[140:143], v[28:31]
    buffer_load_dwordx4 v[92:95], v49, s[8:11], s38 offen offset:3072 sc1
    s_add_u32 s38, s38, 32768
    s_and_b32 s38, s38, 0x3ffff
    s_or_b32 s38, s38, s31
    v_mfma_f32_16x16x32_bf16 v[44:47], v[100:103], v[140:143], v[44:47]
    v_mfma_f32_16x16x32_bf16 v[40:43], v[100:103], v[136:139], v[40:43]
    v_mfma_f32_16x16x32_bf16 v[36:39], v[100:103], v[132:135], v[36:39]
    v_mfma_f32_16x16x32_bf16 v[32:35], v[100:103], v[128:131], v[32:35]
    s_waitcnt vmcnt(12) lgkmcnt(0)
    v_mfma_f32_16x16x32_bf16 v[16:19], v[104:107], v[144:147], v[16:19]
    ds_read_b128 v[128:131], v6 offset:0
    ds_read_b128 v[132:135], v6 offset:2048
    v_mfma_f32_16x16x32_bf16 v[20:23], v[104:107], v[148:151], v[20:23]
    ds_read_b128 v[136:139], v6 offset:4096
    ds_read_b128 v[140:143], v6 offset:6144
    v_mfma_f32_16x16x32_bf16 v[24:27], v[104:107], v[152:155], v[24:27]
    s_cmp_gt_u32 s37, 11
    s_cbranch_scc0 C2_h11
    C2_h11_r:
    buffer_load_dwordx4 v[96:99], v48, s[8:11], s38 offen offset:0 sc1
    v_mfma_f32_16x16x32_bf16 v[28:31], v[104:107], v[156:159], v[28:31]
    buffer_load_dwordx4 v[100:103], v49, s[8:11], s38 offen offset:0 sc1
    v_mfma_f32_16x16x32_bf16 v[44:47], v[108:111], v[156:159], v[44:47]
    v_mfma_f32_16x16x32_bf16 v[40:43], v[108:111], v[152:155], v[40:43]
    v_mfma_f32_16x16x32_bf16 v[36:39], v[108:111], v[148:151], v[36:39]
    v_mfma_f32_16x16x32_bf16 v[32:35], v[108:111], v[144:147], v[32:35]
    s_waitcnt vmcnt(12) lgkmcnt(0)
    v_mfma_f32_16x16x32_bf16 v[16:19], v[112:115], v[128:131], v[16:19]
    ds_read_b128 v[144:147], v7 offset:0
    ds_read_b128 v[148:151], v7 offset:2048
    v_mfma_f32_16x16x32_bf16 v[20:23], v[112:115], v[132:135], v[20:23]
    ds_read_b128 v[152:155], v7 offset:4096
    ds_read_b128 v[156:159], v7 offset:6144
    v_mfma_f32_16x16x32_bf16 v[24:27], v[112:115], v[136:139], v[24:27]
    buffer_load_dwordx4 v[104:107], v48, s[8:11], s38 offen offset:1024 sc1
    v_mfma_f32_16x16x32_bf16 v[28:31], v[112:115], v[140:143], v[28:31]
    buffer_load_dwordx4 v[108:111], v49, s[8:11], s38 offen offset:1024 sc1
    v_mfma_f32_16x16x32_bf16 v[44:47], v[116:119], v[140:143], v[44:47]
    v_mfma_f32_16x16x32_bf16 v[40:43], v[116:119], v[136:139], v[40:43]
    v_mfma_f32_16x16x32_bf16 v[36:39], v[116:119], v[132:135], v[36:39]
    v_mfma_f32_16x16x32_bf16 v[32:35], v[116:119], v[128:131], v[32:35]
    s_waitcnt vmcnt(12) lgkmcnt(0)
    v_mfma_f32_16x16x32_bf16 v[16:19], v[120:123], v[144:147], v[16:19]
    ds_read_b128 v[128:131], v4 offset:16384
    ds_read_b128 v[132:135], v4 offset:18432
    v_mfma_f32_16x16x32_bf16 v[20:23], v[120:123], v[148:151], v[20:23]
    ds_read_b128 v[136:139], v4 offset:20480
    ds_read_b128 v[140:143], v4 offset:22528
    v_mfma_f32_16x16x32_bf16 v[24:27], v[120:123], v[152:155], v[24:27]
    v_mov_b32 v1, 10
    ds_write_b32 v63, v1 offset:96
    v_mfma_f32_16x16x32_bf16 v[28:31], v[120:123], v[156:159], v[28:31]
    ds_read_b128 v[12:15], v62 offset:48
    v_mfma_f32_16x16x32_bf16 v[44:47], v[124:127], v[156:159], v[44:47]
    buffer_load_dwordx4 v[112:115], v48, s[8:11], s38 offen offset:2048 sc1
    v_mfma_f32_16x16x32_bf16 v[40:43], v[124:127], v[152:155], v[40:43]
    buffer_load_dwordx4 v[116:119], v49, s[8:11], s38 offen offset:2048 sc1
    v_mfma_f32_16x16x32_bf16 v[36:39], v[124:127], v[148:151], v[36:39]
    v_mfma_f32_16x16x32_bf16 v[32:35], v[124:127], v[144:147], v[32:35]
    s_waitcnt vmcnt(12) lgkmcnt(0)
    v_mfma_f32_16x16x32_bf16 v[16:19], v[64:67], v[128:131], v[16:19]
    ds_read_b128 v[144:147], v5 offset:16384
    ds_read_b128 v[148:151], v5 offset:18432
    v_mfma_f32_16x16x32_bf16 v[20:23], v[64:67], v[132:135], v[20:23]
    ds_read_b128 v[152:155], v5 offset:20480
    ds_read_b128 v[156:159], v5 offset:22528
    v_mfma_f32_16x16x32_bf16 v[24:27], v[64:67], v[136:139], v[24:27]
    buffer_load_dwordx4 v[120:123], v48, s[8:11], s38 offen offset:3072 sc1
    v_mfma_f32_16x16x32_bf16 v[28:31], v[64:67], v[140:143], v[28:31]
    buffer_load_dwordx4 v[124:127], v49, s[8:11], s38 offen offset:3072 sc1
    s_add_u32 s38, s38, 32768
    s_and_b32 s38, s38, 0x3ffff
    s_or_b32 s38, s38, s31
    v_mfma_f32_16x16x32_bf16 v[44:47], v[68:71], v[140:143], v[44:47]
    v_min3_u32 v12, v12, v13, v14
    v_mfma_f32_16x16x32_bf16 v[40:43], v[68:71], v[136:139], v[40:43]
    v_min_u32 v12, v12, v15
    v_mfma_f32_16x16x32_bf16 v[36:39], v[68:71], v[132:135], v[36:39]
    v_cmp_gt_u32 vcc, 12, v12
    v_mfma_f32_16x16x32_bf16 v[32:35], v[68:71], v[128:131], v[32:35]
    s_cbranch_vccnz C2_q10
    C2_q10_r:
    s_waitcnt vmcnt(12) lgkmcnt(0)
    v_mfma_f32_16x16x32_bf16 v[16:19], v[72:75], v[144:147], v[16:19]
    ds_read_b128 v[128:131], v6 offset:16384
    ds_read_b128 v[132:135], v6 offset:18432
    v_mfma_f32_16x16x32_bf16 v[20:23], v[72:75], v[148:151], v[20:23]
    ds_read_b128 v[136:139], v6 offset:20480
    ds_read_b128 v[140:143], v6 offset:22528
    v_mfma_f32_16x16x32_bf16 v[24:27], v[72:75], v[152:155], v[24:27]
    s_cmp_gt_u32 s37, 12
    s_cbranch_scc0 C2_h12
    C2_h12_r:
    buffer_load_dwordx4 v[64:67], v48, s[8:11], s38 offen offset:0 sc1
    v_mfma_f32_16x16x32_bf16 v[28:31], v[72:75], v[156:159], v[28:31]
    buffer_load_dwordx4 v[68:71], v49, s[8:11], s38 offen offset:0 sc1
    v_mfma_f32_16x16x32_bf16 v[44:47], v[76:79], v[156:159], v[44:47]
    v_mfma_f32_16x16x32_bf16 v[40:43], v[76:79], v[152:155], v[40:43]
    v_mfma_f32_16x16x32_bf16 v[36:39], v[76:79], v[148:151], v[36:39]
    v_mfma_f32_16x16x32_bf16 v[32:35], v[76:79], v[144:147], v[32:35]
    s_waitcnt vmcnt(12) lgkmcnt(0)
    v_mfma_f32_16x16x32_bf16 v[16:19], v[80:83], v[128:131], v[16:19]
    ds_read_b128 v[144:147], v7 offset:16384
    ds_read_b128 v[148:151], v7 offset:18432
    v_mfma_f32_16x16x32_bf16 v[20:23], v[80:83], v[132:135], v[20:23]
    ds_read_b128 v[152:155], v7 offset:20480
    ds_read_b128 v[156:159], v7 offset:22528
    v_mfma_f32_16x16x32_bf16 v[24:27], v[80:83], v[136:139], v[24:27]
    buffer_load_dwordx4 v[72:75], v48, s[8:11], s38 offen offset:1024 sc1
    v_mfma_f32_16x16x32_bf16 v[28:31], v[80:83], v[140:143], v[28:31]
    buffer_load_dwordx4 v[76:79], v49, s[8:11], s38 offen offset:1024 sc1
    v_mfma_f32_16x16x32_bf16 v[44:47], v[84:87], v[140:143], v[44:47]
    v_mfma_f32_16x16x32_bf16 v[40:43], v[84:87], v[136:139], v[40:43]
    v_mfma_f32_16x16x32_bf16 v[36:39], v[84:87], v[132:135], v[36:39]
    v_mfma_f32_16x16x32_bf16 v[32:35], v[84:87], v[128:131], v[32:35]
    s_waitcnt vmcnt(12) lgkmcnt(0)
    v_mfma_f32_16x16x32_bf16 v[16:19], v[88:91], v[144:147], v[16:19]
    ds_read_b128 v[128:131], v4 offset:32768
    ds_read_b128 v[132:135], v4 offset:34816
    v_mfma_f32_16x16x32_bf16 v[20:23], v[88:91], v[148:151], v[20:23]
    ds_read_b128 v[136:139], v4 offset:36864
    ds_read_b128 v[140:143], v4 offset:38912
    v_mfma_f32_16x16x32_bf16 v[24:27], v[88:91], v[152:155], v[24:27]
    v_mov_b32 v1, 11
    ds_write_b32 v63, v1 offset:96
    v_mfma_f32_16x16x32_bf16 v[28:31], v[88:91], v[156:159], v[28:31]
    ds_read_b128 v[12:15], v62 offset:48
    v_mfma_f32_16x16x32_bf16 v[44:47], v[92:95], v[156:159], v[44:47]
    buffer_load_dwordx4 v[80:83], v48, s[8:11], s38 offen offset:2048 sc1
    v_mfma_f32_16x16x32_bf16 v[40:43], v[92:95], v[152:155], v[40:43]
    buffer_load_dwordx4 v[84:87], v49, s[8:11], s38 offen offset:2048 sc1
    v_mfma_f32_16x16x32_bf16 v[36:39], v[92:95], v[148:151], v[36:39]
    v_mfma_f32_16x16x32_bf16 v[32:35], v[92:95], v[144:147], v[32:35]
    s_waitcnt vmcnt(12) lgkmcnt(0)
    v_mfma_f32_16x16x32_bf16 v[16:19], v[96:99], v[128:131], v[16:19]
    ds_read_b128 v[144:147], v5 offset:32768
    ds_read_b128 v[148:151], v5 offset:34816
    v_mfma_f32_16x16x32_bf16 v[20:23], v[96:99], v[132:135], v[20:23]
    ds_read_b128 v[152:155], v5 offset:36864
    ds_read_b128 v[156:159], v5 offset:38912
    v_mfma_f32_16x16x32_bf16 v[24:27], v[96:99], v[136:139], v[24:27]
    buffer_load_dwordx4 v[88:91], v48, s[8:11], s38 offen offset:3072 sc1
    v_mfma_f32_16x16x32_bf16 v[28:31], v[96:99], v[140:143], v[28:31]
    buffer_load_dwordx4 v[92:95], v49, s[8:11], s38 offen offset:3072 sc1
    s_add_u32 s40, s38, 32768
    s_and_b32 s40, s40, 0x3ffff
    s_or_b32 s40, s40, s31
    s_add_u32 s41, s38, 65536
    s_and_b32 s41, s41, 0x3ffff
    s_or_b32 s41, s41, s31
    s_add_u32 s42, s38, 98304
    s_and_b32 s42, s42, 0x3ffff
    s_or_b32 s42, s42, s31
    v_mfma_f32_16x16x32_bf16 v[44:47], v[100:103], v[140:143], v[44:47]
    v_min3_u32 v12, v12, v13, v14
    v_mfma_f32_16x16x32_bf16 v[40:43], v[100:103], v[136:139], v[40:43]
    v_min_u32 v12, v12, v15
    v_mfma_f32_16x16x32_bf16 v[36:39], v[100:103], v[132:135], v[36:39]
    v_cmp_gt_u32 vcc, 13, v12
    v_mfma_f32_16x16x32_bf16 v[32:35], v[100:103], v[128:131], v[32:35]
    s_cbranch_vccnz C2_q11
    C2_q11_r:
    s_waitcnt vmcnt(12) lgkmcnt(0)
    v_mfma_f32_16x16x32_bf16 v[16:19], v[104:107], v[144:147], v[16:19]
    ds_read_b128 v[128:131], v6 offset:32768
    ds_read_b128 v[132:135], v6 offset:34816
    v_mfma_f32_16x16x32_bf16 v[20:23], v[104:107], v[148:151], v[20:23]
    ds_read_b128 v[136:139], v6 offset:36864
    ds_read_b128 v[140:143], v6 offset:38912
    v_mfma_f32_16x16x32_bf16 v[24:27], v[104:107], v[152:155], v[24:27]
    s_cmp_gt_u32 s37, 13
    s_cbranch_scc0 C2_h13
    C2_h13_r:
    buffer_load_dwordx4 v[96:99], v48, s[8:11], s40 offen offset:0 sc1
    v_mfma_f32_16x16x32_bf16 v[28:31], v[104:107], v[156:159], v[28:31]
    buffer_load_dwordx4 v[100:103], v48, s[8:11], s40 offen offset:1024 sc1
    v_mfma_f32_16x16x32_bf16 v[44:47], v[108:111], v[156:159], v[44:47]
    v_mfma_f32_16x16x32_bf16 v[40:43], v[108:111], v[152:155], v[40:43]
    v_mfma_f32_16x16x32_bf16 v[36:39], v[108:111], v[148:151], v[36:39]
    v_mfma_f32_16x16x32_bf16 v[32:35], v[108:111], v[144:147], v[32:35]
    s_waitcnt vmcnt(12) lgkmcnt(0)
    v_mfma_f32_16x16x32_bf16 v[16:19], v[112:115], v[128:131], v[16:19]
    ds_read_b128 v[144:147], v7 offset:32768
    ds_read_b128 v[148:151], v7 offset:34816
    v_mfma_f32_16x16x32_bf16 v[20:23], v[112:115], v[132:135], v[20:23]
    ds_read_b128 v[152:155], v7 offset:36864
    ds_read_b128 v[156:159], v7 offset:38912
    v_mfma_f32_16x16x32_bf16 v[24:27], v[112:115], v[136:139], v[24:27]
    buffer_load_dwordx4 v[104:107], v48, s[8:11], s40 offen offset:2048 sc1
    v_mfma_f32_16x16x32_bf16 v[28:31], v[112:115], v[140:143], v[28:31]
    buffer_load_dwordx4 v[108:111], v48, s[8:11], s40 offen offset:3072 sc1
    v_mfma_f32_16x16x32_bf16 v[44:47], v[116:119], v[140:143], v[44:47]
    v_mfma_f32_16x16x32_bf16 v[40:43], v[116:119], v[136:139], v[40:43]
    v_mfma_f32_16x16x32_bf16 v[36:39], v[116:119], v[132:135], v[36:39]
    v_mfma_f32_16x16x32_bf16 v[32:35], v[116:119], v[128:131], v[32:35]
    s_waitcnt vmcnt(12) lgkmcnt(0)
    v_mfma_f32_16x16x32_bf16 v[16:19], v[120:123], v[144:147], v[16:19]
    ds_read_b128 v[128:131], v8 offset:0
    ds_read_b128 v[132:135], v8 offset:2048
    v_mfma_f32_16x16x32_bf16 v[20:23], v[120:123], v[148:151], v[20:23]
    ds_read_b128 v[136:139], v8 offset:4096
    ds_read_b128 v[140:143], v8 offset:6144
    v_mfma_f32_16x16x32_bf16 v[24:27], v[120:123], v[152:155], v[24:27]
    v_mov_b32 v1, 12
    ds_write_b32 v63, v1 offset:96
    v_mfma_f32_16x16x32_bf16 v[28:31], v[120:123], v[156:159], v[28:31]
    ds_read_b128 v[12:15], v62 offset:48
    v_mfma_f32_16x16x32_bf16 v[44:47], v[124:127], v[156:159], v[44:47]
    s_cmp_gt_u32 s37, 14
    s_cbranch_scc0 C2_h14
    C2_h14_r:
    buffer_load_dwordx4 v[112:115], v48, s[8:11], s41 offen offset:0 sc1
    v_mfma_f32_16x16x32_bf16 v[40:43], v[124:127], v[152:155], v[40:43]
    buffer_load_dwordx4 v[116:119], v48, s[8:11], s41 offen offset:1024 sc1
    v_mfma_f32_16x16x32_bf16 v[36:39], v[124:127], v[148:151], v[36:39]
    v_mfma_f32_16x16x32_bf16 v[32:35], v[124:127], v[144:147], v[32:35]
    s_waitcnt vmcnt(12) lgkmcnt(0)
    v_mfma_f32_16x16x32_bf16 v[16:19], v[64:67], v[128:131], v[16:19]
    ds_read_b128 v[144:147], v9 offset:0
    ds_read_b128 v[148:151], v9 offset:2048
    v_mfma_f32_16x16x32_bf16 v[20:23], v[64:67], v[132:135], v[20:23]
    ds_read_b128 v[152:155], v9 offset:4096
    ds_read_b128 v[156:159], v9 offset:6144
    v_mfma_f32_16x16x32_bf16 v[24:27], v[64:67], v[136:139], v[24:27]
    buffer_load_dwordx4 v[120:123], v48, s[8:11], s41 offen offset:2048 sc1
    v_mfma_f32_16x16x32_bf16 v[28:31], v[64:67], v[140:143], v[28:31]
    buffer_load_dwordx4 v[124:127], v48, s[8:11], s41 offen offset:3072 sc1
    v_mfma_f32_16x16x32_bf16 v[44:47], v[68:71], v[140:143], v[44:47]
    v_min3_u32 v12, v12, v13, v14
    v_mfma_f32_16x16x32_bf16 v[40:43], v[68:71], v[136:139], v[40:43]
    v_min_u32 v12, v12, v15
    v_mfma_f32_16x16x32_bf16 v[36:39], v[68:71], v[132:135], v[36:39]
    v_cmp_gt_u32 vcc, 14, v12
    v_mfma_f32_16x16x32_bf16 v[32:35], v[68:71], v[128:131], v[32:35]
    s_cbranch_vccnz C2_q12
    C2_q12_r:
    s_waitcnt vmcnt(12) lgkmcnt(0)
    v_mfma_f32_16x16x32_bf16 v[16:19], v[72:75], v[144:147], v[16:19]
    ds_read_b128 v[128:131], v10 offset:0
    ds_read_b128 v[132:135], v10 offset:2048
    v_mfma_f32_16x16x32_bf16 v[20:23], v[72:75], v[148:151], v[20:23]
    ds_read_b128 v[136:139], v10 offset:4096
    ds_read_b128 v[140:143], v10 offset:6144
    v_mfma_f32_16x16x32_bf16 v[24:27], v[72:75], v[152:155], v[24:27]
    s_cmp_gt_u32 s37, 15
    s_cbranch_scc0 C2_h15
    C2_h15_r:
    buffer_load_dwordx4 v[64:67], v48, s[8:11], s42 offen offset:0 sc1
    v_mfma_f32_16x16x32_bf16 v[28:31], v[72:75], v[156:159], v[28:31]
    buffer_load_dwordx4 v[68:71], v48, s[8:11], s42 offen offset:1024 sc1
    v_mfma_f32_16x16x32_bf16 v[44:47], v[76:79], v[156:159], v[44:47]
    v_mfma_f32_16x16x32_bf16 v[40:43], v[76:79], v[152:155], v[40:43]
    v_mfma_f32_16x16x32_bf16 v[36:39], v[76:79], v[148:151], v[36:39]
    v_mfma_f32_16x16x32_bf16 v[32:35], v[76:79], v[144:147], v[32:35]
    s_waitcnt vmcnt(12) lgkmcnt(0)
    v_mfma_f32_16x16x32_bf16 v[16:19], v[80:83], v[128:131], v[16:19]
    ds_read_b128 v[144:147], v11 offset:0
    ds_read_b128 v[148:151], v11 offset:2048
    v_mfma_f32_16x16x32_bf16 v[20:23], v[80:83], v[132:135], v[20:23]
    ds_read_b128 v[152:155], v11 offset:4096
    ds_read_b128 v[156:159], v11 offset:6144
    v_mfma_f32_16x16x32_bf16 v[24:27], v[80:83], v[136:139], v[24:27]
    buffer_load_dwordx4 v[72:75], v48, s[8:11], s42 offen offset:2048 sc1
    v_mfma_f32_16x16x32_bf16 v[28:31], v[80:83], v[140:143], v[28:31]
    buffer_load_dwordx4 v[76:79], v48, s[8:11], s42 offen offset:3072 sc1
    v_mfma_f32_16x16x32_bf16 v[44:47], v[84:87], v[140:143], v[44:47]
    v_mfma_f32_16x16x32_bf16 v[40:43], v[84:87], v[136:139], v[40:43]
    v_mfma_f32_16x16x32_bf16 v[36:39], v[84:87], v[132:135], v[36:39]
    v_mfma_f32_16x16x32_bf16 v[32:35], v[84:87], v[128:131], v[32:35]
    s_waitcnt vmcnt(12) lgkmcnt(0)
    v_mfma_f32_16x16x32_bf16 v[16:19], v[88:91], v[144:147], v[16:19]
    ds_read_b128 v[160:163], v8 offset:16384
    ds_read_b128 v[164:167], v8 offset:18432
    v_mfma_f32_16x16x32_bf16 v[20:23], v[88:91], v[148:151], v[20:23]
    ds_read_b128 v[168:171], v8 offset:20480
    ds_read_b128 v[172:175], v8 offset:22528
    v_mfma_f32_16x16x32_bf16 v[24:27], v[88:91], v[152:155], v[24:27]
    ds_read_b128 v[176:179], v9 offset:16384
    ds_read_b128 v[180:183], v9 offset:18432
    v_mfma_f32_16x16x32_bf16 v[28:31], v[88:91], v[156:159], v[28:31]
    ds_read_b128 v[184:187], v9 offset:20480
    ds_read_b128 v[188:191], v9 offset:22528
    v_mfma_f32_16x16x32_bf16 v[44:47], v[92:95], v[156:159], v[44:47]
    v_mov_b32 v1, 13
    ds_write_b32 v63, v1 offset:96
    v_mfma_f32_16x16x32_bf16 v[40:43], v[92:95], v[152:155], v[40:43]
    ds_read_b128 v[12:15], v62 offset:48
    v_mfma_f32_16x16x32_bf16 v[36:39], v[92:95], v[148:151], v[36:39]
    buffer_load_dwordx4 v[80:83], v49, s[8:11], s40 offen offset:0 sc1
    v_mfma_f32_16x16x32_bf16 v[32:35], v[92:95], v[144:147], v[32:35]
    buffer_load_dwordx4 v[84:87], v49, s[8:11], s40 offen offset:1024 sc1
    s_waitcnt vmcnt(12) lgkmcnt(0)
    v_mfma_f32_16x16x32_bf16 v[16:19], v[96:99], v[160:163], v[16:19]
    ds_read_b128 v[192:195], v10 offset:16384
    ds_read_b128 v[196:199], v10 offset:18432
    v_mfma_f32_16x16x32_bf16 v[20:23], v[96:99], v[164:167], v[20:23]
    ds_read_b128 v[200:203], v10 offset:20480
    ds_read_b128 v[204:207], v10 offset:22528
    v_mfma_f32_16x16x32_bf16 v[24:27], v[96:99], v[168:171], v[24:27]
    ds_read_b128 v[208:211], v11 offset:16384
    ds_read_b128 v[212:215], v11 offset:18432
    v_mfma_f32_16x16x32_bf16 v[28:31], v[96:99], v[172:175], v[28:31]
    ds_read_b128 v[216:219], v11 offset:20480
    ds_read_b128 v[220:223], v11 offset:22528
    v_mfma_f32_16x16x32_bf16 v[16:19], v[100:103], v[176:179], v[16:19]
    buffer_load_dwordx4 v[88:91], v49, s[8:11], s40 offen offset:2048 sc1
    buffer_load_dwordx4 v[92:95], v49, s[8:11], s40 offen offset:3072 sc1
    v_mfma_f32_16x16x32_bf16 v[20:23], v[100:103], v[180:183], v[20:23]
    v_min3_u32 v12, v12, v13, v14
    v_min_u32 v12, v12, v15
    v_mfma_f32_16x16x32_bf16 v[24:27], v[100:103], v[184:187], v[24:27]
    v_cmp_gt_u32 vcc, 16, v12
    v_mfma_f32_16x16x32_bf16 v[28:31], v[100:103], v[188:191], v[28:31]
    s_cbranch_vccnz C2_q13
    C2_q13_r:
    s_waitcnt vmcnt(12) lgkmcnt(0)
    v_mfma_f32_16x16x32_bf16 v[16:19], v[104:107], v[192:195], v[16:19]
    ds_read_b128 v[160:163], v8 offset:32768
    ds_read_b128 v[164:167], v8 offset:34816
    v_mfma_f32_16x16x32_bf16 v[20:23], v[104:107], v[196:199], v[20:23]
    ds_read_b128 v[168:171], v8 offset:36864
    ds_read_b128 v[172:175], v8 offset:38912
    v_mfma_f32_16x16x32_bf16 v[24:27], v[104:107], v[200:203], v[24:27]
    ds_read_b128 v[176:179], v9 offset:32768
    ds_read_b128 v[180:183], v9 offset:34816
    v_mfma_f32_16x16x32_bf16 v[28:31], v[104:107], v[204:207], v[28:31]
    ds_read_b128 v[184:187], v9 offset:36864
    ds_read_b128 v[188:191], v9 offset:38912
    v_mfma_f32_16x16x32_bf16 v[16:19], v[108:111], v[208:211], v[16:19]
    buffer_load_dwordx4 v[96:99], v49, s[8:11], s41 offen offset:0 sc1
    v_mfma_f32_16x16x32_bf16 v[20:23], v[108:111], v[212:215], v[20:23]
    buffer_load_dwordx4 v[100:103], v49, s[8:11], s41 offen offset:1024 sc1
    v_mfma_f32_16x16x32_bf16 v[24:27], v[108:111], v[216:219], v[24:27]
    v_mfma_f32_16x16x32_bf16 v[28:31], v[108:111], v[220:223], v[28:31]
    s_waitcnt vmcnt(12) lgkmcnt(0)
    v_mfma_f32_16x16x32_bf16 v[16:19], v[112:115], v[160:163], v[16:19]
    ds_read_b128 v[192:195], v10 offset:32768
    ds_read_b128 v[196:199], v10 offset:34816
    v_mfma_f32_16x16x32_bf16 v[20:23], v[112:115], v[164:167], v[20:23]
    ds_read_b128 v[200:203], v10 offset:36864
    ds_read_b128 v[204:207], v10 offset:38912
    v_mfma_f32_16x16x32_bf16 v[24:27], v[112:115], v[168:171], v[24:27]
    ds_read_b128 v[208:211], v11 offset:32768
    ds_read_b128 v[212:215], v11 offset:34816
    v_mfma_f32_16x16x32_bf16 v[28:31], v[112:115], v[172:175], v[28:31]
    ds_read_b128 v[216:219], v11 offset:36864
    ds_read_b128 v[220:223], v11 offset:38912
    v_mfma_f32_16x16x32_bf16 v[16:19], v[116:119], v[176:179], v[16:19]
    buffer_load_dwordx4 v[104:107], v49, s[8:11], s41 offen offset:2048 sc1
    v_mfma_f32_16x16x32_bf16 v[20:23], v[116:119], v[180:183], v[20:23]
    buffer_load_dwordx4 v[108:111], v49, s[8:11], s41 offen offset:3072 sc1
    v_mfma_f32_16x16x32_bf16 v[24:27], v[116:119], v[184:187], v[24:27]
    v_mfma_f32_16x16x32_bf16 v[28:31], v[116:119], v[188:191], v[28:31]
    s_waitcnt vmcnt(12) lgkmcnt(0)
    v_mfma_f32_16x16x32_bf16 v[16:19], v[120:123], v[192:195], v[16:19]
    ds_read_b128 v[160:163], v4 offset:0
    ds_read_b128 v[164:167], v4 offset:2048
    v_mfma_f32_16x16x32_bf16 v[20:23], v[120:123], v[196:199], v[20:23]
    ds_read_b128 v[168:171], v4 offset:4096
    ds_read_b128 v[172:175], v4 offset:6144
    v_mfma_f32_16x16x32_bf16 v[24:27], v[120:123], v[200:203], v[24:27]
    ds_read_b128 v[176:179], v5 offset:0
    ds_read_b128 v[180:183], v5 offset:2048
    v_mfma_f32_16x16x32_bf16 v[28:31], v[120:123], v[204:207], v[28:31]
    ds_read_b128 v[184:187], v5 offset:4096
    ds_read_b128 v[188:191], v5 offset:6144
    v_mfma_f32_16x16x32_bf16 v[16:19], v[124:127], v[208:211], v[16:19]
    buffer_load_dwordx4 v[112:115], v49, s[8:11], s42 offen offset:0 sc1
    v_mfma_f32_16x16x32_bf16 v[20:23], v[124:127], v[212:215], v[20:23]
    buffer_load_dwordx4 v[116:119], v49, s[8:11], s42 offen offset:1024 sc1
    v_mfma_f32_16x16x32_bf16 v[24:27], v[124:127], v[216:219], v[24:27]
    v_mfma_f32_16x16x32_bf16 v[28:31], v[124:127], v[220:223], v[28:31]
    s_waitcnt vmcnt(12) lgkmcnt(0)
    v_mfma_f32_16x16x32_bf16 v[16:19], v[64:67], v[160:163], v[16:19]
    ds_read_b128 v[192:195], v6 offset:0
    ds_read_b128 v[196:199], v6 offset:2048
    v_mfma_f32_16x16x32_bf16 v[20:23], v[64:67], v[164:167], v[20:23]
    ds_read_b128 v[200:203], v6 offset:4096
    ds_read_b128 v[204:207], v6 offset:6144
    v_mfma_f32_16x16x32_bf16 v[24:27], v[64:67], v[168:171], v[24:27]
    ds_read_b128 v[208:211], v7 offset:0
    ds_read_b128 v[212:215], v7 offset:2048
    v_mfma_f32_16x16x32_bf16 v[28:31], v[64:67], v[172:175], v[28:31]
    ds_read_b128 v[216:219], v7 offset:4096
    ds_read_b128 v[220:223], v7 offset:6144
    v_mfma_f32_16x16x32_bf16 v[16:19], v[68:71], v[176:179], v[16:19]
    buffer_load_dwordx4 v[120:123], v49, s[8:11], s42 offen offset:2048 sc1
    v_mfma_f32_16x16x32_bf16 v[20:23], v[68:71], v[180:183], v[20:23]
    buffer_load_dwordx4 v[124:127], v49, s[8:11], s42 offen offset:3072 sc1
    v_mfma_f32_16x16x32_bf16 v[24:27], v[68:71], v[184:187], v[24:27]
    v_mfma_f32_16x16x32_bf16 v[28:31], v[68:71], v[188:191], v[28:31]
    s_waitcnt vmcnt(12) lgkmcnt(0)
    v_mfma_f32_16x16x32_bf16 v[16:19], v[72:75], v[192:195], v[16:19]
    ds_read_b128 v[160:163], v8 offset:16384
    ds_read_b128 v[164:167], v8 offset:18432
    v_mfma_f32_16x16x32_bf16 v[20:23], v[72:75], v[196:199], v[20:23]
    ds_read_b128 v[168:171], v8 offset:20480
    ds_read_b128 v[172:175], v8 offset:22528
    v_mfma_f32_16x16x32_bf16 v[24:27], v[72:75], v[200:203], v[24:27]
    ds_read_b128 v[176:179], v9 offset:16384
    ds_read_b128 v[180:183], v9 offset:18432
    v_mfma_f32_16x16x32_bf16 v[28:31], v[72:75], v[204:207], v[28:31]
    ds_read_b128 v[184:187], v9 offset:20480
    ds_read_b128 v[188:191], v9 offset:22528
    v_mfma_f32_16x16x32_bf16 v[16:19], v[76:79], v[208:211], v[16:19]
    v_mfma_f32_16x16x32_bf16 v[20:23], v[76:79], v[212:215], v[20:23]
    v_mfma_f32_16x16x32_bf16 v[24:27], v[76:79], v[216:219], v[24:27]
    v_mfma_f32_16x16x32_bf16 v[28:31], v[76:79], v[220:223], v[28:31]
    s_waitcnt vmcnt(10) lgkmcnt(0)
    v_mfma_f32_16x16x32_bf16 v[32:35], v[80:83], v[160:163], v[32:35]
    ds_read_b128 v[192:195], v10 offset:16384
    ds_read_b128 v[196:199], v10 offset:18432
    v_mfma_f32_16x16x32_bf16 v[36:39], v[80:83], v[164:167], v[36:39]
    ds_read_b128 v[200:203], v10 offset:20480
    ds_read_b128 v[204:207], v10 offset:22528
    v_mfma_f32_16x16x32_bf16 v[40:43], v[80:83], v[168:171], v[40:43]
    ds_read_b128 v[208:211], v11 offset:16384
    ds_read_b128 v[212:215], v11 offset:18432
    v_mfma_f32_16x16x32_bf16 v[44:47], v[80:83], v[172:175], v[44:47]
    ds_read_b128 v[216:219], v11 offset:20480
    ds_read_b128 v[220:223], v11 offset:22528
    v_mfma_f32_16x16x32_bf16 v[32:35], v[84:87], v[176:179], v[32:35]
    v_mfma_f32_16x16x32_bf16 v[36:39], v[84:87], v[180:183], v[36:39]
    v_mfma_f32_16x16x32_bf16 v[40:43], v[84:87], v[184:187], v[40:43]
    v_mfma_f32_16x16x32_bf16 v[44:47], v[84:87], v[188:191], v[44:47]
    s_waitcnt vmcnt(8) lgkmcnt(0)
    v_mfma_f32_16x16x32_bf16 v[32:35], v[88:91], v[192:195], v[32:35]
    ds_read_b128 v[160:163], v8 offset:32768
    ds_read_b128 v[164:167], v8 offset:34816
    v_mfma_f32_16x16x32_bf16 v[36:39], v[88:91], v[196:199], v[36:39]
    ds_read_b128 v[168:171], v8 offset:36864
    ds_read_b128 v[172:175], v8 offset:38912
    v_mfma_f32_16x16x32_bf16 v[40:43], v[88:91], v[200:203], v[40:43]
    ds_read_b128 v[176:179], v9 offset:32768
    ds_read_b128 v[180:183], v9 offset:34816
    v_mfma_f32_16x16x32_bf16 v[44:47], v[88:91], v[204:207], v[44:47]
    ds_read_b128 v[184:187], v9 offset:36864
    ds_read_b128 v[188:191], v9 offset:38912
    v_mfma_f32_16x16x32_bf16 v[32:35], v[92:95], v[208:211], v[32:35]
    v_mov_b32 v224, v16
    v_mov_b32 v225, v20
    v_mov_b32 v226, v24
    v_mov_b32 v227, v28
    v_mfma_f32_16x16x32_bf16 v[36:39], v[92:95], v[212:215], v[36:39]
    s_mov_b32 s6, 0
    buffer_store_dwordx4 v[224:227], v50, s[76:79], s6 offen nt
    v_mfma_f32_16x16x32_bf16 v[40:43], v[92:95], v[216:219], v[40:43]
    v_mfma_f32_16x16x32_bf16 v[44:47], v[92:95], v[220:223], v[44:47]
    s_waitcnt vmcnt(7) lgkmcnt(0)
    v_mfma_f32_16x16x32_bf16 v[32:35], v[96:99], v[160:163], v[32:35]
    ds_read_b128 v[192:195], v10 offset:32768
    ds_read_b128 v[196:199], v10 offset:34816
    v_mfma_f32_16x16x32_bf16 v[36:39], v[96:99], v[164:167], v[36:39]
    ds_read_b128 v[200:203], v10 offset:36864
    ds_read_b128 v[204:207], v10 offset:38912
    v_mfma_f32_16x16x32_bf16 v[40:43], v[96:99], v[168:171], v[40:43]
    ds_read_b128 v[208:211], v11 offset:32768
    ds_read_b128 v[212:215], v11 offset:34816
    v_mfma_f32_16x16x32_bf16 v[44:47], v[96:99], v[172:175], v[44:47]
    ds_read_b128 v[216:219], v11 offset:36864
    ds_read_b128 v[220:223], v11 offset:38912
    v_mfma_f32_16x16x32_bf16 v[32:35], v[100:103], v[176:179], v[32:35]
    v_mov_b32 v228, v17
    v_mov_b32 v229, v21
    v_mov_b32 v230, v25
    v_mov_b32 v231, v29
    v_mfma_f32_16x16x32_bf16 v[36:39], v[100:103], v[180:183], v[36:39]
    s_mov_b32 s6, 65536
    buffer_store_dwordx4 v[228:231], v50, s[76:79], s6 offen nt
    v_mfma_f32_16x16x32_bf16 v[40:43], v[100:103], v[184:187], v[40:43]
    v_mfma_f32_16x16x32_bf16 v[44:47], v[100:103], v[188:191], v[44:47]
    s_waitcnt vmcnt(6) lgkmcnt(0)
    v_mfma_f32_16x16x32_bf16 v[32:35], v[104:107], v[192:195], v[32:35]
    ds_read_b128 v[160:163], v4 offset:0
    ds_read_b128 v[164:167], v4 offset:2048
    v_mfma_f32_16x16x32_bf16 v[36:39], v[104:107], v[196:199], v[36:39]
    ds_read_b128 v[168:171], v4 offset:4096
    ds_read_b128 v[172:175], v4 offset:6144
    v_mfma_f32_16x16x32_bf16 v[40:43], v[104:107], v[200:203], v[40:43]
    ds_read_b128 v[176:179], v5 offset:0
    ds_read_b128 v[180:183], v5 offset:2048
    v_mfma_f32_16x16x32_bf16 v[44:47], v[104:107], v[204:207], v[44:47]
    ds_read_b128 v[184:187], v5 offset:4096
    ds_read_b128 v[188:191], v5 offset:6144
    v_mfma_f32_16x16x32_bf16 v[32:35], v[108:111], v[208:211], v[32:35]
    v_mov_b32 v232, v18
    v_mov_b32 v233, v22
    v_mov_b32 v234, v26
    v_mov_b32 v235, v30
    v_mfma_f32_16x16x32_bf16 v[36:39], v[108:111], v[212:215], v[36:39]
    s_mov_b32 s6, 131072
    buffer_store_dwordx4 v[232:235], v50, s[76:79], s6 offen nt
    v_mfma_f32_16x16x32_bf16 v[40:43], v[108:111], v[216:219], v[40:43]
    v_mfma_f32_16x16x32_bf16 v[44:47], v[108:111], v[220:223], v[44:47]
    s_waitcnt vmcnt(5) lgkmcnt(0)
    v_mfma_f32_16x16x32_bf16 v[32:35], v[112:115], v[160:163], v[32:35]
    ds_read_b128 v[192:195], v6 offset:0
    ds_read_b128 v[196:199], v6 offset:2048
    v_mfma_f32_16x16x32_bf16 v[36:39], v[112:115], v[164:167], v[36:39]
    ds_read_b128 v[200:203], v6 offset:4096
    ds_read_b128 v[204:207], v6 offset:6144
    v_mfma_f32_16x16x32_bf16 v[40:43], v[112:115], v[168:171], v[40:43]
    ds_read_b128 v[208:211], v7 offset:0
    ds_read_b128 v[212:215], v7 offset:2048
    v_mfma_f32_16x16x32_bf16 v[44:47], v[112:115], v[172:175], v[44:47]
    ds_read_b128 v[216:219], v7 offset:4096
    ds_read_b128 v[220:223], v7 offset:6144
    v_mfma_f32_16x16x32_bf16 v[32:35], v[116:119], v[176:179], v[32:35]
    v_mov_b32 v236, v19
    v_mov_b32 v237, v23
    v_mov_b32 v238, v27
    v_mov_b32 v239, v31
    v_mfma_f32_16x16x32_bf16 v[36:39], v[116:119], v[180:183], v[36:39]
    s_mov_b32 s6, 196608
    buffer_store_dwordx4 v[236:239], v50, s[76:79], s6 offen nt
    v_mfma_f32_16x16x32_bf16 v[40:43], v[116:119], v[184:187], v[40:43]
    v_mfma_f32_16x16x32_bf16 v[44:47], v[116:119], v[188:191], v[44:47]
    s_waitcnt vmcnt(4) lgkmcnt(0)
    v_mfma_f32_16x16x32_bf16 v[32:35], v[120:123], v[192:195], v[32:35]
    v_mfma_f32_16x16x32_bf16 v[36:39], v[120:123], v[196:199], v[36:39]
    v_mfma_f32_16x16x32_bf16 v[40:43], v[120:123], v[200:203], v[40:43]
    v_mfma_f32_16x16x32_bf16 v[44:47], v[120:123], v[204:207], v[44:47]
    v_mfma_f32_16x16x32_bf16 v[32:35], v[124:127], v[208:211], v[32:35]
    v_mfma_f32_16x16x32_bf16 v[36:39], v[124:127], v[212:215], v[36:39]
    v_mfma_f32_16x16x32_bf16 v[40:43], v[124:127], v[216:219], v[40:43]
    v_mfma_f32_16x16x32_bf16 v[44:47], v[124:127], v[220:223], v[44:47]
    s_nop 7
    s_nop 2
    v_mov_b32 v80, v32
    v_mov_b32 v81, v36
    v_mov_b32 v82, v40
    v_mov_b32 v83, v44
    s_mov_b32 s6, 8192
    buffer_store_dwordx4 v[80:83], v50, s[76:79], s6 offen nt
    v_mov_b32 v84, v33
    v_mov_b32 v85, v37
    v_mov_b32 v86, v41
    v_mov_b32 v87, v45
    s_mov_b32 s6, 73728
    buffer_store_dwordx4 v[84:87], v50, s[76:79], s6 offen nt
    v_mov_b32 v88, v34
    v_mov_b32 v89, v38
    v_mov_b32 v90, v42
    v_mov_b32 v91, v46
    s_mov_b32 s6, 139264
    buffer_store_dwordx4 v[88:91], v50, s[76:79], s6 offen nt
    v_mov_b32 v92, v35
    v_mov_b32 v93, v39
    v_mov_b32 v94, v43
    v_mov_b32 v95, v47
    s_mov_b32 s6, 204800
    buffer_store_dwordx4 v[92:95], v50, s[76:79], s6 offen nt
    s_endpgm
K_other:
    s_sub_u32 s6, s5, 4
    v_lshrrev_b32 v12, 3, v2
    v_and_b32 v13, 7, v2
    v_lshrrev_b32 v14, 4, v2
    v_xor_b32 v13, v13, v14
    v_lshlrev_b32 v13, 4, v13
    v_lshrrev_b32 v14, 5, v2
    v_and_b32 v15, 3, v12
    v_lshl_add_u32 v15, v14, 3, v15
    v_lshl_add_u32 v14, v12, 14, v13
    v_lshl_add_u32 v15, v15, 11, v13
    s_lshl_b32 s7, s3, 6
    s_add_u32 s7, s7, s6
    s_lshl_b32 s7, s7, 12
    v_add_u32 v4, s7, v14
    v_xor_b32 v5, 64, v4
    v_add_u32 v5, 0x1fc00, v5
    s_lshl_b32 s7, s4, 2
    s_add_u32 s7, s7, s6
    s_lshl_b32 s7, s7, 15
    v_add_u32 v8, s7, v15
    v_xor_b32 v9, 64, v8
    v_add_u32 v9, 0x1c00, v9
    s_and_b32 s30, s2, 3
    s_lshl_b32 s30, s30, 2
    s_and_b32 s31, s2, 4
    s_lshl_b32 s31, s31, 1
    s_add_u32 s30, s30, s31
    s_add_u32 s31, s3, s4
    s_and_b32 s31, s31, 1
    s_lshl_b32 s31, s31, 1
    s_add_u32 s30, s30, s31
    s_and_b32 s30, s30, 15
    s_lshl_b32 s100, s30, 7
    s_lshl_b32 s101, s6, 12
    s_waitcnt lgkmcnt(0)
    s_mov_b32 s8, s44
    s_mov_b32 s9, s45
    s_mov_b32 s10, 4194304
    s_mov_b32 s11, 0x00020000
    s_mov_b32 s12, s50
    s_mov_b32 s13, s51
    s_mov_b32 s14, 2097152
    s_mov_b32 s15, 0x00020000
    s_mov_b32 s16, s52
    s_mov_b32 s17, s53
    s_mov_b32 s18, 2097152
    s_mov_b32 s19, 0x00020000
    s_mov_b32 s58, s32
    s_mov_b32 s59, s33
    s_lshr_b32 s7, s2, 3
    s_and_b32 s32, s7, 15
    s_lshr_b32 s7, s7, 4
    s_and_b32 s33, s2, 7
    s_lshl_b32 s33, s33, 1
    s_add_u32 s33, s33, s7
    s_lshl_b32 s34, s33, 4
    s_add_u32 s34, s34, s32
    s_lshl_b32 s34, s34, 2
    s_add_u32 s34, s34, s6
    s_lshl_b32 s35, s34, 12
    s_lshr_b32 s7, s34, 1
    s_lshl_b32 s7, s7, 2
    s_load_dword s37, s[42:43], s7
    v_and_b32 v12, 15, v2
    v_lshrrev_b32 v13, 4, v2
    s_mov_b32 s68, s40
    s_mov_b32 s69, s41
    s_mov_b32 s70, 4194304
    s_mov_b32 s71, 0x00020000
    s_add_u32 s76, s66, 17825792
    s_addc_u32 s77, s67, 0
    s_mov_b32 s78, 393216
    s_mov_b32 s79, 0x00020000
    s_mov_b32 s24, s54
    s_mov_b32 s25, s55
    s_mov_b32 s26, 2097152
    s_mov_b32 s27, 0x00020000
    s_mov_b32 s28, s56
    s_mov_b32 s29, s57
    s_mov_b32 s30, 2097152
    s_mov_b32 s31, 0x00020000
    s_mov_b32 s40, s58
    s_mov_b32 s41, s59
    s_mov_b32 s42, 4194304
    s_mov_b32 s43, 0x00020000
    s_cmp_lt_u32 s6, 2
    s_cselect_b32 s52, s54, s56
    s_cselect_b32 s53, s55, s57
    s_mov_b32 s54, 2097152
    s_mov_b32 s55, 0x00020000
    s_waitcnt lgkmcnt(0)
    s_lshl_b32 s45, s6, 14
    v_lshlrev_b32 v16, 4, v13
    v_lshl_add_u32 v16, v12, 1, v16
    v_and_b32 v1, 1, v12
    v_mov_b32 v3, 98308
    v_mov_b32 v14, 102466
    v_cmp_eq_u32 vcc, 1, v1
    s_and_b32 s7, s34, 1
    s_lshl_b32 s7, s7, 4
    v_cndmask_b32 v3, v3, v14, vcc
    v_add3_u32 v16, v16, v3, s45
    v_add_u32 v17, 1024, v16
    v_add_u32 v18, 2048, v16
    v_add_u32 v19, 3072, v16
    s_add_u32 s47, s45, 107104
    v_lshlrev_b32 v1, 4, v13
    v_lshlrev_b32 v3, 5, v12
    v_sub_u32 v1, v1, v3
    v_add_u32 v20, s47, v1
    s_lshr_b32 s37, s37, s7
    s_and_b32 s37, s37, 0xffff
    v_lshlrev_b32 v1, 3, v13
    v_add_u32 v1, v1, v12
    v_sub_u32 v1, 15, v1
    v_and_b32 v3, 1, v1
    v_lshlrev_b32 v3, 4, v3
    v_lshlrev_b32 v3, v3, s37
    v_lshrrev_b32 v1, 1, v1
    v_cmp_eq_u32 vcc, 0, v1
    s_nop 1
    v_cndmask_b32 v24, 0, v3, vcc
    v_cmp_eq_u32 vcc, 1, v1
    s_nop 1
    v_cndmask_b32 v25, 0, v3, vcc
    v_cmp_eq_u32 vcc, 2, v1
    s_nop 1
    v_cndmask_b32 v26, 0, v3, vcc
    v_cmp_eq_u32 vcc, 3, v1
    s_nop 1
    v_cndmask_b32 v27, 0, v3, vcc
    s_add_u32 s7, s45, 106496
    v_lshlrev_b32 v1, 3, v2
    v_add_u32 v21, s7, v1
    v_lshlrev_b32 v10, 4, v2
    v_mov_b32 v7, 147328
    s_lshl_b32 s7, s6, 2
    v_add_u32 v6, s7, v7
    v_mov_b32 v1, 0
    ds_write_b32 v6, v1 offset:48
    ds_write_b32 v6, v1 offset:96
    v_mov_b32 v1, 2
    ds_write_b32 v6, v1 offset:64
    v_lshrrev_b32 v1, 3, v2
    v_and_b32 v3, 7, v2
    v_xor_b32 v3, v3, v13
    v_lshlrev_b32 v3, 4, v3
    v_lshl_add_u32 v3, v1, 13, v3
    s_lshl_b32 s7, s4, 6
    s_add_u32 s7, s7, s6
    s_lshl_b32 s7, s7, 11
    v_add_u32 v246, s7, v3
    v_xor_b32 v247, 64, v246
    v_add_u32 v247, 64512, v247
    v_xor_b32 v248, 32, v246
    v_xor_b32 v249, 32, v247
    s_lshl_b32 s38, s4, 7
    v_lshlrev_b32 v3, 11, v13
    v_lshl_add_u32 v3, v12, 3, v3
    s_lshl_b32 s7, s32, 2
    s_add_u32 s7, s7, s6
    s_lshl_b32 s7, s7, 9
    s_add_u32 s7, s7, s33
    s_lshl_b32 s7, s7, 7
    v_add_u32 v31, s7, v3
    s_lshr_b32 s46, s2, 3
    s_and_b32 s46, s46, 7
    s_lshr_b32 s46, s2, 4
    s_and_b32 s46, s46, 7
    s_add_u32 s7, s3, s4
    s_and_b32 s7, s7, 1
    s_cmp_eq_u32 s7, 0
    s_cselect_b32 s46, s46, 99
    s_lshl_b32 s39, s6, 11
    s_and_b32 s7, s3, 0
    s_lshl_b32 s7, s7, 7
    s_add_u32 s38, s38, s7
    s_and_b32 s20, s38, 1024
    s_xor_b32 s21, s20, 1024
    s_and_b32 s7, s3, 3
    s_lshl_b32 s7, s7, 1
    s_and_b32 s47, s6, 1
    s_add_u32 s7, s7, s47
    s_lshl_b32 s7, s7, 7
    s_or_b32 s7, s7, s21
    s_lshl_b32 s47, s4, 17
    s_add_u32 s7, s7, s47
    v_lshlrev_b32 v11, 11, v2
    v_add_u32 v11, s7, v11
    s_and_b32 s7, s3, 14
    s_and_b32 s47, s6, 1
    s_add_u32 s7, s7, s47
    s_add_u32 s7, s7, s4
    s_and_b32 s7, s7, 15
    s_lshl_b32 s7, s7, 7
    s_add_u32 s47, s3, s4
    s_and_b32 s47, s47, 0
    s_lshl_b32 s47, s47, 3
    s_xor_b32 s47, s47, s4
    s_lshl_b32 s47, s47, 17
    s_add_u32 s7, s7, s47
    v_lshlrev_b32 v30, 11, v2
    v_add_u32 v30, s7, v30
    s_barrier
    s_add_u32 m0, s101, 98304
    s_nop 0
    buffer_load_dwordx4 v4, s[8:11], s100 offen lds
    buffer_load_dwordx4 v5, s[8:11], s100 offen offset:1024 lds
    buffer_load_dwordx4 v4, s[8:11], s100 offen offset:2048 lds
    buffer_load_dwordx4 v5, s[8:11], s100 offen offset:3072 lds
    s_add_u32 m0, s101, 114688
    s_nop 0
    buffer_load_dwordx4 v8, s[12:15], s100 offen lds
    buffer_load_dwordx4 v9, s[12:15], s100 offen offset:1024 lds
    s_add_u32 m0, s101, 116736
    s_nop 0
    buffer_load_dwordx4 v8, s[16:19], s100 offen lds
    buffer_load_dwordx4 v9, s[16:19], s100 offen offset:1024 lds
    s_add_u32 s100, s100, 128
    s_and_b32 s100, s100, 2047
    s_add_u32 m0, s101, 0
    s_nop 0
    buffer_load_dwordx4 v4, s[8:11], s100 offen lds
    buffer_load_dwordx4 v5, s[8:11], s100 offen offset:1024 lds
    buffer_load_dwordx4 v4, s[8:11], s100 offen offset:2048 lds
    buffer_load_dwordx4 v5, s[8:11], s100 offen offset:3072 lds
    s_add_u32 m0, s101, 16384
    s_nop 0
    buffer_load_dwordx4 v8, s[12:15], s100 offen lds
    buffer_load_dwordx4 v9, s[12:15], s100 offen offset:1024 lds
    s_add_u32 m0, s101, 18432
    s_nop 0
    buffer_load_dwordx4 v8, s[16:19], s100 offen lds
    buffer_load_dwordx4 v9, s[16:19], s100 offen offset:1024 lds
    s_add_u32 s100, s100, 128
    s_and_b32 s100, s100, 2047
    s_add_u32 m0, s101, 32768
    s_nop 0
    buffer_load_dwordx4 v4, s[8:11], s100 offen lds
    buffer_load_dwordx4 v5, s[8:11], s100 offen offset:1024 lds
    buffer_load_dwordx4 v4, s[8:11], s100 offen offset:2048 lds
    buffer_load_dwordx4 v5, s[8:11], s100 offen offset:3072 lds
    s_add_u32 m0, s101, 49152
    s_nop 0
    buffer_load_dwordx4 v8, s[12:15], s100 offen lds
    buffer_load_dwordx4 v9, s[12:15], s100 offen offset:1024 lds
    s_add_u32 m0, s101, 51200
    s_nop 0
    buffer_load_dwordx4 v8, s[16:19], s100 offen lds
    buffer_load_dwordx4 v9, s[16:19], s100 offen offset:1024 lds
    s_add_u32 s100, s100, 128
    s_and_b32 s100, s100, 2047
    s_waitcnt vmcnt(16)
    s_barrier
    s_add_u32 m0, s101, 65536
    s_nop 0
    buffer_load_dwordx4 v4, s[8:11], s100 offen lds
    buffer_load_dwordx4 v5, s[8:11], s100 offen offset:1024 lds
    buffer_load_dwordx4 v4, s[8:11], s100 offen offset:2048 lds
    buffer_load_dwordx4 v5, s[8:11], s100 offen offset:3072 lds
    s_add_u32 m0, s101, 81920
    s_nop 0
    buffer_load_dwordx4 v8, s[12:15], s100 offen lds
    buffer_load_dwordx4 v9, s[12:15], s100 offen offset:1024 lds
    s_add_u32 m0, s101, 83968
    s_nop 0
    buffer_load_dwordx4 v8, s[16:19], s100 offen lds
    buffer_load_dwordx4 v9, s[16:19], s100 offen offset:1024 lds
    s_add_u32 s100, s100, 128
    s_and_b32 s100, s100, 2047
    buffer_load_dwordx4 v[112:115], v10, s[68:71], s35 offen offset:0 nt
    buffer_load_dwordx4 v[116:119], v10, s[68:71], s35 offen offset:1024 nt
    buffer_load_dwordx4 v[120:123], v10, s[68:71], s35 offen offset:2048 nt
    buffer_load_dwordx4 v[124:127], v10, s[68:71], s35 offen offset:3072 nt
    s_waitcnt vmcnt(20) lgkmcnt(0)
    s_barrier
    s_add_u32 m0, s101, 98304
    s_nop 0
    buffer_load_dwordx4 v4, s[8:11], s100 offen lds
    buffer_load_dwordx4 v5, s[8:11], s100 offen offset:1024 lds
    buffer_load_dwordx4 v4, s[8:11], s100 offen offset:2048 lds
    buffer_load_dwordx4 v5, s[8:11], s100 offen offset:3072 lds
    s_waitcnt vmcnt(16)
    s_barrier
    s_add_u32 m0, s101, 114688
    s_nop 0
    buffer_load_dwordx4 v8, s[12:15], s100 offen lds
    buffer_load_dwordx4 v9, s[12:15], s100 offen offset:1024 lds
    s_add_u32 m0, s101, 116736
    s_nop 0
    buffer_load_dwordx4 v8, s[16:19], s100 offen lds
    buffer_load_dwordx4 v9, s[16:19], s100 offen offset:1024 lds
    s_add_u32 s100, s100, 128
    s_and_b32 s100, s100, 2047
    s_add_u32 m0, s101, 0
    s_nop 0
    buffer_load_dwordx4 v4, s[8:11], s100 offen lds
    buffer_load_dwordx4 v5, s[8:11], s100 offen offset:1024 lds
    buffer_load_dwordx4 v4, s[8:11], s100 offen offset:2048 lds
    buffer_load_dwordx4 v5, s[8:11], s100 offen offset:3072 lds
    s_waitcnt vmcnt(16)
    s_barrier
    s_add_u32 m0, s101, 16384
    s_nop 0
    buffer_load_dwordx4 v8, s[12:15], s100 offen lds
    buffer_load_dwordx4 v9, s[12:15], s100 offen offset:1024 lds
    s_add_u32 m0, s101, 18432
    s_nop 0
    buffer_load_dwordx4 v8, s[16:19], s100 offen lds
    buffer_load_dwordx4 v9, s[16:19], s100 offen offset:1024 lds
    s_add_u32 s100, s100, 128
    s_and_b32 s100, s100, 2047
    s_cmp_eq_u32 s46, 0
    s_cbranch_scc0 L_t0
    buffer_load_dword v240, v30, s[52:55], 0 offen
    buffer_load_dword v241, v30, s[52:55], 0 offen offset:64
    L_t0:
    s_add_u32 m0, s101, 32768
    s_nop 0
    buffer_load_dwordx4 v4, s[8:11], s100 offen lds
    buffer_load_dwordx4 v5, s[8:11], s100 offen offset:1024 lds
    buffer_load_dwordx4 v4, s[8:11], s100 offen offset:2048 lds
    buffer_load_dwordx4 v5, s[8:11], s100 offen offset:3072 lds
    s_waitcnt vmcnt(12)
    s_barrier
    s_add_u32 m0, s101, 49152
    s_nop 0
    buffer_load_dwordx4 v8, s[12:15], s100 offen lds
    buffer_load_dwordx4 v9, s[12:15], s100 offen offset:1024 lds
    s_add_u32 m0, s101, 51200
    s_nop 0
    buffer_load_dwordx4 v8, s[16:19], s100 offen lds
    buffer_load_dwordx4 v9, s[16:19], s100 offen offset:1024 lds
    s_add_u32 s100, s100, 128
    s_and_b32 s100, s100, 2047
    s_cmp_eq_u32 s46, 1
    s_cbranch_scc0 L_t1
    buffer_load_dword v240, v30, s[52:55], 0 offen
    buffer_load_dword v241, v30, s[52:55], 0 offen offset:64
    L_t1:
    s_add_u32 m0, s101, 65536
    s_nop 0
    buffer_load_dwordx4 v4, s[8:11], s100 offen lds
    buffer_load_dwordx4 v5, s[8:11], s100 offen offset:1024 lds
    buffer_load_dwordx4 v4, s[8:11], s100 offen offset:2048 lds
    buffer_load_dwordx4 v5, s[8:11], s100 offen offset:3072 lds
    s_waitcnt vmcnt(12)
    s_barrier
    s_add_u32 m0, s101, 81920
    s_nop 0
    buffer_load_dwordx4 v8, s[12:15], s100 offen lds
    buffer_load_dwordx4 v9, s[12:15], s100 offen offset:1024 lds
    s_add_u32 m0, s101, 83968
    s_nop 0
    buffer_load_dwordx4 v8, s[16:19], s100 offen lds
    buffer_load_dwordx4 v9, s[16:19], s100 offen offset:1024 lds
    s_add_u32 s100, s100, 128
    s_and_b32 s100, s100, 2047
    s_cmp_eq_u32 s46, 2
    s_cbranch_scc0 L_t2
    buffer_load_dword v240, v30, s[52:55], 0 offen
    buffer_load_dword v241, v30, s[52:55], 0 offen offset:64
    L_t2:
    s_add_u32 m0, s101, 98304
    s_nop 0
    buffer_load_dwordx4 v4, s[8:11], s100 offen lds
    buffer_load_dwordx4 v5, s[8:11], s100 offen offset:1024 lds
    buffer_load_dwordx4 v4, s[8:11], s100 offen offset:2048 lds
    buffer_load_dwordx4 v5, s[8:11], s100 offen offset:3072 lds
    v_mov_b32 v1, 147328
    ds_read_b64 v[28:29], v1
    s_waitcnt vmcnt(12)
    s_barrier
    s_add_u32 m0, s101, 114688
    s_nop 0
    buffer_load_dwordx4 v8, s[12:15], s100 offen lds
    buffer_load_dwordx4 v9, s[12:15], s100 offen offset:1024 lds
    s_add_u32 m0, s101, 116736
    s_nop 0
    buffer_load_dwordx4 v8, s[16:19], s100 offen lds
    buffer_load_dwordx4 v9, s[16:19], s100 offen offset:1024 lds
    s_add_u32 s100, s100, 128
    s_and_b32 s100, s100, 2047
    s_cmp_eq_u32 s46, 3
    s_cbranch_scc0 L_t3
    buffer_load_dword v240, v30, s[52:55], 0 offen
    buffer_load_dword v241, v30, s[52:55], 0 offen offset:64
    L_t3:
    s_add_u32 m0, s101, 0
    s_nop 0
    buffer_load_dwordx4 v4, s[8:11], s100 offen lds
    buffer_load_dwordx4 v5, s[8:11], s100 offen offset:1024 lds
    buffer_load_dwordx4 v4, s[8:11], s100 offen offset:2048 lds
    buffer_load_dwordx4 v5, s[8:11], s100 offen offset:3072 lds
    s_waitcnt vmcnt(12)
    s_barrier
    s_add_u32 m0, s101, 16384
    s_nop 0
    buffer_load_dwordx4 v8, s[12:15], s100 offen lds
    buffer_load_dwordx4 v9, s[12:15], s100 offen offset:1024 lds
    s_add_u32 m0, s101, 18432
    s_nop 0
    buffer_load_dwordx4 v8, s[16:19], s100 offen lds
    buffer_load_dwordx4 v9, s[16:19], s100 offen offset:1024 lds
    s_add_u32 s100, s100, 128
    s_and_b32 s100, s100, 2047
    s_cmp_eq_u32 s46, 4
    s_cbranch_scc0 L_t4
    buffer_load_dword v240, v30, s[52:55], 0 offen
    buffer_load_dword v241, v30, s[52:55], 0 offen offset:64
    L_t4:
    s_add_u32 m0, s101, 32768
    s_nop 0
    buffer_load_dwordx4 v4, s[8:11], s100 offen lds
    buffer_load_dwordx4 v5, s[8:11], s100 offen offset:1024 lds
    buffer_load_dwordx4 v4, s[8:11], s100 offen offset:2048 lds
    buffer_load_dwordx4 v5, s[8:11], s100 offen offset:3072 lds
    s_waitcnt vmcnt(12)
    s_barrier
    s_add_u32 m0, s101, 49152
    s_nop 0
    buffer_load_dwordx4 v8, s[12:15], s100 offen lds
    buffer_load_dwordx4 v9, s[12:15], s100 offen offset:1024 lds
    s_add_u32 m0, s101, 51200
    s_nop 0
    buffer_load_dwordx4 v8, s[16:19], s100 offen lds
    buffer_load_dwordx4 v9, s[16:19], s100 offen offset:1024 lds
    s_add_u32 s100, s100, 128
    s_and_b32 s100, s100, 2047
    s_cmp_eq_u32 s46, 5
    s_cbranch_scc0 L_t5
    buffer_load_dword v240, v30, s[52:55], 0 offen
    buffer_load_dword v241, v30, s[52:55], 0 offen offset:64
    L_t5:
    s_add_u32 m0, s101, 65536
    s_nop 0
    buffer_load_dwordx4 v4, s[8:11], s100 offen lds
    buffer_load_dwordx4 v5, s[8:11], s100 offen offset:1024 lds
    buffer_load_dwordx4 v4, s[8:11], s100 offen offset:2048 lds
    buffer_load_dwordx4 v5, s[8:11], s100 offen offset:3072 lds
    v_mov_b32 v32, 0
    v_mov_b32 v33, 0
    v_mov_b32 v34, 0
    v_mov_b32 v35, 0
    s_add_u32 s47, s45, 110720
    v_add_u32 v1, s47, v10
    v_and_b32 v3, 16, v10
    v_and_b32 v15, 32, v10
    v_mul_u32_u24 v15, 130, v15
    v_add3_u32 v3, v3, v15, s45
    v_add_u32 v3, 98304, v3
    v_cmp_gt_u32 vcc, 32, v2
    s_add_u32 s47, s45, 98336
    v_add_u32 v15, s47, v10
    v_cndmask_b32 v1, v3, v1, vcc
    v_mov_b32 v64, 0
    s_waitcnt vmcnt(60)
    v_mov_b32_dpp v68, v115 wave_ror:1 row_mask:0xf bank_mask:0xf
    v_mov_b32_dpp v72, v119 wave_ror:1 row_mask:0xf bank_mask:0xf
    v_mov_b32_dpp v76, v123 wave_ror:1 row_mask:0xf bank_mask:0xf
    v_mov_b32_dpp v64, v115 wave_shr:1 row_mask:0xf bank_mask:0xf
    v_mov_b32_dpp v68, v119 wave_shr:1 row_mask:0xf bank_mask:0xf
    v_mov_b32_dpp v72, v123 wave_shr:1 row_mask:0xf bank_mask:0xf
    v_mov_b32_dpp v76, v127 wave_shr:1 row_mask:0xf bank_mask:0xf
    v_alignbit_b32 v64, v112, v64, 16
    v_alignbit_b32 v65, v113, v112, 16
    v_alignbit_b32 v66, v114, v113, 16
    v_alignbit_b32 v67, v115, v114, 16
    v_alignbit_b32 v68, v116, v68, 16
    v_alignbit_b32 v69, v117, v116, 16
    v_alignbit_b32 v70, v118, v117, 16
    v_alignbit_b32 v71, v119, v118, 16
    v_alignbit_b32 v72, v120, v72, 16
    v_alignbit_b32 v73, v121, v120, 16
    v_alignbit_b32 v74, v122, v121, 16
    v_alignbit_b32 v75, v123, v122, 16
    v_alignbit_b32 v76, v124, v76, 16
    v_alignbit_b32 v77, v125, v124, 16
    v_alignbit_b32 v78, v126, v125, 16
    v_alignbit_b32 v79, v127, v126, 16
    s_waitcnt vmcnt(12)
    s_barrier
    s_add_u32 m0, s101, 81920
    s_nop 0
    buffer_load_dwordx4 v8, s[12:15], s100 offen lds
    buffer_load_dwordx4 v9, s[12:15], s100 offen offset:1024 lds
    s_add_u32 m0, s101, 83968
    s_nop 0
    buffer_load_dwordx4 v8, s[16:19], s100 offen lds
    buffer_load_dwordx4 v9, s[16:19], s100 offen offset:1024 lds
    s_add_u32 s100, s100, 128
    s_and_b32 s100, s100, 2047
    s_cmp_eq_u32 s46, 6
    s_cbranch_scc0 L_t6
    buffer_load_dword v240, v30, s[52:55], 0 offen
    buffer_load_dword v241, v30, s[52:55], 0 offen offset:64
    L_t6:
    s_add_u32 m0, s101, 98304
    s_nop 0
    buffer_load_dwordx4 v4, s[8:11], s100 offen lds
    buffer_load_dwordx4 v5, s[8:11], s100 offen offset:1024 lds
    buffer_load_dwordx4 v4, s[8:11], s100 offen offset:2048 lds
    buffer_load_dwordx4 v5, s[8:11], s100 offen offset:3072 lds
    s_waitcnt vmcnt(12)
    s_barrier
    s_add_u32 m0, s101, 114688
    s_nop 0
    buffer_load_dwordx4 v8, s[12:15], s100 offen lds
    buffer_load_dwordx4 v9, s[12:15], s100 offen offset:1024 lds
    s_add_u32 m0, s101, 116736
    s_nop 0
    buffer_load_dwordx4 v8, s[16:19], s100 offen lds
    buffer_load_dwordx4 v9, s[16:19], s100 offen offset:1024 lds
    s_add_u32 s100, s100, 128
    s_and_b32 s100, s100, 2047
    s_cmp_eq_u32 s46, 7
    s_cbranch_scc0 L_t7
    buffer_load_dword v240, v30, s[52:55], 0 offen
    buffer_load_dword v241, v30, s[52:55], 0 offen offset:64
    L_t7:
    s_add_u32 m0, s101, 0
    s_nop 0
    buffer_load_dwordx4 v4, s[8:11], s100 offen lds
    buffer_load_dwordx4 v5, s[8:11], s100 offen offset:1024 lds
    buffer_load_dwordx4 v4, s[8:11], s100 offen offset:2048 lds
    buffer_load_dwordx4 v5, s[8:11], s100 offen offset:3072 lds
    s_waitcnt vmcnt(12)
    s_barrier
    s_add_u32 m0, s101, 16384
    s_nop 0
    buffer_load_dwordx4 v8, s[12:15], s100 offen lds
    buffer_load_dwordx4 v9, s[12:15], s100 offen offset:1024 lds
    s_add_u32 m0, s101, 18432
    s_nop 0
    buffer_load_dwordx4 v8, s[16:19], s100 offen lds
    buffer_load_dwordx4 v9, s[16:19], s100 offen offset:1024 lds
    s_add_u32 s100, s100, 128
    s_and_b32 s100, s100, 2047
    s_add_u32 m0, s101, 32768
    s_nop 0
    buffer_load_dwordx4 v4, s[8:11], s100 offen lds
    buffer_load_dwordx4 v5, s[8:11], s100 offen offset:1024 lds
    buffer_load_dwordx4 v4, s[8:11], s100 offen offset:2048 lds
    buffer_load_dwordx4 v5, s[8:11], s100 offen offset:3072 lds
    s_waitcnt vmcnt(12)
    s_barrier
    s_add_u32 m0, s101, 49152
    s_nop 0
    buffer_load_dwordx4 v8, s[12:15], s100 offen lds
    buffer_load_dwordx4 v9, s[12:15], s100 offen offset:1024 lds
    s_add_u32 m0, s101, 51200
    s_nop 0
    buffer_load_dwordx4 v8, s[16:19], s100 offen lds
    buffer_load_dwordx4 v9, s[16:19], s100 offen offset:1024 lds
    s_add_u32 s100, s100, 128
    s_and_b32 s100, s100, 2047
    s_add_u32 m0, s101, 65536
    s_nop 0
    buffer_load_dwordx4 v4, s[8:11], s100 offen lds
    buffer_load_dwordx4 v5, s[8:11], s100 offen offset:1024 lds
    buffer_load_dwordx4 v4, s[8:11], s100 offen offset:2048 lds
    buffer_load_dwordx4 v5, s[8:11], s100 offen offset:3072 lds
    s_waitcnt vmcnt(12)
    s_barrier
    s_add_u32 m0, s101, 81920
    s_nop 0
    buffer_load_dwordx4 v8, s[12:15], s100 offen lds
    buffer_load_dwordx4 v9, s[12:15], s100 offen offset:1024 lds
    s_add_u32 m0, s101, 83968
    s_nop 0
    buffer_load_dwordx4 v8, s[16:19], s100 offen lds
    buffer_load_dwordx4 v9, s[16:19], s100 offen offset:1024 lds
    s_add_u32 s100, s100, 128
    s_and_b32 s100, s100, 2047
    s_mov_b32 s36, 0
    buffer_load_dwordx2 v[192:193], v31, s[40:43], s36 offen nt
    s_mov_b32 s36, 8192
    buffer_load_dwordx2 v[194:195], v31, s[40:43], s36 offen nt
    s_mov_b32 s36, 16384
    buffer_load_dwordx2 v[196:197], v31, s[40:43], s36 offen nt
    s_mov_b32 s36, 24576
    buffer_load_dwordx2 v[198:199], v31, s[40:43], s36 offen nt
    s_mov_b32 s36, 32768
    buffer_load_dwordx2 v[200:201], v31, s[40:43], s36 offen nt
    s_mov_b32 s36, 40960
    buffer_load_dwordx2 v[202:203], v31, s[40:43], s36 offen nt
    s_mov_b32 s36, 49152
    buffer_load_dwordx2 v[204:205], v31, s[40:43], s36 offen nt
    s_mov_b32 s36, 57344
    buffer_load_dwordx2 v[206:207], v31, s[40:43], s36 offen nt
    s_waitcnt vmcnt(16)
    s_barrier
    s_add_u32 s44, s38, 0
    s_and_b32 s44, s44, 1023
    s_or_b32 s44, s44, s20
    s_add_u32 m0, s39, 0
    s_nop 0
    buffer_load_dwordx4 v246, s[24:27], s44 offen offset:0 lds
    buffer_load_dwordx4 v247, s[24:27], s44 offen offset:1024 lds
    s_add_u32 m0, s39, 8192
    s_nop 0
    buffer_load_dwordx4 v248, s[28:31], s44 offen offset:0 lds
    buffer_load_dwordx4 v249, s[28:31], s44 offen offset:1024 lds
    s_add_u32 s44, s38, 128
    s_and_b32 s44, s44, 1023
    s_or_b32 s44, s44, s20
    s_add_u32 m0, s39, 16384
    s_nop 0
    buffer_load_dwordx4 v246, s[24:27], s44 offen offset:0 lds
    buffer_load_dwordx4 v247, s[24:27], s44 offen offset:1024 lds
    s_add_u32 m0, s39, 24576
    s_nop 0
    buffer_load_dwordx4 v248, s[28:31], s44 offen offset:0 lds
    buffer_load_dwordx4 v249, s[28:31], s44 offen offset:1024 lds
    s_waitcnt vmcnt(16)
    s_barrier
    ds_write_b128 v1, v[32:35]
    ds_write_b128 v15, v[112:115] offset:4160
    ds_write_b128 v15, v[64:67] offset:0
    ds_write_b128 v15, v[116:119] offset:5184
    ds_write_b128 v15, v[68:71] offset:1024
    ds_write_b128 v15, v[120:123] offset:6208
    ds_write_b128 v15, v[72:75] offset:2048
    ds_write_b128 v15, v[124:127] offset:7232
    ds_write_b128 v15, v[76:79] offset:3072
    s_mov_b32 s51, 0
L_g1d:
    ds_read_b128 v[242:245], v7 offset:16
    s_add_u32 s51, s51, 1
    s_waitcnt lgkmcnt(0)
    v_xor_b32 v242, v242, v28
    v_xor_b32 v243, v243, v28
    v_xor_b32 v244, v244, v28
    v_xor_b32 v245, v245, v28
    v_or3_b32 v242, v242, v243, v244
    v_or_b32 v242, v242, v245
    s_cmp_gt_u32 s51, 16384
    s_cbranch_scc1 L_g1d_ok
    v_cmp_ne_u32 vcc, 0, v242
    s_cbranch_vccnz L_g1d
L_g1d_ok:
    ds_read_b128 v[96:99], v20 offset:3584
    ds_read2_b32 v[64:65], v16 offset0:0 offset1:1
    ds_read2_b32 v[66:67], v16 offset0:2 offset1:3
    ds_read_b128 v[100:103], v20 offset:3072
    ds_read2_b32 v[68:69], v16 offset0:128 offset1:129
    ds_read2_b32 v[70:71], v16 offset0:130 offset1:131
    ds_read_b128 v[104:107], v20 offset:2560
    ds_read2_b32 v[72:73], v17 offset0:0 offset1:1
    ds_read2_b32 v[74:75], v17 offset0:2 offset1:3
    ds_read_b128 v[108:111], v20 offset:2048
    ds_read2_b32 v[76:77], v17 offset0:128 offset1:129
    ds_read2_b32 v[78:79], v17 offset0:130 offset1:131
    ds_read_b128 v[112:115], v20 offset:1536
    ds_read2_b32 v[80:81], v18 offset0:0 offset1:1
    ds_read2_b32 v[82:83], v18 offset0:2 offset1:3
    ds_read_b128 v[116:119], v20 offset:1024
    ds_read2_b32 v[84:85], v18 offset0:128 offset1:129
    ds_read2_b32 v[86:87], v18 offset0:130 offset1:131
    ds_read_b128 v[120:123], v20 offset:512
    ds_read2_b32 v[88:89], v19 offset0:0 offset1:1
    ds_read2_b32 v[90:91], v19 offset0:2 offset1:3
    ds_read_b128 v[124:127], v20 offset:0
    ds_read2_b32 v[92:93], v19 offset0:128 offset1:129
    ds_read2_b32 v[94:95], v19 offset0:130 offset1:131
    s_add_u32 s44, s38, 256
    s_and_b32 s44, s44, 1023
    s_or_b32 s44, s44, s20
    s_add_u32 m0, s39, 32768
    s_nop 0
    buffer_load_dwordx4 v246, s[24:27], s44 offen offset:0 lds
    buffer_load_dwordx4 v247, s[24:27], s44 offen offset:1024 lds
    s_add_u32 m0, s39, 40960
    s_nop 0
    buffer_load_dwordx4 v248, s[28:31], s44 offen offset:0 lds
    buffer_load_dwordx4 v249, s[28:31], s44 offen offset:1024 lds
    s_add_u32 s44, s38, 384
    s_and_b32 s44, s44, 1023
    s_or_b32 s44, s44, s20
    s_add_u32 m0, s39, 49152
    s_nop 0
    buffer_load_dwordx4 v246, s[24:27], s44 offen offset:0 lds
    buffer_load_dwordx4 v247, s[24:27], s44 offen offset:1024 lds
    s_add_u32 m0, s39, 57344
    s_nop 0
    buffer_load_dwordx4 v248, s[28:31], s44 offen offset:0 lds
    buffer_load_dwordx4 v249, s[28:31], s44 offen offset:1024 lds
    ds_read_b32 v1, v6 offset:64
    s_waitcnt lgkmcnt(0)
    v_cmp_gt_u32 vcc, 2, v1
    s_cbranch_vccnz L_g0
    L_g0_r:
    s_waitcnt lgkmcnt(0)
    v_mfma_f32_16x16x32_bf16 v[32:35], v[24:27], v[96:99], 0
    v_mfma_f32_16x16x32_bf16 v[36:39], v[24:27], v[100:103], 0
    v_mfma_f32_16x16x32_bf16 v[40:43], v[24:27], v[104:107], 0
    v_mfma_f32_16x16x32_bf16 v[44:47], v[24:27], v[108:111], 0
    v_mfma_f32_16x16x32_bf16 v[48:51], v[24:27], v[112:115], 0
    v_mfma_f32_16x16x32_bf16 v[52:55], v[24:27], v[116:119], 0
    v_mfma_f32_16x16x32_bf16 v[56:59], v[24:27], v[120:123], 0
    v_mfma_f32_16x16x32_bf16 v[60:63], v[24:27], v[124:127], 0
    s_mov_b32 s51, 0
L_conv:
    s_cmp_eq_u32 s51, 2
    s_cbranch_scc1 L_cs4
L_cr0:
    s_waitcnt lgkmcnt(0)
    v_mfma_f32_16x16x32_bf16 v[60:63], v[64:67], v[124:127], v[60:63]
    ds_read_b128 v[160:163], v20 offset:3648
    v_mfma_f32_16x16x32_bf16 v[56:59], v[64:67], v[120:123], v[56:59]
    ds_read2_b32 v[128:129], v16 offset0:16 offset1:17
    v_mfma_f32_16x16x32_bf16 v[52:55], v[64:67], v[116:119], v[52:55]
    ds_read2_b32 v[130:131], v16 offset0:18 offset1:19
    v_mfma_f32_16x16x32_bf16 v[48:51], v[64:67], v[112:115], v[48:51]
    ds_read_b128 v[164:167], v20 offset:3136
    v_mfma_f32_16x16x32_bf16 v[60:63], v[68:71], v[120:123], v[60:63]
    ds_read_b32 v1, v6 offset:64
    v_mfma_f32_16x16x32_bf16 v[56:59], v[68:71], v[116:119], v[56:59]
    ds_read2_b32 v[132:133], v16 offset0:144 offset1:145
    v_mfma_f32_16x16x32_bf16 v[52:55], v[68:71], v[112:115], v[52:55]
    ds_read2_b32 v[134:135], v16 offset0:146 offset1:147
    v_mfma_f32_16x16x32_bf16 v[44:47], v[64:67], v[108:111], v[44:47]
    ds_read_b128 v[168:171], v20 offset:2624
    v_mfma_f32_16x16x32_bf16 v[60:63], v[72:75], v[116:119], v[60:63]
    ds_read2_b32 v[136:137], v17 offset0:16 offset1:17
    v_mfma_f32_16x16x32_bf16 v[56:59], v[72:75], v[112:115], v[56:59]
    ds_read2_b32 v[138:139], v17 offset0:18 offset1:19
    v_mfma_f32_16x16x32_bf16 v[48:51], v[68:71], v[108:111], v[48:51]
    s_waitcnt lgkmcnt(5)
    v_cmp_gt_u32 vcc, 2, v1
    v_mfma_f32_16x16x32_bf16 v[52:55], v[72:75], v[108:111], v[52:55]
    ds_read_b128 v[172:175], v20 offset:2112
    s_cbranch_vccnz L_g1
    L_g1_r:
    v_mfma_f32_16x16x32_bf16 v[60:63], v[76:79], v[112:115], v[60:63]
    ds_read2_b32 v[140:141], v17 offset0:144 offset1:145
    v_mfma_f32_16x16x32_bf16 v[56:59], v[76:79], v[108:111], v[56:59]
    ds_read2_b32 v[142:143], v17 offset0:146 offset1:147
    v_mfma_f32_16x16x32_bf16 v[40:43], v[64:67], v[104:107], v[40:43]
    ds_read_b128 v[176:179], v20 offset:1600
    v_mfma_f32_16x16x32_bf16 v[44:47], v[68:71], v[104:107], v[44:47]
    ds_read2_b32 v[144:145], v18 offset0:16 offset1:17
    v_mfma_f32_16x16x32_bf16 v[60:63], v[80:83], v[108:111], v[60:63]
    ds_read_b32 v1, v6 offset:64
    v_mfma_f32_16x16x32_bf16 v[48:51], v[72:75], v[104:107], v[48:51]
    ds_read2_b32 v[146:147], v18 offset0:18 offset1:19
    v_mfma_f32_16x16x32_bf16 v[52:55], v[76:79], v[104:107], v[52:55]
    ds_read_b128 v[180:183], v20 offset:1088
    v_mfma_f32_16x16x32_bf16 v[56:59], v[80:83], v[104:107], v[56:59]
    ds_read2_b32 v[148:149], v18 offset0:144 offset1:145
    v_mfma_f32_16x16x32_bf16 v[60:63], v[84:87], v[104:107], v[60:63]
    ds_read2_b32 v[150:151], v18 offset0:146 offset1:147
    v_mfma_f32_16x16x32_bf16 v[36:39], v[64:67], v[100:103], v[36:39]
    ds_read_b128 v[184:187], v20 offset:576
    v_mfma_f32_16x16x32_bf16 v[40:43], v[68:71], v[100:103], v[40:43]
    s_waitcnt lgkmcnt(5)
    v_cmp_gt_u32 vcc, 2, v1
    v_mfma_f32_16x16x32_bf16 v[44:47], v[72:75], v[100:103], v[44:47]
    ds_read2_b32 v[152:153], v19 offset0:16 offset1:17
    s_cbranch_vccnz L_g2
    L_g2_r:
    v_mfma_f32_16x16x32_bf16 v[48:51], v[76:79], v[100:103], v[48:51]
    ds_read2_b32 v[154:155], v19 offset0:18 offset1:19
    v_mfma_f32_16x16x32_bf16 v[52:55], v[80:83], v[100:103], v[52:55]
    ds_read_b128 v[188:191], v20 offset:64
    v_mfma_f32_16x16x32_bf16 v[56:59], v[84:87], v[100:103], v[56:59]
    ds_read2_b32 v[156:157], v19 offset0:144 offset1:145
    v_mfma_f32_16x16x32_bf16 v[60:63], v[88:91], v[100:103], v[60:63]
    ds_read2_b32 v[158:159], v19 offset0:146 offset1:147
    v_mfma_f32_16x16x32_bf16 v[32:35], v[64:67], v[96:99], v[32:35]
    ds_read_b32 v1, v6 offset:64
    v_mfma_f32_16x16x32_bf16 v[36:39], v[68:71], v[96:99], v[36:39]
    v_mfma_f32_16x16x32_bf16 v[40:43], v[72:75], v[96:99], v[40:43]
    v_mfma_f32_16x16x32_bf16 v[44:47], v[76:79], v[96:99], v[44:47]
    v_mfma_f32_16x16x32_bf16 v[48:51], v[80:83], v[96:99], v[48:51]
    v_mfma_f32_16x16x32_bf16 v[52:55], v[84:87], v[96:99], v[52:55]
    v_mfma_f32_16x16x32_bf16 v[56:59], v[88:91], v[96:99], v[56:59]
    s_waitcnt lgkmcnt(0)
    v_cmp_gt_u32 vcc, 2, v1
    v_mfma_f32_16x16x32_bf16 v[60:63], v[92:95], v[96:99], v[60:63]
    s_cbranch_vccnz L_g3
    L_g3_r:
    s_cmp_eq_u32 s51, 0
    s_cbranch_scc1 L_cs1
L_cr1:
    s_waitcnt lgkmcnt(0)
    v_mfma_f32_16x16x32_bf16 v[60:63], v[128:131], v[188:191], v[60:63]
    ds_read_b128 v[96:99], v20 offset:3712
    v_mfma_f32_16x16x32_bf16 v[56:59], v[128:131], v[184:187], v[56:59]
    ds_read2_b32 v[64:65], v16 offset0:32 offset1:33
    v_mfma_f32_16x16x32_bf16 v[52:55], v[128:131], v[180:183], v[52:55]
    ds_read2_b32 v[66:67], v16 offset0:34 offset1:35
    v_mfma_f32_16x16x32_bf16 v[48:51], v[128:131], v[176:179], v[48:51]
    ds_read_b128 v[100:103], v20 offset:3200
    v_mfma_f32_16x16x32_bf16 v[60:63], v[132:135], v[184:187], v[60:63]
    ds_read_b32 v1, v6 offset:64
    v_mfma_f32_16x16x32_bf16 v[56:59], v[132:135], v[180:183], v[56:59]
    ds_read2_b32 v[68:69], v16 offset0:160 offset1:161
    v_mfma_f32_16x16x32_bf16 v[52:55], v[132:135], v[176:179], v[52:55]
    ds_read2_b32 v[70:71], v16 offset0:162 offset1:163
    v_mfma_f32_16x16x32_bf16 v[44:47], v[128:131], v[172:175], v[44:47]
    ds_read_b128 v[104:107], v20 offset:2688
    v_mfma_f32_16x16x32_bf16 v[60:63], v[136:139], v[180:183], v[60:63]
    ds_read2_b32 v[72:73], v17 offset0:32 offset1:33
    v_mfma_f32_16x16x32_bf16 v[56:59], v[136:139], v[176:179], v[56:59]
    ds_read2_b32 v[74:75], v17 offset0:34 offset1:35
    v_mfma_f32_16x16x32_bf16 v[48:51], v[132:135], v[172:175], v[48:51]
    s_waitcnt lgkmcnt(5)
    v_cmp_gt_u32 vcc, 2, v1
    v_mfma_f32_16x16x32_bf16 v[52:55], v[136:139], v[172:175], v[52:55]
    ds_read_b128 v[108:111], v20 offset:2176
    s_cbranch_vccnz L_g4
    L_g4_r:
    v_mfma_f32_16x16x32_bf16 v[60:63], v[140:143], v[176:179], v[60:63]
    ds_read2_b32 v[76:77], v17 offset0:160 offset1:161
    v_mfma_f32_16x16x32_bf16 v[56:59], v[140:143], v[172:175], v[56:59]
    ds_read2_b32 v[78:79], v17 offset0:162 offset1:163
    v_mfma_f32_16x16x32_bf16 v[40:43], v[128:131], v[168:171], v[40:43]
    ds_read_b128 v[112:115], v20 offset:1664
    v_mfma_f32_16x16x32_bf16 v[44:47], v[132:135], v[168:171], v[44:47]
    ds_read2_b32 v[80:81], v18 offset0:32 offset1:33
    v_mfma_f32_16x16x32_bf16 v[60:63], v[144:147], v[172:175], v[60:63]
    ds_read_b32 v1, v6 offset:64
    v_mfma_f32_16x16x32_bf16 v[48:51], v[136:139], v[168:171], v[48:51]
    ds_read2_b32 v[82:83], v18 offset0:34 offset1:35
    v_mfma_f32_16x16x32_bf16 v[52:55], v[140:143], v[168:171], v[52:55]
    ds_read_b128 v[116:119], v20 offset:1152
    v_mfma_f32_16x16x32_bf16 v[56:59], v[144:147], v[168:171], v[56:59]
    ds_read2_b32 v[84:85], v18 offset0:160 offset1:161
    v_mfma_f32_16x16x32_bf16 v[60:63], v[148:151], v[168:171], v[60:63]
    ds_read2_b32 v[86:87], v18 offset0:162 offset1:163
    v_mfma_f32_16x16x32_bf16 v[36:39], v[128:131], v[164:167], v[36:39]
    ds_read_b128 v[120:123], v20 offset:640
    v_mfma_f32_16x16x32_bf16 v[40:43], v[132:135], v[164:167], v[40:43]
    s_waitcnt lgkmcnt(5)
    v_cmp_gt_u32 vcc, 2, v1
    v_mfma_f32_16x16x32_bf16 v[44:47], v[136:139], v[164:167], v[44:47]
    ds_read2_b32 v[88:89], v19 offset0:32 offset1:33
    s_cbranch_vccnz L_g5
    L_g5_r:
    v_mfma_f32_16x16x32_bf16 v[48:51], v[140:143], v[164:167], v[48:51]
    ds_read2_b32 v[90:91], v19 offset0:34 offset1:35
    v_mfma_f32_16x16x32_bf16 v[52:55], v[144:147], v[164:167], v[52:55]
    ds_read_b128 v[124:127], v20 offset:128
    v_mfma_f32_16x16x32_bf16 v[56:59], v[148:151], v[164:167], v[56:59]
    ds_read2_b32 v[92:93], v19 offset0:160 offset1:161
    v_mfma_f32_16x16x32_bf16 v[60:63], v[152:155], v[164:167], v[60:63]
    ds_read2_b32 v[94:95], v19 offset0:162 offset1:163
    v_mfma_f32_16x16x32_bf16 v[32:35], v[128:131], v[160:163], v[32:35]
    ds_read_b32 v1, v6 offset:64
    v_mfma_f32_16x16x32_bf16 v[36:39], v[132:135], v[160:163], v[36:39]
    v_add_u32 v16, 128, v16
    v_mfma_f32_16x16x32_bf16 v[40:43], v[136:139], v[160:163], v[40:43]
    v_add_u32 v17, 128, v17
    v_mfma_f32_16x16x32_bf16 v[44:47], v[140:143], v[160:163], v[44:47]
    v_add_u32 v18, 128, v18
    v_mfma_f32_16x16x32_bf16 v[48:51], v[144:147], v[160:163], v[48:51]
    v_add_u32 v19, 128, v19
    v_mfma_f32_16x16x32_bf16 v[52:55], v[148:151], v[160:163], v[52:55]
    v_add_u32 v20, 128, v20
    v_mfma_f32_16x16x32_bf16 v[56:59], v[152:155], v[160:163], v[56:59]
    s_waitcnt lgkmcnt(0)
    v_cmp_gt_u32 vcc, 2, v1
    v_mfma_f32_16x16x32_bf16 v[60:63], v[156:159], v[160:163], v[60:63]
    s_cbranch_vccnz L_g6
    L_g6_r:
    s_add_u32 s51, s51, 1
    s_cmp_lt_u32 s51, 4
    s_cbranch_scc1 L_conv
    s_waitcnt lgkmcnt(0)
    s_nop 6
    v_cvt_pk_bf16_f32 v32, v32, v33
    v_cvt_pk_bf16_f32 v33, v34, v35
    ds_write_b64 v21, v[32:33] offset:0
    v_cvt_pk_bf16_f32 v34, v36, v37
    v_cvt_pk_bf16_f32 v35, v38, v39
    ds_write_b64 v21, v[34:35] offset:512
    v_cvt_pk_bf16_f32 v36, v40, v41
    v_cvt_pk_bf16_f32 v37, v42, v43
    ds_write_b64 v21, v[36:37] offset:1024
    v_cvt_pk_bf16_f32 v38, v44, v45
    v_cvt_pk_bf16_f32 v39, v46, v47
    ds_write_b64 v21, v[38:39] offset:1536
    v_cvt_pk_bf16_f32 v40, v48, v49
    v_cvt_pk_bf16_f32 v41, v50, v51
    ds_write_b64 v21, v[40:41] offset:2048
    v_cvt_pk_bf16_f32 v42, v52, v53
    v_cvt_pk_bf16_f32 v43, v54, v55
    ds_write_b64 v21, v[42:43] offset:2560
    v_cvt_pk_bf16_f32 v44, v56, v57
    v_cvt_pk_bf16_f32 v45, v58, v59
    ds_write_b64 v21, v[44:45] offset:3072
    v_cvt_pk_bf16_f32 v46, v60, v61
    v_cvt_pk_bf16_f32 v47, v62, v63
    ds_write_b64 v21, v[46:47] offset:3584
    ds_write_b32 v6, v28 offset:80
    s_add_u32 s8, s66, 4194304
    s_addc_u32 s9, s67, 0
    s_mov_b32 s10, 4194304
    s_mov_b32 s11, 0x00020000
    s_mov_b32 s12, s62
    s_mov_b32 s13, s63
    s_mov_b32 s14, 16777216
    s_mov_b32 s15, 0x00020000
    s_lshr_b32 s7, s32, 2
    s_lshl_b32 s7, s7, 4
    s_add_u32 s7, s7, s33
    s_lshl_b32 s7, s7, 11
    s_add_u32 s7, s7, 262144
    v_lshlrev_b32 v1, 7, v12
    v_add_u32 v16, s7, v1
    v_xor_b32 v1, v12, v13
    v_lshlrev_b32 v1, 4, v1
    v_lshl_add_u32 v3, v13, 14, v1
    s_lshl_b32 s47, s32, 2
    s_add_u32 s47, s47, s6
    s_lshl_b32 s7, s33, 10
    s_add_u32 s7, s7, s47
    s_lshl_b32 s7, s7, 8
    v_add_u32 v17, s7, v3
    v_xor_b32 v18, 64, v17
    v_add_u32 v18, 64512, v18
    v_xor_b32 v19, 128, v17
    v_add_u32 v19, 129024, v19
    v_xor_b32 v20, 192, v17
    v_add_u32 v20, 193536, v20
    s_add_u32 s35, s45, 98304
    v_lshl_add_u32 v1, v12, 8, v1
    v_add_u32 v24, s35, v1
    v_xor_b32 v25, 64, v24
    v_xor_b32 v26, 128, v24
    v_xor_b32 v27, 192, v24
    s_lshl_b32 s47, s47, 10
    s_add_u32 s47, s47, s33
    s_lshl_b32 s47, s47, 8
    v_lshlrev_b32 v1, 13, v13
    v_lshl_add_u32 v1, v12, 4, v1
    v_add_u32 v21, s47, v1
    v_bfe_u32 v1, v2, 2, 2
    v_lshlrev_b32 v1, 14, v1
    v_and_b32 v3, 3, v2
    v_lshl_add_u32 v1, v3, 7, v1
    v_lshl_add_u32 v1, v13, 4, v1
    s_lshl_b32 s7, s6, 10
    s_add_u32 s7, s7, 106496
    v_add_u32 v4, s7, v1
    s_lshl_b32 s7, s34, 12
    v_add_u32 v5, s7, v10
    s_lshr_b32 s47, s34, 2
    s_lshl_b32 s7, s6, 8
    s_add_u32 s7, s7, s47
    s_lshl_b32 s7, s7, 7
    s_add_u32 s7, s7, 262144
    v_lshl_add_u32 v8, v12, 3, s7
    v_add_u32 v9, s39, v10
    v_add_u32 v11, 0xc000, v9
    s_mov_b32 s51, 0
L_zd:
    ds_read_b128 v[44:47], v7 offset:80
    s_add_u32 s51, s51, 1
    s_waitcnt lgkmcnt(0)
    v_xor_b32 v44, v44, v28
    v_xor_b32 v45, v45, v28
    v_xor_b32 v46, v46, v28
    v_xor_b32 v47, v47, v28
    v_or3_b32 v44, v44, v45, v46
    v_or_b32 v44, v44, v47
    s_cmp_gt_u32 s51, 16384
    s_cbranch_scc1 L_zd_ok
    v_cmp_ne_u32 vcc, 0, v44
    s_cbranch_vccnz L_zd
L_zd_ok:
    ds_read_b64_tr_b16 v[44:45], v4 offset:0
    ds_read_b64_tr_b16 v[46:47], v4 offset:8
    ds_read_b64_tr_b16 v[48:49], v4 offset:64
    ds_read_b64_tr_b16 v[50:51], v4 offset:72
    ds_read_b64_tr_b16 v[52:53], v4 offset:512
    ds_read_b64_tr_b16 v[54:55], v4 offset:520
    ds_read_b64_tr_b16 v[56:57], v4 offset:576
    ds_read_b64_tr_b16 v[58:59], v4 offset:584
    s_waitcnt lgkmcnt(0)
    buffer_store_dwordx4 v[44:47], v5, s[8:11], 0 offen offset:0 sc1
    buffer_store_dwordx4 v[48:51], v5, s[8:11], 0 offen offset:1024 sc1
    buffer_store_dwordx4 v[52:55], v5, s[8:11], 0 offen offset:2048 sc1
    buffer_store_dwordx4 v[56:59], v5, s[8:11], 0 offen offset:3072 sc1
    s_waitcnt vmcnt(23)
    s_add_u32 s44, s38, 1408
    s_and_b32 s44, s44, 1023
    s_or_b32 s44, s44, s21
    buffer_load_dwordx4 v[208:211], v246, s[24:27], s44 offen offset:0
    s_waitcnt vmcnt(23)
    buffer_load_dwordx4 v[212:215], v247, s[24:27], s44 offen offset:1024
    s_waitcnt vmcnt(23)
    buffer_load_dwordx4 v[216:219], v248, s[28:31], s44 offen offset:0
    s_waitcnt vmcnt(23)
    buffer_load_dwordx4 v[220:223], v249, s[28:31], s44 offen offset:1024
    s_waitcnt vmcnt(23)
    s_add_u32 s44, s38, 1536
    s_and_b32 s44, s44, 1023
    s_or_b32 s44, s44, s21
    buffer_load_dwordx4 v[224:227], v246, s[24:27], s44 offen offset:0
    s_waitcnt vmcnt(23)
    buffer_load_dwordx4 v[228:231], v247, s[24:27], s44 offen offset:1024
    s_waitcnt vmcnt(23)
    buffer_load_dwordx4 v[232:235], v248, s[28:31], s44 offen offset:0
    s_waitcnt vmcnt(23)
    buffer_load_dwordx4 v[236:239], v249, s[28:31], s44 offen offset:1024
    s_waitcnt vmcnt(8)
    s_mov_b64 exec, 0xffff
    buffer_store_dwordx2 v[28:29], v8, s[76:79], 0 offen sc1
    s_mov_b64 exec, -1
    s_mov_b32 s51, 0
L_p1:
    ds_read_b128 v[32:35], v7 offset:96
    s_add_u32 s51, s51, 1
    s_waitcnt lgkmcnt(0)
    v_min3_u32 v32, v32, v33, v34
    v_min_u32 v32, v32, v35
    s_cmp_gt_u32 s51, 65536
    s_cbranch_scc1 L_p1_ok
    v_cmp_gt_u32 vcc, 1, v32
    s_cbranch_vccnz L_p1
L_p1_ok:
    s_waitcnt vmcnt(23)
    s_add_u32 s44, s38, 1664
    s_and_b32 s44, s44, 1023
    s_or_b32 s44, s44, s21
    buffer_load_dwordx4 v[64:67], v246, s[24:27], s44 offen offset:0
    s_waitcnt vmcnt(23)
    buffer_load_dwordx4 v[68:71], v247, s[24:27], s44 offen offset:1024
    s_waitcnt vmcnt(23)
    buffer_load_dwordx4 v[72:75], v248, s[28:31], s44 offen offset:0
    s_waitcnt vmcnt(23)
    buffer_load_dwordx4 v[76:79], v249, s[28:31], s44 offen offset:1024
    s_mov_b32 s51, 0
L_p2:
    ds_read_b128 v[32:35], v7 offset:96
    s_add_u32 s51, s51, 1
    s_waitcnt lgkmcnt(0)
    v_min3_u32 v32, v32, v33, v34
    v_min_u32 v32, v32, v35
    s_cmp_gt_u32 s51, 65536
    s_cbranch_scc1 L_p2_ok
    v_cmp_gt_u32 vcc, 2, v32
    s_cbranch_vccnz L_p2
L_p2_ok:
    s_waitcnt vmcnt(23)
    s_add_u32 s44, s38, 1792
    s_and_b32 s44, s44, 1023
    s_or_b32 s44, s44, s21
    buffer_load_dwordx4 v[80:83], v246, s[24:27], s44 offen offset:0
    s_waitcnt vmcnt(23)
    buffer_load_dwordx4 v[84:87], v247, s[24:27], s44 offen offset:1024
    s_waitcnt vmcnt(23)
    buffer_load_dwordx4 v[88:91], v248, s[28:31], s44 offen offset:0
    s_waitcnt vmcnt(23)
    buffer_load_dwordx4 v[92:95], v249, s[28:31], s44 offen offset:1024
    s_mov_b32 s51, 0
L_p3:
    ds_read_b128 v[32:35], v7 offset:96
    s_add_u32 s51, s51, 1
    s_waitcnt lgkmcnt(0)
    v_min3_u32 v32, v32, v33, v34
    v_min_u32 v32, v32, v35
    s_cmp_gt_u32 s51, 65536
    s_cbranch_scc1 L_p3_ok
    v_cmp_gt_u32 vcc, 3, v32
    s_cbranch_vccnz L_p3
L_p3_ok:
    s_waitcnt vmcnt(23)
    s_add_u32 s44, s38, 1920
    s_and_b32 s44, s44, 1023
    s_or_b32 s44, s44, s21
    buffer_load_dwordx4 v[96:99], v246, s[24:27], s44 offen offset:0
    s_waitcnt vmcnt(23)
    buffer_load_dwordx4 v[100:103], v247, s[24:27], s44 offen offset:1024
    s_waitcnt vmcnt(23)
    buffer_load_dwordx4 v[104:107], v248, s[28:31], s44 offen offset:0
    s_waitcnt vmcnt(23)
    buffer_load_dwordx4 v[108:111], v249, s[28:31], s44 offen offset:1024
    s_mov_b32 s51, 0
L_p6:
    ds_read_b128 v[32:35], v7 offset:96
    s_add_u32 s51, s51, 1
    s_waitcnt lgkmcnt(0)
    v_min3_u32 v32, v32, v33, v34
    v_min_u32 v32, v32, v35
    s_cmp_gt_u32 s51, 65536
    s_cbranch_scc1 L_p6_ok
    v_cmp_gt_u32 vcc, 6, v32
    s_cbranch_vccnz L_p6
L_p6_ok:
    v_mov_b32 v3, 12
    s_waitcnt vmcnt(17)
    ds_write_b128 v11, v[208:211] offset:32768
    ds_write_b128 v11, v[212:215] offset:33792
    ds_write_b128 v11, v[216:219] offset:40960
    ds_write_b128 v11, v[220:223] offset:41984
    ds_write_b32 v6, v3 offset:48
    buffer_load_dwordx2 v[22:23], v16, s[76:79], 0 offen sc1
    s_mov_b32 s51, 0
L_p7:
    ds_read_b128 v[32:35], v7 offset:96
    s_add_u32 s51, s51, 1
    s_waitcnt lgkmcnt(0)
    v_min3_u32 v32, v32, v33, v34
    v_min_u32 v32, v32, v35
    s_cmp_gt_u32 s51, 65536
    s_cbranch_scc1 L_p7_ok
    v_cmp_gt_u32 vcc, 7, v32
    s_cbranch_vccnz L_p7
L_p7_ok:
    v_mov_b32 v3, 13
    s_waitcnt vmcnt(14)
    ds_write_b128 v9, v[224:227] offset:0
    ds_write_b128 v9, v[228:231] offset:1024
    ds_write_b128 v9, v[232:235] offset:8192
    ds_write_b128 v9, v[236:239] offset:9216
    ds_write_b32 v6, v3 offset:48
    s_mov_b32 s51, 0
L_p8:
    ds_read_b128 v[32:35], v7 offset:96
    s_add_u32 s51, s51, 1
    s_waitcnt lgkmcnt(0)
    v_min3_u32 v32, v32, v33, v34
    v_min_u32 v32, v32, v35
    s_cmp_gt_u32 s51, 65536
    s_cbranch_scc1 L_p8_ok
    v_cmp_gt_u32 vcc, 8, v32
    s_cbranch_vccnz L_p8
L_p8_ok:
    v_mov_b32 v3, 14
    s_waitcnt vmcnt(9)
    ds_write_b128 v9, v[64:67] offset:16384
    ds_write_b128 v9, v[68:71] offset:17408
    ds_write_b128 v9, v[72:75] offset:24576
    ds_write_b128 v9, v[76:79] offset:25600
    ds_write_b32 v6, v3 offset:48
    s_waitcnt vmcnt(0)
    v_cmp_eq_u32 vcc, v22, v28
    v_cmp_eq_u32 s[48:49], v23, v29
    s_mov_b32 m0, s35
    s_and_b64 s[48:49], s[48:49], vcc
    s_cmp_eq_u64 s[48:49], -1
    s_cbranch_scc1 L_zspin_go
    s_mov_b32 s51, 0
L_zspin:
    buffer_load_dwordx2 v[22:23], v16, s[76:79], 0 offen sc1
    s_add_u32 s51, s51, 1
    s_waitcnt vmcnt(0)
    v_cmp_eq_u32 vcc, v22, v28
    v_cmp_eq_u32 s[48:49], v23, v29
    s_cmp_gt_u32 s51, 4096
    s_cbranch_scc1 L_zspin_go
    s_and_b64 s[48:49], s[48:49], vcc
    s_cmp_eq_u64 s[48:49], -1
    s_cbranch_scc0 L_zspin
L_zspin_go:
    buffer_load_dwordx4 v17, s[8:11], 0 offen offset:0 sc1 lds
    buffer_load_dwordx4 v18, s[8:11], 0 offen offset:1024 sc1 lds
    buffer_load_dwordx4 v19, s[8:11], 0 offen offset:2048 sc1 lds
    buffer_load_dwordx4 v20, s[8:11], 0 offen offset:3072 sc1 lds
    s_mov_b32 s51, 0
L_p9:
    ds_read_b128 v[32:35], v7 offset:96
    s_add_u32 s51, s51, 1
    s_waitcnt lgkmcnt(0)
    v_min3_u32 v32, v32, v33, v34
    v_min_u32 v32, v32, v35
    s_cmp_gt_u32 s51, 65536
    s_cbranch_scc1 L_p9_ok
    v_cmp_gt_u32 vcc, 9, v32
    s_cbranch_vccnz L_p9
L_p9_ok:
    v_mov_b32 v3, 15
    s_waitcnt vmcnt(9)
    ds_write_b128 v9, v[80:83] offset:32768
    ds_write_b128 v9, v[84:87] offset:33792
    ds_write_b128 v9, v[88:91] offset:40960
    ds_write_b128 v9, v[92:95] offset:41984
    ds_write_b32 v6, v3 offset:48
    s_mov_b32 s51, 0
L_p10:
    ds_read_b128 v[32:35], v7 offset:96
    s_add_u32 s51, s51, 1
    s_waitcnt lgkmcnt(0)
    v_min3_u32 v32, v32, v33, v34
    v_min_u32 v32, v32, v35
    s_cmp_gt_u32 s51, 65536
    s_cbranch_scc1 L_p10_ok
    v_cmp_gt_u32 vcc, 10, v32
    s_cbranch_vccnz L_p10
L_p10_ok:
    v_mov_b32 v3, 16
    s_waitcnt vmcnt(5)
    ds_write_b128 v11, v[96:99] offset:0
    ds_write_b128 v11, v[100:103] offset:1024
    ds_write_b128 v11, v[104:107] offset:8192
    ds_write_b128 v11, v[108:111] offset:9216
    ds_write_b32 v6, v3 offset:48
    s_waitcnt vmcnt(0) lgkmcnt(0)
    ds_read_b128 v[44:47], v24
    ds_read_b128 v[48:51], v25
    ds_read_b128 v[52:55], v26
    ds_read_b128 v[56:59], v27
    s_waitcnt lgkmcnt(3)
    v_lshlrev_b32 v1, 16, v44
    v_lshlrev_b32 v36, 16, v192
    v_mul_f32 v36, v36, v1
    v_and_b32 v1, 0xffff0000, v44
    v_and_b32 v37, 0xffff0000, v192
    v_mul_f32 v37, v37, v1
    v_lshlrev_b32 v1, 16, v45
    v_lshlrev_b32 v38, 16, v193
    v_mul_f32 v38, v38, v1
    v_and_b32 v1, 0xffff0000, v45
    v_and_b32 v39, 0xffff0000, v193
    v_mul_f32 v39, v39, v1
    s_mov_b32 s7, 0
    buffer_store_dwordx4 v[36:39], v21, s[12:15], s7 offen nt
    v_lshlrev_b32 v1, 16, v46
    v_lshlrev_b32 v40, 16, v200
    v_mul_f32 v40, v40, v1
    v_and_b32 v1, 0xffff0000, v46
    v_and_b32 v41, 0xffff0000, v200
    v_mul_f32 v41, v41, v1
    v_lshlrev_b32 v1, 16, v47
    v_lshlrev_b32 v42, 16, v201
    v_mul_f32 v42, v42, v1
    v_and_b32 v1, 0xffff0000, v47
    v_and_b32 v43, 0xffff0000, v201
    v_mul_f32 v43, v43, v1
    s_mov_b32 s7, 131072
    buffer_store_dwordx4 v[40:43], v21, s[12:15], s7 offen nt
    s_waitcnt lgkmcnt(2)
    v_lshlrev_b32 v1, 16, v48
    v_lshlrev_b32 v36, 16, v194
    v_mul_f32 v36, v36, v1
    v_and_b32 v1, 0xffff0000, v48
    v_and_b32 v37, 0xffff0000, v194
    v_mul_f32 v37, v37, v1
    v_lshlrev_b32 v1, 16, v49
    v_lshlrev_b32 v38, 16, v195
    v_mul_f32 v38, v38, v1
    v_and_b32 v1, 0xffff0000, v49
    v_and_b32 v39, 0xffff0000, v195
    v_mul_f32 v39, v39, v1
    s_mov_b32 s7, 32768
    buffer_store_dwordx4 v[36:39], v21, s[12:15], s7 offen nt
    v_lshlrev_b32 v1, 16, v50
    v_lshlrev_b32 v40, 16, v202
    v_mul_f32 v40, v40, v1
    v_and_b32 v1, 0xffff0000, v50
    v_and_b32 v41, 0xffff0000, v202
    v_mul_f32 v41, v41, v1
    v_lshlrev_b32 v1, 16, v51
    v_lshlrev_b32 v42, 16, v203
    v_mul_f32 v42, v42, v1
    v_and_b32 v1, 0xffff0000, v51
    v_and_b32 v43, 0xffff0000, v203
    v_mul_f32 v43, v43, v1
    s_mov_b32 s7, 163840
    buffer_store_dwordx4 v[40:43], v21, s[12:15], s7 offen nt
    s_waitcnt lgkmcnt(1)
    v_lshlrev_b32 v1, 16, v52
    v_lshlrev_b32 v36, 16, v196
    v_mul_f32 v36, v36, v1
    v_and_b32 v1, 0xffff0000, v52
    v_and_b32 v37, 0xffff0000, v196
    v_mul_f32 v37, v37, v1
    v_lshlrev_b32 v1, 16, v53
    v_lshlrev_b32 v38, 16, v197
    v_mul_f32 v38, v38, v1
    v_and_b32 v1, 0xffff0000, v53
    v_and_b32 v39, 0xffff0000, v197
    v_mul_f32 v39, v39, v1
    s_mov_b32 s7, 65536
    buffer_store_dwordx4 v[36:39], v21, s[12:15], s7 offen nt
    v_lshlrev_b32 v1, 16, v54
    v_lshlrev_b32 v40, 16, v204
    v_mul_f32 v40, v40, v1
    v_and_b32 v1, 0xffff0000, v54
    v_and_b32 v41, 0xffff0000, v204
    v_mul_f32 v41, v41, v1
    v_lshlrev_b32 v1, 16, v55
    v_lshlrev_b32 v42, 16, v205
    v_mul_f32 v42, v42, v1
    v_and_b32 v1, 0xffff0000, v55
    v_and_b32 v43, 0xffff0000, v205
    v_mul_f32 v43, v43, v1
    s_mov_b32 s7, 196608
    buffer_store_dwordx4 v[40:43], v21, s[12:15], s7 offen nt
    s_waitcnt lgkmcnt(0)
    v_lshlrev_b32 v1, 16, v56
    v_lshlrev_b32 v36, 16, v198
    v_mul_f32 v36, v36, v1
    v_and_b32 v1, 0xffff0000, v56
    v_and_b32 v37, 0xffff0000, v198
    v_mul_f32 v37, v37, v1
    v_lshlrev_b32 v1, 16, v57
    v_lshlrev_b32 v38, 16, v199
    v_mul_f32 v38, v38, v1
    v_and_b32 v1, 0xffff0000, v57
    v_and_b32 v39, 0xffff0000, v199
    v_mul_f32 v39, v39, v1
    s_mov_b32 s7, 98304
    buffer_store_dwordx4 v[36:39], v21, s[12:15], s7 offen nt
    v_lshlrev_b32 v1, 16, v58
    v_lshlrev_b32 v40, 16, v206
    v_mul_f32 v40, v40, v1
    v_and_b32 v1, 0xffff0000, v58
    v_and_b32 v41, 0xffff0000, v206
    v_mul_f32 v41, v41, v1
    v_lshlrev_b32 v1, 16, v59
    v_lshlrev_b32 v42, 16, v207
    v_mul_f32 v42, v42, v1
    v_and_b32 v1, 0xffff0000, v59
    v_and_b32 v43, 0xffff0000, v207
    v_mul_f32 v43, v43, v1
    s_mov_b32 s7, 229376
    buffer_store_dwordx4 v[40:43], v21, s[12:15], s7 offen nt
K_fin:
K_done:
    s_endpgm
L_g0:
    s_mov_b32 s50, 0
L_g0_s:
    ds_read_b32 v1, v6 offset:64
    s_add_u32 s50, s50, 1
    s_waitcnt lgkmcnt(0)
    v_readfirstlane_b32 s7, v1
    s_cmp_gt_u32 s50, 4096
    s_cbranch_scc1 L_g0_r
    s_cmp_lt_u32 s7, 2
    s_cbranch_scc1 L_g0_s
    s_branch L_g0_r
L_cs1:
    s_add_u32 s44, s38, 512
    s_and_b32 s44, s44, 1023
    s_or_b32 s44, s44, s20
    s_add_u32 m0, s39, 65536
    s_nop 0
    buffer_load_dwordx4 v246, s[24:27], s44 offen offset:0 lds
    buffer_load_dwordx4 v247, s[24:27], s44 offen offset:1024 lds
    s_add_u32 m0, s39, 73728
    s_nop 0
    buffer_load_dwordx4 v248, s[28:31], s44 offen offset:0 lds
    buffer_load_dwordx4 v249, s[28:31], s44 offen offset:1024 lds
    s_add_u32 s44, s38, 640
    s_and_b32 s44, s44, 1023
    s_or_b32 s44, s44, s20
    s_add_u32 m0, s39, 81920
    s_nop 0
    buffer_load_dwordx4 v246, s[24:27], s44 offen offset:0 lds
    buffer_load_dwordx4 v247, s[24:27], s44 offen offset:1024 lds
    s_add_u32 m0, s39, 90112
    s_nop 0
    buffer_load_dwordx4 v248, s[28:31], s44 offen offset:0 lds
    buffer_load_dwordx4 v249, s[28:31], s44 offen offset:1024 lds
    s_branch L_cr1
L_cs4:
    v_mov_b32 v3, 6
    s_waitcnt vmcnt(0)
    ds_write_b32 v6, v3 offset:48
    s_branch L_cr0
L_g1:
    s_mov_b32 s50, 0
L_g1_s:
    ds_read_b32 v1, v6 offset:64
    s_add_u32 s50, s50, 1
    s_waitcnt lgkmcnt(0)
    v_readfirstlane_b32 s7, v1
    s_cmp_gt_u32 s50, 4096
    s_cbranch_scc1 L_g1_r
    s_cmp_lt_u32 s7, 2
    s_cbranch_scc1 L_g1_s
    s_branch L_g1_r
L_g2:
    s_mov_b32 s50, 0
L_g2_s:
    ds_read_b32 v1, v6 offset:64
    s_add_u32 s50, s50, 1
    s_waitcnt lgkmcnt(0)
    v_readfirstlane_b32 s7, v1
    s_cmp_gt_u32 s50, 4096
    s_cbranch_scc1 L_g2_r
    s_cmp_lt_u32 s7, 2
    s_cbranch_scc1 L_g2_s
    s_branch L_g2_r
L_g3:
    s_mov_b32 s50, 0
L_g3_s:
    ds_read_b32 v1, v6 offset:64
    s_add_u32 s50, s50, 1
    s_waitcnt lgkmcnt(0)
    v_readfirstlane_b32 s7, v1
    s_cmp_gt_u32 s50, 4096
    s_cbranch_scc1 L_g3_r
    s_cmp_lt_u32 s7, 2
    s_cbranch_scc1 L_g3_s
    s_branch L_g3_r
L_g4:
    s_mov_b32 s50, 0
L_g4_s:
    ds_read_b32 v1, v6 offset:64
    s_add_u32 s50, s50, 1
    s_waitcnt lgkmcnt(0)
    v_readfirstlane_b32 s7, v1
    s_cmp_gt_u32 s50, 4096
    s_cbranch_scc1 L_g4_r
    s_cmp_lt_u32 s7, 2
    s_cbranch_scc1 L_g4_s
    s_branch L_g4_r
L_g5:
    s_mov_b32 s50, 0
L_g5_s:
    ds_read_b32 v1, v6 offset:64
    s_add_u32 s50, s50, 1
    s_waitcnt lgkmcnt(0)
    v_readfirstlane_b32 s7, v1
    s_cmp_gt_u32 s50, 4096
    s_cbranch_scc1 L_g5_r
    s_cmp_lt_u32 s7, 2
    s_cbranch_scc1 L_g5_s
    s_branch L_g5_r
L_g6:
    s_mov_b32 s50, 0
L_g6_s:
    ds_read_b32 v1, v6 offset:64
    s_add_u32 s50, s50, 1
    s_waitcnt lgkmcnt(0)
    v_readfirstlane_b32 s7, v1
    s_cmp_gt_u32 s50, 4096
    s_cbranch_scc1 L_g6_r
    s_cmp_lt_u32 s7, 2
    s_cbranch_scc1 L_g6_s
    s_branch L_g6_r
C_x0:
    v_add_u32 v240, 98304, v240
    v_add_u32 v241, 98304, v241
    ds_read_b128 v[208:211], v240 offset:0
    ds_read_b128 v[212:215], v241 offset:0
    ds_read_b128 v[216:219], v240 offset:2048
    ds_read_b128 v[220:223], v241 offset:2048
    s_branch C_x0_r
C_x1:
    v_add_u32 v240, 0, v240
    v_add_u32 v241, 0, v241
    ds_read_b128 v[208:211], v240 offset:0
    ds_read_b128 v[212:215], v241 offset:0
    ds_read_b128 v[216:219], v240 offset:2048
    ds_read_b128 v[220:223], v241 offset:2048
    s_branch C_x1_r
C_x2:
    v_add_u32 v240, 32768, v240
    v_add_u32 v241, 32768, v241
    ds_read_b128 v[208:211], v240 offset:0
    ds_read_b128 v[212:215], v241 offset:0
    ds_read_b128 v[216:219], v240 offset:2048
    ds_read_b128 v[220:223], v241 offset:2048
    s_branch C_x2_r
C_x3:
    v_add_u32 v240, 65536, v240
    v_add_u32 v241, 65536, v241
    ds_read_b128 v[208:211], v240 offset:0
    ds_read_b128 v[212:215], v241 offset:0
    ds_read_b128 v[216:219], v240 offset:2048
    ds_read_b128 v[220:223], v241 offset:2048
    s_branch C_x3_r
C_x4:
    v_add_u32 v240, 98304, v240
    v_add_u32 v241, 98304, v241
    ds_read_b128 v[208:211], v240 offset:0
    ds_read_b128 v[212:215], v241 offset:0
    ds_read_b128 v[216:219], v240 offset:2048
    ds_read_b128 v[220:223], v241 offset:2048
    s_branch C_x4_r
C_non:
    s_mov_b32 s39, 0
C_non_s:
    buffer_load_dwordx2 v[54:55], off, s[16:19], 0 sc1
    s_add_u32 s39, s39, 1
    s_waitcnt vmcnt(0)
    s_cmp_gt_u32 s39, 4096
    s_cbranch_scc1 C_non_r
    v_readfirstlane_b32 s7, v54
    s_cmp_lg_u32 s7, 0
    s_cbranch_scc0 C_non_s
    s_branch C_non_r
C_x5:
    v_add_u32 v240, 0, v240
    v_add_u32 v241, 0, v241
    ds_read_b128 v[208:211], v240 offset:0
    ds_read_b128 v[212:215], v241 offset:0
    ds_read_b128 v[216:219], v240 offset:2048
    ds_read_b128 v[220:223], v241 offset:2048
    s_branch C_x5_r
C_x6:
    v_add_u32 v240, 32768, v240
    v_add_u32 v241, 32768, v241
    ds_read_b128 v[208:211], v240 offset:0
    ds_read_b128 v[212:215], v241 offset:0
    ds_read_b128 v[216:219], v240 offset:2048
    ds_read_b128 v[220:223], v241 offset:2048
    s_branch C_x6_r
C_x7:
    v_add_u32 v240, 65536, v240
    v_add_u32 v241, 65536, v241
    ds_read_b128 v[208:211], v240 offset:0
    ds_read_b128 v[212:215], v241 offset:0
    ds_read_b128 v[216:219], v240 offset:2048
    ds_read_b128 v[220:223], v241 offset:2048
    s_branch C_x7_r
C_x8:
    v_add_u32 v240, 98304, v240
    v_add_u32 v241, 98304, v241
    ds_read_b128 v[208:211], v240 offset:0
    ds_read_b128 v[212:215], v241 offset:0
    ds_read_b128 v[216:219], v240 offset:2048
    ds_read_b128 v[220:223], v241 offset:2048
    s_branch C_x8_r
C_x9:
    v_add_u32 v240, 0, v240
    v_add_u32 v241, 0, v241
    ds_read_b128 v[208:211], v240 offset:0
    ds_read_b128 v[212:215], v241 offset:0
    ds_read_b128 v[216:219], v240 offset:2048
    ds_read_b128 v[220:223], v241 offset:2048
    s_branch C_x9_r
C_x10:
    v_add_u32 v240, 32768, v240
    v_add_u32 v241, 32768, v241
    ds_read_b128 v[208:211], v240 offset:0
    ds_read_b128 v[212:215], v241 offset:0
    ds_read_b128 v[216:219], v240 offset:2048
    ds_read_b128 v[220:223], v241 offset:2048
    s_branch C_x10_r
C_x11:
    v_add_u32 v240, 65536, v240
    v_add_u32 v241, 65536, v241
    ds_read_b128 v[208:211], v240 offset:0
    ds_read_b128 v[212:215], v241 offset:0
    ds_read_b128 v[216:219], v240 offset:2048
    ds_read_b128 v[220:223], v241 offset:2048
    s_branch C_x11_r
C_x12:
    v_add_u32 v240, 98304, v240
    v_add_u32 v241, 98304, v241
    ds_read_b128 v[208:211], v240 offset:0
    ds_read_b128 v[212:215], v241 offset:0
    ds_read_b128 v[216:219], v240 offset:2048
    ds_read_b128 v[220:223], v241 offset:2048
    s_branch C_x12_r
C_x13:
    v_add_u32 v240, 0, v240
    v_add_u32 v241, 0, v241
    ds_read_b128 v[208:211], v240 offset:0
    ds_read_b128 v[212:215], v241 offset:0
    ds_read_b128 v[216:219], v240 offset:2048
    ds_read_b128 v[220:223], v241 offset:2048
    s_branch C_x13_r
C_kvp:
    s_mov_b32 s39, 0
C_kvp_s:
    buffer_load_dwordx2 v[244:245], v246, s[72:75], s21 offen sc1
    s_add_u32 s39, s39, 1
    s_waitcnt vmcnt(0)
    s_cmp_gt_u32 s39, 4096
    s_cbranch_scc1 C_kvp_r
    v_cmp_eq_u32 vcc, v244, v54
    v_cmp_eq_u32 s[54:55], v245, v55
    s_mov_b32 m0, s23
    s_and_b64 s[54:55], s[54:55], vcc
    s_cmp_eq_u64 s[54:55], -1
    s_cbranch_scc0 C_kvp_s
    s_branch C_kvp_r
C_x14:
    v_add_u32 v240, 32768, v240
    v_add_u32 v241, 32768, v241
    ds_read_b128 v[208:211], v240 offset:0
    ds_read_b128 v[212:215], v241 offset:0
    ds_read_b128 v[216:219], v240 offset:2048
    ds_read_b128 v[220:223], v241 offset:2048
    s_branch C_x14_r
C_x15:
    v_add_u32 v240, 65536, v240
    v_add_u32 v241, 65536, v241
    ds_read_b128 v[208:211], v240 offset:0
    ds_read_b128 v[212:215], v241 offset:0
    ds_read_b128 v[216:219], v240 offset:2048
    ds_read_b128 v[220:223], v241 offset:2048
    s_branch C_x15_r
C2_h1:
    s_mov_b32 s39, 0
C2_h1_s:
    buffer_load_dwordx2 v[248:249], v51, s[72:75], 0 offen sc1
    s_add_u32 s39, s39, 1
    s_waitcnt vmcnt(0)
    s_cmp_gt_u32 s39, 4096
    s_cbranch_scc1 C2_h1_r
    v_cmp_eq_u32 vcc, v248, v54
    v_cmp_eq_u32 s[54:55], v249, v55
    s_nop 0
    s_and_b64 s[54:55], s[54:55], vcc
    s_or_b32 s54, s54, 15
    s_ff0_i32_b64 s7, s[54:55]
    s_lshr_b32 s7, s7, 2
    s_max_u32 s37, s37, s7
    s_cmp_gt_u32 s37, 1
    s_cbranch_scc0 C2_h1_s
    s_branch C2_h1_r
C_crdy:
    s_mov_b32 s39, 0
C_crdy_s:
    ds_read_b128 v[12:15], v62 offset:48
    s_add_u32 s39, s39, 1
    s_waitcnt lgkmcnt(0)
    v_min3_u32 v12, v12, v13, v14
    v_min_u32 v12, v12, v15
    v_cmp_gt_u32 vcc, 6, v12
    s_cmp_gt_u32 s39, 65536
    s_cbranch_scc1 C_crdy_r
    s_cbranch_vccnz C_crdy_s
    s_branch C_crdy_r
C2_h2:
    s_mov_b32 s39, 0
C2_h2_s:
    buffer_load_dwordx2 v[248:249], v51, s[72:75], 0 offen sc1
    s_add_u32 s39, s39, 1
    s_waitcnt vmcnt(0)
    s_cmp_gt_u32 s39, 4096
    s_cbranch_scc1 C2_h2_r
    v_cmp_eq_u32 vcc, v248, v54
    v_cmp_eq_u32 s[54:55], v249, v55
    s_nop 0
    s_and_b64 s[54:55], s[54:55], vcc
    s_or_b32 s54, s54, 15
    s_ff0_i32_b64 s7, s[54:55]
    s_lshr_b32 s7, s7, 2
    s_max_u32 s37, s37, s7
    s_cmp_gt_u32 s37, 2
    s_cbranch_scc0 C2_h2_s
    s_branch C2_h2_r
C2_h3:
    s_mov_b32 s39, 0
C2_h3_s:
    buffer_load_dwordx2 v[248:249], v51, s[72:75], 0 offen sc1
    s_add_u32 s39, s39, 1
    s_waitcnt vmcnt(0)
    s_cmp_gt_u32 s39, 4096
    s_cbranch_scc1 C2_h3_r
    v_cmp_eq_u32 vcc, v248, v54
    v_cmp_eq_u32 s[54:55], v249, v55
    s_nop 0
    s_and_b64 s[54:55], s[54:55], vcc
    s_or_b32 s54, s54, 15
    s_ff0_i32_b64 s7, s[54:55]
    s_lshr_b32 s7, s7, 2
    s_max_u32 s37, s37, s7
    s_cmp_gt_u32 s37, 3
    s_cbranch_scc0 C2_h3_s
    s_branch C2_h3_r
C2_p2:
    s_mov_b32 s39, 0
C2_p2_s:
    ds_read_b128 v[56:59], v62 offset:96
    s_add_u32 s39, s39, 1
    s_waitcnt lgkmcnt(0)
    v_min3_u32 v56, v56, v57, v58
    v_min_u32 v56, v56, v59
    v_cmp_gt_u32 vcc, 1, v56
    s_cmp_gt_u32 s39, 65536
    s_cbranch_scc1 C2_p2_r
    s_cbranch_vccnz C2_p2_s
    s_branch C2_p2_r
C2_h4:
    s_mov_b32 s39, 0
C2_h4_s:
    buffer_load_dwordx2 v[248:249], v51, s[72:75], 0 offen sc1
    s_add_u32 s39, s39, 1
    s_waitcnt vmcnt(0)
    s_cmp_gt_u32 s39, 4096
    s_cbranch_scc1 C2_h4_r
    v_cmp_eq_u32 vcc, v248, v54
    v_cmp_eq_u32 s[54:55], v249, v55
    s_nop 0
    s_and_b64 s[54:55], s[54:55], vcc
    s_or_b32 s54, s54, 15
    s_ff0_i32_b64 s7, s[54:55]
    s_lshr_b32 s7, s7, 2
    s_max_u32 s37, s37, s7
    s_cmp_gt_u32 s37, 4
    s_cbranch_scc0 C2_h4_s
    s_branch C2_h4_r
C2_p3:
    s_mov_b32 s39, 0
C2_p3_s:
    ds_read_b128 v[56:59], v62 offset:96
    s_add_u32 s39, s39, 1
    s_waitcnt lgkmcnt(0)
    v_min3_u32 v56, v56, v57, v58
    v_min_u32 v56, v56, v59
    v_cmp_gt_u32 vcc, 2, v56
    s_cmp_gt_u32 s39, 65536
    s_cbranch_scc1 C2_p3_r
    s_cbranch_vccnz C2_p3_s
    s_branch C2_p3_r
C2_h5:
    s_mov_b32 s39, 0
C2_h5_s:
    buffer_load_dwordx2 v[248:249], v51, s[72:75], 0 offen sc1
    s_add_u32 s39, s39, 1
    s_waitcnt vmcnt(0)
    s_cmp_gt_u32 s39, 4096
    s_cbranch_scc1 C2_h5_r
    v_cmp_eq_u32 vcc, v248, v54
    v_cmp_eq_u32 s[54:55], v249, v55
    s_nop 0
    s_and_b64 s[54:55], s[54:55], vcc
    s_or_b32 s54, s54, 15
    s_ff0_i32_b64 s7, s[54:55]
    s_lshr_b32 s7, s7, 2
    s_max_u32 s37, s37, s7
    s_cmp_gt_u32 s37, 5
    s_cbranch_scc0 C2_h5_s
    s_branch C2_h5_r
C2_p4:
    s_mov_b32 s39, 0
C2_p4_s:
    ds_read_b128 v[56:59], v62 offset:96
    s_add_u32 s39, s39, 1
    s_waitcnt lgkmcnt(0)
    v_min3_u32 v56, v56, v57, v58
    v_min_u32 v56, v56, v59
    v_cmp_gt_u32 vcc, 3, v56
    s_cmp_gt_u32 s39, 65536
    s_cbranch_scc1 C2_p4_r
    s_cbranch_vccnz C2_p4_s
    s_branch C2_p4_r
C2_h6:
    s_mov_b32 s39, 0
C2_h6_s:
    buffer_load_dwordx2 v[248:249], v51, s[72:75], 0 offen sc1
    s_add_u32 s39, s39, 1
    s_waitcnt vmcnt(0)
    s_cmp_gt_u32 s39, 4096
    s_cbranch_scc1 C2_h6_r
    v_cmp_eq_u32 vcc, v248, v54
    v_cmp_eq_u32 s[54:55], v249, v55
    s_nop 0
    s_and_b64 s[54:55], s[54:55], vcc
    s_or_b32 s54, s54, 15
    s_ff0_i32_b64 s7, s[54:55]
    s_lshr_b32 s7, s7, 2
    s_max_u32 s37, s37, s7
    s_cmp_gt_u32 s37, 6
    s_cbranch_scc0 C2_h6_s
    s_branch C2_h6_r
C2_p5:
    s_mov_b32 s39, 0
C2_p5_s:
    ds_read_b128 v[56:59], v62 offset:96
    s_add_u32 s39, s39, 1
    s_waitcnt lgkmcnt(0)
    v_min3_u32 v56, v56, v57, v58
    v_min_u32 v56, v56, v59
    v_cmp_gt_u32 vcc, 4, v56
    s_cmp_gt_u32 s39, 65536
    s_cbranch_scc1 C2_p5_r
    s_cbranch_vccnz C2_p5_s
    s_branch C2_p5_r
C2_h7:
    s_mov_b32 s39, 0
C2_h7_s:
    buffer_load_dwordx2 v[248:249], v51, s[72:75], 0 offen sc1
    s_add_u32 s39, s39, 1
    s_waitcnt vmcnt(0)
    s_cmp_gt_u32 s39, 4096
    s_cbranch_scc1 C2_h7_r
    v_cmp_eq_u32 vcc, v248, v54
    v_cmp_eq_u32 s[54:55], v249, v55
    s_nop 0
    s_and_b64 s[54:55], s[54:55], vcc
    s_or_b32 s54, s54, 15
    s_ff0_i32_b64 s7, s[54:55]
    s_lshr_b32 s7, s7, 2
    s_max_u32 s37, s37, s7
    s_cmp_gt_u32 s37, 7
    s_cbranch_scc0 C2_h7_s
    s_branch C2_h7_r
C2_p6:
    s_mov_b32 s39, 0
C2_p6_s:
    ds_read_b128 v[56:59], v62 offset:96
    s_add_u32 s39, s39, 1
    s_waitcnt lgkmcnt(0)
    v_min3_u32 v56, v56, v57, v58
    v_min_u32 v56, v56, v59
    v_cmp_gt_u32 vcc, 5, v56
    s_cmp_gt_u32 s39, 65536
    s_cbranch_scc1 C2_p6_r
    s_cbranch_vccnz C2_p6_s
    s_branch C2_p6_r
C2_h8:
    s_mov_b32 s39, 0
C2_h8_s:
    buffer_load_dwordx2 v[248:249], v51, s[72:75], 0 offen sc1
    s_add_u32 s39, s39, 1
    s_waitcnt vmcnt(0)
    s_cmp_gt_u32 s39, 4096
    s_cbranch_scc1 C2_h8_r
    v_cmp_eq_u32 vcc, v248, v54
    v_cmp_eq_u32 s[54:55], v249, v55
    s_nop 0
    s_and_b64 s[54:55], s[54:55], vcc
    s_or_b32 s54, s54, 15
    s_ff0_i32_b64 s7, s[54:55]
    s_lshr_b32 s7, s7, 2
    s_max_u32 s37, s37, s7
    s_cmp_gt_u32 s37, 8
    s_cbranch_scc0 C2_h8_s
    s_branch C2_h8_r
C2_p7:
    s_mov_b32 s39, 0
C2_p7_s:
    ds_read_b128 v[56:59], v62 offset:96
    s_add_u32 s39, s39, 1
    s_waitcnt lgkmcnt(0)
    v_min3_u32 v56, v56, v57, v58
    v_min_u32 v56, v56, v59
    v_cmp_gt_u32 vcc, 6, v56
    s_cmp_gt_u32 s39, 65536
    s_cbranch_scc1 C2_p7_r
    s_cbranch_vccnz C2_p7_s
    s_branch C2_p7_r
C2_h9:
    s_mov_b32 s39, 0
C2_h9_s:
    buffer_load_dwordx2 v[248:249], v51, s[72:75], 0 offen sc1
    s_add_u32 s39, s39, 1
    s_waitcnt vmcnt(0)
    s_cmp_gt_u32 s39, 4096
    s_cbranch_scc1 C2_h9_r
    v_cmp_eq_u32 vcc, v248, v54
    v_cmp_eq_u32 s[54:55], v249, v55
    s_nop 0
    s_and_b64 s[54:55], s[54:55], vcc
    s_or_b32 s54, s54, 15
    s_ff0_i32_b64 s7, s[54:55]
    s_lshr_b32 s7, s7, 2
    s_max_u32 s37, s37, s7
    s_cmp_gt_u32 s37, 9
    s_cbranch_scc0 C2_h9_s
    s_branch C2_h9_r
C2_p8:
    s_mov_b32 s39, 0
C2_p8_s:
    ds_read_b128 v[56:59], v62 offset:96
    s_add_u32 s39, s39, 1
    s_waitcnt lgkmcnt(0)
    v_min3_u32 v56, v56, v57, v58
    v_min_u32 v56, v56, v59
    v_cmp_gt_u32 vcc, 7, v56
    s_cmp_gt_u32 s39, 65536
    s_cbranch_scc1 C2_p8_r
    s_cbranch_vccnz C2_p8_s
    s_branch C2_p8_r
C2_h10:
    s_mov_b32 s39, 0
C2_h10_s:
    buffer_load_dwordx2 v[248:249], v51, s[72:75], 0 offen sc1
    s_add_u32 s39, s39, 1
    s_waitcnt vmcnt(0)
    s_cmp_gt_u32 s39, 4096
    s_cbranch_scc1 C2_h10_r
    v_cmp_eq_u32 vcc, v248, v54
    v_cmp_eq_u32 s[54:55], v249, v55
    s_nop 0
    s_and_b64 s[54:55], s[54:55], vcc
    s_or_b32 s54, s54, 15
    s_ff0_i32_b64 s7, s[54:55]
    s_lshr_b32 s7, s7, 2
    s_max_u32 s37, s37, s7
    s_cmp_gt_u32 s37, 10
    s_cbranch_scc0 C2_h10_s
    s_branch C2_h10_r
C2_h11:
    s_mov_b32 s39, 0
C2_h11_s:
    buffer_load_dwordx2 v[248:249], v51, s[72:75], 0 offen sc1
    s_add_u32 s39, s39, 1
    s_waitcnt vmcnt(0)
    s_cmp_gt_u32 s39, 4096
    s_cbranch_scc1 C2_h11_r
    v_cmp_eq_u32 vcc, v248, v54
    v_cmp_eq_u32 s[54:55], v249, v55
    s_nop 0
    s_and_b64 s[54:55], s[54:55], vcc
    s_or_b32 s54, s54, 15
    s_ff0_i32_b64 s7, s[54:55]
    s_lshr_b32 s7, s7, 2
    s_max_u32 s37, s37, s7
    s_cmp_gt_u32 s37, 11
    s_cbranch_scc0 C2_h11_s
    s_branch C2_h11_r
C2_q10:
    s_mov_b32 s39, 0
C2_q10_s:
    ds_read_b128 v[12:15], v62 offset:48
    s_add_u32 s39, s39, 1
    s_waitcnt lgkmcnt(0)
    v_min3_u32 v12, v12, v13, v14
    v_min_u32 v12, v12, v15
    v_cmp_gt_u32 vcc, 12, v12
    s_cmp_gt_u32 s39, 65536
    s_cbranch_scc1 C2_q10_r
    s_cbranch_vccnz C2_q10_s
    s_branch C2_q10_r
C2_h12:
    s_mov_b32 s39, 0
C2_h12_s:
    buffer_load_dwordx2 v[248:249], v51, s[72:75], 0 offen sc1
    s_add_u32 s39, s39, 1
    s_waitcnt vmcnt(0)
    s_cmp_gt_u32 s39, 4096
    s_cbranch_scc1 C2_h12_r
    v_cmp_eq_u32 vcc, v248, v54
    v_cmp_eq_u32 s[54:55], v249, v55
    s_nop 0
    s_and_b64 s[54:55], s[54:55], vcc
    s_or_b32 s54, s54, 15
    s_ff0_i32_b64 s7, s[54:55]
    s_lshr_b32 s7, s7, 2
    s_max_u32 s37, s37, s7
    s_cmp_gt_u32 s37, 12
    s_cbranch_scc0 C2_h12_s
    s_branch C2_h12_r
C2_q11:
    s_mov_b32 s39, 0
C2_q11_s:
    ds_read_b128 v[12:15], v62 offset:48
    s_add_u32 s39, s39, 1
    s_waitcnt lgkmcnt(0)
    v_min3_u32 v12, v12, v13, v14
    v_min_u32 v12, v12, v15
    v_cmp_gt_u32 vcc, 13, v12
    s_cmp_gt_u32 s39, 65536
    s_cbranch_scc1 C2_q11_r
    s_cbranch_vccnz C2_q11_s
    s_branch C2_q11_r
C2_h13:
    s_mov_b32 s39, 0
C2_h13_s:
    buffer_load_dwordx2 v[248:249], v51, s[72:75], 0 offen sc1
    s_add_u32 s39, s39, 1
    s_waitcnt vmcnt(0)
    s_cmp_gt_u32 s39, 4096
    s_cbranch_scc1 C2_h13_r
    v_cmp_eq_u32 vcc, v248, v54
    v_cmp_eq_u32 s[54:55], v249, v55
    s_nop 0
    s_and_b64 s[54:55], s[54:55], vcc
    s_or_b32 s54, s54, 15
    s_ff0_i32_b64 s7, s[54:55]
    s_lshr_b32 s7, s7, 2
    s_max_u32 s37, s37, s7
    s_cmp_gt_u32 s37, 13
    s_cbranch_scc0 C2_h13_s
    s_branch C2_h13_r
C2_h14:
    s_mov_b32 s39, 0
C2_h14_s:
    buffer_load_dwordx2 v[248:249], v51, s[72:75], 0 offen sc1
    s_add_u32 s39, s39, 1
    s_waitcnt vmcnt(0)
    s_cmp_gt_u32 s39, 4096
    s_cbranch_scc1 C2_h14_r
    v_cmp_eq_u32 vcc, v248, v54
    v_cmp_eq_u32 s[54:55], v249, v55
    s_nop 0
    s_and_b64 s[54:55], s[54:55], vcc
    s_or_b32 s54, s54, 15
    s_ff0_i32_b64 s7, s[54:55]
    s_lshr_b32 s7, s7, 2
    s_max_u32 s37, s37, s7
    s_cmp_gt_u32 s37, 14
    s_cbranch_scc0 C2_h14_s
    s_branch C2_h14_r
C2_q12:
    s_mov_b32 s39, 0
C2_q12_s:
    ds_read_b128 v[12:15], v62 offset:48
    s_add_u32 s39, s39, 1
    s_waitcnt lgkmcnt(0)
    v_min3_u32 v12, v12, v13, v14
    v_min_u32 v12, v12, v15
    v_cmp_gt_u32 vcc, 14, v12
    s_cmp_gt_u32 s39, 65536
    s_cbranch_scc1 C2_q12_r
    s_cbranch_vccnz C2_q12_s
    s_branch C2_q12_r
C2_h15:
    s_mov_b32 s39, 0
C2_h15_s:
    buffer_load_dwordx2 v[248:249], v51, s[72:75], 0 offen sc1
    s_add_u32 s39, s39, 1
    s_waitcnt vmcnt(0)
    s_cmp_gt_u32 s39, 4096
    s_cbranch_scc1 C2_h15_r
    v_cmp_eq_u32 vcc, v248, v54
    v_cmp_eq_u32 s[54:55], v249, v55
    s_nop 0
    s_and_b64 s[54:55], s[54:55], vcc
    s_or_b32 s54, s54, 15
    s_ff0_i32_b64 s7, s[54:55]
    s_lshr_b32 s7, s7, 2
    s_max_u32 s37, s37, s7
    s_cmp_gt_u32 s37, 15
    s_cbranch_scc0 C2_h15_s
    s_branch C2_h15_r
C2_q13:
    s_mov_b32 s39, 0
C2_q13_s:
    ds_read_b128 v[12:15], v62 offset:48
    s_add_u32 s39, s39, 1
    s_waitcnt lgkmcnt(0)
    v_min3_u32 v12, v12, v13, v14
    v_min_u32 v12, v12, v15
    v_cmp_gt_u32 vcc, 16, v12
    s_cmp_gt_u32 s39, 65536
    s_cbranch_scc1 C2_q13_r
    s_cbranch_vccnz C2_q13_s
    s_branch C2_q13_r
K_end:
.section .rodata,"a"
.p2align 6
.amdhsa_kernel concat_heads__ssm_conv_h3__ssm_conv_s5__prompt_kernel
  .amdhsa_next_free_vgpr 252
  .amdhsa_next_free_sgpr 102
  .amdhsa_accum_offset 252
  .amdhsa_group_segment_fixed_size 0
  .amdhsa_kernarg_size 144
  .amdhsa_user_sgpr_count 2
  .amdhsa_user_sgpr_kernarg_segment_ptr 1
  .amdhsa_system_sgpr_workgroup_id_x 1
.end_amdhsa_kernel
```
